```python
import torch

def _softmax(x, axis=-1):
    return torch.softmax(x, dim=axis)
def _gelu(x):
    return torch.nn.functional.gelu(x, approximate="tanh")
def _silu(x):
    return torch.nn.functional.silu(x)
def _sigmoid(x):
    return torch.sigmoid(x)
def _layernorm(x, axis=-1, eps=1e-5):
    m = x.mean(dim=axis, keepdim=True)
    v = x.var(dim=axis, keepdim=True, unbiased=False)
    return (x - m) / torch.sqrt(v + eps)
def _scatter_add(tgt, idx, src, axis=0):
    return tgt.clone().index_add_(axis, idx, src)
def _segment_sum(src, seg, n):
    out = torch.zeros((n,) + src.shape[1:], dtype=src.dtype)
    return out.index_add_(0, seg, src)
def _pad(x, pw):
    flat = tuple(v for pair in reversed(pw) for v in pair)
    return torch.nn.functional.pad(x, flat)

kernel_name = 'interleave_layers__spectral_fnet__glu_gated_glu__prompt'

def setup_inputs():

    _w = (lambda a: (lambda t: t.to(torch.bfloat16) if t.is_floating_point() else t)(torch.as_tensor(a)))
    def _A_setup():
        B, S, D = 1, 2048, 576
        ns = torch.arange(S)[:, None] * torch.arange(S)[None, :]
        nd = torch.arange(D)[:, None] * torch.arange(D)[None, :]
        Ws_re = torch.cos(-2.0 * torch.pi * ns / S).to(float)
        Ws_im = torch.sin(-2.0 * torch.pi * ns / S).to(float)
        Wd_re = torch.cos(-2.0 * torch.pi * nd / D).to(float)
        Wd_im = torch.sin(-2.0 * torch.pi * nd / D).to(float)
        return {
            "x": _w((lambda *s: torch.randn(*s, dtype=torch.bfloat16) * 0.05)(B, S, D)),
            "dft_seq_re": _w(Ws_re),
            "dft_seq_im": _w(Ws_im),
            "dft_hid_re": _w(Wd_re),
            "dft_hid_im": _w(Wd_im),
        }
    _A_in = _A_setup()

    def _B_setup():
        B, S, D, F = 1, 2048, 576, 4608
        return {
            "x": _w((lambda *s: torch.randn(*s, dtype=torch.bfloat16) * 0.05)(B, S, D)),
            "w_gate": _w((lambda *s: torch.randn(*s, dtype=torch.bfloat16) * 1.6)(D, F)),
            "w_up": _w((lambda *s: torch.randn(*s, dtype=torch.bfloat16) * 0.4)(D, F)),
            "w_down": _w((lambda *s: torch.randn(*s, dtype=torch.bfloat16) * 0.4)(F, D)),
        }
    _B_in = _B_setup()

    return {
        "A_x": _A_in["x"],
        "A_dft_seq_re": _A_in["dft_seq_re"],
        "A_dft_seq_im": _A_in["dft_seq_im"],
        "A_dft_hid_re": _A_in["dft_hid_re"],
        "A_dft_hid_im": _A_in["dft_hid_im"],
        "B_x": _B_in["x"],
        "B_w_gate": _B_in["w_gate"],
        "B_w_up": _B_in["w_up"],
        "B_w_down": _B_in["w_down"],
    }

def reference(A_x, A_dft_seq_re, A_dft_seq_im, A_dft_hid_re, A_dft_hid_im, B_x, B_w_gate, B_w_up, B_w_down):
    def _A_ref(x, dft_seq_re, dft_seq_im, dft_hid_re, dft_hid_im):
        a = torch.einsum("bsd,ed->bse", x, dft_hid_re)
        b = torch.einsum("bsd,ed->bse", x, dft_hid_im)
        y = torch.einsum("ts,bse->bte", dft_seq_re, a) - torch.einsum("ts,bse->bte", dft_seq_im, b)
        return y

    def _B_ref(x, w_gate, w_up, w_down):
        g = torch.einsum("bsd,df->bsf", x, w_gate)
        u = torch.einsum("bsd,df->bsf", x, w_up)
        h = _sigmoid(g) * u
        return torch.einsum("bsf,fd->bsd", h, w_down)

    x = A_x
    x = x + _A_ref(_layernorm(x, axis=-1), A_dft_seq_re, A_dft_seq_im, A_dft_hid_re, A_dft_hid_im)
    x = x + _B_ref(_layernorm(x, axis=-1), B_w_gate, B_w_up, B_w_down)
    x = x + _A_ref(_layernorm(x, axis=-1), A_dft_seq_re, A_dft_seq_im, A_dft_hid_re, A_dft_hid_im)
    x = x + _B_ref(_layernorm(x, axis=-1), B_w_gate, B_w_up, B_w_down)
    return x
```

```asm
; @launch kernel=interleave_layers__spectral_fnet__glu_gated_glu__prompt_kernel grid=(256,1,1) block=(512,1,1) lds=157952
.amdgcn_target "amdgcn-amd-amdhsa--gfx950"
.text
.globl interleave_layers__spectral_fnet__glu_gated_glu__prompt_kernel
.p2align 8
.type interleave_layers__spectral_fnet__glu_gated_glu__prompt_kernel,@function
interleave_layers__spectral_fnet__glu_gated_glu__prompt_kernel:
    s_cmp_ge_u32 s2, 256
    s_cbranch_scc1 L_end_interleave_layers__spectral_fnet__glu_gated_glu__prompt_kernel
    s_setprio 3
    s_load_dwordx2 s[4:5], s[0:1], 88
    s_load_dwordx2 s[8:9], s[0:1], 24
    s_load_dwordx2 s[10:11], s[0:1], 32
    s_load_dwordx2 s[48:49], s[0:1], 0
    s_load_dwordx2 s[56:57], s[0:1], 8
    s_load_dwordx2 s[58:59], s[0:1], 16
    v_and_b32 v1, 63, v0
    v_lshrrev_b32 v2, 6, v0
    s_nop 0
    v_readfirstlane_b32 s28, v2
    s_and_b32 s34, s2, 7
    s_lshr_b32 s35, s2, 3
    s_mov_b32 s38, s34
    s_mov_b32 s37, s35
    s_lshl_b32 s29, s28, 10
    s_lshl_b32 s30, s28, 8
    v_lshrrev_b32 v2, 3, v1
    s_lshl_b32 s33, s28, 3
    v_add_u32 v2, s33, v2
    v_bfe_u32 v3, v2, 1, 3
    v_and_b32 v4, 7, v1
    v_xor_b32 v3, v3, v4
    v_mul_u32_u24 v8, 1152, v2
    v_lshl_add_u32 v8, v3, 4, v8
    v_mul_u32_u24 v9, 1152, v2
    v_lshl_add_u32 v9, v3, 4, v9
    v_lshrrev_b32 v2, 3, v1
    s_lshl_b32 s33, s28, 1
    s_add_u32 s33, s33, 128
    v_add_u32 v2, s33, v2
    v_bfe_u32 v3, v2, 1, 3
    v_xor_b32 v3, v3, v4
    v_mul_u32_u24 v11, 1152, v2
    v_lshl_add_u32 v11, v3, 4, v11
    v_subrev_u32 v10, 36864, v9
    v_lshrrev_b32 v2, 3, v1
    s_and_b32 s33, s28, 3
    s_lshl_b32 s41, s33, 9
    s_lshl_b32 s33, s33, 2
    s_add_u32 s33, s33, 128
    v_add_u32 v2, s33, v2
    v_bfe_u32 v3, v2, 1, 3
    v_xor_b32 v3, v3, v4
    v_mul_u32_u24 v8, 1152, v2
    v_lshl_add_u32 v8, v3, 4, v8
    s_mov_b32 s31, 0
    s_mov_b32 s32, 0
    s_waitcnt lgkmcnt(0)
    s_mul_i32 s44, s37, 73728
    s_add_u32 s12, s48, 0x0
    s_addc_u32 s13, s49, 0
    s_add_u32 s12, s12, s44
    s_addc_u32 s13, s13, 0
    s_sub_u32 s14, 0x240000, s44
    s_and_b32 s13, s13, 0xffff
    s_mov_b32 s15, 0x20000
    s_mul_i32 s44, s28, 9216
    v_lshl_add_u32 v2, v1, 4, s44
    v_lshrrev_b32 v3, 3, v1
    v_mul_u32_u24 v3, 1152, v3
    v_and_b32 v4, 7, v1
    v_lshl_add_u32 v3, v4, 4, v3
    v_add_u32 v3, s44, v3
    s_mov_b32 s44, 0
    buffer_load_dwordx4 v[40:43], v2, s[12:15], s44 offen
    s_mov_b32 s44, 1152
    buffer_load_dwordx4 v[56:59], v2, s[12:15], s44 offen
    s_mov_b32 s44, 2304
    buffer_load_dwordx4 v[72:75], v2, s[12:15], s44 offen
    s_mov_b32 s44, 3456
    buffer_load_dwordx4 v[88:91], v2, s[12:15], s44 offen
    s_mov_b32 s44, 4608
    buffer_load_dwordx4 v[104:107], v2, s[12:15], s44 offen
    s_mov_b32 s44, 5760
    buffer_load_dwordx4 v[120:123], v2, s[12:15], s44 offen
    s_mov_b32 s44, 6912
    buffer_load_dwordx4 v[136:139], v2, s[12:15], s44 offen
    s_mov_b32 s44, 8064
    buffer_load_dwordx4 v[152:155], v2, s[12:15], s44 offen
    buffer_load_dwordx4 v[168:171], v3, s[12:15], 0 offen offset:1024
    s_getpc_b64 s[72:73]
LPC_rompt_kernel_1:
    s_sub_u32 s72, s72, LPC_rompt_kernel_1-interleave_layers__spectral_fnet__glu_gated_glu__prompt_kernel
    s_subb_u32 s73, s73, 0
    s_and_b32 s73, s73, 0xffff
    s_mov_b32 s74, L_end_interleave_layers__spectral_fnet__glu_gated_glu__prompt_kernel-interleave_layers__spectral_fnet__glu_gated_glu__prompt_kernel
    s_mov_b32 s75, 0x20000
    s_lshr_b32 s33, s2, 3
    s_and_b32 s33, s33, 1
    s_lshl_b32 s33, s33, 3
    s_add_u32 s33, s33, s28
    s_lshl_b32 s33, s33, 13
    v_lshl_add_u32 v2, v1, 7, s33
    buffer_load_dword v196, v2, s[72:75], 0 offen
    s_cmp_lt_u32 s38, 4
    s_cselect_b32 s6, s8, s10
    s_cselect_b32 s7, s9, s11
    s_and_b32 s45, s38, 3
    s_mul_i32 s44, s45, 165888
    s_add_u32 s16, s6, 0x0
    s_addc_u32 s17, s7, 0
    s_add_u32 s16, s16, s44
    s_addc_u32 s17, s17, 0
    s_sub_u32 s18, 0xa2000, s44
    s_and_b32 s17, s17, 0xffff
    s_mov_b32 s19, 0x20000
    s_add_u32 m0, s29, 0x12000
    s_nop 0
    buffer_load_dwordx4 v9, s[16:19], s32 offen lds
    s_add_u32 m0, s29, 0x14000
    s_add_u32 s33, s32, 0x12000
    buffer_load_dwordx4 v9, s[16:19], s33 offen lds
    s_add_u32 m0, s30, 0x16000
    s_nop 0
    s_mov_b64 exec, 0xffff
    buffer_load_dwordx4 v11, s[16:19], s32 offen lds
    s_mov_b64 exec, -1
    s_add_u32 s32, s32, 0x80
    s_add_u32 m0, s29, 0x16800
    s_nop 0
    buffer_load_dwordx4 v9, s[16:19], s32 offen lds
    s_add_u32 m0, s29, 0x18800
    s_add_u32 s33, s32, 0x12000
    buffer_load_dwordx4 v9, s[16:19], s33 offen lds
    s_add_u32 m0, s30, 0x1a800
    s_nop 0
    s_mov_b64 exec, 0xffff
    buffer_load_dwordx4 v11, s[16:19], s32 offen lds
    s_mov_b64 exec, -1
    s_add_u32 s32, s32, 0x80
    s_lshl_b32 s64, s2, 3
    s_add_u32 s64, s64, s28
    s_mul_i32 s64, s64, 8192
    s_mov_b32 s60, s56
    s_mov_b32 s61, s57
    s_mov_b32 s62, 0x800000
    s_cmp_ge_u32 s64, 0x800000
    s_cselect_b32 s60, s58, s60
    s_cselect_b32 s61, s59, s61
    s_cselect_b32 s65, 0x800000, 0
    s_sub_u32 s64, s64, s65
    s_and_b32 s61, s61, 0xffff
    s_mov_b32 s63, 0x20000
    v_mul_u32_u24 v197, 128, v1
    v_add_u32 v197, s64, v197
    s_and_b32 s33, s28, 3
    s_mul_i32 s33, s33, 2048
    v_and_b32 v2, 15, v1
    v_lshrrev_b32 v3, 4, v1
    v_bfe_u32 v4, v1, 1, 3
    v_xor_b32 v4, v3, v4
    v_lshlrev_b32 v4, 4, v4
    v_lshl_add_u32 v4, v2, 7, v4
    v_add_u32 v5, s33, v4
    v_add_u32 v12, 0x0, v5
    v_xor_b32 v13, 64, v12
    v_add_u32 v16, 0x10000, v5
    v_xor_b32 v17, 64, v16
    v_add_u32 v20, 0x20000, v5
    v_xor_b32 v21, 64, v20
    v_add_u32 v24, 0x30000, v5
    v_xor_b32 v25, 64, v24
    v_add_u32 v14, 0x12000, v4
    v_xor_b32 v15, 64, v14
    v_add_u32 v18, 0x16800, v4
    v_xor_b32 v19, 64, v18
    v_add_u32 v22, 0x1b000, v4
    v_xor_b32 v23, 64, v22
    v_add_u32 v26, 0x1f800, v4
    v_xor_b32 v27, 64, v26
    s_and_b32 s33, s28, 3
    s_mul_i32 s33, s33, 16
    v_and_b32 v5, 15, v1
    v_add_u32 v5, s33, v5
    v_lshrrev_b32 v6, 4, v1
    v_mul_u32_u24 v5, 288, v5
    v_and_b32 v2, 1, v6
    v_lshl_add_u32 v7, v2, 5, v5
    v_lshrrev_b32 v2, 1, v6
    v_lshl_add_u32 v7, v2, 4, v7
    v_lshl_add_u32 v6, v6, 3, v5
    s_lshr_b32 s45, s38, 2
    s_lshl_b32 s44, s38, 5
    s_add_u32 s44, s44, s37
    s_mul_i32 s44, s44, 18432
    s_add_u32 s24, s4, 0xc00000
    s_addc_u32 s25, s5, 0
    s_add_u32 s24, s24, s44
    s_addc_u32 s25, s25, 0
    s_sub_u32 s26, 0x480000, s44
    s_and_b32 s25, s25, 0xffff
    s_mov_b32 s27, 0x20000
    s_mov_b32 s26, 18432
    s_mul_i32 s47, s45, 0x80008000
    v_lshrrev_b32 v2, 3, v1
    v_and_b32 v3, 7, v1
    v_lshlrev_b32 v3, 4, v3
    v_lshl_add_u32 v4, v2, 13, v3
    v_add_u32 v4, s29, v4
    s_lshl_b32 s44, s28, 2
    s_add_u32 s44, s44, 0
    s_and_b32 s44, s44, 7
    s_lshl_b32 s44, s44, 4
    v_xor_b32 v176, s44, v4
    s_lshl_b32 s44, s28, 2
    s_add_u32 s44, s44, 1
    s_and_b32 s44, s44, 7
    s_lshl_b32 s44, s44, 4
    v_xor_b32 v177, s44, v4
    s_lshl_b32 s44, s28, 2
    s_add_u32 s44, s44, 2
    s_and_b32 s44, s44, 7
    s_lshl_b32 s44, s44, 4
    v_xor_b32 v178, s44, v4
    s_lshl_b32 s44, s28, 2
    s_add_u32 s44, s44, 3
    s_and_b32 s44, s44, 7
    s_lshl_b32 s44, s44, 4
    v_xor_b32 v179, s44, v4
    s_lshl_b32 s44, s28, 2
    v_lshrrev_b32 v4, 4, v1
    v_add_u32 v4, s44, v4
    v_and_b32 v4, 7, v4
    v_lshlrev_b32 v4, 4, v4
    v_xor_b32 v4, v4, v3
    v_lshl_add_u32 v4, v2, 7, v4
    v_add_u32 v4, s29, v4
    v_add_u32 v180, 0x10000, v4
    v_cmp_eq_u32 vcc, 0, v2
    s_nop 1
    v_cndmask_b32 v181, 0, 1.0, vcc
    v_cmp_eq_u32 vcc, 1, v2
    s_nop 1
    v_cndmask_b32 v182, 0, 1.0, vcc
    v_cmp_eq_u32 vcc, 2, v2
    s_nop 1
    v_cndmask_b32 v183, 0, 1.0, vcc
    v_cmp_eq_u32 vcc, 3, v2
    s_nop 1
    v_cndmask_b32 v184, 0, 1.0, vcc
    v_cmp_eq_u32 vcc, 4, v2
    s_nop 1
    v_cndmask_b32 v185, 0, 1.0, vcc
    v_cmp_eq_u32 vcc, 5, v2
    s_nop 1
    v_cndmask_b32 v186, 0, 1.0, vcc
    v_cmp_eq_u32 vcc, 6, v2
    s_nop 1
    v_cndmask_b32 v187, 0, 1.0, vcc
    v_cmp_eq_u32 vcc, 7, v2
    s_nop 1
    v_cndmask_b32 v188, 0, 1.0, vcc
    s_setprio 0
    s_waitcnt vmcnt(7)
    s_add_u32 m0, s29, 0x1b000
    s_nop 0
    buffer_load_dwordx4 v9, s[16:19], s32 offen lds
    s_add_u32 m0, s29, 0x1d000
    s_add_u32 s33, s32, 0x12000
    buffer_load_dwordx4 v9, s[16:19], s33 offen lds
    s_add_u32 m0, s30, 0x1f000
    s_nop 0
    s_mov_b64 exec, 0xffff
    buffer_load_dwordx4 v11, s[16:19], s32 offen lds
    s_mov_b64 exec, -1
    s_add_u32 s32, s32, 0x80
    s_add_u32 m0, s29, 0x1f800
    s_nop 0
    buffer_load_dwordx4 v9, s[16:19], s32 offen lds
    s_add_u32 m0, s29, 0x21800
    s_add_u32 s33, s32, 0x12000
    buffer_load_dwordx4 v9, s[16:19], s33 offen lds
    s_add_u32 m0, s30, 0x23800
    s_nop 0
    s_mov_b64 exec, 0xffff
    buffer_load_dwordx4 v11, s[16:19], s32 offen lds
    s_mov_b64 exec, -1
    s_add_u32 s32, s32, 0x80
    buffer_load_dword v196, v197, s[60:63], 0 offen
    v_lshlrev_b32 v32, 16, v40
    v_lshlrev_b32 v48, 16, v56
    v_lshlrev_b32 v64, 16, v72
    v_lshlrev_b32 v80, 16, v88
    v_lshlrev_b32 v96, 16, v104
    v_lshlrev_b32 v112, 16, v120
    v_lshlrev_b32 v128, 16, v136
    v_lshlrev_b32 v144, 16, v152
    v_lshlrev_b32 v160, 16, v168
    v_and_b32 v33, 0xffff0000, v40
    v_and_b32 v49, 0xffff0000, v56
    v_and_b32 v65, 0xffff0000, v72
    v_and_b32 v81, 0xffff0000, v88
    v_and_b32 v97, 0xffff0000, v104
    v_and_b32 v113, 0xffff0000, v120
    v_and_b32 v129, 0xffff0000, v136
    v_and_b32 v145, 0xffff0000, v152
    v_and_b32 v161, 0xffff0000, v168
    v_lshlrev_b32 v34, 16, v41
    v_lshlrev_b32 v50, 16, v57
    v_lshlrev_b32 v66, 16, v73
    v_lshlrev_b32 v82, 16, v89
    v_lshlrev_b32 v98, 16, v105
    v_lshlrev_b32 v114, 16, v121
    v_lshlrev_b32 v130, 16, v137
    v_lshlrev_b32 v146, 16, v153
    v_lshlrev_b32 v162, 16, v169
    v_and_b32 v35, 0xffff0000, v41
    v_and_b32 v51, 0xffff0000, v57
    v_and_b32 v67, 0xffff0000, v73
    v_and_b32 v83, 0xffff0000, v89
    v_and_b32 v99, 0xffff0000, v105
    v_and_b32 v115, 0xffff0000, v121
    v_and_b32 v131, 0xffff0000, v137
    v_and_b32 v147, 0xffff0000, v153
    v_and_b32 v163, 0xffff0000, v169
    v_lshlrev_b32 v36, 16, v42
    v_lshlrev_b32 v52, 16, v58
    v_lshlrev_b32 v68, 16, v74
    v_lshlrev_b32 v84, 16, v90
    v_lshlrev_b32 v100, 16, v106
    v_lshlrev_b32 v116, 16, v122
    v_lshlrev_b32 v132, 16, v138
    v_lshlrev_b32 v148, 16, v154
    v_lshlrev_b32 v164, 16, v170
    v_and_b32 v37, 0xffff0000, v42
    v_and_b32 v53, 0xffff0000, v58
    v_and_b32 v69, 0xffff0000, v74
    v_and_b32 v85, 0xffff0000, v90
    v_and_b32 v101, 0xffff0000, v106
    v_and_b32 v117, 0xffff0000, v122
    v_and_b32 v133, 0xffff0000, v138
    v_and_b32 v149, 0xffff0000, v154
    v_and_b32 v165, 0xffff0000, v170
    v_lshlrev_b32 v38, 16, v43
    v_lshlrev_b32 v54, 16, v59
    v_lshlrev_b32 v70, 16, v75
    v_lshlrev_b32 v86, 16, v91
    v_lshlrev_b32 v102, 16, v107
    v_lshlrev_b32 v118, 16, v123
    v_lshlrev_b32 v134, 16, v139
    v_lshlrev_b32 v150, 16, v155
    v_lshlrev_b32 v166, 16, v171
    v_and_b32 v39, 0xffff0000, v43
    v_and_b32 v55, 0xffff0000, v59
    v_and_b32 v71, 0xffff0000, v75
    v_and_b32 v87, 0xffff0000, v91
    v_and_b32 v103, 0xffff0000, v107
    v_and_b32 v119, 0xffff0000, v123
    v_and_b32 v135, 0xffff0000, v139
    v_and_b32 v151, 0xffff0000, v155
    v_and_b32 v167, 0xffff0000, v171
    v_pk_add_f32 v[40:41], v[32:33], v[34:35]
    v_pk_add_f32 v[56:57], v[48:49], v[50:51]
    v_pk_add_f32 v[72:73], v[64:65], v[66:67]
    v_pk_add_f32 v[88:89], v[80:81], v[82:83]
    v_pk_add_f32 v[104:105], v[96:97], v[98:99]
    v_pk_add_f32 v[120:121], v[112:113], v[114:115]
    v_pk_add_f32 v[136:137], v[128:129], v[130:131]
    v_pk_add_f32 v[152:153], v[144:145], v[146:147]
    v_pk_add_f32 v[168:169], v[160:161], v[162:163]
    v_pk_add_f32 v[42:43], v[36:37], v[38:39]
    v_pk_add_f32 v[58:59], v[52:53], v[54:55]
    v_pk_add_f32 v[74:75], v[68:69], v[70:71]
    v_pk_add_f32 v[90:91], v[84:85], v[86:87]
    v_pk_add_f32 v[106:107], v[100:101], v[102:103]
    v_pk_add_f32 v[122:123], v[116:117], v[118:119]
    v_pk_add_f32 v[138:139], v[132:133], v[134:135]
    v_pk_add_f32 v[154:155], v[148:149], v[150:151]
    v_pk_add_f32 v[170:171], v[164:165], v[166:167]
    v_pk_add_f32 v[40:41], v[40:41], v[42:43]
    v_pk_add_f32 v[56:57], v[56:57], v[58:59]
    v_pk_add_f32 v[72:73], v[72:73], v[74:75]
    v_pk_add_f32 v[88:89], v[88:89], v[90:91]
    v_pk_add_f32 v[104:105], v[104:105], v[106:107]
    v_pk_add_f32 v[120:121], v[120:121], v[122:123]
    v_pk_add_f32 v[136:137], v[136:137], v[138:139]
    v_pk_add_f32 v[152:153], v[152:153], v[154:155]
    v_pk_add_f32 v[168:169], v[168:169], v[170:171]
    v_add_f32 v44, v40, v41
    v_add_f32 v60, v56, v57
    v_add_f32 v76, v72, v73
    v_add_f32 v92, v88, v89
    v_add_f32 v108, v104, v105
    v_add_f32 v124, v120, v121
    v_add_f32 v140, v136, v137
    v_add_f32 v156, v152, v153
    v_add_f32 v172, v168, v169
    v_fmac_f32 v44, v181, v172
    v_fmac_f32 v60, v182, v172
    v_fmac_f32 v76, v183, v172
    v_fmac_f32 v92, v184, v172
    v_fmac_f32 v108, v185, v172
    v_fmac_f32 v124, v186, v172
    v_fmac_f32 v140, v187, v172
    v_fmac_f32 v156, v188, v172
    v_add_f32_dpp v44, v44, v44 quad_perm:[1,0,3,2] row_mask:0xf bank_mask:0xf
    v_add_f32_dpp v60, v60, v60 quad_perm:[1,0,3,2] row_mask:0xf bank_mask:0xf
    v_add_f32_dpp v76, v76, v76 quad_perm:[1,0,3,2] row_mask:0xf bank_mask:0xf
    v_add_f32_dpp v92, v92, v92 quad_perm:[1,0,3,2] row_mask:0xf bank_mask:0xf
    v_add_f32_dpp v108, v108, v108 quad_perm:[1,0,3,2] row_mask:0xf bank_mask:0xf
    v_add_f32_dpp v124, v124, v124 quad_perm:[1,0,3,2] row_mask:0xf bank_mask:0xf
    v_add_f32_dpp v140, v140, v140 quad_perm:[1,0,3,2] row_mask:0xf bank_mask:0xf
    v_add_f32_dpp v156, v156, v156 quad_perm:[1,0,3,2] row_mask:0xf bank_mask:0xf
    v_add_f32_dpp v44, v44, v44 quad_perm:[2,3,0,1] row_mask:0xf bank_mask:0xf
    v_add_f32_dpp v60, v60, v60 quad_perm:[2,3,0,1] row_mask:0xf bank_mask:0xf
    v_add_f32_dpp v76, v76, v76 quad_perm:[2,3,0,1] row_mask:0xf bank_mask:0xf
    v_add_f32_dpp v92, v92, v92 quad_perm:[2,3,0,1] row_mask:0xf bank_mask:0xf
    v_add_f32_dpp v108, v108, v108 quad_perm:[2,3,0,1] row_mask:0xf bank_mask:0xf
    v_add_f32_dpp v124, v124, v124 quad_perm:[2,3,0,1] row_mask:0xf bank_mask:0xf
    v_add_f32_dpp v140, v140, v140 quad_perm:[2,3,0,1] row_mask:0xf bank_mask:0xf
    v_add_f32_dpp v156, v156, v156 quad_perm:[2,3,0,1] row_mask:0xf bank_mask:0xf
    v_add_f32_dpp v44, v44, v44 row_half_mirror row_mask:0xf bank_mask:0xf
    v_add_f32_dpp v60, v60, v60 row_half_mirror row_mask:0xf bank_mask:0xf
    v_add_f32_dpp v76, v76, v76 row_half_mirror row_mask:0xf bank_mask:0xf
    v_add_f32_dpp v92, v92, v92 row_half_mirror row_mask:0xf bank_mask:0xf
    v_add_f32_dpp v108, v108, v108 row_half_mirror row_mask:0xf bank_mask:0xf
    v_add_f32_dpp v124, v124, v124 row_half_mirror row_mask:0xf bank_mask:0xf
    v_add_f32_dpp v140, v140, v140 row_half_mirror row_mask:0xf bank_mask:0xf
    v_add_f32_dpp v156, v156, v156 row_half_mirror row_mask:0xf bank_mask:0xf
    v_add_f32_dpp v44, v44, v44 row_mirror row_mask:0xf bank_mask:0xf
    v_add_f32_dpp v60, v60, v60 row_mirror row_mask:0xf bank_mask:0xf
    v_add_f32_dpp v76, v76, v76 row_mirror row_mask:0xf bank_mask:0xf
    v_add_f32_dpp v92, v92, v92 row_mirror row_mask:0xf bank_mask:0xf
    v_add_f32_dpp v108, v108, v108 row_mirror row_mask:0xf bank_mask:0xf
    v_add_f32_dpp v124, v124, v124 row_mirror row_mask:0xf bank_mask:0xf
    v_add_f32_dpp v140, v140, v140 row_mirror row_mask:0xf bank_mask:0xf
    v_add_f32_dpp v156, v156, v156 row_mirror row_mask:0xf bank_mask:0xf
    v_mov_b32 v45, v44
    v_mov_b32 v61, v60
    v_mov_b32 v77, v76
    v_mov_b32 v93, v92
    v_mov_b32 v109, v108
    v_mov_b32 v125, v124
    v_mov_b32 v141, v140
    v_mov_b32 v157, v156
    v_permlane16_swap_b32 v44, v45
    v_permlane16_swap_b32 v60, v61
    v_permlane16_swap_b32 v76, v77
    v_permlane16_swap_b32 v92, v93
    v_permlane16_swap_b32 v108, v109
    v_permlane16_swap_b32 v124, v125
    v_permlane16_swap_b32 v140, v141
    v_permlane16_swap_b32 v156, v157
    v_add_f32 v44, v44, v45
    v_add_f32 v60, v60, v61
    v_add_f32 v76, v76, v77
    v_add_f32 v92, v92, v93
    v_add_f32 v108, v108, v109
    v_add_f32 v124, v124, v125
    v_add_f32 v140, v140, v141
    v_add_f32 v156, v156, v157
    v_mov_b32 v45, v44
    v_mov_b32 v61, v60
    v_mov_b32 v77, v76
    v_mov_b32 v93, v92
    v_mov_b32 v109, v108
    v_mov_b32 v125, v124
    v_mov_b32 v141, v140
    v_mov_b32 v157, v156
    v_permlane32_swap_b32 v44, v45
    v_permlane32_swap_b32 v60, v61
    v_permlane32_swap_b32 v76, v77
    v_permlane32_swap_b32 v92, v93
    v_permlane32_swap_b32 v108, v109
    v_permlane32_swap_b32 v124, v125
    v_permlane32_swap_b32 v140, v141
    v_permlane32_swap_b32 v156, v157
    v_add_f32 v44, v44, v45
    v_add_f32 v60, v60, v61
    v_add_f32 v76, v76, v77
    v_add_f32 v92, v92, v93
    v_add_f32 v108, v108, v109
    v_add_f32 v124, v124, v125
    v_add_f32 v140, v140, v141
    v_add_f32 v156, v156, v157
    v_mul_f32 v44, 0xbae38e39, v44
    v_mul_f32 v60, 0xbae38e39, v60
    v_mul_f32 v76, 0xbae38e39, v76
    v_mul_f32 v92, 0xbae38e39, v92
    v_mul_f32 v108, 0xbae38e39, v108
    v_mul_f32 v124, 0xbae38e39, v124
    v_mul_f32 v140, 0xbae38e39, v140
    v_mul_f32 v156, 0xbae38e39, v156
    v_mul_f32 v172, v181, v44
    v_fmac_f32 v172, v182, v60
    v_fmac_f32 v172, v183, v76
    v_fmac_f32 v172, v184, v92
    v_fmac_f32 v172, v185, v108
    v_fmac_f32 v172, v186, v124
    v_fmac_f32 v172, v187, v140
    v_fmac_f32 v172, v188, v156
    v_cvt_pk_bf16_f32 v45, v44, v44
    v_cvt_pk_bf16_f32 v61, v60, v60
    v_cvt_pk_bf16_f32 v77, v76, v76
    v_cvt_pk_bf16_f32 v93, v92, v92
    v_cvt_pk_bf16_f32 v109, v108, v108
    v_cvt_pk_bf16_f32 v125, v124, v124
    v_cvt_pk_bf16_f32 v141, v140, v140
    v_cvt_pk_bf16_f32 v157, v156, v156
    v_cvt_pk_bf16_f32 v173, v172, v172
    v_lshlrev_b32 v45, 16, v45
    v_lshlrev_b32 v61, 16, v61
    v_lshlrev_b32 v77, 16, v77
    v_lshlrev_b32 v93, 16, v93
    v_lshlrev_b32 v109, 16, v109
    v_lshlrev_b32 v125, 16, v125
    v_lshlrev_b32 v141, 16, v141
    v_lshlrev_b32 v157, 16, v157
    v_lshlrev_b32 v173, 16, v173
    v_sub_f32 v46, v45, v44
    v_sub_f32 v62, v61, v60
    v_sub_f32 v78, v77, v76
    v_sub_f32 v94, v93, v92
    v_sub_f32 v110, v109, v108
    v_sub_f32 v126, v125, v124
    v_sub_f32 v142, v141, v140
    v_sub_f32 v158, v157, v156
    v_mov_b32 v44, v45
    v_mov_b32 v60, v61
    v_mov_b32 v76, v77
    v_mov_b32 v92, v93
    v_mov_b32 v108, v109
    v_mov_b32 v124, v125
    v_mov_b32 v140, v141
    v_mov_b32 v156, v157
    v_mov_b32 v172, v173
    v_pk_add_f32 v[32:33], v[32:33], v[44:45]
    v_pk_add_f32 v[48:49], v[48:49], v[60:61]
    v_pk_add_f32 v[64:65], v[64:65], v[76:77]
    v_pk_add_f32 v[80:81], v[80:81], v[92:93]
    v_pk_add_f32 v[96:97], v[96:97], v[108:109]
    v_pk_add_f32 v[112:113], v[112:113], v[124:125]
    v_pk_add_f32 v[128:129], v[128:129], v[140:141]
    v_pk_add_f32 v[144:145], v[144:145], v[156:157]
    v_pk_add_f32 v[160:161], v[160:161], v[172:173]
    v_pk_add_f32 v[34:35], v[34:35], v[44:45]
    v_pk_add_f32 v[50:51], v[50:51], v[60:61]
    v_pk_add_f32 v[66:67], v[66:67], v[76:77]
    v_pk_add_f32 v[82:83], v[82:83], v[92:93]
    v_pk_add_f32 v[98:99], v[98:99], v[108:109]
    v_pk_add_f32 v[114:115], v[114:115], v[124:125]
    v_pk_add_f32 v[130:131], v[130:131], v[140:141]
    v_pk_add_f32 v[146:147], v[146:147], v[156:157]
    v_pk_add_f32 v[162:163], v[162:163], v[172:173]
    v_pk_add_f32 v[36:37], v[36:37], v[44:45]
    v_pk_add_f32 v[52:53], v[52:53], v[60:61]
    v_pk_add_f32 v[68:69], v[68:69], v[76:77]
    v_pk_add_f32 v[84:85], v[84:85], v[92:93]
    v_pk_add_f32 v[100:101], v[100:101], v[108:109]
    v_pk_add_f32 v[116:117], v[116:117], v[124:125]
    v_pk_add_f32 v[132:133], v[132:133], v[140:141]
    v_pk_add_f32 v[148:149], v[148:149], v[156:157]
    v_pk_add_f32 v[164:165], v[164:165], v[172:173]
    v_pk_add_f32 v[38:39], v[38:39], v[44:45]
    v_pk_add_f32 v[54:55], v[54:55], v[60:61]
    v_pk_add_f32 v[70:71], v[70:71], v[76:77]
    v_pk_add_f32 v[86:87], v[86:87], v[92:93]
    v_pk_add_f32 v[102:103], v[102:103], v[108:109]
    v_pk_add_f32 v[118:119], v[118:119], v[124:125]
    v_pk_add_f32 v[134:135], v[134:135], v[140:141]
    v_pk_add_f32 v[150:151], v[150:151], v[156:157]
    v_pk_add_f32 v[166:167], v[166:167], v[172:173]
    v_pk_mul_f32 v[40:41], v[32:33], v[32:33]
    v_pk_mul_f32 v[56:57], v[48:49], v[48:49]
    v_pk_mul_f32 v[72:73], v[64:65], v[64:65]
    v_pk_mul_f32 v[88:89], v[80:81], v[80:81]
    v_pk_mul_f32 v[104:105], v[96:97], v[96:97]
    v_pk_mul_f32 v[120:121], v[112:113], v[112:113]
    v_pk_mul_f32 v[136:137], v[128:129], v[128:129]
    v_pk_mul_f32 v[152:153], v[144:145], v[144:145]
    v_pk_mul_f32 v[168:169], v[160:161], v[160:161]
    v_pk_mul_f32 v[42:43], v[34:35], v[34:35]
    v_pk_mul_f32 v[58:59], v[50:51], v[50:51]
    v_pk_mul_f32 v[74:75], v[66:67], v[66:67]
    v_pk_mul_f32 v[90:91], v[82:83], v[82:83]
    v_pk_mul_f32 v[106:107], v[98:99], v[98:99]
    v_pk_mul_f32 v[122:123], v[114:115], v[114:115]
    v_pk_mul_f32 v[138:139], v[130:131], v[130:131]
    v_pk_mul_f32 v[154:155], v[146:147], v[146:147]
    v_pk_mul_f32 v[170:171], v[162:163], v[162:163]
    v_pk_fma_f32 v[40:41], v[36:37], v[36:37], v[40:41]
    v_pk_fma_f32 v[56:57], v[52:53], v[52:53], v[56:57]
    v_pk_fma_f32 v[72:73], v[68:69], v[68:69], v[72:73]
    v_pk_fma_f32 v[88:89], v[84:85], v[84:85], v[88:89]
    v_pk_fma_f32 v[104:105], v[100:101], v[100:101], v[104:105]
    v_pk_fma_f32 v[120:121], v[116:117], v[116:117], v[120:121]
    v_pk_fma_f32 v[136:137], v[132:133], v[132:133], v[136:137]
    v_pk_fma_f32 v[152:153], v[148:149], v[148:149], v[152:153]
    v_pk_fma_f32 v[168:169], v[164:165], v[164:165], v[168:169]
    v_pk_fma_f32 v[42:43], v[38:39], v[38:39], v[42:43]
    v_pk_fma_f32 v[58:59], v[54:55], v[54:55], v[58:59]
    v_pk_fma_f32 v[74:75], v[70:71], v[70:71], v[74:75]
    v_pk_fma_f32 v[90:91], v[86:87], v[86:87], v[90:91]
    v_pk_fma_f32 v[106:107], v[102:103], v[102:103], v[106:107]
    v_pk_fma_f32 v[122:123], v[118:119], v[118:119], v[122:123]
    v_pk_fma_f32 v[138:139], v[134:135], v[134:135], v[138:139]
    v_pk_fma_f32 v[154:155], v[150:151], v[150:151], v[154:155]
    v_pk_fma_f32 v[170:171], v[166:167], v[166:167], v[170:171]
    v_pk_add_f32 v[40:41], v[40:41], v[42:43]
    v_pk_add_f32 v[56:57], v[56:57], v[58:59]
    v_pk_add_f32 v[72:73], v[72:73], v[74:75]
    v_pk_add_f32 v[88:89], v[88:89], v[90:91]
    v_pk_add_f32 v[104:105], v[104:105], v[106:107]
    v_pk_add_f32 v[120:121], v[120:121], v[122:123]
    v_pk_add_f32 v[136:137], v[136:137], v[138:139]
    v_pk_add_f32 v[152:153], v[152:153], v[154:155]
    v_pk_add_f32 v[168:169], v[168:169], v[170:171]
    v_add_f32 v44, v40, v41
    v_add_f32 v60, v56, v57
    v_add_f32 v76, v72, v73
    v_add_f32 v92, v88, v89
    v_add_f32 v108, v104, v105
    v_add_f32 v124, v120, v121
    v_add_f32 v140, v136, v137
    v_add_f32 v156, v152, v153
    v_add_f32 v172, v168, v169
    v_fmac_f32 v44, v181, v172
    v_fmac_f32 v60, v182, v172
    v_fmac_f32 v76, v183, v172
    v_fmac_f32 v92, v184, v172
    v_fmac_f32 v108, v185, v172
    v_fmac_f32 v124, v186, v172
    v_fmac_f32 v140, v187, v172
    v_fmac_f32 v156, v188, v172
    v_add_f32_dpp v44, v44, v44 quad_perm:[1,0,3,2] row_mask:0xf bank_mask:0xf
    v_add_f32_dpp v60, v60, v60 quad_perm:[1,0,3,2] row_mask:0xf bank_mask:0xf
    v_add_f32_dpp v76, v76, v76 quad_perm:[1,0,3,2] row_mask:0xf bank_mask:0xf
    v_add_f32_dpp v92, v92, v92 quad_perm:[1,0,3,2] row_mask:0xf bank_mask:0xf
    v_add_f32_dpp v108, v108, v108 quad_perm:[1,0,3,2] row_mask:0xf bank_mask:0xf
    v_add_f32_dpp v124, v124, v124 quad_perm:[1,0,3,2] row_mask:0xf bank_mask:0xf
    v_add_f32_dpp v140, v140, v140 quad_perm:[1,0,3,2] row_mask:0xf bank_mask:0xf
    v_add_f32_dpp v156, v156, v156 quad_perm:[1,0,3,2] row_mask:0xf bank_mask:0xf
    v_add_f32_dpp v44, v44, v44 quad_perm:[2,3,0,1] row_mask:0xf bank_mask:0xf
    v_add_f32_dpp v60, v60, v60 quad_perm:[2,3,0,1] row_mask:0xf bank_mask:0xf
    v_add_f32_dpp v76, v76, v76 quad_perm:[2,3,0,1] row_mask:0xf bank_mask:0xf
    v_add_f32_dpp v92, v92, v92 quad_perm:[2,3,0,1] row_mask:0xf bank_mask:0xf
    v_add_f32_dpp v108, v108, v108 quad_perm:[2,3,0,1] row_mask:0xf bank_mask:0xf
    v_add_f32_dpp v124, v124, v124 quad_perm:[2,3,0,1] row_mask:0xf bank_mask:0xf
    v_add_f32_dpp v140, v140, v140 quad_perm:[2,3,0,1] row_mask:0xf bank_mask:0xf
    v_add_f32_dpp v156, v156, v156 quad_perm:[2,3,0,1] row_mask:0xf bank_mask:0xf
    v_add_f32_dpp v44, v44, v44 row_half_mirror row_mask:0xf bank_mask:0xf
    v_add_f32_dpp v60, v60, v60 row_half_mirror row_mask:0xf bank_mask:0xf
    v_add_f32_dpp v76, v76, v76 row_half_mirror row_mask:0xf bank_mask:0xf
    v_add_f32_dpp v92, v92, v92 row_half_mirror row_mask:0xf bank_mask:0xf
    v_add_f32_dpp v108, v108, v108 row_half_mirror row_mask:0xf bank_mask:0xf
    v_add_f32_dpp v124, v124, v124 row_half_mirror row_mask:0xf bank_mask:0xf
    v_add_f32_dpp v140, v140, v140 row_half_mirror row_mask:0xf bank_mask:0xf
    v_add_f32_dpp v156, v156, v156 row_half_mirror row_mask:0xf bank_mask:0xf
    v_add_f32_dpp v44, v44, v44 row_mirror row_mask:0xf bank_mask:0xf
    v_add_f32_dpp v60, v60, v60 row_mirror row_mask:0xf bank_mask:0xf
    v_add_f32_dpp v76, v76, v76 row_mirror row_mask:0xf bank_mask:0xf
    v_add_f32_dpp v92, v92, v92 row_mirror row_mask:0xf bank_mask:0xf
    v_add_f32_dpp v108, v108, v108 row_mirror row_mask:0xf bank_mask:0xf
    v_add_f32_dpp v124, v124, v124 row_mirror row_mask:0xf bank_mask:0xf
    v_add_f32_dpp v140, v140, v140 row_mirror row_mask:0xf bank_mask:0xf
    v_add_f32_dpp v156, v156, v156 row_mirror row_mask:0xf bank_mask:0xf
    v_mov_b32 v45, v44
    v_mov_b32 v61, v60
    v_mov_b32 v77, v76
    v_mov_b32 v93, v92
    v_mov_b32 v109, v108
    v_mov_b32 v125, v124
    v_mov_b32 v141, v140
    v_mov_b32 v157, v156
    v_permlane16_swap_b32 v44, v45
    v_permlane16_swap_b32 v60, v61
    v_permlane16_swap_b32 v76, v77
    v_permlane16_swap_b32 v92, v93
    v_permlane16_swap_b32 v108, v109
    v_permlane16_swap_b32 v124, v125
    v_permlane16_swap_b32 v140, v141
    v_permlane16_swap_b32 v156, v157
    v_add_f32 v44, v44, v45
    v_add_f32 v60, v60, v61
    v_add_f32 v76, v76, v77
    v_add_f32 v92, v92, v93
    v_add_f32 v108, v108, v109
    v_add_f32 v124, v124, v125
    v_add_f32 v140, v140, v141
    v_add_f32 v156, v156, v157
    v_mov_b32 v45, v44
    v_mov_b32 v61, v60
    v_mov_b32 v77, v76
    v_mov_b32 v93, v92
    v_mov_b32 v109, v108
    v_mov_b32 v125, v124
    v_mov_b32 v141, v140
    v_mov_b32 v157, v156
    v_permlane32_swap_b32 v44, v45
    v_permlane32_swap_b32 v60, v61
    v_permlane32_swap_b32 v76, v77
    v_permlane32_swap_b32 v92, v93
    v_permlane32_swap_b32 v108, v109
    v_permlane32_swap_b32 v124, v125
    v_permlane32_swap_b32 v140, v141
    v_permlane32_swap_b32 v156, v157
    v_add_f32 v44, v44, v45
    v_add_f32 v60, v60, v61
    v_add_f32 v76, v76, v77
    v_add_f32 v92, v92, v93
    v_add_f32 v108, v108, v109
    v_add_f32 v124, v124, v125
    v_add_f32 v140, v140, v141
    v_add_f32 v156, v156, v157
    v_mul_f32 v44, 0x3ae38e39, v44
    v_mul_f32 v60, 0x3ae38e39, v60
    v_mul_f32 v76, 0x3ae38e39, v76
    v_mul_f32 v92, 0x3ae38e39, v92
    v_mul_f32 v108, 0x3ae38e39, v108
    v_mul_f32 v124, 0x3ae38e39, v124
    v_mul_f32 v140, 0x3ae38e39, v140
    v_mul_f32 v156, 0x3ae38e39, v156
    v_fma_f32 v44, -v46, v46, v44
    v_fma_f32 v60, -v62, v62, v60
    v_fma_f32 v76, -v78, v78, v76
    v_fma_f32 v92, -v94, v94, v92
    v_fma_f32 v108, -v110, v110, v108
    v_fma_f32 v124, -v126, v126, v124
    v_fma_f32 v140, -v142, v142, v140
    v_fma_f32 v156, -v158, v158, v156
    v_max_f32 v44, 0, v44
    v_max_f32 v60, 0, v60
    v_max_f32 v76, 0, v76
    v_max_f32 v92, 0, v92
    v_max_f32 v108, 0, v108
    v_max_f32 v124, 0, v124
    v_max_f32 v140, 0, v140
    v_max_f32 v156, 0, v156
    v_cvt_pk_bf16_f32 v44, v44, v44
    v_cvt_pk_bf16_f32 v60, v60, v60
    v_cvt_pk_bf16_f32 v76, v76, v76
    v_cvt_pk_bf16_f32 v92, v92, v92
    v_cvt_pk_bf16_f32 v108, v108, v108
    v_cvt_pk_bf16_f32 v124, v124, v124
    v_cvt_pk_bf16_f32 v140, v140, v140
    v_cvt_pk_bf16_f32 v156, v156, v156
    v_lshlrev_b32 v44, 16, v44
    v_lshlrev_b32 v60, 16, v60
    v_lshlrev_b32 v76, 16, v76
    v_lshlrev_b32 v92, 16, v92
    v_lshlrev_b32 v108, 16, v108
    v_lshlrev_b32 v124, 16, v124
    v_lshlrev_b32 v140, 16, v140
    v_lshlrev_b32 v156, 16, v156
    v_add_f32 v44, 0x3727c5ac, v44
    v_add_f32 v60, 0x3727c5ac, v60
    v_add_f32 v76, 0x3727c5ac, v76
    v_add_f32 v92, 0x3727c5ac, v92
    v_add_f32 v108, 0x3727c5ac, v108
    v_add_f32 v124, 0x3727c5ac, v124
    v_add_f32 v140, 0x3727c5ac, v140
    v_add_f32 v156, 0x3727c5ac, v156
    v_cvt_pk_bf16_f32 v44, v44, v44
    v_cvt_pk_bf16_f32 v60, v60, v60
    v_cvt_pk_bf16_f32 v76, v76, v76
    v_cvt_pk_bf16_f32 v92, v92, v92
    v_cvt_pk_bf16_f32 v108, v108, v108
    v_cvt_pk_bf16_f32 v124, v124, v124
    v_cvt_pk_bf16_f32 v140, v140, v140
    v_cvt_pk_bf16_f32 v156, v156, v156
    v_lshlrev_b32 v44, 16, v44
    v_lshlrev_b32 v60, 16, v60
    v_lshlrev_b32 v76, 16, v76
    v_lshlrev_b32 v92, 16, v92
    v_lshlrev_b32 v108, 16, v108
    v_lshlrev_b32 v124, 16, v124
    v_lshlrev_b32 v140, 16, v140
    v_lshlrev_b32 v156, 16, v156
    v_sqrt_f32 v44, v44
    v_sqrt_f32 v60, v60
    v_sqrt_f32 v76, v76
    v_sqrt_f32 v92, v92
    v_sqrt_f32 v108, v108
    v_sqrt_f32 v124, v124
    v_sqrt_f32 v140, v140
    v_sqrt_f32 v156, v156
    v_cvt_pk_bf16_f32 v44, v44, v44
    v_cvt_pk_bf16_f32 v60, v60, v60
    v_cvt_pk_bf16_f32 v76, v76, v76
    v_cvt_pk_bf16_f32 v92, v92, v92
    v_cvt_pk_bf16_f32 v108, v108, v108
    v_cvt_pk_bf16_f32 v124, v124, v124
    v_cvt_pk_bf16_f32 v140, v140, v140
    v_cvt_pk_bf16_f32 v156, v156, v156
    v_lshlrev_b32 v44, 16, v44
    v_lshlrev_b32 v60, 16, v60
    v_lshlrev_b32 v76, 16, v76
    v_lshlrev_b32 v92, 16, v92
    v_lshlrev_b32 v108, 16, v108
    v_lshlrev_b32 v124, 16, v124
    v_lshlrev_b32 v140, 16, v140
    v_lshlrev_b32 v156, 16, v156
    v_rcp_f32 v44, v44
    v_rcp_f32 v60, v60
    v_rcp_f32 v76, v76
    v_rcp_f32 v92, v92
    v_rcp_f32 v108, v108
    v_rcp_f32 v124, v124
    v_rcp_f32 v140, v140
    v_rcp_f32 v156, v156
    v_cvt_pk_bf16_f32 v40, v32, v33
    v_cvt_pk_bf16_f32 v56, v48, v49
    v_cvt_pk_bf16_f32 v72, v64, v65
    v_cvt_pk_bf16_f32 v88, v80, v81
    v_cvt_pk_bf16_f32 v104, v96, v97
    v_cvt_pk_bf16_f32 v120, v112, v113
    v_cvt_pk_bf16_f32 v136, v128, v129
    v_cvt_pk_bf16_f32 v152, v144, v145
    v_cvt_pk_bf16_f32 v168, v160, v161
    v_cvt_pk_bf16_f32 v41, v34, v35
    v_cvt_pk_bf16_f32 v57, v50, v51
    v_cvt_pk_bf16_f32 v73, v66, v67
    v_cvt_pk_bf16_f32 v89, v82, v83
    v_cvt_pk_bf16_f32 v105, v98, v99
    v_cvt_pk_bf16_f32 v121, v114, v115
    v_cvt_pk_bf16_f32 v137, v130, v131
    v_cvt_pk_bf16_f32 v153, v146, v147
    v_cvt_pk_bf16_f32 v169, v162, v163
    v_cvt_pk_bf16_f32 v42, v36, v37
    v_cvt_pk_bf16_f32 v58, v52, v53
    v_cvt_pk_bf16_f32 v74, v68, v69
    v_cvt_pk_bf16_f32 v90, v84, v85
    v_cvt_pk_bf16_f32 v106, v100, v101
    v_cvt_pk_bf16_f32 v122, v116, v117
    v_cvt_pk_bf16_f32 v138, v132, v133
    v_cvt_pk_bf16_f32 v154, v148, v149
    v_cvt_pk_bf16_f32 v170, v164, v165
    v_cvt_pk_bf16_f32 v43, v38, v39
    v_cvt_pk_bf16_f32 v59, v54, v55
    v_cvt_pk_bf16_f32 v75, v70, v71
    v_cvt_pk_bf16_f32 v91, v86, v87
    v_cvt_pk_bf16_f32 v107, v102, v103
    v_cvt_pk_bf16_f32 v123, v118, v119
    v_cvt_pk_bf16_f32 v139, v134, v135
    v_cvt_pk_bf16_f32 v155, v150, v151
    v_cvt_pk_bf16_f32 v171, v166, v167
    v_lshlrev_b32 v32, 16, v40
    v_lshlrev_b32 v48, 16, v56
    v_lshlrev_b32 v64, 16, v72
    v_lshlrev_b32 v80, 16, v88
    v_lshlrev_b32 v96, 16, v104
    v_lshlrev_b32 v112, 16, v120
    v_lshlrev_b32 v128, 16, v136
    v_lshlrev_b32 v144, 16, v152
    v_lshlrev_b32 v160, 16, v168
    v_and_b32 v33, 0xffff0000, v40
    v_and_b32 v49, 0xffff0000, v56
    v_and_b32 v65, 0xffff0000, v72
    v_and_b32 v81, 0xffff0000, v88
    v_and_b32 v97, 0xffff0000, v104
    v_and_b32 v113, 0xffff0000, v120
    v_and_b32 v129, 0xffff0000, v136
    v_and_b32 v145, 0xffff0000, v152
    v_and_b32 v161, 0xffff0000, v168
    v_lshlrev_b32 v34, 16, v41
    v_lshlrev_b32 v50, 16, v57
    v_lshlrev_b32 v66, 16, v73
    v_lshlrev_b32 v82, 16, v89
    v_lshlrev_b32 v98, 16, v105
    v_lshlrev_b32 v114, 16, v121
    v_lshlrev_b32 v130, 16, v137
    v_lshlrev_b32 v146, 16, v153
    v_lshlrev_b32 v162, 16, v169
    v_and_b32 v35, 0xffff0000, v41
    v_and_b32 v51, 0xffff0000, v57
    v_and_b32 v67, 0xffff0000, v73
    v_and_b32 v83, 0xffff0000, v89
    v_and_b32 v99, 0xffff0000, v105
    v_and_b32 v115, 0xffff0000, v121
    v_and_b32 v131, 0xffff0000, v137
    v_and_b32 v147, 0xffff0000, v153
    v_and_b32 v163, 0xffff0000, v169
    v_lshlrev_b32 v36, 16, v42
    v_lshlrev_b32 v52, 16, v58
    v_lshlrev_b32 v68, 16, v74
    v_lshlrev_b32 v84, 16, v90
    v_lshlrev_b32 v100, 16, v106
    v_lshlrev_b32 v116, 16, v122
    v_lshlrev_b32 v132, 16, v138
    v_lshlrev_b32 v148, 16, v154
    v_lshlrev_b32 v164, 16, v170
    v_and_b32 v37, 0xffff0000, v42
    v_and_b32 v53, 0xffff0000, v58
    v_and_b32 v69, 0xffff0000, v74
    v_and_b32 v85, 0xffff0000, v90
    v_and_b32 v101, 0xffff0000, v106
    v_and_b32 v117, 0xffff0000, v122
    v_and_b32 v133, 0xffff0000, v138
    v_and_b32 v149, 0xffff0000, v154
    v_and_b32 v165, 0xffff0000, v170
    v_lshlrev_b32 v38, 16, v43
    v_lshlrev_b32 v54, 16, v59
    v_lshlrev_b32 v70, 16, v75
    v_lshlrev_b32 v86, 16, v91
    v_lshlrev_b32 v102, 16, v107
    v_lshlrev_b32 v118, 16, v123
    v_lshlrev_b32 v134, 16, v139
    v_lshlrev_b32 v150, 16, v155
    v_lshlrev_b32 v166, 16, v171
    v_and_b32 v39, 0xffff0000, v43
    v_and_b32 v55, 0xffff0000, v59
    v_and_b32 v71, 0xffff0000, v75
    v_and_b32 v87, 0xffff0000, v91
    v_and_b32 v103, 0xffff0000, v107
    v_and_b32 v119, 0xffff0000, v123
    v_and_b32 v135, 0xffff0000, v139
    v_and_b32 v151, 0xffff0000, v155
    v_and_b32 v167, 0xffff0000, v171
    v_mul_f32 v172, v181, v44
    v_fmac_f32 v172, v182, v60
    v_fmac_f32 v172, v183, v76
    v_fmac_f32 v172, v184, v92
    v_fmac_f32 v172, v185, v108
    v_fmac_f32 v172, v186, v124
    v_fmac_f32 v172, v187, v140
    v_fmac_f32 v172, v188, v156
    v_mov_b32 v45, v44
    v_mov_b32 v61, v60
    v_mov_b32 v77, v76
    v_mov_b32 v93, v92
    v_mov_b32 v109, v108
    v_mov_b32 v125, v124
    v_mov_b32 v141, v140
    v_mov_b32 v157, v156
    v_mov_b32 v173, v172
    v_pk_mul_f32 v[32:33], v[32:33], v[44:45]
    v_pk_mul_f32 v[48:49], v[48:49], v[60:61]
    v_pk_mul_f32 v[64:65], v[64:65], v[76:77]
    v_pk_mul_f32 v[80:81], v[80:81], v[92:93]
    v_pk_mul_f32 v[96:97], v[96:97], v[108:109]
    v_pk_mul_f32 v[112:113], v[112:113], v[124:125]
    v_pk_mul_f32 v[128:129], v[128:129], v[140:141]
    v_pk_mul_f32 v[144:145], v[144:145], v[156:157]
    v_pk_mul_f32 v[160:161], v[160:161], v[172:173]
    v_pk_mul_f32 v[34:35], v[34:35], v[44:45]
    v_pk_mul_f32 v[50:51], v[50:51], v[60:61]
    v_pk_mul_f32 v[66:67], v[66:67], v[76:77]
    v_pk_mul_f32 v[82:83], v[82:83], v[92:93]
    v_pk_mul_f32 v[98:99], v[98:99], v[108:109]
    v_pk_mul_f32 v[114:115], v[114:115], v[124:125]
    v_pk_mul_f32 v[130:131], v[130:131], v[140:141]
    v_pk_mul_f32 v[146:147], v[146:147], v[156:157]
    v_pk_mul_f32 v[162:163], v[162:163], v[172:173]
    v_pk_mul_f32 v[36:37], v[36:37], v[44:45]
    v_pk_mul_f32 v[52:53], v[52:53], v[60:61]
    v_pk_mul_f32 v[68:69], v[68:69], v[76:77]
    v_pk_mul_f32 v[84:85], v[84:85], v[92:93]
    v_pk_mul_f32 v[100:101], v[100:101], v[108:109]
    v_pk_mul_f32 v[116:117], v[116:117], v[124:125]
    v_pk_mul_f32 v[132:133], v[132:133], v[140:141]
    v_pk_mul_f32 v[148:149], v[148:149], v[156:157]
    v_pk_mul_f32 v[164:165], v[164:165], v[172:173]
    v_pk_mul_f32 v[38:39], v[38:39], v[44:45]
    v_pk_mul_f32 v[54:55], v[54:55], v[60:61]
    v_pk_mul_f32 v[70:71], v[70:71], v[76:77]
    v_pk_mul_f32 v[86:87], v[86:87], v[92:93]
    v_pk_mul_f32 v[102:103], v[102:103], v[108:109]
    v_pk_mul_f32 v[118:119], v[118:119], v[124:125]
    v_pk_mul_f32 v[134:135], v[134:135], v[140:141]
    v_pk_mul_f32 v[150:151], v[150:151], v[156:157]
    v_pk_mul_f32 v[166:167], v[166:167], v[172:173]
    v_cvt_pk_bf16_f32 v40, v32, v33
    v_cvt_pk_bf16_f32 v56, v48, v49
    v_cvt_pk_bf16_f32 v72, v64, v65
    v_cvt_pk_bf16_f32 v88, v80, v81
    v_cvt_pk_bf16_f32 v104, v96, v97
    v_cvt_pk_bf16_f32 v120, v112, v113
    v_cvt_pk_bf16_f32 v136, v128, v129
    v_cvt_pk_bf16_f32 v152, v144, v145
    v_cvt_pk_bf16_f32 v168, v160, v161
    v_cvt_pk_bf16_f32 v41, v34, v35
    v_cvt_pk_bf16_f32 v57, v50, v51
    v_cvt_pk_bf16_f32 v73, v66, v67
    v_cvt_pk_bf16_f32 v89, v82, v83
    v_cvt_pk_bf16_f32 v105, v98, v99
    v_cvt_pk_bf16_f32 v121, v114, v115
    v_cvt_pk_bf16_f32 v137, v130, v131
    v_cvt_pk_bf16_f32 v153, v146, v147
    v_cvt_pk_bf16_f32 v169, v162, v163
    v_cvt_pk_bf16_f32 v42, v36, v37
    v_cvt_pk_bf16_f32 v58, v52, v53
    v_cvt_pk_bf16_f32 v74, v68, v69
    v_cvt_pk_bf16_f32 v90, v84, v85
    v_cvt_pk_bf16_f32 v106, v100, v101
    v_cvt_pk_bf16_f32 v122, v116, v117
    v_cvt_pk_bf16_f32 v138, v132, v133
    v_cvt_pk_bf16_f32 v154, v148, v149
    v_cvt_pk_bf16_f32 v170, v164, v165
    v_cvt_pk_bf16_f32 v43, v38, v39
    v_cvt_pk_bf16_f32 v59, v54, v55
    v_cvt_pk_bf16_f32 v75, v70, v71
    v_cvt_pk_bf16_f32 v91, v86, v87
    v_cvt_pk_bf16_f32 v107, v102, v103
    v_cvt_pk_bf16_f32 v123, v118, v119
    v_cvt_pk_bf16_f32 v139, v134, v135
    v_cvt_pk_bf16_f32 v155, v150, v151
    v_cvt_pk_bf16_f32 v171, v166, v167
    ds_write_b128 v176, v[40:43] offset:0
    ds_write_b128 v176, v[56:59] offset:128
    ds_write_b128 v177, v[72:75] offset:256
    ds_write_b128 v177, v[88:91] offset:384
    ds_write_b128 v178, v[104:107] offset:512
    ds_write_b128 v178, v[120:123] offset:640
    ds_write_b128 v179, v[136:139] offset:768
    ds_write_b128 v179, v[152:155] offset:896
    ds_write_b128 v180, v[168:171]
    s_mul_i32 s33, s2, 36864
    s_add_u32 s72, s4, 0x1400000
    s_addc_u32 s73, s5, 0
    s_add_u32 s72, s72, s33
    s_addc_u32 s73, s73, 0
    s_and_b32 s73, s73, 0xffff
    s_mov_b32 s74, 36864
    s_mov_b32 s75, 0x20000
    s_mul_i32 s33, s28, 5120
    v_lshl_add_u32 v4, v1, 4, s33
    v_mov_b32 v28, 0
    v_mov_b32 v29, 0
    v_mov_b32 v30, 0
    v_mov_b32 v31, 0
    buffer_store_dwordx4 v[28:31], v4, s[72:75], 0 offen sc0 sc1
    buffer_store_dwordx4 v[28:31], v4, s[72:75], 0 offen offset:1024 sc0 sc1
    buffer_store_dwordx4 v[28:31], v4, s[72:75], 0 offen offset:2048 sc0 sc1
    buffer_store_dwordx4 v[28:31], v4, s[72:75], 0 offen offset:3072 sc0 sc1
    s_mov_b32 s33, 4096
    buffer_store_dwordx4 v[28:31], v4, s[72:75], s33 offen sc0 sc1
    s_cmp_ge_u32 s2, 1
    s_cbranch_scc1 LZ_rompt_kernel_2
    s_add_u32 s72, s4, 0x1200000
    s_addc_u32 s73, s5, 0
    s_mov_b32 s74, 0x2000
    s_and_b32 s73, s73, 0xffff
    s_mov_b32 s75, 0x20000
    v_lshlrev_b32 v4, 4, v0
    buffer_store_dwordx4 v[28:31], v4, s[72:75], 0 offen sc0 sc1
LZ_rompt_kernel_2:
    s_waitcnt lgkmcnt(0)
    s_waitcnt vmcnt(15)
    s_barrier
    s_cmp_ge_u32 s28, 4
    s_cbranch_scc1 LG_rompt_kernel_4
    ds_read_b128 v[72:75], v12 offset:0
    ds_read_b128 v[32:35], v14 offset:0
    ds_read_b128 v[36:39], v14 offset:2048
    ds_read_b128 v[40:43], v14 offset:4096
    ds_read_b128 v[44:47], v14 offset:6144
    ds_read_b128 v[48:51], v14 offset:8192
    ds_read_b128 v[76:79], v13 offset:0
    ds_read_b128 v[52:55], v15 offset:0
    ds_read_b128 v[56:59], v15 offset:2048
    ds_read_b128 v[60:63], v15 offset:4096
    ds_read_b128 v[80:83], v12 offset:8192
    ds_read_b128 v[84:87], v13 offset:8192
    s_waitcnt lgkmcnt(10)
    v_mfma_f32_16x16x32_bf16 v[88:91], v[32:35], v[72:75], 0
    ds_read_b128 v[64:67], v15 offset:6144
    s_waitcnt lgkmcnt(10)
    v_mfma_f32_16x16x32_bf16 v[92:95], v[36:39], v[72:75], 0
    ds_read_b128 v[68:71], v15 offset:8192
    s_waitcnt lgkmcnt(10)
    v_mfma_f32_16x16x32_bf16 v[96:99], v[40:43], v[72:75], 0
    s_waitcnt vmcnt(12) lgkmcnt(0)
    s_barrier
    ds_read_b128 v[32:35], v18 offset:0
    s_add_u32 m0, s29, 0x12000
    s_nop 0
    buffer_load_dwordx4 v9, s[16:19], s32 offen lds
    v_mfma_f32_16x16x32_bf16 v[100:103], v[44:47], v[72:75], 0
    ds_read_b128 v[36:39], v18 offset:2048
    s_add_u32 m0, s29, 0x14000
    s_add_u32 s33, s32, 0x12000
    buffer_load_dwordx4 v9, s[16:19], s33 offen lds
    v_mfma_f32_16x16x32_bf16 v[104:107], v[48:51], v[72:75], 0
    ds_read_b128 v[40:43], v18 offset:4096
    ds_read_b128 v[72:75], v12 offset:16384
    s_add_u32 m0, s30, 0x16000
    s_nop 0
    s_mov_b64 exec, 0xffff
    buffer_load_dwordx4 v11, s[16:19], s32 offen lds
    s_mov_b64 exec, -1
    s_add_u32 s32, s32, 0x80
    v_mfma_f32_16x16x32_bf16 v[88:91], v[52:55], v[76:79], v[88:91]
    ds_read_b128 v[44:47], v18 offset:6144
    v_mfma_f32_16x16x32_bf16 v[92:95], v[56:59], v[76:79], v[92:95]
    ds_read_b128 v[48:51], v18 offset:8192
    v_mfma_f32_16x16x32_bf16 v[96:99], v[60:63], v[76:79], v[96:99]
    ds_read_b128 v[52:55], v19 offset:0
    v_mfma_f32_16x16x32_bf16 v[100:103], v[64:67], v[76:79], v[100:103]
    ds_read_b128 v[56:59], v19 offset:2048
    v_mfma_f32_16x16x32_bf16 v[104:107], v[68:71], v[76:79], v[104:107]
    ds_read_b128 v[60:63], v19 offset:4096
    ds_read_b128 v[76:79], v13 offset:16384
    s_waitcnt lgkmcnt(9)
    v_mfma_f32_16x16x32_bf16 v[88:91], v[32:35], v[80:83], v[88:91]
    ds_read_b128 v[64:67], v19 offset:6144
    s_waitcnt lgkmcnt(9)
    v_mfma_f32_16x16x32_bf16 v[92:95], v[36:39], v[80:83], v[92:95]
    ds_read_b128 v[68:71], v19 offset:8192
    s_waitcnt lgkmcnt(9)
    v_mfma_f32_16x16x32_bf16 v[96:99], v[40:43], v[80:83], v[96:99]
    s_waitcnt vmcnt(12) lgkmcnt(0)
    s_barrier
    ds_read_b128 v[32:35], v22 offset:0
    s_add_u32 m0, s29, 0x16800
    s_nop 0
    buffer_load_dwordx4 v9, s[16:19], s32 offen lds
    v_mfma_f32_16x16x32_bf16 v[100:103], v[44:47], v[80:83], v[100:103]
    ds_read_b128 v[36:39], v22 offset:2048
    s_add_u32 m0, s29, 0x18800
    s_add_u32 s33, s32, 0x12000
    buffer_load_dwordx4 v9, s[16:19], s33 offen lds
    v_mfma_f32_16x16x32_bf16 v[104:107], v[48:51], v[80:83], v[104:107]
    ds_read_b128 v[40:43], v22 offset:4096
    ds_read_b128 v[80:83], v12 offset:24576
    s_add_u32 m0, s30, 0x1a800
    s_nop 0
    s_mov_b64 exec, 0xffff
    buffer_load_dwordx4 v11, s[16:19], s32 offen lds
    s_mov_b64 exec, -1
    s_add_u32 s32, s32, 0x80
    v_mfma_f32_16x16x32_bf16 v[88:91], v[52:55], v[84:87], v[88:91]
    ds_read_b128 v[44:47], v22 offset:6144
    v_mfma_f32_16x16x32_bf16 v[92:95], v[56:59], v[84:87], v[92:95]
    ds_read_b128 v[48:51], v22 offset:8192
    v_mfma_f32_16x16x32_bf16 v[96:99], v[60:63], v[84:87], v[96:99]
    ds_read_b128 v[52:55], v23 offset:0
    v_mfma_f32_16x16x32_bf16 v[100:103], v[64:67], v[84:87], v[100:103]
    ds_read_b128 v[56:59], v23 offset:2048
    v_mfma_f32_16x16x32_bf16 v[104:107], v[68:71], v[84:87], v[104:107]
    ds_read_b128 v[60:63], v23 offset:4096
    ds_read_b128 v[84:87], v13 offset:24576
    s_waitcnt lgkmcnt(9)
    v_mfma_f32_16x16x32_bf16 v[88:91], v[32:35], v[72:75], v[88:91]
    ds_read_b128 v[64:67], v23 offset:6144
    s_waitcnt lgkmcnt(9)
    v_mfma_f32_16x16x32_bf16 v[92:95], v[36:39], v[72:75], v[92:95]
    ds_read_b128 v[68:71], v23 offset:8192
    s_waitcnt lgkmcnt(9)
    v_mfma_f32_16x16x32_bf16 v[96:99], v[40:43], v[72:75], v[96:99]
    s_waitcnt vmcnt(12) lgkmcnt(0)
    s_barrier
    ds_read_b128 v[32:35], v26 offset:0
    s_add_u32 m0, s29, 0x1b000
    s_nop 0
    buffer_load_dwordx4 v9, s[16:19], s32 offen lds
    v_mfma_f32_16x16x32_bf16 v[100:103], v[44:47], v[72:75], v[100:103]
    ds_read_b128 v[36:39], v26 offset:2048
    s_add_u32 m0, s29, 0x1d000
    s_add_u32 s33, s32, 0x12000
    buffer_load_dwordx4 v9, s[16:19], s33 offen lds
    v_mfma_f32_16x16x32_bf16 v[104:107], v[48:51], v[72:75], v[104:107]
    ds_read_b128 v[40:43], v26 offset:4096
    ds_read_b128 v[72:75], v12 offset:32768
    s_add_u32 m0, s30, 0x1f000
    s_nop 0
    s_mov_b64 exec, 0xffff
    buffer_load_dwordx4 v11, s[16:19], s32 offen lds
    s_mov_b64 exec, -1
    s_add_u32 s32, s32, 0x80
    v_mfma_f32_16x16x32_bf16 v[88:91], v[52:55], v[76:79], v[88:91]
    ds_read_b128 v[44:47], v26 offset:6144
    v_mfma_f32_16x16x32_bf16 v[92:95], v[56:59], v[76:79], v[92:95]
    ds_read_b128 v[48:51], v26 offset:8192
    v_mfma_f32_16x16x32_bf16 v[96:99], v[60:63], v[76:79], v[96:99]
    ds_read_b128 v[52:55], v27 offset:0
    v_mfma_f32_16x16x32_bf16 v[100:103], v[64:67], v[76:79], v[100:103]
    ds_read_b128 v[56:59], v27 offset:2048
    v_mfma_f32_16x16x32_bf16 v[104:107], v[68:71], v[76:79], v[104:107]
    ds_read_b128 v[60:63], v27 offset:4096
    ds_read_b128 v[76:79], v13 offset:32768
    s_waitcnt lgkmcnt(9)
    v_mfma_f32_16x16x32_bf16 v[88:91], v[32:35], v[80:83], v[88:91]
    ds_read_b128 v[64:67], v27 offset:6144
    s_waitcnt lgkmcnt(9)
    v_mfma_f32_16x16x32_bf16 v[92:95], v[36:39], v[80:83], v[92:95]
    ds_read_b128 v[68:71], v27 offset:8192
    s_waitcnt lgkmcnt(9)
    v_mfma_f32_16x16x32_bf16 v[96:99], v[40:43], v[80:83], v[96:99]
    s_waitcnt vmcnt(6) lgkmcnt(0)
    s_barrier
    ds_read_b128 v[32:35], v14 offset:0
    s_add_u32 m0, s29, 0x1f800
    s_nop 0
    buffer_load_dwordx4 v9, s[16:19], s32 offen lds
    v_mfma_f32_16x16x32_bf16 v[100:103], v[44:47], v[80:83], v[100:103]
    ds_read_b128 v[36:39], v14 offset:2048
    s_add_u32 m0, s29, 0x21800
    s_add_u32 s33, s32, 0x12000
    buffer_load_dwordx4 v9, s[16:19], s33 offen lds
    v_mfma_f32_16x16x32_bf16 v[104:107], v[48:51], v[80:83], v[104:107]
    ds_read_b128 v[40:43], v14 offset:4096
    ds_read_b128 v[80:83], v12 offset:40960
    s_add_u32 m0, s30, 0x23800
    s_nop 0
    s_mov_b64 exec, 0xffff
    buffer_load_dwordx4 v11, s[16:19], s32 offen lds
    s_mov_b64 exec, -1
    s_add_u32 s32, s32, 0x80
    v_mfma_f32_16x16x32_bf16 v[88:91], v[52:55], v[84:87], v[88:91]
    ds_read_b128 v[44:47], v14 offset:6144
    v_mfma_f32_16x16x32_bf16 v[92:95], v[56:59], v[84:87], v[92:95]
    ds_read_b128 v[48:51], v14 offset:8192
    v_mfma_f32_16x16x32_bf16 v[96:99], v[60:63], v[84:87], v[96:99]
    ds_read_b128 v[52:55], v15 offset:0
    v_mfma_f32_16x16x32_bf16 v[100:103], v[64:67], v[84:87], v[100:103]
    ds_read_b128 v[56:59], v15 offset:2048
    v_mfma_f32_16x16x32_bf16 v[104:107], v[68:71], v[84:87], v[104:107]
    ds_read_b128 v[60:63], v15 offset:4096
    ds_read_b128 v[84:87], v13 offset:40960
    s_waitcnt lgkmcnt(9)
    v_mfma_f32_16x16x32_bf16 v[88:91], v[32:35], v[72:75], v[88:91]
    ds_read_b128 v[64:67], v15 offset:6144
    s_waitcnt lgkmcnt(9)
    v_mfma_f32_16x16x32_bf16 v[92:95], v[36:39], v[72:75], v[92:95]
    ds_read_b128 v[68:71], v15 offset:8192
    s_waitcnt lgkmcnt(9)
    v_mfma_f32_16x16x32_bf16 v[96:99], v[40:43], v[72:75], v[96:99]
    s_waitcnt vmcnt(6) lgkmcnt(0)
    s_barrier
    ds_read_b128 v[32:35], v18 offset:0
    s_add_u32 m0, s29, 0x12000
    s_nop 0
    buffer_load_dwordx4 v9, s[16:19], s32 offen lds
    v_mfma_f32_16x16x32_bf16 v[100:103], v[44:47], v[72:75], v[100:103]
    ds_read_b128 v[36:39], v18 offset:2048
    s_add_u32 m0, s29, 0x14000
    s_add_u32 s33, s32, 0x12000
    buffer_load_dwordx4 v9, s[16:19], s33 offen lds
    v_mfma_f32_16x16x32_bf16 v[104:107], v[48:51], v[72:75], v[104:107]
    ds_read_b128 v[40:43], v18 offset:4096
    ds_read_b128 v[72:75], v12 offset:49152
    s_add_u32 m0, s30, 0x16000
    s_nop 0
    s_mov_b64 exec, 0xffff
    buffer_load_dwordx4 v11, s[16:19], s32 offen lds
    s_mov_b64 exec, -1
    s_add_u32 s32, s32, 0x80
    v_mfma_f32_16x16x32_bf16 v[88:91], v[52:55], v[76:79], v[88:91]
    ds_read_b128 v[44:47], v18 offset:6144
    v_mfma_f32_16x16x32_bf16 v[92:95], v[56:59], v[76:79], v[92:95]
    ds_read_b128 v[48:51], v18 offset:8192
    v_mfma_f32_16x16x32_bf16 v[96:99], v[60:63], v[76:79], v[96:99]
    ds_read_b128 v[52:55], v19 offset:0
    v_mfma_f32_16x16x32_bf16 v[100:103], v[64:67], v[76:79], v[100:103]
    ds_read_b128 v[56:59], v19 offset:2048
    v_mfma_f32_16x16x32_bf16 v[104:107], v[68:71], v[76:79], v[104:107]
    ds_read_b128 v[60:63], v19 offset:4096
    ds_read_b128 v[76:79], v13 offset:49152
    s_waitcnt lgkmcnt(9)
    v_mfma_f32_16x16x32_bf16 v[88:91], v[32:35], v[80:83], v[88:91]
    ds_read_b128 v[64:67], v19 offset:6144
    s_waitcnt lgkmcnt(9)
    v_mfma_f32_16x16x32_bf16 v[92:95], v[36:39], v[80:83], v[92:95]
    ds_read_b128 v[68:71], v19 offset:8192
    s_waitcnt lgkmcnt(9)
    v_mfma_f32_16x16x32_bf16 v[96:99], v[40:43], v[80:83], v[96:99]
    s_waitcnt vmcnt(6) lgkmcnt(0)
    s_barrier
    ds_read_b128 v[32:35], v22 offset:0
    v_mfma_f32_16x16x32_bf16 v[100:103], v[44:47], v[80:83], v[100:103]
    ds_read_b128 v[36:39], v22 offset:2048
    v_mfma_f32_16x16x32_bf16 v[104:107], v[48:51], v[80:83], v[104:107]
    ds_read_b128 v[40:43], v22 offset:4096
    ds_read_b128 v[80:83], v12 offset:57344
    v_mfma_f32_16x16x32_bf16 v[88:91], v[52:55], v[84:87], v[88:91]
    ds_read_b128 v[44:47], v22 offset:6144
    v_mfma_f32_16x16x32_bf16 v[92:95], v[56:59], v[84:87], v[92:95]
    ds_read_b128 v[48:51], v22 offset:8192
    v_mfma_f32_16x16x32_bf16 v[96:99], v[60:63], v[84:87], v[96:99]
    ds_read_b128 v[52:55], v23 offset:0
    v_mfma_f32_16x16x32_bf16 v[100:103], v[64:67], v[84:87], v[100:103]
    ds_read_b128 v[56:59], v23 offset:2048
    v_mfma_f32_16x16x32_bf16 v[104:107], v[68:71], v[84:87], v[104:107]
    ds_read_b128 v[60:63], v23 offset:4096
    ds_read_b128 v[84:87], v13 offset:57344
    s_waitcnt lgkmcnt(9)
    v_mfma_f32_16x16x32_bf16 v[88:91], v[32:35], v[72:75], v[88:91]
    ds_read_b128 v[64:67], v23 offset:6144
    s_waitcnt lgkmcnt(9)
    v_mfma_f32_16x16x32_bf16 v[92:95], v[36:39], v[72:75], v[92:95]
    ds_read_b128 v[68:71], v23 offset:8192
    s_waitcnt lgkmcnt(9)
    v_mfma_f32_16x16x32_bf16 v[96:99], v[40:43], v[72:75], v[96:99]
    s_waitcnt vmcnt(3) lgkmcnt(0)
    s_barrier
    ds_read_b128 v[32:35], v26 offset:0
    v_mfma_f32_16x16x32_bf16 v[100:103], v[44:47], v[72:75], v[100:103]
    ds_read_b128 v[36:39], v26 offset:2048
    v_mfma_f32_16x16x32_bf16 v[104:107], v[48:51], v[72:75], v[104:107]
    ds_read_b128 v[40:43], v26 offset:4096
    ds_read_b128 v[72:75], v16 offset:0
    v_mfma_f32_16x16x32_bf16 v[88:91], v[52:55], v[76:79], v[88:91]
    ds_read_b128 v[44:47], v26 offset:6144
    v_mfma_f32_16x16x32_bf16 v[92:95], v[56:59], v[76:79], v[92:95]
    ds_read_b128 v[48:51], v26 offset:8192
    v_mfma_f32_16x16x32_bf16 v[96:99], v[60:63], v[76:79], v[96:99]
    ds_read_b128 v[52:55], v27 offset:0
    v_mfma_f32_16x16x32_bf16 v[100:103], v[64:67], v[76:79], v[100:103]
    ds_read_b128 v[56:59], v27 offset:2048
    v_mfma_f32_16x16x32_bf16 v[104:107], v[68:71], v[76:79], v[104:107]
    ds_read_b128 v[60:63], v27 offset:4096
    ds_read_b128 v[76:79], v17 offset:0
    s_waitcnt lgkmcnt(9)
    v_mfma_f32_16x16x32_bf16 v[88:91], v[32:35], v[80:83], v[88:91]
    ds_read_b128 v[64:67], v27 offset:6144
    s_waitcnt lgkmcnt(9)
    v_mfma_f32_16x16x32_bf16 v[92:95], v[36:39], v[80:83], v[92:95]
    ds_read_b128 v[68:71], v27 offset:8192
    s_waitcnt lgkmcnt(9)
    v_mfma_f32_16x16x32_bf16 v[96:99], v[40:43], v[80:83], v[96:99]
    s_waitcnt vmcnt(0) lgkmcnt(0)
    s_barrier
    ds_read_b128 v[32:35], v14 offset:0
    v_mfma_f32_16x16x32_bf16 v[100:103], v[44:47], v[80:83], v[100:103]
    ds_read_b128 v[36:39], v14 offset:2048
    v_mfma_f32_16x16x32_bf16 v[104:107], v[48:51], v[80:83], v[104:107]
    ds_read_b128 v[40:43], v14 offset:4096
    v_mfma_f32_16x16x32_bf16 v[88:91], v[52:55], v[84:87], v[88:91]
    ds_read_b128 v[44:47], v14 offset:6144
    v_mfma_f32_16x16x32_bf16 v[92:95], v[56:59], v[84:87], v[92:95]
    ds_read_b128 v[48:51], v14 offset:8192
    v_mfma_f32_16x16x32_bf16 v[96:99], v[60:63], v[84:87], v[96:99]
    ds_read_b128 v[52:55], v15 offset:0
    v_mfma_f32_16x16x32_bf16 v[100:103], v[64:67], v[84:87], v[100:103]
    ds_read_b128 v[56:59], v15 offset:2048
    v_mfma_f32_16x16x32_bf16 v[104:107], v[68:71], v[84:87], v[104:107]
    ds_read_b128 v[60:63], v15 offset:4096
    s_waitcnt lgkmcnt(7)
    v_mfma_f32_16x16x32_bf16 v[88:91], v[32:35], v[72:75], v[88:91]
    ds_read_b128 v[64:67], v15 offset:6144
    s_waitcnt lgkmcnt(7)
    v_mfma_f32_16x16x32_bf16 v[92:95], v[36:39], v[72:75], v[92:95]
    ds_read_b128 v[68:71], v15 offset:8192
    s_waitcnt lgkmcnt(7)
    v_mfma_f32_16x16x32_bf16 v[96:99], v[40:43], v[72:75], v[96:99]
    s_waitcnt lgkmcnt(6)
    v_mfma_f32_16x16x32_bf16 v[100:103], v[44:47], v[72:75], v[100:103]
    s_waitcnt lgkmcnt(5)
    v_mfma_f32_16x16x32_bf16 v[104:107], v[48:51], v[72:75], v[104:107]
    s_waitcnt lgkmcnt(4)
    v_mfma_f32_16x16x32_bf16 v[88:91], v[52:55], v[76:79], v[88:91]
    s_waitcnt lgkmcnt(3)
    v_mfma_f32_16x16x32_bf16 v[92:95], v[56:59], v[76:79], v[92:95]
    s_waitcnt lgkmcnt(2)
    v_mfma_f32_16x16x32_bf16 v[96:99], v[60:63], v[76:79], v[96:99]
    s_waitcnt lgkmcnt(1)
    v_mfma_f32_16x16x32_bf16 v[100:103], v[64:67], v[76:79], v[100:103]
    s_waitcnt lgkmcnt(0)
    v_mfma_f32_16x16x32_bf16 v[104:107], v[68:71], v[76:79], v[104:107]
    s_nop 7
    s_nop 3
    s_barrier
    v_cvt_pk_bf16_f32 v28, v88, v89
    v_cvt_pk_bf16_f32 v29, v90, v91
    v_xor_b32 v28, s47, v28
    v_xor_b32 v29, s47, v29
    v_cvt_pk_bf16_f32 v30, v92, v93
    v_cvt_pk_bf16_f32 v31, v94, v95
    v_xor_b32 v30, s47, v30
    v_xor_b32 v31, s47, v31
    s_nop 1
    v_permlane16_swap_b32 v28, v30
    v_permlane16_swap_b32 v29, v31
    s_nop 0
    ds_write_b128 v7, v[28:31] offset:0
    v_cvt_pk_bf16_f32 v32, v96, v97
    v_cvt_pk_bf16_f32 v33, v98, v99
    v_xor_b32 v32, s47, v32
    v_xor_b32 v33, s47, v33
    v_cvt_pk_bf16_f32 v34, v100, v101
    v_cvt_pk_bf16_f32 v35, v102, v103
    v_xor_b32 v34, s47, v34
    v_xor_b32 v35, s47, v35
    s_nop 1
    v_permlane16_swap_b32 v32, v34
    v_permlane16_swap_b32 v33, v35
    s_nop 0
    ds_write_b128 v7, v[32:35] offset:64
    v_cvt_pk_bf16_f32 v36, v104, v105
    v_cvt_pk_bf16_f32 v37, v106, v107
    v_xor_b32 v36, s47, v36
    v_xor_b32 v37, s47, v37
    ds_write_b64 v6, v[36:37] offset:128
    s_branch LJ_rompt_kernel_3
LG_rompt_kernel_4:
    ds_read_b128 v[72:75], v12 offset:0
    ds_read_b128 v[32:35], v14 offset:10240
    ds_read_b128 v[36:39], v14 offset:12288
    ds_read_b128 v[40:43], v14 offset:14336
    ds_read_b128 v[44:47], v14 offset:16384
    ds_read_b128 v[76:79], v13 offset:0
    ds_read_b128 v[48:51], v15 offset:10240
    ds_read_b128 v[52:55], v15 offset:12288
    ds_read_b128 v[80:83], v12 offset:8192
    ds_read_b128 v[84:87], v13 offset:8192
    s_waitcnt lgkmcnt(8)
    v_mfma_f32_16x16x32_bf16 v[88:91], v[32:35], v[72:75], 0
    ds_read_b128 v[56:59], v15 offset:14336
    s_waitcnt lgkmcnt(8)
    v_mfma_f32_16x16x32_bf16 v[92:95], v[36:39], v[72:75], 0
    ds_read_b128 v[60:63], v15 offset:16384
    s_waitcnt lgkmcnt(8)
    v_mfma_f32_16x16x32_bf16 v[96:99], v[40:43], v[72:75], 0
    s_waitcnt vmcnt(12) lgkmcnt(0)
    s_barrier
    ds_read_b128 v[32:35], v18 offset:10240
    s_add_u32 m0, s29, 0x12000
    s_nop 0
    buffer_load_dwordx4 v9, s[16:19], s32 offen lds
    v_mfma_f32_16x16x32_bf16 v[100:103], v[44:47], v[72:75], 0
    ds_read_b128 v[36:39], v18 offset:12288
    ds_read_b128 v[72:75], v12 offset:16384
    s_add_u32 m0, s29, 0x14000
    s_add_u32 s33, s32, 0x12000
    buffer_load_dwordx4 v9, s[16:19], s33 offen lds
    v_mfma_f32_16x16x32_bf16 v[88:91], v[48:51], v[76:79], v[88:91]
    ds_read_b128 v[40:43], v18 offset:14336
    s_add_u32 m0, s30, 0x16000
    s_nop 0
    s_mov_b64 exec, 0xffff
    buffer_load_dwordx4 v11, s[16:19], s32 offen lds
    s_mov_b64 exec, -1
    s_add_u32 s32, s32, 0x80
    v_mfma_f32_16x16x32_bf16 v[92:95], v[52:55], v[76:79], v[92:95]
    ds_read_b128 v[44:47], v18 offset:16384
    v_mfma_f32_16x16x32_bf16 v[96:99], v[56:59], v[76:79], v[96:99]
    ds_read_b128 v[48:51], v19 offset:10240
    v_mfma_f32_16x16x32_bf16 v[100:103], v[60:63], v[76:79], v[100:103]
    ds_read_b128 v[52:55], v19 offset:12288
    ds_read_b128 v[76:79], v13 offset:16384
    s_waitcnt lgkmcnt(7)
    v_mfma_f32_16x16x32_bf16 v[88:91], v[32:35], v[80:83], v[88:91]
    ds_read_b128 v[56:59], v19 offset:14336
    s_waitcnt lgkmcnt(7)
    v_mfma_f32_16x16x32_bf16 v[92:95], v[36:39], v[80:83], v[92:95]
    ds_read_b128 v[60:63], v19 offset:16384
    s_waitcnt lgkmcnt(6)
    v_mfma_f32_16x16x32_bf16 v[96:99], v[40:43], v[80:83], v[96:99]
    s_waitcnt vmcnt(12) lgkmcnt(0)
    s_barrier
    ds_read_b128 v[32:35], v22 offset:10240
    s_add_u32 m0, s29, 0x16800
    s_nop 0
    buffer_load_dwordx4 v9, s[16:19], s32 offen lds
    v_mfma_f32_16x16x32_bf16 v[100:103], v[44:47], v[80:83], v[100:103]
    ds_read_b128 v[36:39], v22 offset:12288
    ds_read_b128 v[80:83], v12 offset:24576
    s_add_u32 m0, s29, 0x18800
    s_add_u32 s33, s32, 0x12000
    buffer_load_dwordx4 v9, s[16:19], s33 offen lds
    v_mfma_f32_16x16x32_bf16 v[88:91], v[48:51], v[84:87], v[88:91]
    ds_read_b128 v[40:43], v22 offset:14336
    s_add_u32 m0, s30, 0x1a800
    s_nop 0
    s_mov_b64 exec, 0xffff
    buffer_load_dwordx4 v11, s[16:19], s32 offen lds
    s_mov_b64 exec, -1
    s_add_u32 s32, s32, 0x80
    v_mfma_f32_16x16x32_bf16 v[92:95], v[52:55], v[84:87], v[92:95]
    ds_read_b128 v[44:47], v22 offset:16384
    v_mfma_f32_16x16x32_bf16 v[96:99], v[56:59], v[84:87], v[96:99]
    ds_read_b128 v[48:51], v23 offset:10240
    v_mfma_f32_16x16x32_bf16 v[100:103], v[60:63], v[84:87], v[100:103]
    ds_read_b128 v[52:55], v23 offset:12288
    ds_read_b128 v[84:87], v13 offset:24576
    s_waitcnt lgkmcnt(7)
    v_mfma_f32_16x16x32_bf16 v[88:91], v[32:35], v[72:75], v[88:91]
    ds_read_b128 v[56:59], v23 offset:14336
    s_waitcnt lgkmcnt(7)
    v_mfma_f32_16x16x32_bf16 v[92:95], v[36:39], v[72:75], v[92:95]
    ds_read_b128 v[60:63], v23 offset:16384
    s_waitcnt lgkmcnt(6)
    v_mfma_f32_16x16x32_bf16 v[96:99], v[40:43], v[72:75], v[96:99]
    s_waitcnt vmcnt(12) lgkmcnt(0)
    s_barrier
    ds_read_b128 v[32:35], v26 offset:10240
    s_add_u32 m0, s29, 0x1b000
    s_nop 0
    buffer_load_dwordx4 v9, s[16:19], s32 offen lds
    v_mfma_f32_16x16x32_bf16 v[100:103], v[44:47], v[72:75], v[100:103]
    ds_read_b128 v[36:39], v26 offset:12288
    ds_read_b128 v[72:75], v12 offset:32768
    s_add_u32 m0, s29, 0x1d000
    s_add_u32 s33, s32, 0x12000
    buffer_load_dwordx4 v9, s[16:19], s33 offen lds
    v_mfma_f32_16x16x32_bf16 v[88:91], v[48:51], v[76:79], v[88:91]
    ds_read_b128 v[40:43], v26 offset:14336
    s_add_u32 m0, s30, 0x1f000
    s_nop 0
    s_mov_b64 exec, 0xffff
    buffer_load_dwordx4 v11, s[16:19], s32 offen lds
    s_mov_b64 exec, -1
    s_add_u32 s32, s32, 0x80
    v_mfma_f32_16x16x32_bf16 v[92:95], v[52:55], v[76:79], v[92:95]
    ds_read_b128 v[44:47], v26 offset:16384
    v_mfma_f32_16x16x32_bf16 v[96:99], v[56:59], v[76:79], v[96:99]
    ds_read_b128 v[48:51], v27 offset:10240
    v_mfma_f32_16x16x32_bf16 v[100:103], v[60:63], v[76:79], v[100:103]
    ds_read_b128 v[52:55], v27 offset:12288
    ds_read_b128 v[76:79], v13 offset:32768
    s_waitcnt lgkmcnt(7)
    v_mfma_f32_16x16x32_bf16 v[88:91], v[32:35], v[80:83], v[88:91]
    ds_read_b128 v[56:59], v27 offset:14336
    s_waitcnt lgkmcnt(7)
    v_mfma_f32_16x16x32_bf16 v[92:95], v[36:39], v[80:83], v[92:95]
    ds_read_b128 v[60:63], v27 offset:16384
    s_waitcnt lgkmcnt(6)
    v_mfma_f32_16x16x32_bf16 v[96:99], v[40:43], v[80:83], v[96:99]
    s_waitcnt vmcnt(6) lgkmcnt(0)
    s_barrier
    ds_read_b128 v[32:35], v14 offset:10240
    s_add_u32 m0, s29, 0x1f800
    s_nop 0
    buffer_load_dwordx4 v9, s[16:19], s32 offen lds
    v_mfma_f32_16x16x32_bf16 v[100:103], v[44:47], v[80:83], v[100:103]
    ds_read_b128 v[36:39], v14 offset:12288
    ds_read_b128 v[80:83], v12 offset:40960
    s_add_u32 m0, s29, 0x21800
    s_add_u32 s33, s32, 0x12000
    buffer_load_dwordx4 v9, s[16:19], s33 offen lds
    v_mfma_f32_16x16x32_bf16 v[88:91], v[48:51], v[84:87], v[88:91]
    ds_read_b128 v[40:43], v14 offset:14336
    s_add_u32 m0, s30, 0x23800
    s_nop 0
    s_mov_b64 exec, 0xffff
    buffer_load_dwordx4 v11, s[16:19], s32 offen lds
    s_mov_b64 exec, -1
    s_add_u32 s32, s32, 0x80
    v_mfma_f32_16x16x32_bf16 v[92:95], v[52:55], v[84:87], v[92:95]
    ds_read_b128 v[44:47], v14 offset:16384
    v_mfma_f32_16x16x32_bf16 v[96:99], v[56:59], v[84:87], v[96:99]
    ds_read_b128 v[48:51], v15 offset:10240
    v_mfma_f32_16x16x32_bf16 v[100:103], v[60:63], v[84:87], v[100:103]
    ds_read_b128 v[52:55], v15 offset:12288
    ds_read_b128 v[84:87], v13 offset:40960
    s_waitcnt lgkmcnt(7)
    v_mfma_f32_16x16x32_bf16 v[88:91], v[32:35], v[72:75], v[88:91]
    ds_read_b128 v[56:59], v15 offset:14336
    s_waitcnt lgkmcnt(7)
    v_mfma_f32_16x16x32_bf16 v[92:95], v[36:39], v[72:75], v[92:95]
    ds_read_b128 v[60:63], v15 offset:16384
    s_waitcnt lgkmcnt(6)
    v_mfma_f32_16x16x32_bf16 v[96:99], v[40:43], v[72:75], v[96:99]
    s_waitcnt vmcnt(6) lgkmcnt(0)
    s_barrier
    ds_read_b128 v[32:35], v18 offset:10240
    s_add_u32 m0, s29, 0x12000
    s_nop 0
    buffer_load_dwordx4 v9, s[16:19], s32 offen lds
    v_mfma_f32_16x16x32_bf16 v[100:103], v[44:47], v[72:75], v[100:103]
    ds_read_b128 v[36:39], v18 offset:12288
    ds_read_b128 v[72:75], v12 offset:49152
    s_add_u32 m0, s29, 0x14000
    s_add_u32 s33, s32, 0x12000
    buffer_load_dwordx4 v9, s[16:19], s33 offen lds
    v_mfma_f32_16x16x32_bf16 v[88:91], v[48:51], v[76:79], v[88:91]
    ds_read_b128 v[40:43], v18 offset:14336
    s_add_u32 m0, s30, 0x16000
    s_nop 0
    s_mov_b64 exec, 0xffff
    buffer_load_dwordx4 v11, s[16:19], s32 offen lds
    s_mov_b64 exec, -1
    s_add_u32 s32, s32, 0x80
    v_mfma_f32_16x16x32_bf16 v[92:95], v[52:55], v[76:79], v[92:95]
    ds_read_b128 v[44:47], v18 offset:16384
    v_mfma_f32_16x16x32_bf16 v[96:99], v[56:59], v[76:79], v[96:99]
    ds_read_b128 v[48:51], v19 offset:10240
    v_mfma_f32_16x16x32_bf16 v[100:103], v[60:63], v[76:79], v[100:103]
    ds_read_b128 v[52:55], v19 offset:12288
    ds_read_b128 v[76:79], v13 offset:49152
    s_waitcnt lgkmcnt(7)
    v_mfma_f32_16x16x32_bf16 v[88:91], v[32:35], v[80:83], v[88:91]
    ds_read_b128 v[56:59], v19 offset:14336
    s_waitcnt lgkmcnt(7)
    v_mfma_f32_16x16x32_bf16 v[92:95], v[36:39], v[80:83], v[92:95]
    ds_read_b128 v[60:63], v19 offset:16384
    s_waitcnt lgkmcnt(6)
    v_mfma_f32_16x16x32_bf16 v[96:99], v[40:43], v[80:83], v[96:99]
    s_waitcnt vmcnt(6) lgkmcnt(0)
    s_barrier
    ds_read_b128 v[32:35], v22 offset:10240
    v_mfma_f32_16x16x32_bf16 v[100:103], v[44:47], v[80:83], v[100:103]
    ds_read_b128 v[36:39], v22 offset:12288
    ds_read_b128 v[80:83], v12 offset:57344
    v_mfma_f32_16x16x32_bf16 v[88:91], v[48:51], v[84:87], v[88:91]
    ds_read_b128 v[40:43], v22 offset:14336
    v_mfma_f32_16x16x32_bf16 v[92:95], v[52:55], v[84:87], v[92:95]
    ds_read_b128 v[44:47], v22 offset:16384
    v_mfma_f32_16x16x32_bf16 v[96:99], v[56:59], v[84:87], v[96:99]
    ds_read_b128 v[48:51], v23 offset:10240
    v_mfma_f32_16x16x32_bf16 v[100:103], v[60:63], v[84:87], v[100:103]
    ds_read_b128 v[52:55], v23 offset:12288
    ds_read_b128 v[84:87], v13 offset:57344
    s_waitcnt lgkmcnt(7)
    v_mfma_f32_16x16x32_bf16 v[88:91], v[32:35], v[72:75], v[88:91]
    ds_read_b128 v[56:59], v23 offset:14336
    s_waitcnt lgkmcnt(7)
    v_mfma_f32_16x16x32_bf16 v[92:95], v[36:39], v[72:75], v[92:95]
    ds_read_b128 v[60:63], v23 offset:16384
    s_waitcnt lgkmcnt(6)
    v_mfma_f32_16x16x32_bf16 v[96:99], v[40:43], v[72:75], v[96:99]
    s_waitcnt vmcnt(3) lgkmcnt(0)
    s_barrier
    ds_read_b128 v[32:35], v26 offset:10240
    v_mfma_f32_16x16x32_bf16 v[100:103], v[44:47], v[72:75], v[100:103]
    ds_read_b128 v[36:39], v26 offset:12288
    ds_read_b128 v[72:75], v16 offset:0
    v_mfma_f32_16x16x32_bf16 v[88:91], v[48:51], v[76:79], v[88:91]
    ds_read_b128 v[40:43], v26 offset:14336
    v_mfma_f32_16x16x32_bf16 v[92:95], v[52:55], v[76:79], v[92:95]
    ds_read_b128 v[44:47], v26 offset:16384
    v_mfma_f32_16x16x32_bf16 v[96:99], v[56:59], v[76:79], v[96:99]
    ds_read_b128 v[48:51], v27 offset:10240
    v_mfma_f32_16x16x32_bf16 v[100:103], v[60:63], v[76:79], v[100:103]
    ds_read_b128 v[52:55], v27 offset:12288
    ds_read_b128 v[76:79], v17 offset:0
    s_waitcnt lgkmcnt(7)
    v_mfma_f32_16x16x32_bf16 v[88:91], v[32:35], v[80:83], v[88:91]
    ds_read_b128 v[56:59], v27 offset:14336
    s_waitcnt lgkmcnt(7)
    v_mfma_f32_16x16x32_bf16 v[92:95], v[36:39], v[80:83], v[92:95]
    ds_read_b128 v[60:63], v27 offset:16384
    s_waitcnt lgkmcnt(6)
    v_mfma_f32_16x16x32_bf16 v[96:99], v[40:43], v[80:83], v[96:99]
    s_waitcnt vmcnt(0) lgkmcnt(0)
    s_barrier
    ds_read_b128 v[32:35], v14 offset:10240
    v_mfma_f32_16x16x32_bf16 v[100:103], v[44:47], v[80:83], v[100:103]
    ds_read_b128 v[36:39], v14 offset:12288
    v_mfma_f32_16x16x32_bf16 v[88:91], v[48:51], v[84:87], v[88:91]
    ds_read_b128 v[40:43], v14 offset:14336
    v_mfma_f32_16x16x32_bf16 v[92:95], v[52:55], v[84:87], v[92:95]
    ds_read_b128 v[44:47], v14 offset:16384
    v_mfma_f32_16x16x32_bf16 v[96:99], v[56:59], v[84:87], v[96:99]
    ds_read_b128 v[48:51], v15 offset:10240
    v_mfma_f32_16x16x32_bf16 v[100:103], v[60:63], v[84:87], v[100:103]
    ds_read_b128 v[52:55], v15 offset:12288
    s_waitcnt lgkmcnt(5)
    v_mfma_f32_16x16x32_bf16 v[88:91], v[32:35], v[72:75], v[88:91]
    ds_read_b128 v[56:59], v15 offset:14336
    s_waitcnt lgkmcnt(5)
    v_mfma_f32_16x16x32_bf16 v[92:95], v[36:39], v[72:75], v[92:95]
    ds_read_b128 v[60:63], v15 offset:16384
    s_waitcnt lgkmcnt(5)
    v_mfma_f32_16x16x32_bf16 v[96:99], v[40:43], v[72:75], v[96:99]
    s_waitcnt lgkmcnt(4)
    v_mfma_f32_16x16x32_bf16 v[100:103], v[44:47], v[72:75], v[100:103]
    s_waitcnt lgkmcnt(3)
    v_mfma_f32_16x16x32_bf16 v[88:91], v[48:51], v[76:79], v[88:91]
    s_waitcnt lgkmcnt(2)
    v_mfma_f32_16x16x32_bf16 v[92:95], v[52:55], v[76:79], v[92:95]
    s_waitcnt lgkmcnt(1)
    v_mfma_f32_16x16x32_bf16 v[96:99], v[56:59], v[76:79], v[96:99]
    s_waitcnt lgkmcnt(0)
    v_mfma_f32_16x16x32_bf16 v[100:103], v[60:63], v[76:79], v[100:103]
    s_nop 7
    s_nop 3
    s_barrier
    v_cvt_pk_bf16_f32 v28, v88, v89
    v_cvt_pk_bf16_f32 v29, v90, v91
    v_xor_b32 v28, s47, v28
    v_xor_b32 v29, s47, v29
    v_cvt_pk_bf16_f32 v30, v92, v93
    v_cvt_pk_bf16_f32 v31, v94, v95
    v_xor_b32 v30, s47, v30
    v_xor_b32 v31, s47, v31
    s_nop 1
    v_permlane16_swap_b32 v28, v30
    v_permlane16_swap_b32 v29, v31
    s_nop 0
    ds_write_b128 v7, v[28:31] offset:160
    v_cvt_pk_bf16_f32 v32, v96, v97
    v_cvt_pk_bf16_f32 v33, v98, v99
    v_xor_b32 v32, s47, v32
    v_xor_b32 v33, s47, v33
    v_cvt_pk_bf16_f32 v34, v100, v101
    v_cvt_pk_bf16_f32 v35, v102, v103
    v_xor_b32 v34, s47, v34
    v_xor_b32 v35, s47, v35
    s_nop 1
    v_permlane16_swap_b32 v32, v34
    v_permlane16_swap_b32 v33, v35
    s_nop 0
    ds_write_b128 v7, v[32:35] offset:224
LJ_rompt_kernel_3:
    v_lshlrev_b32 v2, 4, v0
    s_waitcnt lgkmcnt(0)
    s_barrier
    ds_read_b128 v[28:31], v2 offset:0
    ds_read_b128 v[32:35], v2 offset:8192
    ds_read_b128 v[36:39], v2 offset:16384
    s_mov_b32 s33, 0
    s_waitcnt lgkmcnt(2)
    buffer_store_dwordx4 v[28:31], v2, s[24:27], s33 offen sc0 sc1
    s_mov_b32 s33, 8192
    s_waitcnt lgkmcnt(1)
    buffer_store_dwordx4 v[32:35], v2, s[24:27], s33 offen sc0 sc1
    s_mov_b32 s33, 16384
    s_waitcnt lgkmcnt(0)
    buffer_store_dwordx4 v[36:39], v2, s[24:27], s33 offen sc0 sc1
    s_mov_b32 s44, s2
    s_waitcnt vmcnt(0)
    s_barrier
    s_cmp_lg_u32 s28, 0
    s_cbranch_scc1 LPB_rompt_kernel_5
    s_load_dwordx2 s[72:73], s[0:1], 80
    s_waitcnt lgkmcnt(0)
    s_add_u32 s72, s72, 0x0
    s_addc_u32 s73, s73, 0
    s_mov_b32 s74, 0x100
    s_and_b32 s73, s73, 0xffff
    s_mov_b32 s75, 0x20000
    s_mov_b64 exec, 1
    s_and_b32 s46, s2, 7
    s_lshl_b32 s46, s46, 5
    v_mov_b32 v2, s46
    v_mov_b32 v3, 1
    buffer_atomic_add v3, v2, s[72:75], 0 offen sc1
    s_mov_b64 exec, -1
LPB_rompt_kernel_5:
    s_load_dwordx2 s[4:5], s[0:1], 88
    s_load_dwordx4 s[8:11], s[0:1], 8
    s_load_dwordx2 s[48:49], s[0:1], 0
    s_load_dwordx2 s[56:57], s[0:1], 48
    s_load_dwordx2 s[58:59], s[0:1], 56
    v_and_b32 v1, 63, v0
    v_lshrrev_b32 v2, 6, v0
    s_nop 0
    v_readfirstlane_b32 s28, v2
    s_and_b32 s34, s2, 7
    s_lshr_b32 s35, s2, 3
    s_and_b32 s36, s34, 3
    s_lshr_b32 s37, s34, 2
    s_lshl_b32 s37, s37, 3
    s_lshr_b32 s38, s35, 2
    s_add_u32 s37, s37, s38
    s_and_b32 s38, s35, 3
    s_lshl_b32 s29, s28, 10
    s_lshl_b32 s30, s28, 8
    v_lshrrev_b32 v2, 3, v1
    s_lshl_b32 s33, s28, 3
    v_add_u32 v2, s33, v2
    v_bfe_u32 v3, v2, 1, 3
    v_and_b32 v4, 7, v1
    v_xor_b32 v3, v3, v4
    v_mul_u32_u24 v8, 4096, v2
    v_lshl_add_u32 v8, v3, 4, v8
    s_lshl_b32 s33, s28, 6
    s_add_u32 s33, s33, 0
    v_add_u32 v2, s33, v1
    v_mul_u32_u24 v3, 3641, v2
    v_lshrrev_b32 v3, 16, v3
    v_mul_u32_u24 v4, 18, v3
    v_sub_u32 v4, v2, v4
    v_and_b32 v5, 0x33, v3
    v_and_b32 v6, 4, v3
    v_lshl_or_b32 v5, v6, 1, v5
    v_and_b32 v6, 8, v3
    v_lshrrev_b32 v6, 1, v6
    v_or_b32 v5, v5, v6
    v_mul_u32_u24 v9, 288, v5
    v_lshl_add_u32 v9, v4, 4, v9
    s_lshl_b32 s33, s28, 6
    s_add_u32 s33, s33, 512
    v_add_u32 v2, s33, v1
    v_mul_u32_u24 v3, 3641, v2
    v_lshrrev_b32 v3, 16, v3
    v_mul_u32_u24 v4, 18, v3
    v_sub_u32 v4, v2, v4
    v_and_b32 v5, 0x33, v3
    v_and_b32 v6, 4, v3
    v_lshl_or_b32 v5, v6, 1, v5
    v_and_b32 v6, 8, v3
    v_lshrrev_b32 v6, 1, v6
    v_or_b32 v5, v5, v6
    v_mul_u32_u24 v10, 288, v5
    v_lshl_add_u32 v10, v4, 4, v10
    s_lshl_b32 s33, s28, 4
    s_add_u32 s33, s33, 1024
    v_add_u32 v2, s33, v1
    v_mul_u32_u24 v3, 3641, v2
    v_lshrrev_b32 v3, 16, v3
    v_mul_u32_u24 v4, 18, v3
    v_sub_u32 v4, v2, v4
    v_and_b32 v5, 0x33, v3
    v_and_b32 v6, 4, v3
    v_lshl_or_b32 v5, v6, 1, v5
    v_and_b32 v6, 8, v3
    v_lshrrev_b32 v6, 1, v6
    v_or_b32 v5, v5, v6
    v_mul_u32_u24 v11, 288, v5
    v_lshl_add_u32 v11, v4, 4, v11
    s_mov_b32 s31, 0
    s_mov_b32 s32, 0
    s_waitcnt lgkmcnt(0)
    s_cmp_lt_u32 s36, 2
    s_cselect_b32 s6, s8, s10
    s_cselect_b32 s7, s9, s11
    s_mul_i32 s44, s37, 524288
    s_and_b32 s45, s36, 1
    s_lshl_b32 s45, s45, 11
    s_add_u32 s44, s44, s45
    s_add_u32 s12, s6, 0x0
    s_addc_u32 s13, s7, 0
    s_add_u32 s12, s12, s44
    s_addc_u32 s13, s13, 0
    s_sub_u32 s14, 0x800000, s44
    s_and_b32 s13, s13, 0xffff
    s_mov_b32 s15, 0x20000
    s_lshr_b32 s44, s36, 1
    s_lshl_b32 s44, s44, 2
    s_add_u32 s44, s44, s38
    s_lshl_b32 s44, s44, 1
    s_and_b32 s45, s36, 1
    s_add_u32 s44, s44, s45
    s_mul_i32 s44, s44, 294912
    s_add_u32 s16, s4, 0xc00000
    s_addc_u32 s17, s5, 0
    s_add_u32 s16, s16, s44
    s_addc_u32 s17, s17, 0
    s_sub_u32 s18, 0x480000, s44
    s_and_b32 s17, s17, 0xffff
    s_mov_b32 s19, 0x20000
    s_add_u32 m0, s29, 0x0
    s_nop 0
    buffer_load_dwordx4 v8, s[12:15], s31 offen lds
    s_add_u32 m0, s29, 0x2000
    s_add_u32 s33, s31, 0x40000
    buffer_load_dwordx4 v8, s[12:15], s33 offen lds
    s_add_u32 s31, s31, 128
    s_add_u32 m0, s29, 0x8800
    s_nop 0
    buffer_load_dwordx4 v8, s[12:15], s31 offen lds
    s_add_u32 m0, s29, 0xa800
    s_add_u32 s33, s31, 0x40000
    buffer_load_dwordx4 v8, s[12:15], s33 offen lds
    s_add_u32 s31, s31, 128
    s_add_u32 m0, s29, 0x11000
    s_nop 0
    buffer_load_dwordx4 v8, s[12:15], s31 offen lds
    s_add_u32 m0, s29, 0x13000
    s_add_u32 s33, s31, 0x40000
    buffer_load_dwordx4 v8, s[12:15], s33 offen lds
    s_add_u32 s31, s31, 128
    s_add_u32 m0, s29, 0x19800
    s_nop 0
    buffer_load_dwordx4 v8, s[12:15], s31 offen lds
    s_add_u32 m0, s29, 0x1b800
    s_add_u32 s33, s31, 0x40000
    buffer_load_dwordx4 v8, s[12:15], s33 offen lds
    s_add_u32 s31, s31, 128
    s_and_b32 s44, s36, 1
    s_lshl_b32 s44, s44, 7
    s_lshr_b32 s45, s36, 1
    s_lshl_b32 s45, s45, 2
    s_add_u32 s44, s44, s45
    s_add_u32 s44, s44, s38
    v_lshl_add_u32 v2, v1, 3, s44
    s_lshl_b32 s64, s2, 3
    s_add_u32 s64, s64, s28
    s_mul_i32 s64, s64, 8192
    s_mov_b32 s60, s56
    s_mov_b32 s61, s57
    s_mov_b32 s62, 0x510000
    s_cmp_ge_u32 s64, 0x510000
    s_cselect_b32 s60, s58, s60
    s_cselect_b32 s61, s59, s61
    s_cselect_b32 s65, 0x510000, 0
    s_sub_u32 s64, s64, s65
    s_and_b32 s61, s61, 0xffff
    s_mov_b32 s63, 0x20000
    v_mul_u32_u24 v197, 128, v1
    v_add_u32 v197, s64, v197
    s_cmp_eq_u32 s28, 0
    s_cbranch_scc1 LPF_rompt_kernel_6
    buffer_load_dword v196, v197, s[60:63], 0 offen
LPF_rompt_kernel_6:
    s_cmp_lg_u32 s28, 0
    s_cbranch_scc1 LFS_rompt_kernel_7
    s_load_dwordx2 s[72:73], s[0:1], 80
    s_waitcnt lgkmcnt(0)
    s_add_u32 s72, s72, 0x0
    s_addc_u32 s73, s73, 0
    s_mov_b32 s74, 0x100
    s_and_b32 s73, s73, 0xffff
    s_mov_b32 s75, 0x20000
    v_and_b32 v2, 63, v0
    v_lshlrev_b32 v2, 3, v2
    v_lshlrev_b32 v2, 2, v2
    s_mov_b64 exec, 0xff
    s_mov_b32 s45, 0
LFW_rompt_kernel_8:
    buffer_load_dword v3, v2, s[72:75], 0 offen sc0 sc1
    s_waitcnt vmcnt(0)
    v_cmp_ne_u32 vcc, 32, v3
    s_nop 3
    s_cmp_eq_u64 vcc, 0
    s_cbranch_scc1 LFD_rompt_kernel_9
    s_add_u32 s45, s45, 1
    s_cmp_lt_u32 s45, 0x100000
    s_cbranch_scc1 LFW_rompt_kernel_8
LFD_rompt_kernel_9:
    s_mov_b64 exec, -1
LFS_rompt_kernel_7:
    s_barrier
    s_add_u32 m0, s29, 0x4000
    s_nop 0
    buffer_load_dwordx4 v9, s[16:19], s32 offen lds
    s_add_u32 m0, s29, 0x6000
    s_nop 0
    buffer_load_dwordx4 v10, s[16:19], s32 offen lds
    s_add_u32 m0, s30, 0x8000
    s_nop 0
    s_mov_b64 exec, 0xffff
    buffer_load_dwordx4 v11, s[16:19], s32 offen lds
    s_mov_b64 exec, -1
    s_add_u32 s32, s32, 0x4800
    s_add_u32 m0, s29, 0xc800
    s_nop 0
    buffer_load_dwordx4 v9, s[16:19], s32 offen lds
    s_add_u32 m0, s29, 0xe800
    s_nop 0
    buffer_load_dwordx4 v10, s[16:19], s32 offen lds
    s_add_u32 m0, s30, 0x10800
    s_nop 0
    s_mov_b64 exec, 0xffff
    buffer_load_dwordx4 v11, s[16:19], s32 offen lds
    s_mov_b64 exec, -1
    s_add_u32 s32, s32, 0x4800
    s_add_u32 m0, s29, 0x15000
    s_nop 0
    buffer_load_dwordx4 v9, s[16:19], s32 offen lds
    s_add_u32 m0, s29, 0x17000
    s_nop 0
    buffer_load_dwordx4 v10, s[16:19], s32 offen lds
    s_add_u32 m0, s30, 0x19000
    s_nop 0
    s_mov_b64 exec, 0xffff
    buffer_load_dwordx4 v11, s[16:19], s32 offen lds
    s_mov_b64 exec, -1
    s_add_u32 s32, s32, 0x4800
    s_add_u32 m0, s29, 0x1d800
    s_nop 0
    buffer_load_dwordx4 v9, s[16:19], s32 offen lds
    s_add_u32 m0, s29, 0x1f800
    s_nop 0
    buffer_load_dwordx4 v10, s[16:19], s32 offen lds
    s_add_u32 m0, s30, 0x21800
    s_nop 0
    s_mov_b64 exec, 0xffff
    buffer_load_dwordx4 v11, s[16:19], s32 offen lds
    s_mov_b64 exec, -1
    s_add_u32 s32, s32, 0x4800
    s_lshl_b32 s64, s2, 3
    s_add_u32 s64, s64, s28
    s_mul_i32 s64, s64, 8192
    s_mov_b32 s60, s56
    s_mov_b32 s61, s57
    s_mov_b32 s62, 0x510000
    s_cmp_ge_u32 s64, 0x510000
    s_cselect_b32 s60, s58, s60
    s_cselect_b32 s61, s59, s61
    s_cselect_b32 s65, 0x510000, 0
    s_sub_u32 s64, s64, s65
    s_and_b32 s61, s61, 0xffff
    s_mov_b32 s63, 0x20000
    v_mul_u32_u24 v197, 128, v1
    v_add_u32 v197, s64, v197
    s_and_b32 s33, s28, 3
    s_mul_i32 s33, s33, 4096
    v_and_b32 v2, 15, v1
    v_lshrrev_b32 v3, 4, v1
    v_bfe_u32 v4, v1, 1, 3
    v_xor_b32 v4, v3, v4
    v_lshlrev_b32 v4, 4, v4
    v_lshl_add_u32 v4, v2, 7, v4
    v_add_u32 v5, s33, v4
    v_add_u32 v12, 0x0, v5
    v_xor_b32 v13, 64, v12
    v_add_u32 v15, 0x8800, v5
    v_xor_b32 v16, 64, v15
    v_add_u32 v18, 0x11000, v5
    v_xor_b32 v19, 64, v18
    v_add_u32 v21, 0x19800, v5
    v_xor_b32 v22, 64, v21
    v_lshrrev_b32 v4, 5, v1
    v_lshlrev_b32 v4, 4, v4
    v_bfe_u32 v5, v1, 4, 1
    v_lshl_add_u32 v4, v5, 2, v4
    v_bfe_u32 v5, v1, 2, 2
    v_add_u32 v4, v4, v5
    v_mul_u32_u24 v4, 288, v4
    v_and_b32 v5, 3, v1
    v_lshl_add_u32 v4, v5, 3, v4
    v_add_u32 v14, 0x4000, v4
    v_add_u32 v17, 0xc800, v4
    v_add_u32 v20, 0x15000, v4
    v_add_u32 v23, 0x1d800, v4
    s_and_b32 s33, s28, 3
    s_mul_i32 s33, s33, 32
    v_and_b32 v5, 15, v1
    v_add_u32 v5, s33, v5
    v_lshrrev_b32 v6, 4, v1
    v_mul_u32_u24 v5, 288, v5
    v_and_b32 v2, 1, v6
    v_lshl_add_u32 v7, v2, 5, v5
    v_lshrrev_b32 v2, 1, v6
    v_lshl_add_u32 v7, v2, 4, v7
    v_lshl_add_u32 v6, v6, 3, v5
    s_lshl_b32 s44, s36, 4
    s_add_u32 s44, s44, s37
    s_lshl_b32 s44, s44, 2
    s_and_b32 s46, s28, 3
    s_add_u32 s44, s44, s46
    s_mul_i32 s44, s44, 36864
    s_mul_i32 s46, s38, 9216
    s_add_u32 s44, s44, s46
    s_add_u32 s24, s4, 0x1400000
    s_addc_u32 s25, s5, 0
    s_add_u32 s24, s24, s44
    s_addc_u32 s25, s25, 0
    s_sub_u32 s26, 0x900000, s44
    s_and_b32 s25, s25, 0xffff
    s_mov_b32 s27, 0x20000
    v_lshlrev_b32 v7, 4, v1
    s_waitcnt vmcnt(9)
    s_barrier
    s_cmp_ge_u32 s28, 4
    s_cbranch_scc1 LG_rompt_kernel_11
    ds_read_b128 v[68:71], v12 offset:0
    ds_read_b128 v[72:75], v12 offset:2048
    ds_read_b64_tr_b16 v[28:29], v14 offset:0
    ds_read_b64_tr_b16 v[30:31], v14 offset:2304
    ds_read_b64_tr_b16 v[32:33], v14 offset:32
    ds_read_b64_tr_b16 v[34:35], v14 offset:2336
    ds_read_b64_tr_b16 v[36:37], v14 offset:64
    ds_read_b64_tr_b16 v[38:39], v14 offset:2368
    ds_read_b64_tr_b16 v[40:41], v14 offset:96
    ds_read_b64_tr_b16 v[42:43], v14 offset:2400
    ds_read_b64_tr_b16 v[44:45], v14 offset:128
    ds_read_b64_tr_b16 v[46:47], v14 offset:2432
    ds_read_b128 v[76:79], v13 offset:0
    ds_read_b128 v[80:83], v13 offset:2048
    ds_read_b64_tr_b16 v[48:49], v14 offset:9216
    s_waitcnt lgkmcnt(13)
    ds_read_b64_tr_b16 v[50:51], v14 offset:11520
    ds_read_b64_tr_b16 v[52:53], v14 offset:9248
    s_waitcnt lgkmcnt(13)
    ds_read_b64_tr_b16 v[54:55], v14 offset:11552
    ds_read_b64_tr_b16 v[56:57], v14 offset:9280
    s_waitcnt lgkmcnt(13)
    ds_read_b64_tr_b16 v[58:59], v14 offset:11584
    v_mfma_f32_16x16x32_bf16 v[100:103], v[28:31], v[68:71], 0
    v_mfma_f32_16x16x32_bf16 v[104:107], v[28:31], v[72:75], 0
    ds_read_b64_tr_b16 v[60:61], v14 offset:9312
    s_waitcnt lgkmcnt(13)
    ds_read_b64_tr_b16 v[62:63], v14 offset:11616
    v_mfma_f32_16x16x32_bf16 v[108:111], v[32:35], v[68:71], 0
    v_mfma_f32_16x16x32_bf16 v[112:115], v[32:35], v[72:75], 0
    ds_read_b64_tr_b16 v[64:65], v14 offset:9344
    s_waitcnt lgkmcnt(13)
    ds_read_b64_tr_b16 v[66:67], v14 offset:11648
    v_mfma_f32_16x16x32_bf16 v[116:119], v[36:39], v[68:71], 0
    v_mfma_f32_16x16x32_bf16 v[120:123], v[36:39], v[72:75], 0
    s_waitcnt vmcnt(6) lgkmcnt(0)
    s_barrier
    ds_read_b128 v[84:87], v15 offset:0
    ds_read_b128 v[88:91], v15 offset:2048
    ds_read_b64_tr_b16 v[28:29], v17 offset:0
    ds_read_b64_tr_b16 v[30:31], v17 offset:2304
    s_add_u32 m0, s29, 0x0
    s_nop 0
    buffer_load_dwordx4 v8, s[12:15], s31 offen lds
    v_mfma_f32_16x16x32_bf16 v[124:127], v[40:43], v[68:71], 0
    v_mfma_f32_16x16x32_bf16 v[128:131], v[40:43], v[72:75], 0
    ds_read_b64_tr_b16 v[32:33], v17 offset:32
    ds_read_b64_tr_b16 v[34:35], v17 offset:2336
    ds_read_b128 v[92:95], v16 offset:0
    s_add_u32 m0, s29, 0x2000
    s_add_u32 s33, s31, 0x40000
    buffer_load_dwordx4 v8, s[12:15], s33 offen lds
    s_add_u32 s31, s31, 128
    v_mfma_f32_16x16x32_bf16 v[132:135], v[44:47], v[68:71], 0
    v_mfma_f32_16x16x32_bf16 v[136:139], v[44:47], v[72:75], 0
    ds_read_b64_tr_b16 v[36:37], v17 offset:64
    ds_read_b64_tr_b16 v[38:39], v17 offset:2368
    ds_read_b128 v[96:99], v16 offset:2048
    s_add_u32 m0, s29, 0x4000
    s_nop 0
    buffer_load_dwordx4 v9, s[16:19], s32 offen lds
    v_mfma_f32_16x16x32_bf16 v[100:103], v[48:51], v[76:79], v[100:103]
    v_mfma_f32_16x16x32_bf16 v[104:107], v[48:51], v[80:83], v[104:107]
    ds_read_b64_tr_b16 v[40:41], v17 offset:96
    ds_read_b64_tr_b16 v[42:43], v17 offset:2400
    s_add_u32 m0, s29, 0x6000
    s_nop 0
    buffer_load_dwordx4 v10, s[16:19], s32 offen lds
    v_mfma_f32_16x16x32_bf16 v[108:111], v[52:55], v[76:79], v[108:111]
    v_mfma_f32_16x16x32_bf16 v[112:115], v[52:55], v[80:83], v[112:115]
    ds_read_b64_tr_b16 v[44:45], v17 offset:128
    ds_read_b64_tr_b16 v[46:47], v17 offset:2432
    s_add_u32 m0, s30, 0x8000
    s_nop 0
    s_mov_b64 exec, 0xffff
    buffer_load_dwordx4 v11, s[16:19], s32 offen lds
    s_mov_b64 exec, -1
    s_add_u32 s32, s32, 0x4800
    v_mfma_f32_16x16x32_bf16 v[116:119], v[56:59], v[76:79], v[116:119]
    v_mfma_f32_16x16x32_bf16 v[120:123], v[56:59], v[80:83], v[120:123]
    ds_read_b64_tr_b16 v[48:49], v17 offset:9216
    s_waitcnt lgkmcnt(13)
    ds_read_b64_tr_b16 v[50:51], v17 offset:11520
    v_mfma_f32_16x16x32_bf16 v[124:127], v[60:63], v[76:79], v[124:127]
    v_mfma_f32_16x16x32_bf16 v[128:131], v[60:63], v[80:83], v[128:131]
    ds_read_b64_tr_b16 v[52:53], v17 offset:9248
    s_waitcnt lgkmcnt(13)
    ds_read_b64_tr_b16 v[54:55], v17 offset:11552
    v_mfma_f32_16x16x32_bf16 v[132:135], v[64:67], v[76:79], v[132:135]
    v_mfma_f32_16x16x32_bf16 v[136:139], v[64:67], v[80:83], v[136:139]
    ds_read_b64_tr_b16 v[56:57], v17 offset:9280
    s_waitcnt lgkmcnt(13)
    ds_read_b64_tr_b16 v[58:59], v17 offset:11584
    v_mfma_f32_16x16x32_bf16 v[100:103], v[28:31], v[84:87], v[100:103]
    v_mfma_f32_16x16x32_bf16 v[104:107], v[28:31], v[88:91], v[104:107]
    ds_read_b64_tr_b16 v[60:61], v17 offset:9312
    s_waitcnt lgkmcnt(13)
    ds_read_b64_tr_b16 v[62:63], v17 offset:11616
    v_mfma_f32_16x16x32_bf16 v[108:111], v[32:35], v[84:87], v[108:111]
    v_mfma_f32_16x16x32_bf16 v[112:115], v[32:35], v[88:91], v[112:115]
    ds_read_b64_tr_b16 v[64:65], v17 offset:9344
    s_waitcnt lgkmcnt(13)
    ds_read_b64_tr_b16 v[66:67], v17 offset:11648
    v_mfma_f32_16x16x32_bf16 v[116:119], v[36:39], v[84:87], v[116:119]
    v_mfma_f32_16x16x32_bf16 v[120:123], v[36:39], v[88:91], v[120:123]
    s_waitcnt vmcnt(8) lgkmcnt(0)
    s_barrier
    ds_read_b128 v[68:71], v18 offset:0
    ds_read_b128 v[72:75], v18 offset:2048
    ds_read_b64_tr_b16 v[28:29], v20 offset:0
    ds_read_b64_tr_b16 v[30:31], v20 offset:2304
    s_add_u32 m0, s29, 0x8800
    s_nop 0
    buffer_load_dwordx4 v8, s[12:15], s31 offen lds
    v_mfma_f32_16x16x32_bf16 v[124:127], v[40:43], v[84:87], v[124:127]
    v_mfma_f32_16x16x32_bf16 v[128:131], v[40:43], v[88:91], v[128:131]
    ds_read_b64_tr_b16 v[32:33], v20 offset:32
    ds_read_b64_tr_b16 v[34:35], v20 offset:2336
    ds_read_b128 v[76:79], v19 offset:0
    s_add_u32 m0, s29, 0xa800
    s_add_u32 s33, s31, 0x40000
    buffer_load_dwordx4 v8, s[12:15], s33 offen lds
    s_add_u32 s31, s31, 128
    v_mfma_f32_16x16x32_bf16 v[132:135], v[44:47], v[84:87], v[132:135]
    v_mfma_f32_16x16x32_bf16 v[136:139], v[44:47], v[88:91], v[136:139]
    ds_read_b64_tr_b16 v[36:37], v20 offset:64
    ds_read_b64_tr_b16 v[38:39], v20 offset:2368
    ds_read_b128 v[80:83], v19 offset:2048
    s_add_u32 m0, s29, 0xc800
    s_nop 0
    buffer_load_dwordx4 v9, s[16:19], s32 offen lds
    v_mfma_f32_16x16x32_bf16 v[100:103], v[48:51], v[92:95], v[100:103]
    v_mfma_f32_16x16x32_bf16 v[104:107], v[48:51], v[96:99], v[104:107]
    ds_read_b64_tr_b16 v[40:41], v20 offset:96
    ds_read_b64_tr_b16 v[42:43], v20 offset:2400
    s_add_u32 m0, s29, 0xe800
    s_nop 0
    buffer_load_dwordx4 v10, s[16:19], s32 offen lds
    v_mfma_f32_16x16x32_bf16 v[108:111], v[52:55], v[92:95], v[108:111]
    v_mfma_f32_16x16x32_bf16 v[112:115], v[52:55], v[96:99], v[112:115]
    ds_read_b64_tr_b16 v[44:45], v20 offset:128
    ds_read_b64_tr_b16 v[46:47], v20 offset:2432
    s_add_u32 m0, s30, 0x10800
    s_nop 0
    s_mov_b64 exec, 0xffff
    buffer_load_dwordx4 v11, s[16:19], s32 offen lds
    s_mov_b64 exec, -1
    s_add_u32 s32, s32, 0x4800
    v_mfma_f32_16x16x32_bf16 v[116:119], v[56:59], v[92:95], v[116:119]
    v_mfma_f32_16x16x32_bf16 v[120:123], v[56:59], v[96:99], v[120:123]
    ds_read_b64_tr_b16 v[48:49], v20 offset:9216
    s_waitcnt lgkmcnt(13)
    ds_read_b64_tr_b16 v[50:51], v20 offset:11520
    v_mfma_f32_16x16x32_bf16 v[124:127], v[60:63], v[92:95], v[124:127]
    v_mfma_f32_16x16x32_bf16 v[128:131], v[60:63], v[96:99], v[128:131]
    ds_read_b64_tr_b16 v[52:53], v20 offset:9248
    s_waitcnt lgkmcnt(13)
    ds_read_b64_tr_b16 v[54:55], v20 offset:11552
    v_mfma_f32_16x16x32_bf16 v[132:135], v[64:67], v[92:95], v[132:135]
    v_mfma_f32_16x16x32_bf16 v[136:139], v[64:67], v[96:99], v[136:139]
    ds_read_b64_tr_b16 v[56:57], v20 offset:9280
    s_waitcnt lgkmcnt(13)
    ds_read_b64_tr_b16 v[58:59], v20 offset:11584
    s_mov_b32 s40, 2
LP_rompt_kernel_12:
    v_mfma_f32_16x16x32_bf16 v[100:103], v[28:31], v[68:71], v[100:103]
    v_mfma_f32_16x16x32_bf16 v[104:107], v[28:31], v[72:75], v[104:107]
    ds_read_b64_tr_b16 v[60:61], v20 offset:9312
    s_waitcnt lgkmcnt(13)
    ds_read_b64_tr_b16 v[62:63], v20 offset:11616
    v_mfma_f32_16x16x32_bf16 v[108:111], v[32:35], v[68:71], v[108:111]
    v_mfma_f32_16x16x32_bf16 v[112:115], v[32:35], v[72:75], v[112:115]
    ds_read_b64_tr_b16 v[64:65], v20 offset:9344
    s_waitcnt lgkmcnt(13)
    ds_read_b64_tr_b16 v[66:67], v20 offset:11648
    v_mfma_f32_16x16x32_bf16 v[116:119], v[36:39], v[68:71], v[116:119]
    v_mfma_f32_16x16x32_bf16 v[120:123], v[36:39], v[72:75], v[120:123]
    s_waitcnt vmcnt(10) lgkmcnt(0)
    s_barrier
    ds_read_b128 v[84:87], v21 offset:0
    ds_read_b128 v[88:91], v21 offset:2048
    ds_read_b64_tr_b16 v[28:29], v23 offset:0
    ds_read_b64_tr_b16 v[30:31], v23 offset:2304
    s_add_u32 m0, s29, 0x11000
    s_nop 0
    buffer_load_dwordx4 v8, s[12:15], s31 offen lds
    v_mfma_f32_16x16x32_bf16 v[124:127], v[40:43], v[68:71], v[124:127]
    v_mfma_f32_16x16x32_bf16 v[128:131], v[40:43], v[72:75], v[128:131]
    ds_read_b64_tr_b16 v[32:33], v23 offset:32
    ds_read_b64_tr_b16 v[34:35], v23 offset:2336
    ds_read_b128 v[92:95], v22 offset:0
    s_add_u32 m0, s29, 0x13000
    s_add_u32 s33, s31, 0x40000
    buffer_load_dwordx4 v8, s[12:15], s33 offen lds
    s_add_u32 s31, s31, 128
    v_mfma_f32_16x16x32_bf16 v[132:135], v[44:47], v[68:71], v[132:135]
    v_mfma_f32_16x16x32_bf16 v[136:139], v[44:47], v[72:75], v[136:139]
    ds_read_b64_tr_b16 v[36:37], v23 offset:64
    ds_read_b64_tr_b16 v[38:39], v23 offset:2368
    ds_read_b128 v[96:99], v22 offset:2048
    s_add_u32 m0, s29, 0x15000
    s_nop 0
    buffer_load_dwordx4 v9, s[16:19], s32 offen lds
    v_mfma_f32_16x16x32_bf16 v[100:103], v[48:51], v[76:79], v[100:103]
    v_mfma_f32_16x16x32_bf16 v[104:107], v[48:51], v[80:83], v[104:107]
    ds_read_b64_tr_b16 v[40:41], v23 offset:96
    ds_read_b64_tr_b16 v[42:43], v23 offset:2400
    s_add_u32 m0, s29, 0x17000
    s_nop 0
    buffer_load_dwordx4 v10, s[16:19], s32 offen lds
    v_mfma_f32_16x16x32_bf16 v[108:111], v[52:55], v[76:79], v[108:111]
    v_mfma_f32_16x16x32_bf16 v[112:115], v[52:55], v[80:83], v[112:115]
    ds_read_b64_tr_b16 v[44:45], v23 offset:128
    ds_read_b64_tr_b16 v[46:47], v23 offset:2432
    s_add_u32 m0, s30, 0x19000
    s_nop 0
    s_mov_b64 exec, 0xffff
    buffer_load_dwordx4 v11, s[16:19], s32 offen lds
    s_mov_b64 exec, -1
    s_add_u32 s32, s32, 0x4800
    v_mfma_f32_16x16x32_bf16 v[116:119], v[56:59], v[76:79], v[116:119]
    v_mfma_f32_16x16x32_bf16 v[120:123], v[56:59], v[80:83], v[120:123]
    ds_read_b64_tr_b16 v[48:49], v23 offset:9216
    s_waitcnt lgkmcnt(13)
    ds_read_b64_tr_b16 v[50:51], v23 offset:11520
    v_mfma_f32_16x16x32_bf16 v[124:127], v[60:63], v[76:79], v[124:127]
    v_mfma_f32_16x16x32_bf16 v[128:131], v[60:63], v[80:83], v[128:131]
    ds_read_b64_tr_b16 v[52:53], v23 offset:9248
    s_waitcnt lgkmcnt(13)
    ds_read_b64_tr_b16 v[54:55], v23 offset:11552
    v_mfma_f32_16x16x32_bf16 v[132:135], v[64:67], v[76:79], v[132:135]
    v_mfma_f32_16x16x32_bf16 v[136:139], v[64:67], v[80:83], v[136:139]
    ds_read_b64_tr_b16 v[56:57], v23 offset:9280
    s_waitcnt lgkmcnt(13)
    ds_read_b64_tr_b16 v[58:59], v23 offset:11584
    v_mfma_f32_16x16x32_bf16 v[100:103], v[28:31], v[84:87], v[100:103]
    v_mfma_f32_16x16x32_bf16 v[104:107], v[28:31], v[88:91], v[104:107]
    ds_read_b64_tr_b16 v[60:61], v23 offset:9312
    s_waitcnt lgkmcnt(13)
    ds_read_b64_tr_b16 v[62:63], v23 offset:11616
    v_mfma_f32_16x16x32_bf16 v[108:111], v[32:35], v[84:87], v[108:111]
    v_mfma_f32_16x16x32_bf16 v[112:115], v[32:35], v[88:91], v[112:115]
    ds_read_b64_tr_b16 v[64:65], v23 offset:9344
    s_waitcnt lgkmcnt(13)
    ds_read_b64_tr_b16 v[66:67], v23 offset:11648
    v_mfma_f32_16x16x32_bf16 v[116:119], v[36:39], v[84:87], v[116:119]
    v_mfma_f32_16x16x32_bf16 v[120:123], v[36:39], v[88:91], v[120:123]
    s_waitcnt vmcnt(10) lgkmcnt(0)
    s_barrier
    ds_read_b128 v[68:71], v12 offset:0
    ds_read_b128 v[72:75], v12 offset:2048
    ds_read_b64_tr_b16 v[28:29], v14 offset:0
    ds_read_b64_tr_b16 v[30:31], v14 offset:2304
    s_add_u32 m0, s29, 0x19800
    s_nop 0
    buffer_load_dwordx4 v8, s[12:15], s31 offen lds
    v_mfma_f32_16x16x32_bf16 v[124:127], v[40:43], v[84:87], v[124:127]
    v_mfma_f32_16x16x32_bf16 v[128:131], v[40:43], v[88:91], v[128:131]
    ds_read_b64_tr_b16 v[32:33], v14 offset:32
    ds_read_b64_tr_b16 v[34:35], v14 offset:2336
    ds_read_b128 v[76:79], v13 offset:0
    s_add_u32 m0, s29, 0x1b800
    s_add_u32 s33, s31, 0x40000
    buffer_load_dwordx4 v8, s[12:15], s33 offen lds
    s_add_u32 s31, s31, 128
    v_mfma_f32_16x16x32_bf16 v[132:135], v[44:47], v[84:87], v[132:135]
    v_mfma_f32_16x16x32_bf16 v[136:139], v[44:47], v[88:91], v[136:139]
    ds_read_b64_tr_b16 v[36:37], v14 offset:64
    ds_read_b64_tr_b16 v[38:39], v14 offset:2368
    ds_read_b128 v[80:83], v13 offset:2048
    s_add_u32 m0, s29, 0x1d800
    s_nop 0
    buffer_load_dwordx4 v9, s[16:19], s32 offen lds
    v_mfma_f32_16x16x32_bf16 v[100:103], v[48:51], v[92:95], v[100:103]
    v_mfma_f32_16x16x32_bf16 v[104:107], v[48:51], v[96:99], v[104:107]
    ds_read_b64_tr_b16 v[40:41], v14 offset:96
    ds_read_b64_tr_b16 v[42:43], v14 offset:2400
    s_add_u32 m0, s29, 0x1f800
    s_nop 0
    buffer_load_dwordx4 v10, s[16:19], s32 offen lds
    v_mfma_f32_16x16x32_bf16 v[108:111], v[52:55], v[92:95], v[108:111]
    v_mfma_f32_16x16x32_bf16 v[112:115], v[52:55], v[96:99], v[112:115]
    ds_read_b64_tr_b16 v[44:45], v14 offset:128
    ds_read_b64_tr_b16 v[46:47], v14 offset:2432
    s_add_u32 m0, s30, 0x21800
    s_nop 0
    s_mov_b64 exec, 0xffff
    buffer_load_dwordx4 v11, s[16:19], s32 offen lds
    s_mov_b64 exec, -1
    s_add_u32 s32, s32, 0x4800
    v_mfma_f32_16x16x32_bf16 v[116:119], v[56:59], v[92:95], v[116:119]
    v_mfma_f32_16x16x32_bf16 v[120:123], v[56:59], v[96:99], v[120:123]
    ds_read_b64_tr_b16 v[48:49], v14 offset:9216
    s_waitcnt lgkmcnt(13)
    ds_read_b64_tr_b16 v[50:51], v14 offset:11520
    v_mfma_f32_16x16x32_bf16 v[124:127], v[60:63], v[92:95], v[124:127]
    v_mfma_f32_16x16x32_bf16 v[128:131], v[60:63], v[96:99], v[128:131]
    ds_read_b64_tr_b16 v[52:53], v14 offset:9248
    s_waitcnt lgkmcnt(13)
    ds_read_b64_tr_b16 v[54:55], v14 offset:11552
    v_mfma_f32_16x16x32_bf16 v[132:135], v[64:67], v[92:95], v[132:135]
    v_mfma_f32_16x16x32_bf16 v[136:139], v[64:67], v[96:99], v[136:139]
    ds_read_b64_tr_b16 v[56:57], v14 offset:9280
    s_waitcnt lgkmcnt(13)
    ds_read_b64_tr_b16 v[58:59], v14 offset:11584
    v_mfma_f32_16x16x32_bf16 v[100:103], v[28:31], v[68:71], v[100:103]
    v_mfma_f32_16x16x32_bf16 v[104:107], v[28:31], v[72:75], v[104:107]
    ds_read_b64_tr_b16 v[60:61], v14 offset:9312
    s_waitcnt lgkmcnt(13)
    ds_read_b64_tr_b16 v[62:63], v14 offset:11616
    v_mfma_f32_16x16x32_bf16 v[108:111], v[32:35], v[68:71], v[108:111]
    v_mfma_f32_16x16x32_bf16 v[112:115], v[32:35], v[72:75], v[112:115]
    ds_read_b64_tr_b16 v[64:65], v14 offset:9344
    s_waitcnt lgkmcnt(13)
    ds_read_b64_tr_b16 v[66:67], v14 offset:11648
    v_mfma_f32_16x16x32_bf16 v[116:119], v[36:39], v[68:71], v[116:119]
    v_mfma_f32_16x16x32_bf16 v[120:123], v[36:39], v[72:75], v[120:123]
    s_waitcnt vmcnt(10) lgkmcnt(0)
    s_barrier
    ds_read_b128 v[84:87], v15 offset:0
    ds_read_b128 v[88:91], v15 offset:2048
    ds_read_b64_tr_b16 v[28:29], v17 offset:0
    ds_read_b64_tr_b16 v[30:31], v17 offset:2304
    s_add_u32 m0, s29, 0x0
    s_nop 0
    buffer_load_dwordx4 v8, s[12:15], s31 offen lds
    v_mfma_f32_16x16x32_bf16 v[124:127], v[40:43], v[68:71], v[124:127]
    v_mfma_f32_16x16x32_bf16 v[128:131], v[40:43], v[72:75], v[128:131]
    ds_read_b64_tr_b16 v[32:33], v17 offset:32
    ds_read_b64_tr_b16 v[34:35], v17 offset:2336
    ds_read_b128 v[92:95], v16 offset:0
    s_add_u32 m0, s29, 0x2000
    s_add_u32 s33, s31, 0x40000
    buffer_load_dwordx4 v8, s[12:15], s33 offen lds
    s_add_u32 s31, s31, 128
    v_mfma_f32_16x16x32_bf16 v[132:135], v[44:47], v[68:71], v[132:135]
    v_mfma_f32_16x16x32_bf16 v[136:139], v[44:47], v[72:75], v[136:139]
    ds_read_b64_tr_b16 v[36:37], v17 offset:64
    ds_read_b64_tr_b16 v[38:39], v17 offset:2368
    ds_read_b128 v[96:99], v16 offset:2048
    s_add_u32 m0, s29, 0x4000
    s_nop 0
    buffer_load_dwordx4 v9, s[16:19], s32 offen lds
    v_mfma_f32_16x16x32_bf16 v[100:103], v[48:51], v[76:79], v[100:103]
    v_mfma_f32_16x16x32_bf16 v[104:107], v[48:51], v[80:83], v[104:107]
    ds_read_b64_tr_b16 v[40:41], v17 offset:96
    ds_read_b64_tr_b16 v[42:43], v17 offset:2400
    s_add_u32 m0, s29, 0x6000
    s_nop 0
    buffer_load_dwordx4 v10, s[16:19], s32 offen lds
    v_mfma_f32_16x16x32_bf16 v[108:111], v[52:55], v[76:79], v[108:111]
    v_mfma_f32_16x16x32_bf16 v[112:115], v[52:55], v[80:83], v[112:115]
    ds_read_b64_tr_b16 v[44:45], v17 offset:128
    ds_read_b64_tr_b16 v[46:47], v17 offset:2432
    s_add_u32 m0, s30, 0x8000
    s_nop 0
    s_mov_b64 exec, 0xffff
    buffer_load_dwordx4 v11, s[16:19], s32 offen lds
    s_mov_b64 exec, -1
    s_add_u32 s32, s32, 0x4800
    v_mfma_f32_16x16x32_bf16 v[116:119], v[56:59], v[76:79], v[116:119]
    v_mfma_f32_16x16x32_bf16 v[120:123], v[56:59], v[80:83], v[120:123]
    ds_read_b64_tr_b16 v[48:49], v17 offset:9216
    s_waitcnt lgkmcnt(13)
    ds_read_b64_tr_b16 v[50:51], v17 offset:11520
    v_mfma_f32_16x16x32_bf16 v[124:127], v[60:63], v[76:79], v[124:127]
    v_mfma_f32_16x16x32_bf16 v[128:131], v[60:63], v[80:83], v[128:131]
    ds_read_b64_tr_b16 v[52:53], v17 offset:9248
    s_waitcnt lgkmcnt(13)
    ds_read_b64_tr_b16 v[54:55], v17 offset:11552
    v_mfma_f32_16x16x32_bf16 v[132:135], v[64:67], v[76:79], v[132:135]
    v_mfma_f32_16x16x32_bf16 v[136:139], v[64:67], v[80:83], v[136:139]
    ds_read_b64_tr_b16 v[56:57], v17 offset:9280
    s_waitcnt lgkmcnt(13)
    ds_read_b64_tr_b16 v[58:59], v17 offset:11584
    v_mfma_f32_16x16x32_bf16 v[100:103], v[28:31], v[84:87], v[100:103]
    v_mfma_f32_16x16x32_bf16 v[104:107], v[28:31], v[88:91], v[104:107]
    ds_read_b64_tr_b16 v[60:61], v17 offset:9312
    s_waitcnt lgkmcnt(13)
    ds_read_b64_tr_b16 v[62:63], v17 offset:11616
    v_mfma_f32_16x16x32_bf16 v[108:111], v[32:35], v[84:87], v[108:111]
    v_mfma_f32_16x16x32_bf16 v[112:115], v[32:35], v[88:91], v[112:115]
    ds_read_b64_tr_b16 v[64:65], v17 offset:9344
    s_waitcnt lgkmcnt(13)
    ds_read_b64_tr_b16 v[66:67], v17 offset:11648
    v_mfma_f32_16x16x32_bf16 v[116:119], v[36:39], v[84:87], v[116:119]
    v_mfma_f32_16x16x32_bf16 v[120:123], v[36:39], v[88:91], v[120:123]
    s_waitcnt vmcnt(10) lgkmcnt(0)
    s_barrier
    ds_read_b128 v[68:71], v18 offset:0
    ds_read_b128 v[72:75], v18 offset:2048
    ds_read_b64_tr_b16 v[28:29], v20 offset:0
    ds_read_b64_tr_b16 v[30:31], v20 offset:2304
    s_add_u32 m0, s29, 0x8800
    s_nop 0
    buffer_load_dwordx4 v8, s[12:15], s31 offen lds
    v_mfma_f32_16x16x32_bf16 v[124:127], v[40:43], v[84:87], v[124:127]
    v_mfma_f32_16x16x32_bf16 v[128:131], v[40:43], v[88:91], v[128:131]
    ds_read_b64_tr_b16 v[32:33], v20 offset:32
    ds_read_b64_tr_b16 v[34:35], v20 offset:2336
    ds_read_b128 v[76:79], v19 offset:0
    s_add_u32 m0, s29, 0xa800
    s_add_u32 s33, s31, 0x40000
    buffer_load_dwordx4 v8, s[12:15], s33 offen lds
    s_add_u32 s31, s31, 128
    v_mfma_f32_16x16x32_bf16 v[132:135], v[44:47], v[84:87], v[132:135]
    v_mfma_f32_16x16x32_bf16 v[136:139], v[44:47], v[88:91], v[136:139]
    ds_read_b64_tr_b16 v[36:37], v20 offset:64
    ds_read_b64_tr_b16 v[38:39], v20 offset:2368
    ds_read_b128 v[80:83], v19 offset:2048
    s_add_u32 m0, s29, 0xc800
    s_nop 0
    buffer_load_dwordx4 v9, s[16:19], s32 offen lds
    v_mfma_f32_16x16x32_bf16 v[100:103], v[48:51], v[92:95], v[100:103]
    v_mfma_f32_16x16x32_bf16 v[104:107], v[48:51], v[96:99], v[104:107]
    ds_read_b64_tr_b16 v[40:41], v20 offset:96
    ds_read_b64_tr_b16 v[42:43], v20 offset:2400
    s_add_u32 m0, s29, 0xe800
    s_nop 0
    buffer_load_dwordx4 v10, s[16:19], s32 offen lds
    v_mfma_f32_16x16x32_bf16 v[108:111], v[52:55], v[92:95], v[108:111]
    v_mfma_f32_16x16x32_bf16 v[112:115], v[52:55], v[96:99], v[112:115]
    ds_read_b64_tr_b16 v[44:45], v20 offset:128
    ds_read_b64_tr_b16 v[46:47], v20 offset:2432
    s_add_u32 m0, s30, 0x10800
    s_nop 0
    s_mov_b64 exec, 0xffff
    buffer_load_dwordx4 v11, s[16:19], s32 offen lds
    s_mov_b64 exec, -1
    s_add_u32 s32, s32, 0x4800
    v_mfma_f32_16x16x32_bf16 v[116:119], v[56:59], v[92:95], v[116:119]
    v_mfma_f32_16x16x32_bf16 v[120:123], v[56:59], v[96:99], v[120:123]
    ds_read_b64_tr_b16 v[48:49], v20 offset:9216
    s_waitcnt lgkmcnt(13)
    ds_read_b64_tr_b16 v[50:51], v20 offset:11520
    v_mfma_f32_16x16x32_bf16 v[124:127], v[60:63], v[92:95], v[124:127]
    v_mfma_f32_16x16x32_bf16 v[128:131], v[60:63], v[96:99], v[128:131]
    ds_read_b64_tr_b16 v[52:53], v20 offset:9248
    s_waitcnt lgkmcnt(13)
    ds_read_b64_tr_b16 v[54:55], v20 offset:11552
    v_mfma_f32_16x16x32_bf16 v[132:135], v[64:67], v[92:95], v[132:135]
    v_mfma_f32_16x16x32_bf16 v[136:139], v[64:67], v[96:99], v[136:139]
    ds_read_b64_tr_b16 v[56:57], v20 offset:9280
    s_waitcnt lgkmcnt(13)
    ds_read_b64_tr_b16 v[58:59], v20 offset:11584
    s_sub_u32 s40, s40, 1
    s_cmp_lg_u32 s40, 0
    s_cbranch_scc1 LP_rompt_kernel_12
    v_mfma_f32_16x16x32_bf16 v[100:103], v[28:31], v[68:71], v[100:103]
    v_mfma_f32_16x16x32_bf16 v[104:107], v[28:31], v[72:75], v[104:107]
    ds_read_b64_tr_b16 v[60:61], v20 offset:9312
    s_waitcnt lgkmcnt(13)
    ds_read_b64_tr_b16 v[62:63], v20 offset:11616
    v_mfma_f32_16x16x32_bf16 v[108:111], v[32:35], v[68:71], v[108:111]
    v_mfma_f32_16x16x32_bf16 v[112:115], v[32:35], v[72:75], v[112:115]
    ds_read_b64_tr_b16 v[64:65], v20 offset:9344
    s_waitcnt lgkmcnt(13)
    ds_read_b64_tr_b16 v[66:67], v20 offset:11648
    v_mfma_f32_16x16x32_bf16 v[116:119], v[36:39], v[68:71], v[116:119]
    v_mfma_f32_16x16x32_bf16 v[120:123], v[36:39], v[72:75], v[120:123]
    s_waitcnt vmcnt(10) lgkmcnt(0)
    s_barrier
    ds_read_b128 v[84:87], v21 offset:0
    ds_read_b128 v[88:91], v21 offset:2048
    ds_read_b64_tr_b16 v[28:29], v23 offset:0
    ds_read_b64_tr_b16 v[30:31], v23 offset:2304
    s_add_u32 m0, s29, 0x11000
    s_nop 0
    buffer_load_dwordx4 v8, s[12:15], s31 offen lds
    v_mfma_f32_16x16x32_bf16 v[124:127], v[40:43], v[68:71], v[124:127]
    v_mfma_f32_16x16x32_bf16 v[128:131], v[40:43], v[72:75], v[128:131]
    ds_read_b64_tr_b16 v[32:33], v23 offset:32
    ds_read_b64_tr_b16 v[34:35], v23 offset:2336
    ds_read_b128 v[92:95], v22 offset:0
    s_add_u32 m0, s29, 0x13000
    s_add_u32 s33, s31, 0x40000
    buffer_load_dwordx4 v8, s[12:15], s33 offen lds
    s_add_u32 s31, s31, 128
    v_mfma_f32_16x16x32_bf16 v[132:135], v[44:47], v[68:71], v[132:135]
    v_mfma_f32_16x16x32_bf16 v[136:139], v[44:47], v[72:75], v[136:139]
    ds_read_b64_tr_b16 v[36:37], v23 offset:64
    ds_read_b64_tr_b16 v[38:39], v23 offset:2368
    ds_read_b128 v[96:99], v22 offset:2048
    s_add_u32 m0, s29, 0x15000
    s_nop 0
    buffer_load_dwordx4 v9, s[16:19], s32 offen lds
    v_mfma_f32_16x16x32_bf16 v[100:103], v[48:51], v[76:79], v[100:103]
    v_mfma_f32_16x16x32_bf16 v[104:107], v[48:51], v[80:83], v[104:107]
    ds_read_b64_tr_b16 v[40:41], v23 offset:96
    ds_read_b64_tr_b16 v[42:43], v23 offset:2400
    s_add_u32 m0, s29, 0x17000
    s_nop 0
    buffer_load_dwordx4 v10, s[16:19], s32 offen lds
    v_mfma_f32_16x16x32_bf16 v[108:111], v[52:55], v[76:79], v[108:111]
    v_mfma_f32_16x16x32_bf16 v[112:115], v[52:55], v[80:83], v[112:115]
    ds_read_b64_tr_b16 v[44:45], v23 offset:128
    ds_read_b64_tr_b16 v[46:47], v23 offset:2432
    s_add_u32 m0, s30, 0x19000
    s_nop 0
    s_mov_b64 exec, 0xffff
    buffer_load_dwordx4 v11, s[16:19], s32 offen lds
    s_mov_b64 exec, -1
    s_add_u32 s32, s32, 0x4800
    v_mfma_f32_16x16x32_bf16 v[116:119], v[56:59], v[76:79], v[116:119]
    v_mfma_f32_16x16x32_bf16 v[120:123], v[56:59], v[80:83], v[120:123]
    ds_read_b64_tr_b16 v[48:49], v23 offset:9216
    s_waitcnt lgkmcnt(13)
    ds_read_b64_tr_b16 v[50:51], v23 offset:11520
    v_mfma_f32_16x16x32_bf16 v[124:127], v[60:63], v[76:79], v[124:127]
    v_mfma_f32_16x16x32_bf16 v[128:131], v[60:63], v[80:83], v[128:131]
    ds_read_b64_tr_b16 v[52:53], v23 offset:9248
    s_waitcnt lgkmcnt(13)
    ds_read_b64_tr_b16 v[54:55], v23 offset:11552
    v_mfma_f32_16x16x32_bf16 v[132:135], v[64:67], v[76:79], v[132:135]
    v_mfma_f32_16x16x32_bf16 v[136:139], v[64:67], v[80:83], v[136:139]
    ds_read_b64_tr_b16 v[56:57], v23 offset:9280
    s_waitcnt lgkmcnt(13)
    ds_read_b64_tr_b16 v[58:59], v23 offset:11584
    v_mfma_f32_16x16x32_bf16 v[100:103], v[28:31], v[84:87], v[100:103]
    v_mfma_f32_16x16x32_bf16 v[104:107], v[28:31], v[88:91], v[104:107]
    ds_read_b64_tr_b16 v[60:61], v23 offset:9312
    s_waitcnt lgkmcnt(13)
    ds_read_b64_tr_b16 v[62:63], v23 offset:11616
    v_mfma_f32_16x16x32_bf16 v[108:111], v[32:35], v[84:87], v[108:111]
    v_mfma_f32_16x16x32_bf16 v[112:115], v[32:35], v[88:91], v[112:115]
    ds_read_b64_tr_b16 v[64:65], v23 offset:9344
    s_waitcnt lgkmcnt(13)
    ds_read_b64_tr_b16 v[66:67], v23 offset:11648
    v_mfma_f32_16x16x32_bf16 v[116:119], v[36:39], v[84:87], v[116:119]
    v_mfma_f32_16x16x32_bf16 v[120:123], v[36:39], v[88:91], v[120:123]
    s_waitcnt vmcnt(10) lgkmcnt(0)
    s_barrier
    ds_read_b128 v[68:71], v12 offset:0
    ds_read_b128 v[72:75], v12 offset:2048
    ds_read_b64_tr_b16 v[28:29], v14 offset:0
    ds_read_b64_tr_b16 v[30:31], v14 offset:2304
    s_add_u32 m0, s29, 0x19800
    s_nop 0
    buffer_load_dwordx4 v8, s[12:15], s31 offen lds
    v_mfma_f32_16x16x32_bf16 v[124:127], v[40:43], v[84:87], v[124:127]
    v_mfma_f32_16x16x32_bf16 v[128:131], v[40:43], v[88:91], v[128:131]
    ds_read_b64_tr_b16 v[32:33], v14 offset:32
    ds_read_b64_tr_b16 v[34:35], v14 offset:2336
    ds_read_b128 v[76:79], v13 offset:0
    s_add_u32 m0, s29, 0x1b800
    s_add_u32 s33, s31, 0x40000
    buffer_load_dwordx4 v8, s[12:15], s33 offen lds
    s_add_u32 s31, s31, 128
    v_mfma_f32_16x16x32_bf16 v[132:135], v[44:47], v[84:87], v[132:135]
    v_mfma_f32_16x16x32_bf16 v[136:139], v[44:47], v[88:91], v[136:139]
    ds_read_b64_tr_b16 v[36:37], v14 offset:64
    ds_read_b64_tr_b16 v[38:39], v14 offset:2368
    ds_read_b128 v[80:83], v13 offset:2048
    s_add_u32 m0, s29, 0x1d800
    s_nop 0
    buffer_load_dwordx4 v9, s[16:19], s32 offen lds
    v_mfma_f32_16x16x32_bf16 v[100:103], v[48:51], v[92:95], v[100:103]
    v_mfma_f32_16x16x32_bf16 v[104:107], v[48:51], v[96:99], v[104:107]
    ds_read_b64_tr_b16 v[40:41], v14 offset:96
    ds_read_b64_tr_b16 v[42:43], v14 offset:2400
    s_add_u32 m0, s29, 0x1f800
    s_nop 0
    buffer_load_dwordx4 v10, s[16:19], s32 offen lds
    v_mfma_f32_16x16x32_bf16 v[108:111], v[52:55], v[92:95], v[108:111]
    v_mfma_f32_16x16x32_bf16 v[112:115], v[52:55], v[96:99], v[112:115]
    ds_read_b64_tr_b16 v[44:45], v14 offset:128
    ds_read_b64_tr_b16 v[46:47], v14 offset:2432
    s_add_u32 m0, s30, 0x21800
    s_nop 0
    s_mov_b64 exec, 0xffff
    buffer_load_dwordx4 v11, s[16:19], s32 offen lds
    s_mov_b64 exec, -1
    s_add_u32 s32, s32, 0x4800
    v_mfma_f32_16x16x32_bf16 v[116:119], v[56:59], v[92:95], v[116:119]
    v_mfma_f32_16x16x32_bf16 v[120:123], v[56:59], v[96:99], v[120:123]
    ds_read_b64_tr_b16 v[48:49], v14 offset:9216
    s_waitcnt lgkmcnt(13)
    ds_read_b64_tr_b16 v[50:51], v14 offset:11520
    v_mfma_f32_16x16x32_bf16 v[124:127], v[60:63], v[92:95], v[124:127]
    v_mfma_f32_16x16x32_bf16 v[128:131], v[60:63], v[96:99], v[128:131]
    ds_read_b64_tr_b16 v[52:53], v14 offset:9248
    s_waitcnt lgkmcnt(13)
    ds_read_b64_tr_b16 v[54:55], v14 offset:11552
    v_mfma_f32_16x16x32_bf16 v[132:135], v[64:67], v[92:95], v[132:135]
    v_mfma_f32_16x16x32_bf16 v[136:139], v[64:67], v[96:99], v[136:139]
    ds_read_b64_tr_b16 v[56:57], v14 offset:9280
    s_waitcnt lgkmcnt(13)
    ds_read_b64_tr_b16 v[58:59], v14 offset:11584
    v_mfma_f32_16x16x32_bf16 v[100:103], v[28:31], v[68:71], v[100:103]
    v_mfma_f32_16x16x32_bf16 v[104:107], v[28:31], v[72:75], v[104:107]
    ds_read_b64_tr_b16 v[60:61], v14 offset:9312
    s_waitcnt lgkmcnt(13)
    ds_read_b64_tr_b16 v[62:63], v14 offset:11616
    v_mfma_f32_16x16x32_bf16 v[108:111], v[32:35], v[68:71], v[108:111]
    v_mfma_f32_16x16x32_bf16 v[112:115], v[32:35], v[72:75], v[112:115]
    ds_read_b64_tr_b16 v[64:65], v14 offset:9344
    s_waitcnt lgkmcnt(13)
    ds_read_b64_tr_b16 v[66:67], v14 offset:11648
    v_mfma_f32_16x16x32_bf16 v[116:119], v[36:39], v[68:71], v[116:119]
    v_mfma_f32_16x16x32_bf16 v[120:123], v[36:39], v[72:75], v[120:123]
    s_waitcnt vmcnt(10) lgkmcnt(0)
    s_barrier
    ds_read_b128 v[84:87], v15 offset:0
    ds_read_b128 v[88:91], v15 offset:2048
    ds_read_b64_tr_b16 v[28:29], v17 offset:0
    ds_read_b64_tr_b16 v[30:31], v17 offset:2304
    v_mfma_f32_16x16x32_bf16 v[124:127], v[40:43], v[68:71], v[124:127]
    v_mfma_f32_16x16x32_bf16 v[128:131], v[40:43], v[72:75], v[128:131]
    ds_read_b64_tr_b16 v[32:33], v17 offset:32
    ds_read_b64_tr_b16 v[34:35], v17 offset:2336
    ds_read_b128 v[92:95], v16 offset:0
    v_mfma_f32_16x16x32_bf16 v[132:135], v[44:47], v[68:71], v[132:135]
    v_mfma_f32_16x16x32_bf16 v[136:139], v[44:47], v[72:75], v[136:139]
    ds_read_b64_tr_b16 v[36:37], v17 offset:64
    ds_read_b64_tr_b16 v[38:39], v17 offset:2368
    ds_read_b128 v[96:99], v16 offset:2048
    v_mfma_f32_16x16x32_bf16 v[100:103], v[48:51], v[76:79], v[100:103]
    v_mfma_f32_16x16x32_bf16 v[104:107], v[48:51], v[80:83], v[104:107]
    ds_read_b64_tr_b16 v[40:41], v17 offset:96
    ds_read_b64_tr_b16 v[42:43], v17 offset:2400
    v_mfma_f32_16x16x32_bf16 v[108:111], v[52:55], v[76:79], v[108:111]
    v_mfma_f32_16x16x32_bf16 v[112:115], v[52:55], v[80:83], v[112:115]
    ds_read_b64_tr_b16 v[44:45], v17 offset:128
    ds_read_b64_tr_b16 v[46:47], v17 offset:2432
    v_mfma_f32_16x16x32_bf16 v[116:119], v[56:59], v[76:79], v[116:119]
    v_mfma_f32_16x16x32_bf16 v[120:123], v[56:59], v[80:83], v[120:123]
    ds_read_b64_tr_b16 v[48:49], v17 offset:9216
    s_waitcnt lgkmcnt(13)
    ds_read_b64_tr_b16 v[50:51], v17 offset:11520
    v_mfma_f32_16x16x32_bf16 v[124:127], v[60:63], v[76:79], v[124:127]
    v_mfma_f32_16x16x32_bf16 v[128:131], v[60:63], v[80:83], v[128:131]
    ds_read_b64_tr_b16 v[52:53], v17 offset:9248
    s_waitcnt lgkmcnt(13)
    ds_read_b64_tr_b16 v[54:55], v17 offset:11552
    v_mfma_f32_16x16x32_bf16 v[132:135], v[64:67], v[76:79], v[132:135]
    v_mfma_f32_16x16x32_bf16 v[136:139], v[64:67], v[80:83], v[136:139]
    ds_read_b64_tr_b16 v[56:57], v17 offset:9280
    s_waitcnt lgkmcnt(13)
    ds_read_b64_tr_b16 v[58:59], v17 offset:11584
    v_mfma_f32_16x16x32_bf16 v[100:103], v[28:31], v[84:87], v[100:103]
    v_mfma_f32_16x16x32_bf16 v[104:107], v[28:31], v[88:91], v[104:107]
    ds_read_b64_tr_b16 v[60:61], v17 offset:9312
    s_waitcnt lgkmcnt(13)
    ds_read_b64_tr_b16 v[62:63], v17 offset:11616
    v_mfma_f32_16x16x32_bf16 v[108:111], v[32:35], v[84:87], v[108:111]
    v_mfma_f32_16x16x32_bf16 v[112:115], v[32:35], v[88:91], v[112:115]
    ds_read_b64_tr_b16 v[64:65], v17 offset:9344
    s_waitcnt lgkmcnt(13)
    ds_read_b64_tr_b16 v[66:67], v17 offset:11648
    v_mfma_f32_16x16x32_bf16 v[116:119], v[36:39], v[84:87], v[116:119]
    v_mfma_f32_16x16x32_bf16 v[120:123], v[36:39], v[88:91], v[120:123]
    s_waitcnt vmcnt(5) lgkmcnt(0)
    s_barrier
    ds_read_b128 v[68:71], v18 offset:0
    ds_read_b128 v[72:75], v18 offset:2048
    ds_read_b64_tr_b16 v[28:29], v20 offset:0
    ds_read_b64_tr_b16 v[30:31], v20 offset:2304
    v_mfma_f32_16x16x32_bf16 v[124:127], v[40:43], v[84:87], v[124:127]
    v_mfma_f32_16x16x32_bf16 v[128:131], v[40:43], v[88:91], v[128:131]
    ds_read_b64_tr_b16 v[32:33], v20 offset:32
    ds_read_b64_tr_b16 v[34:35], v20 offset:2336
    ds_read_b128 v[76:79], v19 offset:0
    v_mfma_f32_16x16x32_bf16 v[132:135], v[44:47], v[84:87], v[132:135]
    v_mfma_f32_16x16x32_bf16 v[136:139], v[44:47], v[88:91], v[136:139]
    ds_read_b64_tr_b16 v[36:37], v20 offset:64
    ds_read_b64_tr_b16 v[38:39], v20 offset:2368
    ds_read_b128 v[80:83], v19 offset:2048
    v_mfma_f32_16x16x32_bf16 v[100:103], v[48:51], v[92:95], v[100:103]
    v_mfma_f32_16x16x32_bf16 v[104:107], v[48:51], v[96:99], v[104:107]
    ds_read_b64_tr_b16 v[40:41], v20 offset:96
    ds_read_b64_tr_b16 v[42:43], v20 offset:2400
    v_mfma_f32_16x16x32_bf16 v[108:111], v[52:55], v[92:95], v[108:111]
    v_mfma_f32_16x16x32_bf16 v[112:115], v[52:55], v[96:99], v[112:115]
    ds_read_b64_tr_b16 v[44:45], v20 offset:128
    ds_read_b64_tr_b16 v[46:47], v20 offset:2432
    v_mfma_f32_16x16x32_bf16 v[116:119], v[56:59], v[92:95], v[116:119]
    v_mfma_f32_16x16x32_bf16 v[120:123], v[56:59], v[96:99], v[120:123]
    ds_read_b64_tr_b16 v[48:49], v20 offset:9216
    s_waitcnt lgkmcnt(13)
    ds_read_b64_tr_b16 v[50:51], v20 offset:11520
    v_mfma_f32_16x16x32_bf16 v[124:127], v[60:63], v[92:95], v[124:127]
    v_mfma_f32_16x16x32_bf16 v[128:131], v[60:63], v[96:99], v[128:131]
    ds_read_b64_tr_b16 v[52:53], v20 offset:9248
    s_waitcnt lgkmcnt(13)
    ds_read_b64_tr_b16 v[54:55], v20 offset:11552
    v_mfma_f32_16x16x32_bf16 v[132:135], v[64:67], v[92:95], v[132:135]
    v_mfma_f32_16x16x32_bf16 v[136:139], v[64:67], v[96:99], v[136:139]
    ds_read_b64_tr_b16 v[56:57], v20 offset:9280
    s_waitcnt lgkmcnt(13)
    ds_read_b64_tr_b16 v[58:59], v20 offset:11584
    v_mfma_f32_16x16x32_bf16 v[100:103], v[28:31], v[68:71], v[100:103]
    v_mfma_f32_16x16x32_bf16 v[104:107], v[28:31], v[72:75], v[104:107]
    ds_read_b64_tr_b16 v[60:61], v20 offset:9312
    s_waitcnt lgkmcnt(13)
    ds_read_b64_tr_b16 v[62:63], v20 offset:11616
    v_mfma_f32_16x16x32_bf16 v[108:111], v[32:35], v[68:71], v[108:111]
    v_mfma_f32_16x16x32_bf16 v[112:115], v[32:35], v[72:75], v[112:115]
    ds_read_b64_tr_b16 v[64:65], v20 offset:9344
    s_waitcnt lgkmcnt(13)
    ds_read_b64_tr_b16 v[66:67], v20 offset:11648
    v_mfma_f32_16x16x32_bf16 v[116:119], v[36:39], v[68:71], v[116:119]
    v_mfma_f32_16x16x32_bf16 v[120:123], v[36:39], v[72:75], v[120:123]
    s_waitcnt vmcnt(0) lgkmcnt(0)
    s_barrier
    ds_read_b128 v[84:87], v21 offset:0
    ds_read_b128 v[88:91], v21 offset:2048
    ds_read_b64_tr_b16 v[28:29], v23 offset:0
    ds_read_b64_tr_b16 v[30:31], v23 offset:2304
    v_mfma_f32_16x16x32_bf16 v[124:127], v[40:43], v[68:71], v[124:127]
    v_mfma_f32_16x16x32_bf16 v[128:131], v[40:43], v[72:75], v[128:131]
    ds_read_b64_tr_b16 v[32:33], v23 offset:32
    ds_read_b64_tr_b16 v[34:35], v23 offset:2336
    ds_read_b128 v[92:95], v22 offset:0
    v_mfma_f32_16x16x32_bf16 v[132:135], v[44:47], v[68:71], v[132:135]
    v_mfma_f32_16x16x32_bf16 v[136:139], v[44:47], v[72:75], v[136:139]
    ds_read_b64_tr_b16 v[36:37], v23 offset:64
    ds_read_b64_tr_b16 v[38:39], v23 offset:2368
    ds_read_b128 v[96:99], v22 offset:2048
    v_mfma_f32_16x16x32_bf16 v[100:103], v[48:51], v[76:79], v[100:103]
    v_mfma_f32_16x16x32_bf16 v[104:107], v[48:51], v[80:83], v[104:107]
    ds_read_b64_tr_b16 v[40:41], v23 offset:96
    ds_read_b64_tr_b16 v[42:43], v23 offset:2400
    v_mfma_f32_16x16x32_bf16 v[108:111], v[52:55], v[76:79], v[108:111]
    v_mfma_f32_16x16x32_bf16 v[112:115], v[52:55], v[80:83], v[112:115]
    ds_read_b64_tr_b16 v[44:45], v23 offset:128
    ds_read_b64_tr_b16 v[46:47], v23 offset:2432
    v_mfma_f32_16x16x32_bf16 v[116:119], v[56:59], v[76:79], v[116:119]
    v_mfma_f32_16x16x32_bf16 v[120:123], v[56:59], v[80:83], v[120:123]
    ds_read_b64_tr_b16 v[48:49], v23 offset:9216
    s_waitcnt lgkmcnt(13)
    ds_read_b64_tr_b16 v[50:51], v23 offset:11520
    v_mfma_f32_16x16x32_bf16 v[124:127], v[60:63], v[76:79], v[124:127]
    v_mfma_f32_16x16x32_bf16 v[128:131], v[60:63], v[80:83], v[128:131]
    ds_read_b64_tr_b16 v[52:53], v23 offset:9248
    s_waitcnt lgkmcnt(13)
    ds_read_b64_tr_b16 v[54:55], v23 offset:11552
    v_mfma_f32_16x16x32_bf16 v[132:135], v[64:67], v[76:79], v[132:135]
    v_mfma_f32_16x16x32_bf16 v[136:139], v[64:67], v[80:83], v[136:139]
    ds_read_b64_tr_b16 v[56:57], v23 offset:9280
    s_waitcnt lgkmcnt(13)
    ds_read_b64_tr_b16 v[58:59], v23 offset:11584
    v_mfma_f32_16x16x32_bf16 v[100:103], v[28:31], v[84:87], v[100:103]
    v_mfma_f32_16x16x32_bf16 v[104:107], v[28:31], v[88:91], v[104:107]
    ds_read_b64_tr_b16 v[60:61], v23 offset:9312
    s_waitcnt lgkmcnt(13)
    ds_read_b64_tr_b16 v[62:63], v23 offset:11616
    v_mfma_f32_16x16x32_bf16 v[108:111], v[32:35], v[84:87], v[108:111]
    v_mfma_f32_16x16x32_bf16 v[112:115], v[32:35], v[88:91], v[112:115]
    ds_read_b64_tr_b16 v[64:65], v23 offset:9344
    s_waitcnt lgkmcnt(13)
    ds_read_b64_tr_b16 v[66:67], v23 offset:11648
    v_mfma_f32_16x16x32_bf16 v[116:119], v[36:39], v[84:87], v[116:119]
    v_mfma_f32_16x16x32_bf16 v[120:123], v[36:39], v[88:91], v[120:123]
    s_waitcnt lgkmcnt(12)
    v_mfma_f32_16x16x32_bf16 v[124:127], v[40:43], v[84:87], v[124:127]
    v_mfma_f32_16x16x32_bf16 v[128:131], v[40:43], v[88:91], v[128:131]
    s_waitcnt lgkmcnt(10)
    v_mfma_f32_16x16x32_bf16 v[132:135], v[44:47], v[84:87], v[132:135]
    v_mfma_f32_16x16x32_bf16 v[136:139], v[44:47], v[88:91], v[136:139]
    s_waitcnt lgkmcnt(8)
    v_mfma_f32_16x16x32_bf16 v[100:103], v[48:51], v[92:95], v[100:103]
    v_mfma_f32_16x16x32_bf16 v[104:107], v[48:51], v[96:99], v[104:107]
    s_waitcnt lgkmcnt(6)
    v_mfma_f32_16x16x32_bf16 v[108:111], v[52:55], v[92:95], v[108:111]
    v_mfma_f32_16x16x32_bf16 v[112:115], v[52:55], v[96:99], v[112:115]
    s_waitcnt lgkmcnt(4)
    v_mfma_f32_16x16x32_bf16 v[116:119], v[56:59], v[92:95], v[116:119]
    v_mfma_f32_16x16x32_bf16 v[120:123], v[56:59], v[96:99], v[120:123]
    s_waitcnt lgkmcnt(2)
    v_mfma_f32_16x16x32_bf16 v[124:127], v[60:63], v[92:95], v[124:127]
    v_mfma_f32_16x16x32_bf16 v[128:131], v[60:63], v[96:99], v[128:131]
    s_waitcnt lgkmcnt(0)
    v_mfma_f32_16x16x32_bf16 v[132:135], v[64:67], v[92:95], v[132:135]
    v_mfma_f32_16x16x32_bf16 v[136:139], v[64:67], v[96:99], v[136:139]
    s_nop 7
    s_nop 3
    v_and_b32 v100, 0xfffe0000, v100
    v_or_b32 v100, 0x10000, v100
    v_cvt_pk_bf16_f32 v28, v100, v101
    v_cvt_pk_bf16_f32 v29, v102, v103
    v_or_b32 v28, 1, v28
    v_and_b32 v104, 0xfffe0000, v104
    v_or_b32 v104, 0x10000, v104
    v_cvt_pk_bf16_f32 v30, v104, v105
    v_cvt_pk_bf16_f32 v31, v106, v107
    v_or_b32 v30, 1, v30
    s_mov_b32 s33, 0
    s_nop 0
    v_permlane16_swap_b32 v28, v30
    v_permlane16_swap_b32 v29, v31
    s_nop 0
    buffer_store_dwordx4 v[28:31], v7, s[24:27], s33 offen offset:0 sc0 sc1
    v_and_b32 v108, 0xfffe0000, v108
    v_or_b32 v108, 0x10000, v108
    v_cvt_pk_bf16_f32 v32, v108, v109
    v_cvt_pk_bf16_f32 v33, v110, v111
    v_or_b32 v32, 1, v32
    v_and_b32 v112, 0xfffe0000, v112
    v_or_b32 v112, 0x10000, v112
    v_cvt_pk_bf16_f32 v34, v112, v113
    v_cvt_pk_bf16_f32 v35, v114, v115
    v_or_b32 v34, 1, v34
    s_nop 0
    s_nop 0
    v_permlane16_swap_b32 v32, v34
    v_permlane16_swap_b32 v33, v35
    s_nop 0
    buffer_store_dwordx4 v[32:35], v7, s[24:27], s33 offen offset:1024 sc0 sc1
    v_and_b32 v116, 0xfffe0000, v116
    v_or_b32 v116, 0x10000, v116
    v_cvt_pk_bf16_f32 v36, v116, v117
    v_cvt_pk_bf16_f32 v37, v118, v119
    v_or_b32 v36, 1, v36
    v_and_b32 v120, 0xfffe0000, v120
    v_or_b32 v120, 0x10000, v120
    v_cvt_pk_bf16_f32 v38, v120, v121
    v_cvt_pk_bf16_f32 v39, v122, v123
    v_or_b32 v38, 1, v38
    s_nop 0
    s_nop 0
    v_permlane16_swap_b32 v36, v38
    v_permlane16_swap_b32 v37, v39
    s_nop 0
    buffer_store_dwordx4 v[36:39], v7, s[24:27], s33 offen offset:2048 sc0 sc1
    v_and_b32 v124, 0xfffe0000, v124
    v_or_b32 v124, 0x10000, v124
    v_cvt_pk_bf16_f32 v40, v124, v125
    v_cvt_pk_bf16_f32 v41, v126, v127
    v_or_b32 v40, 1, v40
    v_and_b32 v128, 0xfffe0000, v128
    v_or_b32 v128, 0x10000, v128
    v_cvt_pk_bf16_f32 v42, v128, v129
    v_cvt_pk_bf16_f32 v43, v130, v131
    v_or_b32 v42, 1, v42
    s_nop 0
    s_nop 0
    v_permlane16_swap_b32 v40, v42
    v_permlane16_swap_b32 v41, v43
    s_nop 0
    buffer_store_dwordx4 v[40:43], v7, s[24:27], s33 offen offset:3072 sc0 sc1
    v_and_b32 v132, 0xfffe0000, v132
    v_or_b32 v132, 0x10000, v132
    v_cvt_pk_bf16_f32 v28, v132, v133
    v_cvt_pk_bf16_f32 v29, v134, v135
    v_or_b32 v28, 1, v28
    v_and_b32 v136, 0xfffe0000, v136
    v_or_b32 v136, 0x10000, v136
    v_cvt_pk_bf16_f32 v30, v136, v137
    v_cvt_pk_bf16_f32 v31, v138, v139
    v_or_b32 v30, 1, v30
    s_mov_b32 s33, 4096
    s_nop 0
    v_permlane16_swap_b32 v28, v30
    v_permlane16_swap_b32 v29, v31
    s_nop 0
    buffer_store_dwordx4 v[28:31], v7, s[24:27], s33 offen offset:0 sc0 sc1
    s_branch LJ_rompt_kernel_10
LG_rompt_kernel_11:
    ds_read_b128 v[68:71], v12 offset:0
    ds_read_b128 v[72:75], v12 offset:2048
    ds_read_b64_tr_b16 v[28:29], v14 offset:160
    ds_read_b64_tr_b16 v[30:31], v14 offset:2464
    ds_read_b64_tr_b16 v[32:33], v14 offset:192
    ds_read_b64_tr_b16 v[34:35], v14 offset:2496
    ds_read_b64_tr_b16 v[36:37], v14 offset:224
    ds_read_b64_tr_b16 v[38:39], v14 offset:2528
    ds_read_b64_tr_b16 v[40:41], v14 offset:256
    ds_read_b64_tr_b16 v[42:43], v14 offset:2560
    ds_read_b128 v[76:79], v13 offset:0
    ds_read_b128 v[80:83], v13 offset:2048
    ds_read_b64_tr_b16 v[44:45], v14 offset:9376
    ds_read_b64_tr_b16 v[46:47], v14 offset:11680
    ds_read_b64_tr_b16 v[48:49], v14 offset:9408
    s_waitcnt lgkmcnt(13)
    ds_read_b64_tr_b16 v[50:51], v14 offset:11712
    s_waitcnt lgkmcnt(12)
    v_mfma_f32_16x16x32_bf16 v[100:103], v[28:31], v[68:71], 0
    v_mfma_f32_16x16x32_bf16 v[104:107], v[28:31], v[72:75], 0
    ds_read_b64_tr_b16 v[52:53], v14 offset:9440
    ds_read_b64_tr_b16 v[54:55], v14 offset:11744
    s_waitcnt lgkmcnt(12)
    v_mfma_f32_16x16x32_bf16 v[108:111], v[32:35], v[68:71], 0
    v_mfma_f32_16x16x32_bf16 v[112:115], v[32:35], v[72:75], 0
    ds_read_b64_tr_b16 v[56:57], v14 offset:9472
    ds_read_b64_tr_b16 v[58:59], v14 offset:11776
    s_waitcnt lgkmcnt(12)
    v_mfma_f32_16x16x32_bf16 v[116:119], v[36:39], v[68:71], 0
    v_mfma_f32_16x16x32_bf16 v[120:123], v[36:39], v[72:75], 0
    s_waitcnt vmcnt(6) lgkmcnt(0)
    s_barrier
    ds_read_b128 v[84:87], v15 offset:0
    ds_read_b128 v[88:91], v15 offset:2048
    ds_read_b64_tr_b16 v[28:29], v17 offset:160
    ds_read_b64_tr_b16 v[30:31], v17 offset:2464
    s_add_u32 m0, s29, 0x0
    s_nop 0
    buffer_load_dwordx4 v8, s[12:15], s31 offen lds
    v_mfma_f32_16x16x32_bf16 v[124:127], v[40:43], v[68:71], 0
    v_mfma_f32_16x16x32_bf16 v[128:131], v[40:43], v[72:75], 0
    ds_read_b64_tr_b16 v[32:33], v17 offset:192
    ds_read_b64_tr_b16 v[34:35], v17 offset:2496
    ds_read_b128 v[92:95], v16 offset:0
    s_add_u32 m0, s29, 0x2000
    s_add_u32 s33, s31, 0x40000
    buffer_load_dwordx4 v8, s[12:15], s33 offen lds
    s_add_u32 s31, s31, 128
    v_mfma_f32_16x16x32_bf16 v[100:103], v[44:47], v[76:79], v[100:103]
    v_mfma_f32_16x16x32_bf16 v[104:107], v[44:47], v[80:83], v[104:107]
    ds_read_b64_tr_b16 v[36:37], v17 offset:224
    ds_read_b64_tr_b16 v[38:39], v17 offset:2528
    ds_read_b128 v[96:99], v16 offset:2048
    s_add_u32 m0, s29, 0x4000
    s_nop 0
    buffer_load_dwordx4 v9, s[16:19], s32 offen lds
    v_mfma_f32_16x16x32_bf16 v[108:111], v[48:51], v[76:79], v[108:111]
    v_mfma_f32_16x16x32_bf16 v[112:115], v[48:51], v[80:83], v[112:115]
    ds_read_b64_tr_b16 v[40:41], v17 offset:256
    ds_read_b64_tr_b16 v[42:43], v17 offset:2560
    s_add_u32 m0, s29, 0x6000
    s_nop 0
    buffer_load_dwordx4 v10, s[16:19], s32 offen lds
    v_mfma_f32_16x16x32_bf16 v[116:119], v[52:55], v[76:79], v[116:119]
    v_mfma_f32_16x16x32_bf16 v[120:123], v[52:55], v[80:83], v[120:123]
    ds_read_b64_tr_b16 v[44:45], v17 offset:9376
    ds_read_b64_tr_b16 v[46:47], v17 offset:11680
    s_add_u32 m0, s30, 0x8000
    s_nop 0
    s_mov_b64 exec, 0xffff
    buffer_load_dwordx4 v11, s[16:19], s32 offen lds
    s_mov_b64 exec, -1
    s_add_u32 s32, s32, 0x4800
    v_mfma_f32_16x16x32_bf16 v[124:127], v[56:59], v[76:79], v[124:127]
    v_mfma_f32_16x16x32_bf16 v[128:131], v[56:59], v[80:83], v[128:131]
    ds_read_b64_tr_b16 v[48:49], v17 offset:9408
    s_waitcnt lgkmcnt(13)
    ds_read_b64_tr_b16 v[50:51], v17 offset:11712
    s_waitcnt lgkmcnt(12)
    v_mfma_f32_16x16x32_bf16 v[100:103], v[28:31], v[84:87], v[100:103]
    v_mfma_f32_16x16x32_bf16 v[104:107], v[28:31], v[88:91], v[104:107]
    ds_read_b64_tr_b16 v[52:53], v17 offset:9440
    ds_read_b64_tr_b16 v[54:55], v17 offset:11744
    s_waitcnt lgkmcnt(12)
    v_mfma_f32_16x16x32_bf16 v[108:111], v[32:35], v[84:87], v[108:111]
    v_mfma_f32_16x16x32_bf16 v[112:115], v[32:35], v[88:91], v[112:115]
    ds_read_b64_tr_b16 v[56:57], v17 offset:9472
    ds_read_b64_tr_b16 v[58:59], v17 offset:11776
    s_waitcnt lgkmcnt(11)
    v_mfma_f32_16x16x32_bf16 v[116:119], v[36:39], v[84:87], v[116:119]
    v_mfma_f32_16x16x32_bf16 v[120:123], v[36:39], v[88:91], v[120:123]
    s_waitcnt vmcnt(8) lgkmcnt(0)
    s_barrier
    ds_read_b128 v[68:71], v18 offset:0
    ds_read_b128 v[72:75], v18 offset:2048
    ds_read_b64_tr_b16 v[28:29], v20 offset:160
    ds_read_b64_tr_b16 v[30:31], v20 offset:2464
    s_add_u32 m0, s29, 0x8800
    s_nop 0
    buffer_load_dwordx4 v8, s[12:15], s31 offen lds
    v_mfma_f32_16x16x32_bf16 v[124:127], v[40:43], v[84:87], v[124:127]
    v_mfma_f32_16x16x32_bf16 v[128:131], v[40:43], v[88:91], v[128:131]
    ds_read_b64_tr_b16 v[32:33], v20 offset:192
    ds_read_b64_tr_b16 v[34:35], v20 offset:2496
    ds_read_b128 v[76:79], v19 offset:0
    s_add_u32 m0, s29, 0xa800
    s_add_u32 s33, s31, 0x40000
    buffer_load_dwordx4 v8, s[12:15], s33 offen lds
    s_add_u32 s31, s31, 128
    v_mfma_f32_16x16x32_bf16 v[100:103], v[44:47], v[92:95], v[100:103]
    v_mfma_f32_16x16x32_bf16 v[104:107], v[44:47], v[96:99], v[104:107]
    ds_read_b64_tr_b16 v[36:37], v20 offset:224
    ds_read_b64_tr_b16 v[38:39], v20 offset:2528
    ds_read_b128 v[80:83], v19 offset:2048
    s_add_u32 m0, s29, 0xc800
    s_nop 0
    buffer_load_dwordx4 v9, s[16:19], s32 offen lds
    v_mfma_f32_16x16x32_bf16 v[108:111], v[48:51], v[92:95], v[108:111]
    v_mfma_f32_16x16x32_bf16 v[112:115], v[48:51], v[96:99], v[112:115]
    ds_read_b64_tr_b16 v[40:41], v20 offset:256
    ds_read_b64_tr_b16 v[42:43], v20 offset:2560
    s_add_u32 m0, s29, 0xe800
    s_nop 0
    buffer_load_dwordx4 v10, s[16:19], s32 offen lds
    v_mfma_f32_16x16x32_bf16 v[116:119], v[52:55], v[92:95], v[116:119]
    v_mfma_f32_16x16x32_bf16 v[120:123], v[52:55], v[96:99], v[120:123]
    ds_read_b64_tr_b16 v[44:45], v20 offset:9376
    ds_read_b64_tr_b16 v[46:47], v20 offset:11680
    s_add_u32 m0, s30, 0x10800
    s_nop 0
    s_mov_b64 exec, 0xffff
    buffer_load_dwordx4 v11, s[16:19], s32 offen lds
    s_mov_b64 exec, -1
    s_add_u32 s32, s32, 0x4800
    v_mfma_f32_16x16x32_bf16 v[124:127], v[56:59], v[92:95], v[124:127]
    v_mfma_f32_16x16x32_bf16 v[128:131], v[56:59], v[96:99], v[128:131]
    ds_read_b64_tr_b16 v[48:49], v20 offset:9408
    s_waitcnt lgkmcnt(13)
    ds_read_b64_tr_b16 v[50:51], v20 offset:11712
    s_mov_b32 s40, 2
LP_rompt_kernel_13:
    s_waitcnt lgkmcnt(12)
    v_mfma_f32_16x16x32_bf16 v[100:103], v[28:31], v[68:71], v[100:103]
    v_mfma_f32_16x16x32_bf16 v[104:107], v[28:31], v[72:75], v[104:107]
    ds_read_b64_tr_b16 v[52:53], v20 offset:9440
    ds_read_b64_tr_b16 v[54:55], v20 offset:11744
    s_waitcnt lgkmcnt(12)
    v_mfma_f32_16x16x32_bf16 v[108:111], v[32:35], v[68:71], v[108:111]
    v_mfma_f32_16x16x32_bf16 v[112:115], v[32:35], v[72:75], v[112:115]
    ds_read_b64_tr_b16 v[56:57], v20 offset:9472
    ds_read_b64_tr_b16 v[58:59], v20 offset:11776
    s_waitcnt lgkmcnt(11)
    v_mfma_f32_16x16x32_bf16 v[116:119], v[36:39], v[68:71], v[116:119]
    v_mfma_f32_16x16x32_bf16 v[120:123], v[36:39], v[72:75], v[120:123]
    s_waitcnt vmcnt(10) lgkmcnt(0)
    s_barrier
    ds_read_b128 v[84:87], v21 offset:0
    ds_read_b128 v[88:91], v21 offset:2048
    ds_read_b64_tr_b16 v[28:29], v23 offset:160
    ds_read_b64_tr_b16 v[30:31], v23 offset:2464
    s_add_u32 m0, s29, 0x11000
    s_nop 0
    buffer_load_dwordx4 v8, s[12:15], s31 offen lds
    v_mfma_f32_16x16x32_bf16 v[124:127], v[40:43], v[68:71], v[124:127]
    v_mfma_f32_16x16x32_bf16 v[128:131], v[40:43], v[72:75], v[128:131]
    ds_read_b64_tr_b16 v[32:33], v23 offset:192
    ds_read_b64_tr_b16 v[34:35], v23 offset:2496
    ds_read_b128 v[92:95], v22 offset:0
    s_add_u32 m0, s29, 0x13000
    s_add_u32 s33, s31, 0x40000
    buffer_load_dwordx4 v8, s[12:15], s33 offen lds
    s_add_u32 s31, s31, 128
    v_mfma_f32_16x16x32_bf16 v[100:103], v[44:47], v[76:79], v[100:103]
    v_mfma_f32_16x16x32_bf16 v[104:107], v[44:47], v[80:83], v[104:107]
    ds_read_b64_tr_b16 v[36:37], v23 offset:224
    ds_read_b64_tr_b16 v[38:39], v23 offset:2528
    ds_read_b128 v[96:99], v22 offset:2048
    s_add_u32 m0, s29, 0x15000
    s_nop 0
    buffer_load_dwordx4 v9, s[16:19], s32 offen lds
    v_mfma_f32_16x16x32_bf16 v[108:111], v[48:51], v[76:79], v[108:111]
    v_mfma_f32_16x16x32_bf16 v[112:115], v[48:51], v[80:83], v[112:115]
    ds_read_b64_tr_b16 v[40:41], v23 offset:256
    ds_read_b64_tr_b16 v[42:43], v23 offset:2560
    s_add_u32 m0, s29, 0x17000
    s_nop 0
    buffer_load_dwordx4 v10, s[16:19], s32 offen lds
    v_mfma_f32_16x16x32_bf16 v[116:119], v[52:55], v[76:79], v[116:119]
    v_mfma_f32_16x16x32_bf16 v[120:123], v[52:55], v[80:83], v[120:123]
    ds_read_b64_tr_b16 v[44:45], v23 offset:9376
    ds_read_b64_tr_b16 v[46:47], v23 offset:11680
    s_add_u32 m0, s30, 0x19000
    s_nop 0
    s_mov_b64 exec, 0xffff
    buffer_load_dwordx4 v11, s[16:19], s32 offen lds
    s_mov_b64 exec, -1
    s_add_u32 s32, s32, 0x4800
    v_mfma_f32_16x16x32_bf16 v[124:127], v[56:59], v[76:79], v[124:127]
    v_mfma_f32_16x16x32_bf16 v[128:131], v[56:59], v[80:83], v[128:131]
    ds_read_b64_tr_b16 v[48:49], v23 offset:9408
    s_waitcnt lgkmcnt(13)
    ds_read_b64_tr_b16 v[50:51], v23 offset:11712
    s_waitcnt lgkmcnt(12)
    v_mfma_f32_16x16x32_bf16 v[100:103], v[28:31], v[84:87], v[100:103]
    v_mfma_f32_16x16x32_bf16 v[104:107], v[28:31], v[88:91], v[104:107]
    ds_read_b64_tr_b16 v[52:53], v23 offset:9440
    ds_read_b64_tr_b16 v[54:55], v23 offset:11744
    s_waitcnt lgkmcnt(12)
    v_mfma_f32_16x16x32_bf16 v[108:111], v[32:35], v[84:87], v[108:111]
    v_mfma_f32_16x16x32_bf16 v[112:115], v[32:35], v[88:91], v[112:115]
    ds_read_b64_tr_b16 v[56:57], v23 offset:9472
    ds_read_b64_tr_b16 v[58:59], v23 offset:11776
    s_waitcnt lgkmcnt(11)
    v_mfma_f32_16x16x32_bf16 v[116:119], v[36:39], v[84:87], v[116:119]
    v_mfma_f32_16x16x32_bf16 v[120:123], v[36:39], v[88:91], v[120:123]
    s_waitcnt vmcnt(10) lgkmcnt(0)
    s_barrier
    ds_read_b128 v[68:71], v12 offset:0
    ds_read_b128 v[72:75], v12 offset:2048
    ds_read_b64_tr_b16 v[28:29], v14 offset:160
    ds_read_b64_tr_b16 v[30:31], v14 offset:2464
    s_add_u32 m0, s29, 0x19800
    s_nop 0
    buffer_load_dwordx4 v8, s[12:15], s31 offen lds
    v_mfma_f32_16x16x32_bf16 v[124:127], v[40:43], v[84:87], v[124:127]
    v_mfma_f32_16x16x32_bf16 v[128:131], v[40:43], v[88:91], v[128:131]
    ds_read_b64_tr_b16 v[32:33], v14 offset:192
    ds_read_b64_tr_b16 v[34:35], v14 offset:2496
    ds_read_b128 v[76:79], v13 offset:0
    s_add_u32 m0, s29, 0x1b800
    s_add_u32 s33, s31, 0x40000
    buffer_load_dwordx4 v8, s[12:15], s33 offen lds
    s_add_u32 s31, s31, 128
    v_mfma_f32_16x16x32_bf16 v[100:103], v[44:47], v[92:95], v[100:103]
    v_mfma_f32_16x16x32_bf16 v[104:107], v[44:47], v[96:99], v[104:107]
    ds_read_b64_tr_b16 v[36:37], v14 offset:224
    ds_read_b64_tr_b16 v[38:39], v14 offset:2528
    ds_read_b128 v[80:83], v13 offset:2048
    s_add_u32 m0, s29, 0x1d800
    s_nop 0
    buffer_load_dwordx4 v9, s[16:19], s32 offen lds
    v_mfma_f32_16x16x32_bf16 v[108:111], v[48:51], v[92:95], v[108:111]
    v_mfma_f32_16x16x32_bf16 v[112:115], v[48:51], v[96:99], v[112:115]
    ds_read_b64_tr_b16 v[40:41], v14 offset:256
    ds_read_b64_tr_b16 v[42:43], v14 offset:2560
    s_add_u32 m0, s29, 0x1f800
    s_nop 0
    buffer_load_dwordx4 v10, s[16:19], s32 offen lds
    v_mfma_f32_16x16x32_bf16 v[116:119], v[52:55], v[92:95], v[116:119]
    v_mfma_f32_16x16x32_bf16 v[120:123], v[52:55], v[96:99], v[120:123]
    ds_read_b64_tr_b16 v[44:45], v14 offset:9376
    ds_read_b64_tr_b16 v[46:47], v14 offset:11680
    s_add_u32 m0, s30, 0x21800
    s_nop 0
    s_mov_b64 exec, 0xffff
    buffer_load_dwordx4 v11, s[16:19], s32 offen lds
    s_mov_b64 exec, -1
    s_add_u32 s32, s32, 0x4800
    v_mfma_f32_16x16x32_bf16 v[124:127], v[56:59], v[92:95], v[124:127]
    v_mfma_f32_16x16x32_bf16 v[128:131], v[56:59], v[96:99], v[128:131]
    ds_read_b64_tr_b16 v[48:49], v14 offset:9408
    s_waitcnt lgkmcnt(13)
    ds_read_b64_tr_b16 v[50:51], v14 offset:11712
    s_waitcnt lgkmcnt(12)
    v_mfma_f32_16x16x32_bf16 v[100:103], v[28:31], v[68:71], v[100:103]
    v_mfma_f32_16x16x32_bf16 v[104:107], v[28:31], v[72:75], v[104:107]
    ds_read_b64_tr_b16 v[52:53], v14 offset:9440
    ds_read_b64_tr_b16 v[54:55], v14 offset:11744
    s_waitcnt lgkmcnt(12)
    v_mfma_f32_16x16x32_bf16 v[108:111], v[32:35], v[68:71], v[108:111]
    v_mfma_f32_16x16x32_bf16 v[112:115], v[32:35], v[72:75], v[112:115]
    ds_read_b64_tr_b16 v[56:57], v14 offset:9472
    ds_read_b64_tr_b16 v[58:59], v14 offset:11776
    s_waitcnt lgkmcnt(11)
    v_mfma_f32_16x16x32_bf16 v[116:119], v[36:39], v[68:71], v[116:119]
    v_mfma_f32_16x16x32_bf16 v[120:123], v[36:39], v[72:75], v[120:123]
    s_waitcnt vmcnt(10) lgkmcnt(0)
    s_barrier
    ds_read_b128 v[84:87], v15 offset:0
    ds_read_b128 v[88:91], v15 offset:2048
    ds_read_b64_tr_b16 v[28:29], v17 offset:160
    ds_read_b64_tr_b16 v[30:31], v17 offset:2464
    s_add_u32 m0, s29, 0x0
    s_nop 0
    buffer_load_dwordx4 v8, s[12:15], s31 offen lds
    v_mfma_f32_16x16x32_bf16 v[124:127], v[40:43], v[68:71], v[124:127]
    v_mfma_f32_16x16x32_bf16 v[128:131], v[40:43], v[72:75], v[128:131]
    ds_read_b64_tr_b16 v[32:33], v17 offset:192
    ds_read_b64_tr_b16 v[34:35], v17 offset:2496
    ds_read_b128 v[92:95], v16 offset:0
    s_add_u32 m0, s29, 0x2000
    s_add_u32 s33, s31, 0x40000
    buffer_load_dwordx4 v8, s[12:15], s33 offen lds
    s_add_u32 s31, s31, 128
    v_mfma_f32_16x16x32_bf16 v[100:103], v[44:47], v[76:79], v[100:103]
    v_mfma_f32_16x16x32_bf16 v[104:107], v[44:47], v[80:83], v[104:107]
    ds_read_b64_tr_b16 v[36:37], v17 offset:224
    ds_read_b64_tr_b16 v[38:39], v17 offset:2528
    ds_read_b128 v[96:99], v16 offset:2048
    s_add_u32 m0, s29, 0x4000
    s_nop 0
    buffer_load_dwordx4 v9, s[16:19], s32 offen lds
    v_mfma_f32_16x16x32_bf16 v[108:111], v[48:51], v[76:79], v[108:111]
    v_mfma_f32_16x16x32_bf16 v[112:115], v[48:51], v[80:83], v[112:115]
    ds_read_b64_tr_b16 v[40:41], v17 offset:256
    ds_read_b64_tr_b16 v[42:43], v17 offset:2560
    s_add_u32 m0, s29, 0x6000
    s_nop 0
    buffer_load_dwordx4 v10, s[16:19], s32 offen lds
    v_mfma_f32_16x16x32_bf16 v[116:119], v[52:55], v[76:79], v[116:119]
    v_mfma_f32_16x16x32_bf16 v[120:123], v[52:55], v[80:83], v[120:123]
    ds_read_b64_tr_b16 v[44:45], v17 offset:9376
    ds_read_b64_tr_b16 v[46:47], v17 offset:11680
    s_add_u32 m0, s30, 0x8000
    s_nop 0
    s_mov_b64 exec, 0xffff
    buffer_load_dwordx4 v11, s[16:19], s32 offen lds
    s_mov_b64 exec, -1
    s_add_u32 s32, s32, 0x4800
    v_mfma_f32_16x16x32_bf16 v[124:127], v[56:59], v[76:79], v[124:127]
    v_mfma_f32_16x16x32_bf16 v[128:131], v[56:59], v[80:83], v[128:131]
    ds_read_b64_tr_b16 v[48:49], v17 offset:9408
    s_waitcnt lgkmcnt(13)
    ds_read_b64_tr_b16 v[50:51], v17 offset:11712
    s_waitcnt lgkmcnt(12)
    v_mfma_f32_16x16x32_bf16 v[100:103], v[28:31], v[84:87], v[100:103]
    v_mfma_f32_16x16x32_bf16 v[104:107], v[28:31], v[88:91], v[104:107]
    ds_read_b64_tr_b16 v[52:53], v17 offset:9440
    ds_read_b64_tr_b16 v[54:55], v17 offset:11744
    s_waitcnt lgkmcnt(12)
    v_mfma_f32_16x16x32_bf16 v[108:111], v[32:35], v[84:87], v[108:111]
    v_mfma_f32_16x16x32_bf16 v[112:115], v[32:35], v[88:91], v[112:115]
    ds_read_b64_tr_b16 v[56:57], v17 offset:9472
    ds_read_b64_tr_b16 v[58:59], v17 offset:11776
    s_waitcnt lgkmcnt(11)
    v_mfma_f32_16x16x32_bf16 v[116:119], v[36:39], v[84:87], v[116:119]
    v_mfma_f32_16x16x32_bf16 v[120:123], v[36:39], v[88:91], v[120:123]
    s_waitcnt vmcnt(10) lgkmcnt(0)
    s_barrier
    ds_read_b128 v[68:71], v18 offset:0
    ds_read_b128 v[72:75], v18 offset:2048
    ds_read_b64_tr_b16 v[28:29], v20 offset:160
    ds_read_b64_tr_b16 v[30:31], v20 offset:2464
    s_add_u32 m0, s29, 0x8800
    s_nop 0
    buffer_load_dwordx4 v8, s[12:15], s31 offen lds
    v_mfma_f32_16x16x32_bf16 v[124:127], v[40:43], v[84:87], v[124:127]
    v_mfma_f32_16x16x32_bf16 v[128:131], v[40:43], v[88:91], v[128:131]
    ds_read_b64_tr_b16 v[32:33], v20 offset:192
    ds_read_b64_tr_b16 v[34:35], v20 offset:2496
    ds_read_b128 v[76:79], v19 offset:0
    s_add_u32 m0, s29, 0xa800
    s_add_u32 s33, s31, 0x40000
    buffer_load_dwordx4 v8, s[12:15], s33 offen lds
    s_add_u32 s31, s31, 128
    v_mfma_f32_16x16x32_bf16 v[100:103], v[44:47], v[92:95], v[100:103]
    v_mfma_f32_16x16x32_bf16 v[104:107], v[44:47], v[96:99], v[104:107]
    ds_read_b64_tr_b16 v[36:37], v20 offset:224
    ds_read_b64_tr_b16 v[38:39], v20 offset:2528
    ds_read_b128 v[80:83], v19 offset:2048
    s_add_u32 m0, s29, 0xc800
    s_nop 0
    buffer_load_dwordx4 v9, s[16:19], s32 offen lds
    v_mfma_f32_16x16x32_bf16 v[108:111], v[48:51], v[92:95], v[108:111]
    v_mfma_f32_16x16x32_bf16 v[112:115], v[48:51], v[96:99], v[112:115]
    ds_read_b64_tr_b16 v[40:41], v20 offset:256
    ds_read_b64_tr_b16 v[42:43], v20 offset:2560
    s_add_u32 m0, s29, 0xe800
    s_nop 0
    buffer_load_dwordx4 v10, s[16:19], s32 offen lds
    v_mfma_f32_16x16x32_bf16 v[116:119], v[52:55], v[92:95], v[116:119]
    v_mfma_f32_16x16x32_bf16 v[120:123], v[52:55], v[96:99], v[120:123]
    ds_read_b64_tr_b16 v[44:45], v20 offset:9376
    ds_read_b64_tr_b16 v[46:47], v20 offset:11680
    s_add_u32 m0, s30, 0x10800
    s_nop 0
    s_mov_b64 exec, 0xffff
    buffer_load_dwordx4 v11, s[16:19], s32 offen lds
    s_mov_b64 exec, -1
    s_add_u32 s32, s32, 0x4800
    v_mfma_f32_16x16x32_bf16 v[124:127], v[56:59], v[92:95], v[124:127]
    v_mfma_f32_16x16x32_bf16 v[128:131], v[56:59], v[96:99], v[128:131]
    ds_read_b64_tr_b16 v[48:49], v20 offset:9408
    s_waitcnt lgkmcnt(13)
    ds_read_b64_tr_b16 v[50:51], v20 offset:11712
    s_sub_u32 s40, s40, 1
    s_cmp_lg_u32 s40, 0
    s_cbranch_scc1 LP_rompt_kernel_13
    s_waitcnt lgkmcnt(12)
    v_mfma_f32_16x16x32_bf16 v[100:103], v[28:31], v[68:71], v[100:103]
    v_mfma_f32_16x16x32_bf16 v[104:107], v[28:31], v[72:75], v[104:107]
    ds_read_b64_tr_b16 v[52:53], v20 offset:9440
    ds_read_b64_tr_b16 v[54:55], v20 offset:11744
    s_waitcnt lgkmcnt(12)
    v_mfma_f32_16x16x32_bf16 v[108:111], v[32:35], v[68:71], v[108:111]
    v_mfma_f32_16x16x32_bf16 v[112:115], v[32:35], v[72:75], v[112:115]
    ds_read_b64_tr_b16 v[56:57], v20 offset:9472
    ds_read_b64_tr_b16 v[58:59], v20 offset:11776
    s_waitcnt lgkmcnt(11)
    v_mfma_f32_16x16x32_bf16 v[116:119], v[36:39], v[68:71], v[116:119]
    v_mfma_f32_16x16x32_bf16 v[120:123], v[36:39], v[72:75], v[120:123]
    s_waitcnt vmcnt(10) lgkmcnt(0)
    s_barrier
    ds_read_b128 v[84:87], v21 offset:0
    ds_read_b128 v[88:91], v21 offset:2048
    ds_read_b64_tr_b16 v[28:29], v23 offset:160
    ds_read_b64_tr_b16 v[30:31], v23 offset:2464
    s_add_u32 m0, s29, 0x11000
    s_nop 0
    buffer_load_dwordx4 v8, s[12:15], s31 offen lds
    v_mfma_f32_16x16x32_bf16 v[124:127], v[40:43], v[68:71], v[124:127]
    v_mfma_f32_16x16x32_bf16 v[128:131], v[40:43], v[72:75], v[128:131]
    ds_read_b64_tr_b16 v[32:33], v23 offset:192
    ds_read_b64_tr_b16 v[34:35], v23 offset:2496
    ds_read_b128 v[92:95], v22 offset:0
    s_add_u32 m0, s29, 0x13000
    s_add_u32 s33, s31, 0x40000
    buffer_load_dwordx4 v8, s[12:15], s33 offen lds
    s_add_u32 s31, s31, 128
    v_mfma_f32_16x16x32_bf16 v[100:103], v[44:47], v[76:79], v[100:103]
    v_mfma_f32_16x16x32_bf16 v[104:107], v[44:47], v[80:83], v[104:107]
    ds_read_b64_tr_b16 v[36:37], v23 offset:224
    ds_read_b64_tr_b16 v[38:39], v23 offset:2528
    ds_read_b128 v[96:99], v22 offset:2048
    s_add_u32 m0, s29, 0x15000
    s_nop 0
    buffer_load_dwordx4 v9, s[16:19], s32 offen lds
    v_mfma_f32_16x16x32_bf16 v[108:111], v[48:51], v[76:79], v[108:111]
    v_mfma_f32_16x16x32_bf16 v[112:115], v[48:51], v[80:83], v[112:115]
    ds_read_b64_tr_b16 v[40:41], v23 offset:256
    ds_read_b64_tr_b16 v[42:43], v23 offset:2560
    s_add_u32 m0, s29, 0x17000
    s_nop 0
    buffer_load_dwordx4 v10, s[16:19], s32 offen lds
    v_mfma_f32_16x16x32_bf16 v[116:119], v[52:55], v[76:79], v[116:119]
    v_mfma_f32_16x16x32_bf16 v[120:123], v[52:55], v[80:83], v[120:123]
    ds_read_b64_tr_b16 v[44:45], v23 offset:9376
    ds_read_b64_tr_b16 v[46:47], v23 offset:11680
    s_add_u32 m0, s30, 0x19000
    s_nop 0
    s_mov_b64 exec, 0xffff
    buffer_load_dwordx4 v11, s[16:19], s32 offen lds
    s_mov_b64 exec, -1
    s_add_u32 s32, s32, 0x4800
    v_mfma_f32_16x16x32_bf16 v[124:127], v[56:59], v[76:79], v[124:127]
    v_mfma_f32_16x16x32_bf16 v[128:131], v[56:59], v[80:83], v[128:131]
    ds_read_b64_tr_b16 v[48:49], v23 offset:9408
    s_waitcnt lgkmcnt(13)
    ds_read_b64_tr_b16 v[50:51], v23 offset:11712
    s_waitcnt lgkmcnt(12)
    v_mfma_f32_16x16x32_bf16 v[100:103], v[28:31], v[84:87], v[100:103]
    v_mfma_f32_16x16x32_bf16 v[104:107], v[28:31], v[88:91], v[104:107]
    ds_read_b64_tr_b16 v[52:53], v23 offset:9440
    ds_read_b64_tr_b16 v[54:55], v23 offset:11744
    s_waitcnt lgkmcnt(12)
    v_mfma_f32_16x16x32_bf16 v[108:111], v[32:35], v[84:87], v[108:111]
    v_mfma_f32_16x16x32_bf16 v[112:115], v[32:35], v[88:91], v[112:115]
    ds_read_b64_tr_b16 v[56:57], v23 offset:9472
    ds_read_b64_tr_b16 v[58:59], v23 offset:11776
    s_waitcnt lgkmcnt(11)
    v_mfma_f32_16x16x32_bf16 v[116:119], v[36:39], v[84:87], v[116:119]
    v_mfma_f32_16x16x32_bf16 v[120:123], v[36:39], v[88:91], v[120:123]
    s_waitcnt vmcnt(10) lgkmcnt(0)
    s_barrier
    ds_read_b128 v[68:71], v12 offset:0
    ds_read_b128 v[72:75], v12 offset:2048
    ds_read_b64_tr_b16 v[28:29], v14 offset:160
    ds_read_b64_tr_b16 v[30:31], v14 offset:2464
    s_add_u32 m0, s29, 0x19800
    s_nop 0
    buffer_load_dwordx4 v8, s[12:15], s31 offen lds
    v_mfma_f32_16x16x32_bf16 v[124:127], v[40:43], v[84:87], v[124:127]
    v_mfma_f32_16x16x32_bf16 v[128:131], v[40:43], v[88:91], v[128:131]
    ds_read_b64_tr_b16 v[32:33], v14 offset:192
    ds_read_b64_tr_b16 v[34:35], v14 offset:2496
    ds_read_b128 v[76:79], v13 offset:0
    s_add_u32 m0, s29, 0x1b800
    s_add_u32 s33, s31, 0x40000
    buffer_load_dwordx4 v8, s[12:15], s33 offen lds
    s_add_u32 s31, s31, 128
    v_mfma_f32_16x16x32_bf16 v[100:103], v[44:47], v[92:95], v[100:103]
    v_mfma_f32_16x16x32_bf16 v[104:107], v[44:47], v[96:99], v[104:107]
    ds_read_b64_tr_b16 v[36:37], v14 offset:224
    ds_read_b64_tr_b16 v[38:39], v14 offset:2528
    ds_read_b128 v[80:83], v13 offset:2048
    s_add_u32 m0, s29, 0x1d800
    s_nop 0
    buffer_load_dwordx4 v9, s[16:19], s32 offen lds
    v_mfma_f32_16x16x32_bf16 v[108:111], v[48:51], v[92:95], v[108:111]
    v_mfma_f32_16x16x32_bf16 v[112:115], v[48:51], v[96:99], v[112:115]
    ds_read_b64_tr_b16 v[40:41], v14 offset:256
    ds_read_b64_tr_b16 v[42:43], v14 offset:2560
    s_add_u32 m0, s29, 0x1f800
    s_nop 0
    buffer_load_dwordx4 v10, s[16:19], s32 offen lds
    v_mfma_f32_16x16x32_bf16 v[116:119], v[52:55], v[92:95], v[116:119]
    v_mfma_f32_16x16x32_bf16 v[120:123], v[52:55], v[96:99], v[120:123]
    ds_read_b64_tr_b16 v[44:45], v14 offset:9376
    ds_read_b64_tr_b16 v[46:47], v14 offset:11680
    s_add_u32 m0, s30, 0x21800
    s_nop 0
    s_mov_b64 exec, 0xffff
    buffer_load_dwordx4 v11, s[16:19], s32 offen lds
    s_mov_b64 exec, -1
    s_add_u32 s32, s32, 0x4800
    v_mfma_f32_16x16x32_bf16 v[124:127], v[56:59], v[92:95], v[124:127]
    v_mfma_f32_16x16x32_bf16 v[128:131], v[56:59], v[96:99], v[128:131]
    ds_read_b64_tr_b16 v[48:49], v14 offset:9408
    s_waitcnt lgkmcnt(13)
    ds_read_b64_tr_b16 v[50:51], v14 offset:11712
    s_waitcnt lgkmcnt(12)
    v_mfma_f32_16x16x32_bf16 v[100:103], v[28:31], v[68:71], v[100:103]
    v_mfma_f32_16x16x32_bf16 v[104:107], v[28:31], v[72:75], v[104:107]
    ds_read_b64_tr_b16 v[52:53], v14 offset:9440
    ds_read_b64_tr_b16 v[54:55], v14 offset:11744
    s_waitcnt lgkmcnt(12)
    v_mfma_f32_16x16x32_bf16 v[108:111], v[32:35], v[68:71], v[108:111]
    v_mfma_f32_16x16x32_bf16 v[112:115], v[32:35], v[72:75], v[112:115]
    ds_read_b64_tr_b16 v[56:57], v14 offset:9472
    ds_read_b64_tr_b16 v[58:59], v14 offset:11776
    s_waitcnt lgkmcnt(11)
    v_mfma_f32_16x16x32_bf16 v[116:119], v[36:39], v[68:71], v[116:119]
    v_mfma_f32_16x16x32_bf16 v[120:123], v[36:39], v[72:75], v[120:123]
    s_waitcnt vmcnt(10) lgkmcnt(0)
    s_barrier
    ds_read_b128 v[84:87], v15 offset:0
    ds_read_b128 v[88:91], v15 offset:2048
    ds_read_b64_tr_b16 v[28:29], v17 offset:160
    ds_read_b64_tr_b16 v[30:31], v17 offset:2464
    v_mfma_f32_16x16x32_bf16 v[124:127], v[40:43], v[68:71], v[124:127]
    v_mfma_f32_16x16x32_bf16 v[128:131], v[40:43], v[72:75], v[128:131]
    ds_read_b64_tr_b16 v[32:33], v17 offset:192
    ds_read_b64_tr_b16 v[34:35], v17 offset:2496
    ds_read_b128 v[92:95], v16 offset:0
    v_mfma_f32_16x16x32_bf16 v[100:103], v[44:47], v[76:79], v[100:103]
    v_mfma_f32_16x16x32_bf16 v[104:107], v[44:47], v[80:83], v[104:107]
    ds_read_b64_tr_b16 v[36:37], v17 offset:224
    ds_read_b64_tr_b16 v[38:39], v17 offset:2528
    ds_read_b128 v[96:99], v16 offset:2048
    v_mfma_f32_16x16x32_bf16 v[108:111], v[48:51], v[76:79], v[108:111]
    v_mfma_f32_16x16x32_bf16 v[112:115], v[48:51], v[80:83], v[112:115]
    ds_read_b64_tr_b16 v[40:41], v17 offset:256
    ds_read_b64_tr_b16 v[42:43], v17 offset:2560
    v_mfma_f32_16x16x32_bf16 v[116:119], v[52:55], v[76:79], v[116:119]
    v_mfma_f32_16x16x32_bf16 v[120:123], v[52:55], v[80:83], v[120:123]
    ds_read_b64_tr_b16 v[44:45], v17 offset:9376
    ds_read_b64_tr_b16 v[46:47], v17 offset:11680
    v_mfma_f32_16x16x32_bf16 v[124:127], v[56:59], v[76:79], v[124:127]
    v_mfma_f32_16x16x32_bf16 v[128:131], v[56:59], v[80:83], v[128:131]
    ds_read_b64_tr_b16 v[48:49], v17 offset:9408
    s_waitcnt lgkmcnt(13)
    ds_read_b64_tr_b16 v[50:51], v17 offset:11712
    s_waitcnt lgkmcnt(12)
    v_mfma_f32_16x16x32_bf16 v[100:103], v[28:31], v[84:87], v[100:103]
    v_mfma_f32_16x16x32_bf16 v[104:107], v[28:31], v[88:91], v[104:107]
    ds_read_b64_tr_b16 v[52:53], v17 offset:9440
    ds_read_b64_tr_b16 v[54:55], v17 offset:11744
    s_waitcnt lgkmcnt(12)
    v_mfma_f32_16x16x32_bf16 v[108:111], v[32:35], v[84:87], v[108:111]
    v_mfma_f32_16x16x32_bf16 v[112:115], v[32:35], v[88:91], v[112:115]
    ds_read_b64_tr_b16 v[56:57], v17 offset:9472
    ds_read_b64_tr_b16 v[58:59], v17 offset:11776
    s_waitcnt lgkmcnt(11)
    v_mfma_f32_16x16x32_bf16 v[116:119], v[36:39], v[84:87], v[116:119]
    v_mfma_f32_16x16x32_bf16 v[120:123], v[36:39], v[88:91], v[120:123]
    s_waitcnt vmcnt(5) lgkmcnt(0)
    s_barrier
    ds_read_b128 v[68:71], v18 offset:0
    ds_read_b128 v[72:75], v18 offset:2048
    ds_read_b64_tr_b16 v[28:29], v20 offset:160
    ds_read_b64_tr_b16 v[30:31], v20 offset:2464
    v_mfma_f32_16x16x32_bf16 v[124:127], v[40:43], v[84:87], v[124:127]
    v_mfma_f32_16x16x32_bf16 v[128:131], v[40:43], v[88:91], v[128:131]
    ds_read_b64_tr_b16 v[32:33], v20 offset:192
    ds_read_b64_tr_b16 v[34:35], v20 offset:2496
    ds_read_b128 v[76:79], v19 offset:0
    v_mfma_f32_16x16x32_bf16 v[100:103], v[44:47], v[92:95], v[100:103]
    v_mfma_f32_16x16x32_bf16 v[104:107], v[44:47], v[96:99], v[104:107]
    ds_read_b64_tr_b16 v[36:37], v20 offset:224
    ds_read_b64_tr_b16 v[38:39], v20 offset:2528
    ds_read_b128 v[80:83], v19 offset:2048
    v_mfma_f32_16x16x32_bf16 v[108:111], v[48:51], v[92:95], v[108:111]
    v_mfma_f32_16x16x32_bf16 v[112:115], v[48:51], v[96:99], v[112:115]
    ds_read_b64_tr_b16 v[40:41], v20 offset:256
    ds_read_b64_tr_b16 v[42:43], v20 offset:2560
    v_mfma_f32_16x16x32_bf16 v[116:119], v[52:55], v[92:95], v[116:119]
    v_mfma_f32_16x16x32_bf16 v[120:123], v[52:55], v[96:99], v[120:123]
    ds_read_b64_tr_b16 v[44:45], v20 offset:9376
    ds_read_b64_tr_b16 v[46:47], v20 offset:11680
    v_mfma_f32_16x16x32_bf16 v[124:127], v[56:59], v[92:95], v[124:127]
    v_mfma_f32_16x16x32_bf16 v[128:131], v[56:59], v[96:99], v[128:131]
    ds_read_b64_tr_b16 v[48:49], v20 offset:9408
    s_waitcnt lgkmcnt(13)
    ds_read_b64_tr_b16 v[50:51], v20 offset:11712
    s_waitcnt lgkmcnt(12)
    v_mfma_f32_16x16x32_bf16 v[100:103], v[28:31], v[68:71], v[100:103]
    v_mfma_f32_16x16x32_bf16 v[104:107], v[28:31], v[72:75], v[104:107]
    ds_read_b64_tr_b16 v[52:53], v20 offset:9440
    ds_read_b64_tr_b16 v[54:55], v20 offset:11744
    s_waitcnt lgkmcnt(12)
    v_mfma_f32_16x16x32_bf16 v[108:111], v[32:35], v[68:71], v[108:111]
    v_mfma_f32_16x16x32_bf16 v[112:115], v[32:35], v[72:75], v[112:115]
    ds_read_b64_tr_b16 v[56:57], v20 offset:9472
    ds_read_b64_tr_b16 v[58:59], v20 offset:11776
    s_waitcnt lgkmcnt(11)
    v_mfma_f32_16x16x32_bf16 v[116:119], v[36:39], v[68:71], v[116:119]
    v_mfma_f32_16x16x32_bf16 v[120:123], v[36:39], v[72:75], v[120:123]
    s_waitcnt vmcnt(0) lgkmcnt(0)
    s_barrier
    ds_read_b128 v[84:87], v21 offset:0
    ds_read_b128 v[88:91], v21 offset:2048
    ds_read_b64_tr_b16 v[28:29], v23 offset:160
    ds_read_b64_tr_b16 v[30:31], v23 offset:2464
    v_mfma_f32_16x16x32_bf16 v[124:127], v[40:43], v[68:71], v[124:127]
    v_mfma_f32_16x16x32_bf16 v[128:131], v[40:43], v[72:75], v[128:131]
    ds_read_b64_tr_b16 v[32:33], v23 offset:192
    ds_read_b64_tr_b16 v[34:35], v23 offset:2496
    ds_read_b128 v[92:95], v22 offset:0
    v_mfma_f32_16x16x32_bf16 v[100:103], v[44:47], v[76:79], v[100:103]
    v_mfma_f32_16x16x32_bf16 v[104:107], v[44:47], v[80:83], v[104:107]
    ds_read_b64_tr_b16 v[36:37], v23 offset:224
    ds_read_b64_tr_b16 v[38:39], v23 offset:2528
    ds_read_b128 v[96:99], v22 offset:2048
    v_mfma_f32_16x16x32_bf16 v[108:111], v[48:51], v[76:79], v[108:111]
    v_mfma_f32_16x16x32_bf16 v[112:115], v[48:51], v[80:83], v[112:115]
    ds_read_b64_tr_b16 v[40:41], v23 offset:256
    ds_read_b64_tr_b16 v[42:43], v23 offset:2560
    v_mfma_f32_16x16x32_bf16 v[116:119], v[52:55], v[76:79], v[116:119]
    v_mfma_f32_16x16x32_bf16 v[120:123], v[52:55], v[80:83], v[120:123]
    ds_read_b64_tr_b16 v[44:45], v23 offset:9376
    ds_read_b64_tr_b16 v[46:47], v23 offset:11680
    v_mfma_f32_16x16x32_bf16 v[124:127], v[56:59], v[76:79], v[124:127]
    v_mfma_f32_16x16x32_bf16 v[128:131], v[56:59], v[80:83], v[128:131]
    ds_read_b64_tr_b16 v[48:49], v23 offset:9408
    s_waitcnt lgkmcnt(13)
    ds_read_b64_tr_b16 v[50:51], v23 offset:11712
    s_waitcnt lgkmcnt(12)
    v_mfma_f32_16x16x32_bf16 v[100:103], v[28:31], v[84:87], v[100:103]
    v_mfma_f32_16x16x32_bf16 v[104:107], v[28:31], v[88:91], v[104:107]
    ds_read_b64_tr_b16 v[52:53], v23 offset:9440
    ds_read_b64_tr_b16 v[54:55], v23 offset:11744
    s_waitcnt lgkmcnt(12)
    v_mfma_f32_16x16x32_bf16 v[108:111], v[32:35], v[84:87], v[108:111]
    v_mfma_f32_16x16x32_bf16 v[112:115], v[32:35], v[88:91], v[112:115]
    ds_read_b64_tr_b16 v[56:57], v23 offset:9472
    ds_read_b64_tr_b16 v[58:59], v23 offset:11776
    s_waitcnt lgkmcnt(11)
    v_mfma_f32_16x16x32_bf16 v[116:119], v[36:39], v[84:87], v[116:119]
    v_mfma_f32_16x16x32_bf16 v[120:123], v[36:39], v[88:91], v[120:123]
    s_waitcnt lgkmcnt(8)
    v_mfma_f32_16x16x32_bf16 v[124:127], v[40:43], v[84:87], v[124:127]
    v_mfma_f32_16x16x32_bf16 v[128:131], v[40:43], v[88:91], v[128:131]
    s_waitcnt lgkmcnt(6)
    v_mfma_f32_16x16x32_bf16 v[100:103], v[44:47], v[92:95], v[100:103]
    v_mfma_f32_16x16x32_bf16 v[104:107], v[44:47], v[96:99], v[104:107]
    s_waitcnt lgkmcnt(4)
    v_mfma_f32_16x16x32_bf16 v[108:111], v[48:51], v[92:95], v[108:111]
    v_mfma_f32_16x16x32_bf16 v[112:115], v[48:51], v[96:99], v[112:115]
    s_waitcnt lgkmcnt(2)
    v_mfma_f32_16x16x32_bf16 v[116:119], v[52:55], v[92:95], v[116:119]
    v_mfma_f32_16x16x32_bf16 v[120:123], v[52:55], v[96:99], v[120:123]
    s_waitcnt lgkmcnt(0)
    v_mfma_f32_16x16x32_bf16 v[124:127], v[56:59], v[92:95], v[124:127]
    v_mfma_f32_16x16x32_bf16 v[128:131], v[56:59], v[96:99], v[128:131]
    s_nop 7
    s_nop 3
    v_and_b32 v100, 0xfffe0000, v100
    v_or_b32 v100, 0x10000, v100
    v_cvt_pk_bf16_f32 v28, v100, v101
    v_cvt_pk_bf16_f32 v29, v102, v103
    v_or_b32 v28, 1, v28
    v_and_b32 v104, 0xfffe0000, v104
    v_or_b32 v104, 0x10000, v104
    v_cvt_pk_bf16_f32 v30, v104, v105
    v_cvt_pk_bf16_f32 v31, v106, v107
    v_or_b32 v30, 1, v30
    s_mov_b32 s33, 5120
    s_nop 0
    v_permlane16_swap_b32 v28, v30
    v_permlane16_swap_b32 v29, v31
    s_nop 0
    buffer_store_dwordx4 v[28:31], v7, s[24:27], s33 offen offset:0 sc0 sc1
    v_and_b32 v108, 0xfffe0000, v108
    v_or_b32 v108, 0x10000, v108
    v_cvt_pk_bf16_f32 v32, v108, v109
    v_cvt_pk_bf16_f32 v33, v110, v111
    v_or_b32 v32, 1, v32
    v_and_b32 v112, 0xfffe0000, v112
    v_or_b32 v112, 0x10000, v112
    v_cvt_pk_bf16_f32 v34, v112, v113
    v_cvt_pk_bf16_f32 v35, v114, v115
    v_or_b32 v34, 1, v34
    s_nop 0
    s_nop 0
    v_permlane16_swap_b32 v32, v34
    v_permlane16_swap_b32 v33, v35
    s_nop 0
    buffer_store_dwordx4 v[32:35], v7, s[24:27], s33 offen offset:1024 sc0 sc1
    v_and_b32 v116, 0xfffe0000, v116
    v_or_b32 v116, 0x10000, v116
    v_cvt_pk_bf16_f32 v36, v116, v117
    v_cvt_pk_bf16_f32 v37, v118, v119
    v_or_b32 v36, 1, v36
    v_and_b32 v120, 0xfffe0000, v120
    v_or_b32 v120, 0x10000, v120
    v_cvt_pk_bf16_f32 v38, v120, v121
    v_cvt_pk_bf16_f32 v39, v122, v123
    v_or_b32 v38, 1, v38
    s_nop 0
    s_nop 0
    v_permlane16_swap_b32 v36, v38
    v_permlane16_swap_b32 v37, v39
    s_nop 0
    buffer_store_dwordx4 v[36:39], v7, s[24:27], s33 offen offset:2048 sc0 sc1
    v_and_b32 v124, 0xfffe0000, v124
    v_or_b32 v124, 0x10000, v124
    v_cvt_pk_bf16_f32 v40, v124, v125
    v_cvt_pk_bf16_f32 v41, v126, v127
    v_or_b32 v40, 1, v40
    v_and_b32 v128, 0xfffe0000, v128
    v_or_b32 v128, 0x10000, v128
    v_cvt_pk_bf16_f32 v42, v128, v129
    v_cvt_pk_bf16_f32 v43, v130, v131
    v_or_b32 v42, 1, v42
    s_nop 0
    s_nop 0
    v_permlane16_swap_b32 v40, v42
    v_permlane16_swap_b32 v41, v43
    s_nop 0
    buffer_store_dwordx4 v[40:43], v7, s[24:27], s33 offen offset:3072 sc0 sc1
LJ_rompt_kernel_10:
    s_lshl_b32 s39, s36, 2
    s_add_u32 s39, s39, s38
    s_add_u32 s12, s48, 0x0
    s_addc_u32 s13, s49, 0
    s_mov_b32 s14, 0x240000
    s_and_b32 s13, s13, 0xffff
    s_mov_b32 s15, 0x20000
    s_lshr_b32 s46, s39, 2
    s_lshl_b32 s47, s37, 2
    s_add_u32 s46, s46, s47
    s_mul_i32 s46, s46, 36864
    s_add_u32 s20, s4, 0x1400000
    s_addc_u32 s21, s5, 0
    s_add_u32 s20, s20, s46
    s_addc_u32 s21, s21, 0
    s_sub_u32 s22, 0x900000, s46
    s_and_b32 s21, s21, 0xffff
    s_mov_b32 s23, 0x20000
    s_add_u32 s24, s4, 0x400000
    s_addc_u32 s25, s5, 0
    s_mov_b32 s26, 0x240000
    s_and_b32 s25, s25, 0xffff
    s_mov_b32 s27, 0x20000
    s_add_u32 s52, s4, 0x0
    s_addc_u32 s53, s5, 0
    s_mov_b32 s54, 0x240000
    s_and_b32 s53, s53, 0xffff
    s_mov_b32 s55, 0x20000
    s_lshl_b32 s46, s37, 7
    s_lshl_b32 s47, s39, 3
    s_add_u32 s46, s46, s47
    s_add_u32 s46, s46, s28
    v_mov_b32 v2, s46
    v_mul_u32_u24 v4, 1152, v2
    v_lshl_add_u32 v7, v1, 3, v4
    v_lshl_add_u32 v8, v1, 1, v4
    buffer_load_dwordx2 v[10:11], v7, s[12:15], 0 offen
    buffer_load_dwordx2 v[12:13], v7, s[12:15], 0 offen offset:512
    buffer_load_ushort v14, v8, s[12:15], 0 offen offset:1024
    s_lshr_b32 s46, s39, 1
    s_and_b32 s46, s46, 1
    s_lshl_b32 s46, s46, 8
    s_and_b32 s47, s39, 1
    s_lshl_b32 s47, s47, 7
    s_add_u32 s46, s46, s47
    s_mul_i32 s47, s28, 64
    s_add_u32 s47, s47, 0
    v_add_u32 v3, s47, v1
    v_lshrrev_b32 v5, 4, v3
    v_lshlrev_b32 v5, 10, v5
    v_bfe_u32 v6, v3, 3, 1
    v_lshl_add_u32 v5, v6, 9, v5
    v_and_b32 v6, 7, v3
    v_lshl_add_u32 v5, v6, 4, v5
    v_add_u32 v40, s46, v5
    v_mul_u32_u24 v5, 2336, v6
    v_lshrrev_b32 v6, 3, v3
    v_lshl_add_u32 v5, v6, 5, v5
    v_add_u32 v42, 0x22000, v5
    s_mul_i32 s47, s28, 8
    s_add_u32 s47, s47, 512
    v_add_u32 v3, s47, v1
    v_lshrrev_b32 v5, 4, v3
    v_lshlrev_b32 v5, 10, v5
    v_bfe_u32 v6, v3, 3, 1
    v_lshl_add_u32 v5, v6, 9, v5
    v_and_b32 v6, 7, v3
    v_lshl_add_u32 v5, v6, 4, v5
    v_add_u32 v41, s46, v5
    v_mul_u32_u24 v5, 2336, v6
    v_lshrrev_b32 v6, 3, v3
    v_lshl_add_u32 v5, v6, 5, v5
    v_add_u32 v43, 0x22000, v5
    v_mov_b32 v48, 1
    v_mov_b32 v49, 1
    v_mov_b32 v50, 1
    v_mov_b32 v51, 1
    v_mov_b32 v56, 1
    v_mov_b32 v57, 1
    v_mov_b32 v58, 1
    v_mov_b32 v59, 1
    v_mov_b32 v64, 1
    v_mov_b32 v65, 1
    v_mov_b32 v66, 1
    v_mov_b32 v67, 1
    v_mov_b32 v72, 1
    v_mov_b32 v73, 1
    v_mov_b32 v74, 1
    v_mov_b32 v75, 1
    s_mov_b32 s45, 0
LW_rompt_kernel_14:
    s_mov_b32 s47, 0x0
    buffer_load_dwordx4 v[44:47], v40, s[20:23], s47 offen sc0 sc1
    s_mov_b64 exec, 0xff
    buffer_load_dwordx4 v[48:51], v41, s[20:23], s47 offen sc0 sc1
    s_mov_b64 exec, -1
    s_mov_b32 s47, 0x240000
    buffer_load_dwordx4 v[52:55], v40, s[20:23], s47 offen sc0 sc1
    s_mov_b64 exec, 0xff
    buffer_load_dwordx4 v[56:59], v41, s[20:23], s47 offen sc0 sc1
    s_mov_b64 exec, -1
    s_mov_b32 s47, 0x480000
    buffer_load_dwordx4 v[60:63], v40, s[20:23], s47 offen sc0 sc1
    s_mov_b64 exec, 0xff
    buffer_load_dwordx4 v[64:67], v41, s[20:23], s47 offen sc0 sc1
    s_mov_b64 exec, -1
    s_mov_b32 s47, 0x6c0000
    buffer_load_dwordx4 v[68:71], v40, s[20:23], s47 offen sc0 sc1
    s_mov_b64 exec, 0xff
    buffer_load_dwordx4 v[72:75], v41, s[20:23], s47 offen sc0 sc1
    s_mov_b64 exec, -1
    s_waitcnt vmcnt(0)
    v_and_b32 v26, v44, v46
    v_and_b32 v27, v48, v50
    v_and_b32 v26, v26, v52
    v_and_b32 v27, v27, v54
    v_and_b32 v26, v26, v56
    v_and_b32 v27, v27, v58
    v_and_b32 v26, v26, v60
    v_and_b32 v27, v27, v62
    v_and_b32 v26, v26, v64
    v_and_b32 v27, v27, v66
    v_and_b32 v26, v26, v68
    v_and_b32 v27, v27, v70
    v_and_b32 v26, v26, v72
    v_and_b32 v27, v27, v74
    v_and_b32 v26, v26, v27
    v_and_b32 v26, 1, v26
    v_cmp_ne_u32 vcc, 1, v26
    s_nop 3
    s_cmp_eq_u64 vcc, 0
    s_cbranch_scc1 LD_rompt_kernel_15
    s_add_u32 s45, s45, 1
    s_cmp_lt_u32 s45, 0x100000
    s_cbranch_scc1 LW_rompt_kernel_14
LD_rompt_kernel_15:
    v_lshlrev_b32 v76, 16, v44
    v_and_b32 v77, 0xffff0000, v44
    v_lshlrev_b32 v78, 16, v45
    v_and_b32 v79, 0xffff0000, v45
    v_lshlrev_b32 v80, 16, v46
    v_and_b32 v81, 0xffff0000, v46
    v_lshlrev_b32 v82, 16, v47
    v_and_b32 v83, 0xffff0000, v47
    v_lshlrev_b32 v84, 16, v48
    v_and_b32 v85, 0xffff0000, v48
    v_lshlrev_b32 v86, 16, v49
    v_and_b32 v87, 0xffff0000, v49
    v_lshlrev_b32 v88, 16, v50
    v_and_b32 v89, 0xffff0000, v50
    v_lshlrev_b32 v90, 16, v51
    v_and_b32 v91, 0xffff0000, v51
    v_lshlrev_b32 v26, 16, v52
    v_and_b32 v27, 0xffff0000, v52
    v_add_f32 v76, v76, v26
    v_add_f32 v77, v77, v27
    v_lshlrev_b32 v26, 16, v53
    v_and_b32 v27, 0xffff0000, v53
    v_add_f32 v78, v78, v26
    v_add_f32 v79, v79, v27
    v_lshlrev_b32 v26, 16, v54
    v_and_b32 v27, 0xffff0000, v54
    v_add_f32 v80, v80, v26
    v_add_f32 v81, v81, v27
    v_lshlrev_b32 v26, 16, v55
    v_and_b32 v27, 0xffff0000, v55
    v_add_f32 v82, v82, v26
    v_add_f32 v83, v83, v27
    v_lshlrev_b32 v26, 16, v56
    v_and_b32 v27, 0xffff0000, v56
    v_add_f32 v84, v84, v26
    v_add_f32 v85, v85, v27
    v_lshlrev_b32 v26, 16, v57
    v_and_b32 v27, 0xffff0000, v57
    v_add_f32 v86, v86, v26
    v_add_f32 v87, v87, v27
    v_lshlrev_b32 v26, 16, v58
    v_and_b32 v27, 0xffff0000, v58
    v_add_f32 v88, v88, v26
    v_add_f32 v89, v89, v27
    v_lshlrev_b32 v26, 16, v59
    v_and_b32 v27, 0xffff0000, v59
    v_add_f32 v90, v90, v26
    v_add_f32 v91, v91, v27
    v_lshlrev_b32 v26, 16, v60
    v_and_b32 v27, 0xffff0000, v60
    v_add_f32 v76, v76, v26
    v_add_f32 v77, v77, v27
    v_lshlrev_b32 v26, 16, v61
    v_and_b32 v27, 0xffff0000, v61
    v_add_f32 v78, v78, v26
    v_add_f32 v79, v79, v27
    v_lshlrev_b32 v26, 16, v62
    v_and_b32 v27, 0xffff0000, v62
    v_add_f32 v80, v80, v26
    v_add_f32 v81, v81, v27
    v_lshlrev_b32 v26, 16, v63
    v_and_b32 v27, 0xffff0000, v63
    v_add_f32 v82, v82, v26
    v_add_f32 v83, v83, v27
    v_lshlrev_b32 v26, 16, v64
    v_and_b32 v27, 0xffff0000, v64
    v_add_f32 v84, v84, v26
    v_add_f32 v85, v85, v27
    v_lshlrev_b32 v26, 16, v65
    v_and_b32 v27, 0xffff0000, v65
    v_add_f32 v86, v86, v26
    v_add_f32 v87, v87, v27
    v_lshlrev_b32 v26, 16, v66
    v_and_b32 v27, 0xffff0000, v66
    v_add_f32 v88, v88, v26
    v_add_f32 v89, v89, v27
    v_lshlrev_b32 v26, 16, v67
    v_and_b32 v27, 0xffff0000, v67
    v_add_f32 v90, v90, v26
    v_add_f32 v91, v91, v27
    v_lshlrev_b32 v26, 16, v68
    v_and_b32 v27, 0xffff0000, v68
    v_add_f32 v76, v76, v26
    v_add_f32 v77, v77, v27
    v_lshlrev_b32 v26, 16, v69
    v_and_b32 v27, 0xffff0000, v69
    v_add_f32 v78, v78, v26
    v_add_f32 v79, v79, v27
    v_lshlrev_b32 v26, 16, v70
    v_and_b32 v27, 0xffff0000, v70
    v_add_f32 v80, v80, v26
    v_add_f32 v81, v81, v27
    v_lshlrev_b32 v26, 16, v71
    v_and_b32 v27, 0xffff0000, v71
    v_add_f32 v82, v82, v26
    v_add_f32 v83, v83, v27
    v_lshlrev_b32 v26, 16, v72
    v_and_b32 v27, 0xffff0000, v72
    v_add_f32 v84, v84, v26
    v_add_f32 v85, v85, v27
    v_lshlrev_b32 v26, 16, v73
    v_and_b32 v27, 0xffff0000, v73
    v_add_f32 v86, v86, v26
    v_add_f32 v87, v87, v27
    v_lshlrev_b32 v26, 16, v74
    v_and_b32 v27, 0xffff0000, v74
    v_add_f32 v88, v88, v26
    v_add_f32 v89, v89, v27
    v_lshlrev_b32 v26, 16, v75
    v_and_b32 v27, 0xffff0000, v75
    v_add_f32 v90, v90, v26
    v_add_f32 v91, v91, v27
    ds_write_b128 v42, v[76:79]
    ds_write_b128 v42, v[80:83] offset:16
    s_mov_b64 exec, 0xff
    ds_write_b128 v43, v[84:87]
    ds_write_b128 v43, v[88:91] offset:16
    s_mov_b64 exec, -1
    s_mul_i32 s47, s28, 2336
    s_add_u32 s47, s47, 0x22000
    v_lshl_add_u32 v5, v1, 4, s47
    v_lshl_add_u32 v6, v1, 2, s47
    s_waitcnt lgkmcnt(0)
    s_barrier
    ds_read_b128 v[16:19], v5
    ds_read_b128 v[20:23], v5 offset:1024
    ds_read_b32 v24, v6 offset:2048
    s_waitcnt lgkmcnt(0)
    v_lshlrev_b32 v30, 16, v10
    v_and_b32 v31, 0xffff0000, v10
    v_lshlrev_b32 v32, 16, v11
    v_and_b32 v33, 0xffff0000, v11
    v_lshlrev_b32 v34, 16, v12
    v_and_b32 v35, 0xffff0000, v12
    v_lshlrev_b32 v36, 16, v13
    v_and_b32 v37, 0xffff0000, v13
    v_lshlrev_b32 v38, 16, v14
    v_add_f32 v30, v30, v16
    v_add_f32 v31, v31, v17
    v_add_f32 v32, v32, v18
    v_add_f32 v33, v33, v19
    v_add_f32 v34, v34, v20
    v_add_f32 v35, v35, v21
    v_add_f32 v36, v36, v22
    v_add_f32 v37, v37, v23
    v_add_f32 v38, v38, v24
    v_cvt_pk_bf16_f32 v10, v30, v31
    v_cvt_pk_bf16_f32 v11, v32, v33
    v_cvt_pk_bf16_f32 v12, v34, v35
    v_cvt_pk_bf16_f32 v13, v36, v37
    v_cvt_pk_bf16_f32 v14, v38, v38
    buffer_store_dwordx2 v[10:11], v7, s[24:27], 0 offen sc0 sc1
    buffer_store_dwordx2 v[12:13], v7, s[24:27], 0 offen offset:512 sc0 sc1
    buffer_store_short v14, v8, s[24:27], 0 offen offset:1024 sc0 sc1
    v_lshlrev_b32 v30, 16, v10
    v_and_b32 v31, 0xffff0000, v10
    v_lshlrev_b32 v32, 16, v11
    v_and_b32 v33, 0xffff0000, v11
    v_lshlrev_b32 v34, 16, v12
    v_and_b32 v35, 0xffff0000, v12
    v_lshlrev_b32 v36, 16, v13
    v_and_b32 v37, 0xffff0000, v13
    v_lshlrev_b32 v38, 16, v14
    v_add_f32 v20, v30, v31
    v_add_f32 v21, v32, v33
    v_add_f32 v22, v34, v35
    v_add_f32 v23, v36, v37
    v_add_f32 v20, v20, v21
    v_add_f32 v22, v22, v23
    v_add_f32 v20, v20, v38
    v_add_f32 v20, v20, v22
    s_nop 1
    v_add_f32_dpp v20, v20, v20 quad_perm:[1,0,3,2] row_mask:0xf bank_mask:0xf
    s_nop 1
    v_add_f32_dpp v20, v20, v20 quad_perm:[2,3,0,1] row_mask:0xf bank_mask:0xf
    s_nop 1
    v_add_f32_dpp v20, v20, v20 row_half_mirror row_mask:0xf bank_mask:0xf
    s_nop 1
    v_add_f32_dpp v20, v20, v20 row_mirror row_mask:0xf bank_mask:0xf
    s_nop 1
    v_readlane_b32 s32, v20, 0
    v_readlane_b32 s33, v20, 16
    v_readlane_b32 s34, v20, 32
    v_readlane_b32 s35, v20, 48
    s_nop 1
    v_mov_b32 v20, s32
    v_add_f32 v20, s33, v20
    v_add_f32 v20, s34, v20
    v_add_f32 v20, s35, v20
    v_mul_f32 v20, 0x3ae38e39, v20
    v_cvt_pk_bf16_f32 v23, v20, v20
    v_lshlrev_b32 v23, 16, v23
    v_sub_f32 v20, v20, v23
    v_sub_f32 v30, v30, v23
    v_sub_f32 v31, v31, v23
    v_sub_f32 v32, v32, v23
    v_sub_f32 v33, v33, v23
    v_sub_f32 v34, v34, v23
    v_sub_f32 v35, v35, v23
    v_sub_f32 v36, v36, v23
    v_sub_f32 v37, v37, v23
    v_sub_f32 v38, v38, v23
    v_mul_f32 v21, v30, v30
    v_mul_f32 v22, v31, v31
    v_fmac_f32 v21, v32, v32
    v_fmac_f32 v22, v33, v33
    v_fmac_f32 v21, v34, v34
    v_fmac_f32 v22, v35, v35
    v_fmac_f32 v21, v36, v36
    v_fmac_f32 v22, v37, v37
    v_fmac_f32 v21, v38, v38
    v_add_f32 v21, v21, v22
    s_nop 1
    v_add_f32_dpp v21, v21, v21 quad_perm:[1,0,3,2] row_mask:0xf bank_mask:0xf
    s_nop 1
    v_add_f32_dpp v21, v21, v21 quad_perm:[2,3,0,1] row_mask:0xf bank_mask:0xf
    s_nop 1
    v_add_f32_dpp v21, v21, v21 row_half_mirror row_mask:0xf bank_mask:0xf
    s_nop 1
    v_add_f32_dpp v21, v21, v21 row_mirror row_mask:0xf bank_mask:0xf
    s_nop 1
    v_readlane_b32 s32, v21, 0
    v_readlane_b32 s33, v21, 16
    v_readlane_b32 s34, v21, 32
    v_readlane_b32 s35, v21, 48
    s_nop 1
    v_mov_b32 v21, s32
    v_add_f32 v21, s33, v21
    v_add_f32 v21, s34, v21
    v_add_f32 v21, s35, v21
    v_mul_f32 v21, 0x3ae38e39, v21
    v_fma_f32 v21, -v20, v20, v21
    v_max_f32 v21, 0, v21
    v_cvt_pk_bf16_f32 v22, v21, v21
    v_lshlrev_b32 v22, 16, v22
    v_add_f32 v22, 0x3727c5ac, v22
    v_cvt_pk_bf16_f32 v22, v22, v22
    v_lshlrev_b32 v22, 16, v22
    v_sqrt_f32 v22, v22
    v_cvt_pk_bf16_f32 v24, v30, v31
    v_cvt_pk_bf16_f32 v25, v32, v33
    v_cvt_pk_bf16_f32 v26, v34, v35
    v_cvt_pk_bf16_f32 v27, v36, v37
    v_cvt_pk_bf16_f32 v28, v38, v38
    v_cvt_pk_bf16_f32 v22, v22, v22
    v_lshlrev_b32 v22, 16, v22
    v_rcp_f32 v22, v22
    v_lshlrev_b32 v30, 16, v24
    v_and_b32 v31, 0xffff0000, v24
    v_lshlrev_b32 v32, 16, v25
    v_and_b32 v33, 0xffff0000, v25
    v_lshlrev_b32 v34, 16, v26
    v_and_b32 v35, 0xffff0000, v26
    v_lshlrev_b32 v36, 16, v27
    v_and_b32 v37, 0xffff0000, v27
    v_lshlrev_b32 v38, 16, v28
    v_mul_f32 v30, v30, v22
    v_mul_f32 v31, v31, v22
    v_mul_f32 v32, v32, v22
    v_mul_f32 v33, v33, v22
    v_mul_f32 v34, v34, v22
    v_mul_f32 v35, v35, v22
    v_mul_f32 v36, v36, v22
    v_mul_f32 v37, v37, v22
    v_mul_f32 v38, v38, v22
    v_cvt_pk_bf16_f32 v24, v30, v31
    v_cvt_pk_bf16_f32 v25, v32, v33
    v_cvt_pk_bf16_f32 v26, v34, v35
    v_cvt_pk_bf16_f32 v27, v36, v37
    v_cvt_pk_bf16_f32 v28, v38, v38
    buffer_store_dwordx2 v[24:25], v7, s[52:55], 0 offen sc0 sc1
    buffer_store_dwordx2 v[26:27], v7, s[52:55], 0 offen offset:512 sc0 sc1
    buffer_store_short v28, v8, s[52:55], 0 offen offset:1024 sc0 sc1
    s_lshl_b32 s44, s37, 4
    s_add_u32 s44, s44, s39
    s_waitcnt vmcnt(0)
    s_barrier
    s_cmp_lg_u32 s28, 0
    s_cbranch_scc1 LPB_rompt_kernel_16
    s_add_u32 s72, s4, 0x1200400
    s_addc_u32 s73, s5, 0
    s_mov_b32 s74, 0x1c00
    s_and_b32 s73, s73, 0xffff
    s_mov_b32 s75, 0x20000
    s_mov_b64 exec, 1
    s_lshl_b32 s46, s44, 2
    v_mov_b32 v2, s46
    v_mov_b32 v3, 1
    buffer_store_dword v3, v2, s[72:75], 0 offen sc0 sc1
    s_mov_b64 exec, -1
LPB_rompt_kernel_16:
    s_load_dwordx2 s[4:5], s[0:1], 88
    s_load_dwordx4 s[8:11], s[0:1], 48
    s_load_dwordx2 s[56:57], s[0:1], 64
    v_and_b32 v1, 63, v0
    v_lshrrev_b32 v2, 6, v0
    s_nop 0
    v_readfirstlane_b32 s28, v2
    s_and_b32 s34, s2, 7
    s_lshr_b32 s35, s2, 3
    s_lshl_b32 s38, s34, 2
    s_and_b32 s36, s35, 3
    s_add_u32 s38, s38, s36
    s_lshr_b32 s37, s35, 2
    s_lshl_b32 s29, s28, 10
    s_and_b32 s44, s28, 3
    s_lshl_b32 s30, s44, 8
    s_lshr_b32 s45, s28, 2
    s_mul_i32 s45, s45, 9216
    s_add_u32 s30, s30, s45
    v_lshrrev_b32 v2, 2, v1
    s_lshl_b32 s33, s28, 4
    v_add_u32 v2, s33, v2
    v_lshrrev_b32 v3, 2, v2
    v_sub_u32 v3, 0, v3
    v_xor_b32 v3, v3, v1
    v_and_b32 v3, 3, v3
    v_mul_u32_u24 v8, 1152, v2
    v_lshl_add_u32 v8, v3, 4, v8
    s_lshl_b32 s33, s28, 6
    v_add_u32 v2, s33, v1
    v_mul_u32_u24 v3, 3641, v2
    v_lshrrev_b32 v3, 16, v3
    v_mul_u32_u24 v4, 18, v3
    v_sub_u32 v4, v2, v4
    v_and_b32 v5, 0x13, v3
    v_and_b32 v6, 4, v3
    v_lshl_or_b32 v5, v6, 1, v5
    v_and_b32 v6, 8, v3
    v_lshrrev_b32 v6, 1, v6
    v_or_b32 v5, v5, v6
    v_mul_u32_u24 v9, 9216, v5
    v_lshl_add_u32 v9, v4, 4, v9
    s_lshl_b32 s33, s44, 4
    s_add_u32 s33, s33, 512
    v_add_u32 v2, s33, v1
    v_mul_u32_u24 v3, 3641, v2
    v_lshrrev_b32 v3, 16, v3
    v_mul_u32_u24 v4, 18, v3
    v_sub_u32 v4, v2, v4
    v_and_b32 v5, 0x13, v3
    v_and_b32 v6, 4, v3
    v_lshl_or_b32 v5, v6, 1, v5
    v_and_b32 v6, 8, v3
    v_lshrrev_b32 v6, 1, v6
    v_or_b32 v5, v5, v6
    v_mul_u32_u24 v10, 9216, v5
    v_lshl_add_u32 v10, v4, 4, v10
    s_mov_b32 s31, 0
    s_mov_b32 s32, 0
    s_waitcnt lgkmcnt(0)
    s_mul_i32 s44, s37, 294912
    s_add_u32 s12, s4, 0x0
    s_addc_u32 s13, s5, 0
    s_add_u32 s12, s12, s44
    s_addc_u32 s13, s13, 0
    s_sub_u32 s14, 0x240000, s44
    s_and_b32 s13, s13, 0xffff
    s_mov_b32 s15, 0x20000
    s_mul_i32 s44, s38, 288
    s_add_u32 s16, s8, 0x0
    s_addc_u32 s17, s9, 0
    s_add_u32 s16, s16, s44
    s_addc_u32 s17, s17, 0
    s_sub_u32 s18, 0x510000, s44
    s_and_b32 s17, s17, 0xffff
    s_mov_b32 s19, 0x20000
    s_add_u32 s20, s10, 0x0
    s_addc_u32 s21, s11, 0
    s_add_u32 s20, s20, s44
    s_addc_u32 s21, s21, 0
    s_sub_u32 s22, 0x510000, s44
    s_and_b32 s21, s21, 0xffff
    s_mov_b32 s23, 0x20000
    s_cmp_lt_u32 s28, 4
    s_cselect_b32 s40, s16, s20
    s_cselect_b32 s41, s17, s21
    s_cselect_b32 s42, s18, s22
    s_mov_b32 s43, 0x20000
    s_add_u32 m0, s29, 0x4000
    s_nop 0
    buffer_load_dwordx4 v9, s[16:19], s32 offen lds
    s_add_u32 m0, s29, 0x6400
    s_nop 0
    buffer_load_dwordx4 v9, s[20:23], s32 offen lds
    s_add_u32 m0, s30, 0x6000
    s_mov_b64 exec, 0xffff
    buffer_load_dwordx4 v10, s[40:43], s32 offen lds
    s_mov_b64 exec, -1
    s_add_u32 s32, s32, 0x48000
    s_add_u32 m0, s29, 0xc800
    s_nop 0
    buffer_load_dwordx4 v9, s[16:19], s32 offen lds
    s_add_u32 m0, s29, 0xec00
    s_nop 0
    buffer_load_dwordx4 v9, s[20:23], s32 offen lds
    s_add_u32 m0, s30, 0xe800
    s_mov_b64 exec, 0xffff
    buffer_load_dwordx4 v10, s[40:43], s32 offen lds
    s_mov_b64 exec, -1
    s_add_u32 s32, s32, 0x48000
    s_add_u32 m0, s29, 0x15000
    s_nop 0
    buffer_load_dwordx4 v9, s[16:19], s32 offen lds
    s_add_u32 m0, s29, 0x17400
    s_nop 0
    buffer_load_dwordx4 v9, s[20:23], s32 offen lds
    s_add_u32 m0, s30, 0x17000
    s_mov_b64 exec, 0xffff
    buffer_load_dwordx4 v10, s[40:43], s32 offen lds
    s_mov_b64 exec, -1
    s_add_u32 s32, s32, 0x48000
    s_lshl_b32 s44, s37, 5
    v_add_u32 v2, s44, v1
    s_cmp_lg_u32 s28, 0
    s_cbranch_scc1 LFS_rompt_kernel_17
    s_add_u32 s72, s4, 0x1200400
    s_addc_u32 s73, s5, 0
    s_mov_b32 s74, 0x1c00
    s_and_b32 s73, s73, 0xffff
    s_mov_b32 s75, 0x20000
    v_lshlrev_b32 v2, 2, v2
    s_mov_b64 exec, 0xffffffff
    s_mov_b32 s45, 0
LFW_rompt_kernel_18:
    buffer_load_dword v3, v2, s[72:75], 0 offen sc0 sc1
    s_waitcnt vmcnt(0)
    v_cmp_ne_u32 vcc, 1, v3
    s_nop 3
    s_cmp_eq_u64 vcc, 0
    s_cbranch_scc1 LFD_rompt_kernel_19
    s_add_u32 s45, s45, 1
    s_cmp_lt_u32 s45, 0x100000
    s_cbranch_scc1 LFW_rompt_kernel_18
LFD_rompt_kernel_19:
    s_mov_b64 exec, -1
LFS_rompt_kernel_17:
    s_barrier
    s_add_u32 m0, s29, 0x0
    s_nop 0
    buffer_load_dwordx4 v8, s[12:15], s31 offen lds
    s_add_u32 m0, s29, 0x2000
    s_add_u32 s33, s31, 0x24000
    buffer_load_dwordx4 v8, s[12:15], s33 offen lds
    s_add_u32 s31, s31, 64
    s_add_u32 m0, s29, 0x8800
    s_nop 0
    buffer_load_dwordx4 v8, s[12:15], s31 offen lds
    s_add_u32 m0, s29, 0xa800
    s_add_u32 s33, s31, 0x24000
    buffer_load_dwordx4 v8, s[12:15], s33 offen lds
    s_add_u32 s31, s31, 64
    s_add_u32 m0, s29, 0x11000
    s_nop 0
    buffer_load_dwordx4 v8, s[12:15], s31 offen lds
    s_add_u32 m0, s29, 0x13000
    s_add_u32 s33, s31, 0x24000
    buffer_load_dwordx4 v8, s[12:15], s33 offen lds
    s_add_u32 s31, s31, 64
    s_lshl_b32 s64, s2, 3
    s_add_u32 s64, s64, s28
    s_mul_i32 s64, s64, 8192
    s_mov_b32 s60, s56
    s_mov_b32 s61, s57
    s_mov_b32 s62, 0x510000
    s_and_b32 s61, s61, 0xffff
    s_mov_b32 s63, 0x20000
    v_mul_u32_u24 v253, 128, v1
    v_add_u32 v253, s64, v253
    v_and_b32 v2, 15, v1
    v_lshrrev_b32 v3, 4, v1
    v_lshrrev_b32 v4, 2, v2
    v_sub_u32 v4, 0, v4
    v_xor_b32 v4, v4, v3
    v_and_b32 v4, 3, v4
    v_lshlrev_b32 v4, 4, v4
    v_lshl_add_u32 v4, v2, 6, v4
    s_and_b32 s33, s28, 3
    s_lshl_b32 s33, s33, 12
    v_add_u32 v5, s33, v4
    v_add_u32 v12, 0x0, v5
    v_add_u32 v13, 0x8800, v5
    v_add_u32 v14, 0x11000, v5
    v_lshrrev_b32 v4, 5, v1
    v_lshlrev_b32 v4, 4, v4
    v_bfe_u32 v5, v1, 4, 1
    v_lshl_add_u32 v4, v5, 2, v4
    v_bfe_u32 v5, v1, 2, 2
    v_add_u32 v4, v4, v5
    v_mul_u32_u24 v4, 288, v4
    v_and_b32 v5, 3, v1
    v_lshl_add_u32 v4, v5, 3, v4
    v_add_u32 v16, 0x4000, v4
    v_add_u32 v17, 0xc800, v4
    v_add_u32 v18, 0x15000, v4
    s_lshl_b32 s44, s37, 3
    s_and_b32 s46, s28, 3
    s_lshl_b32 s46, s46, 1
    s_add_u32 s44, s44, s46
    s_mul_i32 s44, s44, 288
    s_mul_i32 s46, s38, 9
    s_add_u32 s44, s44, s46
    s_lshl_b32 s44, s44, 10
    s_add_u32 s24, s4, 0x3000000
    s_addc_u32 s25, s5, 0
    s_add_u32 s24, s24, s44
    s_addc_u32 s25, s25, 0
    s_sub_u32 s26, 0x1200000, s44
    s_and_b32 s25, s25, 0xffff
    s_mov_b32 s27, 0x20000
    v_lshlrev_b32 v7, 4, v1
    s_mov_b32 s46, 0xbfb8aa3b
    s_mov_b32 s47, s46
    s_waitcnt vmcnt(4)
    s_barrier
    s_cmp_ge_u32 s28, 4
    s_cbranch_scc1 LG_rompt_kernel_21
    ds_read_b128 v[60:63], v12 offset:0
    ds_read_b128 v[64:67], v12 offset:1024
    ds_read_b128 v[68:71], v12 offset:2048
    ds_read_b128 v[72:75], v12 offset:3072
    ds_read_b64_tr_b16 v[20:21], v16 offset:0
    ds_read_b64_tr_b16 v[22:23], v16 offset:2304
    ds_read_b64_tr_b16 v[24:25], v16 offset:9216
    ds_read_b64_tr_b16 v[26:27], v16 offset:11520
    ds_read_b64_tr_b16 v[28:29], v16 offset:32
    ds_read_b64_tr_b16 v[30:31], v16 offset:2336
    ds_read_b64_tr_b16 v[32:33], v16 offset:9248
    ds_read_b64_tr_b16 v[34:35], v16 offset:11552
    ds_read_b64_tr_b16 v[36:37], v16 offset:64
    ds_read_b64_tr_b16 v[38:39], v16 offset:2368
    ds_read_b64_tr_b16 v[40:41], v16 offset:9280
    s_waitcnt lgkmcnt(13)
    ds_read_b64_tr_b16 v[42:43], v16 offset:11584
    ds_read_b64_tr_b16 v[44:45], v16 offset:96
    s_waitcnt lgkmcnt(13)
    ds_read_b64_tr_b16 v[46:47], v16 offset:2400
    ds_read_b64_tr_b16 v[48:49], v16 offset:9312
    s_waitcnt lgkmcnt(13)
    ds_read_b64_tr_b16 v[50:51], v16 offset:11616
    v_mfma_f32_16x16x32_bf16 v[92:95], v[20:23], v[60:63], 0
    v_mfma_f32_16x16x32_bf16 v[96:99], v[20:23], v[64:67], 0
    v_mfma_f32_16x16x32_bf16 v[100:103], v[20:23], v[68:71], 0
    v_mfma_f32_16x16x32_bf16 v[104:107], v[20:23], v[72:75], 0
    ds_read_b64_tr_b16 v[52:53], v16 offset:128
    s_waitcnt lgkmcnt(13)
    ds_read_b64_tr_b16 v[54:55], v16 offset:2432
    v_mfma_f32_16x16x32_bf16 v[108:111], v[24:27], v[60:63], 0
    v_mfma_f32_16x16x32_bf16 v[112:115], v[24:27], v[64:67], 0
    v_mfma_f32_16x16x32_bf16 v[116:119], v[24:27], v[68:71], 0
    v_mfma_f32_16x16x32_bf16 v[120:123], v[24:27], v[72:75], 0
    ds_read_b64_tr_b16 v[56:57], v16 offset:9344
    s_waitcnt lgkmcnt(13)
    ds_read_b64_tr_b16 v[58:59], v16 offset:11648
    v_mfma_f32_16x16x32_bf16 v[124:127], v[28:31], v[60:63], 0
    v_mfma_f32_16x16x32_bf16 v[128:131], v[28:31], v[64:67], 0
    v_mfma_f32_16x16x32_bf16 v[132:135], v[28:31], v[68:71], 0
    v_mfma_f32_16x16x32_bf16 v[136:139], v[28:31], v[72:75], 0
    s_waitcnt lgkmcnt(12)
    v_mfma_f32_16x16x32_bf16 v[140:143], v[32:35], v[60:63], 0
    v_mfma_f32_16x16x32_bf16 v[144:147], v[32:35], v[64:67], 0
    v_mfma_f32_16x16x32_bf16 v[148:151], v[32:35], v[68:71], 0
    v_mfma_f32_16x16x32_bf16 v[152:155], v[32:35], v[72:75], 0
    s_waitcnt vmcnt(2) lgkmcnt(0)
    s_barrier
    ds_read_b128 v[76:79], v13 offset:0
    ds_read_b128 v[80:83], v13 offset:1024
    ds_read_b128 v[84:87], v13 offset:2048
    s_add_u32 m0, s29, 0x0
    s_nop 0
    buffer_load_dwordx4 v8, s[12:15], s31 offen lds
    v_mfma_f32_16x16x32_bf16 v[156:159], v[36:39], v[60:63], 0
    v_mfma_f32_16x16x32_bf16 v[160:163], v[36:39], v[64:67], 0
    v_mfma_f32_16x16x32_bf16 v[164:167], v[36:39], v[68:71], 0
    v_mfma_f32_16x16x32_bf16 v[168:171], v[36:39], v[72:75], 0
    ds_read_b128 v[88:91], v13 offset:3072
    ds_read_b64_tr_b16 v[20:21], v17 offset:0
    ds_read_b64_tr_b16 v[22:23], v17 offset:2304
    s_add_u32 m0, s29, 0x2000
    s_add_u32 s33, s31, 0x24000
    buffer_load_dwordx4 v8, s[12:15], s33 offen lds
    s_add_u32 s31, s31, 64
    v_mfma_f32_16x16x32_bf16 v[172:175], v[40:43], v[60:63], 0
    v_mfma_f32_16x16x32_bf16 v[176:179], v[40:43], v[64:67], 0
    v_mfma_f32_16x16x32_bf16 v[180:183], v[40:43], v[68:71], 0
    v_mfma_f32_16x16x32_bf16 v[184:187], v[40:43], v[72:75], 0
    ds_read_b64_tr_b16 v[24:25], v17 offset:9216
    ds_read_b64_tr_b16 v[26:27], v17 offset:11520
    ds_read_b64_tr_b16 v[28:29], v17 offset:32
    ds_read_b64_tr_b16 v[30:31], v17 offset:2336
    s_add_u32 m0, s29, 0x4000
    s_nop 0
    buffer_load_dwordx4 v9, s[16:19], s32 offen lds
    v_mfma_f32_16x16x32_bf16 v[188:191], v[44:47], v[60:63], 0
    v_mfma_f32_16x16x32_bf16 v[192:195], v[44:47], v[64:67], 0
    v_mfma_f32_16x16x32_bf16 v[196:199], v[44:47], v[68:71], 0
    v_mfma_f32_16x16x32_bf16 v[200:203], v[44:47], v[72:75], 0
    ds_read_b64_tr_b16 v[32:33], v17 offset:9248
    ds_read_b64_tr_b16 v[34:35], v17 offset:11552
    ds_read_b64_tr_b16 v[36:37], v17 offset:64
    ds_read_b64_tr_b16 v[38:39], v17 offset:2368
    s_add_u32 m0, s29, 0x6400
    s_nop 0
    buffer_load_dwordx4 v9, s[20:23], s32 offen lds
    v_mfma_f32_16x16x32_bf16 v[204:207], v[48:51], v[60:63], 0
    v_mfma_f32_16x16x32_bf16 v[208:211], v[48:51], v[64:67], 0
    v_mfma_f32_16x16x32_bf16 v[212:215], v[48:51], v[68:71], 0
    v_mfma_f32_16x16x32_bf16 v[216:219], v[48:51], v[72:75], 0
    ds_read_b64_tr_b16 v[40:41], v17 offset:9280
    s_waitcnt lgkmcnt(13)
    ds_read_b64_tr_b16 v[42:43], v17 offset:11584
    s_add_u32 m0, s30, 0x6000
    s_mov_b64 exec, 0xffff
    buffer_load_dwordx4 v10, s[40:43], s32 offen lds
    s_mov_b64 exec, -1
    s_add_u32 s32, s32, 0x48000
    v_mfma_f32_16x16x32_bf16 v[220:223], v[52:55], v[60:63], 0
    v_mfma_f32_16x16x32_bf16 v[224:227], v[52:55], v[64:67], 0
    v_mfma_f32_16x16x32_bf16 v[228:231], v[52:55], v[68:71], 0
    v_mfma_f32_16x16x32_bf16 v[232:235], v[52:55], v[72:75], 0
    ds_read_b64_tr_b16 v[44:45], v17 offset:96
    s_waitcnt lgkmcnt(13)
    ds_read_b64_tr_b16 v[46:47], v17 offset:2400
    v_mfma_f32_16x16x32_bf16 v[236:239], v[56:59], v[60:63], 0
    v_mfma_f32_16x16x32_bf16 v[240:243], v[56:59], v[64:67], 0
    v_mfma_f32_16x16x32_bf16 v[244:247], v[56:59], v[68:71], 0
    v_mfma_f32_16x16x32_bf16 v[248:251], v[56:59], v[72:75], 0
    ds_read_b64_tr_b16 v[48:49], v17 offset:9312
    s_waitcnt lgkmcnt(13)
    ds_read_b64_tr_b16 v[50:51], v17 offset:11616
    v_mfma_f32_16x16x32_bf16 v[92:95], v[20:23], v[76:79], v[92:95]
    v_mfma_f32_16x16x32_bf16 v[96:99], v[20:23], v[80:83], v[96:99]
    v_mfma_f32_16x16x32_bf16 v[100:103], v[20:23], v[84:87], v[100:103]
    v_mfma_f32_16x16x32_bf16 v[104:107], v[20:23], v[88:91], v[104:107]
    ds_read_b64_tr_b16 v[52:53], v17 offset:128
    s_waitcnt lgkmcnt(13)
    ds_read_b64_tr_b16 v[54:55], v17 offset:2432
    v_mfma_f32_16x16x32_bf16 v[108:111], v[24:27], v[76:79], v[108:111]
    v_mfma_f32_16x16x32_bf16 v[112:115], v[24:27], v[80:83], v[112:115]
    v_mfma_f32_16x16x32_bf16 v[116:119], v[24:27], v[84:87], v[116:119]
    v_mfma_f32_16x16x32_bf16 v[120:123], v[24:27], v[88:91], v[120:123]
    ds_read_b64_tr_b16 v[56:57], v17 offset:9344
    s_waitcnt lgkmcnt(13)
    ds_read_b64_tr_b16 v[58:59], v17 offset:11648
    v_mfma_f32_16x16x32_bf16 v[124:127], v[28:31], v[76:79], v[124:127]
    v_mfma_f32_16x16x32_bf16 v[128:131], v[28:31], v[80:83], v[128:131]
    v_mfma_f32_16x16x32_bf16 v[132:135], v[28:31], v[84:87], v[132:135]
    v_mfma_f32_16x16x32_bf16 v[136:139], v[28:31], v[88:91], v[136:139]
    s_waitcnt lgkmcnt(12)
    v_mfma_f32_16x16x32_bf16 v[140:143], v[32:35], v[76:79], v[140:143]
    v_mfma_f32_16x16x32_bf16 v[144:147], v[32:35], v[80:83], v[144:147]
    v_mfma_f32_16x16x32_bf16 v[148:151], v[32:35], v[84:87], v[148:151]
    v_mfma_f32_16x16x32_bf16 v[152:155], v[32:35], v[88:91], v[152:155]
    s_waitcnt vmcnt(5) lgkmcnt(0)
    s_barrier
    ds_read_b128 v[60:63], v14 offset:0
    ds_read_b128 v[64:67], v14 offset:1024
    ds_read_b128 v[68:71], v14 offset:2048
    s_add_u32 m0, s29, 0x8800
    s_nop 0
    buffer_load_dwordx4 v8, s[12:15], s31 offen lds
    v_mfma_f32_16x16x32_bf16 v[156:159], v[36:39], v[76:79], v[156:159]
    v_mfma_f32_16x16x32_bf16 v[160:163], v[36:39], v[80:83], v[160:163]
    v_mfma_f32_16x16x32_bf16 v[164:167], v[36:39], v[84:87], v[164:167]
    v_mfma_f32_16x16x32_bf16 v[168:171], v[36:39], v[88:91], v[168:171]
    ds_read_b128 v[72:75], v14 offset:3072
    ds_read_b64_tr_b16 v[20:21], v18 offset:0
    ds_read_b64_tr_b16 v[22:23], v18 offset:2304
    s_add_u32 m0, s29, 0xa800
    s_add_u32 s33, s31, 0x24000
    buffer_load_dwordx4 v8, s[12:15], s33 offen lds
    s_add_u32 s31, s31, 64
    v_mfma_f32_16x16x32_bf16 v[172:175], v[40:43], v[76:79], v[172:175]
    v_mfma_f32_16x16x32_bf16 v[176:179], v[40:43], v[80:83], v[176:179]
    v_mfma_f32_16x16x32_bf16 v[180:183], v[40:43], v[84:87], v[180:183]
    v_mfma_f32_16x16x32_bf16 v[184:187], v[40:43], v[88:91], v[184:187]
    ds_read_b64_tr_b16 v[24:25], v18 offset:9216
    ds_read_b64_tr_b16 v[26:27], v18 offset:11520
    ds_read_b64_tr_b16 v[28:29], v18 offset:32
    ds_read_b64_tr_b16 v[30:31], v18 offset:2336
    s_add_u32 m0, s29, 0xc800
    s_nop 0
    buffer_load_dwordx4 v9, s[16:19], s32 offen lds
    v_mfma_f32_16x16x32_bf16 v[188:191], v[44:47], v[76:79], v[188:191]
    v_mfma_f32_16x16x32_bf16 v[192:195], v[44:47], v[80:83], v[192:195]
    v_mfma_f32_16x16x32_bf16 v[196:199], v[44:47], v[84:87], v[196:199]
    v_mfma_f32_16x16x32_bf16 v[200:203], v[44:47], v[88:91], v[200:203]
    ds_read_b64_tr_b16 v[32:33], v18 offset:9248
    ds_read_b64_tr_b16 v[34:35], v18 offset:11552
    ds_read_b64_tr_b16 v[36:37], v18 offset:64
    ds_read_b64_tr_b16 v[38:39], v18 offset:2368
    s_add_u32 m0, s29, 0xec00
    s_nop 0
    buffer_load_dwordx4 v9, s[20:23], s32 offen lds
    v_mfma_f32_16x16x32_bf16 v[204:207], v[48:51], v[76:79], v[204:207]
    v_mfma_f32_16x16x32_bf16 v[208:211], v[48:51], v[80:83], v[208:211]
    v_mfma_f32_16x16x32_bf16 v[212:215], v[48:51], v[84:87], v[212:215]
    v_mfma_f32_16x16x32_bf16 v[216:219], v[48:51], v[88:91], v[216:219]
    ds_read_b64_tr_b16 v[40:41], v18 offset:9280
    s_waitcnt lgkmcnt(13)
    ds_read_b64_tr_b16 v[42:43], v18 offset:11584
    s_add_u32 m0, s30, 0xe800
    s_mov_b64 exec, 0xffff
    buffer_load_dwordx4 v10, s[40:43], s32 offen lds
    s_mov_b64 exec, -1
    s_add_u32 s32, s32, 0x48000
    v_mfma_f32_16x16x32_bf16 v[220:223], v[52:55], v[76:79], v[220:223]
    v_mfma_f32_16x16x32_bf16 v[224:227], v[52:55], v[80:83], v[224:227]
    v_mfma_f32_16x16x32_bf16 v[228:231], v[52:55], v[84:87], v[228:231]
    v_mfma_f32_16x16x32_bf16 v[232:235], v[52:55], v[88:91], v[232:235]
    ds_read_b64_tr_b16 v[44:45], v18 offset:96
    s_waitcnt lgkmcnt(13)
    ds_read_b64_tr_b16 v[46:47], v18 offset:2400
    buffer_load_dword v252, v253, s[60:63], 0 offen
    v_mfma_f32_16x16x32_bf16 v[236:239], v[56:59], v[76:79], v[236:239]
    v_mfma_f32_16x16x32_bf16 v[240:243], v[56:59], v[80:83], v[240:243]
    v_mfma_f32_16x16x32_bf16 v[244:247], v[56:59], v[84:87], v[244:247]
    v_mfma_f32_16x16x32_bf16 v[248:251], v[56:59], v[88:91], v[248:251]
    ds_read_b64_tr_b16 v[48:49], v18 offset:9312
    s_waitcnt lgkmcnt(13)
    ds_read_b64_tr_b16 v[50:51], v18 offset:11616
    v_mfma_f32_16x16x32_bf16 v[92:95], v[20:23], v[60:63], v[92:95]
    v_mfma_f32_16x16x32_bf16 v[96:99], v[20:23], v[64:67], v[96:99]
    v_mfma_f32_16x16x32_bf16 v[100:103], v[20:23], v[68:71], v[100:103]
    v_mfma_f32_16x16x32_bf16 v[104:107], v[20:23], v[72:75], v[104:107]
    ds_read_b64_tr_b16 v[52:53], v18 offset:128
    s_waitcnt lgkmcnt(13)
    ds_read_b64_tr_b16 v[54:55], v18 offset:2432
    v_mfma_f32_16x16x32_bf16 v[108:111], v[24:27], v[60:63], v[108:111]
    v_mfma_f32_16x16x32_bf16 v[112:115], v[24:27], v[64:67], v[112:115]
    v_mfma_f32_16x16x32_bf16 v[116:119], v[24:27], v[68:71], v[116:119]
    v_mfma_f32_16x16x32_bf16 v[120:123], v[24:27], v[72:75], v[120:123]
    ds_read_b64_tr_b16 v[56:57], v18 offset:9344
    s_waitcnt lgkmcnt(13)
    ds_read_b64_tr_b16 v[58:59], v18 offset:11648
    v_mfma_f32_16x16x32_bf16 v[124:127], v[28:31], v[60:63], v[124:127]
    v_mfma_f32_16x16x32_bf16 v[128:131], v[28:31], v[64:67], v[128:131]
    v_mfma_f32_16x16x32_bf16 v[132:135], v[28:31], v[68:71], v[132:135]
    v_mfma_f32_16x16x32_bf16 v[136:139], v[28:31], v[72:75], v[136:139]
    s_waitcnt lgkmcnt(12)
    v_mfma_f32_16x16x32_bf16 v[140:143], v[32:35], v[60:63], v[140:143]
    v_mfma_f32_16x16x32_bf16 v[144:147], v[32:35], v[64:67], v[144:147]
    v_mfma_f32_16x16x32_bf16 v[148:151], v[32:35], v[68:71], v[148:151]
    v_mfma_f32_16x16x32_bf16 v[152:155], v[32:35], v[72:75], v[152:155]
    s_waitcnt vmcnt(6) lgkmcnt(0)
    s_barrier
    ds_read_b128 v[76:79], v12 offset:0
    ds_read_b128 v[80:83], v12 offset:1024
    ds_read_b128 v[84:87], v12 offset:2048
    s_add_u32 m0, s29, 0x11000
    s_nop 0
    buffer_load_dwordx4 v8, s[12:15], s31 offen lds
    v_mfma_f32_16x16x32_bf16 v[156:159], v[36:39], v[60:63], v[156:159]
    v_mfma_f32_16x16x32_bf16 v[160:163], v[36:39], v[64:67], v[160:163]
    v_mfma_f32_16x16x32_bf16 v[164:167], v[36:39], v[68:71], v[164:167]
    v_mfma_f32_16x16x32_bf16 v[168:171], v[36:39], v[72:75], v[168:171]
    ds_read_b128 v[88:91], v12 offset:3072
    ds_read_b64_tr_b16 v[20:21], v16 offset:0
    ds_read_b64_tr_b16 v[22:23], v16 offset:2304
    s_add_u32 m0, s29, 0x13000
    s_add_u32 s33, s31, 0x24000
    buffer_load_dwordx4 v8, s[12:15], s33 offen lds
    s_add_u32 s31, s31, 64
    v_mfma_f32_16x16x32_bf16 v[172:175], v[40:43], v[60:63], v[172:175]
    v_mfma_f32_16x16x32_bf16 v[176:179], v[40:43], v[64:67], v[176:179]
    v_mfma_f32_16x16x32_bf16 v[180:183], v[40:43], v[68:71], v[180:183]
    v_mfma_f32_16x16x32_bf16 v[184:187], v[40:43], v[72:75], v[184:187]
    ds_read_b64_tr_b16 v[24:25], v16 offset:9216
    ds_read_b64_tr_b16 v[26:27], v16 offset:11520
    ds_read_b64_tr_b16 v[28:29], v16 offset:32
    ds_read_b64_tr_b16 v[30:31], v16 offset:2336
    s_add_u32 m0, s29, 0x15000
    s_nop 0
    buffer_load_dwordx4 v9, s[16:19], s32 offen lds
    v_mfma_f32_16x16x32_bf16 v[188:191], v[44:47], v[60:63], v[188:191]
    v_mfma_f32_16x16x32_bf16 v[192:195], v[44:47], v[64:67], v[192:195]
    v_mfma_f32_16x16x32_bf16 v[196:199], v[44:47], v[68:71], v[196:199]
    v_mfma_f32_16x16x32_bf16 v[200:203], v[44:47], v[72:75], v[200:203]
    ds_read_b64_tr_b16 v[32:33], v16 offset:9248
    ds_read_b64_tr_b16 v[34:35], v16 offset:11552
    ds_read_b64_tr_b16 v[36:37], v16 offset:64
    ds_read_b64_tr_b16 v[38:39], v16 offset:2368
    s_add_u32 m0, s29, 0x17400
    s_nop 0
    buffer_load_dwordx4 v9, s[20:23], s32 offen lds
    v_mfma_f32_16x16x32_bf16 v[204:207], v[48:51], v[60:63], v[204:207]
    v_mfma_f32_16x16x32_bf16 v[208:211], v[48:51], v[64:67], v[208:211]
    v_mfma_f32_16x16x32_bf16 v[212:215], v[48:51], v[68:71], v[212:215]
    v_mfma_f32_16x16x32_bf16 v[216:219], v[48:51], v[72:75], v[216:219]
    ds_read_b64_tr_b16 v[40:41], v16 offset:9280
    s_waitcnt lgkmcnt(13)
    ds_read_b64_tr_b16 v[42:43], v16 offset:11584
    s_add_u32 m0, s30, 0x17000
    s_mov_b64 exec, 0xffff
    buffer_load_dwordx4 v10, s[40:43], s32 offen lds
    s_mov_b64 exec, -1
    s_add_u32 s32, s32, 0x48000
    v_mfma_f32_16x16x32_bf16 v[220:223], v[52:55], v[60:63], v[220:223]
    v_mfma_f32_16x16x32_bf16 v[224:227], v[52:55], v[64:67], v[224:227]
    v_mfma_f32_16x16x32_bf16 v[228:231], v[52:55], v[68:71], v[228:231]
    v_mfma_f32_16x16x32_bf16 v[232:235], v[52:55], v[72:75], v[232:235]
    ds_read_b64_tr_b16 v[44:45], v16 offset:96
    s_waitcnt lgkmcnt(13)
    ds_read_b64_tr_b16 v[46:47], v16 offset:2400
    v_mfma_f32_16x16x32_bf16 v[236:239], v[56:59], v[60:63], v[236:239]
    v_mfma_f32_16x16x32_bf16 v[240:243], v[56:59], v[64:67], v[240:243]
    v_mfma_f32_16x16x32_bf16 v[244:247], v[56:59], v[68:71], v[244:247]
    v_mfma_f32_16x16x32_bf16 v[248:251], v[56:59], v[72:75], v[248:251]
    ds_read_b64_tr_b16 v[48:49], v16 offset:9312
    s_waitcnt lgkmcnt(13)
    ds_read_b64_tr_b16 v[50:51], v16 offset:11616
    v_mfma_f32_16x16x32_bf16 v[92:95], v[20:23], v[76:79], v[92:95]
    v_mfma_f32_16x16x32_bf16 v[96:99], v[20:23], v[80:83], v[96:99]
    v_mfma_f32_16x16x32_bf16 v[100:103], v[20:23], v[84:87], v[100:103]
    v_mfma_f32_16x16x32_bf16 v[104:107], v[20:23], v[88:91], v[104:107]
    ds_read_b64_tr_b16 v[52:53], v16 offset:128
    s_waitcnt lgkmcnt(13)
    ds_read_b64_tr_b16 v[54:55], v16 offset:2432
    v_mfma_f32_16x16x32_bf16 v[108:111], v[24:27], v[76:79], v[108:111]
    v_mfma_f32_16x16x32_bf16 v[112:115], v[24:27], v[80:83], v[112:115]
    v_mfma_f32_16x16x32_bf16 v[116:119], v[24:27], v[84:87], v[116:119]
    v_mfma_f32_16x16x32_bf16 v[120:123], v[24:27], v[88:91], v[120:123]
    ds_read_b64_tr_b16 v[56:57], v16 offset:9344
    s_waitcnt lgkmcnt(13)
    ds_read_b64_tr_b16 v[58:59], v16 offset:11648
    v_mfma_f32_16x16x32_bf16 v[124:127], v[28:31], v[76:79], v[124:127]
    v_mfma_f32_16x16x32_bf16 v[128:131], v[28:31], v[80:83], v[128:131]
    v_mfma_f32_16x16x32_bf16 v[132:135], v[28:31], v[84:87], v[132:135]
    v_mfma_f32_16x16x32_bf16 v[136:139], v[28:31], v[88:91], v[136:139]
    s_waitcnt lgkmcnt(12)
    v_mfma_f32_16x16x32_bf16 v[140:143], v[32:35], v[76:79], v[140:143]
    v_mfma_f32_16x16x32_bf16 v[144:147], v[32:35], v[80:83], v[144:147]
    v_mfma_f32_16x16x32_bf16 v[148:151], v[32:35], v[84:87], v[148:151]
    v_mfma_f32_16x16x32_bf16 v[152:155], v[32:35], v[88:91], v[152:155]
    s_waitcnt vmcnt(6) lgkmcnt(0)
    s_barrier
    ds_read_b128 v[60:63], v13 offset:0
    ds_read_b128 v[64:67], v13 offset:1024
    ds_read_b128 v[68:71], v13 offset:2048
    s_add_u32 m0, s29, 0x0
    s_nop 0
    buffer_load_dwordx4 v8, s[12:15], s31 offen lds
    v_mfma_f32_16x16x32_bf16 v[156:159], v[36:39], v[76:79], v[156:159]
    v_mfma_f32_16x16x32_bf16 v[160:163], v[36:39], v[80:83], v[160:163]
    v_mfma_f32_16x16x32_bf16 v[164:167], v[36:39], v[84:87], v[164:167]
    v_mfma_f32_16x16x32_bf16 v[168:171], v[36:39], v[88:91], v[168:171]
    ds_read_b128 v[72:75], v13 offset:3072
    ds_read_b64_tr_b16 v[20:21], v17 offset:0
    ds_read_b64_tr_b16 v[22:23], v17 offset:2304
    s_add_u32 m0, s29, 0x2000
    s_add_u32 s33, s31, 0x24000
    buffer_load_dwordx4 v8, s[12:15], s33 offen lds
    s_add_u32 s31, s31, 64
    v_mfma_f32_16x16x32_bf16 v[172:175], v[40:43], v[76:79], v[172:175]
    v_mfma_f32_16x16x32_bf16 v[176:179], v[40:43], v[80:83], v[176:179]
    v_mfma_f32_16x16x32_bf16 v[180:183], v[40:43], v[84:87], v[180:183]
    v_mfma_f32_16x16x32_bf16 v[184:187], v[40:43], v[88:91], v[184:187]
    ds_read_b64_tr_b16 v[24:25], v17 offset:9216
    ds_read_b64_tr_b16 v[26:27], v17 offset:11520
    ds_read_b64_tr_b16 v[28:29], v17 offset:32
    ds_read_b64_tr_b16 v[30:31], v17 offset:2336
    s_add_u32 m0, s29, 0x4000
    s_nop 0
    buffer_load_dwordx4 v9, s[16:19], s32 offen lds
    v_mfma_f32_16x16x32_bf16 v[188:191], v[44:47], v[76:79], v[188:191]
    v_mfma_f32_16x16x32_bf16 v[192:195], v[44:47], v[80:83], v[192:195]
    v_mfma_f32_16x16x32_bf16 v[196:199], v[44:47], v[84:87], v[196:199]
    v_mfma_f32_16x16x32_bf16 v[200:203], v[44:47], v[88:91], v[200:203]
    ds_read_b64_tr_b16 v[32:33], v17 offset:9248
    ds_read_b64_tr_b16 v[34:35], v17 offset:11552
    ds_read_b64_tr_b16 v[36:37], v17 offset:64
    ds_read_b64_tr_b16 v[38:39], v17 offset:2368
    s_add_u32 m0, s29, 0x6400
    s_nop 0
    buffer_load_dwordx4 v9, s[20:23], s32 offen lds
    v_mfma_f32_16x16x32_bf16 v[204:207], v[48:51], v[76:79], v[204:207]
    v_mfma_f32_16x16x32_bf16 v[208:211], v[48:51], v[80:83], v[208:211]
    v_mfma_f32_16x16x32_bf16 v[212:215], v[48:51], v[84:87], v[212:215]
    v_mfma_f32_16x16x32_bf16 v[216:219], v[48:51], v[88:91], v[216:219]
    ds_read_b64_tr_b16 v[40:41], v17 offset:9280
    s_waitcnt lgkmcnt(13)
    ds_read_b64_tr_b16 v[42:43], v17 offset:11584
    s_add_u32 m0, s30, 0x6000
    s_mov_b64 exec, 0xffff
    buffer_load_dwordx4 v10, s[40:43], s32 offen lds
    s_mov_b64 exec, -1
    s_add_u32 s32, s32, 0x48000
    v_mfma_f32_16x16x32_bf16 v[220:223], v[52:55], v[76:79], v[220:223]
    v_mfma_f32_16x16x32_bf16 v[224:227], v[52:55], v[80:83], v[224:227]
    v_mfma_f32_16x16x32_bf16 v[228:231], v[52:55], v[84:87], v[228:231]
    v_mfma_f32_16x16x32_bf16 v[232:235], v[52:55], v[88:91], v[232:235]
    ds_read_b64_tr_b16 v[44:45], v17 offset:96
    s_waitcnt lgkmcnt(13)
    ds_read_b64_tr_b16 v[46:47], v17 offset:2400
    v_mfma_f32_16x16x32_bf16 v[236:239], v[56:59], v[76:79], v[236:239]
    v_mfma_f32_16x16x32_bf16 v[240:243], v[56:59], v[80:83], v[240:243]
    v_mfma_f32_16x16x32_bf16 v[244:247], v[56:59], v[84:87], v[244:247]
    v_mfma_f32_16x16x32_bf16 v[248:251], v[56:59], v[88:91], v[248:251]
    ds_read_b64_tr_b16 v[48:49], v17 offset:9312
    s_waitcnt lgkmcnt(13)
    ds_read_b64_tr_b16 v[50:51], v17 offset:11616
    v_mfma_f32_16x16x32_bf16 v[92:95], v[20:23], v[60:63], v[92:95]
    v_mfma_f32_16x16x32_bf16 v[96:99], v[20:23], v[64:67], v[96:99]
    v_mfma_f32_16x16x32_bf16 v[100:103], v[20:23], v[68:71], v[100:103]
    v_mfma_f32_16x16x32_bf16 v[104:107], v[20:23], v[72:75], v[104:107]
    ds_read_b64_tr_b16 v[52:53], v17 offset:128
    s_waitcnt lgkmcnt(13)
    ds_read_b64_tr_b16 v[54:55], v17 offset:2432
    v_mfma_f32_16x16x32_bf16 v[108:111], v[24:27], v[60:63], v[108:111]
    v_mfma_f32_16x16x32_bf16 v[112:115], v[24:27], v[64:67], v[112:115]
    v_mfma_f32_16x16x32_bf16 v[116:119], v[24:27], v[68:71], v[116:119]
    v_mfma_f32_16x16x32_bf16 v[120:123], v[24:27], v[72:75], v[120:123]
    ds_read_b64_tr_b16 v[56:57], v17 offset:9344
    s_waitcnt lgkmcnt(13)
    ds_read_b64_tr_b16 v[58:59], v17 offset:11648
    v_mfma_f32_16x16x32_bf16 v[124:127], v[28:31], v[60:63], v[124:127]
    v_mfma_f32_16x16x32_bf16 v[128:131], v[28:31], v[64:67], v[128:131]
    v_mfma_f32_16x16x32_bf16 v[132:135], v[28:31], v[68:71], v[132:135]
    v_mfma_f32_16x16x32_bf16 v[136:139], v[28:31], v[72:75], v[136:139]
    s_waitcnt lgkmcnt(12)
    v_mfma_f32_16x16x32_bf16 v[140:143], v[32:35], v[60:63], v[140:143]
    v_mfma_f32_16x16x32_bf16 v[144:147], v[32:35], v[64:67], v[144:147]
    v_mfma_f32_16x16x32_bf16 v[148:151], v[32:35], v[68:71], v[148:151]
    v_mfma_f32_16x16x32_bf16 v[152:155], v[32:35], v[72:75], v[152:155]
    s_waitcnt vmcnt(5) lgkmcnt(0)
    s_barrier
    ds_read_b128 v[76:79], v14 offset:0
    ds_read_b128 v[80:83], v14 offset:1024
    ds_read_b128 v[84:87], v14 offset:2048
    s_add_u32 m0, s29, 0x8800
    s_nop 0
    buffer_load_dwordx4 v8, s[12:15], s31 offen lds
    v_mfma_f32_16x16x32_bf16 v[156:159], v[36:39], v[60:63], v[156:159]
    v_mfma_f32_16x16x32_bf16 v[160:163], v[36:39], v[64:67], v[160:163]
    v_mfma_f32_16x16x32_bf16 v[164:167], v[36:39], v[68:71], v[164:167]
    v_mfma_f32_16x16x32_bf16 v[168:171], v[36:39], v[72:75], v[168:171]
    ds_read_b128 v[88:91], v14 offset:3072
    ds_read_b64_tr_b16 v[20:21], v18 offset:0
    ds_read_b64_tr_b16 v[22:23], v18 offset:2304
    s_add_u32 m0, s29, 0xa800
    s_add_u32 s33, s31, 0x24000
    buffer_load_dwordx4 v8, s[12:15], s33 offen lds
    s_add_u32 s31, s31, 64
    v_mfma_f32_16x16x32_bf16 v[172:175], v[40:43], v[60:63], v[172:175]
    v_mfma_f32_16x16x32_bf16 v[176:179], v[40:43], v[64:67], v[176:179]
    v_mfma_f32_16x16x32_bf16 v[180:183], v[40:43], v[68:71], v[180:183]
    v_mfma_f32_16x16x32_bf16 v[184:187], v[40:43], v[72:75], v[184:187]
    ds_read_b64_tr_b16 v[24:25], v18 offset:9216
    ds_read_b64_tr_b16 v[26:27], v18 offset:11520
    ds_read_b64_tr_b16 v[28:29], v18 offset:32
    ds_read_b64_tr_b16 v[30:31], v18 offset:2336
    s_add_u32 m0, s29, 0xc800
    s_nop 0
    buffer_load_dwordx4 v9, s[16:19], s32 offen lds
    v_mfma_f32_16x16x32_bf16 v[188:191], v[44:47], v[60:63], v[188:191]
    v_mfma_f32_16x16x32_bf16 v[192:195], v[44:47], v[64:67], v[192:195]
    v_mfma_f32_16x16x32_bf16 v[196:199], v[44:47], v[68:71], v[196:199]
    v_mfma_f32_16x16x32_bf16 v[200:203], v[44:47], v[72:75], v[200:203]
    ds_read_b64_tr_b16 v[32:33], v18 offset:9248
    ds_read_b64_tr_b16 v[34:35], v18 offset:11552
    ds_read_b64_tr_b16 v[36:37], v18 offset:64
    ds_read_b64_tr_b16 v[38:39], v18 offset:2368
    s_add_u32 m0, s29, 0xec00
    s_nop 0
    buffer_load_dwordx4 v9, s[20:23], s32 offen lds
    v_mfma_f32_16x16x32_bf16 v[204:207], v[48:51], v[60:63], v[204:207]
    v_mfma_f32_16x16x32_bf16 v[208:211], v[48:51], v[64:67], v[208:211]
    v_mfma_f32_16x16x32_bf16 v[212:215], v[48:51], v[68:71], v[212:215]
    v_mfma_f32_16x16x32_bf16 v[216:219], v[48:51], v[72:75], v[216:219]
    ds_read_b64_tr_b16 v[40:41], v18 offset:9280
    s_waitcnt lgkmcnt(13)
    ds_read_b64_tr_b16 v[42:43], v18 offset:11584
    s_add_u32 m0, s30, 0xe800
    s_mov_b64 exec, 0xffff
    buffer_load_dwordx4 v10, s[40:43], s32 offen lds
    s_mov_b64 exec, -1
    s_add_u32 s32, s32, 0x48000
    v_mfma_f32_16x16x32_bf16 v[220:223], v[52:55], v[60:63], v[220:223]
    v_mfma_f32_16x16x32_bf16 v[224:227], v[52:55], v[64:67], v[224:227]
    v_mfma_f32_16x16x32_bf16 v[228:231], v[52:55], v[68:71], v[228:231]
    v_mfma_f32_16x16x32_bf16 v[232:235], v[52:55], v[72:75], v[232:235]
    ds_read_b64_tr_b16 v[44:45], v18 offset:96
    s_waitcnt lgkmcnt(13)
    ds_read_b64_tr_b16 v[46:47], v18 offset:2400
    v_mfma_f32_16x16x32_bf16 v[236:239], v[56:59], v[60:63], v[236:239]
    v_mfma_f32_16x16x32_bf16 v[240:243], v[56:59], v[64:67], v[240:243]
    v_mfma_f32_16x16x32_bf16 v[244:247], v[56:59], v[68:71], v[244:247]
    v_mfma_f32_16x16x32_bf16 v[248:251], v[56:59], v[72:75], v[248:251]
    ds_read_b64_tr_b16 v[48:49], v18 offset:9312
    s_waitcnt lgkmcnt(13)
    ds_read_b64_tr_b16 v[50:51], v18 offset:11616
    v_mfma_f32_16x16x32_bf16 v[92:95], v[20:23], v[76:79], v[92:95]
    v_mfma_f32_16x16x32_bf16 v[96:99], v[20:23], v[80:83], v[96:99]
    v_mfma_f32_16x16x32_bf16 v[100:103], v[20:23], v[84:87], v[100:103]
    v_mfma_f32_16x16x32_bf16 v[104:107], v[20:23], v[88:91], v[104:107]
    ds_read_b64_tr_b16 v[52:53], v18 offset:128
    s_waitcnt lgkmcnt(13)
    ds_read_b64_tr_b16 v[54:55], v18 offset:2432
    v_mfma_f32_16x16x32_bf16 v[108:111], v[24:27], v[76:79], v[108:111]
    v_mfma_f32_16x16x32_bf16 v[112:115], v[24:27], v[80:83], v[112:115]
    v_mfma_f32_16x16x32_bf16 v[116:119], v[24:27], v[84:87], v[116:119]
    v_mfma_f32_16x16x32_bf16 v[120:123], v[24:27], v[88:91], v[120:123]
    ds_read_b64_tr_b16 v[56:57], v18 offset:9344
    s_waitcnt lgkmcnt(13)
    ds_read_b64_tr_b16 v[58:59], v18 offset:11648
    v_mfma_f32_16x16x32_bf16 v[124:127], v[28:31], v[76:79], v[124:127]
    v_mfma_f32_16x16x32_bf16 v[128:131], v[28:31], v[80:83], v[128:131]
    v_mfma_f32_16x16x32_bf16 v[132:135], v[28:31], v[84:87], v[132:135]
    v_mfma_f32_16x16x32_bf16 v[136:139], v[28:31], v[88:91], v[136:139]
    s_waitcnt lgkmcnt(12)
    v_mfma_f32_16x16x32_bf16 v[140:143], v[32:35], v[76:79], v[140:143]
    v_mfma_f32_16x16x32_bf16 v[144:147], v[32:35], v[80:83], v[144:147]
    v_mfma_f32_16x16x32_bf16 v[148:151], v[32:35], v[84:87], v[148:151]
    v_mfma_f32_16x16x32_bf16 v[152:155], v[32:35], v[88:91], v[152:155]
    s_waitcnt vmcnt(5) lgkmcnt(0)
    s_barrier
    ds_read_b128 v[60:63], v12 offset:0
    ds_read_b128 v[64:67], v12 offset:1024
    ds_read_b128 v[68:71], v12 offset:2048
    s_add_u32 m0, s29, 0x11000
    s_nop 0
    buffer_load_dwordx4 v8, s[12:15], s31 offen lds
    v_mfma_f32_16x16x32_bf16 v[156:159], v[36:39], v[76:79], v[156:159]
    v_mfma_f32_16x16x32_bf16 v[160:163], v[36:39], v[80:83], v[160:163]
    v_mfma_f32_16x16x32_bf16 v[164:167], v[36:39], v[84:87], v[164:167]
    v_mfma_f32_16x16x32_bf16 v[168:171], v[36:39], v[88:91], v[168:171]
    ds_read_b128 v[72:75], v12 offset:3072
    ds_read_b64_tr_b16 v[20:21], v16 offset:0
    ds_read_b64_tr_b16 v[22:23], v16 offset:2304
    s_add_u32 m0, s29, 0x13000
    s_add_u32 s33, s31, 0x24000
    buffer_load_dwordx4 v8, s[12:15], s33 offen lds
    s_add_u32 s31, s31, 64
    v_mfma_f32_16x16x32_bf16 v[172:175], v[40:43], v[76:79], v[172:175]
    v_mfma_f32_16x16x32_bf16 v[176:179], v[40:43], v[80:83], v[176:179]
    v_mfma_f32_16x16x32_bf16 v[180:183], v[40:43], v[84:87], v[180:183]
    v_mfma_f32_16x16x32_bf16 v[184:187], v[40:43], v[88:91], v[184:187]
    ds_read_b64_tr_b16 v[24:25], v16 offset:9216
    ds_read_b64_tr_b16 v[26:27], v16 offset:11520
    ds_read_b64_tr_b16 v[28:29], v16 offset:32
    ds_read_b64_tr_b16 v[30:31], v16 offset:2336
    s_add_u32 m0, s29, 0x15000
    s_nop 0
    buffer_load_dwordx4 v9, s[16:19], s32 offen lds
    v_mfma_f32_16x16x32_bf16 v[188:191], v[44:47], v[76:79], v[188:191]
    v_mfma_f32_16x16x32_bf16 v[192:195], v[44:47], v[80:83], v[192:195]
    v_mfma_f32_16x16x32_bf16 v[196:199], v[44:47], v[84:87], v[196:199]
    v_mfma_f32_16x16x32_bf16 v[200:203], v[44:47], v[88:91], v[200:203]
    ds_read_b64_tr_b16 v[32:33], v16 offset:9248
    ds_read_b64_tr_b16 v[34:35], v16 offset:11552
    ds_read_b64_tr_b16 v[36:37], v16 offset:64
    ds_read_b64_tr_b16 v[38:39], v16 offset:2368
    s_add_u32 m0, s29, 0x17400
    s_nop 0
    buffer_load_dwordx4 v9, s[20:23], s32 offen lds
    v_mfma_f32_16x16x32_bf16 v[204:207], v[48:51], v[76:79], v[204:207]
    v_mfma_f32_16x16x32_bf16 v[208:211], v[48:51], v[80:83], v[208:211]
    v_mfma_f32_16x16x32_bf16 v[212:215], v[48:51], v[84:87], v[212:215]
    v_mfma_f32_16x16x32_bf16 v[216:219], v[48:51], v[88:91], v[216:219]
    ds_read_b64_tr_b16 v[40:41], v16 offset:9280
    s_waitcnt lgkmcnt(13)
    ds_read_b64_tr_b16 v[42:43], v16 offset:11584
    s_add_u32 m0, s30, 0x17000
    s_mov_b64 exec, 0xffff
    buffer_load_dwordx4 v10, s[40:43], s32 offen lds
    s_mov_b64 exec, -1
    s_add_u32 s32, s32, 0x48000
    v_mfma_f32_16x16x32_bf16 v[220:223], v[52:55], v[76:79], v[220:223]
    v_mfma_f32_16x16x32_bf16 v[224:227], v[52:55], v[80:83], v[224:227]
    v_mfma_f32_16x16x32_bf16 v[228:231], v[52:55], v[84:87], v[228:231]
    v_mfma_f32_16x16x32_bf16 v[232:235], v[52:55], v[88:91], v[232:235]
    ds_read_b64_tr_b16 v[44:45], v16 offset:96
    s_waitcnt lgkmcnt(13)
    ds_read_b64_tr_b16 v[46:47], v16 offset:2400
    v_mfma_f32_16x16x32_bf16 v[236:239], v[56:59], v[76:79], v[236:239]
    v_mfma_f32_16x16x32_bf16 v[240:243], v[56:59], v[80:83], v[240:243]
    v_mfma_f32_16x16x32_bf16 v[244:247], v[56:59], v[84:87], v[244:247]
    v_mfma_f32_16x16x32_bf16 v[248:251], v[56:59], v[88:91], v[248:251]
    ds_read_b64_tr_b16 v[48:49], v16 offset:9312
    s_waitcnt lgkmcnt(13)
    ds_read_b64_tr_b16 v[50:51], v16 offset:11616
    v_mfma_f32_16x16x32_bf16 v[92:95], v[20:23], v[60:63], v[92:95]
    v_mfma_f32_16x16x32_bf16 v[96:99], v[20:23], v[64:67], v[96:99]
    v_mfma_f32_16x16x32_bf16 v[100:103], v[20:23], v[68:71], v[100:103]
    v_mfma_f32_16x16x32_bf16 v[104:107], v[20:23], v[72:75], v[104:107]
    ds_read_b64_tr_b16 v[52:53], v16 offset:128
    s_waitcnt lgkmcnt(13)
    ds_read_b64_tr_b16 v[54:55], v16 offset:2432
    v_mfma_f32_16x16x32_bf16 v[108:111], v[24:27], v[60:63], v[108:111]
    v_mfma_f32_16x16x32_bf16 v[112:115], v[24:27], v[64:67], v[112:115]
    v_mfma_f32_16x16x32_bf16 v[116:119], v[24:27], v[68:71], v[116:119]
    v_mfma_f32_16x16x32_bf16 v[120:123], v[24:27], v[72:75], v[120:123]
    ds_read_b64_tr_b16 v[56:57], v16 offset:9344
    s_waitcnt lgkmcnt(13)
    ds_read_b64_tr_b16 v[58:59], v16 offset:11648
    v_mfma_f32_16x16x32_bf16 v[124:127], v[28:31], v[60:63], v[124:127]
    v_mfma_f32_16x16x32_bf16 v[128:131], v[28:31], v[64:67], v[128:131]
    v_mfma_f32_16x16x32_bf16 v[132:135], v[28:31], v[68:71], v[132:135]
    v_mfma_f32_16x16x32_bf16 v[136:139], v[28:31], v[72:75], v[136:139]
    s_waitcnt lgkmcnt(12)
    v_mfma_f32_16x16x32_bf16 v[140:143], v[32:35], v[60:63], v[140:143]
    v_mfma_f32_16x16x32_bf16 v[144:147], v[32:35], v[64:67], v[144:147]
    v_mfma_f32_16x16x32_bf16 v[148:151], v[32:35], v[68:71], v[148:151]
    v_mfma_f32_16x16x32_bf16 v[152:155], v[32:35], v[72:75], v[152:155]
    s_waitcnt vmcnt(5) lgkmcnt(0)
    s_barrier
    ds_read_b128 v[76:79], v13 offset:0
    ds_read_b128 v[80:83], v13 offset:1024
    ds_read_b128 v[84:87], v13 offset:2048
    s_add_u32 m0, s29, 0x0
    s_nop 0
    buffer_load_dwordx4 v8, s[12:15], s31 offen lds
    v_mfma_f32_16x16x32_bf16 v[156:159], v[36:39], v[60:63], v[156:159]
    v_mfma_f32_16x16x32_bf16 v[160:163], v[36:39], v[64:67], v[160:163]
    v_mfma_f32_16x16x32_bf16 v[164:167], v[36:39], v[68:71], v[164:167]
    v_mfma_f32_16x16x32_bf16 v[168:171], v[36:39], v[72:75], v[168:171]
    ds_read_b128 v[88:91], v13 offset:3072
    ds_read_b64_tr_b16 v[20:21], v17 offset:0
    ds_read_b64_tr_b16 v[22:23], v17 offset:2304
    s_add_u32 m0, s29, 0x2000
    s_add_u32 s33, s31, 0x24000
    buffer_load_dwordx4 v8, s[12:15], s33 offen lds
    s_add_u32 s31, s31, 64
    v_mfma_f32_16x16x32_bf16 v[172:175], v[40:43], v[60:63], v[172:175]
    v_mfma_f32_16x16x32_bf16 v[176:179], v[40:43], v[64:67], v[176:179]
    v_mfma_f32_16x16x32_bf16 v[180:183], v[40:43], v[68:71], v[180:183]
    v_mfma_f32_16x16x32_bf16 v[184:187], v[40:43], v[72:75], v[184:187]
    ds_read_b64_tr_b16 v[24:25], v17 offset:9216
    ds_read_b64_tr_b16 v[26:27], v17 offset:11520
    ds_read_b64_tr_b16 v[28:29], v17 offset:32
    ds_read_b64_tr_b16 v[30:31], v17 offset:2336
    s_add_u32 m0, s29, 0x4000
    s_nop 0
    buffer_load_dwordx4 v9, s[16:19], s32 offen lds
    v_mfma_f32_16x16x32_bf16 v[188:191], v[44:47], v[60:63], v[188:191]
    v_mfma_f32_16x16x32_bf16 v[192:195], v[44:47], v[64:67], v[192:195]
    v_mfma_f32_16x16x32_bf16 v[196:199], v[44:47], v[68:71], v[196:199]
    v_mfma_f32_16x16x32_bf16 v[200:203], v[44:47], v[72:75], v[200:203]
    ds_read_b64_tr_b16 v[32:33], v17 offset:9248
    ds_read_b64_tr_b16 v[34:35], v17 offset:11552
    ds_read_b64_tr_b16 v[36:37], v17 offset:64
    ds_read_b64_tr_b16 v[38:39], v17 offset:2368
    s_add_u32 m0, s29, 0x6400
    s_nop 0
    buffer_load_dwordx4 v9, s[20:23], s32 offen lds
    v_mfma_f32_16x16x32_bf16 v[204:207], v[48:51], v[60:63], v[204:207]
    v_mfma_f32_16x16x32_bf16 v[208:211], v[48:51], v[64:67], v[208:211]
    v_mfma_f32_16x16x32_bf16 v[212:215], v[48:51], v[68:71], v[212:215]
    v_mfma_f32_16x16x32_bf16 v[216:219], v[48:51], v[72:75], v[216:219]
    ds_read_b64_tr_b16 v[40:41], v17 offset:9280
    s_waitcnt lgkmcnt(13)
    ds_read_b64_tr_b16 v[42:43], v17 offset:11584
    s_add_u32 m0, s30, 0x6000
    s_mov_b64 exec, 0xffff
    buffer_load_dwordx4 v10, s[40:43], s32 offen lds
    s_mov_b64 exec, -1
    s_add_u32 s32, s32, 0x48000
    v_mfma_f32_16x16x32_bf16 v[220:223], v[52:55], v[60:63], v[220:223]
    v_mfma_f32_16x16x32_bf16 v[224:227], v[52:55], v[64:67], v[224:227]
    v_mfma_f32_16x16x32_bf16 v[228:231], v[52:55], v[68:71], v[228:231]
    v_mfma_f32_16x16x32_bf16 v[232:235], v[52:55], v[72:75], v[232:235]
    ds_read_b64_tr_b16 v[44:45], v17 offset:96
    s_waitcnt lgkmcnt(13)
    ds_read_b64_tr_b16 v[46:47], v17 offset:2400
    v_mfma_f32_16x16x32_bf16 v[236:239], v[56:59], v[60:63], v[236:239]
    v_mfma_f32_16x16x32_bf16 v[240:243], v[56:59], v[64:67], v[240:243]
    v_mfma_f32_16x16x32_bf16 v[244:247], v[56:59], v[68:71], v[244:247]
    v_mfma_f32_16x16x32_bf16 v[248:251], v[56:59], v[72:75], v[248:251]
    ds_read_b64_tr_b16 v[48:49], v17 offset:9312
    s_waitcnt lgkmcnt(13)
    ds_read_b64_tr_b16 v[50:51], v17 offset:11616
    v_mfma_f32_16x16x32_bf16 v[92:95], v[20:23], v[76:79], v[92:95]
    v_mfma_f32_16x16x32_bf16 v[96:99], v[20:23], v[80:83], v[96:99]
    v_mfma_f32_16x16x32_bf16 v[100:103], v[20:23], v[84:87], v[100:103]
    v_mfma_f32_16x16x32_bf16 v[104:107], v[20:23], v[88:91], v[104:107]
    ds_read_b64_tr_b16 v[52:53], v17 offset:128
    s_waitcnt lgkmcnt(13)
    ds_read_b64_tr_b16 v[54:55], v17 offset:2432
    v_mfma_f32_16x16x32_bf16 v[108:111], v[24:27], v[76:79], v[108:111]
    v_mfma_f32_16x16x32_bf16 v[112:115], v[24:27], v[80:83], v[112:115]
    v_mfma_f32_16x16x32_bf16 v[116:119], v[24:27], v[84:87], v[116:119]
    v_mfma_f32_16x16x32_bf16 v[120:123], v[24:27], v[88:91], v[120:123]
    ds_read_b64_tr_b16 v[56:57], v17 offset:9344
    s_waitcnt lgkmcnt(13)
    ds_read_b64_tr_b16 v[58:59], v17 offset:11648
    v_mfma_f32_16x16x32_bf16 v[124:127], v[28:31], v[76:79], v[124:127]
    v_mfma_f32_16x16x32_bf16 v[128:131], v[28:31], v[80:83], v[128:131]
    v_mfma_f32_16x16x32_bf16 v[132:135], v[28:31], v[84:87], v[132:135]
    v_mfma_f32_16x16x32_bf16 v[136:139], v[28:31], v[88:91], v[136:139]
    s_waitcnt lgkmcnt(12)
    v_mfma_f32_16x16x32_bf16 v[140:143], v[32:35], v[76:79], v[140:143]
    v_mfma_f32_16x16x32_bf16 v[144:147], v[32:35], v[80:83], v[144:147]
    v_mfma_f32_16x16x32_bf16 v[148:151], v[32:35], v[84:87], v[148:151]
    v_mfma_f32_16x16x32_bf16 v[152:155], v[32:35], v[88:91], v[152:155]
    s_waitcnt vmcnt(5) lgkmcnt(0)
    s_barrier
    ds_read_b128 v[60:63], v14 offset:0
    ds_read_b128 v[64:67], v14 offset:1024
    ds_read_b128 v[68:71], v14 offset:2048
    s_add_u32 m0, s29, 0x8800
    s_nop 0
    buffer_load_dwordx4 v8, s[12:15], s31 offen lds
    v_mfma_f32_16x16x32_bf16 v[156:159], v[36:39], v[76:79], v[156:159]
    v_mfma_f32_16x16x32_bf16 v[160:163], v[36:39], v[80:83], v[160:163]
    v_mfma_f32_16x16x32_bf16 v[164:167], v[36:39], v[84:87], v[164:167]
    v_mfma_f32_16x16x32_bf16 v[168:171], v[36:39], v[88:91], v[168:171]
    ds_read_b128 v[72:75], v14 offset:3072
    ds_read_b64_tr_b16 v[20:21], v18 offset:0
    ds_read_b64_tr_b16 v[22:23], v18 offset:2304
    s_add_u32 m0, s29, 0xa800
    s_add_u32 s33, s31, 0x24000
    buffer_load_dwordx4 v8, s[12:15], s33 offen lds
    s_add_u32 s31, s31, 64
    v_mfma_f32_16x16x32_bf16 v[172:175], v[40:43], v[76:79], v[172:175]
    v_mfma_f32_16x16x32_bf16 v[176:179], v[40:43], v[80:83], v[176:179]
    v_mfma_f32_16x16x32_bf16 v[180:183], v[40:43], v[84:87], v[180:183]
    v_mfma_f32_16x16x32_bf16 v[184:187], v[40:43], v[88:91], v[184:187]
    ds_read_b64_tr_b16 v[24:25], v18 offset:9216
    ds_read_b64_tr_b16 v[26:27], v18 offset:11520
    ds_read_b64_tr_b16 v[28:29], v18 offset:32
    ds_read_b64_tr_b16 v[30:31], v18 offset:2336
    s_add_u32 m0, s29, 0xc800
    s_nop 0
    buffer_load_dwordx4 v9, s[16:19], s32 offen lds
    v_mfma_f32_16x16x32_bf16 v[188:191], v[44:47], v[76:79], v[188:191]
    v_mfma_f32_16x16x32_bf16 v[192:195], v[44:47], v[80:83], v[192:195]
    v_mfma_f32_16x16x32_bf16 v[196:199], v[44:47], v[84:87], v[196:199]
    v_mfma_f32_16x16x32_bf16 v[200:203], v[44:47], v[88:91], v[200:203]
    ds_read_b64_tr_b16 v[32:33], v18 offset:9248
    ds_read_b64_tr_b16 v[34:35], v18 offset:11552
    ds_read_b64_tr_b16 v[36:37], v18 offset:64
    ds_read_b64_tr_b16 v[38:39], v18 offset:2368
    s_add_u32 m0, s29, 0xec00
    s_nop 0
    buffer_load_dwordx4 v9, s[20:23], s32 offen lds
    v_mfma_f32_16x16x32_bf16 v[204:207], v[48:51], v[76:79], v[204:207]
    v_mfma_f32_16x16x32_bf16 v[208:211], v[48:51], v[80:83], v[208:211]
    v_mfma_f32_16x16x32_bf16 v[212:215], v[48:51], v[84:87], v[212:215]
    v_mfma_f32_16x16x32_bf16 v[216:219], v[48:51], v[88:91], v[216:219]
    ds_read_b64_tr_b16 v[40:41], v18 offset:9280
    s_waitcnt lgkmcnt(13)
    ds_read_b64_tr_b16 v[42:43], v18 offset:11584
    s_add_u32 m0, s30, 0xe800
    s_mov_b64 exec, 0xffff
    buffer_load_dwordx4 v10, s[40:43], s32 offen lds
    s_mov_b64 exec, -1
    s_add_u32 s32, s32, 0x48000
    v_mfma_f32_16x16x32_bf16 v[220:223], v[52:55], v[76:79], v[220:223]
    v_mfma_f32_16x16x32_bf16 v[224:227], v[52:55], v[80:83], v[224:227]
    v_mfma_f32_16x16x32_bf16 v[228:231], v[52:55], v[84:87], v[228:231]
    v_mfma_f32_16x16x32_bf16 v[232:235], v[52:55], v[88:91], v[232:235]
    ds_read_b64_tr_b16 v[44:45], v18 offset:96
    s_waitcnt lgkmcnt(13)
    ds_read_b64_tr_b16 v[46:47], v18 offset:2400
    v_mfma_f32_16x16x32_bf16 v[236:239], v[56:59], v[76:79], v[236:239]
    v_mfma_f32_16x16x32_bf16 v[240:243], v[56:59], v[80:83], v[240:243]
    v_mfma_f32_16x16x32_bf16 v[244:247], v[56:59], v[84:87], v[244:247]
    v_mfma_f32_16x16x32_bf16 v[248:251], v[56:59], v[88:91], v[248:251]
    ds_read_b64_tr_b16 v[48:49], v18 offset:9312
    s_waitcnt lgkmcnt(13)
    ds_read_b64_tr_b16 v[50:51], v18 offset:11616
    v_mfma_f32_16x16x32_bf16 v[92:95], v[20:23], v[60:63], v[92:95]
    v_mfma_f32_16x16x32_bf16 v[96:99], v[20:23], v[64:67], v[96:99]
    v_mfma_f32_16x16x32_bf16 v[100:103], v[20:23], v[68:71], v[100:103]
    v_mfma_f32_16x16x32_bf16 v[104:107], v[20:23], v[72:75], v[104:107]
    ds_read_b64_tr_b16 v[52:53], v18 offset:128
    s_waitcnt lgkmcnt(13)
    ds_read_b64_tr_b16 v[54:55], v18 offset:2432
    v_mfma_f32_16x16x32_bf16 v[108:111], v[24:27], v[60:63], v[108:111]
    v_mfma_f32_16x16x32_bf16 v[112:115], v[24:27], v[64:67], v[112:115]
    v_mfma_f32_16x16x32_bf16 v[116:119], v[24:27], v[68:71], v[116:119]
    v_mfma_f32_16x16x32_bf16 v[120:123], v[24:27], v[72:75], v[120:123]
    ds_read_b64_tr_b16 v[56:57], v18 offset:9344
    s_waitcnt lgkmcnt(13)
    ds_read_b64_tr_b16 v[58:59], v18 offset:11648
    v_mfma_f32_16x16x32_bf16 v[124:127], v[28:31], v[60:63], v[124:127]
    v_mfma_f32_16x16x32_bf16 v[128:131], v[28:31], v[64:67], v[128:131]
    v_mfma_f32_16x16x32_bf16 v[132:135], v[28:31], v[68:71], v[132:135]
    v_mfma_f32_16x16x32_bf16 v[136:139], v[28:31], v[72:75], v[136:139]
    s_waitcnt lgkmcnt(12)
    v_mfma_f32_16x16x32_bf16 v[140:143], v[32:35], v[60:63], v[140:143]
    v_mfma_f32_16x16x32_bf16 v[144:147], v[32:35], v[64:67], v[144:147]
    v_mfma_f32_16x16x32_bf16 v[148:151], v[32:35], v[68:71], v[148:151]
    v_mfma_f32_16x16x32_bf16 v[152:155], v[32:35], v[72:75], v[152:155]
    s_waitcnt vmcnt(5) lgkmcnt(0)
    s_barrier
    ds_read_b128 v[76:79], v12 offset:0
    ds_read_b128 v[80:83], v12 offset:1024
    ds_read_b128 v[84:87], v12 offset:2048
    s_add_u32 m0, s29, 0x11000
    s_nop 0
    buffer_load_dwordx4 v8, s[12:15], s31 offen lds
    v_mfma_f32_16x16x32_bf16 v[156:159], v[36:39], v[60:63], v[156:159]
    v_mfma_f32_16x16x32_bf16 v[160:163], v[36:39], v[64:67], v[160:163]
    v_mfma_f32_16x16x32_bf16 v[164:167], v[36:39], v[68:71], v[164:167]
    v_mfma_f32_16x16x32_bf16 v[168:171], v[36:39], v[72:75], v[168:171]
    ds_read_b128 v[88:91], v12 offset:3072
    ds_read_b64_tr_b16 v[20:21], v16 offset:0
    ds_read_b64_tr_b16 v[22:23], v16 offset:2304
    s_add_u32 m0, s29, 0x13000
    s_add_u32 s33, s31, 0x24000
    buffer_load_dwordx4 v8, s[12:15], s33 offen lds
    s_add_u32 s31, s31, 64
    v_mfma_f32_16x16x32_bf16 v[172:175], v[40:43], v[60:63], v[172:175]
    v_mfma_f32_16x16x32_bf16 v[176:179], v[40:43], v[64:67], v[176:179]
    v_mfma_f32_16x16x32_bf16 v[180:183], v[40:43], v[68:71], v[180:183]
    v_mfma_f32_16x16x32_bf16 v[184:187], v[40:43], v[72:75], v[184:187]
    ds_read_b64_tr_b16 v[24:25], v16 offset:9216
    ds_read_b64_tr_b16 v[26:27], v16 offset:11520
    ds_read_b64_tr_b16 v[28:29], v16 offset:32
    ds_read_b64_tr_b16 v[30:31], v16 offset:2336
    s_add_u32 m0, s29, 0x15000
    s_nop 0
    buffer_load_dwordx4 v9, s[16:19], s32 offen lds
    v_mfma_f32_16x16x32_bf16 v[188:191], v[44:47], v[60:63], v[188:191]
    v_mfma_f32_16x16x32_bf16 v[192:195], v[44:47], v[64:67], v[192:195]
    v_mfma_f32_16x16x32_bf16 v[196:199], v[44:47], v[68:71], v[196:199]
    v_mfma_f32_16x16x32_bf16 v[200:203], v[44:47], v[72:75], v[200:203]
    ds_read_b64_tr_b16 v[32:33], v16 offset:9248
    ds_read_b64_tr_b16 v[34:35], v16 offset:11552
    ds_read_b64_tr_b16 v[36:37], v16 offset:64
    ds_read_b64_tr_b16 v[38:39], v16 offset:2368
    s_add_u32 m0, s29, 0x17400
    s_nop 0
    buffer_load_dwordx4 v9, s[20:23], s32 offen lds
    v_mfma_f32_16x16x32_bf16 v[204:207], v[48:51], v[60:63], v[204:207]
    v_mfma_f32_16x16x32_bf16 v[208:211], v[48:51], v[64:67], v[208:211]
    v_mfma_f32_16x16x32_bf16 v[212:215], v[48:51], v[68:71], v[212:215]
    v_mfma_f32_16x16x32_bf16 v[216:219], v[48:51], v[72:75], v[216:219]
    ds_read_b64_tr_b16 v[40:41], v16 offset:9280
    s_waitcnt lgkmcnt(13)
    ds_read_b64_tr_b16 v[42:43], v16 offset:11584
    s_add_u32 m0, s30, 0x17000
    s_mov_b64 exec, 0xffff
    buffer_load_dwordx4 v10, s[40:43], s32 offen lds
    s_mov_b64 exec, -1
    s_add_u32 s32, s32, 0x48000
    v_mfma_f32_16x16x32_bf16 v[220:223], v[52:55], v[60:63], v[220:223]
    v_mfma_f32_16x16x32_bf16 v[224:227], v[52:55], v[64:67], v[224:227]
    v_mfma_f32_16x16x32_bf16 v[228:231], v[52:55], v[68:71], v[228:231]
    v_mfma_f32_16x16x32_bf16 v[232:235], v[52:55], v[72:75], v[232:235]
    ds_read_b64_tr_b16 v[44:45], v16 offset:96
    s_waitcnt lgkmcnt(13)
    ds_read_b64_tr_b16 v[46:47], v16 offset:2400
    v_mfma_f32_16x16x32_bf16 v[236:239], v[56:59], v[60:63], v[236:239]
    v_mfma_f32_16x16x32_bf16 v[240:243], v[56:59], v[64:67], v[240:243]
    v_mfma_f32_16x16x32_bf16 v[244:247], v[56:59], v[68:71], v[244:247]
    v_mfma_f32_16x16x32_bf16 v[248:251], v[56:59], v[72:75], v[248:251]
    ds_read_b64_tr_b16 v[48:49], v16 offset:9312
    s_waitcnt lgkmcnt(13)
    ds_read_b64_tr_b16 v[50:51], v16 offset:11616
    v_mfma_f32_16x16x32_bf16 v[92:95], v[20:23], v[76:79], v[92:95]
    v_mfma_f32_16x16x32_bf16 v[96:99], v[20:23], v[80:83], v[96:99]
    v_mfma_f32_16x16x32_bf16 v[100:103], v[20:23], v[84:87], v[100:103]
    v_mfma_f32_16x16x32_bf16 v[104:107], v[20:23], v[88:91], v[104:107]
    ds_read_b64_tr_b16 v[52:53], v16 offset:128
    s_waitcnt lgkmcnt(13)
    ds_read_b64_tr_b16 v[54:55], v16 offset:2432
    v_mfma_f32_16x16x32_bf16 v[108:111], v[24:27], v[76:79], v[108:111]
    v_mfma_f32_16x16x32_bf16 v[112:115], v[24:27], v[80:83], v[112:115]
    v_mfma_f32_16x16x32_bf16 v[116:119], v[24:27], v[84:87], v[116:119]
    v_mfma_f32_16x16x32_bf16 v[120:123], v[24:27], v[88:91], v[120:123]
    ds_read_b64_tr_b16 v[56:57], v16 offset:9344
    s_waitcnt lgkmcnt(13)
    ds_read_b64_tr_b16 v[58:59], v16 offset:11648
    v_mfma_f32_16x16x32_bf16 v[124:127], v[28:31], v[76:79], v[124:127]
    v_mfma_f32_16x16x32_bf16 v[128:131], v[28:31], v[80:83], v[128:131]
    v_mfma_f32_16x16x32_bf16 v[132:135], v[28:31], v[84:87], v[132:135]
    v_mfma_f32_16x16x32_bf16 v[136:139], v[28:31], v[88:91], v[136:139]
    s_waitcnt lgkmcnt(12)
    v_mfma_f32_16x16x32_bf16 v[140:143], v[32:35], v[76:79], v[140:143]
    v_mfma_f32_16x16x32_bf16 v[144:147], v[32:35], v[80:83], v[144:147]
    v_mfma_f32_16x16x32_bf16 v[148:151], v[32:35], v[84:87], v[148:151]
    v_mfma_f32_16x16x32_bf16 v[152:155], v[32:35], v[88:91], v[152:155]
    s_waitcnt vmcnt(5) lgkmcnt(0)
    s_barrier
    ds_read_b128 v[60:63], v13 offset:0
    ds_read_b128 v[64:67], v13 offset:1024
    ds_read_b128 v[68:71], v13 offset:2048
    s_add_u32 m0, s29, 0x0
    s_nop 0
    buffer_load_dwordx4 v8, s[12:15], s31 offen lds
    v_mfma_f32_16x16x32_bf16 v[156:159], v[36:39], v[76:79], v[156:159]
    v_mfma_f32_16x16x32_bf16 v[160:163], v[36:39], v[80:83], v[160:163]
    v_mfma_f32_16x16x32_bf16 v[164:167], v[36:39], v[84:87], v[164:167]
    v_mfma_f32_16x16x32_bf16 v[168:171], v[36:39], v[88:91], v[168:171]
    ds_read_b128 v[72:75], v13 offset:3072
    ds_read_b64_tr_b16 v[20:21], v17 offset:0
    ds_read_b64_tr_b16 v[22:23], v17 offset:2304
    s_add_u32 m0, s29, 0x2000
    s_add_u32 s33, s31, 0x24000
    buffer_load_dwordx4 v8, s[12:15], s33 offen lds
    s_add_u32 s31, s31, 64
    v_mfma_f32_16x16x32_bf16 v[172:175], v[40:43], v[76:79], v[172:175]
    v_mfma_f32_16x16x32_bf16 v[176:179], v[40:43], v[80:83], v[176:179]
    v_mfma_f32_16x16x32_bf16 v[180:183], v[40:43], v[84:87], v[180:183]
    v_mfma_f32_16x16x32_bf16 v[184:187], v[40:43], v[88:91], v[184:187]
    ds_read_b64_tr_b16 v[24:25], v17 offset:9216
    ds_read_b64_tr_b16 v[26:27], v17 offset:11520
    ds_read_b64_tr_b16 v[28:29], v17 offset:32
    ds_read_b64_tr_b16 v[30:31], v17 offset:2336
    s_add_u32 m0, s29, 0x4000
    s_nop 0
    buffer_load_dwordx4 v9, s[16:19], s32 offen lds
    v_mfma_f32_16x16x32_bf16 v[188:191], v[44:47], v[76:79], v[188:191]
    v_mfma_f32_16x16x32_bf16 v[192:195], v[44:47], v[80:83], v[192:195]
    v_mfma_f32_16x16x32_bf16 v[196:199], v[44:47], v[84:87], v[196:199]
    v_mfma_f32_16x16x32_bf16 v[200:203], v[44:47], v[88:91], v[200:203]
    ds_read_b64_tr_b16 v[32:33], v17 offset:9248
    ds_read_b64_tr_b16 v[34:35], v17 offset:11552
    ds_read_b64_tr_b16 v[36:37], v17 offset:64
    ds_read_b64_tr_b16 v[38:39], v17 offset:2368
    s_add_u32 m0, s29, 0x6400
    s_nop 0
    buffer_load_dwordx4 v9, s[20:23], s32 offen lds
    v_mfma_f32_16x16x32_bf16 v[204:207], v[48:51], v[76:79], v[204:207]
    v_mfma_f32_16x16x32_bf16 v[208:211], v[48:51], v[80:83], v[208:211]
    v_mfma_f32_16x16x32_bf16 v[212:215], v[48:51], v[84:87], v[212:215]
    v_mfma_f32_16x16x32_bf16 v[216:219], v[48:51], v[88:91], v[216:219]
    ds_read_b64_tr_b16 v[40:41], v17 offset:9280
    s_waitcnt lgkmcnt(13)
    ds_read_b64_tr_b16 v[42:43], v17 offset:11584
    s_add_u32 m0, s30, 0x6000
    s_mov_b64 exec, 0xffff
    buffer_load_dwordx4 v10, s[40:43], s32 offen lds
    s_mov_b64 exec, -1
    s_add_u32 s32, s32, 0x48000
    v_mfma_f32_16x16x32_bf16 v[220:223], v[52:55], v[76:79], v[220:223]
    v_mfma_f32_16x16x32_bf16 v[224:227], v[52:55], v[80:83], v[224:227]
    v_mfma_f32_16x16x32_bf16 v[228:231], v[52:55], v[84:87], v[228:231]
    v_mfma_f32_16x16x32_bf16 v[232:235], v[52:55], v[88:91], v[232:235]
    ds_read_b64_tr_b16 v[44:45], v17 offset:96
    s_waitcnt lgkmcnt(13)
    ds_read_b64_tr_b16 v[46:47], v17 offset:2400
    v_mfma_f32_16x16x32_bf16 v[236:239], v[56:59], v[76:79], v[236:239]
    v_mfma_f32_16x16x32_bf16 v[240:243], v[56:59], v[80:83], v[240:243]
    v_mfma_f32_16x16x32_bf16 v[244:247], v[56:59], v[84:87], v[244:247]
    v_mfma_f32_16x16x32_bf16 v[248:251], v[56:59], v[88:91], v[248:251]
    ds_read_b64_tr_b16 v[48:49], v17 offset:9312
    s_waitcnt lgkmcnt(13)
    ds_read_b64_tr_b16 v[50:51], v17 offset:11616
    v_mfma_f32_16x16x32_bf16 v[92:95], v[20:23], v[60:63], v[92:95]
    v_mfma_f32_16x16x32_bf16 v[96:99], v[20:23], v[64:67], v[96:99]
    v_mfma_f32_16x16x32_bf16 v[100:103], v[20:23], v[68:71], v[100:103]
    v_mfma_f32_16x16x32_bf16 v[104:107], v[20:23], v[72:75], v[104:107]
    ds_read_b64_tr_b16 v[52:53], v17 offset:128
    s_waitcnt lgkmcnt(13)
    ds_read_b64_tr_b16 v[54:55], v17 offset:2432
    v_mfma_f32_16x16x32_bf16 v[108:111], v[24:27], v[60:63], v[108:111]
    v_mfma_f32_16x16x32_bf16 v[112:115], v[24:27], v[64:67], v[112:115]
    v_mfma_f32_16x16x32_bf16 v[116:119], v[24:27], v[68:71], v[116:119]
    v_mfma_f32_16x16x32_bf16 v[120:123], v[24:27], v[72:75], v[120:123]
    ds_read_b64_tr_b16 v[56:57], v17 offset:9344
    s_waitcnt lgkmcnt(13)
    ds_read_b64_tr_b16 v[58:59], v17 offset:11648
    v_mfma_f32_16x16x32_bf16 v[124:127], v[28:31], v[60:63], v[124:127]
    v_mfma_f32_16x16x32_bf16 v[128:131], v[28:31], v[64:67], v[128:131]
    v_mfma_f32_16x16x32_bf16 v[132:135], v[28:31], v[68:71], v[132:135]
    v_mfma_f32_16x16x32_bf16 v[136:139], v[28:31], v[72:75], v[136:139]
    s_waitcnt lgkmcnt(12)
    v_mfma_f32_16x16x32_bf16 v[140:143], v[32:35], v[60:63], v[140:143]
    v_mfma_f32_16x16x32_bf16 v[144:147], v[32:35], v[64:67], v[144:147]
    v_mfma_f32_16x16x32_bf16 v[148:151], v[32:35], v[68:71], v[148:151]
    v_mfma_f32_16x16x32_bf16 v[152:155], v[32:35], v[72:75], v[152:155]
    s_waitcnt vmcnt(5) lgkmcnt(0)
    s_barrier
    ds_read_b128 v[76:79], v14 offset:0
    ds_read_b128 v[80:83], v14 offset:1024
    ds_read_b128 v[84:87], v14 offset:2048
    s_add_u32 m0, s29, 0x8800
    s_nop 0
    buffer_load_dwordx4 v8, s[12:15], s31 offen lds
    v_mfma_f32_16x16x32_bf16 v[156:159], v[36:39], v[60:63], v[156:159]
    v_mfma_f32_16x16x32_bf16 v[160:163], v[36:39], v[64:67], v[160:163]
    v_mfma_f32_16x16x32_bf16 v[164:167], v[36:39], v[68:71], v[164:167]
    v_mfma_f32_16x16x32_bf16 v[168:171], v[36:39], v[72:75], v[168:171]
    ds_read_b128 v[88:91], v14 offset:3072
    ds_read_b64_tr_b16 v[20:21], v18 offset:0
    ds_read_b64_tr_b16 v[22:23], v18 offset:2304
    s_add_u32 m0, s29, 0xa800
    s_add_u32 s33, s31, 0x24000
    buffer_load_dwordx4 v8, s[12:15], s33 offen lds
    s_add_u32 s31, s31, 64
    v_mfma_f32_16x16x32_bf16 v[172:175], v[40:43], v[60:63], v[172:175]
    v_mfma_f32_16x16x32_bf16 v[176:179], v[40:43], v[64:67], v[176:179]
    v_mfma_f32_16x16x32_bf16 v[180:183], v[40:43], v[68:71], v[180:183]
    v_mfma_f32_16x16x32_bf16 v[184:187], v[40:43], v[72:75], v[184:187]
    ds_read_b64_tr_b16 v[24:25], v18 offset:9216
    ds_read_b64_tr_b16 v[26:27], v18 offset:11520
    ds_read_b64_tr_b16 v[28:29], v18 offset:32
    ds_read_b64_tr_b16 v[30:31], v18 offset:2336
    s_add_u32 m0, s29, 0xc800
    s_nop 0
    buffer_load_dwordx4 v9, s[16:19], s32 offen lds
    v_mfma_f32_16x16x32_bf16 v[188:191], v[44:47], v[60:63], v[188:191]
    v_mfma_f32_16x16x32_bf16 v[192:195], v[44:47], v[64:67], v[192:195]
    v_mfma_f32_16x16x32_bf16 v[196:199], v[44:47], v[68:71], v[196:199]
    v_mfma_f32_16x16x32_bf16 v[200:203], v[44:47], v[72:75], v[200:203]
    ds_read_b64_tr_b16 v[32:33], v18 offset:9248
    ds_read_b64_tr_b16 v[34:35], v18 offset:11552
    ds_read_b64_tr_b16 v[36:37], v18 offset:64
    ds_read_b64_tr_b16 v[38:39], v18 offset:2368
    s_add_u32 m0, s29, 0xec00
    s_nop 0
    buffer_load_dwordx4 v9, s[20:23], s32 offen lds
    v_mfma_f32_16x16x32_bf16 v[204:207], v[48:51], v[60:63], v[204:207]
    v_mfma_f32_16x16x32_bf16 v[208:211], v[48:51], v[64:67], v[208:211]
    v_mfma_f32_16x16x32_bf16 v[212:215], v[48:51], v[68:71], v[212:215]
    v_mfma_f32_16x16x32_bf16 v[216:219], v[48:51], v[72:75], v[216:219]
    ds_read_b64_tr_b16 v[40:41], v18 offset:9280
    s_waitcnt lgkmcnt(13)
    ds_read_b64_tr_b16 v[42:43], v18 offset:11584
    s_add_u32 m0, s30, 0xe800
    s_mov_b64 exec, 0xffff
    buffer_load_dwordx4 v10, s[40:43], s32 offen lds
    s_mov_b64 exec, -1
    s_add_u32 s32, s32, 0x48000
    v_mfma_f32_16x16x32_bf16 v[220:223], v[52:55], v[60:63], v[220:223]
    v_mfma_f32_16x16x32_bf16 v[224:227], v[52:55], v[64:67], v[224:227]
    v_mfma_f32_16x16x32_bf16 v[228:231], v[52:55], v[68:71], v[228:231]
    v_mfma_f32_16x16x32_bf16 v[232:235], v[52:55], v[72:75], v[232:235]
    ds_read_b64_tr_b16 v[44:45], v18 offset:96
    s_waitcnt lgkmcnt(13)
    ds_read_b64_tr_b16 v[46:47], v18 offset:2400
    v_mfma_f32_16x16x32_bf16 v[236:239], v[56:59], v[60:63], v[236:239]
    v_mfma_f32_16x16x32_bf16 v[240:243], v[56:59], v[64:67], v[240:243]
    v_mfma_f32_16x16x32_bf16 v[244:247], v[56:59], v[68:71], v[244:247]
    v_mfma_f32_16x16x32_bf16 v[248:251], v[56:59], v[72:75], v[248:251]
    ds_read_b64_tr_b16 v[48:49], v18 offset:9312
    s_waitcnt lgkmcnt(13)
    ds_read_b64_tr_b16 v[50:51], v18 offset:11616
    v_mfma_f32_16x16x32_bf16 v[92:95], v[20:23], v[76:79], v[92:95]
    v_mfma_f32_16x16x32_bf16 v[96:99], v[20:23], v[80:83], v[96:99]
    v_mfma_f32_16x16x32_bf16 v[100:103], v[20:23], v[84:87], v[100:103]
    v_mfma_f32_16x16x32_bf16 v[104:107], v[20:23], v[88:91], v[104:107]
    ds_read_b64_tr_b16 v[52:53], v18 offset:128
    s_waitcnt lgkmcnt(13)
    ds_read_b64_tr_b16 v[54:55], v18 offset:2432
    v_mfma_f32_16x16x32_bf16 v[108:111], v[24:27], v[76:79], v[108:111]
    v_mfma_f32_16x16x32_bf16 v[112:115], v[24:27], v[80:83], v[112:115]
    v_mfma_f32_16x16x32_bf16 v[116:119], v[24:27], v[84:87], v[116:119]
    v_mfma_f32_16x16x32_bf16 v[120:123], v[24:27], v[88:91], v[120:123]
    ds_read_b64_tr_b16 v[56:57], v18 offset:9344
    s_waitcnt lgkmcnt(13)
    ds_read_b64_tr_b16 v[58:59], v18 offset:11648
    v_mfma_f32_16x16x32_bf16 v[124:127], v[28:31], v[76:79], v[124:127]
    v_mfma_f32_16x16x32_bf16 v[128:131], v[28:31], v[80:83], v[128:131]
    v_mfma_f32_16x16x32_bf16 v[132:135], v[28:31], v[84:87], v[132:135]
    v_mfma_f32_16x16x32_bf16 v[136:139], v[28:31], v[88:91], v[136:139]
    s_waitcnt lgkmcnt(12)
    v_mfma_f32_16x16x32_bf16 v[140:143], v[32:35], v[76:79], v[140:143]
    v_mfma_f32_16x16x32_bf16 v[144:147], v[32:35], v[80:83], v[144:147]
    v_mfma_f32_16x16x32_bf16 v[148:151], v[32:35], v[84:87], v[148:151]
    v_mfma_f32_16x16x32_bf16 v[152:155], v[32:35], v[88:91], v[152:155]
    s_waitcnt vmcnt(5) lgkmcnt(0)
    s_barrier
    ds_read_b128 v[60:63], v12 offset:0
    ds_read_b128 v[64:67], v12 offset:1024
    ds_read_b128 v[68:71], v12 offset:2048
    s_add_u32 m0, s29, 0x11000
    s_nop 0
    buffer_load_dwordx4 v8, s[12:15], s31 offen lds
    v_mfma_f32_16x16x32_bf16 v[156:159], v[36:39], v[76:79], v[156:159]
    v_mfma_f32_16x16x32_bf16 v[160:163], v[36:39], v[80:83], v[160:163]
    v_mfma_f32_16x16x32_bf16 v[164:167], v[36:39], v[84:87], v[164:167]
    v_mfma_f32_16x16x32_bf16 v[168:171], v[36:39], v[88:91], v[168:171]
    ds_read_b128 v[72:75], v12 offset:3072
    ds_read_b64_tr_b16 v[20:21], v16 offset:0
    ds_read_b64_tr_b16 v[22:23], v16 offset:2304
    s_add_u32 m0, s29, 0x13000
    s_add_u32 s33, s31, 0x24000
    buffer_load_dwordx4 v8, s[12:15], s33 offen lds
    s_add_u32 s31, s31, 64
    v_mfma_f32_16x16x32_bf16 v[172:175], v[40:43], v[76:79], v[172:175]
    v_mfma_f32_16x16x32_bf16 v[176:179], v[40:43], v[80:83], v[176:179]
    v_mfma_f32_16x16x32_bf16 v[180:183], v[40:43], v[84:87], v[180:183]
    v_mfma_f32_16x16x32_bf16 v[184:187], v[40:43], v[88:91], v[184:187]
    ds_read_b64_tr_b16 v[24:25], v16 offset:9216
    ds_read_b64_tr_b16 v[26:27], v16 offset:11520
    ds_read_b64_tr_b16 v[28:29], v16 offset:32
    ds_read_b64_tr_b16 v[30:31], v16 offset:2336
    s_add_u32 m0, s29, 0x15000
    s_nop 0
    buffer_load_dwordx4 v9, s[16:19], s32 offen lds
    v_mfma_f32_16x16x32_bf16 v[188:191], v[44:47], v[76:79], v[188:191]
    v_mfma_f32_16x16x32_bf16 v[192:195], v[44:47], v[80:83], v[192:195]
    v_mfma_f32_16x16x32_bf16 v[196:199], v[44:47], v[84:87], v[196:199]
    v_mfma_f32_16x16x32_bf16 v[200:203], v[44:47], v[88:91], v[200:203]
    ds_read_b64_tr_b16 v[32:33], v16 offset:9248
    ds_read_b64_tr_b16 v[34:35], v16 offset:11552
    ds_read_b64_tr_b16 v[36:37], v16 offset:64
    ds_read_b64_tr_b16 v[38:39], v16 offset:2368
    s_add_u32 m0, s29, 0x17400
    s_nop 0
    buffer_load_dwordx4 v9, s[20:23], s32 offen lds
    v_mfma_f32_16x16x32_bf16 v[204:207], v[48:51], v[76:79], v[204:207]
    v_mfma_f32_16x16x32_bf16 v[208:211], v[48:51], v[80:83], v[208:211]
    v_mfma_f32_16x16x32_bf16 v[212:215], v[48:51], v[84:87], v[212:215]
    v_mfma_f32_16x16x32_bf16 v[216:219], v[48:51], v[88:91], v[216:219]
    ds_read_b64_tr_b16 v[40:41], v16 offset:9280
    s_waitcnt lgkmcnt(13)
    ds_read_b64_tr_b16 v[42:43], v16 offset:11584
    s_add_u32 m0, s30, 0x17000
    s_mov_b64 exec, 0xffff
    buffer_load_dwordx4 v10, s[40:43], s32 offen lds
    s_mov_b64 exec, -1
    s_add_u32 s32, s32, 0x48000
    v_mfma_f32_16x16x32_bf16 v[220:223], v[52:55], v[76:79], v[220:223]
    v_mfma_f32_16x16x32_bf16 v[224:227], v[52:55], v[80:83], v[224:227]
    v_mfma_f32_16x16x32_bf16 v[228:231], v[52:55], v[84:87], v[228:231]
    v_mfma_f32_16x16x32_bf16 v[232:235], v[52:55], v[88:91], v[232:235]
    ds_read_b64_tr_b16 v[44:45], v16 offset:96
    s_waitcnt lgkmcnt(13)
    ds_read_b64_tr_b16 v[46:47], v16 offset:2400
    v_mfma_f32_16x16x32_bf16 v[236:239], v[56:59], v[76:79], v[236:239]
    v_mfma_f32_16x16x32_bf16 v[240:243], v[56:59], v[80:83], v[240:243]
    v_mfma_f32_16x16x32_bf16 v[244:247], v[56:59], v[84:87], v[244:247]
    v_mfma_f32_16x16x32_bf16 v[248:251], v[56:59], v[88:91], v[248:251]
    ds_read_b64_tr_b16 v[48:49], v16 offset:9312
    s_waitcnt lgkmcnt(13)
    ds_read_b64_tr_b16 v[50:51], v16 offset:11616
    v_mfma_f32_16x16x32_bf16 v[92:95], v[20:23], v[60:63], v[92:95]
    v_mfma_f32_16x16x32_bf16 v[96:99], v[20:23], v[64:67], v[96:99]
    v_mfma_f32_16x16x32_bf16 v[100:103], v[20:23], v[68:71], v[100:103]
    v_mfma_f32_16x16x32_bf16 v[104:107], v[20:23], v[72:75], v[104:107]
    ds_read_b64_tr_b16 v[52:53], v16 offset:128
    s_waitcnt lgkmcnt(13)
    ds_read_b64_tr_b16 v[54:55], v16 offset:2432
    v_mfma_f32_16x16x32_bf16 v[108:111], v[24:27], v[60:63], v[108:111]
    v_mfma_f32_16x16x32_bf16 v[112:115], v[24:27], v[64:67], v[112:115]
    v_mfma_f32_16x16x32_bf16 v[116:119], v[24:27], v[68:71], v[116:119]
    v_mfma_f32_16x16x32_bf16 v[120:123], v[24:27], v[72:75], v[120:123]
    ds_read_b64_tr_b16 v[56:57], v16 offset:9344
    s_waitcnt lgkmcnt(13)
    ds_read_b64_tr_b16 v[58:59], v16 offset:11648
    v_mfma_f32_16x16x32_bf16 v[124:127], v[28:31], v[60:63], v[124:127]
    v_mfma_f32_16x16x32_bf16 v[128:131], v[28:31], v[64:67], v[128:131]
    v_mfma_f32_16x16x32_bf16 v[132:135], v[28:31], v[68:71], v[132:135]
    v_mfma_f32_16x16x32_bf16 v[136:139], v[28:31], v[72:75], v[136:139]
    s_waitcnt lgkmcnt(12)
    v_mfma_f32_16x16x32_bf16 v[140:143], v[32:35], v[60:63], v[140:143]
    v_mfma_f32_16x16x32_bf16 v[144:147], v[32:35], v[64:67], v[144:147]
    v_mfma_f32_16x16x32_bf16 v[148:151], v[32:35], v[68:71], v[148:151]
    v_mfma_f32_16x16x32_bf16 v[152:155], v[32:35], v[72:75], v[152:155]
    s_waitcnt vmcnt(5) lgkmcnt(0)
    s_barrier
    ds_read_b128 v[76:79], v13 offset:0
    ds_read_b128 v[80:83], v13 offset:1024
    ds_read_b128 v[84:87], v13 offset:2048
    s_add_u32 m0, s29, 0x0
    s_nop 0
    buffer_load_dwordx4 v8, s[12:15], s31 offen lds
    v_mfma_f32_16x16x32_bf16 v[156:159], v[36:39], v[60:63], v[156:159]
    v_mfma_f32_16x16x32_bf16 v[160:163], v[36:39], v[64:67], v[160:163]
    v_mfma_f32_16x16x32_bf16 v[164:167], v[36:39], v[68:71], v[164:167]
    v_mfma_f32_16x16x32_bf16 v[168:171], v[36:39], v[72:75], v[168:171]
    ds_read_b128 v[88:91], v13 offset:3072
    ds_read_b64_tr_b16 v[20:21], v17 offset:0
    ds_read_b64_tr_b16 v[22:23], v17 offset:2304
    s_add_u32 m0, s29, 0x2000
    s_add_u32 s33, s31, 0x24000
    buffer_load_dwordx4 v8, s[12:15], s33 offen lds
    s_add_u32 s31, s31, 64
    v_mfma_f32_16x16x32_bf16 v[172:175], v[40:43], v[60:63], v[172:175]
    v_mfma_f32_16x16x32_bf16 v[176:179], v[40:43], v[64:67], v[176:179]
    v_mfma_f32_16x16x32_bf16 v[180:183], v[40:43], v[68:71], v[180:183]
    v_mfma_f32_16x16x32_bf16 v[184:187], v[40:43], v[72:75], v[184:187]
    ds_read_b64_tr_b16 v[24:25], v17 offset:9216
    ds_read_b64_tr_b16 v[26:27], v17 offset:11520
    ds_read_b64_tr_b16 v[28:29], v17 offset:32
    ds_read_b64_tr_b16 v[30:31], v17 offset:2336
    s_add_u32 m0, s29, 0x4000
    s_nop 0
    buffer_load_dwordx4 v9, s[16:19], s32 offen lds
    v_mfma_f32_16x16x32_bf16 v[188:191], v[44:47], v[60:63], v[188:191]
    v_mfma_f32_16x16x32_bf16 v[192:195], v[44:47], v[64:67], v[192:195]
    v_mfma_f32_16x16x32_bf16 v[196:199], v[44:47], v[68:71], v[196:199]
    v_mfma_f32_16x16x32_bf16 v[200:203], v[44:47], v[72:75], v[200:203]
    ds_read_b64_tr_b16 v[32:33], v17 offset:9248
    ds_read_b64_tr_b16 v[34:35], v17 offset:11552
    ds_read_b64_tr_b16 v[36:37], v17 offset:64
    ds_read_b64_tr_b16 v[38:39], v17 offset:2368
    s_add_u32 m0, s29, 0x6400
    s_nop 0
    buffer_load_dwordx4 v9, s[20:23], s32 offen lds
    v_mfma_f32_16x16x32_bf16 v[204:207], v[48:51], v[60:63], v[204:207]
    v_mfma_f32_16x16x32_bf16 v[208:211], v[48:51], v[64:67], v[208:211]
    v_mfma_f32_16x16x32_bf16 v[212:215], v[48:51], v[68:71], v[212:215]
    v_mfma_f32_16x16x32_bf16 v[216:219], v[48:51], v[72:75], v[216:219]
    ds_read_b64_tr_b16 v[40:41], v17 offset:9280
    s_waitcnt lgkmcnt(13)
    ds_read_b64_tr_b16 v[42:43], v17 offset:11584
    s_add_u32 m0, s30, 0x6000
    s_mov_b64 exec, 0xffff
    buffer_load_dwordx4 v10, s[40:43], s32 offen lds
    s_mov_b64 exec, -1
    s_add_u32 s32, s32, 0x48000
    v_mfma_f32_16x16x32_bf16 v[220:223], v[52:55], v[60:63], v[220:223]
    v_mfma_f32_16x16x32_bf16 v[224:227], v[52:55], v[64:67], v[224:227]
    v_mfma_f32_16x16x32_bf16 v[228:231], v[52:55], v[68:71], v[228:231]
    v_mfma_f32_16x16x32_bf16 v[232:235], v[52:55], v[72:75], v[232:235]
    ds_read_b64_tr_b16 v[44:45], v17 offset:96
    s_waitcnt lgkmcnt(13)
    ds_read_b64_tr_b16 v[46:47], v17 offset:2400
    v_mfma_f32_16x16x32_bf16 v[236:239], v[56:59], v[60:63], v[236:239]
    v_mfma_f32_16x16x32_bf16 v[240:243], v[56:59], v[64:67], v[240:243]
    v_mfma_f32_16x16x32_bf16 v[244:247], v[56:59], v[68:71], v[244:247]
    v_mfma_f32_16x16x32_bf16 v[248:251], v[56:59], v[72:75], v[248:251]
    ds_read_b64_tr_b16 v[48:49], v17 offset:9312
    s_waitcnt lgkmcnt(13)
    ds_read_b64_tr_b16 v[50:51], v17 offset:11616
    v_mfma_f32_16x16x32_bf16 v[92:95], v[20:23], v[76:79], v[92:95]
    v_mfma_f32_16x16x32_bf16 v[96:99], v[20:23], v[80:83], v[96:99]
    v_mfma_f32_16x16x32_bf16 v[100:103], v[20:23], v[84:87], v[100:103]
    v_mfma_f32_16x16x32_bf16 v[104:107], v[20:23], v[88:91], v[104:107]
    ds_read_b64_tr_b16 v[52:53], v17 offset:128
    s_waitcnt lgkmcnt(13)
    ds_read_b64_tr_b16 v[54:55], v17 offset:2432
    v_mfma_f32_16x16x32_bf16 v[108:111], v[24:27], v[76:79], v[108:111]
    v_mfma_f32_16x16x32_bf16 v[112:115], v[24:27], v[80:83], v[112:115]
    v_mfma_f32_16x16x32_bf16 v[116:119], v[24:27], v[84:87], v[116:119]
    v_mfma_f32_16x16x32_bf16 v[120:123], v[24:27], v[88:91], v[120:123]
    ds_read_b64_tr_b16 v[56:57], v17 offset:9344
    s_waitcnt lgkmcnt(13)
    ds_read_b64_tr_b16 v[58:59], v17 offset:11648
    v_mfma_f32_16x16x32_bf16 v[124:127], v[28:31], v[76:79], v[124:127]
    v_mfma_f32_16x16x32_bf16 v[128:131], v[28:31], v[80:83], v[128:131]
    v_mfma_f32_16x16x32_bf16 v[132:135], v[28:31], v[84:87], v[132:135]
    v_mfma_f32_16x16x32_bf16 v[136:139], v[28:31], v[88:91], v[136:139]
    s_waitcnt lgkmcnt(12)
    v_mfma_f32_16x16x32_bf16 v[140:143], v[32:35], v[76:79], v[140:143]
    v_mfma_f32_16x16x32_bf16 v[144:147], v[32:35], v[80:83], v[144:147]
    v_mfma_f32_16x16x32_bf16 v[148:151], v[32:35], v[84:87], v[148:151]
    v_mfma_f32_16x16x32_bf16 v[152:155], v[32:35], v[88:91], v[152:155]
    s_waitcnt vmcnt(5) lgkmcnt(0)
    s_barrier
    ds_read_b128 v[60:63], v14 offset:0
    ds_read_b128 v[64:67], v14 offset:1024
    ds_read_b128 v[68:71], v14 offset:2048
    s_add_u32 m0, s29, 0x8800
    s_nop 0
    buffer_load_dwordx4 v8, s[12:15], s31 offen lds
    v_mfma_f32_16x16x32_bf16 v[156:159], v[36:39], v[76:79], v[156:159]
    v_mfma_f32_16x16x32_bf16 v[160:163], v[36:39], v[80:83], v[160:163]
    v_mfma_f32_16x16x32_bf16 v[164:167], v[36:39], v[84:87], v[164:167]
    v_mfma_f32_16x16x32_bf16 v[168:171], v[36:39], v[88:91], v[168:171]
    ds_read_b128 v[72:75], v14 offset:3072
    ds_read_b64_tr_b16 v[20:21], v18 offset:0
    ds_read_b64_tr_b16 v[22:23], v18 offset:2304
    s_add_u32 m0, s29, 0xa800
    s_add_u32 s33, s31, 0x24000
    buffer_load_dwordx4 v8, s[12:15], s33 offen lds
    s_add_u32 s31, s31, 64
    v_mfma_f32_16x16x32_bf16 v[172:175], v[40:43], v[76:79], v[172:175]
    v_mfma_f32_16x16x32_bf16 v[176:179], v[40:43], v[80:83], v[176:179]
    v_mfma_f32_16x16x32_bf16 v[180:183], v[40:43], v[84:87], v[180:183]
    v_mfma_f32_16x16x32_bf16 v[184:187], v[40:43], v[88:91], v[184:187]
    ds_read_b64_tr_b16 v[24:25], v18 offset:9216
    ds_read_b64_tr_b16 v[26:27], v18 offset:11520
    ds_read_b64_tr_b16 v[28:29], v18 offset:32
    ds_read_b64_tr_b16 v[30:31], v18 offset:2336
    s_add_u32 m0, s29, 0xc800
    s_nop 0
    buffer_load_dwordx4 v9, s[16:19], s32 offen lds
    v_mfma_f32_16x16x32_bf16 v[188:191], v[44:47], v[76:79], v[188:191]
    v_mfma_f32_16x16x32_bf16 v[192:195], v[44:47], v[80:83], v[192:195]
    v_mfma_f32_16x16x32_bf16 v[196:199], v[44:47], v[84:87], v[196:199]
    v_mfma_f32_16x16x32_bf16 v[200:203], v[44:47], v[88:91], v[200:203]
    ds_read_b64_tr_b16 v[32:33], v18 offset:9248
    ds_read_b64_tr_b16 v[34:35], v18 offset:11552
    ds_read_b64_tr_b16 v[36:37], v18 offset:64
    ds_read_b64_tr_b16 v[38:39], v18 offset:2368
    s_add_u32 m0, s29, 0xec00
    s_nop 0
    buffer_load_dwordx4 v9, s[20:23], s32 offen lds
    v_mfma_f32_16x16x32_bf16 v[204:207], v[48:51], v[76:79], v[204:207]
    v_mfma_f32_16x16x32_bf16 v[208:211], v[48:51], v[80:83], v[208:211]
    v_mfma_f32_16x16x32_bf16 v[212:215], v[48:51], v[84:87], v[212:215]
    v_mfma_f32_16x16x32_bf16 v[216:219], v[48:51], v[88:91], v[216:219]
    ds_read_b64_tr_b16 v[40:41], v18 offset:9280
    s_waitcnt lgkmcnt(13)
    ds_read_b64_tr_b16 v[42:43], v18 offset:11584
    s_add_u32 m0, s30, 0xe800
    s_mov_b64 exec, 0xffff
    buffer_load_dwordx4 v10, s[40:43], s32 offen lds
    s_mov_b64 exec, -1
    s_add_u32 s32, s32, 0x48000
    v_mfma_f32_16x16x32_bf16 v[220:223], v[52:55], v[76:79], v[220:223]
    v_mfma_f32_16x16x32_bf16 v[224:227], v[52:55], v[80:83], v[224:227]
    v_mfma_f32_16x16x32_bf16 v[228:231], v[52:55], v[84:87], v[228:231]
    v_mfma_f32_16x16x32_bf16 v[232:235], v[52:55], v[88:91], v[232:235]
    ds_read_b64_tr_b16 v[44:45], v18 offset:96
    s_waitcnt lgkmcnt(13)
    ds_read_b64_tr_b16 v[46:47], v18 offset:2400
    v_mfma_f32_16x16x32_bf16 v[236:239], v[56:59], v[76:79], v[236:239]
    v_mfma_f32_16x16x32_bf16 v[240:243], v[56:59], v[80:83], v[240:243]
    v_mfma_f32_16x16x32_bf16 v[244:247], v[56:59], v[84:87], v[244:247]
    v_mfma_f32_16x16x32_bf16 v[248:251], v[56:59], v[88:91], v[248:251]
    ds_read_b64_tr_b16 v[48:49], v18 offset:9312
    s_waitcnt lgkmcnt(13)
    ds_read_b64_tr_b16 v[50:51], v18 offset:11616
    v_mfma_f32_16x16x32_bf16 v[92:95], v[20:23], v[60:63], v[92:95]
    v_mfma_f32_16x16x32_bf16 v[96:99], v[20:23], v[64:67], v[96:99]
    v_mfma_f32_16x16x32_bf16 v[100:103], v[20:23], v[68:71], v[100:103]
    v_mfma_f32_16x16x32_bf16 v[104:107], v[20:23], v[72:75], v[104:107]
    ds_read_b64_tr_b16 v[52:53], v18 offset:128
    s_waitcnt lgkmcnt(13)
    ds_read_b64_tr_b16 v[54:55], v18 offset:2432
    v_mfma_f32_16x16x32_bf16 v[108:111], v[24:27], v[60:63], v[108:111]
    v_mfma_f32_16x16x32_bf16 v[112:115], v[24:27], v[64:67], v[112:115]
    v_mfma_f32_16x16x32_bf16 v[116:119], v[24:27], v[68:71], v[116:119]
    v_mfma_f32_16x16x32_bf16 v[120:123], v[24:27], v[72:75], v[120:123]
    ds_read_b64_tr_b16 v[56:57], v18 offset:9344
    s_waitcnt lgkmcnt(13)
    ds_read_b64_tr_b16 v[58:59], v18 offset:11648
    v_mfma_f32_16x16x32_bf16 v[124:127], v[28:31], v[60:63], v[124:127]
    v_mfma_f32_16x16x32_bf16 v[128:131], v[28:31], v[64:67], v[128:131]
    v_mfma_f32_16x16x32_bf16 v[132:135], v[28:31], v[68:71], v[132:135]
    v_mfma_f32_16x16x32_bf16 v[136:139], v[28:31], v[72:75], v[136:139]
    s_waitcnt lgkmcnt(12)
    v_mfma_f32_16x16x32_bf16 v[140:143], v[32:35], v[60:63], v[140:143]
    v_mfma_f32_16x16x32_bf16 v[144:147], v[32:35], v[64:67], v[144:147]
    v_mfma_f32_16x16x32_bf16 v[148:151], v[32:35], v[68:71], v[148:151]
    v_mfma_f32_16x16x32_bf16 v[152:155], v[32:35], v[72:75], v[152:155]
    s_waitcnt vmcnt(5) lgkmcnt(0)
    s_barrier
    ds_read_b128 v[76:79], v12 offset:0
    ds_read_b128 v[80:83], v12 offset:1024
    ds_read_b128 v[84:87], v12 offset:2048
    s_add_u32 m0, s29, 0x11000
    s_nop 0
    buffer_load_dwordx4 v8, s[12:15], s31 offen lds
    v_mfma_f32_16x16x32_bf16 v[156:159], v[36:39], v[60:63], v[156:159]
    v_mfma_f32_16x16x32_bf16 v[160:163], v[36:39], v[64:67], v[160:163]
    v_mfma_f32_16x16x32_bf16 v[164:167], v[36:39], v[68:71], v[164:167]
    v_mfma_f32_16x16x32_bf16 v[168:171], v[36:39], v[72:75], v[168:171]
    ds_read_b128 v[88:91], v12 offset:3072
    ds_read_b64_tr_b16 v[20:21], v16 offset:0
    ds_read_b64_tr_b16 v[22:23], v16 offset:2304
    s_add_u32 m0, s29, 0x13000
    s_add_u32 s33, s31, 0x24000
    buffer_load_dwordx4 v8, s[12:15], s33 offen lds
    s_add_u32 s31, s31, 64
    v_mfma_f32_16x16x32_bf16 v[172:175], v[40:43], v[60:63], v[172:175]
    v_mfma_f32_16x16x32_bf16 v[176:179], v[40:43], v[64:67], v[176:179]
    v_mfma_f32_16x16x32_bf16 v[180:183], v[40:43], v[68:71], v[180:183]
    v_mfma_f32_16x16x32_bf16 v[184:187], v[40:43], v[72:75], v[184:187]
    ds_read_b64_tr_b16 v[24:25], v16 offset:9216
    ds_read_b64_tr_b16 v[26:27], v16 offset:11520
    ds_read_b64_tr_b16 v[28:29], v16 offset:32
    ds_read_b64_tr_b16 v[30:31], v16 offset:2336
    s_add_u32 m0, s29, 0x15000
    s_nop 0
    buffer_load_dwordx4 v9, s[16:19], s32 offen lds
    v_mfma_f32_16x16x32_bf16 v[188:191], v[44:47], v[60:63], v[188:191]
    v_mfma_f32_16x16x32_bf16 v[192:195], v[44:47], v[64:67], v[192:195]
    v_mfma_f32_16x16x32_bf16 v[196:199], v[44:47], v[68:71], v[196:199]
    v_mfma_f32_16x16x32_bf16 v[200:203], v[44:47], v[72:75], v[200:203]
    ds_read_b64_tr_b16 v[32:33], v16 offset:9248
    ds_read_b64_tr_b16 v[34:35], v16 offset:11552
    ds_read_b64_tr_b16 v[36:37], v16 offset:64
    ds_read_b64_tr_b16 v[38:39], v16 offset:2368
    s_add_u32 m0, s29, 0x17400
    s_nop 0
    buffer_load_dwordx4 v9, s[20:23], s32 offen lds
    v_mfma_f32_16x16x32_bf16 v[204:207], v[48:51], v[60:63], v[204:207]
    v_mfma_f32_16x16x32_bf16 v[208:211], v[48:51], v[64:67], v[208:211]
    v_mfma_f32_16x16x32_bf16 v[212:215], v[48:51], v[68:71], v[212:215]
    v_mfma_f32_16x16x32_bf16 v[216:219], v[48:51], v[72:75], v[216:219]
    ds_read_b64_tr_b16 v[40:41], v16 offset:9280
    s_waitcnt lgkmcnt(13)
    ds_read_b64_tr_b16 v[42:43], v16 offset:11584
    s_add_u32 m0, s30, 0x17000
    s_mov_b64 exec, 0xffff
    buffer_load_dwordx4 v10, s[40:43], s32 offen lds
    s_mov_b64 exec, -1
    s_add_u32 s32, s32, 0x48000
    v_mfma_f32_16x16x32_bf16 v[220:223], v[52:55], v[60:63], v[220:223]
    v_mfma_f32_16x16x32_bf16 v[224:227], v[52:55], v[64:67], v[224:227]
    v_mfma_f32_16x16x32_bf16 v[228:231], v[52:55], v[68:71], v[228:231]
    v_mfma_f32_16x16x32_bf16 v[232:235], v[52:55], v[72:75], v[232:235]
    ds_read_b64_tr_b16 v[44:45], v16 offset:96
    s_waitcnt lgkmcnt(13)
    ds_read_b64_tr_b16 v[46:47], v16 offset:2400
    v_mfma_f32_16x16x32_bf16 v[236:239], v[56:59], v[60:63], v[236:239]
    v_mfma_f32_16x16x32_bf16 v[240:243], v[56:59], v[64:67], v[240:243]
    v_mfma_f32_16x16x32_bf16 v[244:247], v[56:59], v[68:71], v[244:247]
    v_mfma_f32_16x16x32_bf16 v[248:251], v[56:59], v[72:75], v[248:251]
    ds_read_b64_tr_b16 v[48:49], v16 offset:9312
    s_waitcnt lgkmcnt(13)
    ds_read_b64_tr_b16 v[50:51], v16 offset:11616
    v_mfma_f32_16x16x32_bf16 v[92:95], v[20:23], v[76:79], v[92:95]
    v_mfma_f32_16x16x32_bf16 v[96:99], v[20:23], v[80:83], v[96:99]
    v_mfma_f32_16x16x32_bf16 v[100:103], v[20:23], v[84:87], v[100:103]
    v_mfma_f32_16x16x32_bf16 v[104:107], v[20:23], v[88:91], v[104:107]
    ds_read_b64_tr_b16 v[52:53], v16 offset:128
    s_waitcnt lgkmcnt(13)
    ds_read_b64_tr_b16 v[54:55], v16 offset:2432
    v_mfma_f32_16x16x32_bf16 v[108:111], v[24:27], v[76:79], v[108:111]
    v_mfma_f32_16x16x32_bf16 v[112:115], v[24:27], v[80:83], v[112:115]
    v_mfma_f32_16x16x32_bf16 v[116:119], v[24:27], v[84:87], v[116:119]
    v_mfma_f32_16x16x32_bf16 v[120:123], v[24:27], v[88:91], v[120:123]
    ds_read_b64_tr_b16 v[56:57], v16 offset:9344
    s_waitcnt lgkmcnt(13)
    ds_read_b64_tr_b16 v[58:59], v16 offset:11648
    v_mfma_f32_16x16x32_bf16 v[124:127], v[28:31], v[76:79], v[124:127]
    v_mfma_f32_16x16x32_bf16 v[128:131], v[28:31], v[80:83], v[128:131]
    v_mfma_f32_16x16x32_bf16 v[132:135], v[28:31], v[84:87], v[132:135]
    v_mfma_f32_16x16x32_bf16 v[136:139], v[28:31], v[88:91], v[136:139]
    s_waitcnt lgkmcnt(12)
    v_mfma_f32_16x16x32_bf16 v[140:143], v[32:35], v[76:79], v[140:143]
    v_mfma_f32_16x16x32_bf16 v[144:147], v[32:35], v[80:83], v[144:147]
    v_mfma_f32_16x16x32_bf16 v[148:151], v[32:35], v[84:87], v[148:151]
    v_mfma_f32_16x16x32_bf16 v[152:155], v[32:35], v[88:91], v[152:155]
    s_waitcnt vmcnt(5) lgkmcnt(0)
    s_barrier
    ds_read_b128 v[60:63], v13 offset:0
    ds_read_b128 v[64:67], v13 offset:1024
    ds_read_b128 v[68:71], v13 offset:2048
    v_mfma_f32_16x16x32_bf16 v[156:159], v[36:39], v[76:79], v[156:159]
    v_mfma_f32_16x16x32_bf16 v[160:163], v[36:39], v[80:83], v[160:163]
    v_mfma_f32_16x16x32_bf16 v[164:167], v[36:39], v[84:87], v[164:167]
    v_mfma_f32_16x16x32_bf16 v[168:171], v[36:39], v[88:91], v[168:171]
    ds_read_b128 v[72:75], v13 offset:3072
    ds_read_b64_tr_b16 v[20:21], v17 offset:0
    ds_read_b64_tr_b16 v[22:23], v17 offset:2304
    v_mfma_f32_16x16x32_bf16 v[172:175], v[40:43], v[76:79], v[172:175]
    v_mfma_f32_16x16x32_bf16 v[176:179], v[40:43], v[80:83], v[176:179]
    v_mfma_f32_16x16x32_bf16 v[180:183], v[40:43], v[84:87], v[180:183]
    v_mfma_f32_16x16x32_bf16 v[184:187], v[40:43], v[88:91], v[184:187]
    ds_read_b64_tr_b16 v[24:25], v17 offset:9216
    ds_read_b64_tr_b16 v[26:27], v17 offset:11520
    ds_read_b64_tr_b16 v[28:29], v17 offset:32
    ds_read_b64_tr_b16 v[30:31], v17 offset:2336
    v_mfma_f32_16x16x32_bf16 v[188:191], v[44:47], v[76:79], v[188:191]
    v_mfma_f32_16x16x32_bf16 v[192:195], v[44:47], v[80:83], v[192:195]
    v_mfma_f32_16x16x32_bf16 v[196:199], v[44:47], v[84:87], v[196:199]
    v_mfma_f32_16x16x32_bf16 v[200:203], v[44:47], v[88:91], v[200:203]
    ds_read_b64_tr_b16 v[32:33], v17 offset:9248
    ds_read_b64_tr_b16 v[34:35], v17 offset:11552
    ds_read_b64_tr_b16 v[36:37], v17 offset:64
    ds_read_b64_tr_b16 v[38:39], v17 offset:2368
    v_mfma_f32_16x16x32_bf16 v[204:207], v[48:51], v[76:79], v[204:207]
    v_mfma_f32_16x16x32_bf16 v[208:211], v[48:51], v[80:83], v[208:211]
    v_mfma_f32_16x16x32_bf16 v[212:215], v[48:51], v[84:87], v[212:215]
    v_mfma_f32_16x16x32_bf16 v[216:219], v[48:51], v[88:91], v[216:219]
    ds_read_b64_tr_b16 v[40:41], v17 offset:9280
    s_waitcnt lgkmcnt(13)
    ds_read_b64_tr_b16 v[42:43], v17 offset:11584
    v_mfma_f32_16x16x32_bf16 v[220:223], v[52:55], v[76:79], v[220:223]
    v_mfma_f32_16x16x32_bf16 v[224:227], v[52:55], v[80:83], v[224:227]
    v_mfma_f32_16x16x32_bf16 v[228:231], v[52:55], v[84:87], v[228:231]
    v_mfma_f32_16x16x32_bf16 v[232:235], v[52:55], v[88:91], v[232:235]
    ds_read_b64_tr_b16 v[44:45], v17 offset:96
    s_waitcnt lgkmcnt(13)
    ds_read_b64_tr_b16 v[46:47], v17 offset:2400
    v_mfma_f32_16x16x32_bf16 v[236:239], v[56:59], v[76:79], v[236:239]
    v_mfma_f32_16x16x32_bf16 v[240:243], v[56:59], v[80:83], v[240:243]
    v_mfma_f32_16x16x32_bf16 v[244:247], v[56:59], v[84:87], v[244:247]
    v_mfma_f32_16x16x32_bf16 v[248:251], v[56:59], v[88:91], v[248:251]
    ds_read_b64_tr_b16 v[48:49], v17 offset:9312
    s_waitcnt lgkmcnt(13)
    ds_read_b64_tr_b16 v[50:51], v17 offset:11616
    v_mfma_f32_16x16x32_bf16 v[92:95], v[20:23], v[60:63], v[92:95]
    v_mfma_f32_16x16x32_bf16 v[96:99], v[20:23], v[64:67], v[96:99]
    v_mfma_f32_16x16x32_bf16 v[100:103], v[20:23], v[68:71], v[100:103]
    v_mfma_f32_16x16x32_bf16 v[104:107], v[20:23], v[72:75], v[104:107]
    ds_read_b64_tr_b16 v[52:53], v17 offset:128
    s_waitcnt lgkmcnt(13)
    ds_read_b64_tr_b16 v[54:55], v17 offset:2432
    v_mfma_f32_16x16x32_bf16 v[108:111], v[24:27], v[60:63], v[108:111]
    v_mfma_f32_16x16x32_bf16 v[112:115], v[24:27], v[64:67], v[112:115]
    v_mfma_f32_16x16x32_bf16 v[116:119], v[24:27], v[68:71], v[116:119]
    v_mfma_f32_16x16x32_bf16 v[120:123], v[24:27], v[72:75], v[120:123]
    ds_read_b64_tr_b16 v[56:57], v17 offset:9344
    s_waitcnt lgkmcnt(13)
    ds_read_b64_tr_b16 v[58:59], v17 offset:11648
    v_mfma_f32_16x16x32_bf16 v[124:127], v[28:31], v[60:63], v[124:127]
    v_mfma_f32_16x16x32_bf16 v[128:131], v[28:31], v[64:67], v[128:131]
    v_mfma_f32_16x16x32_bf16 v[132:135], v[28:31], v[68:71], v[132:135]
    v_mfma_f32_16x16x32_bf16 v[136:139], v[28:31], v[72:75], v[136:139]
    s_waitcnt lgkmcnt(12)
    v_mfma_f32_16x16x32_bf16 v[140:143], v[32:35], v[60:63], v[140:143]
    v_mfma_f32_16x16x32_bf16 v[144:147], v[32:35], v[64:67], v[144:147]
    v_mfma_f32_16x16x32_bf16 v[148:151], v[32:35], v[68:71], v[148:151]
    v_mfma_f32_16x16x32_bf16 v[152:155], v[32:35], v[72:75], v[152:155]
    s_waitcnt vmcnt(0) lgkmcnt(0)
    s_barrier
    ds_read_b128 v[76:79], v14 offset:0
    ds_read_b128 v[80:83], v14 offset:1024
    ds_read_b128 v[84:87], v14 offset:2048
    v_mfma_f32_16x16x32_bf16 v[156:159], v[36:39], v[60:63], v[156:159]
    v_mfma_f32_16x16x32_bf16 v[160:163], v[36:39], v[64:67], v[160:163]
    v_mfma_f32_16x16x32_bf16 v[164:167], v[36:39], v[68:71], v[164:167]
    v_mfma_f32_16x16x32_bf16 v[168:171], v[36:39], v[72:75], v[168:171]
    ds_read_b128 v[88:91], v14 offset:3072
    ds_read_b64_tr_b16 v[20:21], v18 offset:0
    ds_read_b64_tr_b16 v[22:23], v18 offset:2304
    v_mfma_f32_16x16x32_bf16 v[172:175], v[40:43], v[60:63], v[172:175]
    v_mfma_f32_16x16x32_bf16 v[176:179], v[40:43], v[64:67], v[176:179]
    v_mfma_f32_16x16x32_bf16 v[180:183], v[40:43], v[68:71], v[180:183]
    v_mfma_f32_16x16x32_bf16 v[184:187], v[40:43], v[72:75], v[184:187]
    ds_read_b64_tr_b16 v[24:25], v18 offset:9216
    ds_read_b64_tr_b16 v[26:27], v18 offset:11520
    ds_read_b64_tr_b16 v[28:29], v18 offset:32
    ds_read_b64_tr_b16 v[30:31], v18 offset:2336
    v_mfma_f32_16x16x32_bf16 v[188:191], v[44:47], v[60:63], v[188:191]
    v_mfma_f32_16x16x32_bf16 v[192:195], v[44:47], v[64:67], v[192:195]
    v_mfma_f32_16x16x32_bf16 v[196:199], v[44:47], v[68:71], v[196:199]
    v_mfma_f32_16x16x32_bf16 v[200:203], v[44:47], v[72:75], v[200:203]
    ds_read_b64_tr_b16 v[32:33], v18 offset:9248
    ds_read_b64_tr_b16 v[34:35], v18 offset:11552
    ds_read_b64_tr_b16 v[36:37], v18 offset:64
    ds_read_b64_tr_b16 v[38:39], v18 offset:2368
    v_mfma_f32_16x16x32_bf16 v[204:207], v[48:51], v[60:63], v[204:207]
    v_mfma_f32_16x16x32_bf16 v[208:211], v[48:51], v[64:67], v[208:211]
    v_mfma_f32_16x16x32_bf16 v[212:215], v[48:51], v[68:71], v[212:215]
    v_mfma_f32_16x16x32_bf16 v[216:219], v[48:51], v[72:75], v[216:219]
    ds_read_b64_tr_b16 v[40:41], v18 offset:9280
    s_waitcnt lgkmcnt(13)
    ds_read_b64_tr_b16 v[42:43], v18 offset:11584
    v_mfma_f32_16x16x32_bf16 v[220:223], v[52:55], v[60:63], v[220:223]
    v_mfma_f32_16x16x32_bf16 v[224:227], v[52:55], v[64:67], v[224:227]
    v_mfma_f32_16x16x32_bf16 v[228:231], v[52:55], v[68:71], v[228:231]
    v_mfma_f32_16x16x32_bf16 v[232:235], v[52:55], v[72:75], v[232:235]
    ds_read_b64_tr_b16 v[44:45], v18 offset:96
    s_waitcnt lgkmcnt(13)
    ds_read_b64_tr_b16 v[46:47], v18 offset:2400
    v_mfma_f32_16x16x32_bf16 v[236:239], v[56:59], v[60:63], v[236:239]
    v_mfma_f32_16x16x32_bf16 v[240:243], v[56:59], v[64:67], v[240:243]
    v_mfma_f32_16x16x32_bf16 v[244:247], v[56:59], v[68:71], v[244:247]
    v_mfma_f32_16x16x32_bf16 v[248:251], v[56:59], v[72:75], v[248:251]
    ds_read_b64_tr_b16 v[48:49], v18 offset:9312
    s_waitcnt lgkmcnt(13)
    ds_read_b64_tr_b16 v[50:51], v18 offset:11616
    v_mfma_f32_16x16x32_bf16 v[92:95], v[20:23], v[76:79], v[92:95]
    v_mfma_f32_16x16x32_bf16 v[96:99], v[20:23], v[80:83], v[96:99]
    v_mfma_f32_16x16x32_bf16 v[100:103], v[20:23], v[84:87], v[100:103]
    v_mfma_f32_16x16x32_bf16 v[104:107], v[20:23], v[88:91], v[104:107]
    ds_read_b64_tr_b16 v[52:53], v18 offset:128
    s_waitcnt lgkmcnt(13)
    ds_read_b64_tr_b16 v[54:55], v18 offset:2432
    v_mfma_f32_16x16x32_bf16 v[108:111], v[24:27], v[76:79], v[108:111]
    v_mfma_f32_16x16x32_bf16 v[112:115], v[24:27], v[80:83], v[112:115]
    v_mfma_f32_16x16x32_bf16 v[116:119], v[24:27], v[84:87], v[116:119]
    v_mfma_f32_16x16x32_bf16 v[120:123], v[24:27], v[88:91], v[120:123]
    ds_read_b64_tr_b16 v[56:57], v18 offset:9344
    s_waitcnt lgkmcnt(13)
    ds_read_b64_tr_b16 v[58:59], v18 offset:11648
    v_mfma_f32_16x16x32_bf16 v[124:127], v[28:31], v[76:79], v[124:127]
    v_mfma_f32_16x16x32_bf16 v[128:131], v[28:31], v[80:83], v[128:131]
    v_mfma_f32_16x16x32_bf16 v[132:135], v[28:31], v[84:87], v[132:135]
    v_mfma_f32_16x16x32_bf16 v[136:139], v[28:31], v[88:91], v[136:139]
    s_waitcnt lgkmcnt(12)
    v_mfma_f32_16x16x32_bf16 v[140:143], v[32:35], v[76:79], v[140:143]
    v_mfma_f32_16x16x32_bf16 v[144:147], v[32:35], v[80:83], v[144:147]
    v_mfma_f32_16x16x32_bf16 v[148:151], v[32:35], v[84:87], v[148:151]
    v_mfma_f32_16x16x32_bf16 v[152:155], v[32:35], v[88:91], v[152:155]
    s_waitcnt lgkmcnt(10)
    v_mfma_f32_16x16x32_bf16 v[156:159], v[36:39], v[76:79], v[156:159]
    v_mfma_f32_16x16x32_bf16 v[160:163], v[36:39], v[80:83], v[160:163]
    v_mfma_f32_16x16x32_bf16 v[164:167], v[36:39], v[84:87], v[164:167]
    v_mfma_f32_16x16x32_bf16 v[168:171], v[36:39], v[88:91], v[168:171]
    s_waitcnt lgkmcnt(8)
    v_mfma_f32_16x16x32_bf16 v[172:175], v[40:43], v[76:79], v[172:175]
    v_mfma_f32_16x16x32_bf16 v[176:179], v[40:43], v[80:83], v[176:179]
    v_mfma_f32_16x16x32_bf16 v[180:183], v[40:43], v[84:87], v[180:183]
    v_mfma_f32_16x16x32_bf16 v[184:187], v[40:43], v[88:91], v[184:187]
    s_waitcnt lgkmcnt(6)
    v_mfma_f32_16x16x32_bf16 v[188:191], v[44:47], v[76:79], v[188:191]
    v_mfma_f32_16x16x32_bf16 v[192:195], v[44:47], v[80:83], v[192:195]
    v_mfma_f32_16x16x32_bf16 v[196:199], v[44:47], v[84:87], v[196:199]
    v_mfma_f32_16x16x32_bf16 v[200:203], v[44:47], v[88:91], v[200:203]
    s_waitcnt lgkmcnt(4)
    v_mfma_f32_16x16x32_bf16 v[204:207], v[48:51], v[76:79], v[204:207]
    v_mfma_f32_16x16x32_bf16 v[208:211], v[48:51], v[80:83], v[208:211]
    v_mfma_f32_16x16x32_bf16 v[212:215], v[48:51], v[84:87], v[212:215]
    v_mfma_f32_16x16x32_bf16 v[216:219], v[48:51], v[88:91], v[216:219]
    s_waitcnt lgkmcnt(2)
    v_mfma_f32_16x16x32_bf16 v[220:223], v[52:55], v[76:79], v[220:223]
    v_mfma_f32_16x16x32_bf16 v[224:227], v[52:55], v[80:83], v[224:227]
    v_mfma_f32_16x16x32_bf16 v[228:231], v[52:55], v[84:87], v[228:231]
    v_mfma_f32_16x16x32_bf16 v[232:235], v[52:55], v[88:91], v[232:235]
    s_waitcnt lgkmcnt(0)
    v_mfma_f32_16x16x32_bf16 v[236:239], v[56:59], v[76:79], v[236:239]
    v_mfma_f32_16x16x32_bf16 v[240:243], v[56:59], v[80:83], v[240:243]
    v_mfma_f32_16x16x32_bf16 v[244:247], v[56:59], v[84:87], v[244:247]
    v_mfma_f32_16x16x32_bf16 v[248:251], v[56:59], v[88:91], v[248:251]
    s_nop 7
    s_nop 3
    v_mul_f32 v92, s46, v92
    v_mul_f32 v93, s46, v93
    v_mul_f32 v94, s46, v94
    v_mul_f32 v95, s46, v95
    v_exp_f32 v92, v92
    v_exp_f32 v93, v93
    v_exp_f32 v94, v94
    v_exp_f32 v95, v95
    v_add_f32 v92, 1.0, v92
    v_add_f32 v93, 1.0, v93
    v_add_f32 v94, 1.0, v94
    v_add_f32 v95, 1.0, v95
    v_rcp_f32 v92, v92
    v_rcp_f32 v93, v93
    v_rcp_f32 v94, v94
    v_rcp_f32 v95, v95
    v_mul_f32 v92, v92, v108
    v_mul_f32 v93, v93, v109
    v_mul_f32 v94, v94, v110
    v_mul_f32 v95, v95, v111
    v_cvt_pk_bf16_f32 v20, v92, v93
    v_cvt_pk_bf16_f32 v21, v94, v95
    v_mul_f32 v96, s46, v96
    v_mul_f32 v97, s46, v97
    v_mul_f32 v98, s46, v98
    v_mul_f32 v99, s46, v99
    v_exp_f32 v96, v96
    v_exp_f32 v97, v97
    v_exp_f32 v98, v98
    v_exp_f32 v99, v99
    v_add_f32 v96, 1.0, v96
    v_add_f32 v97, 1.0, v97
    v_add_f32 v98, 1.0, v98
    v_add_f32 v99, 1.0, v99
    v_rcp_f32 v96, v96
    v_rcp_f32 v97, v97
    v_rcp_f32 v98, v98
    v_rcp_f32 v99, v99
    v_mul_f32 v96, v96, v112
    v_mul_f32 v97, v97, v113
    v_mul_f32 v98, v98, v114
    v_mul_f32 v99, v99, v115
    v_cvt_pk_bf16_f32 v22, v96, v97
    v_cvt_pk_bf16_f32 v23, v98, v99
    s_mov_b32 s33, 0
    s_nop 0
    v_permlane16_swap_b32 v20, v22
    v_permlane16_swap_b32 v21, v23
    s_nop 0
    buffer_store_dwordx4 v[20:23], v7, s[24:27], s33 offen offset:0 sc0 sc1
    v_mul_f32 v124, s46, v124
    v_mul_f32 v125, s46, v125
    v_mul_f32 v126, s46, v126
    v_mul_f32 v127, s46, v127
    v_exp_f32 v124, v124
    v_exp_f32 v125, v125
    v_exp_f32 v126, v126
    v_exp_f32 v127, v127
    v_add_f32 v124, 1.0, v124
    v_add_f32 v125, 1.0, v125
    v_add_f32 v126, 1.0, v126
    v_add_f32 v127, 1.0, v127
    v_rcp_f32 v124, v124
    v_rcp_f32 v125, v125
    v_rcp_f32 v126, v126
    v_rcp_f32 v127, v127
    v_mul_f32 v124, v124, v140
    v_mul_f32 v125, v125, v141
    v_mul_f32 v126, v126, v142
    v_mul_f32 v127, v127, v143
    v_cvt_pk_bf16_f32 v24, v124, v125
    v_cvt_pk_bf16_f32 v25, v126, v127
    v_mul_f32 v128, s46, v128
    v_mul_f32 v129, s46, v129
    v_mul_f32 v130, s46, v130
    v_mul_f32 v131, s46, v131
    v_exp_f32 v128, v128
    v_exp_f32 v129, v129
    v_exp_f32 v130, v130
    v_exp_f32 v131, v131
    v_add_f32 v128, 1.0, v128
    v_add_f32 v129, 1.0, v129
    v_add_f32 v130, 1.0, v130
    v_add_f32 v131, 1.0, v131
    v_rcp_f32 v128, v128
    v_rcp_f32 v129, v129
    v_rcp_f32 v130, v130
    v_rcp_f32 v131, v131
    v_mul_f32 v128, v128, v144
    v_mul_f32 v129, v129, v145
    v_mul_f32 v130, v130, v146
    v_mul_f32 v131, v131, v147
    v_cvt_pk_bf16_f32 v26, v128, v129
    v_cvt_pk_bf16_f32 v27, v130, v131
    s_nop 0
    s_nop 0
    v_permlane16_swap_b32 v24, v26
    v_permlane16_swap_b32 v25, v27
    s_nop 0
    buffer_store_dwordx4 v[24:27], v7, s[24:27], s33 offen offset:1024 sc0 sc1
    v_mul_f32 v156, s46, v156
    v_mul_f32 v157, s46, v157
    v_mul_f32 v158, s46, v158
    v_mul_f32 v159, s46, v159
    v_exp_f32 v156, v156
    v_exp_f32 v157, v157
    v_exp_f32 v158, v158
    v_exp_f32 v159, v159
    v_add_f32 v156, 1.0, v156
    v_add_f32 v157, 1.0, v157
    v_add_f32 v158, 1.0, v158
    v_add_f32 v159, 1.0, v159
    v_rcp_f32 v156, v156
    v_rcp_f32 v157, v157
    v_rcp_f32 v158, v158
    v_rcp_f32 v159, v159
    v_mul_f32 v156, v156, v172
    v_mul_f32 v157, v157, v173
    v_mul_f32 v158, v158, v174
    v_mul_f32 v159, v159, v175
    v_cvt_pk_bf16_f32 v28, v156, v157
    v_cvt_pk_bf16_f32 v29, v158, v159
    v_mul_f32 v160, s46, v160
    v_mul_f32 v161, s46, v161
    v_mul_f32 v162, s46, v162
    v_mul_f32 v163, s46, v163
    v_exp_f32 v160, v160
    v_exp_f32 v161, v161
    v_exp_f32 v162, v162
    v_exp_f32 v163, v163
    v_add_f32 v160, 1.0, v160
    v_add_f32 v161, 1.0, v161
    v_add_f32 v162, 1.0, v162
    v_add_f32 v163, 1.0, v163
    v_rcp_f32 v160, v160
    v_rcp_f32 v161, v161
    v_rcp_f32 v162, v162
    v_rcp_f32 v163, v163
    v_mul_f32 v160, v160, v176
    v_mul_f32 v161, v161, v177
    v_mul_f32 v162, v162, v178
    v_mul_f32 v163, v163, v179
    v_cvt_pk_bf16_f32 v30, v160, v161
    v_cvt_pk_bf16_f32 v31, v162, v163
    s_nop 0
    s_nop 0
    v_permlane16_swap_b32 v28, v30
    v_permlane16_swap_b32 v29, v31
    s_nop 0
    buffer_store_dwordx4 v[28:31], v7, s[24:27], s33 offen offset:2048 sc0 sc1
    v_mul_f32 v188, s46, v188
    v_mul_f32 v189, s46, v189
    v_mul_f32 v190, s46, v190
    v_mul_f32 v191, s46, v191
    v_exp_f32 v188, v188
    v_exp_f32 v189, v189
    v_exp_f32 v190, v190
    v_exp_f32 v191, v191
    v_add_f32 v188, 1.0, v188
    v_add_f32 v189, 1.0, v189
    v_add_f32 v190, 1.0, v190
    v_add_f32 v191, 1.0, v191
    v_rcp_f32 v188, v188
    v_rcp_f32 v189, v189
    v_rcp_f32 v190, v190
    v_rcp_f32 v191, v191
    v_mul_f32 v188, v188, v204
    v_mul_f32 v189, v189, v205
    v_mul_f32 v190, v190, v206
    v_mul_f32 v191, v191, v207
    v_cvt_pk_bf16_f32 v32, v188, v189
    v_cvt_pk_bf16_f32 v33, v190, v191
    v_mul_f32 v192, s46, v192
    v_mul_f32 v193, s46, v193
    v_mul_f32 v194, s46, v194
    v_mul_f32 v195, s46, v195
    v_exp_f32 v192, v192
    v_exp_f32 v193, v193
    v_exp_f32 v194, v194
    v_exp_f32 v195, v195
    v_add_f32 v192, 1.0, v192
    v_add_f32 v193, 1.0, v193
    v_add_f32 v194, 1.0, v194
    v_add_f32 v195, 1.0, v195
    v_rcp_f32 v192, v192
    v_rcp_f32 v193, v193
    v_rcp_f32 v194, v194
    v_rcp_f32 v195, v195
    v_mul_f32 v192, v192, v208
    v_mul_f32 v193, v193, v209
    v_mul_f32 v194, v194, v210
    v_mul_f32 v195, v195, v211
    v_cvt_pk_bf16_f32 v34, v192, v193
    v_cvt_pk_bf16_f32 v35, v194, v195
    s_nop 0
    s_nop 0
    v_permlane16_swap_b32 v32, v34
    v_permlane16_swap_b32 v33, v35
    s_nop 0
    buffer_store_dwordx4 v[32:35], v7, s[24:27], s33 offen offset:3072 sc0 sc1
    v_mul_f32 v220, s46, v220
    v_mul_f32 v221, s46, v221
    v_mul_f32 v222, s46, v222
    v_mul_f32 v223, s46, v223
    v_exp_f32 v220, v220
    v_exp_f32 v221, v221
    v_exp_f32 v222, v222
    v_exp_f32 v223, v223
    v_add_f32 v220, 1.0, v220
    v_add_f32 v221, 1.0, v221
    v_add_f32 v222, 1.0, v222
    v_add_f32 v223, 1.0, v223
    v_rcp_f32 v220, v220
    v_rcp_f32 v221, v221
    v_rcp_f32 v222, v222
    v_rcp_f32 v223, v223
    v_mul_f32 v220, v220, v236
    v_mul_f32 v221, v221, v237
    v_mul_f32 v222, v222, v238
    v_mul_f32 v223, v223, v239
    v_cvt_pk_bf16_f32 v20, v220, v221
    v_cvt_pk_bf16_f32 v21, v222, v223
    v_mul_f32 v224, s46, v224
    v_mul_f32 v225, s46, v225
    v_mul_f32 v226, s46, v226
    v_mul_f32 v227, s46, v227
    v_exp_f32 v224, v224
    v_exp_f32 v225, v225
    v_exp_f32 v226, v226
    v_exp_f32 v227, v227
    v_add_f32 v224, 1.0, v224
    v_add_f32 v225, 1.0, v225
    v_add_f32 v226, 1.0, v226
    v_add_f32 v227, 1.0, v227
    v_rcp_f32 v224, v224
    v_rcp_f32 v225, v225
    v_rcp_f32 v226, v226
    v_rcp_f32 v227, v227
    v_mul_f32 v224, v224, v240
    v_mul_f32 v225, v225, v241
    v_mul_f32 v226, v226, v242
    v_mul_f32 v227, v227, v243
    v_cvt_pk_bf16_f32 v22, v224, v225
    v_cvt_pk_bf16_f32 v23, v226, v227
    s_mov_b32 s33, 4096
    s_nop 0
    v_permlane16_swap_b32 v20, v22
    v_permlane16_swap_b32 v21, v23
    s_nop 0
    buffer_store_dwordx4 v[20:23], v7, s[24:27], s33 offen offset:0 sc0 sc1
    v_mul_f32 v100, s46, v100
    v_mul_f32 v101, s46, v101
    v_mul_f32 v102, s46, v102
    v_mul_f32 v103, s46, v103
    v_exp_f32 v100, v100
    v_exp_f32 v101, v101
    v_exp_f32 v102, v102
    v_exp_f32 v103, v103
    v_add_f32 v100, 1.0, v100
    v_add_f32 v101, 1.0, v101
    v_add_f32 v102, 1.0, v102
    v_add_f32 v103, 1.0, v103
    v_rcp_f32 v100, v100
    v_rcp_f32 v101, v101
    v_rcp_f32 v102, v102
    v_rcp_f32 v103, v103
    v_mul_f32 v100, v100, v116
    v_mul_f32 v101, v101, v117
    v_mul_f32 v102, v102, v118
    v_mul_f32 v103, v103, v119
    v_cvt_pk_bf16_f32 v24, v100, v101
    v_cvt_pk_bf16_f32 v25, v102, v103
    v_mul_f32 v104, s46, v104
    v_mul_f32 v105, s46, v105
    v_mul_f32 v106, s46, v106
    v_mul_f32 v107, s46, v107
    v_exp_f32 v104, v104
    v_exp_f32 v105, v105
    v_exp_f32 v106, v106
    v_exp_f32 v107, v107
    v_add_f32 v104, 1.0, v104
    v_add_f32 v105, 1.0, v105
    v_add_f32 v106, 1.0, v106
    v_add_f32 v107, 1.0, v107
    v_rcp_f32 v104, v104
    v_rcp_f32 v105, v105
    v_rcp_f32 v106, v106
    v_rcp_f32 v107, v107
    v_mul_f32 v104, v104, v120
    v_mul_f32 v105, v105, v121
    v_mul_f32 v106, v106, v122
    v_mul_f32 v107, v107, v123
    v_cvt_pk_bf16_f32 v26, v104, v105
    v_cvt_pk_bf16_f32 v27, v106, v107
    s_mov_b32 s33, 294912
    s_nop 0
    v_permlane16_swap_b32 v24, v26
    v_permlane16_swap_b32 v25, v27
    s_nop 0
    buffer_store_dwordx4 v[24:27], v7, s[24:27], s33 offen offset:0 sc0 sc1
    v_mul_f32 v132, s46, v132
    v_mul_f32 v133, s46, v133
    v_mul_f32 v134, s46, v134
    v_mul_f32 v135, s46, v135
    v_exp_f32 v132, v132
    v_exp_f32 v133, v133
    v_exp_f32 v134, v134
    v_exp_f32 v135, v135
    v_add_f32 v132, 1.0, v132
    v_add_f32 v133, 1.0, v133
    v_add_f32 v134, 1.0, v134
    v_add_f32 v135, 1.0, v135
    v_rcp_f32 v132, v132
    v_rcp_f32 v133, v133
    v_rcp_f32 v134, v134
    v_rcp_f32 v135, v135
    v_mul_f32 v132, v132, v148
    v_mul_f32 v133, v133, v149
    v_mul_f32 v134, v134, v150
    v_mul_f32 v135, v135, v151
    v_cvt_pk_bf16_f32 v28, v132, v133
    v_cvt_pk_bf16_f32 v29, v134, v135
    v_mul_f32 v136, s46, v136
    v_mul_f32 v137, s46, v137
    v_mul_f32 v138, s46, v138
    v_mul_f32 v139, s46, v139
    v_exp_f32 v136, v136
    v_exp_f32 v137, v137
    v_exp_f32 v138, v138
    v_exp_f32 v139, v139
    v_add_f32 v136, 1.0, v136
    v_add_f32 v137, 1.0, v137
    v_add_f32 v138, 1.0, v138
    v_add_f32 v139, 1.0, v139
    v_rcp_f32 v136, v136
    v_rcp_f32 v137, v137
    v_rcp_f32 v138, v138
    v_rcp_f32 v139, v139
    v_mul_f32 v136, v136, v152
    v_mul_f32 v137, v137, v153
    v_mul_f32 v138, v138, v154
    v_mul_f32 v139, v139, v155
    v_cvt_pk_bf16_f32 v30, v136, v137
    v_cvt_pk_bf16_f32 v31, v138, v139
    s_nop 0
    s_nop 0
    v_permlane16_swap_b32 v28, v30
    v_permlane16_swap_b32 v29, v31
    s_nop 0
    buffer_store_dwordx4 v[28:31], v7, s[24:27], s33 offen offset:1024 sc0 sc1
    v_mul_f32 v164, s46, v164
    v_mul_f32 v165, s46, v165
    v_mul_f32 v166, s46, v166
    v_mul_f32 v167, s46, v167
    v_exp_f32 v164, v164
    v_exp_f32 v165, v165
    v_exp_f32 v166, v166
    v_exp_f32 v167, v167
    v_add_f32 v164, 1.0, v164
    v_add_f32 v165, 1.0, v165
    v_add_f32 v166, 1.0, v166
    v_add_f32 v167, 1.0, v167
    v_rcp_f32 v164, v164
    v_rcp_f32 v165, v165
    v_rcp_f32 v166, v166
    v_rcp_f32 v167, v167
    v_mul_f32 v164, v164, v180
    v_mul_f32 v165, v165, v181
    v_mul_f32 v166, v166, v182
    v_mul_f32 v167, v167, v183
    v_cvt_pk_bf16_f32 v32, v164, v165
    v_cvt_pk_bf16_f32 v33, v166, v167
    v_mul_f32 v168, s46, v168
    v_mul_f32 v169, s46, v169
    v_mul_f32 v170, s46, v170
    v_mul_f32 v171, s46, v171
    v_exp_f32 v168, v168
    v_exp_f32 v169, v169
    v_exp_f32 v170, v170
    v_exp_f32 v171, v171
    v_add_f32 v168, 1.0, v168
    v_add_f32 v169, 1.0, v169
    v_add_f32 v170, 1.0, v170
    v_add_f32 v171, 1.0, v171
    v_rcp_f32 v168, v168
    v_rcp_f32 v169, v169
    v_rcp_f32 v170, v170
    v_rcp_f32 v171, v171
    v_mul_f32 v168, v168, v184
    v_mul_f32 v169, v169, v185
    v_mul_f32 v170, v170, v186
    v_mul_f32 v171, v171, v187
    v_cvt_pk_bf16_f32 v34, v168, v169
    v_cvt_pk_bf16_f32 v35, v170, v171
    s_nop 0
    s_nop 0
    v_permlane16_swap_b32 v32, v34
    v_permlane16_swap_b32 v33, v35
    s_nop 0
    buffer_store_dwordx4 v[32:35], v7, s[24:27], s33 offen offset:2048 sc0 sc1
    v_mul_f32 v196, s46, v196
    v_mul_f32 v197, s46, v197
    v_mul_f32 v198, s46, v198
    v_mul_f32 v199, s46, v199
    v_exp_f32 v196, v196
    v_exp_f32 v197, v197
    v_exp_f32 v198, v198
    v_exp_f32 v199, v199
    v_add_f32 v196, 1.0, v196
    v_add_f32 v197, 1.0, v197
    v_add_f32 v198, 1.0, v198
    v_add_f32 v199, 1.0, v199
    v_rcp_f32 v196, v196
    v_rcp_f32 v197, v197
    v_rcp_f32 v198, v198
    v_rcp_f32 v199, v199
    v_mul_f32 v196, v196, v212
    v_mul_f32 v197, v197, v213
    v_mul_f32 v198, v198, v214
    v_mul_f32 v199, v199, v215
    v_cvt_pk_bf16_f32 v20, v196, v197
    v_cvt_pk_bf16_f32 v21, v198, v199
    v_mul_f32 v200, s46, v200
    v_mul_f32 v201, s46, v201
    v_mul_f32 v202, s46, v202
    v_mul_f32 v203, s46, v203
    v_exp_f32 v200, v200
    v_exp_f32 v201, v201
    v_exp_f32 v202, v202
    v_exp_f32 v203, v203
    v_add_f32 v200, 1.0, v200
    v_add_f32 v201, 1.0, v201
    v_add_f32 v202, 1.0, v202
    v_add_f32 v203, 1.0, v203
    v_rcp_f32 v200, v200
    v_rcp_f32 v201, v201
    v_rcp_f32 v202, v202
    v_rcp_f32 v203, v203
    v_mul_f32 v200, v200, v216
    v_mul_f32 v201, v201, v217
    v_mul_f32 v202, v202, v218
    v_mul_f32 v203, v203, v219
    v_cvt_pk_bf16_f32 v22, v200, v201
    v_cvt_pk_bf16_f32 v23, v202, v203
    s_nop 0
    s_nop 0
    v_permlane16_swap_b32 v20, v22
    v_permlane16_swap_b32 v21, v23
    s_nop 0
    buffer_store_dwordx4 v[20:23], v7, s[24:27], s33 offen offset:3072 sc0 sc1
    v_mul_f32 v228, s46, v228
    v_mul_f32 v229, s46, v229
    v_mul_f32 v230, s46, v230
    v_mul_f32 v231, s46, v231
    v_exp_f32 v228, v228
    v_exp_f32 v229, v229
    v_exp_f32 v230, v230
    v_exp_f32 v231, v231
    v_add_f32 v228, 1.0, v228
    v_add_f32 v229, 1.0, v229
    v_add_f32 v230, 1.0, v230
    v_add_f32 v231, 1.0, v231
    v_rcp_f32 v228, v228
    v_rcp_f32 v229, v229
    v_rcp_f32 v230, v230
    v_rcp_f32 v231, v231
    v_mul_f32 v228, v228, v244
    v_mul_f32 v229, v229, v245
    v_mul_f32 v230, v230, v246
    v_mul_f32 v231, v231, v247
    v_cvt_pk_bf16_f32 v24, v228, v229
    v_cvt_pk_bf16_f32 v25, v230, v231
    v_mul_f32 v232, s46, v232
    v_mul_f32 v233, s46, v233
    v_mul_f32 v234, s46, v234
    v_mul_f32 v235, s46, v235
    v_exp_f32 v232, v232
    v_exp_f32 v233, v233
    v_exp_f32 v234, v234
    v_exp_f32 v235, v235
    v_add_f32 v232, 1.0, v232
    v_add_f32 v233, 1.0, v233
    v_add_f32 v234, 1.0, v234
    v_add_f32 v235, 1.0, v235
    v_rcp_f32 v232, v232
    v_rcp_f32 v233, v233
    v_rcp_f32 v234, v234
    v_rcp_f32 v235, v235
    v_mul_f32 v232, v232, v248
    v_mul_f32 v233, v233, v249
    v_mul_f32 v234, v234, v250
    v_mul_f32 v235, v235, v251
    v_cvt_pk_bf16_f32 v26, v232, v233
    v_cvt_pk_bf16_f32 v27, v234, v235
    s_mov_b32 s33, 299008
    s_nop 0
    v_permlane16_swap_b32 v24, v26
    v_permlane16_swap_b32 v25, v27
    s_nop 0
    buffer_store_dwordx4 v[24:27], v7, s[24:27], s33 offen offset:0 sc0 sc1
    s_branch LJ_rompt_kernel_20
LG_rompt_kernel_21:
    ds_read_b128 v[60:63], v12 offset:0
    ds_read_b128 v[64:67], v12 offset:1024
    ds_read_b128 v[68:71], v12 offset:2048
    ds_read_b128 v[72:75], v12 offset:3072
    ds_read_b64_tr_b16 v[20:21], v16 offset:160
    ds_read_b64_tr_b16 v[22:23], v16 offset:2464
    ds_read_b64_tr_b16 v[24:25], v16 offset:9376
    ds_read_b64_tr_b16 v[26:27], v16 offset:11680
    ds_read_b64_tr_b16 v[28:29], v16 offset:192
    ds_read_b64_tr_b16 v[30:31], v16 offset:2496
    ds_read_b64_tr_b16 v[32:33], v16 offset:9408
    ds_read_b64_tr_b16 v[34:35], v16 offset:11712
    ds_read_b64_tr_b16 v[36:37], v16 offset:224
    ds_read_b64_tr_b16 v[38:39], v16 offset:2528
    ds_read_b64_tr_b16 v[40:41], v16 offset:9440
    s_waitcnt lgkmcnt(13)
    ds_read_b64_tr_b16 v[42:43], v16 offset:11744
    s_waitcnt lgkmcnt(10)
    v_mfma_f32_16x16x32_bf16 v[92:95], v[20:23], v[60:63], 0
    v_mfma_f32_16x16x32_bf16 v[96:99], v[20:23], v[64:67], 0
    v_mfma_f32_16x16x32_bf16 v[100:103], v[20:23], v[68:71], 0
    v_mfma_f32_16x16x32_bf16 v[104:107], v[20:23], v[72:75], 0
    ds_read_b64_tr_b16 v[44:45], v16 offset:256
    ds_read_b64_tr_b16 v[46:47], v16 offset:2560
    s_waitcnt lgkmcnt(10)
    v_mfma_f32_16x16x32_bf16 v[108:111], v[24:27], v[60:63], 0
    v_mfma_f32_16x16x32_bf16 v[112:115], v[24:27], v[64:67], 0
    v_mfma_f32_16x16x32_bf16 v[116:119], v[24:27], v[68:71], 0
    v_mfma_f32_16x16x32_bf16 v[120:123], v[24:27], v[72:75], 0
    ds_read_b64_tr_b16 v[48:49], v16 offset:9472
    ds_read_b64_tr_b16 v[50:51], v16 offset:11776
    s_waitcnt lgkmcnt(10)
    v_mfma_f32_16x16x32_bf16 v[124:127], v[28:31], v[60:63], 0
    v_mfma_f32_16x16x32_bf16 v[128:131], v[28:31], v[64:67], 0
    v_mfma_f32_16x16x32_bf16 v[132:135], v[28:31], v[68:71], 0
    v_mfma_f32_16x16x32_bf16 v[136:139], v[28:31], v[72:75], 0
    s_waitcnt lgkmcnt(8)
    v_mfma_f32_16x16x32_bf16 v[140:143], v[32:35], v[60:63], 0
    v_mfma_f32_16x16x32_bf16 v[144:147], v[32:35], v[64:67], 0
    v_mfma_f32_16x16x32_bf16 v[148:151], v[32:35], v[68:71], 0
    v_mfma_f32_16x16x32_bf16 v[152:155], v[32:35], v[72:75], 0
    s_waitcnt vmcnt(2) lgkmcnt(0)
    s_barrier
    ds_read_b128 v[76:79], v13 offset:0
    ds_read_b128 v[80:83], v13 offset:1024
    ds_read_b128 v[84:87], v13 offset:2048
    s_add_u32 m0, s29, 0x0
    s_nop 0
    buffer_load_dwordx4 v8, s[12:15], s31 offen lds
    v_mfma_f32_16x16x32_bf16 v[156:159], v[36:39], v[60:63], 0
    v_mfma_f32_16x16x32_bf16 v[160:163], v[36:39], v[64:67], 0
    v_mfma_f32_16x16x32_bf16 v[164:167], v[36:39], v[68:71], 0
    v_mfma_f32_16x16x32_bf16 v[168:171], v[36:39], v[72:75], 0
    ds_read_b128 v[88:91], v13 offset:3072
    ds_read_b64_tr_b16 v[20:21], v17 offset:160
    ds_read_b64_tr_b16 v[22:23], v17 offset:2464
    s_add_u32 m0, s29, 0x2000
    s_add_u32 s33, s31, 0x24000
    buffer_load_dwordx4 v8, s[12:15], s33 offen lds
    s_add_u32 s31, s31, 64
    v_mfma_f32_16x16x32_bf16 v[172:175], v[40:43], v[60:63], 0
    v_mfma_f32_16x16x32_bf16 v[176:179], v[40:43], v[64:67], 0
    v_mfma_f32_16x16x32_bf16 v[180:183], v[40:43], v[68:71], 0
    v_mfma_f32_16x16x32_bf16 v[184:187], v[40:43], v[72:75], 0
    ds_read_b64_tr_b16 v[24:25], v17 offset:9376
    ds_read_b64_tr_b16 v[26:27], v17 offset:11680
    ds_read_b64_tr_b16 v[28:29], v17 offset:192
    ds_read_b64_tr_b16 v[30:31], v17 offset:2496
    s_add_u32 m0, s29, 0x4000
    s_nop 0
    buffer_load_dwordx4 v9, s[16:19], s32 offen lds
    v_mfma_f32_16x16x32_bf16 v[188:191], v[44:47], v[60:63], 0
    v_mfma_f32_16x16x32_bf16 v[192:195], v[44:47], v[64:67], 0
    v_mfma_f32_16x16x32_bf16 v[196:199], v[44:47], v[68:71], 0
    v_mfma_f32_16x16x32_bf16 v[200:203], v[44:47], v[72:75], 0
    ds_read_b64_tr_b16 v[32:33], v17 offset:9408
    ds_read_b64_tr_b16 v[34:35], v17 offset:11712
    ds_read_b64_tr_b16 v[36:37], v17 offset:224
    ds_read_b64_tr_b16 v[38:39], v17 offset:2528
    s_add_u32 m0, s29, 0x6400
    s_nop 0
    buffer_load_dwordx4 v9, s[20:23], s32 offen lds
    v_mfma_f32_16x16x32_bf16 v[204:207], v[48:51], v[60:63], 0
    v_mfma_f32_16x16x32_bf16 v[208:211], v[48:51], v[64:67], 0
    v_mfma_f32_16x16x32_bf16 v[212:215], v[48:51], v[68:71], 0
    v_mfma_f32_16x16x32_bf16 v[216:219], v[48:51], v[72:75], 0
    ds_read_b64_tr_b16 v[40:41], v17 offset:9440
    s_waitcnt lgkmcnt(13)
    ds_read_b64_tr_b16 v[42:43], v17 offset:11744
    s_add_u32 m0, s30, 0x6000
    s_mov_b64 exec, 0xffff
    buffer_load_dwordx4 v10, s[40:43], s32 offen lds
    s_mov_b64 exec, -1
    s_add_u32 s32, s32, 0x48000
    s_waitcnt lgkmcnt(10)
    v_mfma_f32_16x16x32_bf16 v[92:95], v[20:23], v[76:79], v[92:95]
    v_mfma_f32_16x16x32_bf16 v[96:99], v[20:23], v[80:83], v[96:99]
    v_mfma_f32_16x16x32_bf16 v[100:103], v[20:23], v[84:87], v[100:103]
    v_mfma_f32_16x16x32_bf16 v[104:107], v[20:23], v[88:91], v[104:107]
    ds_read_b64_tr_b16 v[44:45], v17 offset:256
    ds_read_b64_tr_b16 v[46:47], v17 offset:2560
    s_waitcnt lgkmcnt(10)
    v_mfma_f32_16x16x32_bf16 v[108:111], v[24:27], v[76:79], v[108:111]
    v_mfma_f32_16x16x32_bf16 v[112:115], v[24:27], v[80:83], v[112:115]
    v_mfma_f32_16x16x32_bf16 v[116:119], v[24:27], v[84:87], v[116:119]
    v_mfma_f32_16x16x32_bf16 v[120:123], v[24:27], v[88:91], v[120:123]
    ds_read_b64_tr_b16 v[48:49], v17 offset:9472
    ds_read_b64_tr_b16 v[50:51], v17 offset:11776
    s_waitcnt lgkmcnt(10)
    v_mfma_f32_16x16x32_bf16 v[124:127], v[28:31], v[76:79], v[124:127]
    v_mfma_f32_16x16x32_bf16 v[128:131], v[28:31], v[80:83], v[128:131]
    v_mfma_f32_16x16x32_bf16 v[132:135], v[28:31], v[84:87], v[132:135]
    v_mfma_f32_16x16x32_bf16 v[136:139], v[28:31], v[88:91], v[136:139]
    s_waitcnt lgkmcnt(8)
    v_mfma_f32_16x16x32_bf16 v[140:143], v[32:35], v[76:79], v[140:143]
    v_mfma_f32_16x16x32_bf16 v[144:147], v[32:35], v[80:83], v[144:147]
    v_mfma_f32_16x16x32_bf16 v[148:151], v[32:35], v[84:87], v[148:151]
    v_mfma_f32_16x16x32_bf16 v[152:155], v[32:35], v[88:91], v[152:155]
    s_waitcnt vmcnt(5) lgkmcnt(0)
    s_barrier
    ds_read_b128 v[60:63], v14 offset:0
    ds_read_b128 v[64:67], v14 offset:1024
    ds_read_b128 v[68:71], v14 offset:2048
    s_add_u32 m0, s29, 0x8800
    s_nop 0
    buffer_load_dwordx4 v8, s[12:15], s31 offen lds
    s_add_u32 m0, s29, 0xa800
    s_add_u32 s33, s31, 0x24000
    buffer_load_dwordx4 v8, s[12:15], s33 offen lds
    s_add_u32 s31, s31, 64
    v_mfma_f32_16x16x32_bf16 v[156:159], v[36:39], v[76:79], v[156:159]
    v_mfma_f32_16x16x32_bf16 v[160:163], v[36:39], v[80:83], v[160:163]
    v_mfma_f32_16x16x32_bf16 v[164:167], v[36:39], v[84:87], v[164:167]
    v_mfma_f32_16x16x32_bf16 v[168:171], v[36:39], v[88:91], v[168:171]
    ds_read_b128 v[72:75], v14 offset:3072
    ds_read_b64_tr_b16 v[20:21], v18 offset:160
    ds_read_b64_tr_b16 v[22:23], v18 offset:2464
    s_add_u32 m0, s29, 0xc800
    s_nop 0
    buffer_load_dwordx4 v9, s[16:19], s32 offen lds
    v_mfma_f32_16x16x32_bf16 v[172:175], v[40:43], v[76:79], v[172:175]
    v_mfma_f32_16x16x32_bf16 v[176:179], v[40:43], v[80:83], v[176:179]
    v_mfma_f32_16x16x32_bf16 v[180:183], v[40:43], v[84:87], v[180:183]
    v_mfma_f32_16x16x32_bf16 v[184:187], v[40:43], v[88:91], v[184:187]
    ds_read_b64_tr_b16 v[24:25], v18 offset:9376
    ds_read_b64_tr_b16 v[26:27], v18 offset:11680
    ds_read_b64_tr_b16 v[28:29], v18 offset:192
    ds_read_b64_tr_b16 v[30:31], v18 offset:2496
    s_add_u32 m0, s29, 0xec00
    s_nop 0
    buffer_load_dwordx4 v9, s[20:23], s32 offen lds
    v_mfma_f32_16x16x32_bf16 v[188:191], v[44:47], v[76:79], v[188:191]
    v_mfma_f32_16x16x32_bf16 v[192:195], v[44:47], v[80:83], v[192:195]
    v_mfma_f32_16x16x32_bf16 v[196:199], v[44:47], v[84:87], v[196:199]
    v_mfma_f32_16x16x32_bf16 v[200:203], v[44:47], v[88:91], v[200:203]
    ds_read_b64_tr_b16 v[32:33], v18 offset:9408
    ds_read_b64_tr_b16 v[34:35], v18 offset:11712
    ds_read_b64_tr_b16 v[36:37], v18 offset:224
    ds_read_b64_tr_b16 v[38:39], v18 offset:2528
    s_add_u32 m0, s30, 0xe800
    s_mov_b64 exec, 0xffff
    buffer_load_dwordx4 v10, s[40:43], s32 offen lds
    s_mov_b64 exec, -1
    s_add_u32 s32, s32, 0x48000
    v_mfma_f32_16x16x32_bf16 v[204:207], v[48:51], v[76:79], v[204:207]
    v_mfma_f32_16x16x32_bf16 v[208:211], v[48:51], v[80:83], v[208:211]
    v_mfma_f32_16x16x32_bf16 v[212:215], v[48:51], v[84:87], v[212:215]
    v_mfma_f32_16x16x32_bf16 v[216:219], v[48:51], v[88:91], v[216:219]
    ds_read_b64_tr_b16 v[40:41], v18 offset:9440
    s_waitcnt lgkmcnt(13)
    ds_read_b64_tr_b16 v[42:43], v18 offset:11744
    buffer_load_dword v252, v253, s[60:63], 0 offen
    s_waitcnt lgkmcnt(10)
    v_mfma_f32_16x16x32_bf16 v[92:95], v[20:23], v[60:63], v[92:95]
    v_mfma_f32_16x16x32_bf16 v[96:99], v[20:23], v[64:67], v[96:99]
    v_mfma_f32_16x16x32_bf16 v[100:103], v[20:23], v[68:71], v[100:103]
    v_mfma_f32_16x16x32_bf16 v[104:107], v[20:23], v[72:75], v[104:107]
    ds_read_b64_tr_b16 v[44:45], v18 offset:256
    ds_read_b64_tr_b16 v[46:47], v18 offset:2560
    s_waitcnt lgkmcnt(10)
    v_mfma_f32_16x16x32_bf16 v[108:111], v[24:27], v[60:63], v[108:111]
    v_mfma_f32_16x16x32_bf16 v[112:115], v[24:27], v[64:67], v[112:115]
    v_mfma_f32_16x16x32_bf16 v[116:119], v[24:27], v[68:71], v[116:119]
    v_mfma_f32_16x16x32_bf16 v[120:123], v[24:27], v[72:75], v[120:123]
    ds_read_b64_tr_b16 v[48:49], v18 offset:9472
    ds_read_b64_tr_b16 v[50:51], v18 offset:11776
    s_waitcnt lgkmcnt(10)
    v_mfma_f32_16x16x32_bf16 v[124:127], v[28:31], v[60:63], v[124:127]
    v_mfma_f32_16x16x32_bf16 v[128:131], v[28:31], v[64:67], v[128:131]
    v_mfma_f32_16x16x32_bf16 v[132:135], v[28:31], v[68:71], v[132:135]
    v_mfma_f32_16x16x32_bf16 v[136:139], v[28:31], v[72:75], v[136:139]
    s_waitcnt lgkmcnt(8)
    v_mfma_f32_16x16x32_bf16 v[140:143], v[32:35], v[60:63], v[140:143]
    v_mfma_f32_16x16x32_bf16 v[144:147], v[32:35], v[64:67], v[144:147]
    v_mfma_f32_16x16x32_bf16 v[148:151], v[32:35], v[68:71], v[148:151]
    v_mfma_f32_16x16x32_bf16 v[152:155], v[32:35], v[72:75], v[152:155]
    s_waitcnt vmcnt(6) lgkmcnt(0)
    s_barrier
    ds_read_b128 v[76:79], v12 offset:0
    ds_read_b128 v[80:83], v12 offset:1024
    ds_read_b128 v[84:87], v12 offset:2048
    s_add_u32 m0, s29, 0x11000
    s_nop 0
    buffer_load_dwordx4 v8, s[12:15], s31 offen lds
    v_mfma_f32_16x16x32_bf16 v[156:159], v[36:39], v[60:63], v[156:159]
    v_mfma_f32_16x16x32_bf16 v[160:163], v[36:39], v[64:67], v[160:163]
    v_mfma_f32_16x16x32_bf16 v[164:167], v[36:39], v[68:71], v[164:167]
    v_mfma_f32_16x16x32_bf16 v[168:171], v[36:39], v[72:75], v[168:171]
    ds_read_b128 v[88:91], v12 offset:3072
    ds_read_b64_tr_b16 v[20:21], v16 offset:160
    ds_read_b64_tr_b16 v[22:23], v16 offset:2464
    s_add_u32 m0, s29, 0x13000
    s_add_u32 s33, s31, 0x24000
    buffer_load_dwordx4 v8, s[12:15], s33 offen lds
    s_add_u32 s31, s31, 64
    v_mfma_f32_16x16x32_bf16 v[172:175], v[40:43], v[60:63], v[172:175]
    v_mfma_f32_16x16x32_bf16 v[176:179], v[40:43], v[64:67], v[176:179]
    v_mfma_f32_16x16x32_bf16 v[180:183], v[40:43], v[68:71], v[180:183]
    v_mfma_f32_16x16x32_bf16 v[184:187], v[40:43], v[72:75], v[184:187]
    ds_read_b64_tr_b16 v[24:25], v16 offset:9376
    ds_read_b64_tr_b16 v[26:27], v16 offset:11680
    ds_read_b64_tr_b16 v[28:29], v16 offset:192
    ds_read_b64_tr_b16 v[30:31], v16 offset:2496
    s_add_u32 m0, s29, 0x15000
    s_nop 0
    buffer_load_dwordx4 v9, s[16:19], s32 offen lds
    v_mfma_f32_16x16x32_bf16 v[188:191], v[44:47], v[60:63], v[188:191]
    v_mfma_f32_16x16x32_bf16 v[192:195], v[44:47], v[64:67], v[192:195]
    v_mfma_f32_16x16x32_bf16 v[196:199], v[44:47], v[68:71], v[196:199]
    v_mfma_f32_16x16x32_bf16 v[200:203], v[44:47], v[72:75], v[200:203]
    ds_read_b64_tr_b16 v[32:33], v16 offset:9408
    ds_read_b64_tr_b16 v[34:35], v16 offset:11712
    ds_read_b64_tr_b16 v[36:37], v16 offset:224
    ds_read_b64_tr_b16 v[38:39], v16 offset:2528
    s_add_u32 m0, s29, 0x17400
    s_nop 0
    buffer_load_dwordx4 v9, s[20:23], s32 offen lds
    v_mfma_f32_16x16x32_bf16 v[204:207], v[48:51], v[60:63], v[204:207]
    v_mfma_f32_16x16x32_bf16 v[208:211], v[48:51], v[64:67], v[208:211]
    v_mfma_f32_16x16x32_bf16 v[212:215], v[48:51], v[68:71], v[212:215]
    v_mfma_f32_16x16x32_bf16 v[216:219], v[48:51], v[72:75], v[216:219]
    ds_read_b64_tr_b16 v[40:41], v16 offset:9440
    s_waitcnt lgkmcnt(13)
    ds_read_b64_tr_b16 v[42:43], v16 offset:11744
    s_add_u32 m0, s30, 0x17000
    s_mov_b64 exec, 0xffff
    buffer_load_dwordx4 v10, s[40:43], s32 offen lds
    s_mov_b64 exec, -1
    s_add_u32 s32, s32, 0x48000
    s_waitcnt lgkmcnt(10)
    v_mfma_f32_16x16x32_bf16 v[92:95], v[20:23], v[76:79], v[92:95]
    v_mfma_f32_16x16x32_bf16 v[96:99], v[20:23], v[80:83], v[96:99]
    v_mfma_f32_16x16x32_bf16 v[100:103], v[20:23], v[84:87], v[100:103]
    v_mfma_f32_16x16x32_bf16 v[104:107], v[20:23], v[88:91], v[104:107]
    ds_read_b64_tr_b16 v[44:45], v16 offset:256
    ds_read_b64_tr_b16 v[46:47], v16 offset:2560
    s_waitcnt lgkmcnt(10)
    v_mfma_f32_16x16x32_bf16 v[108:111], v[24:27], v[76:79], v[108:111]
    v_mfma_f32_16x16x32_bf16 v[112:115], v[24:27], v[80:83], v[112:115]
    v_mfma_f32_16x16x32_bf16 v[116:119], v[24:27], v[84:87], v[116:119]
    v_mfma_f32_16x16x32_bf16 v[120:123], v[24:27], v[88:91], v[120:123]
    ds_read_b64_tr_b16 v[48:49], v16 offset:9472
    ds_read_b64_tr_b16 v[50:51], v16 offset:11776
    s_waitcnt lgkmcnt(10)
    v_mfma_f32_16x16x32_bf16 v[124:127], v[28:31], v[76:79], v[124:127]
    v_mfma_f32_16x16x32_bf16 v[128:131], v[28:31], v[80:83], v[128:131]
    v_mfma_f32_16x16x32_bf16 v[132:135], v[28:31], v[84:87], v[132:135]
    v_mfma_f32_16x16x32_bf16 v[136:139], v[28:31], v[88:91], v[136:139]
    s_waitcnt lgkmcnt(8)
    v_mfma_f32_16x16x32_bf16 v[140:143], v[32:35], v[76:79], v[140:143]
    v_mfma_f32_16x16x32_bf16 v[144:147], v[32:35], v[80:83], v[144:147]
    v_mfma_f32_16x16x32_bf16 v[148:151], v[32:35], v[84:87], v[148:151]
    v_mfma_f32_16x16x32_bf16 v[152:155], v[32:35], v[88:91], v[152:155]
    s_waitcnt vmcnt(6) lgkmcnt(0)
    s_barrier
    ds_read_b128 v[60:63], v13 offset:0
    ds_read_b128 v[64:67], v13 offset:1024
    ds_read_b128 v[68:71], v13 offset:2048
    s_add_u32 m0, s29, 0x0
    s_nop 0
    buffer_load_dwordx4 v8, s[12:15], s31 offen lds
    v_mfma_f32_16x16x32_bf16 v[156:159], v[36:39], v[76:79], v[156:159]
    v_mfma_f32_16x16x32_bf16 v[160:163], v[36:39], v[80:83], v[160:163]
    v_mfma_f32_16x16x32_bf16 v[164:167], v[36:39], v[84:87], v[164:167]
    v_mfma_f32_16x16x32_bf16 v[168:171], v[36:39], v[88:91], v[168:171]
    ds_read_b128 v[72:75], v13 offset:3072
    ds_read_b64_tr_b16 v[20:21], v17 offset:160
    ds_read_b64_tr_b16 v[22:23], v17 offset:2464
    s_add_u32 m0, s29, 0x2000
    s_add_u32 s33, s31, 0x24000
    buffer_load_dwordx4 v8, s[12:15], s33 offen lds
    s_add_u32 s31, s31, 64
    v_mfma_f32_16x16x32_bf16 v[172:175], v[40:43], v[76:79], v[172:175]
    v_mfma_f32_16x16x32_bf16 v[176:179], v[40:43], v[80:83], v[176:179]
    v_mfma_f32_16x16x32_bf16 v[180:183], v[40:43], v[84:87], v[180:183]
    v_mfma_f32_16x16x32_bf16 v[184:187], v[40:43], v[88:91], v[184:187]
    ds_read_b64_tr_b16 v[24:25], v17 offset:9376
    ds_read_b64_tr_b16 v[26:27], v17 offset:11680
    ds_read_b64_tr_b16 v[28:29], v17 offset:192
    ds_read_b64_tr_b16 v[30:31], v17 offset:2496
    s_add_u32 m0, s29, 0x4000
    s_nop 0
    buffer_load_dwordx4 v9, s[16:19], s32 offen lds
    v_mfma_f32_16x16x32_bf16 v[188:191], v[44:47], v[76:79], v[188:191]
    v_mfma_f32_16x16x32_bf16 v[192:195], v[44:47], v[80:83], v[192:195]
    v_mfma_f32_16x16x32_bf16 v[196:199], v[44:47], v[84:87], v[196:199]
    v_mfma_f32_16x16x32_bf16 v[200:203], v[44:47], v[88:91], v[200:203]
    ds_read_b64_tr_b16 v[32:33], v17 offset:9408
    ds_read_b64_tr_b16 v[34:35], v17 offset:11712
    ds_read_b64_tr_b16 v[36:37], v17 offset:224
    ds_read_b64_tr_b16 v[38:39], v17 offset:2528
    s_add_u32 m0, s29, 0x6400
    s_nop 0
    buffer_load_dwordx4 v9, s[20:23], s32 offen lds
    v_mfma_f32_16x16x32_bf16 v[204:207], v[48:51], v[76:79], v[204:207]
    v_mfma_f32_16x16x32_bf16 v[208:211], v[48:51], v[80:83], v[208:211]
    v_mfma_f32_16x16x32_bf16 v[212:215], v[48:51], v[84:87], v[212:215]
    v_mfma_f32_16x16x32_bf16 v[216:219], v[48:51], v[88:91], v[216:219]
    ds_read_b64_tr_b16 v[40:41], v17 offset:9440
    s_waitcnt lgkmcnt(13)
    ds_read_b64_tr_b16 v[42:43], v17 offset:11744
    s_add_u32 m0, s30, 0x6000
    s_mov_b64 exec, 0xffff
    buffer_load_dwordx4 v10, s[40:43], s32 offen lds
    s_mov_b64 exec, -1
    s_add_u32 s32, s32, 0x48000
    s_waitcnt lgkmcnt(10)
    v_mfma_f32_16x16x32_bf16 v[92:95], v[20:23], v[60:63], v[92:95]
    v_mfma_f32_16x16x32_bf16 v[96:99], v[20:23], v[64:67], v[96:99]
    v_mfma_f32_16x16x32_bf16 v[100:103], v[20:23], v[68:71], v[100:103]
    v_mfma_f32_16x16x32_bf16 v[104:107], v[20:23], v[72:75], v[104:107]
    ds_read_b64_tr_b16 v[44:45], v17 offset:256
    ds_read_b64_tr_b16 v[46:47], v17 offset:2560
    s_waitcnt lgkmcnt(10)
    v_mfma_f32_16x16x32_bf16 v[108:111], v[24:27], v[60:63], v[108:111]
    v_mfma_f32_16x16x32_bf16 v[112:115], v[24:27], v[64:67], v[112:115]
    v_mfma_f32_16x16x32_bf16 v[116:119], v[24:27], v[68:71], v[116:119]
    v_mfma_f32_16x16x32_bf16 v[120:123], v[24:27], v[72:75], v[120:123]
    ds_read_b64_tr_b16 v[48:49], v17 offset:9472
    ds_read_b64_tr_b16 v[50:51], v17 offset:11776
    s_waitcnt lgkmcnt(10)
    v_mfma_f32_16x16x32_bf16 v[124:127], v[28:31], v[60:63], v[124:127]
    v_mfma_f32_16x16x32_bf16 v[128:131], v[28:31], v[64:67], v[128:131]
    v_mfma_f32_16x16x32_bf16 v[132:135], v[28:31], v[68:71], v[132:135]
    v_mfma_f32_16x16x32_bf16 v[136:139], v[28:31], v[72:75], v[136:139]
    s_waitcnt lgkmcnt(8)
    v_mfma_f32_16x16x32_bf16 v[140:143], v[32:35], v[60:63], v[140:143]
    v_mfma_f32_16x16x32_bf16 v[144:147], v[32:35], v[64:67], v[144:147]
    v_mfma_f32_16x16x32_bf16 v[148:151], v[32:35], v[68:71], v[148:151]
    v_mfma_f32_16x16x32_bf16 v[152:155], v[32:35], v[72:75], v[152:155]
    s_waitcnt vmcnt(5) lgkmcnt(0)
    s_barrier
    ds_read_b128 v[76:79], v14 offset:0
    ds_read_b128 v[80:83], v14 offset:1024
    ds_read_b128 v[84:87], v14 offset:2048
    s_add_u32 m0, s29, 0x8800
    s_nop 0
    buffer_load_dwordx4 v8, s[12:15], s31 offen lds
    v_mfma_f32_16x16x32_bf16 v[156:159], v[36:39], v[60:63], v[156:159]
    v_mfma_f32_16x16x32_bf16 v[160:163], v[36:39], v[64:67], v[160:163]
    v_mfma_f32_16x16x32_bf16 v[164:167], v[36:39], v[68:71], v[164:167]
    v_mfma_f32_16x16x32_bf16 v[168:171], v[36:39], v[72:75], v[168:171]
    ds_read_b128 v[88:91], v14 offset:3072
    ds_read_b64_tr_b16 v[20:21], v18 offset:160
    ds_read_b64_tr_b16 v[22:23], v18 offset:2464
    s_add_u32 m0, s29, 0xa800
    s_add_u32 s33, s31, 0x24000
    buffer_load_dwordx4 v8, s[12:15], s33 offen lds
    s_add_u32 s31, s31, 64
    v_mfma_f32_16x16x32_bf16 v[172:175], v[40:43], v[60:63], v[172:175]
    v_mfma_f32_16x16x32_bf16 v[176:179], v[40:43], v[64:67], v[176:179]
    v_mfma_f32_16x16x32_bf16 v[180:183], v[40:43], v[68:71], v[180:183]
    v_mfma_f32_16x16x32_bf16 v[184:187], v[40:43], v[72:75], v[184:187]
    ds_read_b64_tr_b16 v[24:25], v18 offset:9376
    ds_read_b64_tr_b16 v[26:27], v18 offset:11680
    ds_read_b64_tr_b16 v[28:29], v18 offset:192
    ds_read_b64_tr_b16 v[30:31], v18 offset:2496
    s_add_u32 m0, s29, 0xc800
    s_nop 0
    buffer_load_dwordx4 v9, s[16:19], s32 offen lds
    v_mfma_f32_16x16x32_bf16 v[188:191], v[44:47], v[60:63], v[188:191]
    v_mfma_f32_16x16x32_bf16 v[192:195], v[44:47], v[64:67], v[192:195]
    v_mfma_f32_16x16x32_bf16 v[196:199], v[44:47], v[68:71], v[196:199]
    v_mfma_f32_16x16x32_bf16 v[200:203], v[44:47], v[72:75], v[200:203]
    ds_read_b64_tr_b16 v[32:33], v18 offset:9408
    ds_read_b64_tr_b16 v[34:35], v18 offset:11712
    ds_read_b64_tr_b16 v[36:37], v18 offset:224
    ds_read_b64_tr_b16 v[38:39], v18 offset:2528
    s_add_u32 m0, s29, 0xec00
    s_nop 0
    buffer_load_dwordx4 v9, s[20:23], s32 offen lds
    v_mfma_f32_16x16x32_bf16 v[204:207], v[48:51], v[60:63], v[204:207]
    v_mfma_f32_16x16x32_bf16 v[208:211], v[48:51], v[64:67], v[208:211]
    v_mfma_f32_16x16x32_bf16 v[212:215], v[48:51], v[68:71], v[212:215]
    v_mfma_f32_16x16x32_bf16 v[216:219], v[48:51], v[72:75], v[216:219]
    ds_read_b64_tr_b16 v[40:41], v18 offset:9440
    s_waitcnt lgkmcnt(13)
    ds_read_b64_tr_b16 v[42:43], v18 offset:11744
    s_add_u32 m0, s30, 0xe800
    s_mov_b64 exec, 0xffff
    buffer_load_dwordx4 v10, s[40:43], s32 offen lds
    s_mov_b64 exec, -1
    s_add_u32 s32, s32, 0x48000
    s_waitcnt lgkmcnt(10)
    v_mfma_f32_16x16x32_bf16 v[92:95], v[20:23], v[76:79], v[92:95]
    v_mfma_f32_16x16x32_bf16 v[96:99], v[20:23], v[80:83], v[96:99]
    v_mfma_f32_16x16x32_bf16 v[100:103], v[20:23], v[84:87], v[100:103]
    v_mfma_f32_16x16x32_bf16 v[104:107], v[20:23], v[88:91], v[104:107]
    ds_read_b64_tr_b16 v[44:45], v18 offset:256
    ds_read_b64_tr_b16 v[46:47], v18 offset:2560
    s_waitcnt lgkmcnt(10)
    v_mfma_f32_16x16x32_bf16 v[108:111], v[24:27], v[76:79], v[108:111]
    v_mfma_f32_16x16x32_bf16 v[112:115], v[24:27], v[80:83], v[112:115]
    v_mfma_f32_16x16x32_bf16 v[116:119], v[24:27], v[84:87], v[116:119]
    v_mfma_f32_16x16x32_bf16 v[120:123], v[24:27], v[88:91], v[120:123]
    ds_read_b64_tr_b16 v[48:49], v18 offset:9472
    ds_read_b64_tr_b16 v[50:51], v18 offset:11776
    s_waitcnt lgkmcnt(10)
    v_mfma_f32_16x16x32_bf16 v[124:127], v[28:31], v[76:79], v[124:127]
    v_mfma_f32_16x16x32_bf16 v[128:131], v[28:31], v[80:83], v[128:131]
    v_mfma_f32_16x16x32_bf16 v[132:135], v[28:31], v[84:87], v[132:135]
    v_mfma_f32_16x16x32_bf16 v[136:139], v[28:31], v[88:91], v[136:139]
    s_waitcnt lgkmcnt(8)
    v_mfma_f32_16x16x32_bf16 v[140:143], v[32:35], v[76:79], v[140:143]
    v_mfma_f32_16x16x32_bf16 v[144:147], v[32:35], v[80:83], v[144:147]
    v_mfma_f32_16x16x32_bf16 v[148:151], v[32:35], v[84:87], v[148:151]
    v_mfma_f32_16x16x32_bf16 v[152:155], v[32:35], v[88:91], v[152:155]
    s_waitcnt vmcnt(5) lgkmcnt(0)
    s_barrier
    ds_read_b128 v[60:63], v12 offset:0
    ds_read_b128 v[64:67], v12 offset:1024
    ds_read_b128 v[68:71], v12 offset:2048
    s_add_u32 m0, s29, 0x11000
    s_nop 0
    buffer_load_dwordx4 v8, s[12:15], s31 offen lds
    v_mfma_f32_16x16x32_bf16 v[156:159], v[36:39], v[76:79], v[156:159]
    v_mfma_f32_16x16x32_bf16 v[160:163], v[36:39], v[80:83], v[160:163]
    v_mfma_f32_16x16x32_bf16 v[164:167], v[36:39], v[84:87], v[164:167]
    v_mfma_f32_16x16x32_bf16 v[168:171], v[36:39], v[88:91], v[168:171]
    ds_read_b128 v[72:75], v12 offset:3072
    ds_read_b64_tr_b16 v[20:21], v16 offset:160
    ds_read_b64_tr_b16 v[22:23], v16 offset:2464
    s_add_u32 m0, s29, 0x13000
    s_add_u32 s33, s31, 0x24000
    buffer_load_dwordx4 v8, s[12:15], s33 offen lds
    s_add_u32 s31, s31, 64
    v_mfma_f32_16x16x32_bf16 v[172:175], v[40:43], v[76:79], v[172:175]
    v_mfma_f32_16x16x32_bf16 v[176:179], v[40:43], v[80:83], v[176:179]
    v_mfma_f32_16x16x32_bf16 v[180:183], v[40:43], v[84:87], v[180:183]
    v_mfma_f32_16x16x32_bf16 v[184:187], v[40:43], v[88:91], v[184:187]
    ds_read_b64_tr_b16 v[24:25], v16 offset:9376
    ds_read_b64_tr_b16 v[26:27], v16 offset:11680
    ds_read_b64_tr_b16 v[28:29], v16 offset:192
    ds_read_b64_tr_b16 v[30:31], v16 offset:2496
    s_add_u32 m0, s29, 0x15000
    s_nop 0
    buffer_load_dwordx4 v9, s[16:19], s32 offen lds
    v_mfma_f32_16x16x32_bf16 v[188:191], v[44:47], v[76:79], v[188:191]
    v_mfma_f32_16x16x32_bf16 v[192:195], v[44:47], v[80:83], v[192:195]
    v_mfma_f32_16x16x32_bf16 v[196:199], v[44:47], v[84:87], v[196:199]
    v_mfma_f32_16x16x32_bf16 v[200:203], v[44:47], v[88:91], v[200:203]
    ds_read_b64_tr_b16 v[32:33], v16 offset:9408
    ds_read_b64_tr_b16 v[34:35], v16 offset:11712
    ds_read_b64_tr_b16 v[36:37], v16 offset:224
    ds_read_b64_tr_b16 v[38:39], v16 offset:2528
    s_add_u32 m0, s29, 0x17400
    s_nop 0
    buffer_load_dwordx4 v9, s[20:23], s32 offen lds
    v_mfma_f32_16x16x32_bf16 v[204:207], v[48:51], v[76:79], v[204:207]
    v_mfma_f32_16x16x32_bf16 v[208:211], v[48:51], v[80:83], v[208:211]
    v_mfma_f32_16x16x32_bf16 v[212:215], v[48:51], v[84:87], v[212:215]
    v_mfma_f32_16x16x32_bf16 v[216:219], v[48:51], v[88:91], v[216:219]
    ds_read_b64_tr_b16 v[40:41], v16 offset:9440
    s_waitcnt lgkmcnt(13)
    ds_read_b64_tr_b16 v[42:43], v16 offset:11744
    s_add_u32 m0, s30, 0x17000
    s_mov_b64 exec, 0xffff
    buffer_load_dwordx4 v10, s[40:43], s32 offen lds
    s_mov_b64 exec, -1
    s_add_u32 s32, s32, 0x48000
    s_waitcnt lgkmcnt(10)
    v_mfma_f32_16x16x32_bf16 v[92:95], v[20:23], v[60:63], v[92:95]
    v_mfma_f32_16x16x32_bf16 v[96:99], v[20:23], v[64:67], v[96:99]
    v_mfma_f32_16x16x32_bf16 v[100:103], v[20:23], v[68:71], v[100:103]
    v_mfma_f32_16x16x32_bf16 v[104:107], v[20:23], v[72:75], v[104:107]
    ds_read_b64_tr_b16 v[44:45], v16 offset:256
    ds_read_b64_tr_b16 v[46:47], v16 offset:2560
    s_waitcnt lgkmcnt(10)
    v_mfma_f32_16x16x32_bf16 v[108:111], v[24:27], v[60:63], v[108:111]
    v_mfma_f32_16x16x32_bf16 v[112:115], v[24:27], v[64:67], v[112:115]
    v_mfma_f32_16x16x32_bf16 v[116:119], v[24:27], v[68:71], v[116:119]
    v_mfma_f32_16x16x32_bf16 v[120:123], v[24:27], v[72:75], v[120:123]
    ds_read_b64_tr_b16 v[48:49], v16 offset:9472
    ds_read_b64_tr_b16 v[50:51], v16 offset:11776
    s_waitcnt lgkmcnt(10)
    v_mfma_f32_16x16x32_bf16 v[124:127], v[28:31], v[60:63], v[124:127]
    v_mfma_f32_16x16x32_bf16 v[128:131], v[28:31], v[64:67], v[128:131]
    v_mfma_f32_16x16x32_bf16 v[132:135], v[28:31], v[68:71], v[132:135]
    v_mfma_f32_16x16x32_bf16 v[136:139], v[28:31], v[72:75], v[136:139]
    s_waitcnt lgkmcnt(8)
    v_mfma_f32_16x16x32_bf16 v[140:143], v[32:35], v[60:63], v[140:143]
    v_mfma_f32_16x16x32_bf16 v[144:147], v[32:35], v[64:67], v[144:147]
    v_mfma_f32_16x16x32_bf16 v[148:151], v[32:35], v[68:71], v[148:151]
    v_mfma_f32_16x16x32_bf16 v[152:155], v[32:35], v[72:75], v[152:155]
    s_waitcnt vmcnt(5) lgkmcnt(0)
    s_barrier
    ds_read_b128 v[76:79], v13 offset:0
    ds_read_b128 v[80:83], v13 offset:1024
    ds_read_b128 v[84:87], v13 offset:2048
    s_add_u32 m0, s29, 0x0
    s_nop 0
    buffer_load_dwordx4 v8, s[12:15], s31 offen lds
    v_mfma_f32_16x16x32_bf16 v[156:159], v[36:39], v[60:63], v[156:159]
    v_mfma_f32_16x16x32_bf16 v[160:163], v[36:39], v[64:67], v[160:163]
    v_mfma_f32_16x16x32_bf16 v[164:167], v[36:39], v[68:71], v[164:167]
    v_mfma_f32_16x16x32_bf16 v[168:171], v[36:39], v[72:75], v[168:171]
    ds_read_b128 v[88:91], v13 offset:3072
    ds_read_b64_tr_b16 v[20:21], v17 offset:160
    ds_read_b64_tr_b16 v[22:23], v17 offset:2464
    s_add_u32 m0, s29, 0x2000
    s_add_u32 s33, s31, 0x24000
    buffer_load_dwordx4 v8, s[12:15], s33 offen lds
    s_add_u32 s31, s31, 64
    v_mfma_f32_16x16x32_bf16 v[172:175], v[40:43], v[60:63], v[172:175]
    v_mfma_f32_16x16x32_bf16 v[176:179], v[40:43], v[64:67], v[176:179]
    v_mfma_f32_16x16x32_bf16 v[180:183], v[40:43], v[68:71], v[180:183]
    v_mfma_f32_16x16x32_bf16 v[184:187], v[40:43], v[72:75], v[184:187]
    ds_read_b64_tr_b16 v[24:25], v17 offset:9376
    ds_read_b64_tr_b16 v[26:27], v17 offset:11680
    ds_read_b64_tr_b16 v[28:29], v17 offset:192
    ds_read_b64_tr_b16 v[30:31], v17 offset:2496
    s_add_u32 m0, s29, 0x4000
    s_nop 0
    buffer_load_dwordx4 v9, s[16:19], s32 offen lds
    v_mfma_f32_16x16x32_bf16 v[188:191], v[44:47], v[60:63], v[188:191]
    v_mfma_f32_16x16x32_bf16 v[192:195], v[44:47], v[64:67], v[192:195]
    v_mfma_f32_16x16x32_bf16 v[196:199], v[44:47], v[68:71], v[196:199]
    v_mfma_f32_16x16x32_bf16 v[200:203], v[44:47], v[72:75], v[200:203]
    ds_read_b64_tr_b16 v[32:33], v17 offset:9408
    ds_read_b64_tr_b16 v[34:35], v17 offset:11712
    ds_read_b64_tr_b16 v[36:37], v17 offset:224
    ds_read_b64_tr_b16 v[38:39], v17 offset:2528
    s_add_u32 m0, s29, 0x6400
    s_nop 0
    buffer_load_dwordx4 v9, s[20:23], s32 offen lds
    v_mfma_f32_16x16x32_bf16 v[204:207], v[48:51], v[60:63], v[204:207]
    v_mfma_f32_16x16x32_bf16 v[208:211], v[48:51], v[64:67], v[208:211]
    v_mfma_f32_16x16x32_bf16 v[212:215], v[48:51], v[68:71], v[212:215]
    v_mfma_f32_16x16x32_bf16 v[216:219], v[48:51], v[72:75], v[216:219]
    ds_read_b64_tr_b16 v[40:41], v17 offset:9440
    s_waitcnt lgkmcnt(13)
    ds_read_b64_tr_b16 v[42:43], v17 offset:11744
    s_add_u32 m0, s30, 0x6000
    s_mov_b64 exec, 0xffff
    buffer_load_dwordx4 v10, s[40:43], s32 offen lds
    s_mov_b64 exec, -1
    s_add_u32 s32, s32, 0x48000
    s_waitcnt lgkmcnt(10)
    v_mfma_f32_16x16x32_bf16 v[92:95], v[20:23], v[76:79], v[92:95]
    v_mfma_f32_16x16x32_bf16 v[96:99], v[20:23], v[80:83], v[96:99]
    v_mfma_f32_16x16x32_bf16 v[100:103], v[20:23], v[84:87], v[100:103]
    v_mfma_f32_16x16x32_bf16 v[104:107], v[20:23], v[88:91], v[104:107]
    ds_read_b64_tr_b16 v[44:45], v17 offset:256
    ds_read_b64_tr_b16 v[46:47], v17 offset:2560
    s_waitcnt lgkmcnt(10)
    v_mfma_f32_16x16x32_bf16 v[108:111], v[24:27], v[76:79], v[108:111]
    v_mfma_f32_16x16x32_bf16 v[112:115], v[24:27], v[80:83], v[112:115]
    v_mfma_f32_16x16x32_bf16 v[116:119], v[24:27], v[84:87], v[116:119]
    v_mfma_f32_16x16x32_bf16 v[120:123], v[24:27], v[88:91], v[120:123]
    ds_read_b64_tr_b16 v[48:49], v17 offset:9472
    ds_read_b64_tr_b16 v[50:51], v17 offset:11776
    s_waitcnt lgkmcnt(10)
    v_mfma_f32_16x16x32_bf16 v[124:127], v[28:31], v[76:79], v[124:127]
    v_mfma_f32_16x16x32_bf16 v[128:131], v[28:31], v[80:83], v[128:131]
    v_mfma_f32_16x16x32_bf16 v[132:135], v[28:31], v[84:87], v[132:135]
    v_mfma_f32_16x16x32_bf16 v[136:139], v[28:31], v[88:91], v[136:139]
    s_waitcnt lgkmcnt(8)
    v_mfma_f32_16x16x32_bf16 v[140:143], v[32:35], v[76:79], v[140:143]
    v_mfma_f32_16x16x32_bf16 v[144:147], v[32:35], v[80:83], v[144:147]
    v_mfma_f32_16x16x32_bf16 v[148:151], v[32:35], v[84:87], v[148:151]
    v_mfma_f32_16x16x32_bf16 v[152:155], v[32:35], v[88:91], v[152:155]
    s_waitcnt vmcnt(5) lgkmcnt(0)
    s_barrier
    ds_read_b128 v[60:63], v14 offset:0
    ds_read_b128 v[64:67], v14 offset:1024
    ds_read_b128 v[68:71], v14 offset:2048
    s_add_u32 m0, s29, 0x8800
    s_nop 0
    buffer_load_dwordx4 v8, s[12:15], s31 offen lds
    v_mfma_f32_16x16x32_bf16 v[156:159], v[36:39], v[76:79], v[156:159]
    v_mfma_f32_16x16x32_bf16 v[160:163], v[36:39], v[80:83], v[160:163]
    v_mfma_f32_16x16x32_bf16 v[164:167], v[36:39], v[84:87], v[164:167]
    v_mfma_f32_16x16x32_bf16 v[168:171], v[36:39], v[88:91], v[168:171]
    ds_read_b128 v[72:75], v14 offset:3072
    ds_read_b64_tr_b16 v[20:21], v18 offset:160
    ds_read_b64_tr_b16 v[22:23], v18 offset:2464
    s_add_u32 m0, s29, 0xa800
    s_add_u32 s33, s31, 0x24000
    buffer_load_dwordx4 v8, s[12:15], s33 offen lds
    s_add_u32 s31, s31, 64
    v_mfma_f32_16x16x32_bf16 v[172:175], v[40:43], v[76:79], v[172:175]
    v_mfma_f32_16x16x32_bf16 v[176:179], v[40:43], v[80:83], v[176:179]
    v_mfma_f32_16x16x32_bf16 v[180:183], v[40:43], v[84:87], v[180:183]
    v_mfma_f32_16x16x32_bf16 v[184:187], v[40:43], v[88:91], v[184:187]
    ds_read_b64_tr_b16 v[24:25], v18 offset:9376
    ds_read_b64_tr_b16 v[26:27], v18 offset:11680
    ds_read_b64_tr_b16 v[28:29], v18 offset:192
    ds_read_b64_tr_b16 v[30:31], v18 offset:2496
    s_add_u32 m0, s29, 0xc800
    s_nop 0
    buffer_load_dwordx4 v9, s[16:19], s32 offen lds
    v_mfma_f32_16x16x32_bf16 v[188:191], v[44:47], v[76:79], v[188:191]
    v_mfma_f32_16x16x32_bf16 v[192:195], v[44:47], v[80:83], v[192:195]
    v_mfma_f32_16x16x32_bf16 v[196:199], v[44:47], v[84:87], v[196:199]
    v_mfma_f32_16x16x32_bf16 v[200:203], v[44:47], v[88:91], v[200:203]
    ds_read_b64_tr_b16 v[32:33], v18 offset:9408
    ds_read_b64_tr_b16 v[34:35], v18 offset:11712
    ds_read_b64_tr_b16 v[36:37], v18 offset:224
    ds_read_b64_tr_b16 v[38:39], v18 offset:2528
    s_add_u32 m0, s29, 0xec00
    s_nop 0
    buffer_load_dwordx4 v9, s[20:23], s32 offen lds
    v_mfma_f32_16x16x32_bf16 v[204:207], v[48:51], v[76:79], v[204:207]
    v_mfma_f32_16x16x32_bf16 v[208:211], v[48:51], v[80:83], v[208:211]
    v_mfma_f32_16x16x32_bf16 v[212:215], v[48:51], v[84:87], v[212:215]
    v_mfma_f32_16x16x32_bf16 v[216:219], v[48:51], v[88:91], v[216:219]
    ds_read_b64_tr_b16 v[40:41], v18 offset:9440
    s_waitcnt lgkmcnt(13)
    ds_read_b64_tr_b16 v[42:43], v18 offset:11744
    s_add_u32 m0, s30, 0xe800
    s_mov_b64 exec, 0xffff
    buffer_load_dwordx4 v10, s[40:43], s32 offen lds
    s_mov_b64 exec, -1
    s_add_u32 s32, s32, 0x48000
    s_waitcnt lgkmcnt(10)
    v_mfma_f32_16x16x32_bf16 v[92:95], v[20:23], v[60:63], v[92:95]
    v_mfma_f32_16x16x32_bf16 v[96:99], v[20:23], v[64:67], v[96:99]
    v_mfma_f32_16x16x32_bf16 v[100:103], v[20:23], v[68:71], v[100:103]
    v_mfma_f32_16x16x32_bf16 v[104:107], v[20:23], v[72:75], v[104:107]
    ds_read_b64_tr_b16 v[44:45], v18 offset:256
    ds_read_b64_tr_b16 v[46:47], v18 offset:2560
    s_waitcnt lgkmcnt(10)
    v_mfma_f32_16x16x32_bf16 v[108:111], v[24:27], v[60:63], v[108:111]
    v_mfma_f32_16x16x32_bf16 v[112:115], v[24:27], v[64:67], v[112:115]
    v_mfma_f32_16x16x32_bf16 v[116:119], v[24:27], v[68:71], v[116:119]
    v_mfma_f32_16x16x32_bf16 v[120:123], v[24:27], v[72:75], v[120:123]
    ds_read_b64_tr_b16 v[48:49], v18 offset:9472
    ds_read_b64_tr_b16 v[50:51], v18 offset:11776
    s_waitcnt lgkmcnt(10)
    v_mfma_f32_16x16x32_bf16 v[124:127], v[28:31], v[60:63], v[124:127]
    v_mfma_f32_16x16x32_bf16 v[128:131], v[28:31], v[64:67], v[128:131]
    v_mfma_f32_16x16x32_bf16 v[132:135], v[28:31], v[68:71], v[132:135]
    v_mfma_f32_16x16x32_bf16 v[136:139], v[28:31], v[72:75], v[136:139]
    s_waitcnt lgkmcnt(8)
    v_mfma_f32_16x16x32_bf16 v[140:143], v[32:35], v[60:63], v[140:143]
    v_mfma_f32_16x16x32_bf16 v[144:147], v[32:35], v[64:67], v[144:147]
    v_mfma_f32_16x16x32_bf16 v[148:151], v[32:35], v[68:71], v[148:151]
    v_mfma_f32_16x16x32_bf16 v[152:155], v[32:35], v[72:75], v[152:155]
    s_waitcnt vmcnt(5) lgkmcnt(0)
    s_barrier
    ds_read_b128 v[76:79], v12 offset:0
    ds_read_b128 v[80:83], v12 offset:1024
    ds_read_b128 v[84:87], v12 offset:2048
    s_add_u32 m0, s29, 0x11000
    s_nop 0
    buffer_load_dwordx4 v8, s[12:15], s31 offen lds
    v_mfma_f32_16x16x32_bf16 v[156:159], v[36:39], v[60:63], v[156:159]
    v_mfma_f32_16x16x32_bf16 v[160:163], v[36:39], v[64:67], v[160:163]
    v_mfma_f32_16x16x32_bf16 v[164:167], v[36:39], v[68:71], v[164:167]
    v_mfma_f32_16x16x32_bf16 v[168:171], v[36:39], v[72:75], v[168:171]
    ds_read_b128 v[88:91], v12 offset:3072
    ds_read_b64_tr_b16 v[20:21], v16 offset:160
    ds_read_b64_tr_b16 v[22:23], v16 offset:2464
    s_add_u32 m0, s29, 0x13000
    s_add_u32 s33, s31, 0x24000
    buffer_load_dwordx4 v8, s[12:15], s33 offen lds
    s_add_u32 s31, s31, 64
    v_mfma_f32_16x16x32_bf16 v[172:175], v[40:43], v[60:63], v[172:175]
    v_mfma_f32_16x16x32_bf16 v[176:179], v[40:43], v[64:67], v[176:179]
    v_mfma_f32_16x16x32_bf16 v[180:183], v[40:43], v[68:71], v[180:183]
    v_mfma_f32_16x16x32_bf16 v[184:187], v[40:43], v[72:75], v[184:187]
    ds_read_b64_tr_b16 v[24:25], v16 offset:9376
    ds_read_b64_tr_b16 v[26:27], v16 offset:11680
    ds_read_b64_tr_b16 v[28:29], v16 offset:192
    ds_read_b64_tr_b16 v[30:31], v16 offset:2496
    s_add_u32 m0, s29, 0x15000
    s_nop 0
    buffer_load_dwordx4 v9, s[16:19], s32 offen lds
    v_mfma_f32_16x16x32_bf16 v[188:191], v[44:47], v[60:63], v[188:191]
    v_mfma_f32_16x16x32_bf16 v[192:195], v[44:47], v[64:67], v[192:195]
    v_mfma_f32_16x16x32_bf16 v[196:199], v[44:47], v[68:71], v[196:199]
    v_mfma_f32_16x16x32_bf16 v[200:203], v[44:47], v[72:75], v[200:203]
    ds_read_b64_tr_b16 v[32:33], v16 offset:9408
    ds_read_b64_tr_b16 v[34:35], v16 offset:11712
    ds_read_b64_tr_b16 v[36:37], v16 offset:224
    ds_read_b64_tr_b16 v[38:39], v16 offset:2528
    s_add_u32 m0, s29, 0x17400
    s_nop 0
    buffer_load_dwordx4 v9, s[20:23], s32 offen lds
    v_mfma_f32_16x16x32_bf16 v[204:207], v[48:51], v[60:63], v[204:207]
    v_mfma_f32_16x16x32_bf16 v[208:211], v[48:51], v[64:67], v[208:211]
    v_mfma_f32_16x16x32_bf16 v[212:215], v[48:51], v[68:71], v[212:215]
    v_mfma_f32_16x16x32_bf16 v[216:219], v[48:51], v[72:75], v[216:219]
    ds_read_b64_tr_b16 v[40:41], v16 offset:9440
    s_waitcnt lgkmcnt(13)
    ds_read_b64_tr_b16 v[42:43], v16 offset:11744
    s_add_u32 m0, s30, 0x17000
    s_mov_b64 exec, 0xffff
    buffer_load_dwordx4 v10, s[40:43], s32 offen lds
    s_mov_b64 exec, -1
    s_add_u32 s32, s32, 0x48000
    s_waitcnt lgkmcnt(10)
    v_mfma_f32_16x16x32_bf16 v[92:95], v[20:23], v[76:79], v[92:95]
    v_mfma_f32_16x16x32_bf16 v[96:99], v[20:23], v[80:83], v[96:99]
    v_mfma_f32_16x16x32_bf16 v[100:103], v[20:23], v[84:87], v[100:103]
    v_mfma_f32_16x16x32_bf16 v[104:107], v[20:23], v[88:91], v[104:107]
    ds_read_b64_tr_b16 v[44:45], v16 offset:256
    ds_read_b64_tr_b16 v[46:47], v16 offset:2560
    s_waitcnt lgkmcnt(10)
    v_mfma_f32_16x16x32_bf16 v[108:111], v[24:27], v[76:79], v[108:111]
    v_mfma_f32_16x16x32_bf16 v[112:115], v[24:27], v[80:83], v[112:115]
    v_mfma_f32_16x16x32_bf16 v[116:119], v[24:27], v[84:87], v[116:119]
    v_mfma_f32_16x16x32_bf16 v[120:123], v[24:27], v[88:91], v[120:123]
    ds_read_b64_tr_b16 v[48:49], v16 offset:9472
    ds_read_b64_tr_b16 v[50:51], v16 offset:11776
    s_waitcnt lgkmcnt(10)
    v_mfma_f32_16x16x32_bf16 v[124:127], v[28:31], v[76:79], v[124:127]
    v_mfma_f32_16x16x32_bf16 v[128:131], v[28:31], v[80:83], v[128:131]
    v_mfma_f32_16x16x32_bf16 v[132:135], v[28:31], v[84:87], v[132:135]
    v_mfma_f32_16x16x32_bf16 v[136:139], v[28:31], v[88:91], v[136:139]
    s_waitcnt lgkmcnt(8)
    v_mfma_f32_16x16x32_bf16 v[140:143], v[32:35], v[76:79], v[140:143]
    v_mfma_f32_16x16x32_bf16 v[144:147], v[32:35], v[80:83], v[144:147]
    v_mfma_f32_16x16x32_bf16 v[148:151], v[32:35], v[84:87], v[148:151]
    v_mfma_f32_16x16x32_bf16 v[152:155], v[32:35], v[88:91], v[152:155]
    s_waitcnt vmcnt(5) lgkmcnt(0)
    s_barrier
    ds_read_b128 v[60:63], v13 offset:0
    ds_read_b128 v[64:67], v13 offset:1024
    ds_read_b128 v[68:71], v13 offset:2048
    s_add_u32 m0, s29, 0x0
    s_nop 0
    buffer_load_dwordx4 v8, s[12:15], s31 offen lds
    v_mfma_f32_16x16x32_bf16 v[156:159], v[36:39], v[76:79], v[156:159]
    v_mfma_f32_16x16x32_bf16 v[160:163], v[36:39], v[80:83], v[160:163]
    v_mfma_f32_16x16x32_bf16 v[164:167], v[36:39], v[84:87], v[164:167]
    v_mfma_f32_16x16x32_bf16 v[168:171], v[36:39], v[88:91], v[168:171]
    ds_read_b128 v[72:75], v13 offset:3072
    ds_read_b64_tr_b16 v[20:21], v17 offset:160
    ds_read_b64_tr_b16 v[22:23], v17 offset:2464
    s_add_u32 m0, s29, 0x2000
    s_add_u32 s33, s31, 0x24000
    buffer_load_dwordx4 v8, s[12:15], s33 offen lds
    s_add_u32 s31, s31, 64
    v_mfma_f32_16x16x32_bf16 v[172:175], v[40:43], v[76:79], v[172:175]
    v_mfma_f32_16x16x32_bf16 v[176:179], v[40:43], v[80:83], v[176:179]
    v_mfma_f32_16x16x32_bf16 v[180:183], v[40:43], v[84:87], v[180:183]
    v_mfma_f32_16x16x32_bf16 v[184:187], v[40:43], v[88:91], v[184:187]
    ds_read_b64_tr_b16 v[24:25], v17 offset:9376
    ds_read_b64_tr_b16 v[26:27], v17 offset:11680
    ds_read_b64_tr_b16 v[28:29], v17 offset:192
    ds_read_b64_tr_b16 v[30:31], v17 offset:2496
    s_add_u32 m0, s29, 0x4000
    s_nop 0
    buffer_load_dwordx4 v9, s[16:19], s32 offen lds
    v_mfma_f32_16x16x32_bf16 v[188:191], v[44:47], v[76:79], v[188:191]
    v_mfma_f32_16x16x32_bf16 v[192:195], v[44:47], v[80:83], v[192:195]
    v_mfma_f32_16x16x32_bf16 v[196:199], v[44:47], v[84:87], v[196:199]
    v_mfma_f32_16x16x32_bf16 v[200:203], v[44:47], v[88:91], v[200:203]
    ds_read_b64_tr_b16 v[32:33], v17 offset:9408
    ds_read_b64_tr_b16 v[34:35], v17 offset:11712
    ds_read_b64_tr_b16 v[36:37], v17 offset:224
    ds_read_b64_tr_b16 v[38:39], v17 offset:2528
    s_add_u32 m0, s29, 0x6400
    s_nop 0
    buffer_load_dwordx4 v9, s[20:23], s32 offen lds
    v_mfma_f32_16x16x32_bf16 v[204:207], v[48:51], v[76:79], v[204:207]
    v_mfma_f32_16x16x32_bf16 v[208:211], v[48:51], v[80:83], v[208:211]
    v_mfma_f32_16x16x32_bf16 v[212:215], v[48:51], v[84:87], v[212:215]
    v_mfma_f32_16x16x32_bf16 v[216:219], v[48:51], v[88:91], v[216:219]
    ds_read_b64_tr_b16 v[40:41], v17 offset:9440
    s_waitcnt lgkmcnt(13)
    ds_read_b64_tr_b16 v[42:43], v17 offset:11744
    s_add_u32 m0, s30, 0x6000
    s_mov_b64 exec, 0xffff
    buffer_load_dwordx4 v10, s[40:43], s32 offen lds
    s_mov_b64 exec, -1
    s_add_u32 s32, s32, 0x48000
    s_waitcnt lgkmcnt(10)
    v_mfma_f32_16x16x32_bf16 v[92:95], v[20:23], v[60:63], v[92:95]
    v_mfma_f32_16x16x32_bf16 v[96:99], v[20:23], v[64:67], v[96:99]
    v_mfma_f32_16x16x32_bf16 v[100:103], v[20:23], v[68:71], v[100:103]
    v_mfma_f32_16x16x32_bf16 v[104:107], v[20:23], v[72:75], v[104:107]
    ds_read_b64_tr_b16 v[44:45], v17 offset:256
    ds_read_b64_tr_b16 v[46:47], v17 offset:2560
    s_waitcnt lgkmcnt(10)
    v_mfma_f32_16x16x32_bf16 v[108:111], v[24:27], v[60:63], v[108:111]
    v_mfma_f32_16x16x32_bf16 v[112:115], v[24:27], v[64:67], v[112:115]
    v_mfma_f32_16x16x32_bf16 v[116:119], v[24:27], v[68:71], v[116:119]
    v_mfma_f32_16x16x32_bf16 v[120:123], v[24:27], v[72:75], v[120:123]
    ds_read_b64_tr_b16 v[48:49], v17 offset:9472
    ds_read_b64_tr_b16 v[50:51], v17 offset:11776
    s_waitcnt lgkmcnt(10)
    v_mfma_f32_16x16x32_bf16 v[124:127], v[28:31], v[60:63], v[124:127]
    v_mfma_f32_16x16x32_bf16 v[128:131], v[28:31], v[64:67], v[128:131]
    v_mfma_f32_16x16x32_bf16 v[132:135], v[28:31], v[68:71], v[132:135]
    v_mfma_f32_16x16x32_bf16 v[136:139], v[28:31], v[72:75], v[136:139]
    s_waitcnt lgkmcnt(8)
    v_mfma_f32_16x16x32_bf16 v[140:143], v[32:35], v[60:63], v[140:143]
    v_mfma_f32_16x16x32_bf16 v[144:147], v[32:35], v[64:67], v[144:147]
    v_mfma_f32_16x16x32_bf16 v[148:151], v[32:35], v[68:71], v[148:151]
    v_mfma_f32_16x16x32_bf16 v[152:155], v[32:35], v[72:75], v[152:155]
    s_waitcnt vmcnt(5) lgkmcnt(0)
    s_barrier
    ds_read_b128 v[76:79], v14 offset:0
    ds_read_b128 v[80:83], v14 offset:1024
    ds_read_b128 v[84:87], v14 offset:2048
    s_add_u32 m0, s29, 0x8800
    s_nop 0
    buffer_load_dwordx4 v8, s[12:15], s31 offen lds
    v_mfma_f32_16x16x32_bf16 v[156:159], v[36:39], v[60:63], v[156:159]
    v_mfma_f32_16x16x32_bf16 v[160:163], v[36:39], v[64:67], v[160:163]
    v_mfma_f32_16x16x32_bf16 v[164:167], v[36:39], v[68:71], v[164:167]
    v_mfma_f32_16x16x32_bf16 v[168:171], v[36:39], v[72:75], v[168:171]
    ds_read_b128 v[88:91], v14 offset:3072
    ds_read_b64_tr_b16 v[20:21], v18 offset:160
    ds_read_b64_tr_b16 v[22:23], v18 offset:2464
    s_add_u32 m0, s29, 0xa800
    s_add_u32 s33, s31, 0x24000
    buffer_load_dwordx4 v8, s[12:15], s33 offen lds
    s_add_u32 s31, s31, 64
    v_mfma_f32_16x16x32_bf16 v[172:175], v[40:43], v[60:63], v[172:175]
    v_mfma_f32_16x16x32_bf16 v[176:179], v[40:43], v[64:67], v[176:179]
    v_mfma_f32_16x16x32_bf16 v[180:183], v[40:43], v[68:71], v[180:183]
    v_mfma_f32_16x16x32_bf16 v[184:187], v[40:43], v[72:75], v[184:187]
    ds_read_b64_tr_b16 v[24:25], v18 offset:9376
    ds_read_b64_tr_b16 v[26:27], v18 offset:11680
    ds_read_b64_tr_b16 v[28:29], v18 offset:192
    ds_read_b64_tr_b16 v[30:31], v18 offset:2496
    s_add_u32 m0, s29, 0xc800
    s_nop 0
    buffer_load_dwordx4 v9, s[16:19], s32 offen lds
    v_mfma_f32_16x16x32_bf16 v[188:191], v[44:47], v[60:63], v[188:191]
    v_mfma_f32_16x16x32_bf16 v[192:195], v[44:47], v[64:67], v[192:195]
    v_mfma_f32_16x16x32_bf16 v[196:199], v[44:47], v[68:71], v[196:199]
    v_mfma_f32_16x16x32_bf16 v[200:203], v[44:47], v[72:75], v[200:203]
    ds_read_b64_tr_b16 v[32:33], v18 offset:9408
    ds_read_b64_tr_b16 v[34:35], v18 offset:11712
    ds_read_b64_tr_b16 v[36:37], v18 offset:224
    ds_read_b64_tr_b16 v[38:39], v18 offset:2528
    s_add_u32 m0, s29, 0xec00
    s_nop 0
    buffer_load_dwordx4 v9, s[20:23], s32 offen lds
    v_mfma_f32_16x16x32_bf16 v[204:207], v[48:51], v[60:63], v[204:207]
    v_mfma_f32_16x16x32_bf16 v[208:211], v[48:51], v[64:67], v[208:211]
    v_mfma_f32_16x16x32_bf16 v[212:215], v[48:51], v[68:71], v[212:215]
    v_mfma_f32_16x16x32_bf16 v[216:219], v[48:51], v[72:75], v[216:219]
    ds_read_b64_tr_b16 v[40:41], v18 offset:9440
    s_waitcnt lgkmcnt(13)
    ds_read_b64_tr_b16 v[42:43], v18 offset:11744
    s_add_u32 m0, s30, 0xe800
    s_mov_b64 exec, 0xffff
    buffer_load_dwordx4 v10, s[40:43], s32 offen lds
    s_mov_b64 exec, -1
    s_add_u32 s32, s32, 0x48000
    s_waitcnt lgkmcnt(10)
    v_mfma_f32_16x16x32_bf16 v[92:95], v[20:23], v[76:79], v[92:95]
    v_mfma_f32_16x16x32_bf16 v[96:99], v[20:23], v[80:83], v[96:99]
    v_mfma_f32_16x16x32_bf16 v[100:103], v[20:23], v[84:87], v[100:103]
    v_mfma_f32_16x16x32_bf16 v[104:107], v[20:23], v[88:91], v[104:107]
    ds_read_b64_tr_b16 v[44:45], v18 offset:256
    ds_read_b64_tr_b16 v[46:47], v18 offset:2560
    s_waitcnt lgkmcnt(10)
    v_mfma_f32_16x16x32_bf16 v[108:111], v[24:27], v[76:79], v[108:111]
    v_mfma_f32_16x16x32_bf16 v[112:115], v[24:27], v[80:83], v[112:115]
    v_mfma_f32_16x16x32_bf16 v[116:119], v[24:27], v[84:87], v[116:119]
    v_mfma_f32_16x16x32_bf16 v[120:123], v[24:27], v[88:91], v[120:123]
    ds_read_b64_tr_b16 v[48:49], v18 offset:9472
    ds_read_b64_tr_b16 v[50:51], v18 offset:11776
    s_waitcnt lgkmcnt(10)
    v_mfma_f32_16x16x32_bf16 v[124:127], v[28:31], v[76:79], v[124:127]
    v_mfma_f32_16x16x32_bf16 v[128:131], v[28:31], v[80:83], v[128:131]
    v_mfma_f32_16x16x32_bf16 v[132:135], v[28:31], v[84:87], v[132:135]
    v_mfma_f32_16x16x32_bf16 v[136:139], v[28:31], v[88:91], v[136:139]
    s_waitcnt lgkmcnt(8)
    v_mfma_f32_16x16x32_bf16 v[140:143], v[32:35], v[76:79], v[140:143]
    v_mfma_f32_16x16x32_bf16 v[144:147], v[32:35], v[80:83], v[144:147]
    v_mfma_f32_16x16x32_bf16 v[148:151], v[32:35], v[84:87], v[148:151]
    v_mfma_f32_16x16x32_bf16 v[152:155], v[32:35], v[88:91], v[152:155]
    s_waitcnt vmcnt(5) lgkmcnt(0)
    s_barrier
    ds_read_b128 v[60:63], v12 offset:0
    ds_read_b128 v[64:67], v12 offset:1024
    ds_read_b128 v[68:71], v12 offset:2048
    s_add_u32 m0, s29, 0x11000
    s_nop 0
    buffer_load_dwordx4 v8, s[12:15], s31 offen lds
    v_mfma_f32_16x16x32_bf16 v[156:159], v[36:39], v[76:79], v[156:159]
    v_mfma_f32_16x16x32_bf16 v[160:163], v[36:39], v[80:83], v[160:163]
    v_mfma_f32_16x16x32_bf16 v[164:167], v[36:39], v[84:87], v[164:167]
    v_mfma_f32_16x16x32_bf16 v[168:171], v[36:39], v[88:91], v[168:171]
    ds_read_b128 v[72:75], v12 offset:3072
    ds_read_b64_tr_b16 v[20:21], v16 offset:160
    ds_read_b64_tr_b16 v[22:23], v16 offset:2464
    s_add_u32 m0, s29, 0x13000
    s_add_u32 s33, s31, 0x24000
    buffer_load_dwordx4 v8, s[12:15], s33 offen lds
    s_add_u32 s31, s31, 64
    v_mfma_f32_16x16x32_bf16 v[172:175], v[40:43], v[76:79], v[172:175]
    v_mfma_f32_16x16x32_bf16 v[176:179], v[40:43], v[80:83], v[176:179]
    v_mfma_f32_16x16x32_bf16 v[180:183], v[40:43], v[84:87], v[180:183]
    v_mfma_f32_16x16x32_bf16 v[184:187], v[40:43], v[88:91], v[184:187]
    ds_read_b64_tr_b16 v[24:25], v16 offset:9376
    ds_read_b64_tr_b16 v[26:27], v16 offset:11680
    ds_read_b64_tr_b16 v[28:29], v16 offset:192
    ds_read_b64_tr_b16 v[30:31], v16 offset:2496
    s_add_u32 m0, s29, 0x15000
    s_nop 0
    buffer_load_dwordx4 v9, s[16:19], s32 offen lds
    v_mfma_f32_16x16x32_bf16 v[188:191], v[44:47], v[76:79], v[188:191]
    v_mfma_f32_16x16x32_bf16 v[192:195], v[44:47], v[80:83], v[192:195]
    v_mfma_f32_16x16x32_bf16 v[196:199], v[44:47], v[84:87], v[196:199]
    v_mfma_f32_16x16x32_bf16 v[200:203], v[44:47], v[88:91], v[200:203]
    ds_read_b64_tr_b16 v[32:33], v16 offset:9408
    ds_read_b64_tr_b16 v[34:35], v16 offset:11712
    ds_read_b64_tr_b16 v[36:37], v16 offset:224
    ds_read_b64_tr_b16 v[38:39], v16 offset:2528
    s_add_u32 m0, s29, 0x17400
    s_nop 0
    buffer_load_dwordx4 v9, s[20:23], s32 offen lds
    v_mfma_f32_16x16x32_bf16 v[204:207], v[48:51], v[76:79], v[204:207]
    v_mfma_f32_16x16x32_bf16 v[208:211], v[48:51], v[80:83], v[208:211]
    v_mfma_f32_16x16x32_bf16 v[212:215], v[48:51], v[84:87], v[212:215]
    v_mfma_f32_16x16x32_bf16 v[216:219], v[48:51], v[88:91], v[216:219]
    ds_read_b64_tr_b16 v[40:41], v16 offset:9440
    s_waitcnt lgkmcnt(13)
    ds_read_b64_tr_b16 v[42:43], v16 offset:11744
    s_add_u32 m0, s30, 0x17000
    s_mov_b64 exec, 0xffff
    buffer_load_dwordx4 v10, s[40:43], s32 offen lds
    s_mov_b64 exec, -1
    s_add_u32 s32, s32, 0x48000
    s_waitcnt lgkmcnt(10)
    v_mfma_f32_16x16x32_bf16 v[92:95], v[20:23], v[60:63], v[92:95]
    v_mfma_f32_16x16x32_bf16 v[96:99], v[20:23], v[64:67], v[96:99]
    v_mfma_f32_16x16x32_bf16 v[100:103], v[20:23], v[68:71], v[100:103]
    v_mfma_f32_16x16x32_bf16 v[104:107], v[20:23], v[72:75], v[104:107]
    ds_read_b64_tr_b16 v[44:45], v16 offset:256
    ds_read_b64_tr_b16 v[46:47], v16 offset:2560
    s_waitcnt lgkmcnt(10)
    v_mfma_f32_16x16x32_bf16 v[108:111], v[24:27], v[60:63], v[108:111]
    v_mfma_f32_16x16x32_bf16 v[112:115], v[24:27], v[64:67], v[112:115]
    v_mfma_f32_16x16x32_bf16 v[116:119], v[24:27], v[68:71], v[116:119]
    v_mfma_f32_16x16x32_bf16 v[120:123], v[24:27], v[72:75], v[120:123]
    ds_read_b64_tr_b16 v[48:49], v16 offset:9472
    ds_read_b64_tr_b16 v[50:51], v16 offset:11776
    s_waitcnt lgkmcnt(10)
    v_mfma_f32_16x16x32_bf16 v[124:127], v[28:31], v[60:63], v[124:127]
    v_mfma_f32_16x16x32_bf16 v[128:131], v[28:31], v[64:67], v[128:131]
    v_mfma_f32_16x16x32_bf16 v[132:135], v[28:31], v[68:71], v[132:135]
    v_mfma_f32_16x16x32_bf16 v[136:139], v[28:31], v[72:75], v[136:139]
    s_waitcnt lgkmcnt(8)
    v_mfma_f32_16x16x32_bf16 v[140:143], v[32:35], v[60:63], v[140:143]
    v_mfma_f32_16x16x32_bf16 v[144:147], v[32:35], v[64:67], v[144:147]
    v_mfma_f32_16x16x32_bf16 v[148:151], v[32:35], v[68:71], v[148:151]
    v_mfma_f32_16x16x32_bf16 v[152:155], v[32:35], v[72:75], v[152:155]
    s_waitcnt vmcnt(5) lgkmcnt(0)
    s_barrier
    ds_read_b128 v[76:79], v13 offset:0
    ds_read_b128 v[80:83], v13 offset:1024
    ds_read_b128 v[84:87], v13 offset:2048
    s_add_u32 m0, s29, 0x0
    s_nop 0
    buffer_load_dwordx4 v8, s[12:15], s31 offen lds
    v_mfma_f32_16x16x32_bf16 v[156:159], v[36:39], v[60:63], v[156:159]
    v_mfma_f32_16x16x32_bf16 v[160:163], v[36:39], v[64:67], v[160:163]
    v_mfma_f32_16x16x32_bf16 v[164:167], v[36:39], v[68:71], v[164:167]
    v_mfma_f32_16x16x32_bf16 v[168:171], v[36:39], v[72:75], v[168:171]
    ds_read_b128 v[88:91], v13 offset:3072
    ds_read_b64_tr_b16 v[20:21], v17 offset:160
    ds_read_b64_tr_b16 v[22:23], v17 offset:2464
    s_add_u32 m0, s29, 0x2000
    s_add_u32 s33, s31, 0x24000
    buffer_load_dwordx4 v8, s[12:15], s33 offen lds
    s_add_u32 s31, s31, 64
    v_mfma_f32_16x16x32_bf16 v[172:175], v[40:43], v[60:63], v[172:175]
    v_mfma_f32_16x16x32_bf16 v[176:179], v[40:43], v[64:67], v[176:179]
    v_mfma_f32_16x16x32_bf16 v[180:183], v[40:43], v[68:71], v[180:183]
    v_mfma_f32_16x16x32_bf16 v[184:187], v[40:43], v[72:75], v[184:187]
    ds_read_b64_tr_b16 v[24:25], v17 offset:9376
    ds_read_b64_tr_b16 v[26:27], v17 offset:11680
    ds_read_b64_tr_b16 v[28:29], v17 offset:192
    ds_read_b64_tr_b16 v[30:31], v17 offset:2496
    s_add_u32 m0, s29, 0x4000
    s_nop 0
    buffer_load_dwordx4 v9, s[16:19], s32 offen lds
    v_mfma_f32_16x16x32_bf16 v[188:191], v[44:47], v[60:63], v[188:191]
    v_mfma_f32_16x16x32_bf16 v[192:195], v[44:47], v[64:67], v[192:195]
    v_mfma_f32_16x16x32_bf16 v[196:199], v[44:47], v[68:71], v[196:199]
    v_mfma_f32_16x16x32_bf16 v[200:203], v[44:47], v[72:75], v[200:203]
    ds_read_b64_tr_b16 v[32:33], v17 offset:9408
    ds_read_b64_tr_b16 v[34:35], v17 offset:11712
    ds_read_b64_tr_b16 v[36:37], v17 offset:224
    ds_read_b64_tr_b16 v[38:39], v17 offset:2528
    s_add_u32 m0, s29, 0x6400
    s_nop 0
    buffer_load_dwordx4 v9, s[20:23], s32 offen lds
    v_mfma_f32_16x16x32_bf16 v[204:207], v[48:51], v[60:63], v[204:207]
    v_mfma_f32_16x16x32_bf16 v[208:211], v[48:51], v[64:67], v[208:211]
    v_mfma_f32_16x16x32_bf16 v[212:215], v[48:51], v[68:71], v[212:215]
    v_mfma_f32_16x16x32_bf16 v[216:219], v[48:51], v[72:75], v[216:219]
    ds_read_b64_tr_b16 v[40:41], v17 offset:9440
    s_waitcnt lgkmcnt(13)
    ds_read_b64_tr_b16 v[42:43], v17 offset:11744
    s_add_u32 m0, s30, 0x6000
    s_mov_b64 exec, 0xffff
    buffer_load_dwordx4 v10, s[40:43], s32 offen lds
    s_mov_b64 exec, -1
    s_add_u32 s32, s32, 0x48000
    s_waitcnt lgkmcnt(10)
    v_mfma_f32_16x16x32_bf16 v[92:95], v[20:23], v[76:79], v[92:95]
    v_mfma_f32_16x16x32_bf16 v[96:99], v[20:23], v[80:83], v[96:99]
    v_mfma_f32_16x16x32_bf16 v[100:103], v[20:23], v[84:87], v[100:103]
    v_mfma_f32_16x16x32_bf16 v[104:107], v[20:23], v[88:91], v[104:107]
    ds_read_b64_tr_b16 v[44:45], v17 offset:256
    ds_read_b64_tr_b16 v[46:47], v17 offset:2560
    s_waitcnt lgkmcnt(10)
    v_mfma_f32_16x16x32_bf16 v[108:111], v[24:27], v[76:79], v[108:111]
    v_mfma_f32_16x16x32_bf16 v[112:115], v[24:27], v[80:83], v[112:115]
    v_mfma_f32_16x16x32_bf16 v[116:119], v[24:27], v[84:87], v[116:119]
    v_mfma_f32_16x16x32_bf16 v[120:123], v[24:27], v[88:91], v[120:123]
    ds_read_b64_tr_b16 v[48:49], v17 offset:9472
    ds_read_b64_tr_b16 v[50:51], v17 offset:11776
    s_waitcnt lgkmcnt(10)
    v_mfma_f32_16x16x32_bf16 v[124:127], v[28:31], v[76:79], v[124:127]
    v_mfma_f32_16x16x32_bf16 v[128:131], v[28:31], v[80:83], v[128:131]
    v_mfma_f32_16x16x32_bf16 v[132:135], v[28:31], v[84:87], v[132:135]
    v_mfma_f32_16x16x32_bf16 v[136:139], v[28:31], v[88:91], v[136:139]
    s_waitcnt lgkmcnt(8)
    v_mfma_f32_16x16x32_bf16 v[140:143], v[32:35], v[76:79], v[140:143]
    v_mfma_f32_16x16x32_bf16 v[144:147], v[32:35], v[80:83], v[144:147]
    v_mfma_f32_16x16x32_bf16 v[148:151], v[32:35], v[84:87], v[148:151]
    v_mfma_f32_16x16x32_bf16 v[152:155], v[32:35], v[88:91], v[152:155]
    s_waitcnt vmcnt(5) lgkmcnt(0)
    s_barrier
    ds_read_b128 v[60:63], v14 offset:0
    ds_read_b128 v[64:67], v14 offset:1024
    ds_read_b128 v[68:71], v14 offset:2048
    s_add_u32 m0, s29, 0x8800
    s_nop 0
    buffer_load_dwordx4 v8, s[12:15], s31 offen lds
    v_mfma_f32_16x16x32_bf16 v[156:159], v[36:39], v[76:79], v[156:159]
    v_mfma_f32_16x16x32_bf16 v[160:163], v[36:39], v[80:83], v[160:163]
    v_mfma_f32_16x16x32_bf16 v[164:167], v[36:39], v[84:87], v[164:167]
    v_mfma_f32_16x16x32_bf16 v[168:171], v[36:39], v[88:91], v[168:171]
    ds_read_b128 v[72:75], v14 offset:3072
    ds_read_b64_tr_b16 v[20:21], v18 offset:160
    ds_read_b64_tr_b16 v[22:23], v18 offset:2464
    s_add_u32 m0, s29, 0xa800
    s_add_u32 s33, s31, 0x24000
    buffer_load_dwordx4 v8, s[12:15], s33 offen lds
    s_add_u32 s31, s31, 64
    v_mfma_f32_16x16x32_bf16 v[172:175], v[40:43], v[76:79], v[172:175]
    v_mfma_f32_16x16x32_bf16 v[176:179], v[40:43], v[80:83], v[176:179]
    v_mfma_f32_16x16x32_bf16 v[180:183], v[40:43], v[84:87], v[180:183]
    v_mfma_f32_16x16x32_bf16 v[184:187], v[40:43], v[88:91], v[184:187]
    ds_read_b64_tr_b16 v[24:25], v18 offset:9376
    ds_read_b64_tr_b16 v[26:27], v18 offset:11680
    ds_read_b64_tr_b16 v[28:29], v18 offset:192
    ds_read_b64_tr_b16 v[30:31], v18 offset:2496
    s_add_u32 m0, s29, 0xc800
    s_nop 0
    buffer_load_dwordx4 v9, s[16:19], s32 offen lds
    v_mfma_f32_16x16x32_bf16 v[188:191], v[44:47], v[76:79], v[188:191]
    v_mfma_f32_16x16x32_bf16 v[192:195], v[44:47], v[80:83], v[192:195]
    v_mfma_f32_16x16x32_bf16 v[196:199], v[44:47], v[84:87], v[196:199]
    v_mfma_f32_16x16x32_bf16 v[200:203], v[44:47], v[88:91], v[200:203]
    ds_read_b64_tr_b16 v[32:33], v18 offset:9408
    ds_read_b64_tr_b16 v[34:35], v18 offset:11712
    ds_read_b64_tr_b16 v[36:37], v18 offset:224
    ds_read_b64_tr_b16 v[38:39], v18 offset:2528
    s_add_u32 m0, s29, 0xec00
    s_nop 0
    buffer_load_dwordx4 v9, s[20:23], s32 offen lds
    v_mfma_f32_16x16x32_bf16 v[204:207], v[48:51], v[76:79], v[204:207]
    v_mfma_f32_16x16x32_bf16 v[208:211], v[48:51], v[80:83], v[208:211]
    v_mfma_f32_16x16x32_bf16 v[212:215], v[48:51], v[84:87], v[212:215]
    v_mfma_f32_16x16x32_bf16 v[216:219], v[48:51], v[88:91], v[216:219]
    ds_read_b64_tr_b16 v[40:41], v18 offset:9440
    s_waitcnt lgkmcnt(13)
    ds_read_b64_tr_b16 v[42:43], v18 offset:11744
    s_add_u32 m0, s30, 0xe800
    s_mov_b64 exec, 0xffff
    buffer_load_dwordx4 v10, s[40:43], s32 offen lds
    s_mov_b64 exec, -1
    s_add_u32 s32, s32, 0x48000
    s_waitcnt lgkmcnt(10)
    v_mfma_f32_16x16x32_bf16 v[92:95], v[20:23], v[60:63], v[92:95]
    v_mfma_f32_16x16x32_bf16 v[96:99], v[20:23], v[64:67], v[96:99]
    v_mfma_f32_16x16x32_bf16 v[100:103], v[20:23], v[68:71], v[100:103]
    v_mfma_f32_16x16x32_bf16 v[104:107], v[20:23], v[72:75], v[104:107]
    ds_read_b64_tr_b16 v[44:45], v18 offset:256
    ds_read_b64_tr_b16 v[46:47], v18 offset:2560
    s_waitcnt lgkmcnt(10)
    v_mfma_f32_16x16x32_bf16 v[108:111], v[24:27], v[60:63], v[108:111]
    v_mfma_f32_16x16x32_bf16 v[112:115], v[24:27], v[64:67], v[112:115]
    v_mfma_f32_16x16x32_bf16 v[116:119], v[24:27], v[68:71], v[116:119]
    v_mfma_f32_16x16x32_bf16 v[120:123], v[24:27], v[72:75], v[120:123]
    ds_read_b64_tr_b16 v[48:49], v18 offset:9472
    ds_read_b64_tr_b16 v[50:51], v18 offset:11776
    s_waitcnt lgkmcnt(10)
    v_mfma_f32_16x16x32_bf16 v[124:127], v[28:31], v[60:63], v[124:127]
    v_mfma_f32_16x16x32_bf16 v[128:131], v[28:31], v[64:67], v[128:131]
    v_mfma_f32_16x16x32_bf16 v[132:135], v[28:31], v[68:71], v[132:135]
    v_mfma_f32_16x16x32_bf16 v[136:139], v[28:31], v[72:75], v[136:139]
    s_waitcnt lgkmcnt(8)
    v_mfma_f32_16x16x32_bf16 v[140:143], v[32:35], v[60:63], v[140:143]
    v_mfma_f32_16x16x32_bf16 v[144:147], v[32:35], v[64:67], v[144:147]
    v_mfma_f32_16x16x32_bf16 v[148:151], v[32:35], v[68:71], v[148:151]
    v_mfma_f32_16x16x32_bf16 v[152:155], v[32:35], v[72:75], v[152:155]
    s_waitcnt vmcnt(5) lgkmcnt(0)
    s_barrier
    ds_read_b128 v[76:79], v12 offset:0
    ds_read_b128 v[80:83], v12 offset:1024
    ds_read_b128 v[84:87], v12 offset:2048
    s_add_u32 m0, s29, 0x11000
    s_nop 0
    buffer_load_dwordx4 v8, s[12:15], s31 offen lds
    v_mfma_f32_16x16x32_bf16 v[156:159], v[36:39], v[60:63], v[156:159]
    v_mfma_f32_16x16x32_bf16 v[160:163], v[36:39], v[64:67], v[160:163]
    v_mfma_f32_16x16x32_bf16 v[164:167], v[36:39], v[68:71], v[164:167]
    v_mfma_f32_16x16x32_bf16 v[168:171], v[36:39], v[72:75], v[168:171]
    ds_read_b128 v[88:91], v12 offset:3072
    ds_read_b64_tr_b16 v[20:21], v16 offset:160
    ds_read_b64_tr_b16 v[22:23], v16 offset:2464
    s_add_u32 m0, s29, 0x13000
    s_add_u32 s33, s31, 0x24000
    buffer_load_dwordx4 v8, s[12:15], s33 offen lds
    s_add_u32 s31, s31, 64
    v_mfma_f32_16x16x32_bf16 v[172:175], v[40:43], v[60:63], v[172:175]
    v_mfma_f32_16x16x32_bf16 v[176:179], v[40:43], v[64:67], v[176:179]
    v_mfma_f32_16x16x32_bf16 v[180:183], v[40:43], v[68:71], v[180:183]
    v_mfma_f32_16x16x32_bf16 v[184:187], v[40:43], v[72:75], v[184:187]
    ds_read_b64_tr_b16 v[24:25], v16 offset:9376
    ds_read_b64_tr_b16 v[26:27], v16 offset:11680
    ds_read_b64_tr_b16 v[28:29], v16 offset:192
    ds_read_b64_tr_b16 v[30:31], v16 offset:2496
    s_add_u32 m0, s29, 0x15000
    s_nop 0
    buffer_load_dwordx4 v9, s[16:19], s32 offen lds
    v_mfma_f32_16x16x32_bf16 v[188:191], v[44:47], v[60:63], v[188:191]
    v_mfma_f32_16x16x32_bf16 v[192:195], v[44:47], v[64:67], v[192:195]
    v_mfma_f32_16x16x32_bf16 v[196:199], v[44:47], v[68:71], v[196:199]
    v_mfma_f32_16x16x32_bf16 v[200:203], v[44:47], v[72:75], v[200:203]
    ds_read_b64_tr_b16 v[32:33], v16 offset:9408
    ds_read_b64_tr_b16 v[34:35], v16 offset:11712
    ds_read_b64_tr_b16 v[36:37], v16 offset:224
    ds_read_b64_tr_b16 v[38:39], v16 offset:2528
    s_add_u32 m0, s29, 0x17400
    s_nop 0
    buffer_load_dwordx4 v9, s[20:23], s32 offen lds
    v_mfma_f32_16x16x32_bf16 v[204:207], v[48:51], v[60:63], v[204:207]
    v_mfma_f32_16x16x32_bf16 v[208:211], v[48:51], v[64:67], v[208:211]
    v_mfma_f32_16x16x32_bf16 v[212:215], v[48:51], v[68:71], v[212:215]
    v_mfma_f32_16x16x32_bf16 v[216:219], v[48:51], v[72:75], v[216:219]
    ds_read_b64_tr_b16 v[40:41], v16 offset:9440
    s_waitcnt lgkmcnt(13)
    ds_read_b64_tr_b16 v[42:43], v16 offset:11744
    s_add_u32 m0, s30, 0x17000
    s_mov_b64 exec, 0xffff
    buffer_load_dwordx4 v10, s[40:43], s32 offen lds
    s_mov_b64 exec, -1
    s_add_u32 s32, s32, 0x48000
    s_waitcnt lgkmcnt(10)
    v_mfma_f32_16x16x32_bf16 v[92:95], v[20:23], v[76:79], v[92:95]
    v_mfma_f32_16x16x32_bf16 v[96:99], v[20:23], v[80:83], v[96:99]
    v_mfma_f32_16x16x32_bf16 v[100:103], v[20:23], v[84:87], v[100:103]
    v_mfma_f32_16x16x32_bf16 v[104:107], v[20:23], v[88:91], v[104:107]
    ds_read_b64_tr_b16 v[44:45], v16 offset:256
    ds_read_b64_tr_b16 v[46:47], v16 offset:2560
    s_waitcnt lgkmcnt(10)
    v_mfma_f32_16x16x32_bf16 v[108:111], v[24:27], v[76:79], v[108:111]
    v_mfma_f32_16x16x32_bf16 v[112:115], v[24:27], v[80:83], v[112:115]
    v_mfma_f32_16x16x32_bf16 v[116:119], v[24:27], v[84:87], v[116:119]
    v_mfma_f32_16x16x32_bf16 v[120:123], v[24:27], v[88:91], v[120:123]
    ds_read_b64_tr_b16 v[48:49], v16 offset:9472
    ds_read_b64_tr_b16 v[50:51], v16 offset:11776
    s_waitcnt lgkmcnt(10)
    v_mfma_f32_16x16x32_bf16 v[124:127], v[28:31], v[76:79], v[124:127]
    v_mfma_f32_16x16x32_bf16 v[128:131], v[28:31], v[80:83], v[128:131]
    v_mfma_f32_16x16x32_bf16 v[132:135], v[28:31], v[84:87], v[132:135]
    v_mfma_f32_16x16x32_bf16 v[136:139], v[28:31], v[88:91], v[136:139]
    s_waitcnt lgkmcnt(8)
    v_mfma_f32_16x16x32_bf16 v[140:143], v[32:35], v[76:79], v[140:143]
    v_mfma_f32_16x16x32_bf16 v[144:147], v[32:35], v[80:83], v[144:147]
    v_mfma_f32_16x16x32_bf16 v[148:151], v[32:35], v[84:87], v[148:151]
    v_mfma_f32_16x16x32_bf16 v[152:155], v[32:35], v[88:91], v[152:155]
    s_waitcnt vmcnt(5) lgkmcnt(0)
    s_barrier
    ds_read_b128 v[60:63], v13 offset:0
    ds_read_b128 v[64:67], v13 offset:1024
    ds_read_b128 v[68:71], v13 offset:2048
    v_mfma_f32_16x16x32_bf16 v[156:159], v[36:39], v[76:79], v[156:159]
    v_mfma_f32_16x16x32_bf16 v[160:163], v[36:39], v[80:83], v[160:163]
    v_mfma_f32_16x16x32_bf16 v[164:167], v[36:39], v[84:87], v[164:167]
    v_mfma_f32_16x16x32_bf16 v[168:171], v[36:39], v[88:91], v[168:171]
    ds_read_b128 v[72:75], v13 offset:3072
    ds_read_b64_tr_b16 v[20:21], v17 offset:160
    ds_read_b64_tr_b16 v[22:23], v17 offset:2464
    v_mfma_f32_16x16x32_bf16 v[172:175], v[40:43], v[76:79], v[172:175]
    v_mfma_f32_16x16x32_bf16 v[176:179], v[40:43], v[80:83], v[176:179]
    v_mfma_f32_16x16x32_bf16 v[180:183], v[40:43], v[84:87], v[180:183]
    v_mfma_f32_16x16x32_bf16 v[184:187], v[40:43], v[88:91], v[184:187]
    ds_read_b64_tr_b16 v[24:25], v17 offset:9376
    ds_read_b64_tr_b16 v[26:27], v17 offset:11680
    ds_read_b64_tr_b16 v[28:29], v17 offset:192
    ds_read_b64_tr_b16 v[30:31], v17 offset:2496
    v_mfma_f32_16x16x32_bf16 v[188:191], v[44:47], v[76:79], v[188:191]
    v_mfma_f32_16x16x32_bf16 v[192:195], v[44:47], v[80:83], v[192:195]
    v_mfma_f32_16x16x32_bf16 v[196:199], v[44:47], v[84:87], v[196:199]
    v_mfma_f32_16x16x32_bf16 v[200:203], v[44:47], v[88:91], v[200:203]
    ds_read_b64_tr_b16 v[32:33], v17 offset:9408
    ds_read_b64_tr_b16 v[34:35], v17 offset:11712
    ds_read_b64_tr_b16 v[36:37], v17 offset:224
    ds_read_b64_tr_b16 v[38:39], v17 offset:2528
    v_mfma_f32_16x16x32_bf16 v[204:207], v[48:51], v[76:79], v[204:207]
    v_mfma_f32_16x16x32_bf16 v[208:211], v[48:51], v[80:83], v[208:211]
    v_mfma_f32_16x16x32_bf16 v[212:215], v[48:51], v[84:87], v[212:215]
    v_mfma_f32_16x16x32_bf16 v[216:219], v[48:51], v[88:91], v[216:219]
    ds_read_b64_tr_b16 v[40:41], v17 offset:9440
    s_waitcnt lgkmcnt(13)
    ds_read_b64_tr_b16 v[42:43], v17 offset:11744
    s_waitcnt lgkmcnt(10)
    v_mfma_f32_16x16x32_bf16 v[92:95], v[20:23], v[60:63], v[92:95]
    v_mfma_f32_16x16x32_bf16 v[96:99], v[20:23], v[64:67], v[96:99]
    v_mfma_f32_16x16x32_bf16 v[100:103], v[20:23], v[68:71], v[100:103]
    v_mfma_f32_16x16x32_bf16 v[104:107], v[20:23], v[72:75], v[104:107]
    ds_read_b64_tr_b16 v[44:45], v17 offset:256
    ds_read_b64_tr_b16 v[46:47], v17 offset:2560
    s_waitcnt lgkmcnt(10)
    v_mfma_f32_16x16x32_bf16 v[108:111], v[24:27], v[60:63], v[108:111]
    v_mfma_f32_16x16x32_bf16 v[112:115], v[24:27], v[64:67], v[112:115]
    v_mfma_f32_16x16x32_bf16 v[116:119], v[24:27], v[68:71], v[116:119]
    v_mfma_f32_16x16x32_bf16 v[120:123], v[24:27], v[72:75], v[120:123]
    ds_read_b64_tr_b16 v[48:49], v17 offset:9472
    ds_read_b64_tr_b16 v[50:51], v17 offset:11776
    s_waitcnt lgkmcnt(10)
    v_mfma_f32_16x16x32_bf16 v[124:127], v[28:31], v[60:63], v[124:127]
    v_mfma_f32_16x16x32_bf16 v[128:131], v[28:31], v[64:67], v[128:131]
    v_mfma_f32_16x16x32_bf16 v[132:135], v[28:31], v[68:71], v[132:135]
    v_mfma_f32_16x16x32_bf16 v[136:139], v[28:31], v[72:75], v[136:139]
    s_waitcnt lgkmcnt(8)
    v_mfma_f32_16x16x32_bf16 v[140:143], v[32:35], v[60:63], v[140:143]
    v_mfma_f32_16x16x32_bf16 v[144:147], v[32:35], v[64:67], v[144:147]
    v_mfma_f32_16x16x32_bf16 v[148:151], v[32:35], v[68:71], v[148:151]
    v_mfma_f32_16x16x32_bf16 v[152:155], v[32:35], v[72:75], v[152:155]
    s_waitcnt vmcnt(0) lgkmcnt(0)
    s_barrier
    ds_read_b128 v[76:79], v14 offset:0
    ds_read_b128 v[80:83], v14 offset:1024
    ds_read_b128 v[84:87], v14 offset:2048
    v_mfma_f32_16x16x32_bf16 v[156:159], v[36:39], v[60:63], v[156:159]
    v_mfma_f32_16x16x32_bf16 v[160:163], v[36:39], v[64:67], v[160:163]
    v_mfma_f32_16x16x32_bf16 v[164:167], v[36:39], v[68:71], v[164:167]
    v_mfma_f32_16x16x32_bf16 v[168:171], v[36:39], v[72:75], v[168:171]
    ds_read_b128 v[88:91], v14 offset:3072
    ds_read_b64_tr_b16 v[20:21], v18 offset:160
    ds_read_b64_tr_b16 v[22:23], v18 offset:2464
    v_mfma_f32_16x16x32_bf16 v[172:175], v[40:43], v[60:63], v[172:175]
    v_mfma_f32_16x16x32_bf16 v[176:179], v[40:43], v[64:67], v[176:179]
    v_mfma_f32_16x16x32_bf16 v[180:183], v[40:43], v[68:71], v[180:183]
    v_mfma_f32_16x16x32_bf16 v[184:187], v[40:43], v[72:75], v[184:187]
    ds_read_b64_tr_b16 v[24:25], v18 offset:9376
    ds_read_b64_tr_b16 v[26:27], v18 offset:11680
    ds_read_b64_tr_b16 v[28:29], v18 offset:192
    ds_read_b64_tr_b16 v[30:31], v18 offset:2496
    v_mfma_f32_16x16x32_bf16 v[188:191], v[44:47], v[60:63], v[188:191]
    v_mfma_f32_16x16x32_bf16 v[192:195], v[44:47], v[64:67], v[192:195]
    v_mfma_f32_16x16x32_bf16 v[196:199], v[44:47], v[68:71], v[196:199]
    v_mfma_f32_16x16x32_bf16 v[200:203], v[44:47], v[72:75], v[200:203]
    ds_read_b64_tr_b16 v[32:33], v18 offset:9408
    ds_read_b64_tr_b16 v[34:35], v18 offset:11712
    ds_read_b64_tr_b16 v[36:37], v18 offset:224
    ds_read_b64_tr_b16 v[38:39], v18 offset:2528
    v_mfma_f32_16x16x32_bf16 v[204:207], v[48:51], v[60:63], v[204:207]
    v_mfma_f32_16x16x32_bf16 v[208:211], v[48:51], v[64:67], v[208:211]
    v_mfma_f32_16x16x32_bf16 v[212:215], v[48:51], v[68:71], v[212:215]
    v_mfma_f32_16x16x32_bf16 v[216:219], v[48:51], v[72:75], v[216:219]
    ds_read_b64_tr_b16 v[40:41], v18 offset:9440
    s_waitcnt lgkmcnt(13)
    ds_read_b64_tr_b16 v[42:43], v18 offset:11744
    s_waitcnt lgkmcnt(10)
    v_mfma_f32_16x16x32_bf16 v[92:95], v[20:23], v[76:79], v[92:95]
    v_mfma_f32_16x16x32_bf16 v[96:99], v[20:23], v[80:83], v[96:99]
    v_mfma_f32_16x16x32_bf16 v[100:103], v[20:23], v[84:87], v[100:103]
    v_mfma_f32_16x16x32_bf16 v[104:107], v[20:23], v[88:91], v[104:107]
    ds_read_b64_tr_b16 v[44:45], v18 offset:256
    ds_read_b64_tr_b16 v[46:47], v18 offset:2560
    s_waitcnt lgkmcnt(10)
    v_mfma_f32_16x16x32_bf16 v[108:111], v[24:27], v[76:79], v[108:111]
    v_mfma_f32_16x16x32_bf16 v[112:115], v[24:27], v[80:83], v[112:115]
    v_mfma_f32_16x16x32_bf16 v[116:119], v[24:27], v[84:87], v[116:119]
    v_mfma_f32_16x16x32_bf16 v[120:123], v[24:27], v[88:91], v[120:123]
    ds_read_b64_tr_b16 v[48:49], v18 offset:9472
    ds_read_b64_tr_b16 v[50:51], v18 offset:11776
    s_waitcnt lgkmcnt(10)
    v_mfma_f32_16x16x32_bf16 v[124:127], v[28:31], v[76:79], v[124:127]
    v_mfma_f32_16x16x32_bf16 v[128:131], v[28:31], v[80:83], v[128:131]
    v_mfma_f32_16x16x32_bf16 v[132:135], v[28:31], v[84:87], v[132:135]
    v_mfma_f32_16x16x32_bf16 v[136:139], v[28:31], v[88:91], v[136:139]
    s_waitcnt lgkmcnt(8)
    v_mfma_f32_16x16x32_bf16 v[140:143], v[32:35], v[76:79], v[140:143]
    v_mfma_f32_16x16x32_bf16 v[144:147], v[32:35], v[80:83], v[144:147]
    v_mfma_f32_16x16x32_bf16 v[148:151], v[32:35], v[84:87], v[148:151]
    v_mfma_f32_16x16x32_bf16 v[152:155], v[32:35], v[88:91], v[152:155]
    s_waitcnt lgkmcnt(6)
    v_mfma_f32_16x16x32_bf16 v[156:159], v[36:39], v[76:79], v[156:159]
    v_mfma_f32_16x16x32_bf16 v[160:163], v[36:39], v[80:83], v[160:163]
    v_mfma_f32_16x16x32_bf16 v[164:167], v[36:39], v[84:87], v[164:167]
    v_mfma_f32_16x16x32_bf16 v[168:171], v[36:39], v[88:91], v[168:171]
    s_waitcnt lgkmcnt(4)
    v_mfma_f32_16x16x32_bf16 v[172:175], v[40:43], v[76:79], v[172:175]
    v_mfma_f32_16x16x32_bf16 v[176:179], v[40:43], v[80:83], v[176:179]
    v_mfma_f32_16x16x32_bf16 v[180:183], v[40:43], v[84:87], v[180:183]
    v_mfma_f32_16x16x32_bf16 v[184:187], v[40:43], v[88:91], v[184:187]
    s_waitcnt lgkmcnt(2)
    v_mfma_f32_16x16x32_bf16 v[188:191], v[44:47], v[76:79], v[188:191]
    v_mfma_f32_16x16x32_bf16 v[192:195], v[44:47], v[80:83], v[192:195]
    v_mfma_f32_16x16x32_bf16 v[196:199], v[44:47], v[84:87], v[196:199]
    v_mfma_f32_16x16x32_bf16 v[200:203], v[44:47], v[88:91], v[200:203]
    s_waitcnt lgkmcnt(0)
    v_mfma_f32_16x16x32_bf16 v[204:207], v[48:51], v[76:79], v[204:207]
    v_mfma_f32_16x16x32_bf16 v[208:211], v[48:51], v[80:83], v[208:211]
    v_mfma_f32_16x16x32_bf16 v[212:215], v[48:51], v[84:87], v[212:215]
    v_mfma_f32_16x16x32_bf16 v[216:219], v[48:51], v[88:91], v[216:219]
    s_nop 7
    s_nop 3
    v_mul_f32 v92, s46, v92
    v_mul_f32 v93, s46, v93
    v_mul_f32 v94, s46, v94
    v_mul_f32 v95, s46, v95
    v_exp_f32 v92, v92
    v_exp_f32 v93, v93
    v_exp_f32 v94, v94
    v_exp_f32 v95, v95
    v_add_f32 v92, 1.0, v92
    v_add_f32 v93, 1.0, v93
    v_add_f32 v94, 1.0, v94
    v_add_f32 v95, 1.0, v95
    v_rcp_f32 v92, v92
    v_rcp_f32 v93, v93
    v_rcp_f32 v94, v94
    v_rcp_f32 v95, v95
    v_mul_f32 v92, v92, v108
    v_mul_f32 v93, v93, v109
    v_mul_f32 v94, v94, v110
    v_mul_f32 v95, v95, v111
    v_cvt_pk_bf16_f32 v20, v92, v93
    v_cvt_pk_bf16_f32 v21, v94, v95
    v_mul_f32 v96, s46, v96
    v_mul_f32 v97, s46, v97
    v_mul_f32 v98, s46, v98
    v_mul_f32 v99, s46, v99
    v_exp_f32 v96, v96
    v_exp_f32 v97, v97
    v_exp_f32 v98, v98
    v_exp_f32 v99, v99
    v_add_f32 v96, 1.0, v96
    v_add_f32 v97, 1.0, v97
    v_add_f32 v98, 1.0, v98
    v_add_f32 v99, 1.0, v99
    v_rcp_f32 v96, v96
    v_rcp_f32 v97, v97
    v_rcp_f32 v98, v98
    v_rcp_f32 v99, v99
    v_mul_f32 v96, v96, v112
    v_mul_f32 v97, v97, v113
    v_mul_f32 v98, v98, v114
    v_mul_f32 v99, v99, v115
    v_cvt_pk_bf16_f32 v22, v96, v97
    v_cvt_pk_bf16_f32 v23, v98, v99
    s_mov_b32 s33, 5120
    s_nop 0
    v_permlane16_swap_b32 v20, v22
    v_permlane16_swap_b32 v21, v23
    s_nop 0
    buffer_store_dwordx4 v[20:23], v7, s[24:27], s33 offen offset:0 sc0 sc1
    v_mul_f32 v124, s46, v124
    v_mul_f32 v125, s46, v125
    v_mul_f32 v126, s46, v126
    v_mul_f32 v127, s46, v127
    v_exp_f32 v124, v124
    v_exp_f32 v125, v125
    v_exp_f32 v126, v126
    v_exp_f32 v127, v127
    v_add_f32 v124, 1.0, v124
    v_add_f32 v125, 1.0, v125
    v_add_f32 v126, 1.0, v126
    v_add_f32 v127, 1.0, v127
    v_rcp_f32 v124, v124
    v_rcp_f32 v125, v125
    v_rcp_f32 v126, v126
    v_rcp_f32 v127, v127
    v_mul_f32 v124, v124, v140
    v_mul_f32 v125, v125, v141
    v_mul_f32 v126, v126, v142
    v_mul_f32 v127, v127, v143
    v_cvt_pk_bf16_f32 v24, v124, v125
    v_cvt_pk_bf16_f32 v25, v126, v127
    v_mul_f32 v128, s46, v128
    v_mul_f32 v129, s46, v129
    v_mul_f32 v130, s46, v130
    v_mul_f32 v131, s46, v131
    v_exp_f32 v128, v128
    v_exp_f32 v129, v129
    v_exp_f32 v130, v130
    v_exp_f32 v131, v131
    v_add_f32 v128, 1.0, v128
    v_add_f32 v129, 1.0, v129
    v_add_f32 v130, 1.0, v130
    v_add_f32 v131, 1.0, v131
    v_rcp_f32 v128, v128
    v_rcp_f32 v129, v129
    v_rcp_f32 v130, v130
    v_rcp_f32 v131, v131
    v_mul_f32 v128, v128, v144
    v_mul_f32 v129, v129, v145
    v_mul_f32 v130, v130, v146
    v_mul_f32 v131, v131, v147
    v_cvt_pk_bf16_f32 v26, v128, v129
    v_cvt_pk_bf16_f32 v27, v130, v131
    s_nop 0
    s_nop 0
    v_permlane16_swap_b32 v24, v26
    v_permlane16_swap_b32 v25, v27
    s_nop 0
    buffer_store_dwordx4 v[24:27], v7, s[24:27], s33 offen offset:1024 sc0 sc1
    v_mul_f32 v156, s46, v156
    v_mul_f32 v157, s46, v157
    v_mul_f32 v158, s46, v158
    v_mul_f32 v159, s46, v159
    v_exp_f32 v156, v156
    v_exp_f32 v157, v157
    v_exp_f32 v158, v158
    v_exp_f32 v159, v159
    v_add_f32 v156, 1.0, v156
    v_add_f32 v157, 1.0, v157
    v_add_f32 v158, 1.0, v158
    v_add_f32 v159, 1.0, v159
    v_rcp_f32 v156, v156
    v_rcp_f32 v157, v157
    v_rcp_f32 v158, v158
    v_rcp_f32 v159, v159
    v_mul_f32 v156, v156, v172
    v_mul_f32 v157, v157, v173
    v_mul_f32 v158, v158, v174
    v_mul_f32 v159, v159, v175
    v_cvt_pk_bf16_f32 v28, v156, v157
    v_cvt_pk_bf16_f32 v29, v158, v159
    v_mul_f32 v160, s46, v160
    v_mul_f32 v161, s46, v161
    v_mul_f32 v162, s46, v162
    v_mul_f32 v163, s46, v163
    v_exp_f32 v160, v160
    v_exp_f32 v161, v161
    v_exp_f32 v162, v162
    v_exp_f32 v163, v163
    v_add_f32 v160, 1.0, v160
    v_add_f32 v161, 1.0, v161
    v_add_f32 v162, 1.0, v162
    v_add_f32 v163, 1.0, v163
    v_rcp_f32 v160, v160
    v_rcp_f32 v161, v161
    v_rcp_f32 v162, v162
    v_rcp_f32 v163, v163
    v_mul_f32 v160, v160, v176
    v_mul_f32 v161, v161, v177
    v_mul_f32 v162, v162, v178
    v_mul_f32 v163, v163, v179
    v_cvt_pk_bf16_f32 v30, v160, v161
    v_cvt_pk_bf16_f32 v31, v162, v163
    s_nop 0
    s_nop 0
    v_permlane16_swap_b32 v28, v30
    v_permlane16_swap_b32 v29, v31
    s_nop 0
    buffer_store_dwordx4 v[28:31], v7, s[24:27], s33 offen offset:2048 sc0 sc1
    v_mul_f32 v188, s46, v188
    v_mul_f32 v189, s46, v189
    v_mul_f32 v190, s46, v190
    v_mul_f32 v191, s46, v191
    v_exp_f32 v188, v188
    v_exp_f32 v189, v189
    v_exp_f32 v190, v190
    v_exp_f32 v191, v191
    v_add_f32 v188, 1.0, v188
    v_add_f32 v189, 1.0, v189
    v_add_f32 v190, 1.0, v190
    v_add_f32 v191, 1.0, v191
    v_rcp_f32 v188, v188
    v_rcp_f32 v189, v189
    v_rcp_f32 v190, v190
    v_rcp_f32 v191, v191
    v_mul_f32 v188, v188, v204
    v_mul_f32 v189, v189, v205
    v_mul_f32 v190, v190, v206
    v_mul_f32 v191, v191, v207
    v_cvt_pk_bf16_f32 v32, v188, v189
    v_cvt_pk_bf16_f32 v33, v190, v191
    v_mul_f32 v192, s46, v192
    v_mul_f32 v193, s46, v193
    v_mul_f32 v194, s46, v194
    v_mul_f32 v195, s46, v195
    v_exp_f32 v192, v192
    v_exp_f32 v193, v193
    v_exp_f32 v194, v194
    v_exp_f32 v195, v195
    v_add_f32 v192, 1.0, v192
    v_add_f32 v193, 1.0, v193
    v_add_f32 v194, 1.0, v194
    v_add_f32 v195, 1.0, v195
    v_rcp_f32 v192, v192
    v_rcp_f32 v193, v193
    v_rcp_f32 v194, v194
    v_rcp_f32 v195, v195
    v_mul_f32 v192, v192, v208
    v_mul_f32 v193, v193, v209
    v_mul_f32 v194, v194, v210
    v_mul_f32 v195, v195, v211
    v_cvt_pk_bf16_f32 v34, v192, v193
    v_cvt_pk_bf16_f32 v35, v194, v195
    s_nop 0
    s_nop 0
    v_permlane16_swap_b32 v32, v34
    v_permlane16_swap_b32 v33, v35
    s_nop 0
    buffer_store_dwordx4 v[32:35], v7, s[24:27], s33 offen offset:3072 sc0 sc1
    v_mul_f32 v100, s46, v100
    v_mul_f32 v101, s46, v101
    v_mul_f32 v102, s46, v102
    v_mul_f32 v103, s46, v103
    v_exp_f32 v100, v100
    v_exp_f32 v101, v101
    v_exp_f32 v102, v102
    v_exp_f32 v103, v103
    v_add_f32 v100, 1.0, v100
    v_add_f32 v101, 1.0, v101
    v_add_f32 v102, 1.0, v102
    v_add_f32 v103, 1.0, v103
    v_rcp_f32 v100, v100
    v_rcp_f32 v101, v101
    v_rcp_f32 v102, v102
    v_rcp_f32 v103, v103
    v_mul_f32 v100, v100, v116
    v_mul_f32 v101, v101, v117
    v_mul_f32 v102, v102, v118
    v_mul_f32 v103, v103, v119
    v_cvt_pk_bf16_f32 v20, v100, v101
    v_cvt_pk_bf16_f32 v21, v102, v103
    v_mul_f32 v104, s46, v104
    v_mul_f32 v105, s46, v105
    v_mul_f32 v106, s46, v106
    v_mul_f32 v107, s46, v107
    v_exp_f32 v104, v104
    v_exp_f32 v105, v105
    v_exp_f32 v106, v106
    v_exp_f32 v107, v107
    v_add_f32 v104, 1.0, v104
    v_add_f32 v105, 1.0, v105
    v_add_f32 v106, 1.0, v106
    v_add_f32 v107, 1.0, v107
    v_rcp_f32 v104, v104
    v_rcp_f32 v105, v105
    v_rcp_f32 v106, v106
    v_rcp_f32 v107, v107
    v_mul_f32 v104, v104, v120
    v_mul_f32 v105, v105, v121
    v_mul_f32 v106, v106, v122
    v_mul_f32 v107, v107, v123
    v_cvt_pk_bf16_f32 v22, v104, v105
    v_cvt_pk_bf16_f32 v23, v106, v107
    s_mov_b32 s33, 300032
    s_nop 0
    v_permlane16_swap_b32 v20, v22
    v_permlane16_swap_b32 v21, v23
    s_nop 0
    buffer_store_dwordx4 v[20:23], v7, s[24:27], s33 offen offset:0 sc0 sc1
    v_mul_f32 v132, s46, v132
    v_mul_f32 v133, s46, v133
    v_mul_f32 v134, s46, v134
    v_mul_f32 v135, s46, v135
    v_exp_f32 v132, v132
    v_exp_f32 v133, v133
    v_exp_f32 v134, v134
    v_exp_f32 v135, v135
    v_add_f32 v132, 1.0, v132
    v_add_f32 v133, 1.0, v133
    v_add_f32 v134, 1.0, v134
    v_add_f32 v135, 1.0, v135
    v_rcp_f32 v132, v132
    v_rcp_f32 v133, v133
    v_rcp_f32 v134, v134
    v_rcp_f32 v135, v135
    v_mul_f32 v132, v132, v148
    v_mul_f32 v133, v133, v149
    v_mul_f32 v134, v134, v150
    v_mul_f32 v135, v135, v151
    v_cvt_pk_bf16_f32 v24, v132, v133
    v_cvt_pk_bf16_f32 v25, v134, v135
    v_mul_f32 v136, s46, v136
    v_mul_f32 v137, s46, v137
    v_mul_f32 v138, s46, v138
    v_mul_f32 v139, s46, v139
    v_exp_f32 v136, v136
    v_exp_f32 v137, v137
    v_exp_f32 v138, v138
    v_exp_f32 v139, v139
    v_add_f32 v136, 1.0, v136
    v_add_f32 v137, 1.0, v137
    v_add_f32 v138, 1.0, v138
    v_add_f32 v139, 1.0, v139
    v_rcp_f32 v136, v136
    v_rcp_f32 v137, v137
    v_rcp_f32 v138, v138
    v_rcp_f32 v139, v139
    v_mul_f32 v136, v136, v152
    v_mul_f32 v137, v137, v153
    v_mul_f32 v138, v138, v154
    v_mul_f32 v139, v139, v155
    v_cvt_pk_bf16_f32 v26, v136, v137
    v_cvt_pk_bf16_f32 v27, v138, v139
    s_nop 0
    s_nop 0
    v_permlane16_swap_b32 v24, v26
    v_permlane16_swap_b32 v25, v27
    s_nop 0
    buffer_store_dwordx4 v[24:27], v7, s[24:27], s33 offen offset:1024 sc0 sc1
    v_mul_f32 v164, s46, v164
    v_mul_f32 v165, s46, v165
    v_mul_f32 v166, s46, v166
    v_mul_f32 v167, s46, v167
    v_exp_f32 v164, v164
    v_exp_f32 v165, v165
    v_exp_f32 v166, v166
    v_exp_f32 v167, v167
    v_add_f32 v164, 1.0, v164
    v_add_f32 v165, 1.0, v165
    v_add_f32 v166, 1.0, v166
    v_add_f32 v167, 1.0, v167
    v_rcp_f32 v164, v164
    v_rcp_f32 v165, v165
    v_rcp_f32 v166, v166
    v_rcp_f32 v167, v167
    v_mul_f32 v164, v164, v180
    v_mul_f32 v165, v165, v181
    v_mul_f32 v166, v166, v182
    v_mul_f32 v167, v167, v183
    v_cvt_pk_bf16_f32 v28, v164, v165
    v_cvt_pk_bf16_f32 v29, v166, v167
    v_mul_f32 v168, s46, v168
    v_mul_f32 v169, s46, v169
    v_mul_f32 v170, s46, v170
    v_mul_f32 v171, s46, v171
    v_exp_f32 v168, v168
    v_exp_f32 v169, v169
    v_exp_f32 v170, v170
    v_exp_f32 v171, v171
    v_add_f32 v168, 1.0, v168
    v_add_f32 v169, 1.0, v169
    v_add_f32 v170, 1.0, v170
    v_add_f32 v171, 1.0, v171
    v_rcp_f32 v168, v168
    v_rcp_f32 v169, v169
    v_rcp_f32 v170, v170
    v_rcp_f32 v171, v171
    v_mul_f32 v168, v168, v184
    v_mul_f32 v169, v169, v185
    v_mul_f32 v170, v170, v186
    v_mul_f32 v171, v171, v187
    v_cvt_pk_bf16_f32 v30, v168, v169
    v_cvt_pk_bf16_f32 v31, v170, v171
    s_nop 0
    s_nop 0
    v_permlane16_swap_b32 v28, v30
    v_permlane16_swap_b32 v29, v31
    s_nop 0
    buffer_store_dwordx4 v[28:31], v7, s[24:27], s33 offen offset:2048 sc0 sc1
    v_mul_f32 v196, s46, v196
    v_mul_f32 v197, s46, v197
    v_mul_f32 v198, s46, v198
    v_mul_f32 v199, s46, v199
    v_exp_f32 v196, v196
    v_exp_f32 v197, v197
    v_exp_f32 v198, v198
    v_exp_f32 v199, v199
    v_add_f32 v196, 1.0, v196
    v_add_f32 v197, 1.0, v197
    v_add_f32 v198, 1.0, v198
    v_add_f32 v199, 1.0, v199
    v_rcp_f32 v196, v196
    v_rcp_f32 v197, v197
    v_rcp_f32 v198, v198
    v_rcp_f32 v199, v199
    v_mul_f32 v196, v196, v212
    v_mul_f32 v197, v197, v213
    v_mul_f32 v198, v198, v214
    v_mul_f32 v199, v199, v215
    v_cvt_pk_bf16_f32 v32, v196, v197
    v_cvt_pk_bf16_f32 v33, v198, v199
    v_mul_f32 v200, s46, v200
    v_mul_f32 v201, s46, v201
    v_mul_f32 v202, s46, v202
    v_mul_f32 v203, s46, v203
    v_exp_f32 v200, v200
    v_exp_f32 v201, v201
    v_exp_f32 v202, v202
    v_exp_f32 v203, v203
    v_add_f32 v200, 1.0, v200
    v_add_f32 v201, 1.0, v201
    v_add_f32 v202, 1.0, v202
    v_add_f32 v203, 1.0, v203
    v_rcp_f32 v200, v200
    v_rcp_f32 v201, v201
    v_rcp_f32 v202, v202
    v_rcp_f32 v203, v203
    v_mul_f32 v200, v200, v216
    v_mul_f32 v201, v201, v217
    v_mul_f32 v202, v202, v218
    v_mul_f32 v203, v203, v219
    v_cvt_pk_bf16_f32 v34, v200, v201
    v_cvt_pk_bf16_f32 v35, v202, v203
    s_nop 0
    s_nop 0
    v_permlane16_swap_b32 v32, v34
    v_permlane16_swap_b32 v33, v35
    s_nop 0
    buffer_store_dwordx4 v[32:35], v7, s[24:27], s33 offen offset:3072 sc0 sc1
LJ_rompt_kernel_20:
    s_lshl_b32 s44, s37, 5
    s_add_u32 s44, s44, s38
    s_waitcnt vmcnt(0)
    s_barrier
    s_cmp_lg_u32 s28, 0
    s_cbranch_scc1 LPB_rompt_kernel_22
    s_add_u32 s72, s4, 0x1200800
    s_addc_u32 s73, s5, 0
    s_mov_b32 s74, 0x1800
    s_and_b32 s73, s73, 0xffff
    s_mov_b32 s75, 0x20000
    s_mov_b64 exec, 1
    s_lshl_b32 s46, s44, 2
    v_mov_b32 v2, s46
    v_mov_b32 v3, 1
    buffer_store_dword v3, v2, s[72:75], 0 offen sc0 sc1
    s_mov_b64 exec, -1
LPB_rompt_kernel_22:
    s_load_dwordx2 s[4:5], s[0:1], 88
    s_load_dwordx2 s[8:9], s[0:1], 64
    v_and_b32 v1, 63, v0
    v_lshrrev_b32 v2, 6, v0
    s_nop 0
    v_readfirstlane_b32 s28, v2
    s_and_b32 s34, s2, 7
    s_lshr_b32 s35, s2, 3
    s_and_b32 s36, s34, 3
    s_lshr_b32 s37, s34, 2
    s_lshl_b32 s37, s37, 3
    s_lshr_b32 s38, s35, 2
    s_add_u32 s37, s37, s38
    s_and_b32 s38, s35, 3
    s_lshl_b32 s29, s28, 10
    s_lshl_b32 s30, s28, 8
    v_lshrrev_b32 v2, 3, v1
    s_lshl_b32 s33, s28, 3
    v_add_u32 v2, s33, v2
    v_bfe_u32 v3, v2, 1, 3
    v_and_b32 v4, 7, v1
    v_xor_b32 v3, v3, v4
    s_lshr_b32 s44, s28, 2
    s_mul_i32 s44, s44, 294912
    s_and_b32 s45, s28, 3
    s_lshl_b32 s45, s45, 10
    s_add_u32 s44, s44, s45
    v_lshl_add_u32 v8, v1, 4, s44
    s_lshl_b32 s33, s28, 6
    s_add_u32 s33, s33, 0
    v_add_u32 v2, s33, v1
    v_mul_u32_u24 v3, 3641, v2
    v_lshrrev_b32 v3, 16, v3
    v_mul_u32_u24 v4, 18, v3
    v_sub_u32 v4, v2, v4
    v_and_b32 v5, 0x33, v3
    v_and_b32 v6, 4, v3
    v_lshl_or_b32 v5, v6, 1, v5
    v_and_b32 v6, 8, v3
    v_lshrrev_b32 v6, 1, v6
    v_or_b32 v5, v5, v6
    v_mul_u32_u24 v9, 1152, v5
    v_lshl_add_u32 v9, v4, 4, v9
    s_lshl_b32 s33, s28, 6
    s_add_u32 s33, s33, 512
    v_add_u32 v2, s33, v1
    v_mul_u32_u24 v3, 3641, v2
    v_lshrrev_b32 v3, 16, v3
    v_mul_u32_u24 v4, 18, v3
    v_sub_u32 v4, v2, v4
    v_and_b32 v5, 0x33, v3
    v_and_b32 v6, 4, v3
    v_lshl_or_b32 v5, v6, 1, v5
    v_and_b32 v6, 8, v3
    v_lshrrev_b32 v6, 1, v6
    v_or_b32 v5, v5, v6
    v_mul_u32_u24 v10, 1152, v5
    v_lshl_add_u32 v10, v4, 4, v10
    s_lshl_b32 s33, s28, 4
    s_add_u32 s33, s33, 1024
    v_add_u32 v2, s33, v1
    v_mul_u32_u24 v3, 3641, v2
    v_lshrrev_b32 v3, 16, v3
    v_mul_u32_u24 v4, 18, v3
    v_sub_u32 v4, v2, v4
    v_and_b32 v5, 0x33, v3
    v_and_b32 v6, 4, v3
    v_lshl_or_b32 v5, v6, 1, v5
    v_and_b32 v6, 8, v3
    v_lshrrev_b32 v6, 1, v6
    v_or_b32 v5, v5, v6
    v_mul_u32_u24 v11, 1152, v5
    v_lshl_add_u32 v11, v4, 4, v11
    s_mov_b32 s31, 0
    s_mov_b32 s32, 0
    s_waitcnt lgkmcnt(0)
    s_mul_i32 s44, s37, 1179648
    s_mul_i32 s45, s36, 73728
    s_add_u32 s44, s44, s45
    s_add_u32 s12, s4, 0x3000000
    s_addc_u32 s13, s5, 0
    s_add_u32 s12, s12, s44
    s_addc_u32 s13, s13, 0
    s_sub_u32 s14, 0x1200000, s44
    s_and_b32 s13, s13, 0xffff
    s_mov_b32 s15, 0x20000
    s_mul_i32 s44, s36, 1327104
    s_mul_i32 s45, s38, 288
    s_add_u32 s44, s44, s45
    s_add_u32 s16, s8, 0x0
    s_addc_u32 s17, s9, 0
    s_add_u32 s16, s16, s44
    s_addc_u32 s17, s17, 0
    s_sub_u32 s18, 0x510000, s44
    s_and_b32 s17, s17, 0xffff
    s_mov_b32 s19, 0x20000
    s_add_u32 m0, s29, 0x4000
    s_nop 0
    buffer_load_dwordx4 v9, s[16:19], s32 offen lds
    s_add_u32 m0, s29, 0x6000
    s_nop 0
    buffer_load_dwordx4 v10, s[16:19], s32 offen lds
    s_add_u32 m0, s30, 0x8000
    s_nop 0
    s_mov_b64 exec, 0xffff
    buffer_load_dwordx4 v11, s[16:19], s32 offen lds
    s_mov_b64 exec, -1
    s_add_u32 s32, s32, 0x12000
    s_add_u32 m0, s29, 0xc800
    s_nop 0
    buffer_load_dwordx4 v9, s[16:19], s32 offen lds
    s_add_u32 m0, s29, 0xe800
    s_nop 0
    buffer_load_dwordx4 v10, s[16:19], s32 offen lds
    s_add_u32 m0, s30, 0x10800
    s_nop 0
    s_mov_b64 exec, 0xffff
    buffer_load_dwordx4 v11, s[16:19], s32 offen lds
    s_mov_b64 exec, -1
    s_add_u32 s32, s32, 0x12000
    s_add_u32 m0, s29, 0x15000
    s_nop 0
    buffer_load_dwordx4 v9, s[16:19], s32 offen lds
    s_add_u32 m0, s29, 0x17000
    s_nop 0
    buffer_load_dwordx4 v10, s[16:19], s32 offen lds
    s_add_u32 m0, s30, 0x19000
    s_nop 0
    s_mov_b64 exec, 0xffff
    buffer_load_dwordx4 v11, s[16:19], s32 offen lds
    s_mov_b64 exec, -1
    s_add_u32 s32, s32, 0x12000
    s_add_u32 m0, s29, 0x1d800
    s_nop 0
    buffer_load_dwordx4 v9, s[16:19], s32 offen lds
    s_add_u32 m0, s29, 0x1f800
    s_nop 0
    buffer_load_dwordx4 v10, s[16:19], s32 offen lds
    s_add_u32 m0, s30, 0x21800
    s_nop 0
    s_mov_b64 exec, 0xffff
    buffer_load_dwordx4 v11, s[16:19], s32 offen lds
    s_mov_b64 exec, -1
    s_add_u32 s32, s32, 0x12000
    s_lshr_b32 s44, s37, 1
    s_lshl_b32 s44, s44, 5
    s_lshl_b32 s45, s36, 3
    s_add_u32 s44, s44, s45
    v_add_u32 v2, s44, v1
    s_cmp_lg_u32 s28, 0
    s_cbranch_scc1 LFS_rompt_kernel_23
    s_add_u32 s72, s4, 0x1200800
    s_addc_u32 s73, s5, 0
    s_mov_b32 s74, 0x1800
    s_and_b32 s73, s73, 0xffff
    s_mov_b32 s75, 0x20000
    v_lshlrev_b32 v2, 2, v2
    s_mov_b64 exec, 0xff
    s_mov_b32 s45, 0
LFW_rompt_kernel_24:
    buffer_load_dword v3, v2, s[72:75], 0 offen sc0 sc1
    s_waitcnt vmcnt(0)
    v_cmp_ne_u32 vcc, 1, v3
    s_nop 3
    s_cmp_eq_u64 vcc, 0
    s_cbranch_scc1 LFD_rompt_kernel_25
    s_add_u32 s45, s45, 1
    s_cmp_lt_u32 s45, 0x100000
    s_cbranch_scc1 LFW_rompt_kernel_24
LFD_rompt_kernel_25:
    s_mov_b64 exec, -1
LFS_rompt_kernel_23:
    s_barrier
    s_add_u32 m0, s29, 0x0
    s_nop 0
    buffer_load_dwordx4 v8, s[12:15], s31 offen lds
    s_add_u32 m0, s29, 0x2000
    s_add_u32 s33, s31, 0x90000
    buffer_load_dwordx4 v8, s[12:15], s33 offen lds
    s_add_u32 s31, s31, 4096
    s_add_u32 m0, s29, 0x8800
    s_nop 0
    buffer_load_dwordx4 v8, s[12:15], s31 offen lds
    s_add_u32 m0, s29, 0xa800
    s_add_u32 s33, s31, 0x90000
    buffer_load_dwordx4 v8, s[12:15], s33 offen lds
    s_add_u32 s31, s31, 4096
    s_add_u32 m0, s29, 0x11000
    s_nop 0
    buffer_load_dwordx4 v8, s[12:15], s31 offen lds
    s_add_u32 m0, s29, 0x13000
    s_add_u32 s33, s31, 0x90000
    buffer_load_dwordx4 v8, s[12:15], s33 offen lds
    s_add_u32 s31, s31, 4096
    s_add_u32 m0, s29, 0x19800
    s_nop 0
    buffer_load_dwordx4 v8, s[12:15], s31 offen lds
    s_add_u32 m0, s29, 0x1b800
    s_add_u32 s33, s31, 0x90000
    buffer_load_dwordx4 v8, s[12:15], s33 offen lds
    s_add_u32 s31, s31, 4096
    s_and_b32 s33, s28, 3
    s_mul_i32 s33, s33, 4096
    v_and_b32 v2, 15, v1
    v_lshrrev_b32 v3, 4, v1
    v_bfe_u32 v4, v1, 1, 3
    v_xor_b32 v4, v3, v4
    v_lshlrev_b32 v4, 4, v4
    v_lshl_add_u32 v4, v2, 7, v4
    v_add_u32 v5, s33, v4
    v_lshlrev_b32 v5, 9, v3
    v_lshl_add_u32 v5, v2, 4, v5
    v_add_u32 v5, s33, v5
    v_add_u32 v12, 0x0, v5
    v_add_u32 v13, 2048, v12
    v_add_u32 v15, 0x8800, v5
    v_add_u32 v16, 2048, v15
    v_add_u32 v18, 0x11000, v5
    v_add_u32 v19, 2048, v18
    v_add_u32 v21, 0x19800, v5
    v_add_u32 v22, 2048, v21
    v_lshrrev_b32 v4, 5, v1
    v_lshlrev_b32 v4, 4, v4
    v_bfe_u32 v5, v1, 4, 1
    v_lshl_add_u32 v4, v5, 2, v4
    v_bfe_u32 v5, v1, 2, 2
    v_add_u32 v4, v4, v5
    v_mul_u32_u24 v4, 288, v4
    v_and_b32 v5, 3, v1
    v_lshl_add_u32 v4, v5, 3, v4
    v_add_u32 v14, 0x4000, v4
    v_add_u32 v17, 0xc800, v4
    v_add_u32 v20, 0x15000, v4
    v_add_u32 v23, 0x1d800, v4
    s_and_b32 s33, s28, 3
    s_mul_i32 s33, s33, 32
    v_and_b32 v5, 15, v1
    v_add_u32 v5, s33, v5
    v_lshrrev_b32 v6, 4, v1
    v_mul_u32_u24 v5, 288, v5
    v_and_b32 v2, 1, v6
    v_lshl_add_u32 v7, v2, 5, v5
    v_lshrrev_b32 v2, 1, v6
    v_lshl_add_u32 v7, v2, 4, v7
    v_lshl_add_u32 v6, v6, 3, v5
    s_lshl_b32 s44, s36, 4
    s_add_u32 s44, s44, s37
    s_lshl_b32 s44, s44, 2
    s_and_b32 s46, s28, 3
    s_add_u32 s44, s44, s46
    s_mul_i32 s44, s44, 36864
    s_mul_i32 s46, s38, 9216
    s_add_u32 s44, s44, s46
    s_add_u32 s24, s4, 0x1400000
    s_addc_u32 s25, s5, 0
    s_add_u32 s24, s24, s44
    s_addc_u32 s25, s25, 0
    s_sub_u32 s26, 0x900000, s44
    s_and_b32 s25, s25, 0xffff
    s_mov_b32 s27, 0x20000
    v_lshlrev_b32 v7, 4, v1
    s_waitcnt vmcnt(6)
    s_barrier
    s_cmp_ge_u32 s28, 4
    s_cbranch_scc1 LG_rompt_kernel_27
    ds_read_b128 v[68:71], v12 offset:0
    ds_read_b128 v[72:75], v12 offset:256
    ds_read_b64_tr_b16 v[28:29], v14 offset:0
    ds_read_b64_tr_b16 v[30:31], v14 offset:2304
    ds_read_b64_tr_b16 v[32:33], v14 offset:32
    ds_read_b64_tr_b16 v[34:35], v14 offset:2336
    ds_read_b64_tr_b16 v[36:37], v14 offset:64
    ds_read_b64_tr_b16 v[38:39], v14 offset:2368
    ds_read_b64_tr_b16 v[40:41], v14 offset:96
    ds_read_b64_tr_b16 v[42:43], v14 offset:2400
    ds_read_b64_tr_b16 v[44:45], v14 offset:128
    ds_read_b64_tr_b16 v[46:47], v14 offset:2432
    ds_read_b128 v[76:79], v13 offset:0
    ds_read_b128 v[80:83], v13 offset:256
    ds_read_b64_tr_b16 v[48:49], v14 offset:9216
    s_waitcnt lgkmcnt(13)
    ds_read_b64_tr_b16 v[50:51], v14 offset:11520
    ds_read_b64_tr_b16 v[52:53], v14 offset:9248
    s_waitcnt lgkmcnt(13)
    ds_read_b64_tr_b16 v[54:55], v14 offset:11552
    ds_read_b64_tr_b16 v[56:57], v14 offset:9280
    s_waitcnt lgkmcnt(13)
    ds_read_b64_tr_b16 v[58:59], v14 offset:11584
    v_mfma_f32_16x16x32_bf16 v[100:103], v[28:31], v[68:71], 0
    v_mfma_f32_16x16x32_bf16 v[104:107], v[28:31], v[72:75], 0
    ds_read_b64_tr_b16 v[60:61], v14 offset:9312
    s_waitcnt lgkmcnt(13)
    ds_read_b64_tr_b16 v[62:63], v14 offset:11616
    v_mfma_f32_16x16x32_bf16 v[108:111], v[32:35], v[68:71], 0
    v_mfma_f32_16x16x32_bf16 v[112:115], v[32:35], v[72:75], 0
    ds_read_b64_tr_b16 v[64:65], v14 offset:9344
    s_waitcnt lgkmcnt(13)
    ds_read_b64_tr_b16 v[66:67], v14 offset:11648
    v_mfma_f32_16x16x32_bf16 v[116:119], v[36:39], v[68:71], 0
    v_mfma_f32_16x16x32_bf16 v[120:123], v[36:39], v[72:75], 0
    s_waitcnt vmcnt(4) lgkmcnt(0)
    s_barrier
    ds_read_b128 v[84:87], v15 offset:0
    ds_read_b128 v[88:91], v15 offset:256
    ds_read_b64_tr_b16 v[28:29], v17 offset:0
    ds_read_b64_tr_b16 v[30:31], v17 offset:2304
    s_add_u32 m0, s29, 0x0
    s_nop 0
    buffer_load_dwordx4 v8, s[12:15], s31 offen lds
    v_mfma_f32_16x16x32_bf16 v[124:127], v[40:43], v[68:71], 0
    v_mfma_f32_16x16x32_bf16 v[128:131], v[40:43], v[72:75], 0
    ds_read_b64_tr_b16 v[32:33], v17 offset:32
    ds_read_b64_tr_b16 v[34:35], v17 offset:2336
    ds_read_b128 v[92:95], v16 offset:0
    s_add_u32 m0, s29, 0x2000
    s_add_u32 s33, s31, 0x90000
    buffer_load_dwordx4 v8, s[12:15], s33 offen lds
    s_add_u32 s31, s31, 4096
    v_mfma_f32_16x16x32_bf16 v[132:135], v[44:47], v[68:71], 0
    v_mfma_f32_16x16x32_bf16 v[136:139], v[44:47], v[72:75], 0
    ds_read_b64_tr_b16 v[36:37], v17 offset:64
    ds_read_b64_tr_b16 v[38:39], v17 offset:2368
    ds_read_b128 v[96:99], v16 offset:256
    s_add_u32 m0, s29, 0x4000
    s_nop 0
    buffer_load_dwordx4 v9, s[16:19], s32 offen lds
    v_mfma_f32_16x16x32_bf16 v[100:103], v[48:51], v[76:79], v[100:103]
    v_mfma_f32_16x16x32_bf16 v[104:107], v[48:51], v[80:83], v[104:107]
    ds_read_b64_tr_b16 v[40:41], v17 offset:96
    ds_read_b64_tr_b16 v[42:43], v17 offset:2400
    s_add_u32 m0, s29, 0x6000
    s_nop 0
    buffer_load_dwordx4 v10, s[16:19], s32 offen lds
    v_mfma_f32_16x16x32_bf16 v[108:111], v[52:55], v[76:79], v[108:111]
    v_mfma_f32_16x16x32_bf16 v[112:115], v[52:55], v[80:83], v[112:115]
    ds_read_b64_tr_b16 v[44:45], v17 offset:128
    ds_read_b64_tr_b16 v[46:47], v17 offset:2432
    s_add_u32 m0, s30, 0x8000
    s_nop 0
    s_mov_b64 exec, 0xffff
    buffer_load_dwordx4 v11, s[16:19], s32 offen lds
    s_mov_b64 exec, -1
    s_add_u32 s32, s32, 0x12000
    v_mfma_f32_16x16x32_bf16 v[116:119], v[56:59], v[76:79], v[116:119]
    v_mfma_f32_16x16x32_bf16 v[120:123], v[56:59], v[80:83], v[120:123]
    ds_read_b64_tr_b16 v[48:49], v17 offset:9216
    s_waitcnt lgkmcnt(13)
    ds_read_b64_tr_b16 v[50:51], v17 offset:11520
    v_mfma_f32_16x16x32_bf16 v[124:127], v[60:63], v[76:79], v[124:127]
    v_mfma_f32_16x16x32_bf16 v[128:131], v[60:63], v[80:83], v[128:131]
    ds_read_b64_tr_b16 v[52:53], v17 offset:9248
    s_waitcnt lgkmcnt(13)
    ds_read_b64_tr_b16 v[54:55], v17 offset:11552
    v_mfma_f32_16x16x32_bf16 v[132:135], v[64:67], v[76:79], v[132:135]
    v_mfma_f32_16x16x32_bf16 v[136:139], v[64:67], v[80:83], v[136:139]
    ds_read_b64_tr_b16 v[56:57], v17 offset:9280
    s_waitcnt lgkmcnt(13)
    ds_read_b64_tr_b16 v[58:59], v17 offset:11584
    v_mfma_f32_16x16x32_bf16 v[100:103], v[28:31], v[84:87], v[100:103]
    v_mfma_f32_16x16x32_bf16 v[104:107], v[28:31], v[88:91], v[104:107]
    ds_read_b64_tr_b16 v[60:61], v17 offset:9312
    s_waitcnt lgkmcnt(13)
    ds_read_b64_tr_b16 v[62:63], v17 offset:11616
    v_mfma_f32_16x16x32_bf16 v[108:111], v[32:35], v[84:87], v[108:111]
    v_mfma_f32_16x16x32_bf16 v[112:115], v[32:35], v[88:91], v[112:115]
    ds_read_b64_tr_b16 v[64:65], v17 offset:9344
    s_waitcnt lgkmcnt(13)
    ds_read_b64_tr_b16 v[66:67], v17 offset:11648
    v_mfma_f32_16x16x32_bf16 v[116:119], v[36:39], v[84:87], v[116:119]
    v_mfma_f32_16x16x32_bf16 v[120:123], v[36:39], v[88:91], v[120:123]
    s_waitcnt vmcnt(7) lgkmcnt(0)
    s_barrier
    ds_read_b128 v[68:71], v18 offset:0
    ds_read_b128 v[72:75], v18 offset:256
    ds_read_b64_tr_b16 v[28:29], v20 offset:0
    ds_read_b64_tr_b16 v[30:31], v20 offset:2304
    s_add_u32 m0, s29, 0x8800
    s_nop 0
    buffer_load_dwordx4 v8, s[12:15], s31 offen lds
    v_mfma_f32_16x16x32_bf16 v[124:127], v[40:43], v[84:87], v[124:127]
    v_mfma_f32_16x16x32_bf16 v[128:131], v[40:43], v[88:91], v[128:131]
    ds_read_b64_tr_b16 v[32:33], v20 offset:32
    ds_read_b64_tr_b16 v[34:35], v20 offset:2336
    ds_read_b128 v[76:79], v19 offset:0
    s_add_u32 m0, s29, 0xa800
    s_add_u32 s33, s31, 0x90000
    buffer_load_dwordx4 v8, s[12:15], s33 offen lds
    s_add_u32 s31, s31, 4096
    v_mfma_f32_16x16x32_bf16 v[132:135], v[44:47], v[84:87], v[132:135]
    v_mfma_f32_16x16x32_bf16 v[136:139], v[44:47], v[88:91], v[136:139]
    ds_read_b64_tr_b16 v[36:37], v20 offset:64
    ds_read_b64_tr_b16 v[38:39], v20 offset:2368
    ds_read_b128 v[80:83], v19 offset:256
    s_add_u32 m0, s29, 0xc800
    s_nop 0
    buffer_load_dwordx4 v9, s[16:19], s32 offen lds
    v_mfma_f32_16x16x32_bf16 v[100:103], v[48:51], v[92:95], v[100:103]
    v_mfma_f32_16x16x32_bf16 v[104:107], v[48:51], v[96:99], v[104:107]
    ds_read_b64_tr_b16 v[40:41], v20 offset:96
    ds_read_b64_tr_b16 v[42:43], v20 offset:2400
    s_add_u32 m0, s29, 0xe800
    s_nop 0
    buffer_load_dwordx4 v10, s[16:19], s32 offen lds
    v_mfma_f32_16x16x32_bf16 v[108:111], v[52:55], v[92:95], v[108:111]
    v_mfma_f32_16x16x32_bf16 v[112:115], v[52:55], v[96:99], v[112:115]
    ds_read_b64_tr_b16 v[44:45], v20 offset:128
    ds_read_b64_tr_b16 v[46:47], v20 offset:2432
    s_add_u32 m0, s30, 0x10800
    s_nop 0
    s_mov_b64 exec, 0xffff
    buffer_load_dwordx4 v11, s[16:19], s32 offen lds
    s_mov_b64 exec, -1
    s_add_u32 s32, s32, 0x12000
    v_mfma_f32_16x16x32_bf16 v[116:119], v[56:59], v[92:95], v[116:119]
    v_mfma_f32_16x16x32_bf16 v[120:123], v[56:59], v[96:99], v[120:123]
    ds_read_b64_tr_b16 v[48:49], v20 offset:9216
    s_waitcnt lgkmcnt(13)
    ds_read_b64_tr_b16 v[50:51], v20 offset:11520
    v_mfma_f32_16x16x32_bf16 v[124:127], v[60:63], v[92:95], v[124:127]
    v_mfma_f32_16x16x32_bf16 v[128:131], v[60:63], v[96:99], v[128:131]
    ds_read_b64_tr_b16 v[52:53], v20 offset:9248
    s_waitcnt lgkmcnt(13)
    ds_read_b64_tr_b16 v[54:55], v20 offset:11552
    v_mfma_f32_16x16x32_bf16 v[132:135], v[64:67], v[92:95], v[132:135]
    v_mfma_f32_16x16x32_bf16 v[136:139], v[64:67], v[96:99], v[136:139]
    ds_read_b64_tr_b16 v[56:57], v20 offset:9280
    s_waitcnt lgkmcnt(13)
    ds_read_b64_tr_b16 v[58:59], v20 offset:11584
    s_mov_b32 s40, 3
LP_rompt_kernel_28:
    v_mfma_f32_16x16x32_bf16 v[100:103], v[28:31], v[68:71], v[100:103]
    v_mfma_f32_16x16x32_bf16 v[104:107], v[28:31], v[72:75], v[104:107]
    ds_read_b64_tr_b16 v[60:61], v20 offset:9312
    s_waitcnt lgkmcnt(13)
    ds_read_b64_tr_b16 v[62:63], v20 offset:11616
    v_mfma_f32_16x16x32_bf16 v[108:111], v[32:35], v[68:71], v[108:111]
    v_mfma_f32_16x16x32_bf16 v[112:115], v[32:35], v[72:75], v[112:115]
    ds_read_b64_tr_b16 v[64:65], v20 offset:9344
    s_waitcnt lgkmcnt(13)
    ds_read_b64_tr_b16 v[66:67], v20 offset:11648
    v_mfma_f32_16x16x32_bf16 v[116:119], v[36:39], v[68:71], v[116:119]
    v_mfma_f32_16x16x32_bf16 v[120:123], v[36:39], v[72:75], v[120:123]
    s_waitcnt vmcnt(10) lgkmcnt(0)
    s_barrier
    ds_read_b128 v[84:87], v21 offset:0
    ds_read_b128 v[88:91], v21 offset:256
    ds_read_b64_tr_b16 v[28:29], v23 offset:0
    ds_read_b64_tr_b16 v[30:31], v23 offset:2304
    s_add_u32 m0, s29, 0x11000
    s_nop 0
    buffer_load_dwordx4 v8, s[12:15], s31 offen lds
    v_mfma_f32_16x16x32_bf16 v[124:127], v[40:43], v[68:71], v[124:127]
    v_mfma_f32_16x16x32_bf16 v[128:131], v[40:43], v[72:75], v[128:131]
    ds_read_b64_tr_b16 v[32:33], v23 offset:32
    ds_read_b64_tr_b16 v[34:35], v23 offset:2336
    ds_read_b128 v[92:95], v22 offset:0
    s_add_u32 m0, s29, 0x13000
    s_add_u32 s33, s31, 0x90000
    buffer_load_dwordx4 v8, s[12:15], s33 offen lds
    s_add_u32 s31, s31, 4096
    v_mfma_f32_16x16x32_bf16 v[132:135], v[44:47], v[68:71], v[132:135]
    v_mfma_f32_16x16x32_bf16 v[136:139], v[44:47], v[72:75], v[136:139]
    ds_read_b64_tr_b16 v[36:37], v23 offset:64
    ds_read_b64_tr_b16 v[38:39], v23 offset:2368
    ds_read_b128 v[96:99], v22 offset:256
    s_add_u32 m0, s29, 0x15000
    s_nop 0
    buffer_load_dwordx4 v9, s[16:19], s32 offen lds
    v_mfma_f32_16x16x32_bf16 v[100:103], v[48:51], v[76:79], v[100:103]
    v_mfma_f32_16x16x32_bf16 v[104:107], v[48:51], v[80:83], v[104:107]
    ds_read_b64_tr_b16 v[40:41], v23 offset:96
    ds_read_b64_tr_b16 v[42:43], v23 offset:2400
    s_add_u32 m0, s29, 0x17000
    s_nop 0
    buffer_load_dwordx4 v10, s[16:19], s32 offen lds
    v_mfma_f32_16x16x32_bf16 v[108:111], v[52:55], v[76:79], v[108:111]
    v_mfma_f32_16x16x32_bf16 v[112:115], v[52:55], v[80:83], v[112:115]
    ds_read_b64_tr_b16 v[44:45], v23 offset:128
    ds_read_b64_tr_b16 v[46:47], v23 offset:2432
    s_add_u32 m0, s30, 0x19000
    s_nop 0
    s_mov_b64 exec, 0xffff
    buffer_load_dwordx4 v11, s[16:19], s32 offen lds
    s_mov_b64 exec, -1
    s_add_u32 s32, s32, 0x12000
    v_mfma_f32_16x16x32_bf16 v[116:119], v[56:59], v[76:79], v[116:119]
    v_mfma_f32_16x16x32_bf16 v[120:123], v[56:59], v[80:83], v[120:123]
    ds_read_b64_tr_b16 v[48:49], v23 offset:9216
    s_waitcnt lgkmcnt(13)
    ds_read_b64_tr_b16 v[50:51], v23 offset:11520
    v_mfma_f32_16x16x32_bf16 v[124:127], v[60:63], v[76:79], v[124:127]
    v_mfma_f32_16x16x32_bf16 v[128:131], v[60:63], v[80:83], v[128:131]
    ds_read_b64_tr_b16 v[52:53], v23 offset:9248
    s_waitcnt lgkmcnt(13)
    ds_read_b64_tr_b16 v[54:55], v23 offset:11552
    v_mfma_f32_16x16x32_bf16 v[132:135], v[64:67], v[76:79], v[132:135]
    v_mfma_f32_16x16x32_bf16 v[136:139], v[64:67], v[80:83], v[136:139]
    ds_read_b64_tr_b16 v[56:57], v23 offset:9280
    s_waitcnt lgkmcnt(13)
    ds_read_b64_tr_b16 v[58:59], v23 offset:11584
    v_mfma_f32_16x16x32_bf16 v[100:103], v[28:31], v[84:87], v[100:103]
    v_mfma_f32_16x16x32_bf16 v[104:107], v[28:31], v[88:91], v[104:107]
    ds_read_b64_tr_b16 v[60:61], v23 offset:9312
    s_waitcnt lgkmcnt(13)
    ds_read_b64_tr_b16 v[62:63], v23 offset:11616
    v_mfma_f32_16x16x32_bf16 v[108:111], v[32:35], v[84:87], v[108:111]
    v_mfma_f32_16x16x32_bf16 v[112:115], v[32:35], v[88:91], v[112:115]
    ds_read_b64_tr_b16 v[64:65], v23 offset:9344
    s_waitcnt lgkmcnt(13)
    ds_read_b64_tr_b16 v[66:67], v23 offset:11648
    v_mfma_f32_16x16x32_bf16 v[116:119], v[36:39], v[84:87], v[116:119]
    v_mfma_f32_16x16x32_bf16 v[120:123], v[36:39], v[88:91], v[120:123]
    s_waitcnt vmcnt(10) lgkmcnt(0)
    s_barrier
    ds_read_b128 v[68:71], v12 offset:0
    ds_read_b128 v[72:75], v12 offset:256
    ds_read_b64_tr_b16 v[28:29], v14 offset:0
    ds_read_b64_tr_b16 v[30:31], v14 offset:2304
    s_add_u32 m0, s29, 0x19800
    s_nop 0
    buffer_load_dwordx4 v8, s[12:15], s31 offen lds
    v_mfma_f32_16x16x32_bf16 v[124:127], v[40:43], v[84:87], v[124:127]
    v_mfma_f32_16x16x32_bf16 v[128:131], v[40:43], v[88:91], v[128:131]
    ds_read_b64_tr_b16 v[32:33], v14 offset:32
    ds_read_b64_tr_b16 v[34:35], v14 offset:2336
    ds_read_b128 v[76:79], v13 offset:0
    s_add_u32 m0, s29, 0x1b800
    s_add_u32 s33, s31, 0x90000
    buffer_load_dwordx4 v8, s[12:15], s33 offen lds
    s_add_u32 s31, s31, 4096
    v_mfma_f32_16x16x32_bf16 v[132:135], v[44:47], v[84:87], v[132:135]
    v_mfma_f32_16x16x32_bf16 v[136:139], v[44:47], v[88:91], v[136:139]
    ds_read_b64_tr_b16 v[36:37], v14 offset:64
    ds_read_b64_tr_b16 v[38:39], v14 offset:2368
    ds_read_b128 v[80:83], v13 offset:256
    s_add_u32 m0, s29, 0x1d800
    s_nop 0
    buffer_load_dwordx4 v9, s[16:19], s32 offen lds
    v_mfma_f32_16x16x32_bf16 v[100:103], v[48:51], v[92:95], v[100:103]
    v_mfma_f32_16x16x32_bf16 v[104:107], v[48:51], v[96:99], v[104:107]
    ds_read_b64_tr_b16 v[40:41], v14 offset:96
    ds_read_b64_tr_b16 v[42:43], v14 offset:2400
    s_add_u32 m0, s29, 0x1f800
    s_nop 0
    buffer_load_dwordx4 v10, s[16:19], s32 offen lds
    v_mfma_f32_16x16x32_bf16 v[108:111], v[52:55], v[92:95], v[108:111]
    v_mfma_f32_16x16x32_bf16 v[112:115], v[52:55], v[96:99], v[112:115]
    ds_read_b64_tr_b16 v[44:45], v14 offset:128
    ds_read_b64_tr_b16 v[46:47], v14 offset:2432
    s_add_u32 m0, s30, 0x21800
    s_nop 0
    s_mov_b64 exec, 0xffff
    buffer_load_dwordx4 v11, s[16:19], s32 offen lds
    s_mov_b64 exec, -1
    s_add_u32 s32, s32, 0x12000
    v_mfma_f32_16x16x32_bf16 v[116:119], v[56:59], v[92:95], v[116:119]
    v_mfma_f32_16x16x32_bf16 v[120:123], v[56:59], v[96:99], v[120:123]
    ds_read_b64_tr_b16 v[48:49], v14 offset:9216
    s_waitcnt lgkmcnt(13)
    ds_read_b64_tr_b16 v[50:51], v14 offset:11520
    v_mfma_f32_16x16x32_bf16 v[124:127], v[60:63], v[92:95], v[124:127]
    v_mfma_f32_16x16x32_bf16 v[128:131], v[60:63], v[96:99], v[128:131]
    ds_read_b64_tr_b16 v[52:53], v14 offset:9248
    s_waitcnt lgkmcnt(13)
    ds_read_b64_tr_b16 v[54:55], v14 offset:11552
    v_mfma_f32_16x16x32_bf16 v[132:135], v[64:67], v[92:95], v[132:135]
    v_mfma_f32_16x16x32_bf16 v[136:139], v[64:67], v[96:99], v[136:139]
    ds_read_b64_tr_b16 v[56:57], v14 offset:9280
    s_waitcnt lgkmcnt(13)
    ds_read_b64_tr_b16 v[58:59], v14 offset:11584
    v_mfma_f32_16x16x32_bf16 v[100:103], v[28:31], v[68:71], v[100:103]
    v_mfma_f32_16x16x32_bf16 v[104:107], v[28:31], v[72:75], v[104:107]
    ds_read_b64_tr_b16 v[60:61], v14 offset:9312
    s_waitcnt lgkmcnt(13)
    ds_read_b64_tr_b16 v[62:63], v14 offset:11616
    v_mfma_f32_16x16x32_bf16 v[108:111], v[32:35], v[68:71], v[108:111]
    v_mfma_f32_16x16x32_bf16 v[112:115], v[32:35], v[72:75], v[112:115]
    ds_read_b64_tr_b16 v[64:65], v14 offset:9344
    s_waitcnt lgkmcnt(13)
    ds_read_b64_tr_b16 v[66:67], v14 offset:11648
    v_mfma_f32_16x16x32_bf16 v[116:119], v[36:39], v[68:71], v[116:119]
    v_mfma_f32_16x16x32_bf16 v[120:123], v[36:39], v[72:75], v[120:123]
    s_waitcnt vmcnt(10) lgkmcnt(0)
    s_barrier
    ds_read_b128 v[84:87], v15 offset:0
    ds_read_b128 v[88:91], v15 offset:256
    ds_read_b64_tr_b16 v[28:29], v17 offset:0
    ds_read_b64_tr_b16 v[30:31], v17 offset:2304
    s_add_u32 m0, s29, 0x0
    s_nop 0
    buffer_load_dwordx4 v8, s[12:15], s31 offen lds
    v_mfma_f32_16x16x32_bf16 v[124:127], v[40:43], v[68:71], v[124:127]
    v_mfma_f32_16x16x32_bf16 v[128:131], v[40:43], v[72:75], v[128:131]
    ds_read_b64_tr_b16 v[32:33], v17 offset:32
    ds_read_b64_tr_b16 v[34:35], v17 offset:2336
    ds_read_b128 v[92:95], v16 offset:0
    s_add_u32 m0, s29, 0x2000
    s_add_u32 s33, s31, 0x90000
    buffer_load_dwordx4 v8, s[12:15], s33 offen lds
    s_add_u32 s31, s31, 4096
    v_mfma_f32_16x16x32_bf16 v[132:135], v[44:47], v[68:71], v[132:135]
    v_mfma_f32_16x16x32_bf16 v[136:139], v[44:47], v[72:75], v[136:139]
    ds_read_b64_tr_b16 v[36:37], v17 offset:64
    ds_read_b64_tr_b16 v[38:39], v17 offset:2368
    ds_read_b128 v[96:99], v16 offset:256
    s_add_u32 m0, s29, 0x4000
    s_nop 0
    buffer_load_dwordx4 v9, s[16:19], s32 offen lds
    v_mfma_f32_16x16x32_bf16 v[100:103], v[48:51], v[76:79], v[100:103]
    v_mfma_f32_16x16x32_bf16 v[104:107], v[48:51], v[80:83], v[104:107]
    ds_read_b64_tr_b16 v[40:41], v17 offset:96
    ds_read_b64_tr_b16 v[42:43], v17 offset:2400
    s_add_u32 m0, s29, 0x6000
    s_nop 0
    buffer_load_dwordx4 v10, s[16:19], s32 offen lds
    v_mfma_f32_16x16x32_bf16 v[108:111], v[52:55], v[76:79], v[108:111]
    v_mfma_f32_16x16x32_bf16 v[112:115], v[52:55], v[80:83], v[112:115]
    ds_read_b64_tr_b16 v[44:45], v17 offset:128
    ds_read_b64_tr_b16 v[46:47], v17 offset:2432
    s_add_u32 m0, s30, 0x8000
    s_nop 0
    s_mov_b64 exec, 0xffff
    buffer_load_dwordx4 v11, s[16:19], s32 offen lds
    s_mov_b64 exec, -1
    s_add_u32 s32, s32, 0x12000
    v_mfma_f32_16x16x32_bf16 v[116:119], v[56:59], v[76:79], v[116:119]
    v_mfma_f32_16x16x32_bf16 v[120:123], v[56:59], v[80:83], v[120:123]
    ds_read_b64_tr_b16 v[48:49], v17 offset:9216
    s_waitcnt lgkmcnt(13)
    ds_read_b64_tr_b16 v[50:51], v17 offset:11520
    v_mfma_f32_16x16x32_bf16 v[124:127], v[60:63], v[76:79], v[124:127]
    v_mfma_f32_16x16x32_bf16 v[128:131], v[60:63], v[80:83], v[128:131]
    ds_read_b64_tr_b16 v[52:53], v17 offset:9248
    s_waitcnt lgkmcnt(13)
    ds_read_b64_tr_b16 v[54:55], v17 offset:11552
    v_mfma_f32_16x16x32_bf16 v[132:135], v[64:67], v[76:79], v[132:135]
    v_mfma_f32_16x16x32_bf16 v[136:139], v[64:67], v[80:83], v[136:139]
    ds_read_b64_tr_b16 v[56:57], v17 offset:9280
    s_waitcnt lgkmcnt(13)
    ds_read_b64_tr_b16 v[58:59], v17 offset:11584
    v_mfma_f32_16x16x32_bf16 v[100:103], v[28:31], v[84:87], v[100:103]
    v_mfma_f32_16x16x32_bf16 v[104:107], v[28:31], v[88:91], v[104:107]
    ds_read_b64_tr_b16 v[60:61], v17 offset:9312
    s_waitcnt lgkmcnt(13)
    ds_read_b64_tr_b16 v[62:63], v17 offset:11616
    v_mfma_f32_16x16x32_bf16 v[108:111], v[32:35], v[84:87], v[108:111]
    v_mfma_f32_16x16x32_bf16 v[112:115], v[32:35], v[88:91], v[112:115]
    ds_read_b64_tr_b16 v[64:65], v17 offset:9344
    s_waitcnt lgkmcnt(13)
    ds_read_b64_tr_b16 v[66:67], v17 offset:11648
    v_mfma_f32_16x16x32_bf16 v[116:119], v[36:39], v[84:87], v[116:119]
    v_mfma_f32_16x16x32_bf16 v[120:123], v[36:39], v[88:91], v[120:123]
    s_waitcnt vmcnt(10) lgkmcnt(0)
    s_barrier
    ds_read_b128 v[68:71], v18 offset:0
    ds_read_b128 v[72:75], v18 offset:256
    ds_read_b64_tr_b16 v[28:29], v20 offset:0
    ds_read_b64_tr_b16 v[30:31], v20 offset:2304
    s_add_u32 m0, s29, 0x8800
    s_nop 0
    buffer_load_dwordx4 v8, s[12:15], s31 offen lds
    v_mfma_f32_16x16x32_bf16 v[124:127], v[40:43], v[84:87], v[124:127]
    v_mfma_f32_16x16x32_bf16 v[128:131], v[40:43], v[88:91], v[128:131]
    ds_read_b64_tr_b16 v[32:33], v20 offset:32
    ds_read_b64_tr_b16 v[34:35], v20 offset:2336
    ds_read_b128 v[76:79], v19 offset:0
    s_add_u32 m0, s29, 0xa800
    s_add_u32 s33, s31, 0x90000
    buffer_load_dwordx4 v8, s[12:15], s33 offen lds
    s_add_u32 s31, s31, 4096
    v_mfma_f32_16x16x32_bf16 v[132:135], v[44:47], v[84:87], v[132:135]
    v_mfma_f32_16x16x32_bf16 v[136:139], v[44:47], v[88:91], v[136:139]
    ds_read_b64_tr_b16 v[36:37], v20 offset:64
    ds_read_b64_tr_b16 v[38:39], v20 offset:2368
    ds_read_b128 v[80:83], v19 offset:256
    s_add_u32 m0, s29, 0xc800
    s_nop 0
    buffer_load_dwordx4 v9, s[16:19], s32 offen lds
    v_mfma_f32_16x16x32_bf16 v[100:103], v[48:51], v[92:95], v[100:103]
    v_mfma_f32_16x16x32_bf16 v[104:107], v[48:51], v[96:99], v[104:107]
    ds_read_b64_tr_b16 v[40:41], v20 offset:96
    ds_read_b64_tr_b16 v[42:43], v20 offset:2400
    s_add_u32 m0, s29, 0xe800
    s_nop 0
    buffer_load_dwordx4 v10, s[16:19], s32 offen lds
    v_mfma_f32_16x16x32_bf16 v[108:111], v[52:55], v[92:95], v[108:111]
    v_mfma_f32_16x16x32_bf16 v[112:115], v[52:55], v[96:99], v[112:115]
    ds_read_b64_tr_b16 v[44:45], v20 offset:128
    ds_read_b64_tr_b16 v[46:47], v20 offset:2432
    s_add_u32 m0, s30, 0x10800
    s_nop 0
    s_mov_b64 exec, 0xffff
    buffer_load_dwordx4 v11, s[16:19], s32 offen lds
    s_mov_b64 exec, -1
    s_add_u32 s32, s32, 0x12000
    v_mfma_f32_16x16x32_bf16 v[116:119], v[56:59], v[92:95], v[116:119]
    v_mfma_f32_16x16x32_bf16 v[120:123], v[56:59], v[96:99], v[120:123]
    ds_read_b64_tr_b16 v[48:49], v20 offset:9216
    s_waitcnt lgkmcnt(13)
    ds_read_b64_tr_b16 v[50:51], v20 offset:11520
    v_mfma_f32_16x16x32_bf16 v[124:127], v[60:63], v[92:95], v[124:127]
    v_mfma_f32_16x16x32_bf16 v[128:131], v[60:63], v[96:99], v[128:131]
    ds_read_b64_tr_b16 v[52:53], v20 offset:9248
    s_waitcnt lgkmcnt(13)
    ds_read_b64_tr_b16 v[54:55], v20 offset:11552
    v_mfma_f32_16x16x32_bf16 v[132:135], v[64:67], v[92:95], v[132:135]
    v_mfma_f32_16x16x32_bf16 v[136:139], v[64:67], v[96:99], v[136:139]
    ds_read_b64_tr_b16 v[56:57], v20 offset:9280
    s_waitcnt lgkmcnt(13)
    ds_read_b64_tr_b16 v[58:59], v20 offset:11584
    s_sub_u32 s40, s40, 1
    s_cmp_lg_u32 s40, 0
    s_cbranch_scc1 LP_rompt_kernel_28
    v_mfma_f32_16x16x32_bf16 v[100:103], v[28:31], v[68:71], v[100:103]
    v_mfma_f32_16x16x32_bf16 v[104:107], v[28:31], v[72:75], v[104:107]
    ds_read_b64_tr_b16 v[60:61], v20 offset:9312
    s_waitcnt lgkmcnt(13)
    ds_read_b64_tr_b16 v[62:63], v20 offset:11616
    v_mfma_f32_16x16x32_bf16 v[108:111], v[32:35], v[68:71], v[108:111]
    v_mfma_f32_16x16x32_bf16 v[112:115], v[32:35], v[72:75], v[112:115]
    ds_read_b64_tr_b16 v[64:65], v20 offset:9344
    s_waitcnt lgkmcnt(13)
    ds_read_b64_tr_b16 v[66:67], v20 offset:11648
    v_mfma_f32_16x16x32_bf16 v[116:119], v[36:39], v[68:71], v[116:119]
    v_mfma_f32_16x16x32_bf16 v[120:123], v[36:39], v[72:75], v[120:123]
    s_waitcnt vmcnt(10) lgkmcnt(0)
    s_barrier
    ds_read_b128 v[84:87], v21 offset:0
    ds_read_b128 v[88:91], v21 offset:256
    ds_read_b64_tr_b16 v[28:29], v23 offset:0
    ds_read_b64_tr_b16 v[30:31], v23 offset:2304
    v_mfma_f32_16x16x32_bf16 v[124:127], v[40:43], v[68:71], v[124:127]
    v_mfma_f32_16x16x32_bf16 v[128:131], v[40:43], v[72:75], v[128:131]
    ds_read_b64_tr_b16 v[32:33], v23 offset:32
    ds_read_b64_tr_b16 v[34:35], v23 offset:2336
    ds_read_b128 v[92:95], v22 offset:0
    v_mfma_f32_16x16x32_bf16 v[132:135], v[44:47], v[68:71], v[132:135]
    v_mfma_f32_16x16x32_bf16 v[136:139], v[44:47], v[72:75], v[136:139]
    ds_read_b64_tr_b16 v[36:37], v23 offset:64
    ds_read_b64_tr_b16 v[38:39], v23 offset:2368
    ds_read_b128 v[96:99], v22 offset:256
    v_mfma_f32_16x16x32_bf16 v[100:103], v[48:51], v[76:79], v[100:103]
    v_mfma_f32_16x16x32_bf16 v[104:107], v[48:51], v[80:83], v[104:107]
    ds_read_b64_tr_b16 v[40:41], v23 offset:96
    ds_read_b64_tr_b16 v[42:43], v23 offset:2400
    v_mfma_f32_16x16x32_bf16 v[108:111], v[52:55], v[76:79], v[108:111]
    v_mfma_f32_16x16x32_bf16 v[112:115], v[52:55], v[80:83], v[112:115]
    ds_read_b64_tr_b16 v[44:45], v23 offset:128
    ds_read_b64_tr_b16 v[46:47], v23 offset:2432
    v_mfma_f32_16x16x32_bf16 v[116:119], v[56:59], v[76:79], v[116:119]
    v_mfma_f32_16x16x32_bf16 v[120:123], v[56:59], v[80:83], v[120:123]
    ds_read_b64_tr_b16 v[48:49], v23 offset:9216
    s_waitcnt lgkmcnt(13)
    ds_read_b64_tr_b16 v[50:51], v23 offset:11520
    v_mfma_f32_16x16x32_bf16 v[124:127], v[60:63], v[76:79], v[124:127]
    v_mfma_f32_16x16x32_bf16 v[128:131], v[60:63], v[80:83], v[128:131]
    ds_read_b64_tr_b16 v[52:53], v23 offset:9248
    s_waitcnt lgkmcnt(13)
    ds_read_b64_tr_b16 v[54:55], v23 offset:11552
    v_mfma_f32_16x16x32_bf16 v[132:135], v[64:67], v[76:79], v[132:135]
    v_mfma_f32_16x16x32_bf16 v[136:139], v[64:67], v[80:83], v[136:139]
    ds_read_b64_tr_b16 v[56:57], v23 offset:9280
    s_waitcnt lgkmcnt(13)
    ds_read_b64_tr_b16 v[58:59], v23 offset:11584
    v_mfma_f32_16x16x32_bf16 v[100:103], v[28:31], v[84:87], v[100:103]
    v_mfma_f32_16x16x32_bf16 v[104:107], v[28:31], v[88:91], v[104:107]
    ds_read_b64_tr_b16 v[60:61], v23 offset:9312
    s_waitcnt lgkmcnt(13)
    ds_read_b64_tr_b16 v[62:63], v23 offset:11616
    v_mfma_f32_16x16x32_bf16 v[108:111], v[32:35], v[84:87], v[108:111]
    v_mfma_f32_16x16x32_bf16 v[112:115], v[32:35], v[88:91], v[112:115]
    ds_read_b64_tr_b16 v[64:65], v23 offset:9344
    s_waitcnt lgkmcnt(13)
    ds_read_b64_tr_b16 v[66:67], v23 offset:11648
    v_mfma_f32_16x16x32_bf16 v[116:119], v[36:39], v[84:87], v[116:119]
    v_mfma_f32_16x16x32_bf16 v[120:123], v[36:39], v[88:91], v[120:123]
    s_waitcnt vmcnt(5) lgkmcnt(0)
    s_barrier
    ds_read_b128 v[68:71], v12 offset:0
    ds_read_b128 v[72:75], v12 offset:256
    ds_read_b64_tr_b16 v[28:29], v14 offset:0
    ds_read_b64_tr_b16 v[30:31], v14 offset:2304
    v_mfma_f32_16x16x32_bf16 v[124:127], v[40:43], v[84:87], v[124:127]
    v_mfma_f32_16x16x32_bf16 v[128:131], v[40:43], v[88:91], v[128:131]
    ds_read_b64_tr_b16 v[32:33], v14 offset:32
    ds_read_b64_tr_b16 v[34:35], v14 offset:2336
    ds_read_b128 v[76:79], v13 offset:0
    v_mfma_f32_16x16x32_bf16 v[132:135], v[44:47], v[84:87], v[132:135]
    v_mfma_f32_16x16x32_bf16 v[136:139], v[44:47], v[88:91], v[136:139]
    ds_read_b64_tr_b16 v[36:37], v14 offset:64
    ds_read_b64_tr_b16 v[38:39], v14 offset:2368
    ds_read_b128 v[80:83], v13 offset:256
    v_mfma_f32_16x16x32_bf16 v[100:103], v[48:51], v[92:95], v[100:103]
    v_mfma_f32_16x16x32_bf16 v[104:107], v[48:51], v[96:99], v[104:107]
    ds_read_b64_tr_b16 v[40:41], v14 offset:96
    ds_read_b64_tr_b16 v[42:43], v14 offset:2400
    v_mfma_f32_16x16x32_bf16 v[108:111], v[52:55], v[92:95], v[108:111]
    v_mfma_f32_16x16x32_bf16 v[112:115], v[52:55], v[96:99], v[112:115]
    ds_read_b64_tr_b16 v[44:45], v14 offset:128
    ds_read_b64_tr_b16 v[46:47], v14 offset:2432
    v_mfma_f32_16x16x32_bf16 v[116:119], v[56:59], v[92:95], v[116:119]
    v_mfma_f32_16x16x32_bf16 v[120:123], v[56:59], v[96:99], v[120:123]
    ds_read_b64_tr_b16 v[48:49], v14 offset:9216
    s_waitcnt lgkmcnt(13)
    ds_read_b64_tr_b16 v[50:51], v14 offset:11520
    v_mfma_f32_16x16x32_bf16 v[124:127], v[60:63], v[92:95], v[124:127]
    v_mfma_f32_16x16x32_bf16 v[128:131], v[60:63], v[96:99], v[128:131]
    ds_read_b64_tr_b16 v[52:53], v14 offset:9248
    s_waitcnt lgkmcnt(13)
    ds_read_b64_tr_b16 v[54:55], v14 offset:11552
    v_mfma_f32_16x16x32_bf16 v[132:135], v[64:67], v[92:95], v[132:135]
    v_mfma_f32_16x16x32_bf16 v[136:139], v[64:67], v[96:99], v[136:139]
    ds_read_b64_tr_b16 v[56:57], v14 offset:9280
    s_waitcnt lgkmcnt(13)
    ds_read_b64_tr_b16 v[58:59], v14 offset:11584
    v_mfma_f32_16x16x32_bf16 v[100:103], v[28:31], v[68:71], v[100:103]
    v_mfma_f32_16x16x32_bf16 v[104:107], v[28:31], v[72:75], v[104:107]
    ds_read_b64_tr_b16 v[60:61], v14 offset:9312
    s_waitcnt lgkmcnt(13)
    ds_read_b64_tr_b16 v[62:63], v14 offset:11616
    v_mfma_f32_16x16x32_bf16 v[108:111], v[32:35], v[68:71], v[108:111]
    v_mfma_f32_16x16x32_bf16 v[112:115], v[32:35], v[72:75], v[112:115]
    ds_read_b64_tr_b16 v[64:65], v14 offset:9344
    s_waitcnt lgkmcnt(13)
    ds_read_b64_tr_b16 v[66:67], v14 offset:11648
    v_mfma_f32_16x16x32_bf16 v[116:119], v[36:39], v[68:71], v[116:119]
    v_mfma_f32_16x16x32_bf16 v[120:123], v[36:39], v[72:75], v[120:123]
    s_waitcnt vmcnt(0) lgkmcnt(0)
    s_barrier
    ds_read_b128 v[84:87], v15 offset:0
    ds_read_b128 v[88:91], v15 offset:256
    ds_read_b64_tr_b16 v[28:29], v17 offset:0
    ds_read_b64_tr_b16 v[30:31], v17 offset:2304
    v_mfma_f32_16x16x32_bf16 v[124:127], v[40:43], v[68:71], v[124:127]
    v_mfma_f32_16x16x32_bf16 v[128:131], v[40:43], v[72:75], v[128:131]
    ds_read_b64_tr_b16 v[32:33], v17 offset:32
    ds_read_b64_tr_b16 v[34:35], v17 offset:2336
    ds_read_b128 v[92:95], v16 offset:0
    v_mfma_f32_16x16x32_bf16 v[132:135], v[44:47], v[68:71], v[132:135]
    v_mfma_f32_16x16x32_bf16 v[136:139], v[44:47], v[72:75], v[136:139]
    ds_read_b64_tr_b16 v[36:37], v17 offset:64
    ds_read_b64_tr_b16 v[38:39], v17 offset:2368
    ds_read_b128 v[96:99], v16 offset:256
    v_mfma_f32_16x16x32_bf16 v[100:103], v[48:51], v[76:79], v[100:103]
    v_mfma_f32_16x16x32_bf16 v[104:107], v[48:51], v[80:83], v[104:107]
    ds_read_b64_tr_b16 v[40:41], v17 offset:96
    ds_read_b64_tr_b16 v[42:43], v17 offset:2400
    v_mfma_f32_16x16x32_bf16 v[108:111], v[52:55], v[76:79], v[108:111]
    v_mfma_f32_16x16x32_bf16 v[112:115], v[52:55], v[80:83], v[112:115]
    ds_read_b64_tr_b16 v[44:45], v17 offset:128
    ds_read_b64_tr_b16 v[46:47], v17 offset:2432
    v_mfma_f32_16x16x32_bf16 v[116:119], v[56:59], v[76:79], v[116:119]
    v_mfma_f32_16x16x32_bf16 v[120:123], v[56:59], v[80:83], v[120:123]
    ds_read_b64_tr_b16 v[48:49], v17 offset:9216
    s_waitcnt lgkmcnt(13)
    ds_read_b64_tr_b16 v[50:51], v17 offset:11520
    v_mfma_f32_16x16x32_bf16 v[124:127], v[60:63], v[76:79], v[124:127]
    v_mfma_f32_16x16x32_bf16 v[128:131], v[60:63], v[80:83], v[128:131]
    ds_read_b64_tr_b16 v[52:53], v17 offset:9248
    s_waitcnt lgkmcnt(13)
    ds_read_b64_tr_b16 v[54:55], v17 offset:11552
    v_mfma_f32_16x16x32_bf16 v[132:135], v[64:67], v[76:79], v[132:135]
    v_mfma_f32_16x16x32_bf16 v[136:139], v[64:67], v[80:83], v[136:139]
    ds_read_b64_tr_b16 v[56:57], v17 offset:9280
    s_waitcnt lgkmcnt(13)
    ds_read_b64_tr_b16 v[58:59], v17 offset:11584
    v_mfma_f32_16x16x32_bf16 v[100:103], v[28:31], v[84:87], v[100:103]
    v_mfma_f32_16x16x32_bf16 v[104:107], v[28:31], v[88:91], v[104:107]
    ds_read_b64_tr_b16 v[60:61], v17 offset:9312
    s_waitcnt lgkmcnt(13)
    ds_read_b64_tr_b16 v[62:63], v17 offset:11616
    v_mfma_f32_16x16x32_bf16 v[108:111], v[32:35], v[84:87], v[108:111]
    v_mfma_f32_16x16x32_bf16 v[112:115], v[32:35], v[88:91], v[112:115]
    ds_read_b64_tr_b16 v[64:65], v17 offset:9344
    s_waitcnt lgkmcnt(13)
    ds_read_b64_tr_b16 v[66:67], v17 offset:11648
    v_mfma_f32_16x16x32_bf16 v[116:119], v[36:39], v[84:87], v[116:119]
    v_mfma_f32_16x16x32_bf16 v[120:123], v[36:39], v[88:91], v[120:123]
    s_waitcnt lgkmcnt(12)
    v_mfma_f32_16x16x32_bf16 v[124:127], v[40:43], v[84:87], v[124:127]
    v_mfma_f32_16x16x32_bf16 v[128:131], v[40:43], v[88:91], v[128:131]
    s_waitcnt lgkmcnt(10)
    v_mfma_f32_16x16x32_bf16 v[132:135], v[44:47], v[84:87], v[132:135]
    v_mfma_f32_16x16x32_bf16 v[136:139], v[44:47], v[88:91], v[136:139]
    s_waitcnt lgkmcnt(8)
    v_mfma_f32_16x16x32_bf16 v[100:103], v[48:51], v[92:95], v[100:103]
    v_mfma_f32_16x16x32_bf16 v[104:107], v[48:51], v[96:99], v[104:107]
    s_waitcnt lgkmcnt(6)
    v_mfma_f32_16x16x32_bf16 v[108:111], v[52:55], v[92:95], v[108:111]
    v_mfma_f32_16x16x32_bf16 v[112:115], v[52:55], v[96:99], v[112:115]
    s_waitcnt lgkmcnt(4)
    v_mfma_f32_16x16x32_bf16 v[116:119], v[56:59], v[92:95], v[116:119]
    v_mfma_f32_16x16x32_bf16 v[120:123], v[56:59], v[96:99], v[120:123]
    s_waitcnt lgkmcnt(2)
    v_mfma_f32_16x16x32_bf16 v[124:127], v[60:63], v[92:95], v[124:127]
    v_mfma_f32_16x16x32_bf16 v[128:131], v[60:63], v[96:99], v[128:131]
    s_waitcnt lgkmcnt(0)
    v_mfma_f32_16x16x32_bf16 v[132:135], v[64:67], v[92:95], v[132:135]
    v_mfma_f32_16x16x32_bf16 v[136:139], v[64:67], v[96:99], v[136:139]
    s_nop 7
    s_nop 3
    v_add_u32 v100, 0x10000, v100
    v_and_b32 v100, 0xfffe0000, v100
    v_cvt_pk_bf16_f32 v28, v100, v101
    v_cvt_pk_bf16_f32 v29, v102, v103
    v_and_b32 v28, -2, v28
    v_add_u32 v104, 0x10000, v104
    v_and_b32 v104, 0xfffe0000, v104
    v_cvt_pk_bf16_f32 v30, v104, v105
    v_cvt_pk_bf16_f32 v31, v106, v107
    v_and_b32 v30, -2, v30
    s_mov_b32 s33, 0
    s_nop 0
    v_permlane16_swap_b32 v28, v30
    v_permlane16_swap_b32 v29, v31
    s_nop 0
    buffer_store_dwordx4 v[28:31], v7, s[24:27], s33 offen offset:0 sc0 sc1
    v_add_u32 v108, 0x10000, v108
    v_and_b32 v108, 0xfffe0000, v108
    v_cvt_pk_bf16_f32 v32, v108, v109
    v_cvt_pk_bf16_f32 v33, v110, v111
    v_and_b32 v32, -2, v32
    v_add_u32 v112, 0x10000, v112
    v_and_b32 v112, 0xfffe0000, v112
    v_cvt_pk_bf16_f32 v34, v112, v113
    v_cvt_pk_bf16_f32 v35, v114, v115
    v_and_b32 v34, -2, v34
    s_nop 0
    s_nop 0
    v_permlane16_swap_b32 v32, v34
    v_permlane16_swap_b32 v33, v35
    s_nop 0
    buffer_store_dwordx4 v[32:35], v7, s[24:27], s33 offen offset:1024 sc0 sc1
    v_add_u32 v116, 0x10000, v116
    v_and_b32 v116, 0xfffe0000, v116
    v_cvt_pk_bf16_f32 v36, v116, v117
    v_cvt_pk_bf16_f32 v37, v118, v119
    v_and_b32 v36, -2, v36
    v_add_u32 v120, 0x10000, v120
    v_and_b32 v120, 0xfffe0000, v120
    v_cvt_pk_bf16_f32 v38, v120, v121
    v_cvt_pk_bf16_f32 v39, v122, v123
    v_and_b32 v38, -2, v38
    s_nop 0
    s_nop 0
    v_permlane16_swap_b32 v36, v38
    v_permlane16_swap_b32 v37, v39
    s_nop 0
    buffer_store_dwordx4 v[36:39], v7, s[24:27], s33 offen offset:2048 sc0 sc1
    v_add_u32 v124, 0x10000, v124
    v_and_b32 v124, 0xfffe0000, v124
    v_cvt_pk_bf16_f32 v40, v124, v125
    v_cvt_pk_bf16_f32 v41, v126, v127
    v_and_b32 v40, -2, v40
    v_add_u32 v128, 0x10000, v128
    v_and_b32 v128, 0xfffe0000, v128
    v_cvt_pk_bf16_f32 v42, v128, v129
    v_cvt_pk_bf16_f32 v43, v130, v131
    v_and_b32 v42, -2, v42
    s_nop 0
    s_nop 0
    v_permlane16_swap_b32 v40, v42
    v_permlane16_swap_b32 v41, v43
    s_nop 0
    buffer_store_dwordx4 v[40:43], v7, s[24:27], s33 offen offset:3072 sc0 sc1
    v_add_u32 v132, 0x10000, v132
    v_and_b32 v132, 0xfffe0000, v132
    v_cvt_pk_bf16_f32 v28, v132, v133
    v_cvt_pk_bf16_f32 v29, v134, v135
    v_and_b32 v28, -2, v28
    v_add_u32 v136, 0x10000, v136
    v_and_b32 v136, 0xfffe0000, v136
    v_cvt_pk_bf16_f32 v30, v136, v137
    v_cvt_pk_bf16_f32 v31, v138, v139
    v_and_b32 v30, -2, v30
    s_mov_b32 s33, 4096
    s_nop 0
    v_permlane16_swap_b32 v28, v30
    v_permlane16_swap_b32 v29, v31
    s_nop 0
    buffer_store_dwordx4 v[28:31], v7, s[24:27], s33 offen offset:0 sc0 sc1
    s_branch LJ_rompt_kernel_26
LG_rompt_kernel_27:
    ds_read_b128 v[68:71], v12 offset:0
    ds_read_b128 v[72:75], v12 offset:256
    ds_read_b64_tr_b16 v[28:29], v14 offset:160
    ds_read_b64_tr_b16 v[30:31], v14 offset:2464
    ds_read_b64_tr_b16 v[32:33], v14 offset:192
    ds_read_b64_tr_b16 v[34:35], v14 offset:2496
    ds_read_b64_tr_b16 v[36:37], v14 offset:224
    ds_read_b64_tr_b16 v[38:39], v14 offset:2528
    ds_read_b64_tr_b16 v[40:41], v14 offset:256
    ds_read_b64_tr_b16 v[42:43], v14 offset:2560
    ds_read_b128 v[76:79], v13 offset:0
    ds_read_b128 v[80:83], v13 offset:256
    ds_read_b64_tr_b16 v[44:45], v14 offset:9376
    ds_read_b64_tr_b16 v[46:47], v14 offset:11680
    ds_read_b64_tr_b16 v[48:49], v14 offset:9408
    s_waitcnt lgkmcnt(13)
    ds_read_b64_tr_b16 v[50:51], v14 offset:11712
    s_waitcnt lgkmcnt(12)
    v_mfma_f32_16x16x32_bf16 v[100:103], v[28:31], v[68:71], 0
    v_mfma_f32_16x16x32_bf16 v[104:107], v[28:31], v[72:75], 0
    ds_read_b64_tr_b16 v[52:53], v14 offset:9440
    ds_read_b64_tr_b16 v[54:55], v14 offset:11744
    s_waitcnt lgkmcnt(12)
    v_mfma_f32_16x16x32_bf16 v[108:111], v[32:35], v[68:71], 0
    v_mfma_f32_16x16x32_bf16 v[112:115], v[32:35], v[72:75], 0
    ds_read_b64_tr_b16 v[56:57], v14 offset:9472
    ds_read_b64_tr_b16 v[58:59], v14 offset:11776
    s_waitcnt lgkmcnt(12)
    v_mfma_f32_16x16x32_bf16 v[116:119], v[36:39], v[68:71], 0
    v_mfma_f32_16x16x32_bf16 v[120:123], v[36:39], v[72:75], 0
    s_waitcnt vmcnt(4) lgkmcnt(0)
    s_barrier
    ds_read_b128 v[84:87], v15 offset:0
    ds_read_b128 v[88:91], v15 offset:256
    ds_read_b64_tr_b16 v[28:29], v17 offset:160
    ds_read_b64_tr_b16 v[30:31], v17 offset:2464
    s_add_u32 m0, s29, 0x0
    s_nop 0
    buffer_load_dwordx4 v8, s[12:15], s31 offen lds
    v_mfma_f32_16x16x32_bf16 v[124:127], v[40:43], v[68:71], 0
    v_mfma_f32_16x16x32_bf16 v[128:131], v[40:43], v[72:75], 0
    ds_read_b64_tr_b16 v[32:33], v17 offset:192
    ds_read_b64_tr_b16 v[34:35], v17 offset:2496
    ds_read_b128 v[92:95], v16 offset:0
    s_add_u32 m0, s29, 0x2000
    s_add_u32 s33, s31, 0x90000
    buffer_load_dwordx4 v8, s[12:15], s33 offen lds
    s_add_u32 s31, s31, 4096
    v_mfma_f32_16x16x32_bf16 v[100:103], v[44:47], v[76:79], v[100:103]
    v_mfma_f32_16x16x32_bf16 v[104:107], v[44:47], v[80:83], v[104:107]
    ds_read_b64_tr_b16 v[36:37], v17 offset:224
    ds_read_b64_tr_b16 v[38:39], v17 offset:2528
    ds_read_b128 v[96:99], v16 offset:256
    s_add_u32 m0, s29, 0x4000
    s_nop 0
    buffer_load_dwordx4 v9, s[16:19], s32 offen lds
    v_mfma_f32_16x16x32_bf16 v[108:111], v[48:51], v[76:79], v[108:111]
    v_mfma_f32_16x16x32_bf16 v[112:115], v[48:51], v[80:83], v[112:115]
    ds_read_b64_tr_b16 v[40:41], v17 offset:256
    ds_read_b64_tr_b16 v[42:43], v17 offset:2560
    s_add_u32 m0, s29, 0x6000
    s_nop 0
    buffer_load_dwordx4 v10, s[16:19], s32 offen lds
    v_mfma_f32_16x16x32_bf16 v[116:119], v[52:55], v[76:79], v[116:119]
    v_mfma_f32_16x16x32_bf16 v[120:123], v[52:55], v[80:83], v[120:123]
    ds_read_b64_tr_b16 v[44:45], v17 offset:9376
    ds_read_b64_tr_b16 v[46:47], v17 offset:11680
    s_add_u32 m0, s30, 0x8000
    s_nop 0
    s_mov_b64 exec, 0xffff
    buffer_load_dwordx4 v11, s[16:19], s32 offen lds
    s_mov_b64 exec, -1
    s_add_u32 s32, s32, 0x12000
    v_mfma_f32_16x16x32_bf16 v[124:127], v[56:59], v[76:79], v[124:127]
    v_mfma_f32_16x16x32_bf16 v[128:131], v[56:59], v[80:83], v[128:131]
    ds_read_b64_tr_b16 v[48:49], v17 offset:9408
    s_waitcnt lgkmcnt(13)
    ds_read_b64_tr_b16 v[50:51], v17 offset:11712
    s_waitcnt lgkmcnt(12)
    v_mfma_f32_16x16x32_bf16 v[100:103], v[28:31], v[84:87], v[100:103]
    v_mfma_f32_16x16x32_bf16 v[104:107], v[28:31], v[88:91], v[104:107]
    ds_read_b64_tr_b16 v[52:53], v17 offset:9440
    ds_read_b64_tr_b16 v[54:55], v17 offset:11744
    s_waitcnt lgkmcnt(12)
    v_mfma_f32_16x16x32_bf16 v[108:111], v[32:35], v[84:87], v[108:111]
    v_mfma_f32_16x16x32_bf16 v[112:115], v[32:35], v[88:91], v[112:115]
    ds_read_b64_tr_b16 v[56:57], v17 offset:9472
    ds_read_b64_tr_b16 v[58:59], v17 offset:11776
    s_waitcnt lgkmcnt(11)
    v_mfma_f32_16x16x32_bf16 v[116:119], v[36:39], v[84:87], v[116:119]
    v_mfma_f32_16x16x32_bf16 v[120:123], v[36:39], v[88:91], v[120:123]
    s_waitcnt vmcnt(7) lgkmcnt(0)
    s_barrier
    ds_read_b128 v[68:71], v18 offset:0
    ds_read_b128 v[72:75], v18 offset:256
    ds_read_b64_tr_b16 v[28:29], v20 offset:160
    ds_read_b64_tr_b16 v[30:31], v20 offset:2464
    s_add_u32 m0, s29, 0x8800
    s_nop 0
    buffer_load_dwordx4 v8, s[12:15], s31 offen lds
    v_mfma_f32_16x16x32_bf16 v[124:127], v[40:43], v[84:87], v[124:127]
    v_mfma_f32_16x16x32_bf16 v[128:131], v[40:43], v[88:91], v[128:131]
    ds_read_b64_tr_b16 v[32:33], v20 offset:192
    ds_read_b64_tr_b16 v[34:35], v20 offset:2496
    ds_read_b128 v[76:79], v19 offset:0
    s_add_u32 m0, s29, 0xa800
    s_add_u32 s33, s31, 0x90000
    buffer_load_dwordx4 v8, s[12:15], s33 offen lds
    s_add_u32 s31, s31, 4096
    v_mfma_f32_16x16x32_bf16 v[100:103], v[44:47], v[92:95], v[100:103]
    v_mfma_f32_16x16x32_bf16 v[104:107], v[44:47], v[96:99], v[104:107]
    ds_read_b64_tr_b16 v[36:37], v20 offset:224
    ds_read_b64_tr_b16 v[38:39], v20 offset:2528
    ds_read_b128 v[80:83], v19 offset:256
    s_add_u32 m0, s29, 0xc800
    s_nop 0
    buffer_load_dwordx4 v9, s[16:19], s32 offen lds
    v_mfma_f32_16x16x32_bf16 v[108:111], v[48:51], v[92:95], v[108:111]
    v_mfma_f32_16x16x32_bf16 v[112:115], v[48:51], v[96:99], v[112:115]
    ds_read_b64_tr_b16 v[40:41], v20 offset:256
    ds_read_b64_tr_b16 v[42:43], v20 offset:2560
    s_add_u32 m0, s29, 0xe800
    s_nop 0
    buffer_load_dwordx4 v10, s[16:19], s32 offen lds
    v_mfma_f32_16x16x32_bf16 v[116:119], v[52:55], v[92:95], v[116:119]
    v_mfma_f32_16x16x32_bf16 v[120:123], v[52:55], v[96:99], v[120:123]
    ds_read_b64_tr_b16 v[44:45], v20 offset:9376
    ds_read_b64_tr_b16 v[46:47], v20 offset:11680
    s_add_u32 m0, s30, 0x10800
    s_nop 0
    s_mov_b64 exec, 0xffff
    buffer_load_dwordx4 v11, s[16:19], s32 offen lds
    s_mov_b64 exec, -1
    s_add_u32 s32, s32, 0x12000
    v_mfma_f32_16x16x32_bf16 v[124:127], v[56:59], v[92:95], v[124:127]
    v_mfma_f32_16x16x32_bf16 v[128:131], v[56:59], v[96:99], v[128:131]
    ds_read_b64_tr_b16 v[48:49], v20 offset:9408
    s_waitcnt lgkmcnt(13)
    ds_read_b64_tr_b16 v[50:51], v20 offset:11712
    s_mov_b32 s40, 3
LP_rompt_kernel_29:
    s_waitcnt lgkmcnt(12)
    v_mfma_f32_16x16x32_bf16 v[100:103], v[28:31], v[68:71], v[100:103]
    v_mfma_f32_16x16x32_bf16 v[104:107], v[28:31], v[72:75], v[104:107]
    ds_read_b64_tr_b16 v[52:53], v20 offset:9440
    ds_read_b64_tr_b16 v[54:55], v20 offset:11744
    s_waitcnt lgkmcnt(12)
    v_mfma_f32_16x16x32_bf16 v[108:111], v[32:35], v[68:71], v[108:111]
    v_mfma_f32_16x16x32_bf16 v[112:115], v[32:35], v[72:75], v[112:115]
    ds_read_b64_tr_b16 v[56:57], v20 offset:9472
    ds_read_b64_tr_b16 v[58:59], v20 offset:11776
    s_waitcnt lgkmcnt(11)
    v_mfma_f32_16x16x32_bf16 v[116:119], v[36:39], v[68:71], v[116:119]
    v_mfma_f32_16x16x32_bf16 v[120:123], v[36:39], v[72:75], v[120:123]
    s_waitcnt vmcnt(10) lgkmcnt(0)
    s_barrier
    ds_read_b128 v[84:87], v21 offset:0
    ds_read_b128 v[88:91], v21 offset:256
    ds_read_b64_tr_b16 v[28:29], v23 offset:160
    ds_read_b64_tr_b16 v[30:31], v23 offset:2464
    s_add_u32 m0, s29, 0x11000
    s_nop 0
    buffer_load_dwordx4 v8, s[12:15], s31 offen lds
    v_mfma_f32_16x16x32_bf16 v[124:127], v[40:43], v[68:71], v[124:127]
    v_mfma_f32_16x16x32_bf16 v[128:131], v[40:43], v[72:75], v[128:131]
    ds_read_b64_tr_b16 v[32:33], v23 offset:192
    ds_read_b64_tr_b16 v[34:35], v23 offset:2496
    ds_read_b128 v[92:95], v22 offset:0
    s_add_u32 m0, s29, 0x13000
    s_add_u32 s33, s31, 0x90000
    buffer_load_dwordx4 v8, s[12:15], s33 offen lds
    s_add_u32 s31, s31, 4096
    v_mfma_f32_16x16x32_bf16 v[100:103], v[44:47], v[76:79], v[100:103]
    v_mfma_f32_16x16x32_bf16 v[104:107], v[44:47], v[80:83], v[104:107]
    ds_read_b64_tr_b16 v[36:37], v23 offset:224
    ds_read_b64_tr_b16 v[38:39], v23 offset:2528
    ds_read_b128 v[96:99], v22 offset:256
    s_add_u32 m0, s29, 0x15000
    s_nop 0
    buffer_load_dwordx4 v9, s[16:19], s32 offen lds
    v_mfma_f32_16x16x32_bf16 v[108:111], v[48:51], v[76:79], v[108:111]
    v_mfma_f32_16x16x32_bf16 v[112:115], v[48:51], v[80:83], v[112:115]
    ds_read_b64_tr_b16 v[40:41], v23 offset:256
    ds_read_b64_tr_b16 v[42:43], v23 offset:2560
    s_add_u32 m0, s29, 0x17000
    s_nop 0
    buffer_load_dwordx4 v10, s[16:19], s32 offen lds
    v_mfma_f32_16x16x32_bf16 v[116:119], v[52:55], v[76:79], v[116:119]
    v_mfma_f32_16x16x32_bf16 v[120:123], v[52:55], v[80:83], v[120:123]
    ds_read_b64_tr_b16 v[44:45], v23 offset:9376
    ds_read_b64_tr_b16 v[46:47], v23 offset:11680
    s_add_u32 m0, s30, 0x19000
    s_nop 0
    s_mov_b64 exec, 0xffff
    buffer_load_dwordx4 v11, s[16:19], s32 offen lds
    s_mov_b64 exec, -1
    s_add_u32 s32, s32, 0x12000
    v_mfma_f32_16x16x32_bf16 v[124:127], v[56:59], v[76:79], v[124:127]
    v_mfma_f32_16x16x32_bf16 v[128:131], v[56:59], v[80:83], v[128:131]
    ds_read_b64_tr_b16 v[48:49], v23 offset:9408
    s_waitcnt lgkmcnt(13)
    ds_read_b64_tr_b16 v[50:51], v23 offset:11712
    s_waitcnt lgkmcnt(12)
    v_mfma_f32_16x16x32_bf16 v[100:103], v[28:31], v[84:87], v[100:103]
    v_mfma_f32_16x16x32_bf16 v[104:107], v[28:31], v[88:91], v[104:107]
    ds_read_b64_tr_b16 v[52:53], v23 offset:9440
    ds_read_b64_tr_b16 v[54:55], v23 offset:11744
    s_waitcnt lgkmcnt(12)
    v_mfma_f32_16x16x32_bf16 v[108:111], v[32:35], v[84:87], v[108:111]
    v_mfma_f32_16x16x32_bf16 v[112:115], v[32:35], v[88:91], v[112:115]
    ds_read_b64_tr_b16 v[56:57], v23 offset:9472
    ds_read_b64_tr_b16 v[58:59], v23 offset:11776
    s_waitcnt lgkmcnt(11)
    v_mfma_f32_16x16x32_bf16 v[116:119], v[36:39], v[84:87], v[116:119]
    v_mfma_f32_16x16x32_bf16 v[120:123], v[36:39], v[88:91], v[120:123]
    s_waitcnt vmcnt(10) lgkmcnt(0)
    s_barrier
    ds_read_b128 v[68:71], v12 offset:0
    ds_read_b128 v[72:75], v12 offset:256
    ds_read_b64_tr_b16 v[28:29], v14 offset:160
    ds_read_b64_tr_b16 v[30:31], v14 offset:2464
    s_add_u32 m0, s29, 0x19800
    s_nop 0
    buffer_load_dwordx4 v8, s[12:15], s31 offen lds
    v_mfma_f32_16x16x32_bf16 v[124:127], v[40:43], v[84:87], v[124:127]
    v_mfma_f32_16x16x32_bf16 v[128:131], v[40:43], v[88:91], v[128:131]
    ds_read_b64_tr_b16 v[32:33], v14 offset:192
    ds_read_b64_tr_b16 v[34:35], v14 offset:2496
    ds_read_b128 v[76:79], v13 offset:0
    s_add_u32 m0, s29, 0x1b800
    s_add_u32 s33, s31, 0x90000
    buffer_load_dwordx4 v8, s[12:15], s33 offen lds
    s_add_u32 s31, s31, 4096
    v_mfma_f32_16x16x32_bf16 v[100:103], v[44:47], v[92:95], v[100:103]
    v_mfma_f32_16x16x32_bf16 v[104:107], v[44:47], v[96:99], v[104:107]
    ds_read_b64_tr_b16 v[36:37], v14 offset:224
    ds_read_b64_tr_b16 v[38:39], v14 offset:2528
    ds_read_b128 v[80:83], v13 offset:256
    s_add_u32 m0, s29, 0x1d800
    s_nop 0
    buffer_load_dwordx4 v9, s[16:19], s32 offen lds
    v_mfma_f32_16x16x32_bf16 v[108:111], v[48:51], v[92:95], v[108:111]
    v_mfma_f32_16x16x32_bf16 v[112:115], v[48:51], v[96:99], v[112:115]
    ds_read_b64_tr_b16 v[40:41], v14 offset:256
    ds_read_b64_tr_b16 v[42:43], v14 offset:2560
    s_add_u32 m0, s29, 0x1f800
    s_nop 0
    buffer_load_dwordx4 v10, s[16:19], s32 offen lds
    v_mfma_f32_16x16x32_bf16 v[116:119], v[52:55], v[92:95], v[116:119]
    v_mfma_f32_16x16x32_bf16 v[120:123], v[52:55], v[96:99], v[120:123]
    ds_read_b64_tr_b16 v[44:45], v14 offset:9376
    ds_read_b64_tr_b16 v[46:47], v14 offset:11680
    s_add_u32 m0, s30, 0x21800
    s_nop 0
    s_mov_b64 exec, 0xffff
    buffer_load_dwordx4 v11, s[16:19], s32 offen lds
    s_mov_b64 exec, -1
    s_add_u32 s32, s32, 0x12000
    v_mfma_f32_16x16x32_bf16 v[124:127], v[56:59], v[92:95], v[124:127]
    v_mfma_f32_16x16x32_bf16 v[128:131], v[56:59], v[96:99], v[128:131]
    ds_read_b64_tr_b16 v[48:49], v14 offset:9408
    s_waitcnt lgkmcnt(13)
    ds_read_b64_tr_b16 v[50:51], v14 offset:11712
    s_waitcnt lgkmcnt(12)
    v_mfma_f32_16x16x32_bf16 v[100:103], v[28:31], v[68:71], v[100:103]
    v_mfma_f32_16x16x32_bf16 v[104:107], v[28:31], v[72:75], v[104:107]
    ds_read_b64_tr_b16 v[52:53], v14 offset:9440
    ds_read_b64_tr_b16 v[54:55], v14 offset:11744
    s_waitcnt lgkmcnt(12)
    v_mfma_f32_16x16x32_bf16 v[108:111], v[32:35], v[68:71], v[108:111]
    v_mfma_f32_16x16x32_bf16 v[112:115], v[32:35], v[72:75], v[112:115]
    ds_read_b64_tr_b16 v[56:57], v14 offset:9472
    ds_read_b64_tr_b16 v[58:59], v14 offset:11776
    s_waitcnt lgkmcnt(11)
    v_mfma_f32_16x16x32_bf16 v[116:119], v[36:39], v[68:71], v[116:119]
    v_mfma_f32_16x16x32_bf16 v[120:123], v[36:39], v[72:75], v[120:123]
    s_waitcnt vmcnt(10) lgkmcnt(0)
    s_barrier
    ds_read_b128 v[84:87], v15 offset:0
    ds_read_b128 v[88:91], v15 offset:256
    ds_read_b64_tr_b16 v[28:29], v17 offset:160
    ds_read_b64_tr_b16 v[30:31], v17 offset:2464
    s_add_u32 m0, s29, 0x0
    s_nop 0
    buffer_load_dwordx4 v8, s[12:15], s31 offen lds
    v_mfma_f32_16x16x32_bf16 v[124:127], v[40:43], v[68:71], v[124:127]
    v_mfma_f32_16x16x32_bf16 v[128:131], v[40:43], v[72:75], v[128:131]
    ds_read_b64_tr_b16 v[32:33], v17 offset:192
    ds_read_b64_tr_b16 v[34:35], v17 offset:2496
    ds_read_b128 v[92:95], v16 offset:0
    s_add_u32 m0, s29, 0x2000
    s_add_u32 s33, s31, 0x90000
    buffer_load_dwordx4 v8, s[12:15], s33 offen lds
    s_add_u32 s31, s31, 4096
    v_mfma_f32_16x16x32_bf16 v[100:103], v[44:47], v[76:79], v[100:103]
    v_mfma_f32_16x16x32_bf16 v[104:107], v[44:47], v[80:83], v[104:107]
    ds_read_b64_tr_b16 v[36:37], v17 offset:224
    ds_read_b64_tr_b16 v[38:39], v17 offset:2528
    ds_read_b128 v[96:99], v16 offset:256
    s_add_u32 m0, s29, 0x4000
    s_nop 0
    buffer_load_dwordx4 v9, s[16:19], s32 offen lds
    v_mfma_f32_16x16x32_bf16 v[108:111], v[48:51], v[76:79], v[108:111]
    v_mfma_f32_16x16x32_bf16 v[112:115], v[48:51], v[80:83], v[112:115]
    ds_read_b64_tr_b16 v[40:41], v17 offset:256
    ds_read_b64_tr_b16 v[42:43], v17 offset:2560
    s_add_u32 m0, s29, 0x6000
    s_nop 0
    buffer_load_dwordx4 v10, s[16:19], s32 offen lds
    v_mfma_f32_16x16x32_bf16 v[116:119], v[52:55], v[76:79], v[116:119]
    v_mfma_f32_16x16x32_bf16 v[120:123], v[52:55], v[80:83], v[120:123]
    ds_read_b64_tr_b16 v[44:45], v17 offset:9376
    ds_read_b64_tr_b16 v[46:47], v17 offset:11680
    s_add_u32 m0, s30, 0x8000
    s_nop 0
    s_mov_b64 exec, 0xffff
    buffer_load_dwordx4 v11, s[16:19], s32 offen lds
    s_mov_b64 exec, -1
    s_add_u32 s32, s32, 0x12000
    v_mfma_f32_16x16x32_bf16 v[124:127], v[56:59], v[76:79], v[124:127]
    v_mfma_f32_16x16x32_bf16 v[128:131], v[56:59], v[80:83], v[128:131]
    ds_read_b64_tr_b16 v[48:49], v17 offset:9408
    s_waitcnt lgkmcnt(13)
    ds_read_b64_tr_b16 v[50:51], v17 offset:11712
    s_waitcnt lgkmcnt(12)
    v_mfma_f32_16x16x32_bf16 v[100:103], v[28:31], v[84:87], v[100:103]
    v_mfma_f32_16x16x32_bf16 v[104:107], v[28:31], v[88:91], v[104:107]
    ds_read_b64_tr_b16 v[52:53], v17 offset:9440
    ds_read_b64_tr_b16 v[54:55], v17 offset:11744
    s_waitcnt lgkmcnt(12)
    v_mfma_f32_16x16x32_bf16 v[108:111], v[32:35], v[84:87], v[108:111]
    v_mfma_f32_16x16x32_bf16 v[112:115], v[32:35], v[88:91], v[112:115]
    ds_read_b64_tr_b16 v[56:57], v17 offset:9472
    ds_read_b64_tr_b16 v[58:59], v17 offset:11776
    s_waitcnt lgkmcnt(11)
    v_mfma_f32_16x16x32_bf16 v[116:119], v[36:39], v[84:87], v[116:119]
    v_mfma_f32_16x16x32_bf16 v[120:123], v[36:39], v[88:91], v[120:123]
    s_waitcnt vmcnt(10) lgkmcnt(0)
    s_barrier
    ds_read_b128 v[68:71], v18 offset:0
    ds_read_b128 v[72:75], v18 offset:256
    ds_read_b64_tr_b16 v[28:29], v20 offset:160
    ds_read_b64_tr_b16 v[30:31], v20 offset:2464
    s_add_u32 m0, s29, 0x8800
    s_nop 0
    buffer_load_dwordx4 v8, s[12:15], s31 offen lds
    v_mfma_f32_16x16x32_bf16 v[124:127], v[40:43], v[84:87], v[124:127]
    v_mfma_f32_16x16x32_bf16 v[128:131], v[40:43], v[88:91], v[128:131]
    ds_read_b64_tr_b16 v[32:33], v20 offset:192
    ds_read_b64_tr_b16 v[34:35], v20 offset:2496
    ds_read_b128 v[76:79], v19 offset:0
    s_add_u32 m0, s29, 0xa800
    s_add_u32 s33, s31, 0x90000
    buffer_load_dwordx4 v8, s[12:15], s33 offen lds
    s_add_u32 s31, s31, 4096
    v_mfma_f32_16x16x32_bf16 v[100:103], v[44:47], v[92:95], v[100:103]
    v_mfma_f32_16x16x32_bf16 v[104:107], v[44:47], v[96:99], v[104:107]
    ds_read_b64_tr_b16 v[36:37], v20 offset:224
    ds_read_b64_tr_b16 v[38:39], v20 offset:2528
    ds_read_b128 v[80:83], v19 offset:256
    s_add_u32 m0, s29, 0xc800
    s_nop 0
    buffer_load_dwordx4 v9, s[16:19], s32 offen lds
    v_mfma_f32_16x16x32_bf16 v[108:111], v[48:51], v[92:95], v[108:111]
    v_mfma_f32_16x16x32_bf16 v[112:115], v[48:51], v[96:99], v[112:115]
    ds_read_b64_tr_b16 v[40:41], v20 offset:256
    ds_read_b64_tr_b16 v[42:43], v20 offset:2560
    s_add_u32 m0, s29, 0xe800
    s_nop 0
    buffer_load_dwordx4 v10, s[16:19], s32 offen lds
    v_mfma_f32_16x16x32_bf16 v[116:119], v[52:55], v[92:95], v[116:119]
    v_mfma_f32_16x16x32_bf16 v[120:123], v[52:55], v[96:99], v[120:123]
    ds_read_b64_tr_b16 v[44:45], v20 offset:9376
    ds_read_b64_tr_b16 v[46:47], v20 offset:11680
    s_add_u32 m0, s30, 0x10800
    s_nop 0
    s_mov_b64 exec, 0xffff
    buffer_load_dwordx4 v11, s[16:19], s32 offen lds
    s_mov_b64 exec, -1
    s_add_u32 s32, s32, 0x12000
    v_mfma_f32_16x16x32_bf16 v[124:127], v[56:59], v[92:95], v[124:127]
    v_mfma_f32_16x16x32_bf16 v[128:131], v[56:59], v[96:99], v[128:131]
    ds_read_b64_tr_b16 v[48:49], v20 offset:9408
    s_waitcnt lgkmcnt(13)
    ds_read_b64_tr_b16 v[50:51], v20 offset:11712
    s_sub_u32 s40, s40, 1
    s_cmp_lg_u32 s40, 0
    s_cbranch_scc1 LP_rompt_kernel_29
    s_waitcnt lgkmcnt(12)
    v_mfma_f32_16x16x32_bf16 v[100:103], v[28:31], v[68:71], v[100:103]
    v_mfma_f32_16x16x32_bf16 v[104:107], v[28:31], v[72:75], v[104:107]
    ds_read_b64_tr_b16 v[52:53], v20 offset:9440
    ds_read_b64_tr_b16 v[54:55], v20 offset:11744
    s_waitcnt lgkmcnt(12)
    v_mfma_f32_16x16x32_bf16 v[108:111], v[32:35], v[68:71], v[108:111]
    v_mfma_f32_16x16x32_bf16 v[112:115], v[32:35], v[72:75], v[112:115]
    ds_read_b64_tr_b16 v[56:57], v20 offset:9472
    ds_read_b64_tr_b16 v[58:59], v20 offset:11776
    s_waitcnt lgkmcnt(11)
    v_mfma_f32_16x16x32_bf16 v[116:119], v[36:39], v[68:71], v[116:119]
    v_mfma_f32_16x16x32_bf16 v[120:123], v[36:39], v[72:75], v[120:123]
    s_waitcnt vmcnt(10) lgkmcnt(0)
    s_barrier
    ds_read_b128 v[84:87], v21 offset:0
    ds_read_b128 v[88:91], v21 offset:256
    ds_read_b64_tr_b16 v[28:29], v23 offset:160
    ds_read_b64_tr_b16 v[30:31], v23 offset:2464
    v_mfma_f32_16x16x32_bf16 v[124:127], v[40:43], v[68:71], v[124:127]
    v_mfma_f32_16x16x32_bf16 v[128:131], v[40:43], v[72:75], v[128:131]
    ds_read_b64_tr_b16 v[32:33], v23 offset:192
    ds_read_b64_tr_b16 v[34:35], v23 offset:2496
    ds_read_b128 v[92:95], v22 offset:0
    v_mfma_f32_16x16x32_bf16 v[100:103], v[44:47], v[76:79], v[100:103]
    v_mfma_f32_16x16x32_bf16 v[104:107], v[44:47], v[80:83], v[104:107]
    ds_read_b64_tr_b16 v[36:37], v23 offset:224
    ds_read_b64_tr_b16 v[38:39], v23 offset:2528
    ds_read_b128 v[96:99], v22 offset:256
    v_mfma_f32_16x16x32_bf16 v[108:111], v[48:51], v[76:79], v[108:111]
    v_mfma_f32_16x16x32_bf16 v[112:115], v[48:51], v[80:83], v[112:115]
    ds_read_b64_tr_b16 v[40:41], v23 offset:256
    ds_read_b64_tr_b16 v[42:43], v23 offset:2560
    v_mfma_f32_16x16x32_bf16 v[116:119], v[52:55], v[76:79], v[116:119]
    v_mfma_f32_16x16x32_bf16 v[120:123], v[52:55], v[80:83], v[120:123]
    ds_read_b64_tr_b16 v[44:45], v23 offset:9376
    ds_read_b64_tr_b16 v[46:47], v23 offset:11680
    v_mfma_f32_16x16x32_bf16 v[124:127], v[56:59], v[76:79], v[124:127]
    v_mfma_f32_16x16x32_bf16 v[128:131], v[56:59], v[80:83], v[128:131]
    ds_read_b64_tr_b16 v[48:49], v23 offset:9408
    s_waitcnt lgkmcnt(13)
    ds_read_b64_tr_b16 v[50:51], v23 offset:11712
    s_waitcnt lgkmcnt(12)
    v_mfma_f32_16x16x32_bf16 v[100:103], v[28:31], v[84:87], v[100:103]
    v_mfma_f32_16x16x32_bf16 v[104:107], v[28:31], v[88:91], v[104:107]
    ds_read_b64_tr_b16 v[52:53], v23 offset:9440
    ds_read_b64_tr_b16 v[54:55], v23 offset:11744
    s_waitcnt lgkmcnt(12)
    v_mfma_f32_16x16x32_bf16 v[108:111], v[32:35], v[84:87], v[108:111]
    v_mfma_f32_16x16x32_bf16 v[112:115], v[32:35], v[88:91], v[112:115]
    ds_read_b64_tr_b16 v[56:57], v23 offset:9472
    ds_read_b64_tr_b16 v[58:59], v23 offset:11776
    s_waitcnt lgkmcnt(11)
    v_mfma_f32_16x16x32_bf16 v[116:119], v[36:39], v[84:87], v[116:119]
    v_mfma_f32_16x16x32_bf16 v[120:123], v[36:39], v[88:91], v[120:123]
    s_waitcnt vmcnt(5) lgkmcnt(0)
    s_barrier
    ds_read_b128 v[68:71], v12 offset:0
    ds_read_b128 v[72:75], v12 offset:256
    ds_read_b64_tr_b16 v[28:29], v14 offset:160
    ds_read_b64_tr_b16 v[30:31], v14 offset:2464
    v_mfma_f32_16x16x32_bf16 v[124:127], v[40:43], v[84:87], v[124:127]
    v_mfma_f32_16x16x32_bf16 v[128:131], v[40:43], v[88:91], v[128:131]
    ds_read_b64_tr_b16 v[32:33], v14 offset:192
    ds_read_b64_tr_b16 v[34:35], v14 offset:2496
    ds_read_b128 v[76:79], v13 offset:0
    v_mfma_f32_16x16x32_bf16 v[100:103], v[44:47], v[92:95], v[100:103]
    v_mfma_f32_16x16x32_bf16 v[104:107], v[44:47], v[96:99], v[104:107]
    ds_read_b64_tr_b16 v[36:37], v14 offset:224
    ds_read_b64_tr_b16 v[38:39], v14 offset:2528
    ds_read_b128 v[80:83], v13 offset:256
    v_mfma_f32_16x16x32_bf16 v[108:111], v[48:51], v[92:95], v[108:111]
    v_mfma_f32_16x16x32_bf16 v[112:115], v[48:51], v[96:99], v[112:115]
    ds_read_b64_tr_b16 v[40:41], v14 offset:256
    ds_read_b64_tr_b16 v[42:43], v14 offset:2560
    v_mfma_f32_16x16x32_bf16 v[116:119], v[52:55], v[92:95], v[116:119]
    v_mfma_f32_16x16x32_bf16 v[120:123], v[52:55], v[96:99], v[120:123]
    ds_read_b64_tr_b16 v[44:45], v14 offset:9376
    ds_read_b64_tr_b16 v[46:47], v14 offset:11680
    v_mfma_f32_16x16x32_bf16 v[124:127], v[56:59], v[92:95], v[124:127]
    v_mfma_f32_16x16x32_bf16 v[128:131], v[56:59], v[96:99], v[128:131]
    ds_read_b64_tr_b16 v[48:49], v14 offset:9408
    s_waitcnt lgkmcnt(13)
    ds_read_b64_tr_b16 v[50:51], v14 offset:11712
    s_waitcnt lgkmcnt(12)
    v_mfma_f32_16x16x32_bf16 v[100:103], v[28:31], v[68:71], v[100:103]
    v_mfma_f32_16x16x32_bf16 v[104:107], v[28:31], v[72:75], v[104:107]
    ds_read_b64_tr_b16 v[52:53], v14 offset:9440
    ds_read_b64_tr_b16 v[54:55], v14 offset:11744
    s_waitcnt lgkmcnt(12)
    v_mfma_f32_16x16x32_bf16 v[108:111], v[32:35], v[68:71], v[108:111]
    v_mfma_f32_16x16x32_bf16 v[112:115], v[32:35], v[72:75], v[112:115]
    ds_read_b64_tr_b16 v[56:57], v14 offset:9472
    ds_read_b64_tr_b16 v[58:59], v14 offset:11776
    s_waitcnt lgkmcnt(11)
    v_mfma_f32_16x16x32_bf16 v[116:119], v[36:39], v[68:71], v[116:119]
    v_mfma_f32_16x16x32_bf16 v[120:123], v[36:39], v[72:75], v[120:123]
    s_waitcnt vmcnt(0) lgkmcnt(0)
    s_barrier
    ds_read_b128 v[84:87], v15 offset:0
    ds_read_b128 v[88:91], v15 offset:256
    ds_read_b64_tr_b16 v[28:29], v17 offset:160
    ds_read_b64_tr_b16 v[30:31], v17 offset:2464
    v_mfma_f32_16x16x32_bf16 v[124:127], v[40:43], v[68:71], v[124:127]
    v_mfma_f32_16x16x32_bf16 v[128:131], v[40:43], v[72:75], v[128:131]
    ds_read_b64_tr_b16 v[32:33], v17 offset:192
    ds_read_b64_tr_b16 v[34:35], v17 offset:2496
    ds_read_b128 v[92:95], v16 offset:0
    v_mfma_f32_16x16x32_bf16 v[100:103], v[44:47], v[76:79], v[100:103]
    v_mfma_f32_16x16x32_bf16 v[104:107], v[44:47], v[80:83], v[104:107]
    ds_read_b64_tr_b16 v[36:37], v17 offset:224
    ds_read_b64_tr_b16 v[38:39], v17 offset:2528
    ds_read_b128 v[96:99], v16 offset:256
    v_mfma_f32_16x16x32_bf16 v[108:111], v[48:51], v[76:79], v[108:111]
    v_mfma_f32_16x16x32_bf16 v[112:115], v[48:51], v[80:83], v[112:115]
    ds_read_b64_tr_b16 v[40:41], v17 offset:256
    ds_read_b64_tr_b16 v[42:43], v17 offset:2560
    v_mfma_f32_16x16x32_bf16 v[116:119], v[52:55], v[76:79], v[116:119]
    v_mfma_f32_16x16x32_bf16 v[120:123], v[52:55], v[80:83], v[120:123]
    ds_read_b64_tr_b16 v[44:45], v17 offset:9376
    ds_read_b64_tr_b16 v[46:47], v17 offset:11680
    v_mfma_f32_16x16x32_bf16 v[124:127], v[56:59], v[76:79], v[124:127]
    v_mfma_f32_16x16x32_bf16 v[128:131], v[56:59], v[80:83], v[128:131]
    ds_read_b64_tr_b16 v[48:49], v17 offset:9408
    s_waitcnt lgkmcnt(13)
    ds_read_b64_tr_b16 v[50:51], v17 offset:11712
    s_waitcnt lgkmcnt(12)
    v_mfma_f32_16x16x32_bf16 v[100:103], v[28:31], v[84:87], v[100:103]
    v_mfma_f32_16x16x32_bf16 v[104:107], v[28:31], v[88:91], v[104:107]
    ds_read_b64_tr_b16 v[52:53], v17 offset:9440
    ds_read_b64_tr_b16 v[54:55], v17 offset:11744
    s_waitcnt lgkmcnt(12)
    v_mfma_f32_16x16x32_bf16 v[108:111], v[32:35], v[84:87], v[108:111]
    v_mfma_f32_16x16x32_bf16 v[112:115], v[32:35], v[88:91], v[112:115]
    ds_read_b64_tr_b16 v[56:57], v17 offset:9472
    ds_read_b64_tr_b16 v[58:59], v17 offset:11776
    s_waitcnt lgkmcnt(11)
    v_mfma_f32_16x16x32_bf16 v[116:119], v[36:39], v[84:87], v[116:119]
    v_mfma_f32_16x16x32_bf16 v[120:123], v[36:39], v[88:91], v[120:123]
    s_waitcnt lgkmcnt(8)
    v_mfma_f32_16x16x32_bf16 v[124:127], v[40:43], v[84:87], v[124:127]
    v_mfma_f32_16x16x32_bf16 v[128:131], v[40:43], v[88:91], v[128:131]
    s_waitcnt lgkmcnt(6)
    v_mfma_f32_16x16x32_bf16 v[100:103], v[44:47], v[92:95], v[100:103]
    v_mfma_f32_16x16x32_bf16 v[104:107], v[44:47], v[96:99], v[104:107]
    s_waitcnt lgkmcnt(4)
    v_mfma_f32_16x16x32_bf16 v[108:111], v[48:51], v[92:95], v[108:111]
    v_mfma_f32_16x16x32_bf16 v[112:115], v[48:51], v[96:99], v[112:115]
    s_waitcnt lgkmcnt(2)
    v_mfma_f32_16x16x32_bf16 v[116:119], v[52:55], v[92:95], v[116:119]
    v_mfma_f32_16x16x32_bf16 v[120:123], v[52:55], v[96:99], v[120:123]
    s_waitcnt lgkmcnt(0)
    v_mfma_f32_16x16x32_bf16 v[124:127], v[56:59], v[92:95], v[124:127]
    v_mfma_f32_16x16x32_bf16 v[128:131], v[56:59], v[96:99], v[128:131]
    s_nop 7
    s_nop 3
    v_add_u32 v100, 0x10000, v100
    v_and_b32 v100, 0xfffe0000, v100
    v_cvt_pk_bf16_f32 v28, v100, v101
    v_cvt_pk_bf16_f32 v29, v102, v103
    v_and_b32 v28, -2, v28
    v_add_u32 v104, 0x10000, v104
    v_and_b32 v104, 0xfffe0000, v104
    v_cvt_pk_bf16_f32 v30, v104, v105
    v_cvt_pk_bf16_f32 v31, v106, v107
    v_and_b32 v30, -2, v30
    s_mov_b32 s33, 5120
    s_nop 0
    v_permlane16_swap_b32 v28, v30
    v_permlane16_swap_b32 v29, v31
    s_nop 0
    buffer_store_dwordx4 v[28:31], v7, s[24:27], s33 offen offset:0 sc0 sc1
    v_add_u32 v108, 0x10000, v108
    v_and_b32 v108, 0xfffe0000, v108
    v_cvt_pk_bf16_f32 v32, v108, v109
    v_cvt_pk_bf16_f32 v33, v110, v111
    v_and_b32 v32, -2, v32
    v_add_u32 v112, 0x10000, v112
    v_and_b32 v112, 0xfffe0000, v112
    v_cvt_pk_bf16_f32 v34, v112, v113
    v_cvt_pk_bf16_f32 v35, v114, v115
    v_and_b32 v34, -2, v34
    s_nop 0
    s_nop 0
    v_permlane16_swap_b32 v32, v34
    v_permlane16_swap_b32 v33, v35
    s_nop 0
    buffer_store_dwordx4 v[32:35], v7, s[24:27], s33 offen offset:1024 sc0 sc1
    v_add_u32 v116, 0x10000, v116
    v_and_b32 v116, 0xfffe0000, v116
    v_cvt_pk_bf16_f32 v36, v116, v117
    v_cvt_pk_bf16_f32 v37, v118, v119
    v_and_b32 v36, -2, v36
    v_add_u32 v120, 0x10000, v120
    v_and_b32 v120, 0xfffe0000, v120
    v_cvt_pk_bf16_f32 v38, v120, v121
    v_cvt_pk_bf16_f32 v39, v122, v123
    v_and_b32 v38, -2, v38
    s_nop 0
    s_nop 0
    v_permlane16_swap_b32 v36, v38
    v_permlane16_swap_b32 v37, v39
    s_nop 0
    buffer_store_dwordx4 v[36:39], v7, s[24:27], s33 offen offset:2048 sc0 sc1
    v_add_u32 v124, 0x10000, v124
    v_and_b32 v124, 0xfffe0000, v124
    v_cvt_pk_bf16_f32 v40, v124, v125
    v_cvt_pk_bf16_f32 v41, v126, v127
    v_and_b32 v40, -2, v40
    v_add_u32 v128, 0x10000, v128
    v_and_b32 v128, 0xfffe0000, v128
    v_cvt_pk_bf16_f32 v42, v128, v129
    v_cvt_pk_bf16_f32 v43, v130, v131
    v_and_b32 v42, -2, v42
    s_nop 0
    s_nop 0
    v_permlane16_swap_b32 v40, v42
    v_permlane16_swap_b32 v41, v43
    s_nop 0
    buffer_store_dwordx4 v[40:43], v7, s[24:27], s33 offen offset:3072 sc0 sc1
LJ_rompt_kernel_26:
    s_lshl_b32 s39, s36, 2
    s_add_u32 s39, s39, s38
    s_add_u32 s12, s4, 0x400000
    s_addc_u32 s13, s5, 0
    s_mov_b32 s14, 0x240000
    s_and_b32 s13, s13, 0xffff
    s_mov_b32 s15, 0x20000
    s_lshr_b32 s46, s39, 2
    s_lshl_b32 s47, s37, 2
    s_add_u32 s46, s46, s47
    s_mul_i32 s46, s46, 36864
    s_add_u32 s20, s4, 0x1400000
    s_addc_u32 s21, s5, 0
    s_add_u32 s20, s20, s46
    s_addc_u32 s21, s21, 0
    s_sub_u32 s22, 0x900000, s46
    s_and_b32 s21, s21, 0xffff
    s_mov_b32 s23, 0x20000
    s_add_u32 s24, s4, 0x800000
    s_addc_u32 s25, s5, 0
    s_mov_b32 s26, 0x240000
    s_and_b32 s25, s25, 0xffff
    s_mov_b32 s27, 0x20000
    s_add_u32 s52, s4, 0x2000000
    s_addc_u32 s53, s5, 0
    s_mov_b32 s54, 0x240000
    s_and_b32 s53, s53, 0xffff
    s_mov_b32 s55, 0x20000
    s_lshl_b32 s46, s37, 7
    s_lshl_b32 s47, s39, 3
    s_add_u32 s46, s46, s47
    s_add_u32 s46, s46, s28
    v_mov_b32 v2, s46
    v_mul_u32_u24 v4, 1152, v2
    v_lshl_add_u32 v7, v1, 3, v4
    v_lshl_add_u32 v8, v1, 1, v4
    buffer_load_dwordx2 v[10:11], v7, s[12:15], 0 offen
    buffer_load_dwordx2 v[12:13], v7, s[12:15], 0 offen offset:512
    buffer_load_ushort v14, v8, s[12:15], 0 offen offset:1024
    s_lshr_b32 s46, s39, 1
    s_and_b32 s46, s46, 1
    s_lshl_b32 s46, s46, 8
    s_and_b32 s47, s39, 1
    s_lshl_b32 s47, s47, 7
    s_add_u32 s46, s46, s47
    s_mul_i32 s47, s28, 64
    s_add_u32 s47, s47, 0
    v_add_u32 v3, s47, v1
    v_lshrrev_b32 v5, 4, v3
    v_lshlrev_b32 v5, 10, v5
    v_bfe_u32 v6, v3, 3, 1
    v_lshl_add_u32 v5, v6, 9, v5
    v_and_b32 v6, 7, v3
    v_lshl_add_u32 v5, v6, 4, v5
    v_add_u32 v40, s46, v5
    v_mul_u32_u24 v5, 2336, v6
    v_lshrrev_b32 v6, 3, v3
    v_lshl_add_u32 v5, v6, 5, v5
    v_add_u32 v42, 0x22000, v5
    s_mul_i32 s47, s28, 8
    s_add_u32 s47, s47, 512
    v_add_u32 v3, s47, v1
    v_lshrrev_b32 v5, 4, v3
    v_lshlrev_b32 v5, 10, v5
    v_bfe_u32 v6, v3, 3, 1
    v_lshl_add_u32 v5, v6, 9, v5
    v_and_b32 v6, 7, v3
    v_lshl_add_u32 v5, v6, 4, v5
    v_add_u32 v41, s46, v5
    v_mul_u32_u24 v5, 2336, v6
    v_lshrrev_b32 v6, 3, v3
    v_lshl_add_u32 v5, v6, 5, v5
    v_add_u32 v43, 0x22000, v5
    v_mov_b32 v48, 0
    v_mov_b32 v49, 0
    v_mov_b32 v50, 0
    v_mov_b32 v51, 0
    v_mov_b32 v56, 0
    v_mov_b32 v57, 0
    v_mov_b32 v58, 0
    v_mov_b32 v59, 0
    v_mov_b32 v64, 0
    v_mov_b32 v65, 0
    v_mov_b32 v66, 0
    v_mov_b32 v67, 0
    v_mov_b32 v72, 0
    v_mov_b32 v73, 0
    v_mov_b32 v74, 0
    v_mov_b32 v75, 0
    s_mov_b32 s45, 0
LW_rompt_kernel_30:
    s_mov_b32 s47, 0x0
    buffer_load_dwordx4 v[44:47], v40, s[20:23], s47 offen sc0 sc1
    s_mov_b64 exec, 0xff
    buffer_load_dwordx4 v[48:51], v41, s[20:23], s47 offen sc0 sc1
    s_mov_b64 exec, -1
    s_mov_b32 s47, 0x240000
    buffer_load_dwordx4 v[52:55], v40, s[20:23], s47 offen sc0 sc1
    s_mov_b64 exec, 0xff
    buffer_load_dwordx4 v[56:59], v41, s[20:23], s47 offen sc0 sc1
    s_mov_b64 exec, -1
    s_mov_b32 s47, 0x480000
    buffer_load_dwordx4 v[60:63], v40, s[20:23], s47 offen sc0 sc1
    s_mov_b64 exec, 0xff
    buffer_load_dwordx4 v[64:67], v41, s[20:23], s47 offen sc0 sc1
    s_mov_b64 exec, -1
    s_mov_b32 s47, 0x6c0000
    buffer_load_dwordx4 v[68:71], v40, s[20:23], s47 offen sc0 sc1
    s_mov_b64 exec, 0xff
    buffer_load_dwordx4 v[72:75], v41, s[20:23], s47 offen sc0 sc1
    s_mov_b64 exec, -1
    s_waitcnt vmcnt(0)
    v_or_b32 v26, v44, v46
    v_or_b32 v27, v48, v50
    v_or3_b32 v26, v26, v52, v54
    v_or3_b32 v27, v27, v56, v58
    v_or3_b32 v26, v26, v60, v62
    v_or3_b32 v27, v27, v64, v66
    v_or3_b32 v26, v26, v68, v70
    v_or3_b32 v27, v27, v72, v74
    v_or_b32 v26, v26, v27
    v_and_b32 v26, 1, v26
    v_cmp_ne_u32 vcc, 0, v26
    s_nop 3
    s_cmp_eq_u64 vcc, 0
    s_cbranch_scc1 LD_rompt_kernel_31
    s_add_u32 s45, s45, 1
    s_cmp_lt_u32 s45, 0x100000
    s_cbranch_scc1 LW_rompt_kernel_30
LD_rompt_kernel_31:
    v_lshlrev_b32 v76, 16, v44
    v_and_b32 v77, 0xffff0000, v44
    v_lshlrev_b32 v78, 16, v45
    v_and_b32 v79, 0xffff0000, v45
    v_lshlrev_b32 v80, 16, v46
    v_and_b32 v81, 0xffff0000, v46
    v_lshlrev_b32 v82, 16, v47
    v_and_b32 v83, 0xffff0000, v47
    v_lshlrev_b32 v84, 16, v48
    v_and_b32 v85, 0xffff0000, v48
    v_lshlrev_b32 v86, 16, v49
    v_and_b32 v87, 0xffff0000, v49
    v_lshlrev_b32 v88, 16, v50
    v_and_b32 v89, 0xffff0000, v50
    v_lshlrev_b32 v90, 16, v51
    v_and_b32 v91, 0xffff0000, v51
    v_lshlrev_b32 v26, 16, v52
    v_and_b32 v27, 0xffff0000, v52
    v_add_f32 v76, v76, v26
    v_add_f32 v77, v77, v27
    v_lshlrev_b32 v26, 16, v53
    v_and_b32 v27, 0xffff0000, v53
    v_add_f32 v78, v78, v26
    v_add_f32 v79, v79, v27
    v_lshlrev_b32 v26, 16, v54
    v_and_b32 v27, 0xffff0000, v54
    v_add_f32 v80, v80, v26
    v_add_f32 v81, v81, v27
    v_lshlrev_b32 v26, 16, v55
    v_and_b32 v27, 0xffff0000, v55
    v_add_f32 v82, v82, v26
    v_add_f32 v83, v83, v27
    v_lshlrev_b32 v26, 16, v56
    v_and_b32 v27, 0xffff0000, v56
    v_add_f32 v84, v84, v26
    v_add_f32 v85, v85, v27
    v_lshlrev_b32 v26, 16, v57
    v_and_b32 v27, 0xffff0000, v57
    v_add_f32 v86, v86, v26
    v_add_f32 v87, v87, v27
    v_lshlrev_b32 v26, 16, v58
    v_and_b32 v27, 0xffff0000, v58
    v_add_f32 v88, v88, v26
    v_add_f32 v89, v89, v27
    v_lshlrev_b32 v26, 16, v59
    v_and_b32 v27, 0xffff0000, v59
    v_add_f32 v90, v90, v26
    v_add_f32 v91, v91, v27
    v_lshlrev_b32 v26, 16, v60
    v_and_b32 v27, 0xffff0000, v60
    v_add_f32 v76, v76, v26
    v_add_f32 v77, v77, v27
    v_lshlrev_b32 v26, 16, v61
    v_and_b32 v27, 0xffff0000, v61
    v_add_f32 v78, v78, v26
    v_add_f32 v79, v79, v27
    v_lshlrev_b32 v26, 16, v62
    v_and_b32 v27, 0xffff0000, v62
    v_add_f32 v80, v80, v26
    v_add_f32 v81, v81, v27
    v_lshlrev_b32 v26, 16, v63
    v_and_b32 v27, 0xffff0000, v63
    v_add_f32 v82, v82, v26
    v_add_f32 v83, v83, v27
    v_lshlrev_b32 v26, 16, v64
    v_and_b32 v27, 0xffff0000, v64
    v_add_f32 v84, v84, v26
    v_add_f32 v85, v85, v27
    v_lshlrev_b32 v26, 16, v65
    v_and_b32 v27, 0xffff0000, v65
    v_add_f32 v86, v86, v26
    v_add_f32 v87, v87, v27
    v_lshlrev_b32 v26, 16, v66
    v_and_b32 v27, 0xffff0000, v66
    v_add_f32 v88, v88, v26
    v_add_f32 v89, v89, v27
    v_lshlrev_b32 v26, 16, v67
    v_and_b32 v27, 0xffff0000, v67
    v_add_f32 v90, v90, v26
    v_add_f32 v91, v91, v27
    v_lshlrev_b32 v26, 16, v68
    v_and_b32 v27, 0xffff0000, v68
    v_add_f32 v76, v76, v26
    v_add_f32 v77, v77, v27
    v_lshlrev_b32 v26, 16, v69
    v_and_b32 v27, 0xffff0000, v69
    v_add_f32 v78, v78, v26
    v_add_f32 v79, v79, v27
    v_lshlrev_b32 v26, 16, v70
    v_and_b32 v27, 0xffff0000, v70
    v_add_f32 v80, v80, v26
    v_add_f32 v81, v81, v27
    v_lshlrev_b32 v26, 16, v71
    v_and_b32 v27, 0xffff0000, v71
    v_add_f32 v82, v82, v26
    v_add_f32 v83, v83, v27
    v_lshlrev_b32 v26, 16, v72
    v_and_b32 v27, 0xffff0000, v72
    v_add_f32 v84, v84, v26
    v_add_f32 v85, v85, v27
    v_lshlrev_b32 v26, 16, v73
    v_and_b32 v27, 0xffff0000, v73
    v_add_f32 v86, v86, v26
    v_add_f32 v87, v87, v27
    v_lshlrev_b32 v26, 16, v74
    v_and_b32 v27, 0xffff0000, v74
    v_add_f32 v88, v88, v26
    v_add_f32 v89, v89, v27
    v_lshlrev_b32 v26, 16, v75
    v_and_b32 v27, 0xffff0000, v75
    v_add_f32 v90, v90, v26
    v_add_f32 v91, v91, v27
    ds_write_b128 v42, v[76:79]
    ds_write_b128 v42, v[80:83] offset:16
    s_mov_b64 exec, 0xff
    ds_write_b128 v43, v[84:87]
    ds_write_b128 v43, v[88:91] offset:16
    s_mov_b64 exec, -1
    s_mul_i32 s47, s28, 2336
    s_add_u32 s47, s47, 0x22000
    v_lshl_add_u32 v5, v1, 4, s47
    v_lshl_add_u32 v6, v1, 2, s47
    s_waitcnt lgkmcnt(0)
    s_barrier
    ds_read_b128 v[16:19], v5
    ds_read_b128 v[20:23], v5 offset:1024
    ds_read_b32 v24, v6 offset:2048
    s_waitcnt lgkmcnt(0)
    v_lshlrev_b32 v30, 16, v10
    v_and_b32 v31, 0xffff0000, v10
    v_lshlrev_b32 v32, 16, v11
    v_and_b32 v33, 0xffff0000, v11
    v_lshlrev_b32 v34, 16, v12
    v_and_b32 v35, 0xffff0000, v12
    v_lshlrev_b32 v36, 16, v13
    v_and_b32 v37, 0xffff0000, v13
    v_lshlrev_b32 v38, 16, v14
    v_add_f32 v30, v30, v16
    v_add_f32 v31, v31, v17
    v_add_f32 v32, v32, v18
    v_add_f32 v33, v33, v19
    v_add_f32 v34, v34, v20
    v_add_f32 v35, v35, v21
    v_add_f32 v36, v36, v22
    v_add_f32 v37, v37, v23
    v_add_f32 v38, v38, v24
    v_cvt_pk_bf16_f32 v10, v30, v31
    v_cvt_pk_bf16_f32 v11, v32, v33
    v_cvt_pk_bf16_f32 v12, v34, v35
    v_cvt_pk_bf16_f32 v13, v36, v37
    v_cvt_pk_bf16_f32 v14, v38, v38
    buffer_store_dwordx2 v[10:11], v7, s[24:27], 0 offen sc0 sc1
    buffer_store_dwordx2 v[12:13], v7, s[24:27], 0 offen offset:512 sc0 sc1
    buffer_store_short v14, v8, s[24:27], 0 offen offset:1024 sc0 sc1
    v_lshlrev_b32 v30, 16, v10
    v_and_b32 v31, 0xffff0000, v10
    v_lshlrev_b32 v32, 16, v11
    v_and_b32 v33, 0xffff0000, v11
    v_lshlrev_b32 v34, 16, v12
    v_and_b32 v35, 0xffff0000, v12
    v_lshlrev_b32 v36, 16, v13
    v_and_b32 v37, 0xffff0000, v13
    v_lshlrev_b32 v38, 16, v14
    v_add_f32 v20, v30, v31
    v_add_f32 v21, v32, v33
    v_add_f32 v22, v34, v35
    v_add_f32 v23, v36, v37
    v_add_f32 v20, v20, v21
    v_add_f32 v22, v22, v23
    v_add_f32 v20, v20, v38
    v_add_f32 v20, v20, v22
    s_nop 1
    v_add_f32_dpp v20, v20, v20 quad_perm:[1,0,3,2] row_mask:0xf bank_mask:0xf
    s_nop 1
    v_add_f32_dpp v20, v20, v20 quad_perm:[2,3,0,1] row_mask:0xf bank_mask:0xf
    s_nop 1
    v_add_f32_dpp v20, v20, v20 row_half_mirror row_mask:0xf bank_mask:0xf
    s_nop 1
    v_add_f32_dpp v20, v20, v20 row_mirror row_mask:0xf bank_mask:0xf
    s_nop 1
    v_readlane_b32 s32, v20, 0
    v_readlane_b32 s33, v20, 16
    v_readlane_b32 s34, v20, 32
    v_readlane_b32 s35, v20, 48
    s_nop 1
    v_mov_b32 v20, s32
    v_add_f32 v20, s33, v20
    v_add_f32 v20, s34, v20
    v_add_f32 v20, s35, v20
    v_mul_f32 v20, 0x3ae38e39, v20
    v_cvt_pk_bf16_f32 v23, v20, v20
    v_lshlrev_b32 v23, 16, v23
    v_sub_f32 v20, v20, v23
    v_sub_f32 v30, v30, v23
    v_sub_f32 v31, v31, v23
    v_sub_f32 v32, v32, v23
    v_sub_f32 v33, v33, v23
    v_sub_f32 v34, v34, v23
    v_sub_f32 v35, v35, v23
    v_sub_f32 v36, v36, v23
    v_sub_f32 v37, v37, v23
    v_sub_f32 v38, v38, v23
    v_mul_f32 v21, v30, v30
    v_mul_f32 v22, v31, v31
    v_fmac_f32 v21, v32, v32
    v_fmac_f32 v22, v33, v33
    v_fmac_f32 v21, v34, v34
    v_fmac_f32 v22, v35, v35
    v_fmac_f32 v21, v36, v36
    v_fmac_f32 v22, v37, v37
    v_fmac_f32 v21, v38, v38
    v_add_f32 v21, v21, v22
    s_nop 1
    v_add_f32_dpp v21, v21, v21 quad_perm:[1,0,3,2] row_mask:0xf bank_mask:0xf
    s_nop 1
    v_add_f32_dpp v21, v21, v21 quad_perm:[2,3,0,1] row_mask:0xf bank_mask:0xf
    s_nop 1
    v_add_f32_dpp v21, v21, v21 row_half_mirror row_mask:0xf bank_mask:0xf
    s_nop 1
    v_add_f32_dpp v21, v21, v21 row_mirror row_mask:0xf bank_mask:0xf
    s_nop 1
    v_readlane_b32 s32, v21, 0
    v_readlane_b32 s33, v21, 16
    v_readlane_b32 s34, v21, 32
    v_readlane_b32 s35, v21, 48
    s_nop 1
    v_mov_b32 v21, s32
    v_add_f32 v21, s33, v21
    v_add_f32 v21, s34, v21
    v_add_f32 v21, s35, v21
    v_mul_f32 v21, 0x3ae38e39, v21
    v_fma_f32 v21, -v20, v20, v21
    v_max_f32 v21, 0, v21
    v_cvt_pk_bf16_f32 v22, v21, v21
    v_lshlrev_b32 v22, 16, v22
    v_add_f32 v22, 0x3727c5ac, v22
    v_cvt_pk_bf16_f32 v22, v22, v22
    v_lshlrev_b32 v22, 16, v22
    v_sqrt_f32 v22, v22
    v_cvt_pk_bf16_f32 v24, v30, v31
    v_cvt_pk_bf16_f32 v25, v32, v33
    v_cvt_pk_bf16_f32 v26, v34, v35
    v_cvt_pk_bf16_f32 v27, v36, v37
    v_cvt_pk_bf16_f32 v28, v38, v38
    v_cvt_pk_bf16_f32 v22, v22, v22
    v_lshlrev_b32 v22, 16, v22
    v_rcp_f32 v22, v22
    v_lshlrev_b32 v30, 16, v24
    v_and_b32 v31, 0xffff0000, v24
    v_lshlrev_b32 v32, 16, v25
    v_and_b32 v33, 0xffff0000, v25
    v_lshlrev_b32 v34, 16, v26
    v_and_b32 v35, 0xffff0000, v26
    v_lshlrev_b32 v36, 16, v27
    v_and_b32 v37, 0xffff0000, v27
    v_lshlrev_b32 v38, 16, v28
    v_mul_f32 v30, v30, v22
    v_mul_f32 v31, v31, v22
    v_mul_f32 v32, v32, v22
    v_mul_f32 v33, v33, v22
    v_mul_f32 v34, v34, v22
    v_mul_f32 v35, v35, v22
    v_mul_f32 v36, v36, v22
    v_mul_f32 v37, v37, v22
    v_mul_f32 v38, v38, v22
    v_cvt_pk_bf16_f32 v24, v30, v31
    v_cvt_pk_bf16_f32 v25, v32, v33
    v_cvt_pk_bf16_f32 v26, v34, v35
    v_cvt_pk_bf16_f32 v27, v36, v37
    v_cvt_pk_bf16_f32 v28, v38, v38
    buffer_store_dwordx2 v[24:25], v7, s[52:55], 0 offen sc0 sc1
    buffer_store_dwordx2 v[26:27], v7, s[52:55], 0 offen offset:512 sc0 sc1
    buffer_store_short v28, v8, s[52:55], 0 offen offset:1024 sc0 sc1
    s_lshl_b32 s44, s37, 4
    s_add_u32 s44, s44, s39
    s_waitcnt vmcnt(0)
    s_barrier
    s_cmp_lg_u32 s28, 0
    s_cbranch_scc1 LPB_rompt_kernel_32
    s_add_u32 s72, s4, 0x1200c00
    s_addc_u32 s73, s5, 0
    s_mov_b32 s74, 0x1400
    s_and_b32 s73, s73, 0xffff
    s_mov_b32 s75, 0x20000
    s_mov_b64 exec, 1
    s_lshl_b32 s46, s44, 2
    v_mov_b32 v2, s46
    v_mov_b32 v3, 1
    buffer_store_dword v3, v2, s[72:75], 0 offen sc0 sc1
    s_mov_b64 exec, -1
LPB_rompt_kernel_32:
    s_load_dwordx2 s[4:5], s[0:1], 88
    s_load_dwordx2 s[8:9], s[0:1], 24
    s_load_dwordx2 s[10:11], s[0:1], 32
    v_and_b32 v1, 63, v0
    v_lshrrev_b32 v2, 6, v0
    s_nop 0
    v_readfirstlane_b32 s28, v2
    s_and_b32 s34, s2, 7
    s_lshr_b32 s35, s2, 3
    s_mov_b32 s38, s34
    s_mov_b32 s37, s35
    s_lshl_b32 s29, s28, 10
    s_lshl_b32 s30, s28, 8
    v_lshrrev_b32 v2, 3, v1
    s_lshl_b32 s33, s28, 3
    v_add_u32 v2, s33, v2
    v_bfe_u32 v3, v2, 1, 3
    v_and_b32 v4, 7, v1
    v_xor_b32 v3, v3, v4
    v_mul_u32_u24 v8, 1152, v2
    v_lshl_add_u32 v8, v3, 4, v8
    v_mul_u32_u24 v9, 1152, v2
    v_lshl_add_u32 v9, v3, 4, v9
    v_lshrrev_b32 v2, 3, v1
    s_lshl_b32 s33, s28, 1
    s_add_u32 s33, s33, 128
    v_add_u32 v2, s33, v2
    v_bfe_u32 v3, v2, 1, 3
    v_xor_b32 v3, v3, v4
    v_mul_u32_u24 v11, 1152, v2
    v_lshl_add_u32 v11, v3, 4, v11
    s_mov_b32 s31, 0
    s_mov_b32 s32, 0
    s_waitcnt lgkmcnt(0)
    s_mul_i32 s44, s37, 73728
    s_add_u32 s12, s4, 0x2000000
    s_addc_u32 s13, s5, 0
    s_add_u32 s12, s12, s44
    s_addc_u32 s13, s13, 0
    s_sub_u32 s14, 0x240000, s44
    s_and_b32 s13, s13, 0xffff
    s_mov_b32 s15, 0x20000
    s_cmp_lt_u32 s38, 4
    s_cselect_b32 s6, s8, s10
    s_cselect_b32 s7, s9, s11
    s_and_b32 s45, s38, 3
    s_mul_i32 s44, s45, 165888
    s_add_u32 s16, s6, 0x0
    s_addc_u32 s17, s7, 0
    s_add_u32 s16, s16, s44
    s_addc_u32 s17, s17, 0
    s_sub_u32 s18, 0xa2000, s44
    s_and_b32 s17, s17, 0xffff
    s_mov_b32 s19, 0x20000
    s_add_u32 m0, s29, 0x2000
    s_nop 0
    buffer_load_dwordx4 v9, s[16:19], s32 offen lds
    s_add_u32 m0, s29, 0x4000
    s_add_u32 s33, s32, 0x12000
    buffer_load_dwordx4 v9, s[16:19], s33 offen lds
    s_add_u32 m0, s30, 0x6000
    s_nop 0
    s_mov_b64 exec, 0xffff
    buffer_load_dwordx4 v11, s[16:19], s32 offen lds
    s_mov_b64 exec, -1
    s_add_u32 s32, s32, 0x80
    s_add_u32 m0, s29, 0x8800
    s_nop 0
    buffer_load_dwordx4 v9, s[16:19], s32 offen lds
    s_add_u32 m0, s29, 0xa800
    s_add_u32 s33, s32, 0x12000
    buffer_load_dwordx4 v9, s[16:19], s33 offen lds
    s_add_u32 m0, s30, 0xc800
    s_nop 0
    s_mov_b64 exec, 0xffff
    buffer_load_dwordx4 v11, s[16:19], s32 offen lds
    s_mov_b64 exec, -1
    s_add_u32 s32, s32, 0x80
    s_add_u32 m0, s29, 0xf000
    s_nop 0
    buffer_load_dwordx4 v9, s[16:19], s32 offen lds
    s_add_u32 m0, s29, 0x11000
    s_add_u32 s33, s32, 0x12000
    buffer_load_dwordx4 v9, s[16:19], s33 offen lds
    s_add_u32 m0, s30, 0x13000
    s_nop 0
    s_mov_b64 exec, 0xffff
    buffer_load_dwordx4 v11, s[16:19], s32 offen lds
    s_mov_b64 exec, -1
    s_add_u32 s32, s32, 0x80
    s_add_u32 m0, s29, 0x15800
    s_nop 0
    buffer_load_dwordx4 v9, s[16:19], s32 offen lds
    s_add_u32 m0, s29, 0x17800
    s_add_u32 s33, s32, 0x12000
    buffer_load_dwordx4 v9, s[16:19], s33 offen lds
    s_add_u32 m0, s30, 0x19800
    s_nop 0
    s_mov_b64 exec, 0xffff
    buffer_load_dwordx4 v11, s[16:19], s32 offen lds
    s_mov_b64 exec, -1
    s_add_u32 s32, s32, 0x80
    s_lshl_b32 s44, s37, 3
    v_add_u32 v2, s44, v1
    s_cmp_lg_u32 s28, 0
    s_cbranch_scc1 LFS_rompt_kernel_33
    s_add_u32 s72, s4, 0x1200c00
    s_addc_u32 s73, s5, 0
    s_mov_b32 s74, 0x1400
    s_and_b32 s73, s73, 0xffff
    s_mov_b32 s75, 0x20000
    v_lshlrev_b32 v2, 2, v2
    s_mov_b64 exec, 0xff
    s_mov_b32 s45, 0
LFW_rompt_kernel_34:
    buffer_load_dword v3, v2, s[72:75], 0 offen sc0 sc1
    s_waitcnt vmcnt(0)
    v_cmp_ne_u32 vcc, 1, v3
    s_nop 3
    s_cmp_eq_u64 vcc, 0
    s_cbranch_scc1 LFD_rompt_kernel_35
    s_add_u32 s45, s45, 1
    s_cmp_lt_u32 s45, 0x100000
    s_cbranch_scc1 LFW_rompt_kernel_34
LFD_rompt_kernel_35:
    s_mov_b64 exec, -1
LFS_rompt_kernel_33:
    s_barrier
    s_add_u32 m0, s29, 0x0
    s_nop 0
    buffer_load_dwordx4 v8, s[12:15], s31 offen lds
    s_add_u32 s31, s31, 128
    s_add_u32 m0, s29, 0x6800
    s_nop 0
    buffer_load_dwordx4 v8, s[12:15], s31 offen lds
    s_add_u32 s31, s31, 128
    s_add_u32 m0, s29, 0xd000
    s_nop 0
    buffer_load_dwordx4 v8, s[12:15], s31 offen lds
    s_add_u32 s31, s31, 128
    s_add_u32 m0, s29, 0x13800
    s_nop 0
    buffer_load_dwordx4 v8, s[12:15], s31 offen lds
    s_add_u32 s31, s31, 128
    s_and_b32 s33, s28, 3
    s_mul_i32 s33, s33, 2048
    v_and_b32 v2, 15, v1
    v_lshrrev_b32 v3, 4, v1
    v_bfe_u32 v4, v1, 1, 3
    v_xor_b32 v4, v3, v4
    v_lshlrev_b32 v4, 4, v4
    v_lshl_add_u32 v4, v2, 7, v4
    v_add_u32 v5, s33, v4
    v_add_u32 v12, 0x0, v5
    v_xor_b32 v13, 64, v12
    v_add_u32 v16, 0x6800, v5
    v_xor_b32 v17, 64, v16
    v_add_u32 v20, 0xd000, v5
    v_xor_b32 v21, 64, v20
    v_add_u32 v24, 0x13800, v5
    v_xor_b32 v25, 64, v24
    v_add_u32 v14, 0x2000, v4
    v_xor_b32 v15, 64, v14
    v_add_u32 v18, 0x8800, v4
    v_xor_b32 v19, 64, v18
    v_add_u32 v22, 0xf000, v4
    v_xor_b32 v23, 64, v22
    v_add_u32 v26, 0x15800, v4
    v_xor_b32 v27, 64, v26
    s_and_b32 s33, s28, 3
    s_mul_i32 s33, s33, 16
    v_and_b32 v5, 15, v1
    v_add_u32 v5, s33, v5
    v_lshrrev_b32 v6, 4, v1
    v_mul_u32_u24 v5, 288, v5
    v_and_b32 v2, 1, v6
    v_lshl_add_u32 v7, v2, 5, v5
    v_lshrrev_b32 v2, 1, v6
    v_lshl_add_u32 v7, v2, 4, v7
    v_lshl_add_u32 v6, v6, 3, v5
    s_lshr_b32 s45, s38, 2
    s_lshl_b32 s44, s38, 5
    s_add_u32 s44, s44, s37
    s_mul_i32 s44, s44, 18432
    s_add_u32 s24, s4, 0x5800000
    s_addc_u32 s25, s5, 0
    s_add_u32 s24, s24, s44
    s_addc_u32 s25, s25, 0
    s_sub_u32 s26, 0x480000, s44
    s_and_b32 s25, s25, 0xffff
    s_mov_b32 s27, 0x20000
    s_mov_b32 s26, 18432
    s_mul_i32 s47, s45, 0x80008000
    s_waitcnt vmcnt(3)
    s_barrier
    s_cmp_ge_u32 s28, 4
    s_cbranch_scc1 LG_rompt_kernel_37
    ds_read_b128 v[72:75], v12 offset:0
    ds_read_b128 v[32:35], v14 offset:0
    ds_read_b128 v[36:39], v14 offset:2048
    ds_read_b128 v[40:43], v14 offset:4096
    ds_read_b128 v[44:47], v14 offset:6144
    ds_read_b128 v[48:51], v14 offset:8192
    ds_read_b128 v[76:79], v13 offset:0
    ds_read_b128 v[52:55], v15 offset:0
    ds_read_b128 v[56:59], v15 offset:2048
    ds_read_b128 v[60:63], v15 offset:4096
    s_waitcnt lgkmcnt(8)
    v_mfma_f32_16x16x32_bf16 v[88:91], v[32:35], v[72:75], 0
    ds_read_b128 v[64:67], v15 offset:6144
    s_waitcnt lgkmcnt(8)
    v_mfma_f32_16x16x32_bf16 v[92:95], v[36:39], v[72:75], 0
    ds_read_b128 v[68:71], v15 offset:8192
    s_waitcnt lgkmcnt(8)
    v_mfma_f32_16x16x32_bf16 v[96:99], v[40:43], v[72:75], 0
    s_waitcnt vmcnt(2) lgkmcnt(0)
    s_barrier
    ds_read_b128 v[80:83], v16 offset:0
    ds_read_b128 v[32:35], v18 offset:0
    s_add_u32 m0, s29, 0x0
    s_nop 0
    buffer_load_dwordx4 v8, s[12:15], s31 offen lds
    s_add_u32 s31, s31, 128
    v_mfma_f32_16x16x32_bf16 v[100:103], v[44:47], v[72:75], 0
    ds_read_b128 v[36:39], v18 offset:2048
    ds_read_b128 v[84:87], v17 offset:0
    s_add_u32 m0, s29, 0x2000
    s_nop 0
    buffer_load_dwordx4 v9, s[16:19], s32 offen lds
    v_mfma_f32_16x16x32_bf16 v[104:107], v[48:51], v[72:75], 0
    ds_read_b128 v[40:43], v18 offset:4096
    s_add_u32 m0, s29, 0x4000
    s_add_u32 s33, s32, 0x12000
    buffer_load_dwordx4 v9, s[16:19], s33 offen lds
    v_mfma_f32_16x16x32_bf16 v[88:91], v[52:55], v[76:79], v[88:91]
    ds_read_b128 v[44:47], v18 offset:6144
    s_add_u32 m0, s30, 0x6000
    s_nop 0
    s_mov_b64 exec, 0xffff
    buffer_load_dwordx4 v11, s[16:19], s32 offen lds
    s_mov_b64 exec, -1
    s_add_u32 s32, s32, 0x80
    v_mfma_f32_16x16x32_bf16 v[92:95], v[56:59], v[76:79], v[92:95]
    ds_read_b128 v[48:51], v18 offset:8192
    v_mfma_f32_16x16x32_bf16 v[96:99], v[60:63], v[76:79], v[96:99]
    ds_read_b128 v[52:55], v19 offset:0
    v_mfma_f32_16x16x32_bf16 v[100:103], v[64:67], v[76:79], v[100:103]
    ds_read_b128 v[56:59], v19 offset:2048
    v_mfma_f32_16x16x32_bf16 v[104:107], v[68:71], v[76:79], v[104:107]
    ds_read_b128 v[60:63], v19 offset:4096
    s_waitcnt lgkmcnt(8)
    v_mfma_f32_16x16x32_bf16 v[88:91], v[32:35], v[80:83], v[88:91]
    ds_read_b128 v[64:67], v19 offset:6144
    s_waitcnt lgkmcnt(8)
    v_mfma_f32_16x16x32_bf16 v[92:95], v[36:39], v[80:83], v[92:95]
    ds_read_b128 v[68:71], v19 offset:8192
    s_waitcnt lgkmcnt(7)
    v_mfma_f32_16x16x32_bf16 v[96:99], v[40:43], v[80:83], v[96:99]
    s_waitcnt vmcnt(5) lgkmcnt(0)
    s_barrier
    ds_read_b128 v[72:75], v20 offset:0
    ds_read_b128 v[32:35], v22 offset:0
    s_add_u32 m0, s29, 0x6800
    s_nop 0
    buffer_load_dwordx4 v8, s[12:15], s31 offen lds
    s_add_u32 s31, s31, 128
    v_mfma_f32_16x16x32_bf16 v[100:103], v[44:47], v[80:83], v[100:103]
    ds_read_b128 v[36:39], v22 offset:2048
    ds_read_b128 v[76:79], v21 offset:0
    s_add_u32 m0, s29, 0x8800
    s_nop 0
    buffer_load_dwordx4 v9, s[16:19], s32 offen lds
    v_mfma_f32_16x16x32_bf16 v[104:107], v[48:51], v[80:83], v[104:107]
    ds_read_b128 v[40:43], v22 offset:4096
    s_add_u32 m0, s29, 0xa800
    s_add_u32 s33, s32, 0x12000
    buffer_load_dwordx4 v9, s[16:19], s33 offen lds
    v_mfma_f32_16x16x32_bf16 v[88:91], v[52:55], v[84:87], v[88:91]
    ds_read_b128 v[44:47], v22 offset:6144
    s_add_u32 m0, s30, 0xc800
    s_nop 0
    s_mov_b64 exec, 0xffff
    buffer_load_dwordx4 v11, s[16:19], s32 offen lds
    s_mov_b64 exec, -1
    s_add_u32 s32, s32, 0x80
    v_mfma_f32_16x16x32_bf16 v[92:95], v[56:59], v[84:87], v[92:95]
    ds_read_b128 v[48:51], v22 offset:8192
    v_mfma_f32_16x16x32_bf16 v[96:99], v[60:63], v[84:87], v[96:99]
    ds_read_b128 v[52:55], v23 offset:0
    v_mfma_f32_16x16x32_bf16 v[100:103], v[64:67], v[84:87], v[100:103]
    ds_read_b128 v[56:59], v23 offset:2048
    v_mfma_f32_16x16x32_bf16 v[104:107], v[68:71], v[84:87], v[104:107]
    ds_read_b128 v[60:63], v23 offset:4096
    s_waitcnt lgkmcnt(8)
    v_mfma_f32_16x16x32_bf16 v[88:91], v[32:35], v[72:75], v[88:91]
    ds_read_b128 v[64:67], v23 offset:6144
    s_waitcnt lgkmcnt(8)
    v_mfma_f32_16x16x32_bf16 v[92:95], v[36:39], v[72:75], v[92:95]
    ds_read_b128 v[68:71], v23 offset:8192
    s_waitcnt lgkmcnt(7)
    v_mfma_f32_16x16x32_bf16 v[96:99], v[40:43], v[72:75], v[96:99]
    s_waitcnt vmcnt(8) lgkmcnt(0)
    s_barrier
    ds_read_b128 v[80:83], v24 offset:0
    ds_read_b128 v[32:35], v26 offset:0
    s_add_u32 m0, s29, 0xd000
    s_nop 0
    buffer_load_dwordx4 v8, s[12:15], s31 offen lds
    s_add_u32 s31, s31, 128
    v_mfma_f32_16x16x32_bf16 v[100:103], v[44:47], v[72:75], v[100:103]
    ds_read_b128 v[36:39], v26 offset:2048
    ds_read_b128 v[84:87], v25 offset:0
    s_add_u32 m0, s29, 0xf000
    s_nop 0
    buffer_load_dwordx4 v9, s[16:19], s32 offen lds
    v_mfma_f32_16x16x32_bf16 v[104:107], v[48:51], v[72:75], v[104:107]
    ds_read_b128 v[40:43], v26 offset:4096
    s_add_u32 m0, s29, 0x11000
    s_add_u32 s33, s32, 0x12000
    buffer_load_dwordx4 v9, s[16:19], s33 offen lds
    v_mfma_f32_16x16x32_bf16 v[88:91], v[52:55], v[76:79], v[88:91]
    ds_read_b128 v[44:47], v26 offset:6144
    s_add_u32 m0, s30, 0x13000
    s_nop 0
    s_mov_b64 exec, 0xffff
    buffer_load_dwordx4 v11, s[16:19], s32 offen lds
    s_mov_b64 exec, -1
    s_add_u32 s32, s32, 0x80
    v_mfma_f32_16x16x32_bf16 v[92:95], v[56:59], v[76:79], v[92:95]
    ds_read_b128 v[48:51], v26 offset:8192
    v_mfma_f32_16x16x32_bf16 v[96:99], v[60:63], v[76:79], v[96:99]
    ds_read_b128 v[52:55], v27 offset:0
    v_mfma_f32_16x16x32_bf16 v[100:103], v[64:67], v[76:79], v[100:103]
    ds_read_b128 v[56:59], v27 offset:2048
    v_mfma_f32_16x16x32_bf16 v[104:107], v[68:71], v[76:79], v[104:107]
    ds_read_b128 v[60:63], v27 offset:4096
    s_waitcnt lgkmcnt(8)
    v_mfma_f32_16x16x32_bf16 v[88:91], v[32:35], v[80:83], v[88:91]
    ds_read_b128 v[64:67], v27 offset:6144
    s_waitcnt lgkmcnt(8)
    v_mfma_f32_16x16x32_bf16 v[92:95], v[36:39], v[80:83], v[92:95]
    ds_read_b128 v[68:71], v27 offset:8192
    s_waitcnt lgkmcnt(7)
    v_mfma_f32_16x16x32_bf16 v[96:99], v[40:43], v[80:83], v[96:99]
    s_waitcnt vmcnt(8) lgkmcnt(0)
    s_barrier
    ds_read_b128 v[72:75], v12 offset:0
    ds_read_b128 v[32:35], v14 offset:0
    s_add_u32 m0, s29, 0x13800
    s_nop 0
    buffer_load_dwordx4 v8, s[12:15], s31 offen lds
    s_add_u32 s31, s31, 128
    v_mfma_f32_16x16x32_bf16 v[100:103], v[44:47], v[80:83], v[100:103]
    ds_read_b128 v[36:39], v14 offset:2048
    ds_read_b128 v[76:79], v13 offset:0
    s_add_u32 m0, s29, 0x15800
    s_nop 0
    buffer_load_dwordx4 v9, s[16:19], s32 offen lds
    v_mfma_f32_16x16x32_bf16 v[104:107], v[48:51], v[80:83], v[104:107]
    ds_read_b128 v[40:43], v14 offset:4096
    s_add_u32 m0, s29, 0x17800
    s_add_u32 s33, s32, 0x12000
    buffer_load_dwordx4 v9, s[16:19], s33 offen lds
    v_mfma_f32_16x16x32_bf16 v[88:91], v[52:55], v[84:87], v[88:91]
    ds_read_b128 v[44:47], v14 offset:6144
    s_add_u32 m0, s30, 0x19800
    s_nop 0
    s_mov_b64 exec, 0xffff
    buffer_load_dwordx4 v11, s[16:19], s32 offen lds
    s_mov_b64 exec, -1
    s_add_u32 s32, s32, 0x80
    v_mfma_f32_16x16x32_bf16 v[92:95], v[56:59], v[84:87], v[92:95]
    ds_read_b128 v[48:51], v14 offset:8192
    v_mfma_f32_16x16x32_bf16 v[96:99], v[60:63], v[84:87], v[96:99]
    ds_read_b128 v[52:55], v15 offset:0
    v_mfma_f32_16x16x32_bf16 v[100:103], v[64:67], v[84:87], v[100:103]
    ds_read_b128 v[56:59], v15 offset:2048
    v_mfma_f32_16x16x32_bf16 v[104:107], v[68:71], v[84:87], v[104:107]
    ds_read_b128 v[60:63], v15 offset:4096
    s_waitcnt lgkmcnt(8)
    v_mfma_f32_16x16x32_bf16 v[88:91], v[32:35], v[72:75], v[88:91]
    ds_read_b128 v[64:67], v15 offset:6144
    s_waitcnt lgkmcnt(8)
    v_mfma_f32_16x16x32_bf16 v[92:95], v[36:39], v[72:75], v[92:95]
    ds_read_b128 v[68:71], v15 offset:8192
    s_waitcnt lgkmcnt(7)
    v_mfma_f32_16x16x32_bf16 v[96:99], v[40:43], v[72:75], v[96:99]
    s_waitcnt vmcnt(8) lgkmcnt(0)
    s_barrier
    ds_read_b128 v[80:83], v16 offset:0
    ds_read_b128 v[32:35], v18 offset:0
    s_add_u32 m0, s29, 0x0
    s_nop 0
    buffer_load_dwordx4 v8, s[12:15], s31 offen lds
    s_add_u32 s31, s31, 128
    v_mfma_f32_16x16x32_bf16 v[100:103], v[44:47], v[72:75], v[100:103]
    ds_read_b128 v[36:39], v18 offset:2048
    ds_read_b128 v[84:87], v17 offset:0
    s_add_u32 m0, s29, 0x2000
    s_nop 0
    buffer_load_dwordx4 v9, s[16:19], s32 offen lds
    v_mfma_f32_16x16x32_bf16 v[104:107], v[48:51], v[72:75], v[104:107]
    ds_read_b128 v[40:43], v18 offset:4096
    s_add_u32 m0, s29, 0x4000
    s_add_u32 s33, s32, 0x12000
    buffer_load_dwordx4 v9, s[16:19], s33 offen lds
    v_mfma_f32_16x16x32_bf16 v[88:91], v[52:55], v[76:79], v[88:91]
    ds_read_b128 v[44:47], v18 offset:6144
    s_add_u32 m0, s30, 0x6000
    s_nop 0
    s_mov_b64 exec, 0xffff
    buffer_load_dwordx4 v11, s[16:19], s32 offen lds
    s_mov_b64 exec, -1
    s_add_u32 s32, s32, 0x80
    v_mfma_f32_16x16x32_bf16 v[92:95], v[56:59], v[76:79], v[92:95]
    ds_read_b128 v[48:51], v18 offset:8192
    v_mfma_f32_16x16x32_bf16 v[96:99], v[60:63], v[76:79], v[96:99]
    ds_read_b128 v[52:55], v19 offset:0
    v_mfma_f32_16x16x32_bf16 v[100:103], v[64:67], v[76:79], v[100:103]
    ds_read_b128 v[56:59], v19 offset:2048
    v_mfma_f32_16x16x32_bf16 v[104:107], v[68:71], v[76:79], v[104:107]
    ds_read_b128 v[60:63], v19 offset:4096
    s_waitcnt lgkmcnt(8)
    v_mfma_f32_16x16x32_bf16 v[88:91], v[32:35], v[80:83], v[88:91]
    ds_read_b128 v[64:67], v19 offset:6144
    s_waitcnt lgkmcnt(8)
    v_mfma_f32_16x16x32_bf16 v[92:95], v[36:39], v[80:83], v[92:95]
    ds_read_b128 v[68:71], v19 offset:8192
    s_waitcnt lgkmcnt(7)
    v_mfma_f32_16x16x32_bf16 v[96:99], v[40:43], v[80:83], v[96:99]
    s_waitcnt vmcnt(8) lgkmcnt(0)
    s_barrier
    ds_read_b128 v[72:75], v20 offset:0
    ds_read_b128 v[32:35], v22 offset:0
    v_mfma_f32_16x16x32_bf16 v[100:103], v[44:47], v[80:83], v[100:103]
    ds_read_b128 v[36:39], v22 offset:2048
    ds_read_b128 v[76:79], v21 offset:0
    v_mfma_f32_16x16x32_bf16 v[104:107], v[48:51], v[80:83], v[104:107]
    ds_read_b128 v[40:43], v22 offset:4096
    v_mfma_f32_16x16x32_bf16 v[88:91], v[52:55], v[84:87], v[88:91]
    ds_read_b128 v[44:47], v22 offset:6144
    v_mfma_f32_16x16x32_bf16 v[92:95], v[56:59], v[84:87], v[92:95]
    ds_read_b128 v[48:51], v22 offset:8192
    v_mfma_f32_16x16x32_bf16 v[96:99], v[60:63], v[84:87], v[96:99]
    ds_read_b128 v[52:55], v23 offset:0
    v_mfma_f32_16x16x32_bf16 v[100:103], v[64:67], v[84:87], v[100:103]
    ds_read_b128 v[56:59], v23 offset:2048
    v_mfma_f32_16x16x32_bf16 v[104:107], v[68:71], v[84:87], v[104:107]
    ds_read_b128 v[60:63], v23 offset:4096
    s_waitcnt lgkmcnt(8)
    v_mfma_f32_16x16x32_bf16 v[88:91], v[32:35], v[72:75], v[88:91]
    ds_read_b128 v[64:67], v23 offset:6144
    s_waitcnt lgkmcnt(8)
    v_mfma_f32_16x16x32_bf16 v[92:95], v[36:39], v[72:75], v[92:95]
    ds_read_b128 v[68:71], v23 offset:8192
    s_waitcnt lgkmcnt(7)
    v_mfma_f32_16x16x32_bf16 v[96:99], v[40:43], v[72:75], v[96:99]
    s_waitcnt vmcnt(4) lgkmcnt(0)
    s_barrier
    ds_read_b128 v[80:83], v24 offset:0
    ds_read_b128 v[32:35], v26 offset:0
    v_mfma_f32_16x16x32_bf16 v[100:103], v[44:47], v[72:75], v[100:103]
    ds_read_b128 v[36:39], v26 offset:2048
    ds_read_b128 v[84:87], v25 offset:0
    v_mfma_f32_16x16x32_bf16 v[104:107], v[48:51], v[72:75], v[104:107]
    ds_read_b128 v[40:43], v26 offset:4096
    v_mfma_f32_16x16x32_bf16 v[88:91], v[52:55], v[76:79], v[88:91]
    ds_read_b128 v[44:47], v26 offset:6144
    v_mfma_f32_16x16x32_bf16 v[92:95], v[56:59], v[76:79], v[92:95]
    ds_read_b128 v[48:51], v26 offset:8192
    v_mfma_f32_16x16x32_bf16 v[96:99], v[60:63], v[76:79], v[96:99]
    ds_read_b128 v[52:55], v27 offset:0
    v_mfma_f32_16x16x32_bf16 v[100:103], v[64:67], v[76:79], v[100:103]
    ds_read_b128 v[56:59], v27 offset:2048
    v_mfma_f32_16x16x32_bf16 v[104:107], v[68:71], v[76:79], v[104:107]
    ds_read_b128 v[60:63], v27 offset:4096
    s_waitcnt lgkmcnt(8)
    v_mfma_f32_16x16x32_bf16 v[88:91], v[32:35], v[80:83], v[88:91]
    ds_read_b128 v[64:67], v27 offset:6144
    s_waitcnt lgkmcnt(8)
    v_mfma_f32_16x16x32_bf16 v[92:95], v[36:39], v[80:83], v[92:95]
    ds_read_b128 v[68:71], v27 offset:8192
    s_waitcnt lgkmcnt(7)
    v_mfma_f32_16x16x32_bf16 v[96:99], v[40:43], v[80:83], v[96:99]
    s_waitcnt vmcnt(0) lgkmcnt(0)
    s_barrier
    ds_read_b128 v[72:75], v12 offset:0
    ds_read_b128 v[32:35], v14 offset:0
    v_mfma_f32_16x16x32_bf16 v[100:103], v[44:47], v[80:83], v[100:103]
    ds_read_b128 v[36:39], v14 offset:2048
    ds_read_b128 v[76:79], v13 offset:0
    v_mfma_f32_16x16x32_bf16 v[104:107], v[48:51], v[80:83], v[104:107]
    ds_read_b128 v[40:43], v14 offset:4096
    v_mfma_f32_16x16x32_bf16 v[88:91], v[52:55], v[84:87], v[88:91]
    ds_read_b128 v[44:47], v14 offset:6144
    v_mfma_f32_16x16x32_bf16 v[92:95], v[56:59], v[84:87], v[92:95]
    ds_read_b128 v[48:51], v14 offset:8192
    v_mfma_f32_16x16x32_bf16 v[96:99], v[60:63], v[84:87], v[96:99]
    ds_read_b128 v[52:55], v15 offset:0
    v_mfma_f32_16x16x32_bf16 v[100:103], v[64:67], v[84:87], v[100:103]
    ds_read_b128 v[56:59], v15 offset:2048
    v_mfma_f32_16x16x32_bf16 v[104:107], v[68:71], v[84:87], v[104:107]
    ds_read_b128 v[60:63], v15 offset:4096
    s_waitcnt lgkmcnt(8)
    v_mfma_f32_16x16x32_bf16 v[88:91], v[32:35], v[72:75], v[88:91]
    ds_read_b128 v[64:67], v15 offset:6144
    s_waitcnt lgkmcnt(8)
    v_mfma_f32_16x16x32_bf16 v[92:95], v[36:39], v[72:75], v[92:95]
    ds_read_b128 v[68:71], v15 offset:8192
    s_waitcnt lgkmcnt(7)
    v_mfma_f32_16x16x32_bf16 v[96:99], v[40:43], v[72:75], v[96:99]
    s_waitcnt lgkmcnt(6)
    v_mfma_f32_16x16x32_bf16 v[100:103], v[44:47], v[72:75], v[100:103]
    s_waitcnt lgkmcnt(5)
    v_mfma_f32_16x16x32_bf16 v[104:107], v[48:51], v[72:75], v[104:107]
    s_waitcnt lgkmcnt(4)
    v_mfma_f32_16x16x32_bf16 v[88:91], v[52:55], v[76:79], v[88:91]
    s_waitcnt lgkmcnt(3)
    v_mfma_f32_16x16x32_bf16 v[92:95], v[56:59], v[76:79], v[92:95]
    s_waitcnt lgkmcnt(2)
    v_mfma_f32_16x16x32_bf16 v[96:99], v[60:63], v[76:79], v[96:99]
    s_waitcnt lgkmcnt(1)
    v_mfma_f32_16x16x32_bf16 v[100:103], v[64:67], v[76:79], v[100:103]
    s_waitcnt lgkmcnt(0)
    v_mfma_f32_16x16x32_bf16 v[104:107], v[68:71], v[76:79], v[104:107]
    s_nop 7
    s_nop 3
    s_barrier
    v_cvt_pk_bf16_f32 v28, v88, v89
    v_cvt_pk_bf16_f32 v29, v90, v91
    v_xor_b32 v28, s47, v28
    v_xor_b32 v29, s47, v29
    v_cvt_pk_bf16_f32 v30, v92, v93
    v_cvt_pk_bf16_f32 v31, v94, v95
    v_xor_b32 v30, s47, v30
    v_xor_b32 v31, s47, v31
    s_nop 1
    v_permlane16_swap_b32 v28, v30
    v_permlane16_swap_b32 v29, v31
    s_nop 0
    ds_write_b128 v7, v[28:31] offset:0
    v_cvt_pk_bf16_f32 v32, v96, v97
    v_cvt_pk_bf16_f32 v33, v98, v99
    v_xor_b32 v32, s47, v32
    v_xor_b32 v33, s47, v33
    v_cvt_pk_bf16_f32 v34, v100, v101
    v_cvt_pk_bf16_f32 v35, v102, v103
    v_xor_b32 v34, s47, v34
    v_xor_b32 v35, s47, v35
    s_nop 1
    v_permlane16_swap_b32 v32, v34
    v_permlane16_swap_b32 v33, v35
    s_nop 0
    ds_write_b128 v7, v[32:35] offset:64
    v_cvt_pk_bf16_f32 v36, v104, v105
    v_cvt_pk_bf16_f32 v37, v106, v107
    v_xor_b32 v36, s47, v36
    v_xor_b32 v37, s47, v37
    ds_write_b64 v6, v[36:37] offset:128
    s_branch LJ_rompt_kernel_36
LG_rompt_kernel_37:
    ds_read_b128 v[72:75], v12 offset:0
    ds_read_b128 v[32:35], v14 offset:10240
    ds_read_b128 v[36:39], v14 offset:12288
    ds_read_b128 v[40:43], v14 offset:14336
    ds_read_b128 v[44:47], v14 offset:16384
    ds_read_b128 v[76:79], v13 offset:0
    ds_read_b128 v[48:51], v15 offset:10240
    ds_read_b128 v[52:55], v15 offset:12288
    s_waitcnt lgkmcnt(6)
    v_mfma_f32_16x16x32_bf16 v[88:91], v[32:35], v[72:75], 0
    ds_read_b128 v[56:59], v15 offset:14336
    s_waitcnt lgkmcnt(6)
    v_mfma_f32_16x16x32_bf16 v[92:95], v[36:39], v[72:75], 0
    ds_read_b128 v[60:63], v15 offset:16384
    s_waitcnt lgkmcnt(6)
    v_mfma_f32_16x16x32_bf16 v[96:99], v[40:43], v[72:75], 0
    s_waitcnt vmcnt(2) lgkmcnt(0)
    s_barrier
    ds_read_b128 v[80:83], v16 offset:0
    ds_read_b128 v[32:35], v18 offset:10240
    s_add_u32 m0, s29, 0x0
    s_nop 0
    buffer_load_dwordx4 v8, s[12:15], s31 offen lds
    s_add_u32 s31, s31, 128
    v_mfma_f32_16x16x32_bf16 v[100:103], v[44:47], v[72:75], 0
    ds_read_b128 v[36:39], v18 offset:12288
    ds_read_b128 v[84:87], v17 offset:0
    s_add_u32 m0, s29, 0x2000
    s_nop 0
    buffer_load_dwordx4 v9, s[16:19], s32 offen lds
    v_mfma_f32_16x16x32_bf16 v[88:91], v[48:51], v[76:79], v[88:91]
    ds_read_b128 v[40:43], v18 offset:14336
    s_add_u32 m0, s29, 0x4000
    s_add_u32 s33, s32, 0x12000
    buffer_load_dwordx4 v9, s[16:19], s33 offen lds
    v_mfma_f32_16x16x32_bf16 v[92:95], v[52:55], v[76:79], v[92:95]
    ds_read_b128 v[44:47], v18 offset:16384
    s_add_u32 m0, s30, 0x6000
    s_nop 0
    s_mov_b64 exec, 0xffff
    buffer_load_dwordx4 v11, s[16:19], s32 offen lds
    s_mov_b64 exec, -1
    s_add_u32 s32, s32, 0x80
    v_mfma_f32_16x16x32_bf16 v[96:99], v[56:59], v[76:79], v[96:99]
    ds_read_b128 v[48:51], v19 offset:10240
    v_mfma_f32_16x16x32_bf16 v[100:103], v[60:63], v[76:79], v[100:103]
    ds_read_b128 v[52:55], v19 offset:12288
    s_waitcnt lgkmcnt(6)
    v_mfma_f32_16x16x32_bf16 v[88:91], v[32:35], v[80:83], v[88:91]
    ds_read_b128 v[56:59], v19 offset:14336
    s_waitcnt lgkmcnt(6)
    v_mfma_f32_16x16x32_bf16 v[92:95], v[36:39], v[80:83], v[92:95]
    ds_read_b128 v[60:63], v19 offset:16384
    s_waitcnt lgkmcnt(5)
    v_mfma_f32_16x16x32_bf16 v[96:99], v[40:43], v[80:83], v[96:99]
    s_waitcnt vmcnt(5) lgkmcnt(0)
    s_barrier
    ds_read_b128 v[72:75], v20 offset:0
    ds_read_b128 v[32:35], v22 offset:10240
    s_add_u32 m0, s29, 0x6800
    s_nop 0
    buffer_load_dwordx4 v8, s[12:15], s31 offen lds
    s_add_u32 s31, s31, 128
    v_mfma_f32_16x16x32_bf16 v[100:103], v[44:47], v[80:83], v[100:103]
    ds_read_b128 v[36:39], v22 offset:12288
    ds_read_b128 v[76:79], v21 offset:0
    s_add_u32 m0, s29, 0x8800
    s_nop 0
    buffer_load_dwordx4 v9, s[16:19], s32 offen lds
    v_mfma_f32_16x16x32_bf16 v[88:91], v[48:51], v[84:87], v[88:91]
    ds_read_b128 v[40:43], v22 offset:14336
    s_add_u32 m0, s29, 0xa800
    s_add_u32 s33, s32, 0x12000
    buffer_load_dwordx4 v9, s[16:19], s33 offen lds
    v_mfma_f32_16x16x32_bf16 v[92:95], v[52:55], v[84:87], v[92:95]
    ds_read_b128 v[44:47], v22 offset:16384
    s_add_u32 m0, s30, 0xc800
    s_nop 0
    s_mov_b64 exec, 0xffff
    buffer_load_dwordx4 v11, s[16:19], s32 offen lds
    s_mov_b64 exec, -1
    s_add_u32 s32, s32, 0x80
    v_mfma_f32_16x16x32_bf16 v[96:99], v[56:59], v[84:87], v[96:99]
    ds_read_b128 v[48:51], v23 offset:10240
    v_mfma_f32_16x16x32_bf16 v[100:103], v[60:63], v[84:87], v[100:103]
    ds_read_b128 v[52:55], v23 offset:12288
    s_waitcnt lgkmcnt(6)
    v_mfma_f32_16x16x32_bf16 v[88:91], v[32:35], v[72:75], v[88:91]
    ds_read_b128 v[56:59], v23 offset:14336
    s_waitcnt lgkmcnt(6)
    v_mfma_f32_16x16x32_bf16 v[92:95], v[36:39], v[72:75], v[92:95]
    ds_read_b128 v[60:63], v23 offset:16384
    s_waitcnt lgkmcnt(5)
    v_mfma_f32_16x16x32_bf16 v[96:99], v[40:43], v[72:75], v[96:99]
    s_waitcnt vmcnt(8) lgkmcnt(0)
    s_barrier
    ds_read_b128 v[80:83], v24 offset:0
    ds_read_b128 v[32:35], v26 offset:10240
    s_add_u32 m0, s29, 0xd000
    s_nop 0
    buffer_load_dwordx4 v8, s[12:15], s31 offen lds
    s_add_u32 s31, s31, 128
    v_mfma_f32_16x16x32_bf16 v[100:103], v[44:47], v[72:75], v[100:103]
    ds_read_b128 v[36:39], v26 offset:12288
    ds_read_b128 v[84:87], v25 offset:0
    s_add_u32 m0, s29, 0xf000
    s_nop 0
    buffer_load_dwordx4 v9, s[16:19], s32 offen lds
    v_mfma_f32_16x16x32_bf16 v[88:91], v[48:51], v[76:79], v[88:91]
    ds_read_b128 v[40:43], v26 offset:14336
    s_add_u32 m0, s29, 0x11000
    s_add_u32 s33, s32, 0x12000
    buffer_load_dwordx4 v9, s[16:19], s33 offen lds
    v_mfma_f32_16x16x32_bf16 v[92:95], v[52:55], v[76:79], v[92:95]
    ds_read_b128 v[44:47], v26 offset:16384
    s_add_u32 m0, s30, 0x13000
    s_nop 0
    s_mov_b64 exec, 0xffff
    buffer_load_dwordx4 v11, s[16:19], s32 offen lds
    s_mov_b64 exec, -1
    s_add_u32 s32, s32, 0x80
    v_mfma_f32_16x16x32_bf16 v[96:99], v[56:59], v[76:79], v[96:99]
    ds_read_b128 v[48:51], v27 offset:10240
    v_mfma_f32_16x16x32_bf16 v[100:103], v[60:63], v[76:79], v[100:103]
    ds_read_b128 v[52:55], v27 offset:12288
    s_waitcnt lgkmcnt(6)
    v_mfma_f32_16x16x32_bf16 v[88:91], v[32:35], v[80:83], v[88:91]
    ds_read_b128 v[56:59], v27 offset:14336
    s_waitcnt lgkmcnt(6)
    v_mfma_f32_16x16x32_bf16 v[92:95], v[36:39], v[80:83], v[92:95]
    ds_read_b128 v[60:63], v27 offset:16384
    s_waitcnt lgkmcnt(5)
    v_mfma_f32_16x16x32_bf16 v[96:99], v[40:43], v[80:83], v[96:99]
    s_waitcnt vmcnt(8) lgkmcnt(0)
    s_barrier
    ds_read_b128 v[72:75], v12 offset:0
    ds_read_b128 v[32:35], v14 offset:10240
    s_add_u32 m0, s29, 0x13800
    s_nop 0
    buffer_load_dwordx4 v8, s[12:15], s31 offen lds
    s_add_u32 s31, s31, 128
    v_mfma_f32_16x16x32_bf16 v[100:103], v[44:47], v[80:83], v[100:103]
    ds_read_b128 v[36:39], v14 offset:12288
    ds_read_b128 v[76:79], v13 offset:0
    s_add_u32 m0, s29, 0x15800
    s_nop 0
    buffer_load_dwordx4 v9, s[16:19], s32 offen lds
    v_mfma_f32_16x16x32_bf16 v[88:91], v[48:51], v[84:87], v[88:91]
    ds_read_b128 v[40:43], v14 offset:14336
    s_add_u32 m0, s29, 0x17800
    s_add_u32 s33, s32, 0x12000
    buffer_load_dwordx4 v9, s[16:19], s33 offen lds
    v_mfma_f32_16x16x32_bf16 v[92:95], v[52:55], v[84:87], v[92:95]
    ds_read_b128 v[44:47], v14 offset:16384
    s_add_u32 m0, s30, 0x19800
    s_nop 0
    s_mov_b64 exec, 0xffff
    buffer_load_dwordx4 v11, s[16:19], s32 offen lds
    s_mov_b64 exec, -1
    s_add_u32 s32, s32, 0x80
    v_mfma_f32_16x16x32_bf16 v[96:99], v[56:59], v[84:87], v[96:99]
    ds_read_b128 v[48:51], v15 offset:10240
    v_mfma_f32_16x16x32_bf16 v[100:103], v[60:63], v[84:87], v[100:103]
    ds_read_b128 v[52:55], v15 offset:12288
    s_waitcnt lgkmcnt(6)
    v_mfma_f32_16x16x32_bf16 v[88:91], v[32:35], v[72:75], v[88:91]
    ds_read_b128 v[56:59], v15 offset:14336
    s_waitcnt lgkmcnt(6)
    v_mfma_f32_16x16x32_bf16 v[92:95], v[36:39], v[72:75], v[92:95]
    ds_read_b128 v[60:63], v15 offset:16384
    s_waitcnt lgkmcnt(5)
    v_mfma_f32_16x16x32_bf16 v[96:99], v[40:43], v[72:75], v[96:99]
    s_waitcnt vmcnt(8) lgkmcnt(0)
    s_barrier
    ds_read_b128 v[80:83], v16 offset:0
    ds_read_b128 v[32:35], v18 offset:10240
    s_add_u32 m0, s29, 0x0
    s_nop 0
    buffer_load_dwordx4 v8, s[12:15], s31 offen lds
    s_add_u32 s31, s31, 128
    v_mfma_f32_16x16x32_bf16 v[100:103], v[44:47], v[72:75], v[100:103]
    ds_read_b128 v[36:39], v18 offset:12288
    ds_read_b128 v[84:87], v17 offset:0
    s_add_u32 m0, s29, 0x2000
    s_nop 0
    buffer_load_dwordx4 v9, s[16:19], s32 offen lds
    v_mfma_f32_16x16x32_bf16 v[88:91], v[48:51], v[76:79], v[88:91]
    ds_read_b128 v[40:43], v18 offset:14336
    s_add_u32 m0, s29, 0x4000
    s_add_u32 s33, s32, 0x12000
    buffer_load_dwordx4 v9, s[16:19], s33 offen lds
    v_mfma_f32_16x16x32_bf16 v[92:95], v[52:55], v[76:79], v[92:95]
    ds_read_b128 v[44:47], v18 offset:16384
    s_add_u32 m0, s30, 0x6000
    s_nop 0
    s_mov_b64 exec, 0xffff
    buffer_load_dwordx4 v11, s[16:19], s32 offen lds
    s_mov_b64 exec, -1
    s_add_u32 s32, s32, 0x80
    v_mfma_f32_16x16x32_bf16 v[96:99], v[56:59], v[76:79], v[96:99]
    ds_read_b128 v[48:51], v19 offset:10240
    v_mfma_f32_16x16x32_bf16 v[100:103], v[60:63], v[76:79], v[100:103]
    ds_read_b128 v[52:55], v19 offset:12288
    s_waitcnt lgkmcnt(6)
    v_mfma_f32_16x16x32_bf16 v[88:91], v[32:35], v[80:83], v[88:91]
    ds_read_b128 v[56:59], v19 offset:14336
    s_waitcnt lgkmcnt(6)
    v_mfma_f32_16x16x32_bf16 v[92:95], v[36:39], v[80:83], v[92:95]
    ds_read_b128 v[60:63], v19 offset:16384
    s_waitcnt lgkmcnt(5)
    v_mfma_f32_16x16x32_bf16 v[96:99], v[40:43], v[80:83], v[96:99]
    s_waitcnt vmcnt(8) lgkmcnt(0)
    s_barrier
    ds_read_b128 v[72:75], v20 offset:0
    ds_read_b128 v[32:35], v22 offset:10240
    v_mfma_f32_16x16x32_bf16 v[100:103], v[44:47], v[80:83], v[100:103]
    ds_read_b128 v[36:39], v22 offset:12288
    ds_read_b128 v[76:79], v21 offset:0
    v_mfma_f32_16x16x32_bf16 v[88:91], v[48:51], v[84:87], v[88:91]
    ds_read_b128 v[40:43], v22 offset:14336
    v_mfma_f32_16x16x32_bf16 v[92:95], v[52:55], v[84:87], v[92:95]
    ds_read_b128 v[44:47], v22 offset:16384
    v_mfma_f32_16x16x32_bf16 v[96:99], v[56:59], v[84:87], v[96:99]
    ds_read_b128 v[48:51], v23 offset:10240
    v_mfma_f32_16x16x32_bf16 v[100:103], v[60:63], v[84:87], v[100:103]
    ds_read_b128 v[52:55], v23 offset:12288
    s_waitcnt lgkmcnt(6)
    v_mfma_f32_16x16x32_bf16 v[88:91], v[32:35], v[72:75], v[88:91]
    ds_read_b128 v[56:59], v23 offset:14336
    s_waitcnt lgkmcnt(6)
    v_mfma_f32_16x16x32_bf16 v[92:95], v[36:39], v[72:75], v[92:95]
    ds_read_b128 v[60:63], v23 offset:16384
    s_waitcnt lgkmcnt(5)
    v_mfma_f32_16x16x32_bf16 v[96:99], v[40:43], v[72:75], v[96:99]
    s_waitcnt vmcnt(4) lgkmcnt(0)
    s_barrier
    ds_read_b128 v[80:83], v24 offset:0
    ds_read_b128 v[32:35], v26 offset:10240
    v_mfma_f32_16x16x32_bf16 v[100:103], v[44:47], v[72:75], v[100:103]
    ds_read_b128 v[36:39], v26 offset:12288
    ds_read_b128 v[84:87], v25 offset:0
    v_mfma_f32_16x16x32_bf16 v[88:91], v[48:51], v[76:79], v[88:91]
    ds_read_b128 v[40:43], v26 offset:14336
    v_mfma_f32_16x16x32_bf16 v[92:95], v[52:55], v[76:79], v[92:95]
    ds_read_b128 v[44:47], v26 offset:16384
    v_mfma_f32_16x16x32_bf16 v[96:99], v[56:59], v[76:79], v[96:99]
    ds_read_b128 v[48:51], v27 offset:10240
    v_mfma_f32_16x16x32_bf16 v[100:103], v[60:63], v[76:79], v[100:103]
    ds_read_b128 v[52:55], v27 offset:12288
    s_waitcnt lgkmcnt(6)
    v_mfma_f32_16x16x32_bf16 v[88:91], v[32:35], v[80:83], v[88:91]
    ds_read_b128 v[56:59], v27 offset:14336
    s_waitcnt lgkmcnt(6)
    v_mfma_f32_16x16x32_bf16 v[92:95], v[36:39], v[80:83], v[92:95]
    ds_read_b128 v[60:63], v27 offset:16384
    s_waitcnt lgkmcnt(5)
    v_mfma_f32_16x16x32_bf16 v[96:99], v[40:43], v[80:83], v[96:99]
    s_waitcnt vmcnt(0) lgkmcnt(0)
    s_barrier
    ds_read_b128 v[72:75], v12 offset:0
    ds_read_b128 v[32:35], v14 offset:10240
    v_mfma_f32_16x16x32_bf16 v[100:103], v[44:47], v[80:83], v[100:103]
    ds_read_b128 v[36:39], v14 offset:12288
    ds_read_b128 v[76:79], v13 offset:0
    v_mfma_f32_16x16x32_bf16 v[88:91], v[48:51], v[84:87], v[88:91]
    ds_read_b128 v[40:43], v14 offset:14336
    v_mfma_f32_16x16x32_bf16 v[92:95], v[52:55], v[84:87], v[92:95]
    ds_read_b128 v[44:47], v14 offset:16384
    v_mfma_f32_16x16x32_bf16 v[96:99], v[56:59], v[84:87], v[96:99]
    ds_read_b128 v[48:51], v15 offset:10240
    v_mfma_f32_16x16x32_bf16 v[100:103], v[60:63], v[84:87], v[100:103]
    ds_read_b128 v[52:55], v15 offset:12288
    s_waitcnt lgkmcnt(6)
    v_mfma_f32_16x16x32_bf16 v[88:91], v[32:35], v[72:75], v[88:91]
    ds_read_b128 v[56:59], v15 offset:14336
    s_waitcnt lgkmcnt(6)
    v_mfma_f32_16x16x32_bf16 v[92:95], v[36:39], v[72:75], v[92:95]
    ds_read_b128 v[60:63], v15 offset:16384
    s_waitcnt lgkmcnt(5)
    v_mfma_f32_16x16x32_bf16 v[96:99], v[40:43], v[72:75], v[96:99]
    s_waitcnt lgkmcnt(4)
    v_mfma_f32_16x16x32_bf16 v[100:103], v[44:47], v[72:75], v[100:103]
    s_waitcnt lgkmcnt(3)
    v_mfma_f32_16x16x32_bf16 v[88:91], v[48:51], v[76:79], v[88:91]
    s_waitcnt lgkmcnt(2)
    v_mfma_f32_16x16x32_bf16 v[92:95], v[52:55], v[76:79], v[92:95]
    s_waitcnt lgkmcnt(1)
    v_mfma_f32_16x16x32_bf16 v[96:99], v[56:59], v[76:79], v[96:99]
    s_waitcnt lgkmcnt(0)
    v_mfma_f32_16x16x32_bf16 v[100:103], v[60:63], v[76:79], v[100:103]
    s_nop 7
    s_nop 3
    s_barrier
    v_cvt_pk_bf16_f32 v28, v88, v89
    v_cvt_pk_bf16_f32 v29, v90, v91
    v_xor_b32 v28, s47, v28
    v_xor_b32 v29, s47, v29
    v_cvt_pk_bf16_f32 v30, v92, v93
    v_cvt_pk_bf16_f32 v31, v94, v95
    v_xor_b32 v30, s47, v30
    v_xor_b32 v31, s47, v31
    s_nop 1
    v_permlane16_swap_b32 v28, v30
    v_permlane16_swap_b32 v29, v31
    s_nop 0
    ds_write_b128 v7, v[28:31] offset:160
    v_cvt_pk_bf16_f32 v32, v96, v97
    v_cvt_pk_bf16_f32 v33, v98, v99
    v_xor_b32 v32, s47, v32
    v_xor_b32 v33, s47, v33
    v_cvt_pk_bf16_f32 v34, v100, v101
    v_cvt_pk_bf16_f32 v35, v102, v103
    v_xor_b32 v34, s47, v34
    v_xor_b32 v35, s47, v35
    s_nop 1
    v_permlane16_swap_b32 v32, v34
    v_permlane16_swap_b32 v33, v35
    s_nop 0
    ds_write_b128 v7, v[32:35] offset:224
LJ_rompt_kernel_36:
    v_lshlrev_b32 v2, 4, v0
    s_waitcnt lgkmcnt(0)
    s_barrier
    ds_read_b128 v[28:31], v2 offset:0
    ds_read_b128 v[32:35], v2 offset:8192
    ds_read_b128 v[36:39], v2 offset:16384
    s_mov_b32 s33, 0
    s_waitcnt lgkmcnt(2)
    buffer_store_dwordx4 v[28:31], v2, s[24:27], s33 offen sc0 sc1
    s_mov_b32 s33, 8192
    s_waitcnt lgkmcnt(1)
    buffer_store_dwordx4 v[32:35], v2, s[24:27], s33 offen sc0 sc1
    s_mov_b32 s33, 16384
    s_waitcnt lgkmcnt(0)
    buffer_store_dwordx4 v[36:39], v2, s[24:27], s33 offen sc0 sc1
    s_mov_b32 s44, s2
    s_waitcnt vmcnt(0)
    s_barrier
    s_cmp_lg_u32 s28, 0
    s_cbranch_scc1 LPB_rompt_kernel_38
    s_add_u32 s72, s4, 0x1201000
    s_addc_u32 s73, s5, 0
    s_mov_b32 s74, 0x1000
    s_and_b32 s73, s73, 0xffff
    s_mov_b32 s75, 0x20000
    s_mov_b64 exec, 1
    s_lshl_b32 s46, s44, 2
    v_mov_b32 v2, s46
    v_mov_b32 v3, 1
    buffer_store_dword v3, v2, s[72:75], 0 offen sc0 sc1
    s_mov_b64 exec, -1
LPB_rompt_kernel_38:
    s_load_dwordx2 s[4:5], s[0:1], 88
    s_load_dwordx4 s[8:11], s[0:1], 8
    v_and_b32 v1, 63, v0
    v_lshrrev_b32 v2, 6, v0
    s_nop 0
    v_readfirstlane_b32 s28, v2
    s_and_b32 s34, s2, 7
    s_lshr_b32 s35, s2, 3
    s_and_b32 s36, s34, 3
    s_lshr_b32 s37, s34, 2
    s_lshl_b32 s37, s37, 3
    s_lshr_b32 s38, s35, 2
    s_add_u32 s37, s37, s38
    s_and_b32 s38, s35, 3
    s_lshl_b32 s29, s28, 10
    s_lshl_b32 s30, s28, 8
    v_lshrrev_b32 v2, 3, v1
    s_lshl_b32 s33, s28, 3
    v_add_u32 v2, s33, v2
    v_bfe_u32 v3, v2, 1, 3
    v_and_b32 v4, 7, v1
    v_xor_b32 v3, v3, v4
    v_mul_u32_u24 v8, 4096, v2
    v_lshl_add_u32 v8, v3, 4, v8
    s_lshl_b32 s33, s28, 6
    s_add_u32 s33, s33, 0
    v_add_u32 v2, s33, v1
    v_mul_u32_u24 v3, 3641, v2
    v_lshrrev_b32 v3, 16, v3
    v_mul_u32_u24 v4, 18, v3
    v_sub_u32 v4, v2, v4
    v_and_b32 v5, 0x33, v3
    v_and_b32 v6, 4, v3
    v_lshl_or_b32 v5, v6, 1, v5
    v_and_b32 v6, 8, v3
    v_lshrrev_b32 v6, 1, v6
    v_or_b32 v5, v5, v6
    v_mul_u32_u24 v9, 288, v5
    v_lshl_add_u32 v9, v4, 4, v9
    s_lshl_b32 s33, s28, 6
    s_add_u32 s33, s33, 512
    v_add_u32 v2, s33, v1
    v_mul_u32_u24 v3, 3641, v2
    v_lshrrev_b32 v3, 16, v3
    v_mul_u32_u24 v4, 18, v3
    v_sub_u32 v4, v2, v4
    v_and_b32 v5, 0x33, v3
    v_and_b32 v6, 4, v3
    v_lshl_or_b32 v5, v6, 1, v5
    v_and_b32 v6, 8, v3
    v_lshrrev_b32 v6, 1, v6
    v_or_b32 v5, v5, v6
    v_mul_u32_u24 v10, 288, v5
    v_lshl_add_u32 v10, v4, 4, v10
    s_lshl_b32 s33, s28, 4
    s_add_u32 s33, s33, 1024
    v_add_u32 v2, s33, v1
    v_mul_u32_u24 v3, 3641, v2
    v_lshrrev_b32 v3, 16, v3
    v_mul_u32_u24 v4, 18, v3
    v_sub_u32 v4, v2, v4
    v_and_b32 v5, 0x33, v3
    v_and_b32 v6, 4, v3
    v_lshl_or_b32 v5, v6, 1, v5
    v_and_b32 v6, 8, v3
    v_lshrrev_b32 v6, 1, v6
    v_or_b32 v5, v5, v6
    v_mul_u32_u24 v11, 288, v5
    v_lshl_add_u32 v11, v4, 4, v11
    s_mov_b32 s31, 0
    s_mov_b32 s32, 0
    s_waitcnt lgkmcnt(0)
    s_cmp_lt_u32 s36, 2
    s_cselect_b32 s6, s8, s10
    s_cselect_b32 s7, s9, s11
    s_mul_i32 s44, s37, 524288
    s_and_b32 s45, s36, 1
    s_lshl_b32 s45, s45, 11
    s_add_u32 s44, s44, s45
    s_add_u32 s12, s6, 0x0
    s_addc_u32 s13, s7, 0
    s_add_u32 s12, s12, s44
    s_addc_u32 s13, s13, 0
    s_sub_u32 s14, 0x800000, s44
    s_and_b32 s13, s13, 0xffff
    s_mov_b32 s15, 0x20000
    s_lshr_b32 s44, s36, 1
    s_lshl_b32 s44, s44, 2
    s_add_u32 s44, s44, s38
    s_lshl_b32 s44, s44, 1
    s_and_b32 s45, s36, 1
    s_add_u32 s44, s44, s45
    s_mul_i32 s44, s44, 294912
    s_add_u32 s16, s4, 0x5800000
    s_addc_u32 s17, s5, 0
    s_add_u32 s16, s16, s44
    s_addc_u32 s17, s17, 0
    s_sub_u32 s18, 0x480000, s44
    s_and_b32 s17, s17, 0xffff
    s_mov_b32 s19, 0x20000
    s_add_u32 m0, s29, 0x0
    s_nop 0
    buffer_load_dwordx4 v8, s[12:15], s31 offen lds
    s_add_u32 m0, s29, 0x2000
    s_add_u32 s33, s31, 0x40000
    buffer_load_dwordx4 v8, s[12:15], s33 offen lds
    s_add_u32 s31, s31, 128
    s_add_u32 m0, s29, 0x8800
    s_nop 0
    buffer_load_dwordx4 v8, s[12:15], s31 offen lds
    s_add_u32 m0, s29, 0xa800
    s_add_u32 s33, s31, 0x40000
    buffer_load_dwordx4 v8, s[12:15], s33 offen lds
    s_add_u32 s31, s31, 128
    s_add_u32 m0, s29, 0x11000
    s_nop 0
    buffer_load_dwordx4 v8, s[12:15], s31 offen lds
    s_add_u32 m0, s29, 0x13000
    s_add_u32 s33, s31, 0x40000
    buffer_load_dwordx4 v8, s[12:15], s33 offen lds
    s_add_u32 s31, s31, 128
    s_add_u32 m0, s29, 0x19800
    s_nop 0
    buffer_load_dwordx4 v8, s[12:15], s31 offen lds
    s_add_u32 m0, s29, 0x1b800
    s_add_u32 s33, s31, 0x40000
    buffer_load_dwordx4 v8, s[12:15], s33 offen lds
    s_add_u32 s31, s31, 128
    s_and_b32 s44, s36, 1
    s_lshl_b32 s44, s44, 7
    s_lshr_b32 s45, s36, 1
    s_lshl_b32 s45, s45, 2
    s_add_u32 s44, s44, s45
    s_add_u32 s44, s44, s38
    v_lshl_add_u32 v2, v1, 3, s44
    s_cmp_lg_u32 s28, 0
    s_cbranch_scc1 LFS_rompt_kernel_39
    s_add_u32 s72, s4, 0x1201000
    s_addc_u32 s73, s5, 0
    s_mov_b32 s74, 0x1000
    s_and_b32 s73, s73, 0xffff
    s_mov_b32 s75, 0x20000
    v_lshlrev_b32 v2, 2, v2
    s_mov_b64 exec, 0xffff
    s_mov_b32 s45, 0
LFW_rompt_kernel_40:
    buffer_load_dword v3, v2, s[72:75], 0 offen sc0 sc1
    s_waitcnt vmcnt(0)
    v_cmp_ne_u32 vcc, 1, v3
    s_nop 3
    s_cmp_eq_u64 vcc, 0
    s_cbranch_scc1 LFD_rompt_kernel_41
    s_add_u32 s45, s45, 1
    s_cmp_lt_u32 s45, 0x100000
    s_cbranch_scc1 LFW_rompt_kernel_40
LFD_rompt_kernel_41:
    s_mov_b64 exec, -1
LFS_rompt_kernel_39:
    s_barrier
    s_add_u32 m0, s29, 0x4000
    s_nop 0
    buffer_load_dwordx4 v9, s[16:19], s32 offen lds
    s_add_u32 m0, s29, 0x6000
    s_nop 0
    buffer_load_dwordx4 v10, s[16:19], s32 offen lds
    s_add_u32 m0, s30, 0x8000
    s_nop 0
    s_mov_b64 exec, 0xffff
    buffer_load_dwordx4 v11, s[16:19], s32 offen lds
    s_mov_b64 exec, -1
    s_add_u32 s32, s32, 0x4800
    s_add_u32 m0, s29, 0xc800
    s_nop 0
    buffer_load_dwordx4 v9, s[16:19], s32 offen lds
    s_add_u32 m0, s29, 0xe800
    s_nop 0
    buffer_load_dwordx4 v10, s[16:19], s32 offen lds
    s_add_u32 m0, s30, 0x10800
    s_nop 0
    s_mov_b64 exec, 0xffff
    buffer_load_dwordx4 v11, s[16:19], s32 offen lds
    s_mov_b64 exec, -1
    s_add_u32 s32, s32, 0x4800
    s_add_u32 m0, s29, 0x15000
    s_nop 0
    buffer_load_dwordx4 v9, s[16:19], s32 offen lds
    s_add_u32 m0, s29, 0x17000
    s_nop 0
    buffer_load_dwordx4 v10, s[16:19], s32 offen lds
    s_add_u32 m0, s30, 0x19000
    s_nop 0
    s_mov_b64 exec, 0xffff
    buffer_load_dwordx4 v11, s[16:19], s32 offen lds
    s_mov_b64 exec, -1
    s_add_u32 s32, s32, 0x4800
    s_add_u32 m0, s29, 0x1d800
    s_nop 0
    buffer_load_dwordx4 v9, s[16:19], s32 offen lds
    s_add_u32 m0, s29, 0x1f800
    s_nop 0
    buffer_load_dwordx4 v10, s[16:19], s32 offen lds
    s_add_u32 m0, s30, 0x21800
    s_nop 0
    s_mov_b64 exec, 0xffff
    buffer_load_dwordx4 v11, s[16:19], s32 offen lds
    s_mov_b64 exec, -1
    s_add_u32 s32, s32, 0x4800
    s_and_b32 s33, s28, 3
    s_mul_i32 s33, s33, 4096
    v_and_b32 v2, 15, v1
    v_lshrrev_b32 v3, 4, v1
    v_bfe_u32 v4, v1, 1, 3
    v_xor_b32 v4, v3, v4
    v_lshlrev_b32 v4, 4, v4
    v_lshl_add_u32 v4, v2, 7, v4
    v_add_u32 v5, s33, v4
    v_add_u32 v12, 0x0, v5
    v_xor_b32 v13, 64, v12
    v_add_u32 v15, 0x8800, v5
    v_xor_b32 v16, 64, v15
    v_add_u32 v18, 0x11000, v5
    v_xor_b32 v19, 64, v18
    v_add_u32 v21, 0x19800, v5
    v_xor_b32 v22, 64, v21
    v_lshrrev_b32 v4, 5, v1
    v_lshlrev_b32 v4, 4, v4
    v_bfe_u32 v5, v1, 4, 1
    v_lshl_add_u32 v4, v5, 2, v4
    v_bfe_u32 v5, v1, 2, 2
    v_add_u32 v4, v4, v5
    v_mul_u32_u24 v4, 288, v4
    v_and_b32 v5, 3, v1
    v_lshl_add_u32 v4, v5, 3, v4
    v_add_u32 v14, 0x4000, v4
    v_add_u32 v17, 0xc800, v4
    v_add_u32 v20, 0x15000, v4
    v_add_u32 v23, 0x1d800, v4
    s_and_b32 s33, s28, 3
    s_mul_i32 s33, s33, 32
    v_and_b32 v5, 15, v1
    v_add_u32 v5, s33, v5
    v_lshrrev_b32 v6, 4, v1
    v_mul_u32_u24 v5, 288, v5
    v_and_b32 v2, 1, v6
    v_lshl_add_u32 v7, v2, 5, v5
    v_lshrrev_b32 v2, 1, v6
    v_lshl_add_u32 v7, v2, 4, v7
    v_lshl_add_u32 v6, v6, 3, v5
    s_lshl_b32 s44, s36, 4
    s_add_u32 s44, s44, s37
    s_lshl_b32 s44, s44, 2
    s_and_b32 s46, s28, 3
    s_add_u32 s44, s44, s46
    s_mul_i32 s44, s44, 36864
    s_mul_i32 s46, s38, 9216
    s_add_u32 s44, s44, s46
    s_add_u32 s24, s4, 0x1400000
    s_addc_u32 s25, s5, 0
    s_add_u32 s24, s24, s44
    s_addc_u32 s25, s25, 0
    s_sub_u32 s26, 0x900000, s44
    s_and_b32 s25, s25, 0xffff
    s_mov_b32 s27, 0x20000
    v_lshlrev_b32 v7, 4, v1
    s_waitcnt vmcnt(9)
    s_barrier
    s_cmp_ge_u32 s28, 4
    s_cbranch_scc1 LG_rompt_kernel_43
    ds_read_b128 v[68:71], v12 offset:0
    ds_read_b128 v[72:75], v12 offset:2048
    ds_read_b64_tr_b16 v[28:29], v14 offset:0
    ds_read_b64_tr_b16 v[30:31], v14 offset:2304
    ds_read_b64_tr_b16 v[32:33], v14 offset:32
    ds_read_b64_tr_b16 v[34:35], v14 offset:2336
    ds_read_b64_tr_b16 v[36:37], v14 offset:64
    ds_read_b64_tr_b16 v[38:39], v14 offset:2368
    ds_read_b64_tr_b16 v[40:41], v14 offset:96
    ds_read_b64_tr_b16 v[42:43], v14 offset:2400
    ds_read_b64_tr_b16 v[44:45], v14 offset:128
    ds_read_b64_tr_b16 v[46:47], v14 offset:2432
    ds_read_b128 v[76:79], v13 offset:0
    ds_read_b128 v[80:83], v13 offset:2048
    ds_read_b64_tr_b16 v[48:49], v14 offset:9216
    s_waitcnt lgkmcnt(13)
    ds_read_b64_tr_b16 v[50:51], v14 offset:11520
    ds_read_b64_tr_b16 v[52:53], v14 offset:9248
    s_waitcnt lgkmcnt(13)
    ds_read_b64_tr_b16 v[54:55], v14 offset:11552
    ds_read_b64_tr_b16 v[56:57], v14 offset:9280
    s_waitcnt lgkmcnt(13)
    ds_read_b64_tr_b16 v[58:59], v14 offset:11584
    v_mfma_f32_16x16x32_bf16 v[100:103], v[28:31], v[68:71], 0
    v_mfma_f32_16x16x32_bf16 v[104:107], v[28:31], v[72:75], 0
    ds_read_b64_tr_b16 v[60:61], v14 offset:9312
    s_waitcnt lgkmcnt(13)
    ds_read_b64_tr_b16 v[62:63], v14 offset:11616
    v_mfma_f32_16x16x32_bf16 v[108:111], v[32:35], v[68:71], 0
    v_mfma_f32_16x16x32_bf16 v[112:115], v[32:35], v[72:75], 0
    ds_read_b64_tr_b16 v[64:65], v14 offset:9344
    s_waitcnt lgkmcnt(13)
    ds_read_b64_tr_b16 v[66:67], v14 offset:11648
    v_mfma_f32_16x16x32_bf16 v[116:119], v[36:39], v[68:71], 0
    v_mfma_f32_16x16x32_bf16 v[120:123], v[36:39], v[72:75], 0
    s_waitcnt vmcnt(6) lgkmcnt(0)
    s_barrier
    ds_read_b128 v[84:87], v15 offset:0
    ds_read_b128 v[88:91], v15 offset:2048
    ds_read_b64_tr_b16 v[28:29], v17 offset:0
    ds_read_b64_tr_b16 v[30:31], v17 offset:2304
    s_add_u32 m0, s29, 0x0
    s_nop 0
    buffer_load_dwordx4 v8, s[12:15], s31 offen lds
    v_mfma_f32_16x16x32_bf16 v[124:127], v[40:43], v[68:71], 0
    v_mfma_f32_16x16x32_bf16 v[128:131], v[40:43], v[72:75], 0
    ds_read_b64_tr_b16 v[32:33], v17 offset:32
    ds_read_b64_tr_b16 v[34:35], v17 offset:2336
    ds_read_b128 v[92:95], v16 offset:0
    s_add_u32 m0, s29, 0x2000
    s_add_u32 s33, s31, 0x40000
    buffer_load_dwordx4 v8, s[12:15], s33 offen lds
    s_add_u32 s31, s31, 128
    v_mfma_f32_16x16x32_bf16 v[132:135], v[44:47], v[68:71], 0
    v_mfma_f32_16x16x32_bf16 v[136:139], v[44:47], v[72:75], 0
    ds_read_b64_tr_b16 v[36:37], v17 offset:64
    ds_read_b64_tr_b16 v[38:39], v17 offset:2368
    ds_read_b128 v[96:99], v16 offset:2048
    s_add_u32 m0, s29, 0x4000
    s_nop 0
    buffer_load_dwordx4 v9, s[16:19], s32 offen lds
    v_mfma_f32_16x16x32_bf16 v[100:103], v[48:51], v[76:79], v[100:103]
    v_mfma_f32_16x16x32_bf16 v[104:107], v[48:51], v[80:83], v[104:107]
    ds_read_b64_tr_b16 v[40:41], v17 offset:96
    ds_read_b64_tr_b16 v[42:43], v17 offset:2400
    s_add_u32 m0, s29, 0x6000
    s_nop 0
    buffer_load_dwordx4 v10, s[16:19], s32 offen lds
    v_mfma_f32_16x16x32_bf16 v[108:111], v[52:55], v[76:79], v[108:111]
    v_mfma_f32_16x16x32_bf16 v[112:115], v[52:55], v[80:83], v[112:115]
    ds_read_b64_tr_b16 v[44:45], v17 offset:128
    ds_read_b64_tr_b16 v[46:47], v17 offset:2432
    s_add_u32 m0, s30, 0x8000
    s_nop 0
    s_mov_b64 exec, 0xffff
    buffer_load_dwordx4 v11, s[16:19], s32 offen lds
    s_mov_b64 exec, -1
    s_add_u32 s32, s32, 0x4800
    v_mfma_f32_16x16x32_bf16 v[116:119], v[56:59], v[76:79], v[116:119]
    v_mfma_f32_16x16x32_bf16 v[120:123], v[56:59], v[80:83], v[120:123]
    ds_read_b64_tr_b16 v[48:49], v17 offset:9216
    s_waitcnt lgkmcnt(13)
    ds_read_b64_tr_b16 v[50:51], v17 offset:11520
    v_mfma_f32_16x16x32_bf16 v[124:127], v[60:63], v[76:79], v[124:127]
    v_mfma_f32_16x16x32_bf16 v[128:131], v[60:63], v[80:83], v[128:131]
    ds_read_b64_tr_b16 v[52:53], v17 offset:9248
    s_waitcnt lgkmcnt(13)
    ds_read_b64_tr_b16 v[54:55], v17 offset:11552
    v_mfma_f32_16x16x32_bf16 v[132:135], v[64:67], v[76:79], v[132:135]
    v_mfma_f32_16x16x32_bf16 v[136:139], v[64:67], v[80:83], v[136:139]
    ds_read_b64_tr_b16 v[56:57], v17 offset:9280
    s_waitcnt lgkmcnt(13)
    ds_read_b64_tr_b16 v[58:59], v17 offset:11584
    v_mfma_f32_16x16x32_bf16 v[100:103], v[28:31], v[84:87], v[100:103]
    v_mfma_f32_16x16x32_bf16 v[104:107], v[28:31], v[88:91], v[104:107]
    ds_read_b64_tr_b16 v[60:61], v17 offset:9312
    s_waitcnt lgkmcnt(13)
    ds_read_b64_tr_b16 v[62:63], v17 offset:11616
    v_mfma_f32_16x16x32_bf16 v[108:111], v[32:35], v[84:87], v[108:111]
    v_mfma_f32_16x16x32_bf16 v[112:115], v[32:35], v[88:91], v[112:115]
    ds_read_b64_tr_b16 v[64:65], v17 offset:9344
    s_waitcnt lgkmcnt(13)
    ds_read_b64_tr_b16 v[66:67], v17 offset:11648
    v_mfma_f32_16x16x32_bf16 v[116:119], v[36:39], v[84:87], v[116:119]
    v_mfma_f32_16x16x32_bf16 v[120:123], v[36:39], v[88:91], v[120:123]
    s_waitcnt vmcnt(8) lgkmcnt(0)
    s_barrier
    ds_read_b128 v[68:71], v18 offset:0
    ds_read_b128 v[72:75], v18 offset:2048
    ds_read_b64_tr_b16 v[28:29], v20 offset:0
    ds_read_b64_tr_b16 v[30:31], v20 offset:2304
    s_add_u32 m0, s29, 0x8800
    s_nop 0
    buffer_load_dwordx4 v8, s[12:15], s31 offen lds
    v_mfma_f32_16x16x32_bf16 v[124:127], v[40:43], v[84:87], v[124:127]
    v_mfma_f32_16x16x32_bf16 v[128:131], v[40:43], v[88:91], v[128:131]
    ds_read_b64_tr_b16 v[32:33], v20 offset:32
    ds_read_b64_tr_b16 v[34:35], v20 offset:2336
    ds_read_b128 v[76:79], v19 offset:0
    s_add_u32 m0, s29, 0xa800
    s_add_u32 s33, s31, 0x40000
    buffer_load_dwordx4 v8, s[12:15], s33 offen lds
    s_add_u32 s31, s31, 128
    v_mfma_f32_16x16x32_bf16 v[132:135], v[44:47], v[84:87], v[132:135]
    v_mfma_f32_16x16x32_bf16 v[136:139], v[44:47], v[88:91], v[136:139]
    ds_read_b64_tr_b16 v[36:37], v20 offset:64
    ds_read_b64_tr_b16 v[38:39], v20 offset:2368
    ds_read_b128 v[80:83], v19 offset:2048
    s_add_u32 m0, s29, 0xc800
    s_nop 0
    buffer_load_dwordx4 v9, s[16:19], s32 offen lds
    v_mfma_f32_16x16x32_bf16 v[100:103], v[48:51], v[92:95], v[100:103]
    v_mfma_f32_16x16x32_bf16 v[104:107], v[48:51], v[96:99], v[104:107]
    ds_read_b64_tr_b16 v[40:41], v20 offset:96
    ds_read_b64_tr_b16 v[42:43], v20 offset:2400
    s_add_u32 m0, s29, 0xe800
    s_nop 0
    buffer_load_dwordx4 v10, s[16:19], s32 offen lds
    v_mfma_f32_16x16x32_bf16 v[108:111], v[52:55], v[92:95], v[108:111]
    v_mfma_f32_16x16x32_bf16 v[112:115], v[52:55], v[96:99], v[112:115]
    ds_read_b64_tr_b16 v[44:45], v20 offset:128
    ds_read_b64_tr_b16 v[46:47], v20 offset:2432
    s_add_u32 m0, s30, 0x10800
    s_nop 0
    s_mov_b64 exec, 0xffff
    buffer_load_dwordx4 v11, s[16:19], s32 offen lds
    s_mov_b64 exec, -1
    s_add_u32 s32, s32, 0x4800
    v_mfma_f32_16x16x32_bf16 v[116:119], v[56:59], v[92:95], v[116:119]
    v_mfma_f32_16x16x32_bf16 v[120:123], v[56:59], v[96:99], v[120:123]
    ds_read_b64_tr_b16 v[48:49], v20 offset:9216
    s_waitcnt lgkmcnt(13)
    ds_read_b64_tr_b16 v[50:51], v20 offset:11520
    v_mfma_f32_16x16x32_bf16 v[124:127], v[60:63], v[92:95], v[124:127]
    v_mfma_f32_16x16x32_bf16 v[128:131], v[60:63], v[96:99], v[128:131]
    ds_read_b64_tr_b16 v[52:53], v20 offset:9248
    s_waitcnt lgkmcnt(13)
    ds_read_b64_tr_b16 v[54:55], v20 offset:11552
    v_mfma_f32_16x16x32_bf16 v[132:135], v[64:67], v[92:95], v[132:135]
    v_mfma_f32_16x16x32_bf16 v[136:139], v[64:67], v[96:99], v[136:139]
    ds_read_b64_tr_b16 v[56:57], v20 offset:9280
    s_waitcnt lgkmcnt(13)
    ds_read_b64_tr_b16 v[58:59], v20 offset:11584
    s_mov_b32 s40, 2
LP_rompt_kernel_44:
    v_mfma_f32_16x16x32_bf16 v[100:103], v[28:31], v[68:71], v[100:103]
    v_mfma_f32_16x16x32_bf16 v[104:107], v[28:31], v[72:75], v[104:107]
    ds_read_b64_tr_b16 v[60:61], v20 offset:9312
    s_waitcnt lgkmcnt(13)
    ds_read_b64_tr_b16 v[62:63], v20 offset:11616
    v_mfma_f32_16x16x32_bf16 v[108:111], v[32:35], v[68:71], v[108:111]
    v_mfma_f32_16x16x32_bf16 v[112:115], v[32:35], v[72:75], v[112:115]
    ds_read_b64_tr_b16 v[64:65], v20 offset:9344
    s_waitcnt lgkmcnt(13)
    ds_read_b64_tr_b16 v[66:67], v20 offset:11648
    v_mfma_f32_16x16x32_bf16 v[116:119], v[36:39], v[68:71], v[116:119]
    v_mfma_f32_16x16x32_bf16 v[120:123], v[36:39], v[72:75], v[120:123]
    s_waitcnt vmcnt(10) lgkmcnt(0)
    s_barrier
    ds_read_b128 v[84:87], v21 offset:0
    ds_read_b128 v[88:91], v21 offset:2048
    ds_read_b64_tr_b16 v[28:29], v23 offset:0
    ds_read_b64_tr_b16 v[30:31], v23 offset:2304
    s_add_u32 m0, s29, 0x11000
    s_nop 0
    buffer_load_dwordx4 v8, s[12:15], s31 offen lds
    v_mfma_f32_16x16x32_bf16 v[124:127], v[40:43], v[68:71], v[124:127]
    v_mfma_f32_16x16x32_bf16 v[128:131], v[40:43], v[72:75], v[128:131]
    ds_read_b64_tr_b16 v[32:33], v23 offset:32
    ds_read_b64_tr_b16 v[34:35], v23 offset:2336
    ds_read_b128 v[92:95], v22 offset:0
    s_add_u32 m0, s29, 0x13000
    s_add_u32 s33, s31, 0x40000
    buffer_load_dwordx4 v8, s[12:15], s33 offen lds
    s_add_u32 s31, s31, 128
    v_mfma_f32_16x16x32_bf16 v[132:135], v[44:47], v[68:71], v[132:135]
    v_mfma_f32_16x16x32_bf16 v[136:139], v[44:47], v[72:75], v[136:139]
    ds_read_b64_tr_b16 v[36:37], v23 offset:64
    ds_read_b64_tr_b16 v[38:39], v23 offset:2368
    ds_read_b128 v[96:99], v22 offset:2048
    s_add_u32 m0, s29, 0x15000
    s_nop 0
    buffer_load_dwordx4 v9, s[16:19], s32 offen lds
    v_mfma_f32_16x16x32_bf16 v[100:103], v[48:51], v[76:79], v[100:103]
    v_mfma_f32_16x16x32_bf16 v[104:107], v[48:51], v[80:83], v[104:107]
    ds_read_b64_tr_b16 v[40:41], v23 offset:96
    ds_read_b64_tr_b16 v[42:43], v23 offset:2400
    s_add_u32 m0, s29, 0x17000
    s_nop 0
    buffer_load_dwordx4 v10, s[16:19], s32 offen lds
    v_mfma_f32_16x16x32_bf16 v[108:111], v[52:55], v[76:79], v[108:111]
    v_mfma_f32_16x16x32_bf16 v[112:115], v[52:55], v[80:83], v[112:115]
    ds_read_b64_tr_b16 v[44:45], v23 offset:128
    ds_read_b64_tr_b16 v[46:47], v23 offset:2432
    s_add_u32 m0, s30, 0x19000
    s_nop 0
    s_mov_b64 exec, 0xffff
    buffer_load_dwordx4 v11, s[16:19], s32 offen lds
    s_mov_b64 exec, -1
    s_add_u32 s32, s32, 0x4800
    v_mfma_f32_16x16x32_bf16 v[116:119], v[56:59], v[76:79], v[116:119]
    v_mfma_f32_16x16x32_bf16 v[120:123], v[56:59], v[80:83], v[120:123]
    ds_read_b64_tr_b16 v[48:49], v23 offset:9216
    s_waitcnt lgkmcnt(13)
    ds_read_b64_tr_b16 v[50:51], v23 offset:11520
    v_mfma_f32_16x16x32_bf16 v[124:127], v[60:63], v[76:79], v[124:127]
    v_mfma_f32_16x16x32_bf16 v[128:131], v[60:63], v[80:83], v[128:131]
    ds_read_b64_tr_b16 v[52:53], v23 offset:9248
    s_waitcnt lgkmcnt(13)
    ds_read_b64_tr_b16 v[54:55], v23 offset:11552
    v_mfma_f32_16x16x32_bf16 v[132:135], v[64:67], v[76:79], v[132:135]
    v_mfma_f32_16x16x32_bf16 v[136:139], v[64:67], v[80:83], v[136:139]
    ds_read_b64_tr_b16 v[56:57], v23 offset:9280
    s_waitcnt lgkmcnt(13)
    ds_read_b64_tr_b16 v[58:59], v23 offset:11584
    v_mfma_f32_16x16x32_bf16 v[100:103], v[28:31], v[84:87], v[100:103]
    v_mfma_f32_16x16x32_bf16 v[104:107], v[28:31], v[88:91], v[104:107]
    ds_read_b64_tr_b16 v[60:61], v23 offset:9312
    s_waitcnt lgkmcnt(13)
    ds_read_b64_tr_b16 v[62:63], v23 offset:11616
    v_mfma_f32_16x16x32_bf16 v[108:111], v[32:35], v[84:87], v[108:111]
    v_mfma_f32_16x16x32_bf16 v[112:115], v[32:35], v[88:91], v[112:115]
    ds_read_b64_tr_b16 v[64:65], v23 offset:9344
    s_waitcnt lgkmcnt(13)
    ds_read_b64_tr_b16 v[66:67], v23 offset:11648
    v_mfma_f32_16x16x32_bf16 v[116:119], v[36:39], v[84:87], v[116:119]
    v_mfma_f32_16x16x32_bf16 v[120:123], v[36:39], v[88:91], v[120:123]
    s_waitcnt vmcnt(10) lgkmcnt(0)
    s_barrier
    ds_read_b128 v[68:71], v12 offset:0
    ds_read_b128 v[72:75], v12 offset:2048
    ds_read_b64_tr_b16 v[28:29], v14 offset:0
    ds_read_b64_tr_b16 v[30:31], v14 offset:2304
    s_add_u32 m0, s29, 0x19800
    s_nop 0
    buffer_load_dwordx4 v8, s[12:15], s31 offen lds
    v_mfma_f32_16x16x32_bf16 v[124:127], v[40:43], v[84:87], v[124:127]
    v_mfma_f32_16x16x32_bf16 v[128:131], v[40:43], v[88:91], v[128:131]
    ds_read_b64_tr_b16 v[32:33], v14 offset:32
    ds_read_b64_tr_b16 v[34:35], v14 offset:2336
    ds_read_b128 v[76:79], v13 offset:0
    s_add_u32 m0, s29, 0x1b800
    s_add_u32 s33, s31, 0x40000
    buffer_load_dwordx4 v8, s[12:15], s33 offen lds
    s_add_u32 s31, s31, 128
    v_mfma_f32_16x16x32_bf16 v[132:135], v[44:47], v[84:87], v[132:135]
    v_mfma_f32_16x16x32_bf16 v[136:139], v[44:47], v[88:91], v[136:139]
    ds_read_b64_tr_b16 v[36:37], v14 offset:64
    ds_read_b64_tr_b16 v[38:39], v14 offset:2368
    ds_read_b128 v[80:83], v13 offset:2048
    s_add_u32 m0, s29, 0x1d800
    s_nop 0
    buffer_load_dwordx4 v9, s[16:19], s32 offen lds
    v_mfma_f32_16x16x32_bf16 v[100:103], v[48:51], v[92:95], v[100:103]
    v_mfma_f32_16x16x32_bf16 v[104:107], v[48:51], v[96:99], v[104:107]
    ds_read_b64_tr_b16 v[40:41], v14 offset:96
    ds_read_b64_tr_b16 v[42:43], v14 offset:2400
    s_add_u32 m0, s29, 0x1f800
    s_nop 0
    buffer_load_dwordx4 v10, s[16:19], s32 offen lds
    v_mfma_f32_16x16x32_bf16 v[108:111], v[52:55], v[92:95], v[108:111]
    v_mfma_f32_16x16x32_bf16 v[112:115], v[52:55], v[96:99], v[112:115]
    ds_read_b64_tr_b16 v[44:45], v14 offset:128
    ds_read_b64_tr_b16 v[46:47], v14 offset:2432
    s_add_u32 m0, s30, 0x21800
    s_nop 0
    s_mov_b64 exec, 0xffff
    buffer_load_dwordx4 v11, s[16:19], s32 offen lds
    s_mov_b64 exec, -1
    s_add_u32 s32, s32, 0x4800
    v_mfma_f32_16x16x32_bf16 v[116:119], v[56:59], v[92:95], v[116:119]
    v_mfma_f32_16x16x32_bf16 v[120:123], v[56:59], v[96:99], v[120:123]
    ds_read_b64_tr_b16 v[48:49], v14 offset:9216
    s_waitcnt lgkmcnt(13)
    ds_read_b64_tr_b16 v[50:51], v14 offset:11520
    v_mfma_f32_16x16x32_bf16 v[124:127], v[60:63], v[92:95], v[124:127]
    v_mfma_f32_16x16x32_bf16 v[128:131], v[60:63], v[96:99], v[128:131]
    ds_read_b64_tr_b16 v[52:53], v14 offset:9248
    s_waitcnt lgkmcnt(13)
    ds_read_b64_tr_b16 v[54:55], v14 offset:11552
    v_mfma_f32_16x16x32_bf16 v[132:135], v[64:67], v[92:95], v[132:135]
    v_mfma_f32_16x16x32_bf16 v[136:139], v[64:67], v[96:99], v[136:139]
    ds_read_b64_tr_b16 v[56:57], v14 offset:9280
    s_waitcnt lgkmcnt(13)
    ds_read_b64_tr_b16 v[58:59], v14 offset:11584
    v_mfma_f32_16x16x32_bf16 v[100:103], v[28:31], v[68:71], v[100:103]
    v_mfma_f32_16x16x32_bf16 v[104:107], v[28:31], v[72:75], v[104:107]
    ds_read_b64_tr_b16 v[60:61], v14 offset:9312
    s_waitcnt lgkmcnt(13)
    ds_read_b64_tr_b16 v[62:63], v14 offset:11616
    v_mfma_f32_16x16x32_bf16 v[108:111], v[32:35], v[68:71], v[108:111]
    v_mfma_f32_16x16x32_bf16 v[112:115], v[32:35], v[72:75], v[112:115]
    ds_read_b64_tr_b16 v[64:65], v14 offset:9344
    s_waitcnt lgkmcnt(13)
    ds_read_b64_tr_b16 v[66:67], v14 offset:11648
    v_mfma_f32_16x16x32_bf16 v[116:119], v[36:39], v[68:71], v[116:119]
    v_mfma_f32_16x16x32_bf16 v[120:123], v[36:39], v[72:75], v[120:123]
    s_waitcnt vmcnt(10) lgkmcnt(0)
    s_barrier
    ds_read_b128 v[84:87], v15 offset:0
    ds_read_b128 v[88:91], v15 offset:2048
    ds_read_b64_tr_b16 v[28:29], v17 offset:0
    ds_read_b64_tr_b16 v[30:31], v17 offset:2304
    s_add_u32 m0, s29, 0x0
    s_nop 0
    buffer_load_dwordx4 v8, s[12:15], s31 offen lds
    v_mfma_f32_16x16x32_bf16 v[124:127], v[40:43], v[68:71], v[124:127]
    v_mfma_f32_16x16x32_bf16 v[128:131], v[40:43], v[72:75], v[128:131]
    ds_read_b64_tr_b16 v[32:33], v17 offset:32
    ds_read_b64_tr_b16 v[34:35], v17 offset:2336
    ds_read_b128 v[92:95], v16 offset:0
    s_add_u32 m0, s29, 0x2000
    s_add_u32 s33, s31, 0x40000
    buffer_load_dwordx4 v8, s[12:15], s33 offen lds
    s_add_u32 s31, s31, 128
    v_mfma_f32_16x16x32_bf16 v[132:135], v[44:47], v[68:71], v[132:135]
    v_mfma_f32_16x16x32_bf16 v[136:139], v[44:47], v[72:75], v[136:139]
    ds_read_b64_tr_b16 v[36:37], v17 offset:64
    ds_read_b64_tr_b16 v[38:39], v17 offset:2368
    ds_read_b128 v[96:99], v16 offset:2048
    s_add_u32 m0, s29, 0x4000
    s_nop 0
    buffer_load_dwordx4 v9, s[16:19], s32 offen lds
    v_mfma_f32_16x16x32_bf16 v[100:103], v[48:51], v[76:79], v[100:103]
    v_mfma_f32_16x16x32_bf16 v[104:107], v[48:51], v[80:83], v[104:107]
    ds_read_b64_tr_b16 v[40:41], v17 offset:96
    ds_read_b64_tr_b16 v[42:43], v17 offset:2400
    s_add_u32 m0, s29, 0x6000
    s_nop 0
    buffer_load_dwordx4 v10, s[16:19], s32 offen lds
    v_mfma_f32_16x16x32_bf16 v[108:111], v[52:55], v[76:79], v[108:111]
    v_mfma_f32_16x16x32_bf16 v[112:115], v[52:55], v[80:83], v[112:115]
    ds_read_b64_tr_b16 v[44:45], v17 offset:128
    ds_read_b64_tr_b16 v[46:47], v17 offset:2432
    s_add_u32 m0, s30, 0x8000
    s_nop 0
    s_mov_b64 exec, 0xffff
    buffer_load_dwordx4 v11, s[16:19], s32 offen lds
    s_mov_b64 exec, -1
    s_add_u32 s32, s32, 0x4800
    v_mfma_f32_16x16x32_bf16 v[116:119], v[56:59], v[76:79], v[116:119]
    v_mfma_f32_16x16x32_bf16 v[120:123], v[56:59], v[80:83], v[120:123]
    ds_read_b64_tr_b16 v[48:49], v17 offset:9216
    s_waitcnt lgkmcnt(13)
    ds_read_b64_tr_b16 v[50:51], v17 offset:11520
    v_mfma_f32_16x16x32_bf16 v[124:127], v[60:63], v[76:79], v[124:127]
    v_mfma_f32_16x16x32_bf16 v[128:131], v[60:63], v[80:83], v[128:131]
    ds_read_b64_tr_b16 v[52:53], v17 offset:9248
    s_waitcnt lgkmcnt(13)
    ds_read_b64_tr_b16 v[54:55], v17 offset:11552
    v_mfma_f32_16x16x32_bf16 v[132:135], v[64:67], v[76:79], v[132:135]
    v_mfma_f32_16x16x32_bf16 v[136:139], v[64:67], v[80:83], v[136:139]
    ds_read_b64_tr_b16 v[56:57], v17 offset:9280
    s_waitcnt lgkmcnt(13)
    ds_read_b64_tr_b16 v[58:59], v17 offset:11584
    v_mfma_f32_16x16x32_bf16 v[100:103], v[28:31], v[84:87], v[100:103]
    v_mfma_f32_16x16x32_bf16 v[104:107], v[28:31], v[88:91], v[104:107]
    ds_read_b64_tr_b16 v[60:61], v17 offset:9312
    s_waitcnt lgkmcnt(13)
    ds_read_b64_tr_b16 v[62:63], v17 offset:11616
    v_mfma_f32_16x16x32_bf16 v[108:111], v[32:35], v[84:87], v[108:111]
    v_mfma_f32_16x16x32_bf16 v[112:115], v[32:35], v[88:91], v[112:115]
    ds_read_b64_tr_b16 v[64:65], v17 offset:9344
    s_waitcnt lgkmcnt(13)
    ds_read_b64_tr_b16 v[66:67], v17 offset:11648
    v_mfma_f32_16x16x32_bf16 v[116:119], v[36:39], v[84:87], v[116:119]
    v_mfma_f32_16x16x32_bf16 v[120:123], v[36:39], v[88:91], v[120:123]
    s_waitcnt vmcnt(10) lgkmcnt(0)
    s_barrier
    ds_read_b128 v[68:71], v18 offset:0
    ds_read_b128 v[72:75], v18 offset:2048
    ds_read_b64_tr_b16 v[28:29], v20 offset:0
    ds_read_b64_tr_b16 v[30:31], v20 offset:2304
    s_add_u32 m0, s29, 0x8800
    s_nop 0
    buffer_load_dwordx4 v8, s[12:15], s31 offen lds
    v_mfma_f32_16x16x32_bf16 v[124:127], v[40:43], v[84:87], v[124:127]
    v_mfma_f32_16x16x32_bf16 v[128:131], v[40:43], v[88:91], v[128:131]
    ds_read_b64_tr_b16 v[32:33], v20 offset:32
    ds_read_b64_tr_b16 v[34:35], v20 offset:2336
    ds_read_b128 v[76:79], v19 offset:0
    s_add_u32 m0, s29, 0xa800
    s_add_u32 s33, s31, 0x40000
    buffer_load_dwordx4 v8, s[12:15], s33 offen lds
    s_add_u32 s31, s31, 128
    v_mfma_f32_16x16x32_bf16 v[132:135], v[44:47], v[84:87], v[132:135]
    v_mfma_f32_16x16x32_bf16 v[136:139], v[44:47], v[88:91], v[136:139]
    ds_read_b64_tr_b16 v[36:37], v20 offset:64
    ds_read_b64_tr_b16 v[38:39], v20 offset:2368
    ds_read_b128 v[80:83], v19 offset:2048
    s_add_u32 m0, s29, 0xc800
    s_nop 0
    buffer_load_dwordx4 v9, s[16:19], s32 offen lds
    v_mfma_f32_16x16x32_bf16 v[100:103], v[48:51], v[92:95], v[100:103]
    v_mfma_f32_16x16x32_bf16 v[104:107], v[48:51], v[96:99], v[104:107]
    ds_read_b64_tr_b16 v[40:41], v20 offset:96
    ds_read_b64_tr_b16 v[42:43], v20 offset:2400
    s_add_u32 m0, s29, 0xe800
    s_nop 0
    buffer_load_dwordx4 v10, s[16:19], s32 offen lds
    v_mfma_f32_16x16x32_bf16 v[108:111], v[52:55], v[92:95], v[108:111]
    v_mfma_f32_16x16x32_bf16 v[112:115], v[52:55], v[96:99], v[112:115]
    ds_read_b64_tr_b16 v[44:45], v20 offset:128
    ds_read_b64_tr_b16 v[46:47], v20 offset:2432
    s_add_u32 m0, s30, 0x10800
    s_nop 0
    s_mov_b64 exec, 0xffff
    buffer_load_dwordx4 v11, s[16:19], s32 offen lds
    s_mov_b64 exec, -1
    s_add_u32 s32, s32, 0x4800
    v_mfma_f32_16x16x32_bf16 v[116:119], v[56:59], v[92:95], v[116:119]
    v_mfma_f32_16x16x32_bf16 v[120:123], v[56:59], v[96:99], v[120:123]
    ds_read_b64_tr_b16 v[48:49], v20 offset:9216
    s_waitcnt lgkmcnt(13)
    ds_read_b64_tr_b16 v[50:51], v20 offset:11520
    v_mfma_f32_16x16x32_bf16 v[124:127], v[60:63], v[92:95], v[124:127]
    v_mfma_f32_16x16x32_bf16 v[128:131], v[60:63], v[96:99], v[128:131]
    ds_read_b64_tr_b16 v[52:53], v20 offset:9248
    s_waitcnt lgkmcnt(13)
    ds_read_b64_tr_b16 v[54:55], v20 offset:11552
    v_mfma_f32_16x16x32_bf16 v[132:135], v[64:67], v[92:95], v[132:135]
    v_mfma_f32_16x16x32_bf16 v[136:139], v[64:67], v[96:99], v[136:139]
    ds_read_b64_tr_b16 v[56:57], v20 offset:9280
    s_waitcnt lgkmcnt(13)
    ds_read_b64_tr_b16 v[58:59], v20 offset:11584
    s_sub_u32 s40, s40, 1
    s_cmp_lg_u32 s40, 0
    s_cbranch_scc1 LP_rompt_kernel_44
    v_mfma_f32_16x16x32_bf16 v[100:103], v[28:31], v[68:71], v[100:103]
    v_mfma_f32_16x16x32_bf16 v[104:107], v[28:31], v[72:75], v[104:107]
    ds_read_b64_tr_b16 v[60:61], v20 offset:9312
    s_waitcnt lgkmcnt(13)
    ds_read_b64_tr_b16 v[62:63], v20 offset:11616
    v_mfma_f32_16x16x32_bf16 v[108:111], v[32:35], v[68:71], v[108:111]
    v_mfma_f32_16x16x32_bf16 v[112:115], v[32:35], v[72:75], v[112:115]
    ds_read_b64_tr_b16 v[64:65], v20 offset:9344
    s_waitcnt lgkmcnt(13)
    ds_read_b64_tr_b16 v[66:67], v20 offset:11648
    v_mfma_f32_16x16x32_bf16 v[116:119], v[36:39], v[68:71], v[116:119]
    v_mfma_f32_16x16x32_bf16 v[120:123], v[36:39], v[72:75], v[120:123]
    s_waitcnt vmcnt(10) lgkmcnt(0)
    s_barrier
    ds_read_b128 v[84:87], v21 offset:0
    ds_read_b128 v[88:91], v21 offset:2048
    ds_read_b64_tr_b16 v[28:29], v23 offset:0
    ds_read_b64_tr_b16 v[30:31], v23 offset:2304
    s_add_u32 m0, s29, 0x11000
    s_nop 0
    buffer_load_dwordx4 v8, s[12:15], s31 offen lds
    v_mfma_f32_16x16x32_bf16 v[124:127], v[40:43], v[68:71], v[124:127]
    v_mfma_f32_16x16x32_bf16 v[128:131], v[40:43], v[72:75], v[128:131]
    ds_read_b64_tr_b16 v[32:33], v23 offset:32
    ds_read_b64_tr_b16 v[34:35], v23 offset:2336
    ds_read_b128 v[92:95], v22 offset:0
    s_add_u32 m0, s29, 0x13000
    s_add_u32 s33, s31, 0x40000
    buffer_load_dwordx4 v8, s[12:15], s33 offen lds
    s_add_u32 s31, s31, 128
    v_mfma_f32_16x16x32_bf16 v[132:135], v[44:47], v[68:71], v[132:135]
    v_mfma_f32_16x16x32_bf16 v[136:139], v[44:47], v[72:75], v[136:139]
    ds_read_b64_tr_b16 v[36:37], v23 offset:64
    ds_read_b64_tr_b16 v[38:39], v23 offset:2368
    ds_read_b128 v[96:99], v22 offset:2048
    s_add_u32 m0, s29, 0x15000
    s_nop 0
    buffer_load_dwordx4 v9, s[16:19], s32 offen lds
    v_mfma_f32_16x16x32_bf16 v[100:103], v[48:51], v[76:79], v[100:103]
    v_mfma_f32_16x16x32_bf16 v[104:107], v[48:51], v[80:83], v[104:107]
    ds_read_b64_tr_b16 v[40:41], v23 offset:96
    ds_read_b64_tr_b16 v[42:43], v23 offset:2400
    s_add_u32 m0, s29, 0x17000
    s_nop 0
    buffer_load_dwordx4 v10, s[16:19], s32 offen lds
    v_mfma_f32_16x16x32_bf16 v[108:111], v[52:55], v[76:79], v[108:111]
    v_mfma_f32_16x16x32_bf16 v[112:115], v[52:55], v[80:83], v[112:115]
    ds_read_b64_tr_b16 v[44:45], v23 offset:128
    ds_read_b64_tr_b16 v[46:47], v23 offset:2432
    s_add_u32 m0, s30, 0x19000
    s_nop 0
    s_mov_b64 exec, 0xffff
    buffer_load_dwordx4 v11, s[16:19], s32 offen lds
    s_mov_b64 exec, -1
    s_add_u32 s32, s32, 0x4800
    v_mfma_f32_16x16x32_bf16 v[116:119], v[56:59], v[76:79], v[116:119]
    v_mfma_f32_16x16x32_bf16 v[120:123], v[56:59], v[80:83], v[120:123]
    ds_read_b64_tr_b16 v[48:49], v23 offset:9216
    s_waitcnt lgkmcnt(13)
    ds_read_b64_tr_b16 v[50:51], v23 offset:11520
    v_mfma_f32_16x16x32_bf16 v[124:127], v[60:63], v[76:79], v[124:127]
    v_mfma_f32_16x16x32_bf16 v[128:131], v[60:63], v[80:83], v[128:131]
    ds_read_b64_tr_b16 v[52:53], v23 offset:9248
    s_waitcnt lgkmcnt(13)
    ds_read_b64_tr_b16 v[54:55], v23 offset:11552
    v_mfma_f32_16x16x32_bf16 v[132:135], v[64:67], v[76:79], v[132:135]
    v_mfma_f32_16x16x32_bf16 v[136:139], v[64:67], v[80:83], v[136:139]
    ds_read_b64_tr_b16 v[56:57], v23 offset:9280
    s_waitcnt lgkmcnt(13)
    ds_read_b64_tr_b16 v[58:59], v23 offset:11584
    v_mfma_f32_16x16x32_bf16 v[100:103], v[28:31], v[84:87], v[100:103]
    v_mfma_f32_16x16x32_bf16 v[104:107], v[28:31], v[88:91], v[104:107]
    ds_read_b64_tr_b16 v[60:61], v23 offset:9312
    s_waitcnt lgkmcnt(13)
    ds_read_b64_tr_b16 v[62:63], v23 offset:11616
    v_mfma_f32_16x16x32_bf16 v[108:111], v[32:35], v[84:87], v[108:111]
    v_mfma_f32_16x16x32_bf16 v[112:115], v[32:35], v[88:91], v[112:115]
    ds_read_b64_tr_b16 v[64:65], v23 offset:9344
    s_waitcnt lgkmcnt(13)
    ds_read_b64_tr_b16 v[66:67], v23 offset:11648
    v_mfma_f32_16x16x32_bf16 v[116:119], v[36:39], v[84:87], v[116:119]
    v_mfma_f32_16x16x32_bf16 v[120:123], v[36:39], v[88:91], v[120:123]
    s_waitcnt vmcnt(10) lgkmcnt(0)
    s_barrier
    ds_read_b128 v[68:71], v12 offset:0
    ds_read_b128 v[72:75], v12 offset:2048
    ds_read_b64_tr_b16 v[28:29], v14 offset:0
    ds_read_b64_tr_b16 v[30:31], v14 offset:2304
    s_add_u32 m0, s29, 0x19800
    s_nop 0
    buffer_load_dwordx4 v8, s[12:15], s31 offen lds
    v_mfma_f32_16x16x32_bf16 v[124:127], v[40:43], v[84:87], v[124:127]
    v_mfma_f32_16x16x32_bf16 v[128:131], v[40:43], v[88:91], v[128:131]
    ds_read_b64_tr_b16 v[32:33], v14 offset:32
    ds_read_b64_tr_b16 v[34:35], v14 offset:2336
    ds_read_b128 v[76:79], v13 offset:0
    s_add_u32 m0, s29, 0x1b800
    s_add_u32 s33, s31, 0x40000
    buffer_load_dwordx4 v8, s[12:15], s33 offen lds
    s_add_u32 s31, s31, 128
    v_mfma_f32_16x16x32_bf16 v[132:135], v[44:47], v[84:87], v[132:135]
    v_mfma_f32_16x16x32_bf16 v[136:139], v[44:47], v[88:91], v[136:139]
    ds_read_b64_tr_b16 v[36:37], v14 offset:64
    ds_read_b64_tr_b16 v[38:39], v14 offset:2368
    ds_read_b128 v[80:83], v13 offset:2048
    s_add_u32 m0, s29, 0x1d800
    s_nop 0
    buffer_load_dwordx4 v9, s[16:19], s32 offen lds
    v_mfma_f32_16x16x32_bf16 v[100:103], v[48:51], v[92:95], v[100:103]
    v_mfma_f32_16x16x32_bf16 v[104:107], v[48:51], v[96:99], v[104:107]
    ds_read_b64_tr_b16 v[40:41], v14 offset:96
    ds_read_b64_tr_b16 v[42:43], v14 offset:2400
    s_add_u32 m0, s29, 0x1f800
    s_nop 0
    buffer_load_dwordx4 v10, s[16:19], s32 offen lds
    v_mfma_f32_16x16x32_bf16 v[108:111], v[52:55], v[92:95], v[108:111]
    v_mfma_f32_16x16x32_bf16 v[112:115], v[52:55], v[96:99], v[112:115]
    ds_read_b64_tr_b16 v[44:45], v14 offset:128
    ds_read_b64_tr_b16 v[46:47], v14 offset:2432
    s_add_u32 m0, s30, 0x21800
    s_nop 0
    s_mov_b64 exec, 0xffff
    buffer_load_dwordx4 v11, s[16:19], s32 offen lds
    s_mov_b64 exec, -1
    s_add_u32 s32, s32, 0x4800
    v_mfma_f32_16x16x32_bf16 v[116:119], v[56:59], v[92:95], v[116:119]
    v_mfma_f32_16x16x32_bf16 v[120:123], v[56:59], v[96:99], v[120:123]
    ds_read_b64_tr_b16 v[48:49], v14 offset:9216
    s_waitcnt lgkmcnt(13)
    ds_read_b64_tr_b16 v[50:51], v14 offset:11520
    v_mfma_f32_16x16x32_bf16 v[124:127], v[60:63], v[92:95], v[124:127]
    v_mfma_f32_16x16x32_bf16 v[128:131], v[60:63], v[96:99], v[128:131]
    ds_read_b64_tr_b16 v[52:53], v14 offset:9248
    s_waitcnt lgkmcnt(13)
    ds_read_b64_tr_b16 v[54:55], v14 offset:11552
    v_mfma_f32_16x16x32_bf16 v[132:135], v[64:67], v[92:95], v[132:135]
    v_mfma_f32_16x16x32_bf16 v[136:139], v[64:67], v[96:99], v[136:139]
    ds_read_b64_tr_b16 v[56:57], v14 offset:9280
    s_waitcnt lgkmcnt(13)
    ds_read_b64_tr_b16 v[58:59], v14 offset:11584
    v_mfma_f32_16x16x32_bf16 v[100:103], v[28:31], v[68:71], v[100:103]
    v_mfma_f32_16x16x32_bf16 v[104:107], v[28:31], v[72:75], v[104:107]
    ds_read_b64_tr_b16 v[60:61], v14 offset:9312
    s_waitcnt lgkmcnt(13)
    ds_read_b64_tr_b16 v[62:63], v14 offset:11616
    v_mfma_f32_16x16x32_bf16 v[108:111], v[32:35], v[68:71], v[108:111]
    v_mfma_f32_16x16x32_bf16 v[112:115], v[32:35], v[72:75], v[112:115]
    ds_read_b64_tr_b16 v[64:65], v14 offset:9344
    s_waitcnt lgkmcnt(13)
    ds_read_b64_tr_b16 v[66:67], v14 offset:11648
    v_mfma_f32_16x16x32_bf16 v[116:119], v[36:39], v[68:71], v[116:119]
    v_mfma_f32_16x16x32_bf16 v[120:123], v[36:39], v[72:75], v[120:123]
    s_waitcnt vmcnt(10) lgkmcnt(0)
    s_barrier
    ds_read_b128 v[84:87], v15 offset:0
    ds_read_b128 v[88:91], v15 offset:2048
    ds_read_b64_tr_b16 v[28:29], v17 offset:0
    ds_read_b64_tr_b16 v[30:31], v17 offset:2304
    v_mfma_f32_16x16x32_bf16 v[124:127], v[40:43], v[68:71], v[124:127]
    v_mfma_f32_16x16x32_bf16 v[128:131], v[40:43], v[72:75], v[128:131]
    ds_read_b64_tr_b16 v[32:33], v17 offset:32
    ds_read_b64_tr_b16 v[34:35], v17 offset:2336
    ds_read_b128 v[92:95], v16 offset:0
    v_mfma_f32_16x16x32_bf16 v[132:135], v[44:47], v[68:71], v[132:135]
    v_mfma_f32_16x16x32_bf16 v[136:139], v[44:47], v[72:75], v[136:139]
    ds_read_b64_tr_b16 v[36:37], v17 offset:64
    ds_read_b64_tr_b16 v[38:39], v17 offset:2368
    ds_read_b128 v[96:99], v16 offset:2048
    v_mfma_f32_16x16x32_bf16 v[100:103], v[48:51], v[76:79], v[100:103]
    v_mfma_f32_16x16x32_bf16 v[104:107], v[48:51], v[80:83], v[104:107]
    ds_read_b64_tr_b16 v[40:41], v17 offset:96
    ds_read_b64_tr_b16 v[42:43], v17 offset:2400
    v_mfma_f32_16x16x32_bf16 v[108:111], v[52:55], v[76:79], v[108:111]
    v_mfma_f32_16x16x32_bf16 v[112:115], v[52:55], v[80:83], v[112:115]
    ds_read_b64_tr_b16 v[44:45], v17 offset:128
    ds_read_b64_tr_b16 v[46:47], v17 offset:2432
    v_mfma_f32_16x16x32_bf16 v[116:119], v[56:59], v[76:79], v[116:119]
    v_mfma_f32_16x16x32_bf16 v[120:123], v[56:59], v[80:83], v[120:123]
    ds_read_b64_tr_b16 v[48:49], v17 offset:9216
    s_waitcnt lgkmcnt(13)
    ds_read_b64_tr_b16 v[50:51], v17 offset:11520
    v_mfma_f32_16x16x32_bf16 v[124:127], v[60:63], v[76:79], v[124:127]
    v_mfma_f32_16x16x32_bf16 v[128:131], v[60:63], v[80:83], v[128:131]
    ds_read_b64_tr_b16 v[52:53], v17 offset:9248
    s_waitcnt lgkmcnt(13)
    ds_read_b64_tr_b16 v[54:55], v17 offset:11552
    v_mfma_f32_16x16x32_bf16 v[132:135], v[64:67], v[76:79], v[132:135]
    v_mfma_f32_16x16x32_bf16 v[136:139], v[64:67], v[80:83], v[136:139]
    ds_read_b64_tr_b16 v[56:57], v17 offset:9280
    s_waitcnt lgkmcnt(13)
    ds_read_b64_tr_b16 v[58:59], v17 offset:11584
    v_mfma_f32_16x16x32_bf16 v[100:103], v[28:31], v[84:87], v[100:103]
    v_mfma_f32_16x16x32_bf16 v[104:107], v[28:31], v[88:91], v[104:107]
    ds_read_b64_tr_b16 v[60:61], v17 offset:9312
    s_waitcnt lgkmcnt(13)
    ds_read_b64_tr_b16 v[62:63], v17 offset:11616
    v_mfma_f32_16x16x32_bf16 v[108:111], v[32:35], v[84:87], v[108:111]
    v_mfma_f32_16x16x32_bf16 v[112:115], v[32:35], v[88:91], v[112:115]
    ds_read_b64_tr_b16 v[64:65], v17 offset:9344
    s_waitcnt lgkmcnt(13)
    ds_read_b64_tr_b16 v[66:67], v17 offset:11648
    v_mfma_f32_16x16x32_bf16 v[116:119], v[36:39], v[84:87], v[116:119]
    v_mfma_f32_16x16x32_bf16 v[120:123], v[36:39], v[88:91], v[120:123]
    s_waitcnt vmcnt(5) lgkmcnt(0)
    s_barrier
    ds_read_b128 v[68:71], v18 offset:0
    ds_read_b128 v[72:75], v18 offset:2048
    ds_read_b64_tr_b16 v[28:29], v20 offset:0
    ds_read_b64_tr_b16 v[30:31], v20 offset:2304
    v_mfma_f32_16x16x32_bf16 v[124:127], v[40:43], v[84:87], v[124:127]
    v_mfma_f32_16x16x32_bf16 v[128:131], v[40:43], v[88:91], v[128:131]
    ds_read_b64_tr_b16 v[32:33], v20 offset:32
    ds_read_b64_tr_b16 v[34:35], v20 offset:2336
    ds_read_b128 v[76:79], v19 offset:0
    v_mfma_f32_16x16x32_bf16 v[132:135], v[44:47], v[84:87], v[132:135]
    v_mfma_f32_16x16x32_bf16 v[136:139], v[44:47], v[88:91], v[136:139]
    ds_read_b64_tr_b16 v[36:37], v20 offset:64
    ds_read_b64_tr_b16 v[38:39], v20 offset:2368
    ds_read_b128 v[80:83], v19 offset:2048
    v_mfma_f32_16x16x32_bf16 v[100:103], v[48:51], v[92:95], v[100:103]
    v_mfma_f32_16x16x32_bf16 v[104:107], v[48:51], v[96:99], v[104:107]
    ds_read_b64_tr_b16 v[40:41], v20 offset:96
    ds_read_b64_tr_b16 v[42:43], v20 offset:2400
    v_mfma_f32_16x16x32_bf16 v[108:111], v[52:55], v[92:95], v[108:111]
    v_mfma_f32_16x16x32_bf16 v[112:115], v[52:55], v[96:99], v[112:115]
    ds_read_b64_tr_b16 v[44:45], v20 offset:128
    ds_read_b64_tr_b16 v[46:47], v20 offset:2432
    v_mfma_f32_16x16x32_bf16 v[116:119], v[56:59], v[92:95], v[116:119]
    v_mfma_f32_16x16x32_bf16 v[120:123], v[56:59], v[96:99], v[120:123]
    ds_read_b64_tr_b16 v[48:49], v20 offset:9216
    s_waitcnt lgkmcnt(13)
    ds_read_b64_tr_b16 v[50:51], v20 offset:11520
    v_mfma_f32_16x16x32_bf16 v[124:127], v[60:63], v[92:95], v[124:127]
    v_mfma_f32_16x16x32_bf16 v[128:131], v[60:63], v[96:99], v[128:131]
    ds_read_b64_tr_b16 v[52:53], v20 offset:9248
    s_waitcnt lgkmcnt(13)
    ds_read_b64_tr_b16 v[54:55], v20 offset:11552
    v_mfma_f32_16x16x32_bf16 v[132:135], v[64:67], v[92:95], v[132:135]
    v_mfma_f32_16x16x32_bf16 v[136:139], v[64:67], v[96:99], v[136:139]
    ds_read_b64_tr_b16 v[56:57], v20 offset:9280
    s_waitcnt lgkmcnt(13)
    ds_read_b64_tr_b16 v[58:59], v20 offset:11584
    v_mfma_f32_16x16x32_bf16 v[100:103], v[28:31], v[68:71], v[100:103]
    v_mfma_f32_16x16x32_bf16 v[104:107], v[28:31], v[72:75], v[104:107]
    ds_read_b64_tr_b16 v[60:61], v20 offset:9312
    s_waitcnt lgkmcnt(13)
    ds_read_b64_tr_b16 v[62:63], v20 offset:11616
    v_mfma_f32_16x16x32_bf16 v[108:111], v[32:35], v[68:71], v[108:111]
    v_mfma_f32_16x16x32_bf16 v[112:115], v[32:35], v[72:75], v[112:115]
    ds_read_b64_tr_b16 v[64:65], v20 offset:9344
    s_waitcnt lgkmcnt(13)
    ds_read_b64_tr_b16 v[66:67], v20 offset:11648
    v_mfma_f32_16x16x32_bf16 v[116:119], v[36:39], v[68:71], v[116:119]
    v_mfma_f32_16x16x32_bf16 v[120:123], v[36:39], v[72:75], v[120:123]
    s_waitcnt vmcnt(0) lgkmcnt(0)
    s_barrier
    ds_read_b128 v[84:87], v21 offset:0
    ds_read_b128 v[88:91], v21 offset:2048
    ds_read_b64_tr_b16 v[28:29], v23 offset:0
    ds_read_b64_tr_b16 v[30:31], v23 offset:2304
    v_mfma_f32_16x16x32_bf16 v[124:127], v[40:43], v[68:71], v[124:127]
    v_mfma_f32_16x16x32_bf16 v[128:131], v[40:43], v[72:75], v[128:131]
    ds_read_b64_tr_b16 v[32:33], v23 offset:32
    ds_read_b64_tr_b16 v[34:35], v23 offset:2336
    ds_read_b128 v[92:95], v22 offset:0
    v_mfma_f32_16x16x32_bf16 v[132:135], v[44:47], v[68:71], v[132:135]
    v_mfma_f32_16x16x32_bf16 v[136:139], v[44:47], v[72:75], v[136:139]
    ds_read_b64_tr_b16 v[36:37], v23 offset:64
    ds_read_b64_tr_b16 v[38:39], v23 offset:2368
    ds_read_b128 v[96:99], v22 offset:2048
    v_mfma_f32_16x16x32_bf16 v[100:103], v[48:51], v[76:79], v[100:103]
    v_mfma_f32_16x16x32_bf16 v[104:107], v[48:51], v[80:83], v[104:107]
    ds_read_b64_tr_b16 v[40:41], v23 offset:96
    ds_read_b64_tr_b16 v[42:43], v23 offset:2400
    v_mfma_f32_16x16x32_bf16 v[108:111], v[52:55], v[76:79], v[108:111]
    v_mfma_f32_16x16x32_bf16 v[112:115], v[52:55], v[80:83], v[112:115]
    ds_read_b64_tr_b16 v[44:45], v23 offset:128
    ds_read_b64_tr_b16 v[46:47], v23 offset:2432
    v_mfma_f32_16x16x32_bf16 v[116:119], v[56:59], v[76:79], v[116:119]
    v_mfma_f32_16x16x32_bf16 v[120:123], v[56:59], v[80:83], v[120:123]
    ds_read_b64_tr_b16 v[48:49], v23 offset:9216
    s_waitcnt lgkmcnt(13)
    ds_read_b64_tr_b16 v[50:51], v23 offset:11520
    v_mfma_f32_16x16x32_bf16 v[124:127], v[60:63], v[76:79], v[124:127]
    v_mfma_f32_16x16x32_bf16 v[128:131], v[60:63], v[80:83], v[128:131]
    ds_read_b64_tr_b16 v[52:53], v23 offset:9248
    s_waitcnt lgkmcnt(13)
    ds_read_b64_tr_b16 v[54:55], v23 offset:11552
    v_mfma_f32_16x16x32_bf16 v[132:135], v[64:67], v[76:79], v[132:135]
    v_mfma_f32_16x16x32_bf16 v[136:139], v[64:67], v[80:83], v[136:139]
    ds_read_b64_tr_b16 v[56:57], v23 offset:9280
    s_waitcnt lgkmcnt(13)
    ds_read_b64_tr_b16 v[58:59], v23 offset:11584
    v_mfma_f32_16x16x32_bf16 v[100:103], v[28:31], v[84:87], v[100:103]
    v_mfma_f32_16x16x32_bf16 v[104:107], v[28:31], v[88:91], v[104:107]
    ds_read_b64_tr_b16 v[60:61], v23 offset:9312
    s_waitcnt lgkmcnt(13)
    ds_read_b64_tr_b16 v[62:63], v23 offset:11616
    v_mfma_f32_16x16x32_bf16 v[108:111], v[32:35], v[84:87], v[108:111]
    v_mfma_f32_16x16x32_bf16 v[112:115], v[32:35], v[88:91], v[112:115]
    ds_read_b64_tr_b16 v[64:65], v23 offset:9344
    s_waitcnt lgkmcnt(13)
    ds_read_b64_tr_b16 v[66:67], v23 offset:11648
    v_mfma_f32_16x16x32_bf16 v[116:119], v[36:39], v[84:87], v[116:119]
    v_mfma_f32_16x16x32_bf16 v[120:123], v[36:39], v[88:91], v[120:123]
    s_waitcnt lgkmcnt(12)
    v_mfma_f32_16x16x32_bf16 v[124:127], v[40:43], v[84:87], v[124:127]
    v_mfma_f32_16x16x32_bf16 v[128:131], v[40:43], v[88:91], v[128:131]
    s_waitcnt lgkmcnt(10)
    v_mfma_f32_16x16x32_bf16 v[132:135], v[44:47], v[84:87], v[132:135]
    v_mfma_f32_16x16x32_bf16 v[136:139], v[44:47], v[88:91], v[136:139]
    s_waitcnt lgkmcnt(8)
    v_mfma_f32_16x16x32_bf16 v[100:103], v[48:51], v[92:95], v[100:103]
    v_mfma_f32_16x16x32_bf16 v[104:107], v[48:51], v[96:99], v[104:107]
    s_waitcnt lgkmcnt(6)
    v_mfma_f32_16x16x32_bf16 v[108:111], v[52:55], v[92:95], v[108:111]
    v_mfma_f32_16x16x32_bf16 v[112:115], v[52:55], v[96:99], v[112:115]
    s_waitcnt lgkmcnt(4)
    v_mfma_f32_16x16x32_bf16 v[116:119], v[56:59], v[92:95], v[116:119]
    v_mfma_f32_16x16x32_bf16 v[120:123], v[56:59], v[96:99], v[120:123]
    s_waitcnt lgkmcnt(2)
    v_mfma_f32_16x16x32_bf16 v[124:127], v[60:63], v[92:95], v[124:127]
    v_mfma_f32_16x16x32_bf16 v[128:131], v[60:63], v[96:99], v[128:131]
    s_waitcnt lgkmcnt(0)
    v_mfma_f32_16x16x32_bf16 v[132:135], v[64:67], v[92:95], v[132:135]
    v_mfma_f32_16x16x32_bf16 v[136:139], v[64:67], v[96:99], v[136:139]
    s_nop 7
    s_nop 3
    v_and_b32 v100, 0xfffe0000, v100
    v_or_b32 v100, 0x10000, v100
    v_cvt_pk_bf16_f32 v28, v100, v101
    v_cvt_pk_bf16_f32 v29, v102, v103
    v_or_b32 v28, 1, v28
    v_and_b32 v104, 0xfffe0000, v104
    v_or_b32 v104, 0x10000, v104
    v_cvt_pk_bf16_f32 v30, v104, v105
    v_cvt_pk_bf16_f32 v31, v106, v107
    v_or_b32 v30, 1, v30
    s_mov_b32 s33, 0
    s_nop 0
    v_permlane16_swap_b32 v28, v30
    v_permlane16_swap_b32 v29, v31
    s_nop 0
    buffer_store_dwordx4 v[28:31], v7, s[24:27], s33 offen offset:0 sc0 sc1
    v_and_b32 v108, 0xfffe0000, v108
    v_or_b32 v108, 0x10000, v108
    v_cvt_pk_bf16_f32 v32, v108, v109
    v_cvt_pk_bf16_f32 v33, v110, v111
    v_or_b32 v32, 1, v32
    v_and_b32 v112, 0xfffe0000, v112
    v_or_b32 v112, 0x10000, v112
    v_cvt_pk_bf16_f32 v34, v112, v113
    v_cvt_pk_bf16_f32 v35, v114, v115
    v_or_b32 v34, 1, v34
    s_nop 0
    s_nop 0
    v_permlane16_swap_b32 v32, v34
    v_permlane16_swap_b32 v33, v35
    s_nop 0
    buffer_store_dwordx4 v[32:35], v7, s[24:27], s33 offen offset:1024 sc0 sc1
    v_and_b32 v116, 0xfffe0000, v116
    v_or_b32 v116, 0x10000, v116
    v_cvt_pk_bf16_f32 v36, v116, v117
    v_cvt_pk_bf16_f32 v37, v118, v119
    v_or_b32 v36, 1, v36
    v_and_b32 v120, 0xfffe0000, v120
    v_or_b32 v120, 0x10000, v120
    v_cvt_pk_bf16_f32 v38, v120, v121
    v_cvt_pk_bf16_f32 v39, v122, v123
    v_or_b32 v38, 1, v38
    s_nop 0
    s_nop 0
    v_permlane16_swap_b32 v36, v38
    v_permlane16_swap_b32 v37, v39
    s_nop 0
    buffer_store_dwordx4 v[36:39], v7, s[24:27], s33 offen offset:2048 sc0 sc1
    v_and_b32 v124, 0xfffe0000, v124
    v_or_b32 v124, 0x10000, v124
    v_cvt_pk_bf16_f32 v40, v124, v125
    v_cvt_pk_bf16_f32 v41, v126, v127
    v_or_b32 v40, 1, v40
    v_and_b32 v128, 0xfffe0000, v128
    v_or_b32 v128, 0x10000, v128
    v_cvt_pk_bf16_f32 v42, v128, v129
    v_cvt_pk_bf16_f32 v43, v130, v131
    v_or_b32 v42, 1, v42
    s_nop 0
    s_nop 0
    v_permlane16_swap_b32 v40, v42
    v_permlane16_swap_b32 v41, v43
    s_nop 0
    buffer_store_dwordx4 v[40:43], v7, s[24:27], s33 offen offset:3072 sc0 sc1
    v_and_b32 v132, 0xfffe0000, v132
    v_or_b32 v132, 0x10000, v132
    v_cvt_pk_bf16_f32 v28, v132, v133
    v_cvt_pk_bf16_f32 v29, v134, v135
    v_or_b32 v28, 1, v28
    v_and_b32 v136, 0xfffe0000, v136
    v_or_b32 v136, 0x10000, v136
    v_cvt_pk_bf16_f32 v30, v136, v137
    v_cvt_pk_bf16_f32 v31, v138, v139
    v_or_b32 v30, 1, v30
    s_mov_b32 s33, 4096
    s_nop 0
    v_permlane16_swap_b32 v28, v30
    v_permlane16_swap_b32 v29, v31
    s_nop 0
    buffer_store_dwordx4 v[28:31], v7, s[24:27], s33 offen offset:0 sc0 sc1
    s_branch LJ_rompt_kernel_42
LG_rompt_kernel_43:
    ds_read_b128 v[68:71], v12 offset:0
    ds_read_b128 v[72:75], v12 offset:2048
    ds_read_b64_tr_b16 v[28:29], v14 offset:160
    ds_read_b64_tr_b16 v[30:31], v14 offset:2464
    ds_read_b64_tr_b16 v[32:33], v14 offset:192
    ds_read_b64_tr_b16 v[34:35], v14 offset:2496
    ds_read_b64_tr_b16 v[36:37], v14 offset:224
    ds_read_b64_tr_b16 v[38:39], v14 offset:2528
    ds_read_b64_tr_b16 v[40:41], v14 offset:256
    ds_read_b64_tr_b16 v[42:43], v14 offset:2560
    ds_read_b128 v[76:79], v13 offset:0
    ds_read_b128 v[80:83], v13 offset:2048
    ds_read_b64_tr_b16 v[44:45], v14 offset:9376
    ds_read_b64_tr_b16 v[46:47], v14 offset:11680
    ds_read_b64_tr_b16 v[48:49], v14 offset:9408
    s_waitcnt lgkmcnt(13)
    ds_read_b64_tr_b16 v[50:51], v14 offset:11712
    s_waitcnt lgkmcnt(12)
    v_mfma_f32_16x16x32_bf16 v[100:103], v[28:31], v[68:71], 0
    v_mfma_f32_16x16x32_bf16 v[104:107], v[28:31], v[72:75], 0
    ds_read_b64_tr_b16 v[52:53], v14 offset:9440
    ds_read_b64_tr_b16 v[54:55], v14 offset:11744
    s_waitcnt lgkmcnt(12)
    v_mfma_f32_16x16x32_bf16 v[108:111], v[32:35], v[68:71], 0
    v_mfma_f32_16x16x32_bf16 v[112:115], v[32:35], v[72:75], 0
    ds_read_b64_tr_b16 v[56:57], v14 offset:9472
    ds_read_b64_tr_b16 v[58:59], v14 offset:11776
    s_waitcnt lgkmcnt(12)
    v_mfma_f32_16x16x32_bf16 v[116:119], v[36:39], v[68:71], 0
    v_mfma_f32_16x16x32_bf16 v[120:123], v[36:39], v[72:75], 0
    s_waitcnt vmcnt(6) lgkmcnt(0)
    s_barrier
    ds_read_b128 v[84:87], v15 offset:0
    ds_read_b128 v[88:91], v15 offset:2048
    ds_read_b64_tr_b16 v[28:29], v17 offset:160
    ds_read_b64_tr_b16 v[30:31], v17 offset:2464
    s_add_u32 m0, s29, 0x0
    s_nop 0
    buffer_load_dwordx4 v8, s[12:15], s31 offen lds
    v_mfma_f32_16x16x32_bf16 v[124:127], v[40:43], v[68:71], 0
    v_mfma_f32_16x16x32_bf16 v[128:131], v[40:43], v[72:75], 0
    ds_read_b64_tr_b16 v[32:33], v17 offset:192
    ds_read_b64_tr_b16 v[34:35], v17 offset:2496
    ds_read_b128 v[92:95], v16 offset:0
    s_add_u32 m0, s29, 0x2000
    s_add_u32 s33, s31, 0x40000
    buffer_load_dwordx4 v8, s[12:15], s33 offen lds
    s_add_u32 s31, s31, 128
    v_mfma_f32_16x16x32_bf16 v[100:103], v[44:47], v[76:79], v[100:103]
    v_mfma_f32_16x16x32_bf16 v[104:107], v[44:47], v[80:83], v[104:107]
    ds_read_b64_tr_b16 v[36:37], v17 offset:224
    ds_read_b64_tr_b16 v[38:39], v17 offset:2528
    ds_read_b128 v[96:99], v16 offset:2048
    s_add_u32 m0, s29, 0x4000
    s_nop 0
    buffer_load_dwordx4 v9, s[16:19], s32 offen lds
    v_mfma_f32_16x16x32_bf16 v[108:111], v[48:51], v[76:79], v[108:111]
    v_mfma_f32_16x16x32_bf16 v[112:115], v[48:51], v[80:83], v[112:115]
    ds_read_b64_tr_b16 v[40:41], v17 offset:256
    ds_read_b64_tr_b16 v[42:43], v17 offset:2560
    s_add_u32 m0, s29, 0x6000
    s_nop 0
    buffer_load_dwordx4 v10, s[16:19], s32 offen lds
    v_mfma_f32_16x16x32_bf16 v[116:119], v[52:55], v[76:79], v[116:119]
    v_mfma_f32_16x16x32_bf16 v[120:123], v[52:55], v[80:83], v[120:123]
    ds_read_b64_tr_b16 v[44:45], v17 offset:9376
    ds_read_b64_tr_b16 v[46:47], v17 offset:11680
    s_add_u32 m0, s30, 0x8000
    s_nop 0
    s_mov_b64 exec, 0xffff
    buffer_load_dwordx4 v11, s[16:19], s32 offen lds
    s_mov_b64 exec, -1
    s_add_u32 s32, s32, 0x4800
    v_mfma_f32_16x16x32_bf16 v[124:127], v[56:59], v[76:79], v[124:127]
    v_mfma_f32_16x16x32_bf16 v[128:131], v[56:59], v[80:83], v[128:131]
    ds_read_b64_tr_b16 v[48:49], v17 offset:9408
    s_waitcnt lgkmcnt(13)
    ds_read_b64_tr_b16 v[50:51], v17 offset:11712
    s_waitcnt lgkmcnt(12)
    v_mfma_f32_16x16x32_bf16 v[100:103], v[28:31], v[84:87], v[100:103]
    v_mfma_f32_16x16x32_bf16 v[104:107], v[28:31], v[88:91], v[104:107]
    ds_read_b64_tr_b16 v[52:53], v17 offset:9440
    ds_read_b64_tr_b16 v[54:55], v17 offset:11744
    s_waitcnt lgkmcnt(12)
    v_mfma_f32_16x16x32_bf16 v[108:111], v[32:35], v[84:87], v[108:111]
    v_mfma_f32_16x16x32_bf16 v[112:115], v[32:35], v[88:91], v[112:115]
    ds_read_b64_tr_b16 v[56:57], v17 offset:9472
    ds_read_b64_tr_b16 v[58:59], v17 offset:11776
    s_waitcnt lgkmcnt(11)
    v_mfma_f32_16x16x32_bf16 v[116:119], v[36:39], v[84:87], v[116:119]
    v_mfma_f32_16x16x32_bf16 v[120:123], v[36:39], v[88:91], v[120:123]
    s_waitcnt vmcnt(8) lgkmcnt(0)
    s_barrier
    ds_read_b128 v[68:71], v18 offset:0
    ds_read_b128 v[72:75], v18 offset:2048
    ds_read_b64_tr_b16 v[28:29], v20 offset:160
    ds_read_b64_tr_b16 v[30:31], v20 offset:2464
    s_add_u32 m0, s29, 0x8800
    s_nop 0
    buffer_load_dwordx4 v8, s[12:15], s31 offen lds
    v_mfma_f32_16x16x32_bf16 v[124:127], v[40:43], v[84:87], v[124:127]
    v_mfma_f32_16x16x32_bf16 v[128:131], v[40:43], v[88:91], v[128:131]
    ds_read_b64_tr_b16 v[32:33], v20 offset:192
    ds_read_b64_tr_b16 v[34:35], v20 offset:2496
    ds_read_b128 v[76:79], v19 offset:0
    s_add_u32 m0, s29, 0xa800
    s_add_u32 s33, s31, 0x40000
    buffer_load_dwordx4 v8, s[12:15], s33 offen lds
    s_add_u32 s31, s31, 128
    v_mfma_f32_16x16x32_bf16 v[100:103], v[44:47], v[92:95], v[100:103]
    v_mfma_f32_16x16x32_bf16 v[104:107], v[44:47], v[96:99], v[104:107]
    ds_read_b64_tr_b16 v[36:37], v20 offset:224
    ds_read_b64_tr_b16 v[38:39], v20 offset:2528
    ds_read_b128 v[80:83], v19 offset:2048
    s_add_u32 m0, s29, 0xc800
    s_nop 0
    buffer_load_dwordx4 v9, s[16:19], s32 offen lds
    v_mfma_f32_16x16x32_bf16 v[108:111], v[48:51], v[92:95], v[108:111]
    v_mfma_f32_16x16x32_bf16 v[112:115], v[48:51], v[96:99], v[112:115]
    ds_read_b64_tr_b16 v[40:41], v20 offset:256
    ds_read_b64_tr_b16 v[42:43], v20 offset:2560
    s_add_u32 m0, s29, 0xe800
    s_nop 0
    buffer_load_dwordx4 v10, s[16:19], s32 offen lds
    v_mfma_f32_16x16x32_bf16 v[116:119], v[52:55], v[92:95], v[116:119]
    v_mfma_f32_16x16x32_bf16 v[120:123], v[52:55], v[96:99], v[120:123]
    ds_read_b64_tr_b16 v[44:45], v20 offset:9376
    ds_read_b64_tr_b16 v[46:47], v20 offset:11680
    s_add_u32 m0, s30, 0x10800
    s_nop 0
    s_mov_b64 exec, 0xffff
    buffer_load_dwordx4 v11, s[16:19], s32 offen lds
    s_mov_b64 exec, -1
    s_add_u32 s32, s32, 0x4800
    v_mfma_f32_16x16x32_bf16 v[124:127], v[56:59], v[92:95], v[124:127]
    v_mfma_f32_16x16x32_bf16 v[128:131], v[56:59], v[96:99], v[128:131]
    ds_read_b64_tr_b16 v[48:49], v20 offset:9408
    s_waitcnt lgkmcnt(13)
    ds_read_b64_tr_b16 v[50:51], v20 offset:11712
    s_mov_b32 s40, 2
LP_rompt_kernel_45:
    s_waitcnt lgkmcnt(12)
    v_mfma_f32_16x16x32_bf16 v[100:103], v[28:31], v[68:71], v[100:103]
    v_mfma_f32_16x16x32_bf16 v[104:107], v[28:31], v[72:75], v[104:107]
    ds_read_b64_tr_b16 v[52:53], v20 offset:9440
    ds_read_b64_tr_b16 v[54:55], v20 offset:11744
    s_waitcnt lgkmcnt(12)
    v_mfma_f32_16x16x32_bf16 v[108:111], v[32:35], v[68:71], v[108:111]
    v_mfma_f32_16x16x32_bf16 v[112:115], v[32:35], v[72:75], v[112:115]
    ds_read_b64_tr_b16 v[56:57], v20 offset:9472
    ds_read_b64_tr_b16 v[58:59], v20 offset:11776
    s_waitcnt lgkmcnt(11)
    v_mfma_f32_16x16x32_bf16 v[116:119], v[36:39], v[68:71], v[116:119]
    v_mfma_f32_16x16x32_bf16 v[120:123], v[36:39], v[72:75], v[120:123]
    s_waitcnt vmcnt(10) lgkmcnt(0)
    s_barrier
    ds_read_b128 v[84:87], v21 offset:0
    ds_read_b128 v[88:91], v21 offset:2048
    ds_read_b64_tr_b16 v[28:29], v23 offset:160
    ds_read_b64_tr_b16 v[30:31], v23 offset:2464
    s_add_u32 m0, s29, 0x11000
    s_nop 0
    buffer_load_dwordx4 v8, s[12:15], s31 offen lds
    v_mfma_f32_16x16x32_bf16 v[124:127], v[40:43], v[68:71], v[124:127]
    v_mfma_f32_16x16x32_bf16 v[128:131], v[40:43], v[72:75], v[128:131]
    ds_read_b64_tr_b16 v[32:33], v23 offset:192
    ds_read_b64_tr_b16 v[34:35], v23 offset:2496
    ds_read_b128 v[92:95], v22 offset:0
    s_add_u32 m0, s29, 0x13000
    s_add_u32 s33, s31, 0x40000
    buffer_load_dwordx4 v8, s[12:15], s33 offen lds
    s_add_u32 s31, s31, 128
    v_mfma_f32_16x16x32_bf16 v[100:103], v[44:47], v[76:79], v[100:103]
    v_mfma_f32_16x16x32_bf16 v[104:107], v[44:47], v[80:83], v[104:107]
    ds_read_b64_tr_b16 v[36:37], v23 offset:224
    ds_read_b64_tr_b16 v[38:39], v23 offset:2528
    ds_read_b128 v[96:99], v22 offset:2048
    s_add_u32 m0, s29, 0x15000
    s_nop 0
    buffer_load_dwordx4 v9, s[16:19], s32 offen lds
    v_mfma_f32_16x16x32_bf16 v[108:111], v[48:51], v[76:79], v[108:111]
    v_mfma_f32_16x16x32_bf16 v[112:115], v[48:51], v[80:83], v[112:115]
    ds_read_b64_tr_b16 v[40:41], v23 offset:256
    ds_read_b64_tr_b16 v[42:43], v23 offset:2560
    s_add_u32 m0, s29, 0x17000
    s_nop 0
    buffer_load_dwordx4 v10, s[16:19], s32 offen lds
    v_mfma_f32_16x16x32_bf16 v[116:119], v[52:55], v[76:79], v[116:119]
    v_mfma_f32_16x16x32_bf16 v[120:123], v[52:55], v[80:83], v[120:123]
    ds_read_b64_tr_b16 v[44:45], v23 offset:9376
    ds_read_b64_tr_b16 v[46:47], v23 offset:11680
    s_add_u32 m0, s30, 0x19000
    s_nop 0
    s_mov_b64 exec, 0xffff
    buffer_load_dwordx4 v11, s[16:19], s32 offen lds
    s_mov_b64 exec, -1
    s_add_u32 s32, s32, 0x4800
    v_mfma_f32_16x16x32_bf16 v[124:127], v[56:59], v[76:79], v[124:127]
    v_mfma_f32_16x16x32_bf16 v[128:131], v[56:59], v[80:83], v[128:131]
    ds_read_b64_tr_b16 v[48:49], v23 offset:9408
    s_waitcnt lgkmcnt(13)
    ds_read_b64_tr_b16 v[50:51], v23 offset:11712
    s_waitcnt lgkmcnt(12)
    v_mfma_f32_16x16x32_bf16 v[100:103], v[28:31], v[84:87], v[100:103]
    v_mfma_f32_16x16x32_bf16 v[104:107], v[28:31], v[88:91], v[104:107]
    ds_read_b64_tr_b16 v[52:53], v23 offset:9440
    ds_read_b64_tr_b16 v[54:55], v23 offset:11744
    s_waitcnt lgkmcnt(12)
    v_mfma_f32_16x16x32_bf16 v[108:111], v[32:35], v[84:87], v[108:111]
    v_mfma_f32_16x16x32_bf16 v[112:115], v[32:35], v[88:91], v[112:115]
    ds_read_b64_tr_b16 v[56:57], v23 offset:9472
    ds_read_b64_tr_b16 v[58:59], v23 offset:11776
    s_waitcnt lgkmcnt(11)
    v_mfma_f32_16x16x32_bf16 v[116:119], v[36:39], v[84:87], v[116:119]
    v_mfma_f32_16x16x32_bf16 v[120:123], v[36:39], v[88:91], v[120:123]
    s_waitcnt vmcnt(10) lgkmcnt(0)
    s_barrier
    ds_read_b128 v[68:71], v12 offset:0
    ds_read_b128 v[72:75], v12 offset:2048
    ds_read_b64_tr_b16 v[28:29], v14 offset:160
    ds_read_b64_tr_b16 v[30:31], v14 offset:2464
    s_add_u32 m0, s29, 0x19800
    s_nop 0
    buffer_load_dwordx4 v8, s[12:15], s31 offen lds
    v_mfma_f32_16x16x32_bf16 v[124:127], v[40:43], v[84:87], v[124:127]
    v_mfma_f32_16x16x32_bf16 v[128:131], v[40:43], v[88:91], v[128:131]
    ds_read_b64_tr_b16 v[32:33], v14 offset:192
    ds_read_b64_tr_b16 v[34:35], v14 offset:2496
    ds_read_b128 v[76:79], v13 offset:0
    s_add_u32 m0, s29, 0x1b800
    s_add_u32 s33, s31, 0x40000
    buffer_load_dwordx4 v8, s[12:15], s33 offen lds
    s_add_u32 s31, s31, 128
    v_mfma_f32_16x16x32_bf16 v[100:103], v[44:47], v[92:95], v[100:103]
    v_mfma_f32_16x16x32_bf16 v[104:107], v[44:47], v[96:99], v[104:107]
    ds_read_b64_tr_b16 v[36:37], v14 offset:224
    ds_read_b64_tr_b16 v[38:39], v14 offset:2528
    ds_read_b128 v[80:83], v13 offset:2048
    s_add_u32 m0, s29, 0x1d800
    s_nop 0
    buffer_load_dwordx4 v9, s[16:19], s32 offen lds
    v_mfma_f32_16x16x32_bf16 v[108:111], v[48:51], v[92:95], v[108:111]
    v_mfma_f32_16x16x32_bf16 v[112:115], v[48:51], v[96:99], v[112:115]
    ds_read_b64_tr_b16 v[40:41], v14 offset:256
    ds_read_b64_tr_b16 v[42:43], v14 offset:2560
    s_add_u32 m0, s29, 0x1f800
    s_nop 0
    buffer_load_dwordx4 v10, s[16:19], s32 offen lds
    v_mfma_f32_16x16x32_bf16 v[116:119], v[52:55], v[92:95], v[116:119]
    v_mfma_f32_16x16x32_bf16 v[120:123], v[52:55], v[96:99], v[120:123]
    ds_read_b64_tr_b16 v[44:45], v14 offset:9376
    ds_read_b64_tr_b16 v[46:47], v14 offset:11680
    s_add_u32 m0, s30, 0x21800
    s_nop 0
    s_mov_b64 exec, 0xffff
    buffer_load_dwordx4 v11, s[16:19], s32 offen lds
    s_mov_b64 exec, -1
    s_add_u32 s32, s32, 0x4800
    v_mfma_f32_16x16x32_bf16 v[124:127], v[56:59], v[92:95], v[124:127]
    v_mfma_f32_16x16x32_bf16 v[128:131], v[56:59], v[96:99], v[128:131]
    ds_read_b64_tr_b16 v[48:49], v14 offset:9408
    s_waitcnt lgkmcnt(13)
    ds_read_b64_tr_b16 v[50:51], v14 offset:11712
    s_waitcnt lgkmcnt(12)
    v_mfma_f32_16x16x32_bf16 v[100:103], v[28:31], v[68:71], v[100:103]
    v_mfma_f32_16x16x32_bf16 v[104:107], v[28:31], v[72:75], v[104:107]
    ds_read_b64_tr_b16 v[52:53], v14 offset:9440
    ds_read_b64_tr_b16 v[54:55], v14 offset:11744
    s_waitcnt lgkmcnt(12)
    v_mfma_f32_16x16x32_bf16 v[108:111], v[32:35], v[68:71], v[108:111]
    v_mfma_f32_16x16x32_bf16 v[112:115], v[32:35], v[72:75], v[112:115]
    ds_read_b64_tr_b16 v[56:57], v14 offset:9472
    ds_read_b64_tr_b16 v[58:59], v14 offset:11776
    s_waitcnt lgkmcnt(11)
    v_mfma_f32_16x16x32_bf16 v[116:119], v[36:39], v[68:71], v[116:119]
    v_mfma_f32_16x16x32_bf16 v[120:123], v[36:39], v[72:75], v[120:123]
    s_waitcnt vmcnt(10) lgkmcnt(0)
    s_barrier
    ds_read_b128 v[84:87], v15 offset:0
    ds_read_b128 v[88:91], v15 offset:2048
    ds_read_b64_tr_b16 v[28:29], v17 offset:160
    ds_read_b64_tr_b16 v[30:31], v17 offset:2464
    s_add_u32 m0, s29, 0x0
    s_nop 0
    buffer_load_dwordx4 v8, s[12:15], s31 offen lds
    v_mfma_f32_16x16x32_bf16 v[124:127], v[40:43], v[68:71], v[124:127]
    v_mfma_f32_16x16x32_bf16 v[128:131], v[40:43], v[72:75], v[128:131]
    ds_read_b64_tr_b16 v[32:33], v17 offset:192
    ds_read_b64_tr_b16 v[34:35], v17 offset:2496
    ds_read_b128 v[92:95], v16 offset:0
    s_add_u32 m0, s29, 0x2000
    s_add_u32 s33, s31, 0x40000
    buffer_load_dwordx4 v8, s[12:15], s33 offen lds
    s_add_u32 s31, s31, 128
    v_mfma_f32_16x16x32_bf16 v[100:103], v[44:47], v[76:79], v[100:103]
    v_mfma_f32_16x16x32_bf16 v[104:107], v[44:47], v[80:83], v[104:107]
    ds_read_b64_tr_b16 v[36:37], v17 offset:224
    ds_read_b64_tr_b16 v[38:39], v17 offset:2528
    ds_read_b128 v[96:99], v16 offset:2048
    s_add_u32 m0, s29, 0x4000
    s_nop 0
    buffer_load_dwordx4 v9, s[16:19], s32 offen lds
    v_mfma_f32_16x16x32_bf16 v[108:111], v[48:51], v[76:79], v[108:111]
    v_mfma_f32_16x16x32_bf16 v[112:115], v[48:51], v[80:83], v[112:115]
    ds_read_b64_tr_b16 v[40:41], v17 offset:256
    ds_read_b64_tr_b16 v[42:43], v17 offset:2560
    s_add_u32 m0, s29, 0x6000
    s_nop 0
    buffer_load_dwordx4 v10, s[16:19], s32 offen lds
    v_mfma_f32_16x16x32_bf16 v[116:119], v[52:55], v[76:79], v[116:119]
    v_mfma_f32_16x16x32_bf16 v[120:123], v[52:55], v[80:83], v[120:123]
    ds_read_b64_tr_b16 v[44:45], v17 offset:9376
    ds_read_b64_tr_b16 v[46:47], v17 offset:11680
    s_add_u32 m0, s30, 0x8000
    s_nop 0
    s_mov_b64 exec, 0xffff
    buffer_load_dwordx4 v11, s[16:19], s32 offen lds
    s_mov_b64 exec, -1
    s_add_u32 s32, s32, 0x4800
    v_mfma_f32_16x16x32_bf16 v[124:127], v[56:59], v[76:79], v[124:127]
    v_mfma_f32_16x16x32_bf16 v[128:131], v[56:59], v[80:83], v[128:131]
    ds_read_b64_tr_b16 v[48:49], v17 offset:9408
    s_waitcnt lgkmcnt(13)
    ds_read_b64_tr_b16 v[50:51], v17 offset:11712
    s_waitcnt lgkmcnt(12)
    v_mfma_f32_16x16x32_bf16 v[100:103], v[28:31], v[84:87], v[100:103]
    v_mfma_f32_16x16x32_bf16 v[104:107], v[28:31], v[88:91], v[104:107]
    ds_read_b64_tr_b16 v[52:53], v17 offset:9440
    ds_read_b64_tr_b16 v[54:55], v17 offset:11744
    s_waitcnt lgkmcnt(12)
    v_mfma_f32_16x16x32_bf16 v[108:111], v[32:35], v[84:87], v[108:111]
    v_mfma_f32_16x16x32_bf16 v[112:115], v[32:35], v[88:91], v[112:115]
    ds_read_b64_tr_b16 v[56:57], v17 offset:9472
    ds_read_b64_tr_b16 v[58:59], v17 offset:11776
    s_waitcnt lgkmcnt(11)
    v_mfma_f32_16x16x32_bf16 v[116:119], v[36:39], v[84:87], v[116:119]
    v_mfma_f32_16x16x32_bf16 v[120:123], v[36:39], v[88:91], v[120:123]
    s_waitcnt vmcnt(10) lgkmcnt(0)
    s_barrier
    ds_read_b128 v[68:71], v18 offset:0
    ds_read_b128 v[72:75], v18 offset:2048
    ds_read_b64_tr_b16 v[28:29], v20 offset:160
    ds_read_b64_tr_b16 v[30:31], v20 offset:2464
    s_add_u32 m0, s29, 0x8800
    s_nop 0
    buffer_load_dwordx4 v8, s[12:15], s31 offen lds
    v_mfma_f32_16x16x32_bf16 v[124:127], v[40:43], v[84:87], v[124:127]
    v_mfma_f32_16x16x32_bf16 v[128:131], v[40:43], v[88:91], v[128:131]
    ds_read_b64_tr_b16 v[32:33], v20 offset:192
    ds_read_b64_tr_b16 v[34:35], v20 offset:2496
    ds_read_b128 v[76:79], v19 offset:0
    s_add_u32 m0, s29, 0xa800
    s_add_u32 s33, s31, 0x40000
    buffer_load_dwordx4 v8, s[12:15], s33 offen lds
    s_add_u32 s31, s31, 128
    v_mfma_f32_16x16x32_bf16 v[100:103], v[44:47], v[92:95], v[100:103]
    v_mfma_f32_16x16x32_bf16 v[104:107], v[44:47], v[96:99], v[104:107]
    ds_read_b64_tr_b16 v[36:37], v20 offset:224
    ds_read_b64_tr_b16 v[38:39], v20 offset:2528
    ds_read_b128 v[80:83], v19 offset:2048
    s_add_u32 m0, s29, 0xc800
    s_nop 0
    buffer_load_dwordx4 v9, s[16:19], s32 offen lds
    v_mfma_f32_16x16x32_bf16 v[108:111], v[48:51], v[92:95], v[108:111]
    v_mfma_f32_16x16x32_bf16 v[112:115], v[48:51], v[96:99], v[112:115]
    ds_read_b64_tr_b16 v[40:41], v20 offset:256
    ds_read_b64_tr_b16 v[42:43], v20 offset:2560
    s_add_u32 m0, s29, 0xe800
    s_nop 0
    buffer_load_dwordx4 v10, s[16:19], s32 offen lds
    v_mfma_f32_16x16x32_bf16 v[116:119], v[52:55], v[92:95], v[116:119]
    v_mfma_f32_16x16x32_bf16 v[120:123], v[52:55], v[96:99], v[120:123]
    ds_read_b64_tr_b16 v[44:45], v20 offset:9376
    ds_read_b64_tr_b16 v[46:47], v20 offset:11680
    s_add_u32 m0, s30, 0x10800
    s_nop 0
    s_mov_b64 exec, 0xffff
    buffer_load_dwordx4 v11, s[16:19], s32 offen lds
    s_mov_b64 exec, -1
    s_add_u32 s32, s32, 0x4800
    v_mfma_f32_16x16x32_bf16 v[124:127], v[56:59], v[92:95], v[124:127]
    v_mfma_f32_16x16x32_bf16 v[128:131], v[56:59], v[96:99], v[128:131]
    ds_read_b64_tr_b16 v[48:49], v20 offset:9408
    s_waitcnt lgkmcnt(13)
    ds_read_b64_tr_b16 v[50:51], v20 offset:11712
    s_sub_u32 s40, s40, 1
    s_cmp_lg_u32 s40, 0
    s_cbranch_scc1 LP_rompt_kernel_45
    s_waitcnt lgkmcnt(12)
    v_mfma_f32_16x16x32_bf16 v[100:103], v[28:31], v[68:71], v[100:103]
    v_mfma_f32_16x16x32_bf16 v[104:107], v[28:31], v[72:75], v[104:107]
    ds_read_b64_tr_b16 v[52:53], v20 offset:9440
    ds_read_b64_tr_b16 v[54:55], v20 offset:11744
    s_waitcnt lgkmcnt(12)
    v_mfma_f32_16x16x32_bf16 v[108:111], v[32:35], v[68:71], v[108:111]
    v_mfma_f32_16x16x32_bf16 v[112:115], v[32:35], v[72:75], v[112:115]
    ds_read_b64_tr_b16 v[56:57], v20 offset:9472
    ds_read_b64_tr_b16 v[58:59], v20 offset:11776
    s_waitcnt lgkmcnt(11)
    v_mfma_f32_16x16x32_bf16 v[116:119], v[36:39], v[68:71], v[116:119]
    v_mfma_f32_16x16x32_bf16 v[120:123], v[36:39], v[72:75], v[120:123]
    s_waitcnt vmcnt(10) lgkmcnt(0)
    s_barrier
    ds_read_b128 v[84:87], v21 offset:0
    ds_read_b128 v[88:91], v21 offset:2048
    ds_read_b64_tr_b16 v[28:29], v23 offset:160
    ds_read_b64_tr_b16 v[30:31], v23 offset:2464
    s_add_u32 m0, s29, 0x11000
    s_nop 0
    buffer_load_dwordx4 v8, s[12:15], s31 offen lds
    v_mfma_f32_16x16x32_bf16 v[124:127], v[40:43], v[68:71], v[124:127]
    v_mfma_f32_16x16x32_bf16 v[128:131], v[40:43], v[72:75], v[128:131]
    ds_read_b64_tr_b16 v[32:33], v23 offset:192
    ds_read_b64_tr_b16 v[34:35], v23 offset:2496
    ds_read_b128 v[92:95], v22 offset:0
    s_add_u32 m0, s29, 0x13000
    s_add_u32 s33, s31, 0x40000
    buffer_load_dwordx4 v8, s[12:15], s33 offen lds
    s_add_u32 s31, s31, 128
    v_mfma_f32_16x16x32_bf16 v[100:103], v[44:47], v[76:79], v[100:103]
    v_mfma_f32_16x16x32_bf16 v[104:107], v[44:47], v[80:83], v[104:107]
    ds_read_b64_tr_b16 v[36:37], v23 offset:224
    ds_read_b64_tr_b16 v[38:39], v23 offset:2528
    ds_read_b128 v[96:99], v22 offset:2048
    s_add_u32 m0, s29, 0x15000
    s_nop 0
    buffer_load_dwordx4 v9, s[16:19], s32 offen lds
    v_mfma_f32_16x16x32_bf16 v[108:111], v[48:51], v[76:79], v[108:111]
    v_mfma_f32_16x16x32_bf16 v[112:115], v[48:51], v[80:83], v[112:115]
    ds_read_b64_tr_b16 v[40:41], v23 offset:256
    ds_read_b64_tr_b16 v[42:43], v23 offset:2560
    s_add_u32 m0, s29, 0x17000
    s_nop 0
    buffer_load_dwordx4 v10, s[16:19], s32 offen lds
    v_mfma_f32_16x16x32_bf16 v[116:119], v[52:55], v[76:79], v[116:119]
    v_mfma_f32_16x16x32_bf16 v[120:123], v[52:55], v[80:83], v[120:123]
    ds_read_b64_tr_b16 v[44:45], v23 offset:9376
    ds_read_b64_tr_b16 v[46:47], v23 offset:11680
    s_add_u32 m0, s30, 0x19000
    s_nop 0
    s_mov_b64 exec, 0xffff
    buffer_load_dwordx4 v11, s[16:19], s32 offen lds
    s_mov_b64 exec, -1
    s_add_u32 s32, s32, 0x4800
    v_mfma_f32_16x16x32_bf16 v[124:127], v[56:59], v[76:79], v[124:127]
    v_mfma_f32_16x16x32_bf16 v[128:131], v[56:59], v[80:83], v[128:131]
    ds_read_b64_tr_b16 v[48:49], v23 offset:9408
    s_waitcnt lgkmcnt(13)
    ds_read_b64_tr_b16 v[50:51], v23 offset:11712
    s_waitcnt lgkmcnt(12)
    v_mfma_f32_16x16x32_bf16 v[100:103], v[28:31], v[84:87], v[100:103]
    v_mfma_f32_16x16x32_bf16 v[104:107], v[28:31], v[88:91], v[104:107]
    ds_read_b64_tr_b16 v[52:53], v23 offset:9440
    ds_read_b64_tr_b16 v[54:55], v23 offset:11744
    s_waitcnt lgkmcnt(12)
    v_mfma_f32_16x16x32_bf16 v[108:111], v[32:35], v[84:87], v[108:111]
    v_mfma_f32_16x16x32_bf16 v[112:115], v[32:35], v[88:91], v[112:115]
    ds_read_b64_tr_b16 v[56:57], v23 offset:9472
    ds_read_b64_tr_b16 v[58:59], v23 offset:11776
    s_waitcnt lgkmcnt(11)
    v_mfma_f32_16x16x32_bf16 v[116:119], v[36:39], v[84:87], v[116:119]
    v_mfma_f32_16x16x32_bf16 v[120:123], v[36:39], v[88:91], v[120:123]
    s_waitcnt vmcnt(10) lgkmcnt(0)
    s_barrier
    ds_read_b128 v[68:71], v12 offset:0
    ds_read_b128 v[72:75], v12 offset:2048
    ds_read_b64_tr_b16 v[28:29], v14 offset:160
    ds_read_b64_tr_b16 v[30:31], v14 offset:2464
    s_add_u32 m0, s29, 0x19800
    s_nop 0
    buffer_load_dwordx4 v8, s[12:15], s31 offen lds
    v_mfma_f32_16x16x32_bf16 v[124:127], v[40:43], v[84:87], v[124:127]
    v_mfma_f32_16x16x32_bf16 v[128:131], v[40:43], v[88:91], v[128:131]
    ds_read_b64_tr_b16 v[32:33], v14 offset:192
    ds_read_b64_tr_b16 v[34:35], v14 offset:2496
    ds_read_b128 v[76:79], v13 offset:0
    s_add_u32 m0, s29, 0x1b800
    s_add_u32 s33, s31, 0x40000
    buffer_load_dwordx4 v8, s[12:15], s33 offen lds
    s_add_u32 s31, s31, 128
    v_mfma_f32_16x16x32_bf16 v[100:103], v[44:47], v[92:95], v[100:103]
    v_mfma_f32_16x16x32_bf16 v[104:107], v[44:47], v[96:99], v[104:107]
    ds_read_b64_tr_b16 v[36:37], v14 offset:224
    ds_read_b64_tr_b16 v[38:39], v14 offset:2528
    ds_read_b128 v[80:83], v13 offset:2048
    s_add_u32 m0, s29, 0x1d800
    s_nop 0
    buffer_load_dwordx4 v9, s[16:19], s32 offen lds
    v_mfma_f32_16x16x32_bf16 v[108:111], v[48:51], v[92:95], v[108:111]
    v_mfma_f32_16x16x32_bf16 v[112:115], v[48:51], v[96:99], v[112:115]
    ds_read_b64_tr_b16 v[40:41], v14 offset:256
    ds_read_b64_tr_b16 v[42:43], v14 offset:2560
    s_add_u32 m0, s29, 0x1f800
    s_nop 0
    buffer_load_dwordx4 v10, s[16:19], s32 offen lds
    v_mfma_f32_16x16x32_bf16 v[116:119], v[52:55], v[92:95], v[116:119]
    v_mfma_f32_16x16x32_bf16 v[120:123], v[52:55], v[96:99], v[120:123]
    ds_read_b64_tr_b16 v[44:45], v14 offset:9376
    ds_read_b64_tr_b16 v[46:47], v14 offset:11680
    s_add_u32 m0, s30, 0x21800
    s_nop 0
    s_mov_b64 exec, 0xffff
    buffer_load_dwordx4 v11, s[16:19], s32 offen lds
    s_mov_b64 exec, -1
    s_add_u32 s32, s32, 0x4800
    v_mfma_f32_16x16x32_bf16 v[124:127], v[56:59], v[92:95], v[124:127]
    v_mfma_f32_16x16x32_bf16 v[128:131], v[56:59], v[96:99], v[128:131]
    ds_read_b64_tr_b16 v[48:49], v14 offset:9408
    s_waitcnt lgkmcnt(13)
    ds_read_b64_tr_b16 v[50:51], v14 offset:11712
    s_waitcnt lgkmcnt(12)
    v_mfma_f32_16x16x32_bf16 v[100:103], v[28:31], v[68:71], v[100:103]
    v_mfma_f32_16x16x32_bf16 v[104:107], v[28:31], v[72:75], v[104:107]
    ds_read_b64_tr_b16 v[52:53], v14 offset:9440
    ds_read_b64_tr_b16 v[54:55], v14 offset:11744
    s_waitcnt lgkmcnt(12)
    v_mfma_f32_16x16x32_bf16 v[108:111], v[32:35], v[68:71], v[108:111]
    v_mfma_f32_16x16x32_bf16 v[112:115], v[32:35], v[72:75], v[112:115]
    ds_read_b64_tr_b16 v[56:57], v14 offset:9472
    ds_read_b64_tr_b16 v[58:59], v14 offset:11776
    s_waitcnt lgkmcnt(11)
    v_mfma_f32_16x16x32_bf16 v[116:119], v[36:39], v[68:71], v[116:119]
    v_mfma_f32_16x16x32_bf16 v[120:123], v[36:39], v[72:75], v[120:123]
    s_waitcnt vmcnt(10) lgkmcnt(0)
    s_barrier
    ds_read_b128 v[84:87], v15 offset:0
    ds_read_b128 v[88:91], v15 offset:2048
    ds_read_b64_tr_b16 v[28:29], v17 offset:160
    ds_read_b64_tr_b16 v[30:31], v17 offset:2464
    v_mfma_f32_16x16x32_bf16 v[124:127], v[40:43], v[68:71], v[124:127]
    v_mfma_f32_16x16x32_bf16 v[128:131], v[40:43], v[72:75], v[128:131]
    ds_read_b64_tr_b16 v[32:33], v17 offset:192
    ds_read_b64_tr_b16 v[34:35], v17 offset:2496
    ds_read_b128 v[92:95], v16 offset:0
    v_mfma_f32_16x16x32_bf16 v[100:103], v[44:47], v[76:79], v[100:103]
    v_mfma_f32_16x16x32_bf16 v[104:107], v[44:47], v[80:83], v[104:107]
    ds_read_b64_tr_b16 v[36:37], v17 offset:224
    ds_read_b64_tr_b16 v[38:39], v17 offset:2528
    ds_read_b128 v[96:99], v16 offset:2048
    v_mfma_f32_16x16x32_bf16 v[108:111], v[48:51], v[76:79], v[108:111]
    v_mfma_f32_16x16x32_bf16 v[112:115], v[48:51], v[80:83], v[112:115]
    ds_read_b64_tr_b16 v[40:41], v17 offset:256
    ds_read_b64_tr_b16 v[42:43], v17 offset:2560
    v_mfma_f32_16x16x32_bf16 v[116:119], v[52:55], v[76:79], v[116:119]
    v_mfma_f32_16x16x32_bf16 v[120:123], v[52:55], v[80:83], v[120:123]
    ds_read_b64_tr_b16 v[44:45], v17 offset:9376
    ds_read_b64_tr_b16 v[46:47], v17 offset:11680
    v_mfma_f32_16x16x32_bf16 v[124:127], v[56:59], v[76:79], v[124:127]
    v_mfma_f32_16x16x32_bf16 v[128:131], v[56:59], v[80:83], v[128:131]
    ds_read_b64_tr_b16 v[48:49], v17 offset:9408
    s_waitcnt lgkmcnt(13)
    ds_read_b64_tr_b16 v[50:51], v17 offset:11712
    s_waitcnt lgkmcnt(12)
    v_mfma_f32_16x16x32_bf16 v[100:103], v[28:31], v[84:87], v[100:103]
    v_mfma_f32_16x16x32_bf16 v[104:107], v[28:31], v[88:91], v[104:107]
    ds_read_b64_tr_b16 v[52:53], v17 offset:9440
    ds_read_b64_tr_b16 v[54:55], v17 offset:11744
    s_waitcnt lgkmcnt(12)
    v_mfma_f32_16x16x32_bf16 v[108:111], v[32:35], v[84:87], v[108:111]
    v_mfma_f32_16x16x32_bf16 v[112:115], v[32:35], v[88:91], v[112:115]
    ds_read_b64_tr_b16 v[56:57], v17 offset:9472
    ds_read_b64_tr_b16 v[58:59], v17 offset:11776
    s_waitcnt lgkmcnt(11)
    v_mfma_f32_16x16x32_bf16 v[116:119], v[36:39], v[84:87], v[116:119]
    v_mfma_f32_16x16x32_bf16 v[120:123], v[36:39], v[88:91], v[120:123]
    s_waitcnt vmcnt(5) lgkmcnt(0)
    s_barrier
    ds_read_b128 v[68:71], v18 offset:0
    ds_read_b128 v[72:75], v18 offset:2048
    ds_read_b64_tr_b16 v[28:29], v20 offset:160
    ds_read_b64_tr_b16 v[30:31], v20 offset:2464
    v_mfma_f32_16x16x32_bf16 v[124:127], v[40:43], v[84:87], v[124:127]
    v_mfma_f32_16x16x32_bf16 v[128:131], v[40:43], v[88:91], v[128:131]
    ds_read_b64_tr_b16 v[32:33], v20 offset:192
    ds_read_b64_tr_b16 v[34:35], v20 offset:2496
    ds_read_b128 v[76:79], v19 offset:0
    v_mfma_f32_16x16x32_bf16 v[100:103], v[44:47], v[92:95], v[100:103]
    v_mfma_f32_16x16x32_bf16 v[104:107], v[44:47], v[96:99], v[104:107]
    ds_read_b64_tr_b16 v[36:37], v20 offset:224
    ds_read_b64_tr_b16 v[38:39], v20 offset:2528
    ds_read_b128 v[80:83], v19 offset:2048
    v_mfma_f32_16x16x32_bf16 v[108:111], v[48:51], v[92:95], v[108:111]
    v_mfma_f32_16x16x32_bf16 v[112:115], v[48:51], v[96:99], v[112:115]
    ds_read_b64_tr_b16 v[40:41], v20 offset:256
    ds_read_b64_tr_b16 v[42:43], v20 offset:2560
    v_mfma_f32_16x16x32_bf16 v[116:119], v[52:55], v[92:95], v[116:119]
    v_mfma_f32_16x16x32_bf16 v[120:123], v[52:55], v[96:99], v[120:123]
    ds_read_b64_tr_b16 v[44:45], v20 offset:9376
    ds_read_b64_tr_b16 v[46:47], v20 offset:11680
    v_mfma_f32_16x16x32_bf16 v[124:127], v[56:59], v[92:95], v[124:127]
    v_mfma_f32_16x16x32_bf16 v[128:131], v[56:59], v[96:99], v[128:131]
    ds_read_b64_tr_b16 v[48:49], v20 offset:9408
    s_waitcnt lgkmcnt(13)
    ds_read_b64_tr_b16 v[50:51], v20 offset:11712
    s_waitcnt lgkmcnt(12)
    v_mfma_f32_16x16x32_bf16 v[100:103], v[28:31], v[68:71], v[100:103]
    v_mfma_f32_16x16x32_bf16 v[104:107], v[28:31], v[72:75], v[104:107]
    ds_read_b64_tr_b16 v[52:53], v20 offset:9440
    ds_read_b64_tr_b16 v[54:55], v20 offset:11744
    s_waitcnt lgkmcnt(12)
    v_mfma_f32_16x16x32_bf16 v[108:111], v[32:35], v[68:71], v[108:111]
    v_mfma_f32_16x16x32_bf16 v[112:115], v[32:35], v[72:75], v[112:115]
    ds_read_b64_tr_b16 v[56:57], v20 offset:9472
    ds_read_b64_tr_b16 v[58:59], v20 offset:11776
    s_waitcnt lgkmcnt(11)
    v_mfma_f32_16x16x32_bf16 v[116:119], v[36:39], v[68:71], v[116:119]
    v_mfma_f32_16x16x32_bf16 v[120:123], v[36:39], v[72:75], v[120:123]
    s_waitcnt vmcnt(0) lgkmcnt(0)
    s_barrier
    ds_read_b128 v[84:87], v21 offset:0
    ds_read_b128 v[88:91], v21 offset:2048
    ds_read_b64_tr_b16 v[28:29], v23 offset:160
    ds_read_b64_tr_b16 v[30:31], v23 offset:2464
    v_mfma_f32_16x16x32_bf16 v[124:127], v[40:43], v[68:71], v[124:127]
    v_mfma_f32_16x16x32_bf16 v[128:131], v[40:43], v[72:75], v[128:131]
    ds_read_b64_tr_b16 v[32:33], v23 offset:192
    ds_read_b64_tr_b16 v[34:35], v23 offset:2496
    ds_read_b128 v[92:95], v22 offset:0
    v_mfma_f32_16x16x32_bf16 v[100:103], v[44:47], v[76:79], v[100:103]
    v_mfma_f32_16x16x32_bf16 v[104:107], v[44:47], v[80:83], v[104:107]
    ds_read_b64_tr_b16 v[36:37], v23 offset:224
    ds_read_b64_tr_b16 v[38:39], v23 offset:2528
    ds_read_b128 v[96:99], v22 offset:2048
    v_mfma_f32_16x16x32_bf16 v[108:111], v[48:51], v[76:79], v[108:111]
    v_mfma_f32_16x16x32_bf16 v[112:115], v[48:51], v[80:83], v[112:115]
    ds_read_b64_tr_b16 v[40:41], v23 offset:256
    ds_read_b64_tr_b16 v[42:43], v23 offset:2560
    v_mfma_f32_16x16x32_bf16 v[116:119], v[52:55], v[76:79], v[116:119]
    v_mfma_f32_16x16x32_bf16 v[120:123], v[52:55], v[80:83], v[120:123]
    ds_read_b64_tr_b16 v[44:45], v23 offset:9376
    ds_read_b64_tr_b16 v[46:47], v23 offset:11680
    v_mfma_f32_16x16x32_bf16 v[124:127], v[56:59], v[76:79], v[124:127]
    v_mfma_f32_16x16x32_bf16 v[128:131], v[56:59], v[80:83], v[128:131]
    ds_read_b64_tr_b16 v[48:49], v23 offset:9408
    s_waitcnt lgkmcnt(13)
    ds_read_b64_tr_b16 v[50:51], v23 offset:11712
    s_waitcnt lgkmcnt(12)
    v_mfma_f32_16x16x32_bf16 v[100:103], v[28:31], v[84:87], v[100:103]
    v_mfma_f32_16x16x32_bf16 v[104:107], v[28:31], v[88:91], v[104:107]
    ds_read_b64_tr_b16 v[52:53], v23 offset:9440
    ds_read_b64_tr_b16 v[54:55], v23 offset:11744
    s_waitcnt lgkmcnt(12)
    v_mfma_f32_16x16x32_bf16 v[108:111], v[32:35], v[84:87], v[108:111]
    v_mfma_f32_16x16x32_bf16 v[112:115], v[32:35], v[88:91], v[112:115]
    ds_read_b64_tr_b16 v[56:57], v23 offset:9472
    ds_read_b64_tr_b16 v[58:59], v23 offset:11776
    s_waitcnt lgkmcnt(11)
    v_mfma_f32_16x16x32_bf16 v[116:119], v[36:39], v[84:87], v[116:119]
    v_mfma_f32_16x16x32_bf16 v[120:123], v[36:39], v[88:91], v[120:123]
    s_waitcnt lgkmcnt(8)
    v_mfma_f32_16x16x32_bf16 v[124:127], v[40:43], v[84:87], v[124:127]
    v_mfma_f32_16x16x32_bf16 v[128:131], v[40:43], v[88:91], v[128:131]
    s_waitcnt lgkmcnt(6)
    v_mfma_f32_16x16x32_bf16 v[100:103], v[44:47], v[92:95], v[100:103]
    v_mfma_f32_16x16x32_bf16 v[104:107], v[44:47], v[96:99], v[104:107]
    s_waitcnt lgkmcnt(4)
    v_mfma_f32_16x16x32_bf16 v[108:111], v[48:51], v[92:95], v[108:111]
    v_mfma_f32_16x16x32_bf16 v[112:115], v[48:51], v[96:99], v[112:115]
    s_waitcnt lgkmcnt(2)
    v_mfma_f32_16x16x32_bf16 v[116:119], v[52:55], v[92:95], v[116:119]
    v_mfma_f32_16x16x32_bf16 v[120:123], v[52:55], v[96:99], v[120:123]
    s_waitcnt lgkmcnt(0)
    v_mfma_f32_16x16x32_bf16 v[124:127], v[56:59], v[92:95], v[124:127]
    v_mfma_f32_16x16x32_bf16 v[128:131], v[56:59], v[96:99], v[128:131]
    s_nop 7
    s_nop 3
    v_and_b32 v100, 0xfffe0000, v100
    v_or_b32 v100, 0x10000, v100
    v_cvt_pk_bf16_f32 v28, v100, v101
    v_cvt_pk_bf16_f32 v29, v102, v103
    v_or_b32 v28, 1, v28
    v_and_b32 v104, 0xfffe0000, v104
    v_or_b32 v104, 0x10000, v104
    v_cvt_pk_bf16_f32 v30, v104, v105
    v_cvt_pk_bf16_f32 v31, v106, v107
    v_or_b32 v30, 1, v30
    s_mov_b32 s33, 5120
    s_nop 0
    v_permlane16_swap_b32 v28, v30
    v_permlane16_swap_b32 v29, v31
    s_nop 0
    buffer_store_dwordx4 v[28:31], v7, s[24:27], s33 offen offset:0 sc0 sc1
    v_and_b32 v108, 0xfffe0000, v108
    v_or_b32 v108, 0x10000, v108
    v_cvt_pk_bf16_f32 v32, v108, v109
    v_cvt_pk_bf16_f32 v33, v110, v111
    v_or_b32 v32, 1, v32
    v_and_b32 v112, 0xfffe0000, v112
    v_or_b32 v112, 0x10000, v112
    v_cvt_pk_bf16_f32 v34, v112, v113
    v_cvt_pk_bf16_f32 v35, v114, v115
    v_or_b32 v34, 1, v34
    s_nop 0
    s_nop 0
    v_permlane16_swap_b32 v32, v34
    v_permlane16_swap_b32 v33, v35
    s_nop 0
    buffer_store_dwordx4 v[32:35], v7, s[24:27], s33 offen offset:1024 sc0 sc1
    v_and_b32 v116, 0xfffe0000, v116
    v_or_b32 v116, 0x10000, v116
    v_cvt_pk_bf16_f32 v36, v116, v117
    v_cvt_pk_bf16_f32 v37, v118, v119
    v_or_b32 v36, 1, v36
    v_and_b32 v120, 0xfffe0000, v120
    v_or_b32 v120, 0x10000, v120
    v_cvt_pk_bf16_f32 v38, v120, v121
    v_cvt_pk_bf16_f32 v39, v122, v123
    v_or_b32 v38, 1, v38
    s_nop 0
    s_nop 0
    v_permlane16_swap_b32 v36, v38
    v_permlane16_swap_b32 v37, v39
    s_nop 0
    buffer_store_dwordx4 v[36:39], v7, s[24:27], s33 offen offset:2048 sc0 sc1
    v_and_b32 v124, 0xfffe0000, v124
    v_or_b32 v124, 0x10000, v124
    v_cvt_pk_bf16_f32 v40, v124, v125
    v_cvt_pk_bf16_f32 v41, v126, v127
    v_or_b32 v40, 1, v40
    v_and_b32 v128, 0xfffe0000, v128
    v_or_b32 v128, 0x10000, v128
    v_cvt_pk_bf16_f32 v42, v128, v129
    v_cvt_pk_bf16_f32 v43, v130, v131
    v_or_b32 v42, 1, v42
    s_nop 0
    s_nop 0
    v_permlane16_swap_b32 v40, v42
    v_permlane16_swap_b32 v41, v43
    s_nop 0
    buffer_store_dwordx4 v[40:43], v7, s[24:27], s33 offen offset:3072 sc0 sc1
LJ_rompt_kernel_42:
    s_lshl_b32 s39, s36, 2
    s_add_u32 s39, s39, s38
    s_add_u32 s12, s4, 0x800000
    s_addc_u32 s13, s5, 0
    s_mov_b32 s14, 0x240000
    s_and_b32 s13, s13, 0xffff
    s_mov_b32 s15, 0x20000
    s_lshr_b32 s46, s39, 2
    s_lshl_b32 s47, s37, 2
    s_add_u32 s46, s46, s47
    s_mul_i32 s46, s46, 36864
    s_add_u32 s20, s4, 0x1400000
    s_addc_u32 s21, s5, 0
    s_add_u32 s20, s20, s46
    s_addc_u32 s21, s21, 0
    s_sub_u32 s22, 0x900000, s46
    s_and_b32 s21, s21, 0xffff
    s_mov_b32 s23, 0x20000
    s_add_u32 s24, s4, 0x2800000
    s_addc_u32 s25, s5, 0
    s_mov_b32 s26, 0x240000
    s_and_b32 s25, s25, 0xffff
    s_mov_b32 s27, 0x20000
    s_add_u32 s52, s4, 0x2400000
    s_addc_u32 s53, s5, 0
    s_mov_b32 s54, 0x240000
    s_and_b32 s53, s53, 0xffff
    s_mov_b32 s55, 0x20000
    s_lshl_b32 s46, s37, 7
    s_lshl_b32 s47, s39, 3
    s_add_u32 s46, s46, s47
    s_add_u32 s46, s46, s28
    v_mov_b32 v2, s46
    v_mul_u32_u24 v4, 1152, v2
    v_lshl_add_u32 v7, v1, 3, v4
    v_lshl_add_u32 v8, v1, 1, v4
    buffer_load_dwordx2 v[10:11], v7, s[12:15], 0 offen
    buffer_load_dwordx2 v[12:13], v7, s[12:15], 0 offen offset:512
    buffer_load_ushort v14, v8, s[12:15], 0 offen offset:1024
    s_lshr_b32 s46, s39, 1
    s_and_b32 s46, s46, 1
    s_lshl_b32 s46, s46, 8
    s_and_b32 s47, s39, 1
    s_lshl_b32 s47, s47, 7
    s_add_u32 s46, s46, s47
    s_mul_i32 s47, s28, 64
    s_add_u32 s47, s47, 0
    v_add_u32 v3, s47, v1
    v_lshrrev_b32 v5, 4, v3
    v_lshlrev_b32 v5, 10, v5
    v_bfe_u32 v6, v3, 3, 1
    v_lshl_add_u32 v5, v6, 9, v5
    v_and_b32 v6, 7, v3
    v_lshl_add_u32 v5, v6, 4, v5
    v_add_u32 v40, s46, v5
    v_mul_u32_u24 v5, 2336, v6
    v_lshrrev_b32 v6, 3, v3
    v_lshl_add_u32 v5, v6, 5, v5
    v_add_u32 v42, 0x22000, v5
    s_mul_i32 s47, s28, 8
    s_add_u32 s47, s47, 512
    v_add_u32 v3, s47, v1
    v_lshrrev_b32 v5, 4, v3
    v_lshlrev_b32 v5, 10, v5
    v_bfe_u32 v6, v3, 3, 1
    v_lshl_add_u32 v5, v6, 9, v5
    v_and_b32 v6, 7, v3
    v_lshl_add_u32 v5, v6, 4, v5
    v_add_u32 v41, s46, v5
    v_mul_u32_u24 v5, 2336, v6
    v_lshrrev_b32 v6, 3, v3
    v_lshl_add_u32 v5, v6, 5, v5
    v_add_u32 v43, 0x22000, v5
    v_mov_b32 v48, 1
    v_mov_b32 v49, 1
    v_mov_b32 v50, 1
    v_mov_b32 v51, 1
    v_mov_b32 v56, 1
    v_mov_b32 v57, 1
    v_mov_b32 v58, 1
    v_mov_b32 v59, 1
    v_mov_b32 v64, 1
    v_mov_b32 v65, 1
    v_mov_b32 v66, 1
    v_mov_b32 v67, 1
    v_mov_b32 v72, 1
    v_mov_b32 v73, 1
    v_mov_b32 v74, 1
    v_mov_b32 v75, 1
    s_mov_b32 s45, 0
LW_rompt_kernel_46:
    s_mov_b32 s47, 0x0
    buffer_load_dwordx4 v[44:47], v40, s[20:23], s47 offen sc0 sc1
    s_mov_b64 exec, 0xff
    buffer_load_dwordx4 v[48:51], v41, s[20:23], s47 offen sc0 sc1
    s_mov_b64 exec, -1
    s_mov_b32 s47, 0x240000
    buffer_load_dwordx4 v[52:55], v40, s[20:23], s47 offen sc0 sc1
    s_mov_b64 exec, 0xff
    buffer_load_dwordx4 v[56:59], v41, s[20:23], s47 offen sc0 sc1
    s_mov_b64 exec, -1
    s_mov_b32 s47, 0x480000
    buffer_load_dwordx4 v[60:63], v40, s[20:23], s47 offen sc0 sc1
    s_mov_b64 exec, 0xff
    buffer_load_dwordx4 v[64:67], v41, s[20:23], s47 offen sc0 sc1
    s_mov_b64 exec, -1
    s_mov_b32 s47, 0x6c0000
    buffer_load_dwordx4 v[68:71], v40, s[20:23], s47 offen sc0 sc1
    s_mov_b64 exec, 0xff
    buffer_load_dwordx4 v[72:75], v41, s[20:23], s47 offen sc0 sc1
    s_mov_b64 exec, -1
    s_waitcnt vmcnt(0)
    v_and_b32 v26, v44, v46
    v_and_b32 v27, v48, v50
    v_and_b32 v26, v26, v52
    v_and_b32 v27, v27, v54
    v_and_b32 v26, v26, v56
    v_and_b32 v27, v27, v58
    v_and_b32 v26, v26, v60
    v_and_b32 v27, v27, v62
    v_and_b32 v26, v26, v64
    v_and_b32 v27, v27, v66
    v_and_b32 v26, v26, v68
    v_and_b32 v27, v27, v70
    v_and_b32 v26, v26, v72
    v_and_b32 v27, v27, v74
    v_and_b32 v26, v26, v27
    v_and_b32 v26, 1, v26
    v_cmp_ne_u32 vcc, 1, v26
    s_nop 3
    s_cmp_eq_u64 vcc, 0
    s_cbranch_scc1 LD_rompt_kernel_47
    s_add_u32 s45, s45, 1
    s_cmp_lt_u32 s45, 0x100000
    s_cbranch_scc1 LW_rompt_kernel_46
LD_rompt_kernel_47:
    v_lshlrev_b32 v76, 16, v44
    v_and_b32 v77, 0xffff0000, v44
    v_lshlrev_b32 v78, 16, v45
    v_and_b32 v79, 0xffff0000, v45
    v_lshlrev_b32 v80, 16, v46
    v_and_b32 v81, 0xffff0000, v46
    v_lshlrev_b32 v82, 16, v47
    v_and_b32 v83, 0xffff0000, v47
    v_lshlrev_b32 v84, 16, v48
    v_and_b32 v85, 0xffff0000, v48
    v_lshlrev_b32 v86, 16, v49
    v_and_b32 v87, 0xffff0000, v49
    v_lshlrev_b32 v88, 16, v50
    v_and_b32 v89, 0xffff0000, v50
    v_lshlrev_b32 v90, 16, v51
    v_and_b32 v91, 0xffff0000, v51
    v_lshlrev_b32 v26, 16, v52
    v_and_b32 v27, 0xffff0000, v52
    v_add_f32 v76, v76, v26
    v_add_f32 v77, v77, v27
    v_lshlrev_b32 v26, 16, v53
    v_and_b32 v27, 0xffff0000, v53
    v_add_f32 v78, v78, v26
    v_add_f32 v79, v79, v27
    v_lshlrev_b32 v26, 16, v54
    v_and_b32 v27, 0xffff0000, v54
    v_add_f32 v80, v80, v26
    v_add_f32 v81, v81, v27
    v_lshlrev_b32 v26, 16, v55
    v_and_b32 v27, 0xffff0000, v55
    v_add_f32 v82, v82, v26
    v_add_f32 v83, v83, v27
    v_lshlrev_b32 v26, 16, v56
    v_and_b32 v27, 0xffff0000, v56
    v_add_f32 v84, v84, v26
    v_add_f32 v85, v85, v27
    v_lshlrev_b32 v26, 16, v57
    v_and_b32 v27, 0xffff0000, v57
    v_add_f32 v86, v86, v26
    v_add_f32 v87, v87, v27
    v_lshlrev_b32 v26, 16, v58
    v_and_b32 v27, 0xffff0000, v58
    v_add_f32 v88, v88, v26
    v_add_f32 v89, v89, v27
    v_lshlrev_b32 v26, 16, v59
    v_and_b32 v27, 0xffff0000, v59
    v_add_f32 v90, v90, v26
    v_add_f32 v91, v91, v27
    v_lshlrev_b32 v26, 16, v60
    v_and_b32 v27, 0xffff0000, v60
    v_add_f32 v76, v76, v26
    v_add_f32 v77, v77, v27
    v_lshlrev_b32 v26, 16, v61
    v_and_b32 v27, 0xffff0000, v61
    v_add_f32 v78, v78, v26
    v_add_f32 v79, v79, v27
    v_lshlrev_b32 v26, 16, v62
    v_and_b32 v27, 0xffff0000, v62
    v_add_f32 v80, v80, v26
    v_add_f32 v81, v81, v27
    v_lshlrev_b32 v26, 16, v63
    v_and_b32 v27, 0xffff0000, v63
    v_add_f32 v82, v82, v26
    v_add_f32 v83, v83, v27
    v_lshlrev_b32 v26, 16, v64
    v_and_b32 v27, 0xffff0000, v64
    v_add_f32 v84, v84, v26
    v_add_f32 v85, v85, v27
    v_lshlrev_b32 v26, 16, v65
    v_and_b32 v27, 0xffff0000, v65
    v_add_f32 v86, v86, v26
    v_add_f32 v87, v87, v27
    v_lshlrev_b32 v26, 16, v66
    v_and_b32 v27, 0xffff0000, v66
    v_add_f32 v88, v88, v26
    v_add_f32 v89, v89, v27
    v_lshlrev_b32 v26, 16, v67
    v_and_b32 v27, 0xffff0000, v67
    v_add_f32 v90, v90, v26
    v_add_f32 v91, v91, v27
    v_lshlrev_b32 v26, 16, v68
    v_and_b32 v27, 0xffff0000, v68
    v_add_f32 v76, v76, v26
    v_add_f32 v77, v77, v27
    v_lshlrev_b32 v26, 16, v69
    v_and_b32 v27, 0xffff0000, v69
    v_add_f32 v78, v78, v26
    v_add_f32 v79, v79, v27
    v_lshlrev_b32 v26, 16, v70
    v_and_b32 v27, 0xffff0000, v70
    v_add_f32 v80, v80, v26
    v_add_f32 v81, v81, v27
    v_lshlrev_b32 v26, 16, v71
    v_and_b32 v27, 0xffff0000, v71
    v_add_f32 v82, v82, v26
    v_add_f32 v83, v83, v27
    v_lshlrev_b32 v26, 16, v72
    v_and_b32 v27, 0xffff0000, v72
    v_add_f32 v84, v84, v26
    v_add_f32 v85, v85, v27
    v_lshlrev_b32 v26, 16, v73
    v_and_b32 v27, 0xffff0000, v73
    v_add_f32 v86, v86, v26
    v_add_f32 v87, v87, v27
    v_lshlrev_b32 v26, 16, v74
    v_and_b32 v27, 0xffff0000, v74
    v_add_f32 v88, v88, v26
    v_add_f32 v89, v89, v27
    v_lshlrev_b32 v26, 16, v75
    v_and_b32 v27, 0xffff0000, v75
    v_add_f32 v90, v90, v26
    v_add_f32 v91, v91, v27
    ds_write_b128 v42, v[76:79]
    ds_write_b128 v42, v[80:83] offset:16
    s_mov_b64 exec, 0xff
    ds_write_b128 v43, v[84:87]
    ds_write_b128 v43, v[88:91] offset:16
    s_mov_b64 exec, -1
    s_mul_i32 s47, s28, 2336
    s_add_u32 s47, s47, 0x22000
    v_lshl_add_u32 v5, v1, 4, s47
    v_lshl_add_u32 v6, v1, 2, s47
    s_waitcnt lgkmcnt(0)
    s_barrier
    ds_read_b128 v[16:19], v5
    ds_read_b128 v[20:23], v5 offset:1024
    ds_read_b32 v24, v6 offset:2048
    s_waitcnt lgkmcnt(0)
    v_lshlrev_b32 v30, 16, v10
    v_and_b32 v31, 0xffff0000, v10
    v_lshlrev_b32 v32, 16, v11
    v_and_b32 v33, 0xffff0000, v11
    v_lshlrev_b32 v34, 16, v12
    v_and_b32 v35, 0xffff0000, v12
    v_lshlrev_b32 v36, 16, v13
    v_and_b32 v37, 0xffff0000, v13
    v_lshlrev_b32 v38, 16, v14
    v_add_f32 v30, v30, v16
    v_add_f32 v31, v31, v17
    v_add_f32 v32, v32, v18
    v_add_f32 v33, v33, v19
    v_add_f32 v34, v34, v20
    v_add_f32 v35, v35, v21
    v_add_f32 v36, v36, v22
    v_add_f32 v37, v37, v23
    v_add_f32 v38, v38, v24
    v_cvt_pk_bf16_f32 v10, v30, v31
    v_cvt_pk_bf16_f32 v11, v32, v33
    v_cvt_pk_bf16_f32 v12, v34, v35
    v_cvt_pk_bf16_f32 v13, v36, v37
    v_cvt_pk_bf16_f32 v14, v38, v38
    buffer_store_dwordx2 v[10:11], v7, s[24:27], 0 offen sc0 sc1
    buffer_store_dwordx2 v[12:13], v7, s[24:27], 0 offen offset:512 sc0 sc1
    buffer_store_short v14, v8, s[24:27], 0 offen offset:1024 sc0 sc1
    v_lshlrev_b32 v30, 16, v10
    v_and_b32 v31, 0xffff0000, v10
    v_lshlrev_b32 v32, 16, v11
    v_and_b32 v33, 0xffff0000, v11
    v_lshlrev_b32 v34, 16, v12
    v_and_b32 v35, 0xffff0000, v12
    v_lshlrev_b32 v36, 16, v13
    v_and_b32 v37, 0xffff0000, v13
    v_lshlrev_b32 v38, 16, v14
    v_add_f32 v20, v30, v31
    v_add_f32 v21, v32, v33
    v_add_f32 v22, v34, v35
    v_add_f32 v23, v36, v37
    v_add_f32 v20, v20, v21
    v_add_f32 v22, v22, v23
    v_add_f32 v20, v20, v38
    v_add_f32 v20, v20, v22
    s_nop 1
    v_add_f32_dpp v20, v20, v20 quad_perm:[1,0,3,2] row_mask:0xf bank_mask:0xf
    s_nop 1
    v_add_f32_dpp v20, v20, v20 quad_perm:[2,3,0,1] row_mask:0xf bank_mask:0xf
    s_nop 1
    v_add_f32_dpp v20, v20, v20 row_half_mirror row_mask:0xf bank_mask:0xf
    s_nop 1
    v_add_f32_dpp v20, v20, v20 row_mirror row_mask:0xf bank_mask:0xf
    s_nop 1
    v_readlane_b32 s32, v20, 0
    v_readlane_b32 s33, v20, 16
    v_readlane_b32 s34, v20, 32
    v_readlane_b32 s35, v20, 48
    s_nop 1
    v_mov_b32 v20, s32
    v_add_f32 v20, s33, v20
    v_add_f32 v20, s34, v20
    v_add_f32 v20, s35, v20
    v_mul_f32 v20, 0x3ae38e39, v20
    v_cvt_pk_bf16_f32 v23, v20, v20
    v_lshlrev_b32 v23, 16, v23
    v_sub_f32 v20, v20, v23
    v_sub_f32 v30, v30, v23
    v_sub_f32 v31, v31, v23
    v_sub_f32 v32, v32, v23
    v_sub_f32 v33, v33, v23
    v_sub_f32 v34, v34, v23
    v_sub_f32 v35, v35, v23
    v_sub_f32 v36, v36, v23
    v_sub_f32 v37, v37, v23
    v_sub_f32 v38, v38, v23
    v_mul_f32 v21, v30, v30
    v_mul_f32 v22, v31, v31
    v_fmac_f32 v21, v32, v32
    v_fmac_f32 v22, v33, v33
    v_fmac_f32 v21, v34, v34
    v_fmac_f32 v22, v35, v35
    v_fmac_f32 v21, v36, v36
    v_fmac_f32 v22, v37, v37
    v_fmac_f32 v21, v38, v38
    v_add_f32 v21, v21, v22
    s_nop 1
    v_add_f32_dpp v21, v21, v21 quad_perm:[1,0,3,2] row_mask:0xf bank_mask:0xf
    s_nop 1
    v_add_f32_dpp v21, v21, v21 quad_perm:[2,3,0,1] row_mask:0xf bank_mask:0xf
    s_nop 1
    v_add_f32_dpp v21, v21, v21 row_half_mirror row_mask:0xf bank_mask:0xf
    s_nop 1
    v_add_f32_dpp v21, v21, v21 row_mirror row_mask:0xf bank_mask:0xf
    s_nop 1
    v_readlane_b32 s32, v21, 0
    v_readlane_b32 s33, v21, 16
    v_readlane_b32 s34, v21, 32
    v_readlane_b32 s35, v21, 48
    s_nop 1
    v_mov_b32 v21, s32
    v_add_f32 v21, s33, v21
    v_add_f32 v21, s34, v21
    v_add_f32 v21, s35, v21
    v_mul_f32 v21, 0x3ae38e39, v21
    v_fma_f32 v21, -v20, v20, v21
    v_max_f32 v21, 0, v21
    v_cvt_pk_bf16_f32 v22, v21, v21
    v_lshlrev_b32 v22, 16, v22
    v_add_f32 v22, 0x3727c5ac, v22
    v_cvt_pk_bf16_f32 v22, v22, v22
    v_lshlrev_b32 v22, 16, v22
    v_sqrt_f32 v22, v22
    v_cvt_pk_bf16_f32 v24, v30, v31
    v_cvt_pk_bf16_f32 v25, v32, v33
    v_cvt_pk_bf16_f32 v26, v34, v35
    v_cvt_pk_bf16_f32 v27, v36, v37
    v_cvt_pk_bf16_f32 v28, v38, v38
    v_cvt_pk_bf16_f32 v22, v22, v22
    v_lshlrev_b32 v22, 16, v22
    v_rcp_f32 v22, v22
    v_lshlrev_b32 v30, 16, v24
    v_and_b32 v31, 0xffff0000, v24
    v_lshlrev_b32 v32, 16, v25
    v_and_b32 v33, 0xffff0000, v25
    v_lshlrev_b32 v34, 16, v26
    v_and_b32 v35, 0xffff0000, v26
    v_lshlrev_b32 v36, 16, v27
    v_and_b32 v37, 0xffff0000, v27
    v_lshlrev_b32 v38, 16, v28
    v_mul_f32 v30, v30, v22
    v_mul_f32 v31, v31, v22
    v_mul_f32 v32, v32, v22
    v_mul_f32 v33, v33, v22
    v_mul_f32 v34, v34, v22
    v_mul_f32 v35, v35, v22
    v_mul_f32 v36, v36, v22
    v_mul_f32 v37, v37, v22
    v_mul_f32 v38, v38, v22
    v_cvt_pk_bf16_f32 v24, v30, v31
    v_cvt_pk_bf16_f32 v25, v32, v33
    v_cvt_pk_bf16_f32 v26, v34, v35
    v_cvt_pk_bf16_f32 v27, v36, v37
    v_cvt_pk_bf16_f32 v28, v38, v38
    buffer_store_dwordx2 v[24:25], v7, s[52:55], 0 offen sc0 sc1
    buffer_store_dwordx2 v[26:27], v7, s[52:55], 0 offen offset:512 sc0 sc1
    buffer_store_short v28, v8, s[52:55], 0 offen offset:1024 sc0 sc1
    s_lshl_b32 s44, s37, 4
    s_add_u32 s44, s44, s39
    s_waitcnt vmcnt(0)
    s_barrier
    s_cmp_lg_u32 s28, 0
    s_cbranch_scc1 LPB_rompt_kernel_48
    s_add_u32 s72, s4, 0x1201400
    s_addc_u32 s73, s5, 0
    s_mov_b32 s74, 0xc00
    s_and_b32 s73, s73, 0xffff
    s_mov_b32 s75, 0x20000
    s_mov_b64 exec, 1
    s_lshl_b32 s46, s44, 2
    v_mov_b32 v2, s46
    v_mov_b32 v3, 1
    buffer_store_dword v3, v2, s[72:75], 0 offen sc0 sc1
    s_mov_b64 exec, -1
LPB_rompt_kernel_48:
    s_load_dwordx2 s[4:5], s[0:1], 88
    s_load_dwordx4 s[8:11], s[0:1], 48
    v_and_b32 v1, 63, v0
    v_lshrrev_b32 v2, 6, v0
    s_nop 0
    v_readfirstlane_b32 s28, v2
    s_and_b32 s34, s2, 7
    s_lshr_b32 s35, s2, 3
    s_lshl_b32 s38, s34, 2
    s_and_b32 s36, s35, 3
    s_add_u32 s38, s38, s36
    s_lshr_b32 s37, s35, 2
    s_lshl_b32 s29, s28, 10
    s_and_b32 s44, s28, 3
    s_lshl_b32 s30, s44, 8
    s_lshr_b32 s45, s28, 2
    s_mul_i32 s45, s45, 9216
    s_add_u32 s30, s30, s45
    v_lshrrev_b32 v2, 2, v1
    s_lshl_b32 s33, s28, 4
    v_add_u32 v2, s33, v2
    v_lshrrev_b32 v3, 2, v2
    v_sub_u32 v3, 0, v3
    v_xor_b32 v3, v3, v1
    v_and_b32 v3, 3, v3
    v_mul_u32_u24 v8, 1152, v2
    v_lshl_add_u32 v8, v3, 4, v8
    s_lshl_b32 s33, s28, 6
    v_add_u32 v2, s33, v1
    v_mul_u32_u24 v3, 3641, v2
    v_lshrrev_b32 v3, 16, v3
    v_mul_u32_u24 v4, 18, v3
    v_sub_u32 v4, v2, v4
    v_and_b32 v5, 0x13, v3
    v_and_b32 v6, 4, v3
    v_lshl_or_b32 v5, v6, 1, v5
    v_and_b32 v6, 8, v3
    v_lshrrev_b32 v6, 1, v6
    v_or_b32 v5, v5, v6
    v_mul_u32_u24 v9, 9216, v5
    v_lshl_add_u32 v9, v4, 4, v9
    s_lshl_b32 s33, s44, 4
    s_add_u32 s33, s33, 512
    v_add_u32 v2, s33, v1
    v_mul_u32_u24 v3, 3641, v2
    v_lshrrev_b32 v3, 16, v3
    v_mul_u32_u24 v4, 18, v3
    v_sub_u32 v4, v2, v4
    v_and_b32 v5, 0x13, v3
    v_and_b32 v6, 4, v3
    v_lshl_or_b32 v5, v6, 1, v5
    v_and_b32 v6, 8, v3
    v_lshrrev_b32 v6, 1, v6
    v_or_b32 v5, v5, v6
    v_mul_u32_u24 v10, 9216, v5
    v_lshl_add_u32 v10, v4, 4, v10
    s_mov_b32 s31, 0
    s_mov_b32 s32, 0
    s_waitcnt lgkmcnt(0)
    s_mul_i32 s44, s37, 294912
    s_add_u32 s12, s4, 0x2400000
    s_addc_u32 s13, s5, 0
    s_add_u32 s12, s12, s44
    s_addc_u32 s13, s13, 0
    s_sub_u32 s14, 0x240000, s44
    s_and_b32 s13, s13, 0xffff
    s_mov_b32 s15, 0x20000
    s_mul_i32 s44, s38, 288
    s_add_u32 s16, s8, 0x0
    s_addc_u32 s17, s9, 0
    s_add_u32 s16, s16, s44
    s_addc_u32 s17, s17, 0
    s_sub_u32 s18, 0x510000, s44
    s_and_b32 s17, s17, 0xffff
    s_mov_b32 s19, 0x20000
    s_add_u32 s20, s10, 0x0
    s_addc_u32 s21, s11, 0
    s_add_u32 s20, s20, s44
    s_addc_u32 s21, s21, 0
    s_sub_u32 s22, 0x510000, s44
    s_and_b32 s21, s21, 0xffff
    s_mov_b32 s23, 0x20000
    s_cmp_lt_u32 s28, 4
    s_cselect_b32 s40, s16, s20
    s_cselect_b32 s41, s17, s21
    s_cselect_b32 s42, s18, s22
    s_mov_b32 s43, 0x20000
    s_add_u32 m0, s29, 0x4000
    s_nop 0
    buffer_load_dwordx4 v9, s[16:19], s32 offen lds
    s_add_u32 m0, s29, 0x6400
    s_nop 0
    buffer_load_dwordx4 v9, s[20:23], s32 offen lds
    s_add_u32 m0, s30, 0x6000
    s_mov_b64 exec, 0xffff
    buffer_load_dwordx4 v10, s[40:43], s32 offen lds
    s_mov_b64 exec, -1
    s_add_u32 s32, s32, 0x48000
    s_add_u32 m0, s29, 0xc800
    s_nop 0
    buffer_load_dwordx4 v9, s[16:19], s32 offen lds
    s_add_u32 m0, s29, 0xec00
    s_nop 0
    buffer_load_dwordx4 v9, s[20:23], s32 offen lds
    s_add_u32 m0, s30, 0xe800
    s_mov_b64 exec, 0xffff
    buffer_load_dwordx4 v10, s[40:43], s32 offen lds
    s_mov_b64 exec, -1
    s_add_u32 s32, s32, 0x48000
    s_add_u32 m0, s29, 0x15000
    s_nop 0
    buffer_load_dwordx4 v9, s[16:19], s32 offen lds
    s_add_u32 m0, s29, 0x17400
    s_nop 0
    buffer_load_dwordx4 v9, s[20:23], s32 offen lds
    s_add_u32 m0, s30, 0x17000
    s_mov_b64 exec, 0xffff
    buffer_load_dwordx4 v10, s[40:43], s32 offen lds
    s_mov_b64 exec, -1
    s_add_u32 s32, s32, 0x48000
    s_lshl_b32 s44, s37, 5
    v_add_u32 v2, s44, v1
    s_cmp_lg_u32 s28, 0
    s_cbranch_scc1 LFS_rompt_kernel_49
    s_add_u32 s72, s4, 0x1201400
    s_addc_u32 s73, s5, 0
    s_mov_b32 s74, 0xc00
    s_and_b32 s73, s73, 0xffff
    s_mov_b32 s75, 0x20000
    v_lshlrev_b32 v2, 2, v2
    s_mov_b64 exec, 0xffffffff
    s_mov_b32 s45, 0
LFW_rompt_kernel_50:
    buffer_load_dword v3, v2, s[72:75], 0 offen sc0 sc1
    s_waitcnt vmcnt(0)
    v_cmp_ne_u32 vcc, 1, v3
    s_nop 3
    s_cmp_eq_u64 vcc, 0
    s_cbranch_scc1 LFD_rompt_kernel_51
    s_add_u32 s45, s45, 1
    s_cmp_lt_u32 s45, 0x100000
    s_cbranch_scc1 LFW_rompt_kernel_50
LFD_rompt_kernel_51:
    s_mov_b64 exec, -1
LFS_rompt_kernel_49:
    s_barrier
    s_add_u32 m0, s29, 0x0
    s_nop 0
    buffer_load_dwordx4 v8, s[12:15], s31 offen lds
    s_add_u32 m0, s29, 0x2000
    s_add_u32 s33, s31, 0x24000
    buffer_load_dwordx4 v8, s[12:15], s33 offen lds
    s_add_u32 s31, s31, 64
    s_add_u32 m0, s29, 0x8800
    s_nop 0
    buffer_load_dwordx4 v8, s[12:15], s31 offen lds
    s_add_u32 m0, s29, 0xa800
    s_add_u32 s33, s31, 0x24000
    buffer_load_dwordx4 v8, s[12:15], s33 offen lds
    s_add_u32 s31, s31, 64
    s_add_u32 m0, s29, 0x11000
    s_nop 0
    buffer_load_dwordx4 v8, s[12:15], s31 offen lds
    s_add_u32 m0, s29, 0x13000
    s_add_u32 s33, s31, 0x24000
    buffer_load_dwordx4 v8, s[12:15], s33 offen lds
    s_add_u32 s31, s31, 64
    v_and_b32 v2, 15, v1
    v_lshrrev_b32 v3, 4, v1
    v_lshrrev_b32 v4, 2, v2
    v_sub_u32 v4, 0, v4
    v_xor_b32 v4, v4, v3
    v_and_b32 v4, 3, v4
    v_lshlrev_b32 v4, 4, v4
    v_lshl_add_u32 v4, v2, 6, v4
    s_and_b32 s33, s28, 3
    s_lshl_b32 s33, s33, 12
    v_add_u32 v5, s33, v4
    v_add_u32 v12, 0x0, v5
    v_add_u32 v13, 0x8800, v5
    v_add_u32 v14, 0x11000, v5
    v_lshrrev_b32 v4, 5, v1
    v_lshlrev_b32 v4, 4, v4
    v_bfe_u32 v5, v1, 4, 1
    v_lshl_add_u32 v4, v5, 2, v4
    v_bfe_u32 v5, v1, 2, 2
    v_add_u32 v4, v4, v5
    v_mul_u32_u24 v4, 288, v4
    v_and_b32 v5, 3, v1
    v_lshl_add_u32 v4, v5, 3, v4
    v_add_u32 v16, 0x4000, v4
    v_add_u32 v17, 0xc800, v4
    v_add_u32 v18, 0x15000, v4
    s_lshl_b32 s44, s37, 3
    s_and_b32 s46, s28, 3
    s_lshl_b32 s46, s46, 1
    s_add_u32 s44, s44, s46
    s_mul_i32 s44, s44, 288
    s_mul_i32 s46, s38, 9
    s_add_u32 s44, s44, s46
    s_lshl_b32 s44, s44, 10
    s_add_u32 s24, s4, 0x4400000
    s_addc_u32 s25, s5, 0
    s_add_u32 s24, s24, s44
    s_addc_u32 s25, s25, 0
    s_sub_u32 s26, 0x1200000, s44
    s_and_b32 s25, s25, 0xffff
    s_mov_b32 s27, 0x20000
    v_lshlrev_b32 v7, 4, v1
    s_mov_b32 s46, 0xbfb8aa3b
    s_mov_b32 s47, s46
    s_waitcnt vmcnt(4)
    s_barrier
    s_cmp_ge_u32 s28, 4
    s_cbranch_scc1 LG_rompt_kernel_53
    ds_read_b128 v[60:63], v12 offset:0
    ds_read_b128 v[64:67], v12 offset:1024
    ds_read_b128 v[68:71], v12 offset:2048
    ds_read_b128 v[72:75], v12 offset:3072
    ds_read_b64_tr_b16 v[20:21], v16 offset:0
    ds_read_b64_tr_b16 v[22:23], v16 offset:2304
    ds_read_b64_tr_b16 v[24:25], v16 offset:9216
    ds_read_b64_tr_b16 v[26:27], v16 offset:11520
    ds_read_b64_tr_b16 v[28:29], v16 offset:32
    ds_read_b64_tr_b16 v[30:31], v16 offset:2336
    ds_read_b64_tr_b16 v[32:33], v16 offset:9248
    ds_read_b64_tr_b16 v[34:35], v16 offset:11552
    ds_read_b64_tr_b16 v[36:37], v16 offset:64
    ds_read_b64_tr_b16 v[38:39], v16 offset:2368
    ds_read_b64_tr_b16 v[40:41], v16 offset:9280
    s_waitcnt lgkmcnt(13)
    ds_read_b64_tr_b16 v[42:43], v16 offset:11584
    ds_read_b64_tr_b16 v[44:45], v16 offset:96
    s_waitcnt lgkmcnt(13)
    ds_read_b64_tr_b16 v[46:47], v16 offset:2400
    ds_read_b64_tr_b16 v[48:49], v16 offset:9312
    s_waitcnt lgkmcnt(13)
    ds_read_b64_tr_b16 v[50:51], v16 offset:11616
    v_mfma_f32_16x16x32_bf16 v[92:95], v[20:23], v[60:63], 0
    v_mfma_f32_16x16x32_bf16 v[96:99], v[20:23], v[64:67], 0
    v_mfma_f32_16x16x32_bf16 v[100:103], v[20:23], v[68:71], 0
    v_mfma_f32_16x16x32_bf16 v[104:107], v[20:23], v[72:75], 0
    ds_read_b64_tr_b16 v[52:53], v16 offset:128
    s_waitcnt lgkmcnt(13)
    ds_read_b64_tr_b16 v[54:55], v16 offset:2432
    v_mfma_f32_16x16x32_bf16 v[108:111], v[24:27], v[60:63], 0
    v_mfma_f32_16x16x32_bf16 v[112:115], v[24:27], v[64:67], 0
    v_mfma_f32_16x16x32_bf16 v[116:119], v[24:27], v[68:71], 0
    v_mfma_f32_16x16x32_bf16 v[120:123], v[24:27], v[72:75], 0
    ds_read_b64_tr_b16 v[56:57], v16 offset:9344
    s_waitcnt lgkmcnt(13)
    ds_read_b64_tr_b16 v[58:59], v16 offset:11648
    v_mfma_f32_16x16x32_bf16 v[124:127], v[28:31], v[60:63], 0
    v_mfma_f32_16x16x32_bf16 v[128:131], v[28:31], v[64:67], 0
    v_mfma_f32_16x16x32_bf16 v[132:135], v[28:31], v[68:71], 0
    v_mfma_f32_16x16x32_bf16 v[136:139], v[28:31], v[72:75], 0
    s_waitcnt lgkmcnt(12)
    v_mfma_f32_16x16x32_bf16 v[140:143], v[32:35], v[60:63], 0
    v_mfma_f32_16x16x32_bf16 v[144:147], v[32:35], v[64:67], 0
    v_mfma_f32_16x16x32_bf16 v[148:151], v[32:35], v[68:71], 0
    v_mfma_f32_16x16x32_bf16 v[152:155], v[32:35], v[72:75], 0
    s_waitcnt vmcnt(2) lgkmcnt(0)
    s_barrier
    ds_read_b128 v[76:79], v13 offset:0
    ds_read_b128 v[80:83], v13 offset:1024
    ds_read_b128 v[84:87], v13 offset:2048
    s_add_u32 m0, s29, 0x0
    s_nop 0
    buffer_load_dwordx4 v8, s[12:15], s31 offen lds
    v_mfma_f32_16x16x32_bf16 v[156:159], v[36:39], v[60:63], 0
    v_mfma_f32_16x16x32_bf16 v[160:163], v[36:39], v[64:67], 0
    v_mfma_f32_16x16x32_bf16 v[164:167], v[36:39], v[68:71], 0
    v_mfma_f32_16x16x32_bf16 v[168:171], v[36:39], v[72:75], 0
    ds_read_b128 v[88:91], v13 offset:3072
    ds_read_b64_tr_b16 v[20:21], v17 offset:0
    ds_read_b64_tr_b16 v[22:23], v17 offset:2304
    s_add_u32 m0, s29, 0x2000
    s_add_u32 s33, s31, 0x24000
    buffer_load_dwordx4 v8, s[12:15], s33 offen lds
    s_add_u32 s31, s31, 64
    v_mfma_f32_16x16x32_bf16 v[172:175], v[40:43], v[60:63], 0
    v_mfma_f32_16x16x32_bf16 v[176:179], v[40:43], v[64:67], 0
    v_mfma_f32_16x16x32_bf16 v[180:183], v[40:43], v[68:71], 0
    v_mfma_f32_16x16x32_bf16 v[184:187], v[40:43], v[72:75], 0
    ds_read_b64_tr_b16 v[24:25], v17 offset:9216
    ds_read_b64_tr_b16 v[26:27], v17 offset:11520
    ds_read_b64_tr_b16 v[28:29], v17 offset:32
    ds_read_b64_tr_b16 v[30:31], v17 offset:2336
    s_add_u32 m0, s29, 0x4000
    s_nop 0
    buffer_load_dwordx4 v9, s[16:19], s32 offen lds
    v_mfma_f32_16x16x32_bf16 v[188:191], v[44:47], v[60:63], 0
    v_mfma_f32_16x16x32_bf16 v[192:195], v[44:47], v[64:67], 0
    v_mfma_f32_16x16x32_bf16 v[196:199], v[44:47], v[68:71], 0
    v_mfma_f32_16x16x32_bf16 v[200:203], v[44:47], v[72:75], 0
    ds_read_b64_tr_b16 v[32:33], v17 offset:9248
    ds_read_b64_tr_b16 v[34:35], v17 offset:11552
    ds_read_b64_tr_b16 v[36:37], v17 offset:64
    ds_read_b64_tr_b16 v[38:39], v17 offset:2368
    s_add_u32 m0, s29, 0x6400
    s_nop 0
    buffer_load_dwordx4 v9, s[20:23], s32 offen lds
    v_mfma_f32_16x16x32_bf16 v[204:207], v[48:51], v[60:63], 0
    v_mfma_f32_16x16x32_bf16 v[208:211], v[48:51], v[64:67], 0
    v_mfma_f32_16x16x32_bf16 v[212:215], v[48:51], v[68:71], 0
    v_mfma_f32_16x16x32_bf16 v[216:219], v[48:51], v[72:75], 0
    ds_read_b64_tr_b16 v[40:41], v17 offset:9280
    s_waitcnt lgkmcnt(13)
    ds_read_b64_tr_b16 v[42:43], v17 offset:11584
    s_add_u32 m0, s30, 0x6000
    s_mov_b64 exec, 0xffff
    buffer_load_dwordx4 v10, s[40:43], s32 offen lds
    s_mov_b64 exec, -1
    s_add_u32 s32, s32, 0x48000
    v_mfma_f32_16x16x32_bf16 v[220:223], v[52:55], v[60:63], 0
    v_mfma_f32_16x16x32_bf16 v[224:227], v[52:55], v[64:67], 0
    v_mfma_f32_16x16x32_bf16 v[228:231], v[52:55], v[68:71], 0
    v_mfma_f32_16x16x32_bf16 v[232:235], v[52:55], v[72:75], 0
    ds_read_b64_tr_b16 v[44:45], v17 offset:96
    s_waitcnt lgkmcnt(13)
    ds_read_b64_tr_b16 v[46:47], v17 offset:2400
    v_mfma_f32_16x16x32_bf16 v[236:239], v[56:59], v[60:63], 0
    v_mfma_f32_16x16x32_bf16 v[240:243], v[56:59], v[64:67], 0
    v_mfma_f32_16x16x32_bf16 v[244:247], v[56:59], v[68:71], 0
    v_mfma_f32_16x16x32_bf16 v[248:251], v[56:59], v[72:75], 0
    ds_read_b64_tr_b16 v[48:49], v17 offset:9312
    s_waitcnt lgkmcnt(13)
    ds_read_b64_tr_b16 v[50:51], v17 offset:11616
    s_mov_b32 s39, 2
LP_rompt_kernel_54:
    v_mfma_f32_16x16x32_bf16 v[92:95], v[20:23], v[76:79], v[92:95]
    v_mfma_f32_16x16x32_bf16 v[96:99], v[20:23], v[80:83], v[96:99]
    v_mfma_f32_16x16x32_bf16 v[100:103], v[20:23], v[84:87], v[100:103]
    v_mfma_f32_16x16x32_bf16 v[104:107], v[20:23], v[88:91], v[104:107]
    ds_read_b64_tr_b16 v[52:53], v17 offset:128
    s_waitcnt lgkmcnt(13)
    ds_read_b64_tr_b16 v[54:55], v17 offset:2432
    v_mfma_f32_16x16x32_bf16 v[108:111], v[24:27], v[76:79], v[108:111]
    v_mfma_f32_16x16x32_bf16 v[112:115], v[24:27], v[80:83], v[112:115]
    v_mfma_f32_16x16x32_bf16 v[116:119], v[24:27], v[84:87], v[116:119]
    v_mfma_f32_16x16x32_bf16 v[120:123], v[24:27], v[88:91], v[120:123]
    ds_read_b64_tr_b16 v[56:57], v17 offset:9344
    s_waitcnt lgkmcnt(13)
    ds_read_b64_tr_b16 v[58:59], v17 offset:11648
    v_mfma_f32_16x16x32_bf16 v[124:127], v[28:31], v[76:79], v[124:127]
    v_mfma_f32_16x16x32_bf16 v[128:131], v[28:31], v[80:83], v[128:131]
    v_mfma_f32_16x16x32_bf16 v[132:135], v[28:31], v[84:87], v[132:135]
    v_mfma_f32_16x16x32_bf16 v[136:139], v[28:31], v[88:91], v[136:139]
    s_waitcnt lgkmcnt(12)
    v_mfma_f32_16x16x32_bf16 v[140:143], v[32:35], v[76:79], v[140:143]
    v_mfma_f32_16x16x32_bf16 v[144:147], v[32:35], v[80:83], v[144:147]
    v_mfma_f32_16x16x32_bf16 v[148:151], v[32:35], v[84:87], v[148:151]
    v_mfma_f32_16x16x32_bf16 v[152:155], v[32:35], v[88:91], v[152:155]
    s_waitcnt vmcnt(5) lgkmcnt(0)
    s_barrier
    ds_read_b128 v[60:63], v14 offset:0
    ds_read_b128 v[64:67], v14 offset:1024
    ds_read_b128 v[68:71], v14 offset:2048
    s_add_u32 m0, s29, 0x8800
    s_nop 0
    buffer_load_dwordx4 v8, s[12:15], s31 offen lds
    v_mfma_f32_16x16x32_bf16 v[156:159], v[36:39], v[76:79], v[156:159]
    v_mfma_f32_16x16x32_bf16 v[160:163], v[36:39], v[80:83], v[160:163]
    v_mfma_f32_16x16x32_bf16 v[164:167], v[36:39], v[84:87], v[164:167]
    v_mfma_f32_16x16x32_bf16 v[168:171], v[36:39], v[88:91], v[168:171]
    ds_read_b128 v[72:75], v14 offset:3072
    ds_read_b64_tr_b16 v[20:21], v18 offset:0
    ds_read_b64_tr_b16 v[22:23], v18 offset:2304
    s_add_u32 m0, s29, 0xa800
    s_add_u32 s33, s31, 0x24000
    buffer_load_dwordx4 v8, s[12:15], s33 offen lds
    s_add_u32 s31, s31, 64
    v_mfma_f32_16x16x32_bf16 v[172:175], v[40:43], v[76:79], v[172:175]
    v_mfma_f32_16x16x32_bf16 v[176:179], v[40:43], v[80:83], v[176:179]
    v_mfma_f32_16x16x32_bf16 v[180:183], v[40:43], v[84:87], v[180:183]
    v_mfma_f32_16x16x32_bf16 v[184:187], v[40:43], v[88:91], v[184:187]
    ds_read_b64_tr_b16 v[24:25], v18 offset:9216
    ds_read_b64_tr_b16 v[26:27], v18 offset:11520
    ds_read_b64_tr_b16 v[28:29], v18 offset:32
    ds_read_b64_tr_b16 v[30:31], v18 offset:2336
    s_add_u32 m0, s29, 0xc800
    s_nop 0
    buffer_load_dwordx4 v9, s[16:19], s32 offen lds
    v_mfma_f32_16x16x32_bf16 v[188:191], v[44:47], v[76:79], v[188:191]
    v_mfma_f32_16x16x32_bf16 v[192:195], v[44:47], v[80:83], v[192:195]
    v_mfma_f32_16x16x32_bf16 v[196:199], v[44:47], v[84:87], v[196:199]
    v_mfma_f32_16x16x32_bf16 v[200:203], v[44:47], v[88:91], v[200:203]
    ds_read_b64_tr_b16 v[32:33], v18 offset:9248
    ds_read_b64_tr_b16 v[34:35], v18 offset:11552
    ds_read_b64_tr_b16 v[36:37], v18 offset:64
    ds_read_b64_tr_b16 v[38:39], v18 offset:2368
    s_add_u32 m0, s29, 0xec00
    s_nop 0
    buffer_load_dwordx4 v9, s[20:23], s32 offen lds
    v_mfma_f32_16x16x32_bf16 v[204:207], v[48:51], v[76:79], v[204:207]
    v_mfma_f32_16x16x32_bf16 v[208:211], v[48:51], v[80:83], v[208:211]
    v_mfma_f32_16x16x32_bf16 v[212:215], v[48:51], v[84:87], v[212:215]
    v_mfma_f32_16x16x32_bf16 v[216:219], v[48:51], v[88:91], v[216:219]
    ds_read_b64_tr_b16 v[40:41], v18 offset:9280
    s_waitcnt lgkmcnt(13)
    ds_read_b64_tr_b16 v[42:43], v18 offset:11584
    s_add_u32 m0, s30, 0xe800
    s_mov_b64 exec, 0xffff
    buffer_load_dwordx4 v10, s[40:43], s32 offen lds
    s_mov_b64 exec, -1
    s_add_u32 s32, s32, 0x48000
    v_mfma_f32_16x16x32_bf16 v[220:223], v[52:55], v[76:79], v[220:223]
    v_mfma_f32_16x16x32_bf16 v[224:227], v[52:55], v[80:83], v[224:227]
    v_mfma_f32_16x16x32_bf16 v[228:231], v[52:55], v[84:87], v[228:231]
    v_mfma_f32_16x16x32_bf16 v[232:235], v[52:55], v[88:91], v[232:235]
    ds_read_b64_tr_b16 v[44:45], v18 offset:96
    s_waitcnt lgkmcnt(13)
    ds_read_b64_tr_b16 v[46:47], v18 offset:2400
    v_mfma_f32_16x16x32_bf16 v[236:239], v[56:59], v[76:79], v[236:239]
    v_mfma_f32_16x16x32_bf16 v[240:243], v[56:59], v[80:83], v[240:243]
    v_mfma_f32_16x16x32_bf16 v[244:247], v[56:59], v[84:87], v[244:247]
    v_mfma_f32_16x16x32_bf16 v[248:251], v[56:59], v[88:91], v[248:251]
    ds_read_b64_tr_b16 v[48:49], v18 offset:9312
    s_waitcnt lgkmcnt(13)
    ds_read_b64_tr_b16 v[50:51], v18 offset:11616
    v_mfma_f32_16x16x32_bf16 v[92:95], v[20:23], v[60:63], v[92:95]
    v_mfma_f32_16x16x32_bf16 v[96:99], v[20:23], v[64:67], v[96:99]
    v_mfma_f32_16x16x32_bf16 v[100:103], v[20:23], v[68:71], v[100:103]
    v_mfma_f32_16x16x32_bf16 v[104:107], v[20:23], v[72:75], v[104:107]
    ds_read_b64_tr_b16 v[52:53], v18 offset:128
    s_waitcnt lgkmcnt(13)
    ds_read_b64_tr_b16 v[54:55], v18 offset:2432
    v_mfma_f32_16x16x32_bf16 v[108:111], v[24:27], v[60:63], v[108:111]
    v_mfma_f32_16x16x32_bf16 v[112:115], v[24:27], v[64:67], v[112:115]
    v_mfma_f32_16x16x32_bf16 v[116:119], v[24:27], v[68:71], v[116:119]
    v_mfma_f32_16x16x32_bf16 v[120:123], v[24:27], v[72:75], v[120:123]
    ds_read_b64_tr_b16 v[56:57], v18 offset:9344
    s_waitcnt lgkmcnt(13)
    ds_read_b64_tr_b16 v[58:59], v18 offset:11648
    v_mfma_f32_16x16x32_bf16 v[124:127], v[28:31], v[60:63], v[124:127]
    v_mfma_f32_16x16x32_bf16 v[128:131], v[28:31], v[64:67], v[128:131]
    v_mfma_f32_16x16x32_bf16 v[132:135], v[28:31], v[68:71], v[132:135]
    v_mfma_f32_16x16x32_bf16 v[136:139], v[28:31], v[72:75], v[136:139]
    s_waitcnt lgkmcnt(12)
    v_mfma_f32_16x16x32_bf16 v[140:143], v[32:35], v[60:63], v[140:143]
    v_mfma_f32_16x16x32_bf16 v[144:147], v[32:35], v[64:67], v[144:147]
    v_mfma_f32_16x16x32_bf16 v[148:151], v[32:35], v[68:71], v[148:151]
    v_mfma_f32_16x16x32_bf16 v[152:155], v[32:35], v[72:75], v[152:155]
    s_waitcnt vmcnt(5) lgkmcnt(0)
    s_barrier
    ds_read_b128 v[76:79], v12 offset:0
    ds_read_b128 v[80:83], v12 offset:1024
    ds_read_b128 v[84:87], v12 offset:2048
    s_add_u32 m0, s29, 0x11000
    s_nop 0
    buffer_load_dwordx4 v8, s[12:15], s31 offen lds
    v_mfma_f32_16x16x32_bf16 v[156:159], v[36:39], v[60:63], v[156:159]
    v_mfma_f32_16x16x32_bf16 v[160:163], v[36:39], v[64:67], v[160:163]
    v_mfma_f32_16x16x32_bf16 v[164:167], v[36:39], v[68:71], v[164:167]
    v_mfma_f32_16x16x32_bf16 v[168:171], v[36:39], v[72:75], v[168:171]
    ds_read_b128 v[88:91], v12 offset:3072
    ds_read_b64_tr_b16 v[20:21], v16 offset:0
    ds_read_b64_tr_b16 v[22:23], v16 offset:2304
    s_add_u32 m0, s29, 0x13000
    s_add_u32 s33, s31, 0x24000
    buffer_load_dwordx4 v8, s[12:15], s33 offen lds
    s_add_u32 s31, s31, 64
    v_mfma_f32_16x16x32_bf16 v[172:175], v[40:43], v[60:63], v[172:175]
    v_mfma_f32_16x16x32_bf16 v[176:179], v[40:43], v[64:67], v[176:179]
    v_mfma_f32_16x16x32_bf16 v[180:183], v[40:43], v[68:71], v[180:183]
    v_mfma_f32_16x16x32_bf16 v[184:187], v[40:43], v[72:75], v[184:187]
    ds_read_b64_tr_b16 v[24:25], v16 offset:9216
    ds_read_b64_tr_b16 v[26:27], v16 offset:11520
    ds_read_b64_tr_b16 v[28:29], v16 offset:32
    ds_read_b64_tr_b16 v[30:31], v16 offset:2336
    s_add_u32 m0, s29, 0x15000
    s_nop 0
    buffer_load_dwordx4 v9, s[16:19], s32 offen lds
    v_mfma_f32_16x16x32_bf16 v[188:191], v[44:47], v[60:63], v[188:191]
    v_mfma_f32_16x16x32_bf16 v[192:195], v[44:47], v[64:67], v[192:195]
    v_mfma_f32_16x16x32_bf16 v[196:199], v[44:47], v[68:71], v[196:199]
    v_mfma_f32_16x16x32_bf16 v[200:203], v[44:47], v[72:75], v[200:203]
    ds_read_b64_tr_b16 v[32:33], v16 offset:9248
    ds_read_b64_tr_b16 v[34:35], v16 offset:11552
    ds_read_b64_tr_b16 v[36:37], v16 offset:64
    ds_read_b64_tr_b16 v[38:39], v16 offset:2368
    s_add_u32 m0, s29, 0x17400
    s_nop 0
    buffer_load_dwordx4 v9, s[20:23], s32 offen lds
    v_mfma_f32_16x16x32_bf16 v[204:207], v[48:51], v[60:63], v[204:207]
    v_mfma_f32_16x16x32_bf16 v[208:211], v[48:51], v[64:67], v[208:211]
    v_mfma_f32_16x16x32_bf16 v[212:215], v[48:51], v[68:71], v[212:215]
    v_mfma_f32_16x16x32_bf16 v[216:219], v[48:51], v[72:75], v[216:219]
    ds_read_b64_tr_b16 v[40:41], v16 offset:9280
    s_waitcnt lgkmcnt(13)
    ds_read_b64_tr_b16 v[42:43], v16 offset:11584
    s_add_u32 m0, s30, 0x17000
    s_mov_b64 exec, 0xffff
    buffer_load_dwordx4 v10, s[40:43], s32 offen lds
    s_mov_b64 exec, -1
    s_add_u32 s32, s32, 0x48000
    v_mfma_f32_16x16x32_bf16 v[220:223], v[52:55], v[60:63], v[220:223]
    v_mfma_f32_16x16x32_bf16 v[224:227], v[52:55], v[64:67], v[224:227]
    v_mfma_f32_16x16x32_bf16 v[228:231], v[52:55], v[68:71], v[228:231]
    v_mfma_f32_16x16x32_bf16 v[232:235], v[52:55], v[72:75], v[232:235]
    ds_read_b64_tr_b16 v[44:45], v16 offset:96
    s_waitcnt lgkmcnt(13)
    ds_read_b64_tr_b16 v[46:47], v16 offset:2400
    v_mfma_f32_16x16x32_bf16 v[236:239], v[56:59], v[60:63], v[236:239]
    v_mfma_f32_16x16x32_bf16 v[240:243], v[56:59], v[64:67], v[240:243]
    v_mfma_f32_16x16x32_bf16 v[244:247], v[56:59], v[68:71], v[244:247]
    v_mfma_f32_16x16x32_bf16 v[248:251], v[56:59], v[72:75], v[248:251]
    ds_read_b64_tr_b16 v[48:49], v16 offset:9312
    s_waitcnt lgkmcnt(13)
    ds_read_b64_tr_b16 v[50:51], v16 offset:11616
    v_mfma_f32_16x16x32_bf16 v[92:95], v[20:23], v[76:79], v[92:95]
    v_mfma_f32_16x16x32_bf16 v[96:99], v[20:23], v[80:83], v[96:99]
    v_mfma_f32_16x16x32_bf16 v[100:103], v[20:23], v[84:87], v[100:103]
    v_mfma_f32_16x16x32_bf16 v[104:107], v[20:23], v[88:91], v[104:107]
    ds_read_b64_tr_b16 v[52:53], v16 offset:128
    s_waitcnt lgkmcnt(13)
    ds_read_b64_tr_b16 v[54:55], v16 offset:2432
    v_mfma_f32_16x16x32_bf16 v[108:111], v[24:27], v[76:79], v[108:111]
    v_mfma_f32_16x16x32_bf16 v[112:115], v[24:27], v[80:83], v[112:115]
    v_mfma_f32_16x16x32_bf16 v[116:119], v[24:27], v[84:87], v[116:119]
    v_mfma_f32_16x16x32_bf16 v[120:123], v[24:27], v[88:91], v[120:123]
    ds_read_b64_tr_b16 v[56:57], v16 offset:9344
    s_waitcnt lgkmcnt(13)
    ds_read_b64_tr_b16 v[58:59], v16 offset:11648
    v_mfma_f32_16x16x32_bf16 v[124:127], v[28:31], v[76:79], v[124:127]
    v_mfma_f32_16x16x32_bf16 v[128:131], v[28:31], v[80:83], v[128:131]
    v_mfma_f32_16x16x32_bf16 v[132:135], v[28:31], v[84:87], v[132:135]
    v_mfma_f32_16x16x32_bf16 v[136:139], v[28:31], v[88:91], v[136:139]
    s_waitcnt lgkmcnt(12)
    v_mfma_f32_16x16x32_bf16 v[140:143], v[32:35], v[76:79], v[140:143]
    v_mfma_f32_16x16x32_bf16 v[144:147], v[32:35], v[80:83], v[144:147]
    v_mfma_f32_16x16x32_bf16 v[148:151], v[32:35], v[84:87], v[148:151]
    v_mfma_f32_16x16x32_bf16 v[152:155], v[32:35], v[88:91], v[152:155]
    s_waitcnt vmcnt(5) lgkmcnt(0)
    s_barrier
    ds_read_b128 v[60:63], v13 offset:0
    ds_read_b128 v[64:67], v13 offset:1024
    ds_read_b128 v[68:71], v13 offset:2048
    s_add_u32 m0, s29, 0x0
    s_nop 0
    buffer_load_dwordx4 v8, s[12:15], s31 offen lds
    v_mfma_f32_16x16x32_bf16 v[156:159], v[36:39], v[76:79], v[156:159]
    v_mfma_f32_16x16x32_bf16 v[160:163], v[36:39], v[80:83], v[160:163]
    v_mfma_f32_16x16x32_bf16 v[164:167], v[36:39], v[84:87], v[164:167]
    v_mfma_f32_16x16x32_bf16 v[168:171], v[36:39], v[88:91], v[168:171]
    ds_read_b128 v[72:75], v13 offset:3072
    ds_read_b64_tr_b16 v[20:21], v17 offset:0
    ds_read_b64_tr_b16 v[22:23], v17 offset:2304
    s_add_u32 m0, s29, 0x2000
    s_add_u32 s33, s31, 0x24000
    buffer_load_dwordx4 v8, s[12:15], s33 offen lds
    s_add_u32 s31, s31, 64
    v_mfma_f32_16x16x32_bf16 v[172:175], v[40:43], v[76:79], v[172:175]
    v_mfma_f32_16x16x32_bf16 v[176:179], v[40:43], v[80:83], v[176:179]
    v_mfma_f32_16x16x32_bf16 v[180:183], v[40:43], v[84:87], v[180:183]
    v_mfma_f32_16x16x32_bf16 v[184:187], v[40:43], v[88:91], v[184:187]
    ds_read_b64_tr_b16 v[24:25], v17 offset:9216
    ds_read_b64_tr_b16 v[26:27], v17 offset:11520
    ds_read_b64_tr_b16 v[28:29], v17 offset:32
    ds_read_b64_tr_b16 v[30:31], v17 offset:2336
    s_add_u32 m0, s29, 0x4000
    s_nop 0
    buffer_load_dwordx4 v9, s[16:19], s32 offen lds
    v_mfma_f32_16x16x32_bf16 v[188:191], v[44:47], v[76:79], v[188:191]
    v_mfma_f32_16x16x32_bf16 v[192:195], v[44:47], v[80:83], v[192:195]
    v_mfma_f32_16x16x32_bf16 v[196:199], v[44:47], v[84:87], v[196:199]
    v_mfma_f32_16x16x32_bf16 v[200:203], v[44:47], v[88:91], v[200:203]
    ds_read_b64_tr_b16 v[32:33], v17 offset:9248
    ds_read_b64_tr_b16 v[34:35], v17 offset:11552
    ds_read_b64_tr_b16 v[36:37], v17 offset:64
    ds_read_b64_tr_b16 v[38:39], v17 offset:2368
    s_add_u32 m0, s29, 0x6400
    s_nop 0
    buffer_load_dwordx4 v9, s[20:23], s32 offen lds
    v_mfma_f32_16x16x32_bf16 v[204:207], v[48:51], v[76:79], v[204:207]
    v_mfma_f32_16x16x32_bf16 v[208:211], v[48:51], v[80:83], v[208:211]
    v_mfma_f32_16x16x32_bf16 v[212:215], v[48:51], v[84:87], v[212:215]
    v_mfma_f32_16x16x32_bf16 v[216:219], v[48:51], v[88:91], v[216:219]
    ds_read_b64_tr_b16 v[40:41], v17 offset:9280
    s_waitcnt lgkmcnt(13)
    ds_read_b64_tr_b16 v[42:43], v17 offset:11584
    s_add_u32 m0, s30, 0x6000
    s_mov_b64 exec, 0xffff
    buffer_load_dwordx4 v10, s[40:43], s32 offen lds
    s_mov_b64 exec, -1
    s_add_u32 s32, s32, 0x48000
    v_mfma_f32_16x16x32_bf16 v[220:223], v[52:55], v[76:79], v[220:223]
    v_mfma_f32_16x16x32_bf16 v[224:227], v[52:55], v[80:83], v[224:227]
    v_mfma_f32_16x16x32_bf16 v[228:231], v[52:55], v[84:87], v[228:231]
    v_mfma_f32_16x16x32_bf16 v[232:235], v[52:55], v[88:91], v[232:235]
    ds_read_b64_tr_b16 v[44:45], v17 offset:96
    s_waitcnt lgkmcnt(13)
    ds_read_b64_tr_b16 v[46:47], v17 offset:2400
    v_mfma_f32_16x16x32_bf16 v[236:239], v[56:59], v[76:79], v[236:239]
    v_mfma_f32_16x16x32_bf16 v[240:243], v[56:59], v[80:83], v[240:243]
    v_mfma_f32_16x16x32_bf16 v[244:247], v[56:59], v[84:87], v[244:247]
    v_mfma_f32_16x16x32_bf16 v[248:251], v[56:59], v[88:91], v[248:251]
    ds_read_b64_tr_b16 v[48:49], v17 offset:9312
    s_waitcnt lgkmcnt(13)
    ds_read_b64_tr_b16 v[50:51], v17 offset:11616
    v_mfma_f32_16x16x32_bf16 v[92:95], v[20:23], v[60:63], v[92:95]
    v_mfma_f32_16x16x32_bf16 v[96:99], v[20:23], v[64:67], v[96:99]
    v_mfma_f32_16x16x32_bf16 v[100:103], v[20:23], v[68:71], v[100:103]
    v_mfma_f32_16x16x32_bf16 v[104:107], v[20:23], v[72:75], v[104:107]
    ds_read_b64_tr_b16 v[52:53], v17 offset:128
    s_waitcnt lgkmcnt(13)
    ds_read_b64_tr_b16 v[54:55], v17 offset:2432
    v_mfma_f32_16x16x32_bf16 v[108:111], v[24:27], v[60:63], v[108:111]
    v_mfma_f32_16x16x32_bf16 v[112:115], v[24:27], v[64:67], v[112:115]
    v_mfma_f32_16x16x32_bf16 v[116:119], v[24:27], v[68:71], v[116:119]
    v_mfma_f32_16x16x32_bf16 v[120:123], v[24:27], v[72:75], v[120:123]
    ds_read_b64_tr_b16 v[56:57], v17 offset:9344
    s_waitcnt lgkmcnt(13)
    ds_read_b64_tr_b16 v[58:59], v17 offset:11648
    v_mfma_f32_16x16x32_bf16 v[124:127], v[28:31], v[60:63], v[124:127]
    v_mfma_f32_16x16x32_bf16 v[128:131], v[28:31], v[64:67], v[128:131]
    v_mfma_f32_16x16x32_bf16 v[132:135], v[28:31], v[68:71], v[132:135]
    v_mfma_f32_16x16x32_bf16 v[136:139], v[28:31], v[72:75], v[136:139]
    s_waitcnt lgkmcnt(12)
    v_mfma_f32_16x16x32_bf16 v[140:143], v[32:35], v[60:63], v[140:143]
    v_mfma_f32_16x16x32_bf16 v[144:147], v[32:35], v[64:67], v[144:147]
    v_mfma_f32_16x16x32_bf16 v[148:151], v[32:35], v[68:71], v[148:151]
    v_mfma_f32_16x16x32_bf16 v[152:155], v[32:35], v[72:75], v[152:155]
    s_waitcnt vmcnt(5) lgkmcnt(0)
    s_barrier
    ds_read_b128 v[76:79], v14 offset:0
    ds_read_b128 v[80:83], v14 offset:1024
    ds_read_b128 v[84:87], v14 offset:2048
    s_add_u32 m0, s29, 0x8800
    s_nop 0
    buffer_load_dwordx4 v8, s[12:15], s31 offen lds
    v_mfma_f32_16x16x32_bf16 v[156:159], v[36:39], v[60:63], v[156:159]
    v_mfma_f32_16x16x32_bf16 v[160:163], v[36:39], v[64:67], v[160:163]
    v_mfma_f32_16x16x32_bf16 v[164:167], v[36:39], v[68:71], v[164:167]
    v_mfma_f32_16x16x32_bf16 v[168:171], v[36:39], v[72:75], v[168:171]
    ds_read_b128 v[88:91], v14 offset:3072
    ds_read_b64_tr_b16 v[20:21], v18 offset:0
    ds_read_b64_tr_b16 v[22:23], v18 offset:2304
    s_add_u32 m0, s29, 0xa800
    s_add_u32 s33, s31, 0x24000
    buffer_load_dwordx4 v8, s[12:15], s33 offen lds
    s_add_u32 s31, s31, 64
    v_mfma_f32_16x16x32_bf16 v[172:175], v[40:43], v[60:63], v[172:175]
    v_mfma_f32_16x16x32_bf16 v[176:179], v[40:43], v[64:67], v[176:179]
    v_mfma_f32_16x16x32_bf16 v[180:183], v[40:43], v[68:71], v[180:183]
    v_mfma_f32_16x16x32_bf16 v[184:187], v[40:43], v[72:75], v[184:187]
    ds_read_b64_tr_b16 v[24:25], v18 offset:9216
    ds_read_b64_tr_b16 v[26:27], v18 offset:11520
    ds_read_b64_tr_b16 v[28:29], v18 offset:32
    ds_read_b64_tr_b16 v[30:31], v18 offset:2336
    s_add_u32 m0, s29, 0xc800
    s_nop 0
    buffer_load_dwordx4 v9, s[16:19], s32 offen lds
    v_mfma_f32_16x16x32_bf16 v[188:191], v[44:47], v[60:63], v[188:191]
    v_mfma_f32_16x16x32_bf16 v[192:195], v[44:47], v[64:67], v[192:195]
    v_mfma_f32_16x16x32_bf16 v[196:199], v[44:47], v[68:71], v[196:199]
    v_mfma_f32_16x16x32_bf16 v[200:203], v[44:47], v[72:75], v[200:203]
    ds_read_b64_tr_b16 v[32:33], v18 offset:9248
    ds_read_b64_tr_b16 v[34:35], v18 offset:11552
    ds_read_b64_tr_b16 v[36:37], v18 offset:64
    ds_read_b64_tr_b16 v[38:39], v18 offset:2368
    s_add_u32 m0, s29, 0xec00
    s_nop 0
    buffer_load_dwordx4 v9, s[20:23], s32 offen lds
    v_mfma_f32_16x16x32_bf16 v[204:207], v[48:51], v[60:63], v[204:207]
    v_mfma_f32_16x16x32_bf16 v[208:211], v[48:51], v[64:67], v[208:211]
    v_mfma_f32_16x16x32_bf16 v[212:215], v[48:51], v[68:71], v[212:215]
    v_mfma_f32_16x16x32_bf16 v[216:219], v[48:51], v[72:75], v[216:219]
    ds_read_b64_tr_b16 v[40:41], v18 offset:9280
    s_waitcnt lgkmcnt(13)
    ds_read_b64_tr_b16 v[42:43], v18 offset:11584
    s_add_u32 m0, s30, 0xe800
    s_mov_b64 exec, 0xffff
    buffer_load_dwordx4 v10, s[40:43], s32 offen lds
    s_mov_b64 exec, -1
    s_add_u32 s32, s32, 0x48000
    v_mfma_f32_16x16x32_bf16 v[220:223], v[52:55], v[60:63], v[220:223]
    v_mfma_f32_16x16x32_bf16 v[224:227], v[52:55], v[64:67], v[224:227]
    v_mfma_f32_16x16x32_bf16 v[228:231], v[52:55], v[68:71], v[228:231]
    v_mfma_f32_16x16x32_bf16 v[232:235], v[52:55], v[72:75], v[232:235]
    ds_read_b64_tr_b16 v[44:45], v18 offset:96
    s_waitcnt lgkmcnt(13)
    ds_read_b64_tr_b16 v[46:47], v18 offset:2400
    v_mfma_f32_16x16x32_bf16 v[236:239], v[56:59], v[60:63], v[236:239]
    v_mfma_f32_16x16x32_bf16 v[240:243], v[56:59], v[64:67], v[240:243]
    v_mfma_f32_16x16x32_bf16 v[244:247], v[56:59], v[68:71], v[244:247]
    v_mfma_f32_16x16x32_bf16 v[248:251], v[56:59], v[72:75], v[248:251]
    ds_read_b64_tr_b16 v[48:49], v18 offset:9312
    s_waitcnt lgkmcnt(13)
    ds_read_b64_tr_b16 v[50:51], v18 offset:11616
    v_mfma_f32_16x16x32_bf16 v[92:95], v[20:23], v[76:79], v[92:95]
    v_mfma_f32_16x16x32_bf16 v[96:99], v[20:23], v[80:83], v[96:99]
    v_mfma_f32_16x16x32_bf16 v[100:103], v[20:23], v[84:87], v[100:103]
    v_mfma_f32_16x16x32_bf16 v[104:107], v[20:23], v[88:91], v[104:107]
    ds_read_b64_tr_b16 v[52:53], v18 offset:128
    s_waitcnt lgkmcnt(13)
    ds_read_b64_tr_b16 v[54:55], v18 offset:2432
    v_mfma_f32_16x16x32_bf16 v[108:111], v[24:27], v[76:79], v[108:111]
    v_mfma_f32_16x16x32_bf16 v[112:115], v[24:27], v[80:83], v[112:115]
    v_mfma_f32_16x16x32_bf16 v[116:119], v[24:27], v[84:87], v[116:119]
    v_mfma_f32_16x16x32_bf16 v[120:123], v[24:27], v[88:91], v[120:123]
    ds_read_b64_tr_b16 v[56:57], v18 offset:9344
    s_waitcnt lgkmcnt(13)
    ds_read_b64_tr_b16 v[58:59], v18 offset:11648
    v_mfma_f32_16x16x32_bf16 v[124:127], v[28:31], v[76:79], v[124:127]
    v_mfma_f32_16x16x32_bf16 v[128:131], v[28:31], v[80:83], v[128:131]
    v_mfma_f32_16x16x32_bf16 v[132:135], v[28:31], v[84:87], v[132:135]
    v_mfma_f32_16x16x32_bf16 v[136:139], v[28:31], v[88:91], v[136:139]
    s_waitcnt lgkmcnt(12)
    v_mfma_f32_16x16x32_bf16 v[140:143], v[32:35], v[76:79], v[140:143]
    v_mfma_f32_16x16x32_bf16 v[144:147], v[32:35], v[80:83], v[144:147]
    v_mfma_f32_16x16x32_bf16 v[148:151], v[32:35], v[84:87], v[148:151]
    v_mfma_f32_16x16x32_bf16 v[152:155], v[32:35], v[88:91], v[152:155]
    s_waitcnt vmcnt(5) lgkmcnt(0)
    s_barrier
    ds_read_b128 v[60:63], v12 offset:0
    ds_read_b128 v[64:67], v12 offset:1024
    ds_read_b128 v[68:71], v12 offset:2048
    s_add_u32 m0, s29, 0x11000
    s_nop 0
    buffer_load_dwordx4 v8, s[12:15], s31 offen lds
    v_mfma_f32_16x16x32_bf16 v[156:159], v[36:39], v[76:79], v[156:159]
    v_mfma_f32_16x16x32_bf16 v[160:163], v[36:39], v[80:83], v[160:163]
    v_mfma_f32_16x16x32_bf16 v[164:167], v[36:39], v[84:87], v[164:167]
    v_mfma_f32_16x16x32_bf16 v[168:171], v[36:39], v[88:91], v[168:171]
    ds_read_b128 v[72:75], v12 offset:3072
    ds_read_b64_tr_b16 v[20:21], v16 offset:0
    ds_read_b64_tr_b16 v[22:23], v16 offset:2304
    s_add_u32 m0, s29, 0x13000
    s_add_u32 s33, s31, 0x24000
    buffer_load_dwordx4 v8, s[12:15], s33 offen lds
    s_add_u32 s31, s31, 64
    v_mfma_f32_16x16x32_bf16 v[172:175], v[40:43], v[76:79], v[172:175]
    v_mfma_f32_16x16x32_bf16 v[176:179], v[40:43], v[80:83], v[176:179]
    v_mfma_f32_16x16x32_bf16 v[180:183], v[40:43], v[84:87], v[180:183]
    v_mfma_f32_16x16x32_bf16 v[184:187], v[40:43], v[88:91], v[184:187]
    ds_read_b64_tr_b16 v[24:25], v16 offset:9216
    ds_read_b64_tr_b16 v[26:27], v16 offset:11520
    ds_read_b64_tr_b16 v[28:29], v16 offset:32
    ds_read_b64_tr_b16 v[30:31], v16 offset:2336
    s_add_u32 m0, s29, 0x15000
    s_nop 0
    buffer_load_dwordx4 v9, s[16:19], s32 offen lds
    v_mfma_f32_16x16x32_bf16 v[188:191], v[44:47], v[76:79], v[188:191]
    v_mfma_f32_16x16x32_bf16 v[192:195], v[44:47], v[80:83], v[192:195]
    v_mfma_f32_16x16x32_bf16 v[196:199], v[44:47], v[84:87], v[196:199]
    v_mfma_f32_16x16x32_bf16 v[200:203], v[44:47], v[88:91], v[200:203]
    ds_read_b64_tr_b16 v[32:33], v16 offset:9248
    ds_read_b64_tr_b16 v[34:35], v16 offset:11552
    ds_read_b64_tr_b16 v[36:37], v16 offset:64
    ds_read_b64_tr_b16 v[38:39], v16 offset:2368
    s_add_u32 m0, s29, 0x17400
    s_nop 0
    buffer_load_dwordx4 v9, s[20:23], s32 offen lds
    v_mfma_f32_16x16x32_bf16 v[204:207], v[48:51], v[76:79], v[204:207]
    v_mfma_f32_16x16x32_bf16 v[208:211], v[48:51], v[80:83], v[208:211]
    v_mfma_f32_16x16x32_bf16 v[212:215], v[48:51], v[84:87], v[212:215]
    v_mfma_f32_16x16x32_bf16 v[216:219], v[48:51], v[88:91], v[216:219]
    ds_read_b64_tr_b16 v[40:41], v16 offset:9280
    s_waitcnt lgkmcnt(13)
    ds_read_b64_tr_b16 v[42:43], v16 offset:11584
    s_add_u32 m0, s30, 0x17000
    s_mov_b64 exec, 0xffff
    buffer_load_dwordx4 v10, s[40:43], s32 offen lds
    s_mov_b64 exec, -1
    s_add_u32 s32, s32, 0x48000
    v_mfma_f32_16x16x32_bf16 v[220:223], v[52:55], v[76:79], v[220:223]
    v_mfma_f32_16x16x32_bf16 v[224:227], v[52:55], v[80:83], v[224:227]
    v_mfma_f32_16x16x32_bf16 v[228:231], v[52:55], v[84:87], v[228:231]
    v_mfma_f32_16x16x32_bf16 v[232:235], v[52:55], v[88:91], v[232:235]
    ds_read_b64_tr_b16 v[44:45], v16 offset:96
    s_waitcnt lgkmcnt(13)
    ds_read_b64_tr_b16 v[46:47], v16 offset:2400
    v_mfma_f32_16x16x32_bf16 v[236:239], v[56:59], v[76:79], v[236:239]
    v_mfma_f32_16x16x32_bf16 v[240:243], v[56:59], v[80:83], v[240:243]
    v_mfma_f32_16x16x32_bf16 v[244:247], v[56:59], v[84:87], v[244:247]
    v_mfma_f32_16x16x32_bf16 v[248:251], v[56:59], v[88:91], v[248:251]
    ds_read_b64_tr_b16 v[48:49], v16 offset:9312
    s_waitcnt lgkmcnt(13)
    ds_read_b64_tr_b16 v[50:51], v16 offset:11616
    v_mfma_f32_16x16x32_bf16 v[92:95], v[20:23], v[60:63], v[92:95]
    v_mfma_f32_16x16x32_bf16 v[96:99], v[20:23], v[64:67], v[96:99]
    v_mfma_f32_16x16x32_bf16 v[100:103], v[20:23], v[68:71], v[100:103]
    v_mfma_f32_16x16x32_bf16 v[104:107], v[20:23], v[72:75], v[104:107]
    ds_read_b64_tr_b16 v[52:53], v16 offset:128
    s_waitcnt lgkmcnt(13)
    ds_read_b64_tr_b16 v[54:55], v16 offset:2432
    v_mfma_f32_16x16x32_bf16 v[108:111], v[24:27], v[60:63], v[108:111]
    v_mfma_f32_16x16x32_bf16 v[112:115], v[24:27], v[64:67], v[112:115]
    v_mfma_f32_16x16x32_bf16 v[116:119], v[24:27], v[68:71], v[116:119]
    v_mfma_f32_16x16x32_bf16 v[120:123], v[24:27], v[72:75], v[120:123]
    ds_read_b64_tr_b16 v[56:57], v16 offset:9344
    s_waitcnt lgkmcnt(13)
    ds_read_b64_tr_b16 v[58:59], v16 offset:11648
    v_mfma_f32_16x16x32_bf16 v[124:127], v[28:31], v[60:63], v[124:127]
    v_mfma_f32_16x16x32_bf16 v[128:131], v[28:31], v[64:67], v[128:131]
    v_mfma_f32_16x16x32_bf16 v[132:135], v[28:31], v[68:71], v[132:135]
    v_mfma_f32_16x16x32_bf16 v[136:139], v[28:31], v[72:75], v[136:139]
    s_waitcnt lgkmcnt(12)
    v_mfma_f32_16x16x32_bf16 v[140:143], v[32:35], v[60:63], v[140:143]
    v_mfma_f32_16x16x32_bf16 v[144:147], v[32:35], v[64:67], v[144:147]
    v_mfma_f32_16x16x32_bf16 v[148:151], v[32:35], v[68:71], v[148:151]
    v_mfma_f32_16x16x32_bf16 v[152:155], v[32:35], v[72:75], v[152:155]
    s_waitcnt vmcnt(5) lgkmcnt(0)
    s_barrier
    ds_read_b128 v[76:79], v13 offset:0
    ds_read_b128 v[80:83], v13 offset:1024
    ds_read_b128 v[84:87], v13 offset:2048
    s_add_u32 m0, s29, 0x0
    s_nop 0
    buffer_load_dwordx4 v8, s[12:15], s31 offen lds
    v_mfma_f32_16x16x32_bf16 v[156:159], v[36:39], v[60:63], v[156:159]
    v_mfma_f32_16x16x32_bf16 v[160:163], v[36:39], v[64:67], v[160:163]
    v_mfma_f32_16x16x32_bf16 v[164:167], v[36:39], v[68:71], v[164:167]
    v_mfma_f32_16x16x32_bf16 v[168:171], v[36:39], v[72:75], v[168:171]
    ds_read_b128 v[88:91], v13 offset:3072
    ds_read_b64_tr_b16 v[20:21], v17 offset:0
    ds_read_b64_tr_b16 v[22:23], v17 offset:2304
    s_add_u32 m0, s29, 0x2000
    s_add_u32 s33, s31, 0x24000
    buffer_load_dwordx4 v8, s[12:15], s33 offen lds
    s_add_u32 s31, s31, 64
    v_mfma_f32_16x16x32_bf16 v[172:175], v[40:43], v[60:63], v[172:175]
    v_mfma_f32_16x16x32_bf16 v[176:179], v[40:43], v[64:67], v[176:179]
    v_mfma_f32_16x16x32_bf16 v[180:183], v[40:43], v[68:71], v[180:183]
    v_mfma_f32_16x16x32_bf16 v[184:187], v[40:43], v[72:75], v[184:187]
    ds_read_b64_tr_b16 v[24:25], v17 offset:9216
    ds_read_b64_tr_b16 v[26:27], v17 offset:11520
    ds_read_b64_tr_b16 v[28:29], v17 offset:32
    ds_read_b64_tr_b16 v[30:31], v17 offset:2336
    s_add_u32 m0, s29, 0x4000
    s_nop 0
    buffer_load_dwordx4 v9, s[16:19], s32 offen lds
    v_mfma_f32_16x16x32_bf16 v[188:191], v[44:47], v[60:63], v[188:191]
    v_mfma_f32_16x16x32_bf16 v[192:195], v[44:47], v[64:67], v[192:195]
    v_mfma_f32_16x16x32_bf16 v[196:199], v[44:47], v[68:71], v[196:199]
    v_mfma_f32_16x16x32_bf16 v[200:203], v[44:47], v[72:75], v[200:203]
    ds_read_b64_tr_b16 v[32:33], v17 offset:9248
    ds_read_b64_tr_b16 v[34:35], v17 offset:11552
    ds_read_b64_tr_b16 v[36:37], v17 offset:64
    ds_read_b64_tr_b16 v[38:39], v17 offset:2368
    s_add_u32 m0, s29, 0x6400
    s_nop 0
    buffer_load_dwordx4 v9, s[20:23], s32 offen lds
    v_mfma_f32_16x16x32_bf16 v[204:207], v[48:51], v[60:63], v[204:207]
    v_mfma_f32_16x16x32_bf16 v[208:211], v[48:51], v[64:67], v[208:211]
    v_mfma_f32_16x16x32_bf16 v[212:215], v[48:51], v[68:71], v[212:215]
    v_mfma_f32_16x16x32_bf16 v[216:219], v[48:51], v[72:75], v[216:219]
    ds_read_b64_tr_b16 v[40:41], v17 offset:9280
    s_waitcnt lgkmcnt(13)
    ds_read_b64_tr_b16 v[42:43], v17 offset:11584
    s_add_u32 m0, s30, 0x6000
    s_mov_b64 exec, 0xffff
    buffer_load_dwordx4 v10, s[40:43], s32 offen lds
    s_mov_b64 exec, -1
    s_add_u32 s32, s32, 0x48000
    v_mfma_f32_16x16x32_bf16 v[220:223], v[52:55], v[60:63], v[220:223]
    v_mfma_f32_16x16x32_bf16 v[224:227], v[52:55], v[64:67], v[224:227]
    v_mfma_f32_16x16x32_bf16 v[228:231], v[52:55], v[68:71], v[228:231]
    v_mfma_f32_16x16x32_bf16 v[232:235], v[52:55], v[72:75], v[232:235]
    ds_read_b64_tr_b16 v[44:45], v17 offset:96
    s_waitcnt lgkmcnt(13)
    ds_read_b64_tr_b16 v[46:47], v17 offset:2400
    v_mfma_f32_16x16x32_bf16 v[236:239], v[56:59], v[60:63], v[236:239]
    v_mfma_f32_16x16x32_bf16 v[240:243], v[56:59], v[64:67], v[240:243]
    v_mfma_f32_16x16x32_bf16 v[244:247], v[56:59], v[68:71], v[244:247]
    v_mfma_f32_16x16x32_bf16 v[248:251], v[56:59], v[72:75], v[248:251]
    ds_read_b64_tr_b16 v[48:49], v17 offset:9312
    s_waitcnt lgkmcnt(13)
    ds_read_b64_tr_b16 v[50:51], v17 offset:11616
    s_sub_u32 s39, s39, 1
    s_cmp_lg_u32 s39, 0
    s_cbranch_scc1 LP_rompt_kernel_54
    v_mfma_f32_16x16x32_bf16 v[92:95], v[20:23], v[76:79], v[92:95]
    v_mfma_f32_16x16x32_bf16 v[96:99], v[20:23], v[80:83], v[96:99]
    v_mfma_f32_16x16x32_bf16 v[100:103], v[20:23], v[84:87], v[100:103]
    v_mfma_f32_16x16x32_bf16 v[104:107], v[20:23], v[88:91], v[104:107]
    ds_read_b64_tr_b16 v[52:53], v17 offset:128
    s_waitcnt lgkmcnt(13)
    ds_read_b64_tr_b16 v[54:55], v17 offset:2432
    v_mfma_f32_16x16x32_bf16 v[108:111], v[24:27], v[76:79], v[108:111]
    v_mfma_f32_16x16x32_bf16 v[112:115], v[24:27], v[80:83], v[112:115]
    v_mfma_f32_16x16x32_bf16 v[116:119], v[24:27], v[84:87], v[116:119]
    v_mfma_f32_16x16x32_bf16 v[120:123], v[24:27], v[88:91], v[120:123]
    ds_read_b64_tr_b16 v[56:57], v17 offset:9344
    s_waitcnt lgkmcnt(13)
    ds_read_b64_tr_b16 v[58:59], v17 offset:11648
    v_mfma_f32_16x16x32_bf16 v[124:127], v[28:31], v[76:79], v[124:127]
    v_mfma_f32_16x16x32_bf16 v[128:131], v[28:31], v[80:83], v[128:131]
    v_mfma_f32_16x16x32_bf16 v[132:135], v[28:31], v[84:87], v[132:135]
    v_mfma_f32_16x16x32_bf16 v[136:139], v[28:31], v[88:91], v[136:139]
    s_waitcnt lgkmcnt(12)
    v_mfma_f32_16x16x32_bf16 v[140:143], v[32:35], v[76:79], v[140:143]
    v_mfma_f32_16x16x32_bf16 v[144:147], v[32:35], v[80:83], v[144:147]
    v_mfma_f32_16x16x32_bf16 v[148:151], v[32:35], v[84:87], v[148:151]
    v_mfma_f32_16x16x32_bf16 v[152:155], v[32:35], v[88:91], v[152:155]
    s_waitcnt vmcnt(5) lgkmcnt(0)
    s_barrier
    ds_read_b128 v[60:63], v14 offset:0
    ds_read_b128 v[64:67], v14 offset:1024
    ds_read_b128 v[68:71], v14 offset:2048
    s_add_u32 m0, s29, 0x8800
    s_nop 0
    buffer_load_dwordx4 v8, s[12:15], s31 offen lds
    v_mfma_f32_16x16x32_bf16 v[156:159], v[36:39], v[76:79], v[156:159]
    v_mfma_f32_16x16x32_bf16 v[160:163], v[36:39], v[80:83], v[160:163]
    v_mfma_f32_16x16x32_bf16 v[164:167], v[36:39], v[84:87], v[164:167]
    v_mfma_f32_16x16x32_bf16 v[168:171], v[36:39], v[88:91], v[168:171]
    ds_read_b128 v[72:75], v14 offset:3072
    ds_read_b64_tr_b16 v[20:21], v18 offset:0
    ds_read_b64_tr_b16 v[22:23], v18 offset:2304
    s_add_u32 m0, s29, 0xa800
    s_add_u32 s33, s31, 0x24000
    buffer_load_dwordx4 v8, s[12:15], s33 offen lds
    s_add_u32 s31, s31, 64
    v_mfma_f32_16x16x32_bf16 v[172:175], v[40:43], v[76:79], v[172:175]
    v_mfma_f32_16x16x32_bf16 v[176:179], v[40:43], v[80:83], v[176:179]
    v_mfma_f32_16x16x32_bf16 v[180:183], v[40:43], v[84:87], v[180:183]
    v_mfma_f32_16x16x32_bf16 v[184:187], v[40:43], v[88:91], v[184:187]
    ds_read_b64_tr_b16 v[24:25], v18 offset:9216
    ds_read_b64_tr_b16 v[26:27], v18 offset:11520
    ds_read_b64_tr_b16 v[28:29], v18 offset:32
    ds_read_b64_tr_b16 v[30:31], v18 offset:2336
    s_add_u32 m0, s29, 0xc800
    s_nop 0
    buffer_load_dwordx4 v9, s[16:19], s32 offen lds
    v_mfma_f32_16x16x32_bf16 v[188:191], v[44:47], v[76:79], v[188:191]
    v_mfma_f32_16x16x32_bf16 v[192:195], v[44:47], v[80:83], v[192:195]
    v_mfma_f32_16x16x32_bf16 v[196:199], v[44:47], v[84:87], v[196:199]
    v_mfma_f32_16x16x32_bf16 v[200:203], v[44:47], v[88:91], v[200:203]
    ds_read_b64_tr_b16 v[32:33], v18 offset:9248
    ds_read_b64_tr_b16 v[34:35], v18 offset:11552
    ds_read_b64_tr_b16 v[36:37], v18 offset:64
    ds_read_b64_tr_b16 v[38:39], v18 offset:2368
    s_add_u32 m0, s29, 0xec00
    s_nop 0
    buffer_load_dwordx4 v9, s[20:23], s32 offen lds
    v_mfma_f32_16x16x32_bf16 v[204:207], v[48:51], v[76:79], v[204:207]
    v_mfma_f32_16x16x32_bf16 v[208:211], v[48:51], v[80:83], v[208:211]
    v_mfma_f32_16x16x32_bf16 v[212:215], v[48:51], v[84:87], v[212:215]
    v_mfma_f32_16x16x32_bf16 v[216:219], v[48:51], v[88:91], v[216:219]
    ds_read_b64_tr_b16 v[40:41], v18 offset:9280
    s_waitcnt lgkmcnt(13)
    ds_read_b64_tr_b16 v[42:43], v18 offset:11584
    s_add_u32 m0, s30, 0xe800
    s_mov_b64 exec, 0xffff
    buffer_load_dwordx4 v10, s[40:43], s32 offen lds
    s_mov_b64 exec, -1
    s_add_u32 s32, s32, 0x48000
    v_mfma_f32_16x16x32_bf16 v[220:223], v[52:55], v[76:79], v[220:223]
    v_mfma_f32_16x16x32_bf16 v[224:227], v[52:55], v[80:83], v[224:227]
    v_mfma_f32_16x16x32_bf16 v[228:231], v[52:55], v[84:87], v[228:231]
    v_mfma_f32_16x16x32_bf16 v[232:235], v[52:55], v[88:91], v[232:235]
    ds_read_b64_tr_b16 v[44:45], v18 offset:96
    s_waitcnt lgkmcnt(13)
    ds_read_b64_tr_b16 v[46:47], v18 offset:2400
    v_mfma_f32_16x16x32_bf16 v[236:239], v[56:59], v[76:79], v[236:239]
    v_mfma_f32_16x16x32_bf16 v[240:243], v[56:59], v[80:83], v[240:243]
    v_mfma_f32_16x16x32_bf16 v[244:247], v[56:59], v[84:87], v[244:247]
    v_mfma_f32_16x16x32_bf16 v[248:251], v[56:59], v[88:91], v[248:251]
    ds_read_b64_tr_b16 v[48:49], v18 offset:9312
    s_waitcnt lgkmcnt(13)
    ds_read_b64_tr_b16 v[50:51], v18 offset:11616
    v_mfma_f32_16x16x32_bf16 v[92:95], v[20:23], v[60:63], v[92:95]
    v_mfma_f32_16x16x32_bf16 v[96:99], v[20:23], v[64:67], v[96:99]
    v_mfma_f32_16x16x32_bf16 v[100:103], v[20:23], v[68:71], v[100:103]
    v_mfma_f32_16x16x32_bf16 v[104:107], v[20:23], v[72:75], v[104:107]
    ds_read_b64_tr_b16 v[52:53], v18 offset:128
    s_waitcnt lgkmcnt(13)
    ds_read_b64_tr_b16 v[54:55], v18 offset:2432
    v_mfma_f32_16x16x32_bf16 v[108:111], v[24:27], v[60:63], v[108:111]
    v_mfma_f32_16x16x32_bf16 v[112:115], v[24:27], v[64:67], v[112:115]
    v_mfma_f32_16x16x32_bf16 v[116:119], v[24:27], v[68:71], v[116:119]
    v_mfma_f32_16x16x32_bf16 v[120:123], v[24:27], v[72:75], v[120:123]
    ds_read_b64_tr_b16 v[56:57], v18 offset:9344
    s_waitcnt lgkmcnt(13)
    ds_read_b64_tr_b16 v[58:59], v18 offset:11648
    v_mfma_f32_16x16x32_bf16 v[124:127], v[28:31], v[60:63], v[124:127]
    v_mfma_f32_16x16x32_bf16 v[128:131], v[28:31], v[64:67], v[128:131]
    v_mfma_f32_16x16x32_bf16 v[132:135], v[28:31], v[68:71], v[132:135]
    v_mfma_f32_16x16x32_bf16 v[136:139], v[28:31], v[72:75], v[136:139]
    s_waitcnt lgkmcnt(12)
    v_mfma_f32_16x16x32_bf16 v[140:143], v[32:35], v[60:63], v[140:143]
    v_mfma_f32_16x16x32_bf16 v[144:147], v[32:35], v[64:67], v[144:147]
    v_mfma_f32_16x16x32_bf16 v[148:151], v[32:35], v[68:71], v[148:151]
    v_mfma_f32_16x16x32_bf16 v[152:155], v[32:35], v[72:75], v[152:155]
    s_waitcnt vmcnt(5) lgkmcnt(0)
    s_barrier
    ds_read_b128 v[76:79], v12 offset:0
    ds_read_b128 v[80:83], v12 offset:1024
    ds_read_b128 v[84:87], v12 offset:2048
    s_add_u32 m0, s29, 0x11000
    s_nop 0
    buffer_load_dwordx4 v8, s[12:15], s31 offen lds
    v_mfma_f32_16x16x32_bf16 v[156:159], v[36:39], v[60:63], v[156:159]
    v_mfma_f32_16x16x32_bf16 v[160:163], v[36:39], v[64:67], v[160:163]
    v_mfma_f32_16x16x32_bf16 v[164:167], v[36:39], v[68:71], v[164:167]
    v_mfma_f32_16x16x32_bf16 v[168:171], v[36:39], v[72:75], v[168:171]
    ds_read_b128 v[88:91], v12 offset:3072
    ds_read_b64_tr_b16 v[20:21], v16 offset:0
    ds_read_b64_tr_b16 v[22:23], v16 offset:2304
    s_add_u32 m0, s29, 0x13000
    s_add_u32 s33, s31, 0x24000
    buffer_load_dwordx4 v8, s[12:15], s33 offen lds
    s_add_u32 s31, s31, 64
    v_mfma_f32_16x16x32_bf16 v[172:175], v[40:43], v[60:63], v[172:175]
    v_mfma_f32_16x16x32_bf16 v[176:179], v[40:43], v[64:67], v[176:179]
    v_mfma_f32_16x16x32_bf16 v[180:183], v[40:43], v[68:71], v[180:183]
    v_mfma_f32_16x16x32_bf16 v[184:187], v[40:43], v[72:75], v[184:187]
    ds_read_b64_tr_b16 v[24:25], v16 offset:9216
    ds_read_b64_tr_b16 v[26:27], v16 offset:11520
    ds_read_b64_tr_b16 v[28:29], v16 offset:32
    ds_read_b64_tr_b16 v[30:31], v16 offset:2336
    s_add_u32 m0, s29, 0x15000
    s_nop 0
    buffer_load_dwordx4 v9, s[16:19], s32 offen lds
    v_mfma_f32_16x16x32_bf16 v[188:191], v[44:47], v[60:63], v[188:191]
    v_mfma_f32_16x16x32_bf16 v[192:195], v[44:47], v[64:67], v[192:195]
    v_mfma_f32_16x16x32_bf16 v[196:199], v[44:47], v[68:71], v[196:199]
    v_mfma_f32_16x16x32_bf16 v[200:203], v[44:47], v[72:75], v[200:203]
    ds_read_b64_tr_b16 v[32:33], v16 offset:9248
    ds_read_b64_tr_b16 v[34:35], v16 offset:11552
    ds_read_b64_tr_b16 v[36:37], v16 offset:64
    ds_read_b64_tr_b16 v[38:39], v16 offset:2368
    s_add_u32 m0, s29, 0x17400
    s_nop 0
    buffer_load_dwordx4 v9, s[20:23], s32 offen lds
    v_mfma_f32_16x16x32_bf16 v[204:207], v[48:51], v[60:63], v[204:207]
    v_mfma_f32_16x16x32_bf16 v[208:211], v[48:51], v[64:67], v[208:211]
    v_mfma_f32_16x16x32_bf16 v[212:215], v[48:51], v[68:71], v[212:215]
    v_mfma_f32_16x16x32_bf16 v[216:219], v[48:51], v[72:75], v[216:219]
    ds_read_b64_tr_b16 v[40:41], v16 offset:9280
    s_waitcnt lgkmcnt(13)
    ds_read_b64_tr_b16 v[42:43], v16 offset:11584
    s_add_u32 m0, s30, 0x17000
    s_mov_b64 exec, 0xffff
    buffer_load_dwordx4 v10, s[40:43], s32 offen lds
    s_mov_b64 exec, -1
    s_add_u32 s32, s32, 0x48000
    v_mfma_f32_16x16x32_bf16 v[220:223], v[52:55], v[60:63], v[220:223]
    v_mfma_f32_16x16x32_bf16 v[224:227], v[52:55], v[64:67], v[224:227]
    v_mfma_f32_16x16x32_bf16 v[228:231], v[52:55], v[68:71], v[228:231]
    v_mfma_f32_16x16x32_bf16 v[232:235], v[52:55], v[72:75], v[232:235]
    ds_read_b64_tr_b16 v[44:45], v16 offset:96
    s_waitcnt lgkmcnt(13)
    ds_read_b64_tr_b16 v[46:47], v16 offset:2400
    v_mfma_f32_16x16x32_bf16 v[236:239], v[56:59], v[60:63], v[236:239]
    v_mfma_f32_16x16x32_bf16 v[240:243], v[56:59], v[64:67], v[240:243]
    v_mfma_f32_16x16x32_bf16 v[244:247], v[56:59], v[68:71], v[244:247]
    v_mfma_f32_16x16x32_bf16 v[248:251], v[56:59], v[72:75], v[248:251]
    ds_read_b64_tr_b16 v[48:49], v16 offset:9312
    s_waitcnt lgkmcnt(13)
    ds_read_b64_tr_b16 v[50:51], v16 offset:11616
    v_mfma_f32_16x16x32_bf16 v[92:95], v[20:23], v[76:79], v[92:95]
    v_mfma_f32_16x16x32_bf16 v[96:99], v[20:23], v[80:83], v[96:99]
    v_mfma_f32_16x16x32_bf16 v[100:103], v[20:23], v[84:87], v[100:103]
    v_mfma_f32_16x16x32_bf16 v[104:107], v[20:23], v[88:91], v[104:107]
    ds_read_b64_tr_b16 v[52:53], v16 offset:128
    s_waitcnt lgkmcnt(13)
    ds_read_b64_tr_b16 v[54:55], v16 offset:2432
    v_mfma_f32_16x16x32_bf16 v[108:111], v[24:27], v[76:79], v[108:111]
    v_mfma_f32_16x16x32_bf16 v[112:115], v[24:27], v[80:83], v[112:115]
    v_mfma_f32_16x16x32_bf16 v[116:119], v[24:27], v[84:87], v[116:119]
    v_mfma_f32_16x16x32_bf16 v[120:123], v[24:27], v[88:91], v[120:123]
    ds_read_b64_tr_b16 v[56:57], v16 offset:9344
    s_waitcnt lgkmcnt(13)
    ds_read_b64_tr_b16 v[58:59], v16 offset:11648
    v_mfma_f32_16x16x32_bf16 v[124:127], v[28:31], v[76:79], v[124:127]
    v_mfma_f32_16x16x32_bf16 v[128:131], v[28:31], v[80:83], v[128:131]
    v_mfma_f32_16x16x32_bf16 v[132:135], v[28:31], v[84:87], v[132:135]
    v_mfma_f32_16x16x32_bf16 v[136:139], v[28:31], v[88:91], v[136:139]
    s_waitcnt lgkmcnt(12)
    v_mfma_f32_16x16x32_bf16 v[140:143], v[32:35], v[76:79], v[140:143]
    v_mfma_f32_16x16x32_bf16 v[144:147], v[32:35], v[80:83], v[144:147]
    v_mfma_f32_16x16x32_bf16 v[148:151], v[32:35], v[84:87], v[148:151]
    v_mfma_f32_16x16x32_bf16 v[152:155], v[32:35], v[88:91], v[152:155]
    s_waitcnt vmcnt(5) lgkmcnt(0)
    s_barrier
    ds_read_b128 v[60:63], v13 offset:0
    ds_read_b128 v[64:67], v13 offset:1024
    ds_read_b128 v[68:71], v13 offset:2048
    v_mfma_f32_16x16x32_bf16 v[156:159], v[36:39], v[76:79], v[156:159]
    v_mfma_f32_16x16x32_bf16 v[160:163], v[36:39], v[80:83], v[160:163]
    v_mfma_f32_16x16x32_bf16 v[164:167], v[36:39], v[84:87], v[164:167]
    v_mfma_f32_16x16x32_bf16 v[168:171], v[36:39], v[88:91], v[168:171]
    ds_read_b128 v[72:75], v13 offset:3072
    ds_read_b64_tr_b16 v[20:21], v17 offset:0
    ds_read_b64_tr_b16 v[22:23], v17 offset:2304
    v_mfma_f32_16x16x32_bf16 v[172:175], v[40:43], v[76:79], v[172:175]
    v_mfma_f32_16x16x32_bf16 v[176:179], v[40:43], v[80:83], v[176:179]
    v_mfma_f32_16x16x32_bf16 v[180:183], v[40:43], v[84:87], v[180:183]
    v_mfma_f32_16x16x32_bf16 v[184:187], v[40:43], v[88:91], v[184:187]
    ds_read_b64_tr_b16 v[24:25], v17 offset:9216
    ds_read_b64_tr_b16 v[26:27], v17 offset:11520
    ds_read_b64_tr_b16 v[28:29], v17 offset:32
    ds_read_b64_tr_b16 v[30:31], v17 offset:2336
    v_mfma_f32_16x16x32_bf16 v[188:191], v[44:47], v[76:79], v[188:191]
    v_mfma_f32_16x16x32_bf16 v[192:195], v[44:47], v[80:83], v[192:195]
    v_mfma_f32_16x16x32_bf16 v[196:199], v[44:47], v[84:87], v[196:199]
    v_mfma_f32_16x16x32_bf16 v[200:203], v[44:47], v[88:91], v[200:203]
    ds_read_b64_tr_b16 v[32:33], v17 offset:9248
    ds_read_b64_tr_b16 v[34:35], v17 offset:11552
    ds_read_b64_tr_b16 v[36:37], v17 offset:64
    ds_read_b64_tr_b16 v[38:39], v17 offset:2368
    v_mfma_f32_16x16x32_bf16 v[204:207], v[48:51], v[76:79], v[204:207]
    v_mfma_f32_16x16x32_bf16 v[208:211], v[48:51], v[80:83], v[208:211]
    v_mfma_f32_16x16x32_bf16 v[212:215], v[48:51], v[84:87], v[212:215]
    v_mfma_f32_16x16x32_bf16 v[216:219], v[48:51], v[88:91], v[216:219]
    ds_read_b64_tr_b16 v[40:41], v17 offset:9280
    s_waitcnt lgkmcnt(13)
    ds_read_b64_tr_b16 v[42:43], v17 offset:11584
    v_mfma_f32_16x16x32_bf16 v[220:223], v[52:55], v[76:79], v[220:223]
    v_mfma_f32_16x16x32_bf16 v[224:227], v[52:55], v[80:83], v[224:227]
    v_mfma_f32_16x16x32_bf16 v[228:231], v[52:55], v[84:87], v[228:231]
    v_mfma_f32_16x16x32_bf16 v[232:235], v[52:55], v[88:91], v[232:235]
    ds_read_b64_tr_b16 v[44:45], v17 offset:96
    s_waitcnt lgkmcnt(13)
    ds_read_b64_tr_b16 v[46:47], v17 offset:2400
    v_mfma_f32_16x16x32_bf16 v[236:239], v[56:59], v[76:79], v[236:239]
    v_mfma_f32_16x16x32_bf16 v[240:243], v[56:59], v[80:83], v[240:243]
    v_mfma_f32_16x16x32_bf16 v[244:247], v[56:59], v[84:87], v[244:247]
    v_mfma_f32_16x16x32_bf16 v[248:251], v[56:59], v[88:91], v[248:251]
    ds_read_b64_tr_b16 v[48:49], v17 offset:9312
    s_waitcnt lgkmcnt(13)
    ds_read_b64_tr_b16 v[50:51], v17 offset:11616
    v_mfma_f32_16x16x32_bf16 v[92:95], v[20:23], v[60:63], v[92:95]
    v_mfma_f32_16x16x32_bf16 v[96:99], v[20:23], v[64:67], v[96:99]
    v_mfma_f32_16x16x32_bf16 v[100:103], v[20:23], v[68:71], v[100:103]
    v_mfma_f32_16x16x32_bf16 v[104:107], v[20:23], v[72:75], v[104:107]
    ds_read_b64_tr_b16 v[52:53], v17 offset:128
    s_waitcnt lgkmcnt(13)
    ds_read_b64_tr_b16 v[54:55], v17 offset:2432
    v_mfma_f32_16x16x32_bf16 v[108:111], v[24:27], v[60:63], v[108:111]
    v_mfma_f32_16x16x32_bf16 v[112:115], v[24:27], v[64:67], v[112:115]
    v_mfma_f32_16x16x32_bf16 v[116:119], v[24:27], v[68:71], v[116:119]
    v_mfma_f32_16x16x32_bf16 v[120:123], v[24:27], v[72:75], v[120:123]
    ds_read_b64_tr_b16 v[56:57], v17 offset:9344
    s_waitcnt lgkmcnt(13)
    ds_read_b64_tr_b16 v[58:59], v17 offset:11648
    v_mfma_f32_16x16x32_bf16 v[124:127], v[28:31], v[60:63], v[124:127]
    v_mfma_f32_16x16x32_bf16 v[128:131], v[28:31], v[64:67], v[128:131]
    v_mfma_f32_16x16x32_bf16 v[132:135], v[28:31], v[68:71], v[132:135]
    v_mfma_f32_16x16x32_bf16 v[136:139], v[28:31], v[72:75], v[136:139]
    s_waitcnt lgkmcnt(12)
    v_mfma_f32_16x16x32_bf16 v[140:143], v[32:35], v[60:63], v[140:143]
    v_mfma_f32_16x16x32_bf16 v[144:147], v[32:35], v[64:67], v[144:147]
    v_mfma_f32_16x16x32_bf16 v[148:151], v[32:35], v[68:71], v[148:151]
    v_mfma_f32_16x16x32_bf16 v[152:155], v[32:35], v[72:75], v[152:155]
    s_waitcnt vmcnt(0) lgkmcnt(0)
    s_barrier
    ds_read_b128 v[76:79], v14 offset:0
    ds_read_b128 v[80:83], v14 offset:1024
    ds_read_b128 v[84:87], v14 offset:2048
    v_mfma_f32_16x16x32_bf16 v[156:159], v[36:39], v[60:63], v[156:159]
    v_mfma_f32_16x16x32_bf16 v[160:163], v[36:39], v[64:67], v[160:163]
    v_mfma_f32_16x16x32_bf16 v[164:167], v[36:39], v[68:71], v[164:167]
    v_mfma_f32_16x16x32_bf16 v[168:171], v[36:39], v[72:75], v[168:171]
    ds_read_b128 v[88:91], v14 offset:3072
    ds_read_b64_tr_b16 v[20:21], v18 offset:0
    ds_read_b64_tr_b16 v[22:23], v18 offset:2304
    v_mfma_f32_16x16x32_bf16 v[172:175], v[40:43], v[60:63], v[172:175]
    v_mfma_f32_16x16x32_bf16 v[176:179], v[40:43], v[64:67], v[176:179]
    v_mfma_f32_16x16x32_bf16 v[180:183], v[40:43], v[68:71], v[180:183]
    v_mfma_f32_16x16x32_bf16 v[184:187], v[40:43], v[72:75], v[184:187]
    ds_read_b64_tr_b16 v[24:25], v18 offset:9216
    ds_read_b64_tr_b16 v[26:27], v18 offset:11520
    ds_read_b64_tr_b16 v[28:29], v18 offset:32
    ds_read_b64_tr_b16 v[30:31], v18 offset:2336
    v_mfma_f32_16x16x32_bf16 v[188:191], v[44:47], v[60:63], v[188:191]
    v_mfma_f32_16x16x32_bf16 v[192:195], v[44:47], v[64:67], v[192:195]
    v_mfma_f32_16x16x32_bf16 v[196:199], v[44:47], v[68:71], v[196:199]
    v_mfma_f32_16x16x32_bf16 v[200:203], v[44:47], v[72:75], v[200:203]
    ds_read_b64_tr_b16 v[32:33], v18 offset:9248
    ds_read_b64_tr_b16 v[34:35], v18 offset:11552
    ds_read_b64_tr_b16 v[36:37], v18 offset:64
    ds_read_b64_tr_b16 v[38:39], v18 offset:2368
    v_mfma_f32_16x16x32_bf16 v[204:207], v[48:51], v[60:63], v[204:207]
    v_mfma_f32_16x16x32_bf16 v[208:211], v[48:51], v[64:67], v[208:211]
    v_mfma_f32_16x16x32_bf16 v[212:215], v[48:51], v[68:71], v[212:215]
    v_mfma_f32_16x16x32_bf16 v[216:219], v[48:51], v[72:75], v[216:219]
    ds_read_b64_tr_b16 v[40:41], v18 offset:9280
    s_waitcnt lgkmcnt(13)
    ds_read_b64_tr_b16 v[42:43], v18 offset:11584
    v_mfma_f32_16x16x32_bf16 v[220:223], v[52:55], v[60:63], v[220:223]
    v_mfma_f32_16x16x32_bf16 v[224:227], v[52:55], v[64:67], v[224:227]
    v_mfma_f32_16x16x32_bf16 v[228:231], v[52:55], v[68:71], v[228:231]
    v_mfma_f32_16x16x32_bf16 v[232:235], v[52:55], v[72:75], v[232:235]
    ds_read_b64_tr_b16 v[44:45], v18 offset:96
    s_waitcnt lgkmcnt(13)
    ds_read_b64_tr_b16 v[46:47], v18 offset:2400
    v_mfma_f32_16x16x32_bf16 v[236:239], v[56:59], v[60:63], v[236:239]
    v_mfma_f32_16x16x32_bf16 v[240:243], v[56:59], v[64:67], v[240:243]
    v_mfma_f32_16x16x32_bf16 v[244:247], v[56:59], v[68:71], v[244:247]
    v_mfma_f32_16x16x32_bf16 v[248:251], v[56:59], v[72:75], v[248:251]
    ds_read_b64_tr_b16 v[48:49], v18 offset:9312
    s_waitcnt lgkmcnt(13)
    ds_read_b64_tr_b16 v[50:51], v18 offset:11616
    v_mfma_f32_16x16x32_bf16 v[92:95], v[20:23], v[76:79], v[92:95]
    v_mfma_f32_16x16x32_bf16 v[96:99], v[20:23], v[80:83], v[96:99]
    v_mfma_f32_16x16x32_bf16 v[100:103], v[20:23], v[84:87], v[100:103]
    v_mfma_f32_16x16x32_bf16 v[104:107], v[20:23], v[88:91], v[104:107]
    ds_read_b64_tr_b16 v[52:53], v18 offset:128
    s_waitcnt lgkmcnt(13)
    ds_read_b64_tr_b16 v[54:55], v18 offset:2432
    v_mfma_f32_16x16x32_bf16 v[108:111], v[24:27], v[76:79], v[108:111]
    v_mfma_f32_16x16x32_bf16 v[112:115], v[24:27], v[80:83], v[112:115]
    v_mfma_f32_16x16x32_bf16 v[116:119], v[24:27], v[84:87], v[116:119]
    v_mfma_f32_16x16x32_bf16 v[120:123], v[24:27], v[88:91], v[120:123]
    ds_read_b64_tr_b16 v[56:57], v18 offset:9344
    s_waitcnt lgkmcnt(13)
    ds_read_b64_tr_b16 v[58:59], v18 offset:11648
    v_mfma_f32_16x16x32_bf16 v[124:127], v[28:31], v[76:79], v[124:127]
    v_mfma_f32_16x16x32_bf16 v[128:131], v[28:31], v[80:83], v[128:131]
    v_mfma_f32_16x16x32_bf16 v[132:135], v[28:31], v[84:87], v[132:135]
    v_mfma_f32_16x16x32_bf16 v[136:139], v[28:31], v[88:91], v[136:139]
    s_waitcnt lgkmcnt(12)
    v_mfma_f32_16x16x32_bf16 v[140:143], v[32:35], v[76:79], v[140:143]
    v_mfma_f32_16x16x32_bf16 v[144:147], v[32:35], v[80:83], v[144:147]
    v_mfma_f32_16x16x32_bf16 v[148:151], v[32:35], v[84:87], v[148:151]
    v_mfma_f32_16x16x32_bf16 v[152:155], v[32:35], v[88:91], v[152:155]
    s_waitcnt lgkmcnt(10)
    v_mfma_f32_16x16x32_bf16 v[156:159], v[36:39], v[76:79], v[156:159]
    v_mfma_f32_16x16x32_bf16 v[160:163], v[36:39], v[80:83], v[160:163]
    v_mfma_f32_16x16x32_bf16 v[164:167], v[36:39], v[84:87], v[164:167]
    v_mfma_f32_16x16x32_bf16 v[168:171], v[36:39], v[88:91], v[168:171]
    s_waitcnt lgkmcnt(8)
    v_mfma_f32_16x16x32_bf16 v[172:175], v[40:43], v[76:79], v[172:175]
    v_mfma_f32_16x16x32_bf16 v[176:179], v[40:43], v[80:83], v[176:179]
    v_mfma_f32_16x16x32_bf16 v[180:183], v[40:43], v[84:87], v[180:183]
    v_mfma_f32_16x16x32_bf16 v[184:187], v[40:43], v[88:91], v[184:187]
    s_waitcnt lgkmcnt(6)
    v_mfma_f32_16x16x32_bf16 v[188:191], v[44:47], v[76:79], v[188:191]
    v_mfma_f32_16x16x32_bf16 v[192:195], v[44:47], v[80:83], v[192:195]
    v_mfma_f32_16x16x32_bf16 v[196:199], v[44:47], v[84:87], v[196:199]
    v_mfma_f32_16x16x32_bf16 v[200:203], v[44:47], v[88:91], v[200:203]
    s_waitcnt lgkmcnt(4)
    v_mfma_f32_16x16x32_bf16 v[204:207], v[48:51], v[76:79], v[204:207]
    v_mfma_f32_16x16x32_bf16 v[208:211], v[48:51], v[80:83], v[208:211]
    v_mfma_f32_16x16x32_bf16 v[212:215], v[48:51], v[84:87], v[212:215]
    v_mfma_f32_16x16x32_bf16 v[216:219], v[48:51], v[88:91], v[216:219]
    s_waitcnt lgkmcnt(2)
    v_mfma_f32_16x16x32_bf16 v[220:223], v[52:55], v[76:79], v[220:223]
    v_mfma_f32_16x16x32_bf16 v[224:227], v[52:55], v[80:83], v[224:227]
    v_mfma_f32_16x16x32_bf16 v[228:231], v[52:55], v[84:87], v[228:231]
    v_mfma_f32_16x16x32_bf16 v[232:235], v[52:55], v[88:91], v[232:235]
    s_waitcnt lgkmcnt(0)
    v_mfma_f32_16x16x32_bf16 v[236:239], v[56:59], v[76:79], v[236:239]
    v_mfma_f32_16x16x32_bf16 v[240:243], v[56:59], v[80:83], v[240:243]
    v_mfma_f32_16x16x32_bf16 v[244:247], v[56:59], v[84:87], v[244:247]
    v_mfma_f32_16x16x32_bf16 v[248:251], v[56:59], v[88:91], v[248:251]
    s_nop 7
    s_nop 3
    v_mul_f32 v92, s46, v92
    v_mul_f32 v93, s46, v93
    v_mul_f32 v94, s46, v94
    v_mul_f32 v95, s46, v95
    v_exp_f32 v92, v92
    v_exp_f32 v93, v93
    v_exp_f32 v94, v94
    v_exp_f32 v95, v95
    v_add_f32 v92, 1.0, v92
    v_add_f32 v93, 1.0, v93
    v_add_f32 v94, 1.0, v94
    v_add_f32 v95, 1.0, v95
    v_rcp_f32 v92, v92
    v_rcp_f32 v93, v93
    v_rcp_f32 v94, v94
    v_rcp_f32 v95, v95
    v_mul_f32 v92, v92, v108
    v_mul_f32 v93, v93, v109
    v_mul_f32 v94, v94, v110
    v_mul_f32 v95, v95, v111
    v_cvt_pk_bf16_f32 v20, v92, v93
    v_cvt_pk_bf16_f32 v21, v94, v95
    v_mul_f32 v96, s46, v96
    v_mul_f32 v97, s46, v97
    v_mul_f32 v98, s46, v98
    v_mul_f32 v99, s46, v99
    v_exp_f32 v96, v96
    v_exp_f32 v97, v97
    v_exp_f32 v98, v98
    v_exp_f32 v99, v99
    v_add_f32 v96, 1.0, v96
    v_add_f32 v97, 1.0, v97
    v_add_f32 v98, 1.0, v98
    v_add_f32 v99, 1.0, v99
    v_rcp_f32 v96, v96
    v_rcp_f32 v97, v97
    v_rcp_f32 v98, v98
    v_rcp_f32 v99, v99
    v_mul_f32 v96, v96, v112
    v_mul_f32 v97, v97, v113
    v_mul_f32 v98, v98, v114
    v_mul_f32 v99, v99, v115
    v_cvt_pk_bf16_f32 v22, v96, v97
    v_cvt_pk_bf16_f32 v23, v98, v99
    s_mov_b32 s33, 0
    s_nop 0
    v_permlane16_swap_b32 v20, v22
    v_permlane16_swap_b32 v21, v23
    s_nop 0
    buffer_store_dwordx4 v[20:23], v7, s[24:27], s33 offen offset:0 sc0 sc1
    v_mul_f32 v124, s46, v124
    v_mul_f32 v125, s46, v125
    v_mul_f32 v126, s46, v126
    v_mul_f32 v127, s46, v127
    v_exp_f32 v124, v124
    v_exp_f32 v125, v125
    v_exp_f32 v126, v126
    v_exp_f32 v127, v127
    v_add_f32 v124, 1.0, v124
    v_add_f32 v125, 1.0, v125
    v_add_f32 v126, 1.0, v126
    v_add_f32 v127, 1.0, v127
    v_rcp_f32 v124, v124
    v_rcp_f32 v125, v125
    v_rcp_f32 v126, v126
    v_rcp_f32 v127, v127
    v_mul_f32 v124, v124, v140
    v_mul_f32 v125, v125, v141
    v_mul_f32 v126, v126, v142
    v_mul_f32 v127, v127, v143
    v_cvt_pk_bf16_f32 v24, v124, v125
    v_cvt_pk_bf16_f32 v25, v126, v127
    v_mul_f32 v128, s46, v128
    v_mul_f32 v129, s46, v129
    v_mul_f32 v130, s46, v130
    v_mul_f32 v131, s46, v131
    v_exp_f32 v128, v128
    v_exp_f32 v129, v129
    v_exp_f32 v130, v130
    v_exp_f32 v131, v131
    v_add_f32 v128, 1.0, v128
    v_add_f32 v129, 1.0, v129
    v_add_f32 v130, 1.0, v130
    v_add_f32 v131, 1.0, v131
    v_rcp_f32 v128, v128
    v_rcp_f32 v129, v129
    v_rcp_f32 v130, v130
    v_rcp_f32 v131, v131
    v_mul_f32 v128, v128, v144
    v_mul_f32 v129, v129, v145
    v_mul_f32 v130, v130, v146
    v_mul_f32 v131, v131, v147
    v_cvt_pk_bf16_f32 v26, v128, v129
    v_cvt_pk_bf16_f32 v27, v130, v131
    s_nop 0
    s_nop 0
    v_permlane16_swap_b32 v24, v26
    v_permlane16_swap_b32 v25, v27
    s_nop 0
    buffer_store_dwordx4 v[24:27], v7, s[24:27], s33 offen offset:1024 sc0 sc1
    v_mul_f32 v156, s46, v156
    v_mul_f32 v157, s46, v157
    v_mul_f32 v158, s46, v158
    v_mul_f32 v159, s46, v159
    v_exp_f32 v156, v156
    v_exp_f32 v157, v157
    v_exp_f32 v158, v158
    v_exp_f32 v159, v159
    v_add_f32 v156, 1.0, v156
    v_add_f32 v157, 1.0, v157
    v_add_f32 v158, 1.0, v158
    v_add_f32 v159, 1.0, v159
    v_rcp_f32 v156, v156
    v_rcp_f32 v157, v157
    v_rcp_f32 v158, v158
    v_rcp_f32 v159, v159
    v_mul_f32 v156, v156, v172
    v_mul_f32 v157, v157, v173
    v_mul_f32 v158, v158, v174
    v_mul_f32 v159, v159, v175
    v_cvt_pk_bf16_f32 v28, v156, v157
    v_cvt_pk_bf16_f32 v29, v158, v159
    v_mul_f32 v160, s46, v160
    v_mul_f32 v161, s46, v161
    v_mul_f32 v162, s46, v162
    v_mul_f32 v163, s46, v163
    v_exp_f32 v160, v160
    v_exp_f32 v161, v161
    v_exp_f32 v162, v162
    v_exp_f32 v163, v163
    v_add_f32 v160, 1.0, v160
    v_add_f32 v161, 1.0, v161
    v_add_f32 v162, 1.0, v162
    v_add_f32 v163, 1.0, v163
    v_rcp_f32 v160, v160
    v_rcp_f32 v161, v161
    v_rcp_f32 v162, v162
    v_rcp_f32 v163, v163
    v_mul_f32 v160, v160, v176
    v_mul_f32 v161, v161, v177
    v_mul_f32 v162, v162, v178
    v_mul_f32 v163, v163, v179
    v_cvt_pk_bf16_f32 v30, v160, v161
    v_cvt_pk_bf16_f32 v31, v162, v163
    s_nop 0
    s_nop 0
    v_permlane16_swap_b32 v28, v30
    v_permlane16_swap_b32 v29, v31
    s_nop 0
    buffer_store_dwordx4 v[28:31], v7, s[24:27], s33 offen offset:2048 sc0 sc1
    v_mul_f32 v188, s46, v188
    v_mul_f32 v189, s46, v189
    v_mul_f32 v190, s46, v190
    v_mul_f32 v191, s46, v191
    v_exp_f32 v188, v188
    v_exp_f32 v189, v189
    v_exp_f32 v190, v190
    v_exp_f32 v191, v191
    v_add_f32 v188, 1.0, v188
    v_add_f32 v189, 1.0, v189
    v_add_f32 v190, 1.0, v190
    v_add_f32 v191, 1.0, v191
    v_rcp_f32 v188, v188
    v_rcp_f32 v189, v189
    v_rcp_f32 v190, v190
    v_rcp_f32 v191, v191
    v_mul_f32 v188, v188, v204
    v_mul_f32 v189, v189, v205
    v_mul_f32 v190, v190, v206
    v_mul_f32 v191, v191, v207
    v_cvt_pk_bf16_f32 v32, v188, v189
    v_cvt_pk_bf16_f32 v33, v190, v191
    v_mul_f32 v192, s46, v192
    v_mul_f32 v193, s46, v193
    v_mul_f32 v194, s46, v194
    v_mul_f32 v195, s46, v195
    v_exp_f32 v192, v192
    v_exp_f32 v193, v193
    v_exp_f32 v194, v194
    v_exp_f32 v195, v195
    v_add_f32 v192, 1.0, v192
    v_add_f32 v193, 1.0, v193
    v_add_f32 v194, 1.0, v194
    v_add_f32 v195, 1.0, v195
    v_rcp_f32 v192, v192
    v_rcp_f32 v193, v193
    v_rcp_f32 v194, v194
    v_rcp_f32 v195, v195
    v_mul_f32 v192, v192, v208
    v_mul_f32 v193, v193, v209
    v_mul_f32 v194, v194, v210
    v_mul_f32 v195, v195, v211
    v_cvt_pk_bf16_f32 v34, v192, v193
    v_cvt_pk_bf16_f32 v35, v194, v195
    s_nop 0
    s_nop 0
    v_permlane16_swap_b32 v32, v34
    v_permlane16_swap_b32 v33, v35
    s_nop 0
    buffer_store_dwordx4 v[32:35], v7, s[24:27], s33 offen offset:3072 sc0 sc1
    v_mul_f32 v220, s46, v220
    v_mul_f32 v221, s46, v221
    v_mul_f32 v222, s46, v222
    v_mul_f32 v223, s46, v223
    v_exp_f32 v220, v220
    v_exp_f32 v221, v221
    v_exp_f32 v222, v222
    v_exp_f32 v223, v223
    v_add_f32 v220, 1.0, v220
    v_add_f32 v221, 1.0, v221
    v_add_f32 v222, 1.0, v222
    v_add_f32 v223, 1.0, v223
    v_rcp_f32 v220, v220
    v_rcp_f32 v221, v221
    v_rcp_f32 v222, v222
    v_rcp_f32 v223, v223
    v_mul_f32 v220, v220, v236
    v_mul_f32 v221, v221, v237
    v_mul_f32 v222, v222, v238
    v_mul_f32 v223, v223, v239
    v_cvt_pk_bf16_f32 v20, v220, v221
    v_cvt_pk_bf16_f32 v21, v222, v223
    v_mul_f32 v224, s46, v224
    v_mul_f32 v225, s46, v225
    v_mul_f32 v226, s46, v226
    v_mul_f32 v227, s46, v227
    v_exp_f32 v224, v224
    v_exp_f32 v225, v225
    v_exp_f32 v226, v226
    v_exp_f32 v227, v227
    v_add_f32 v224, 1.0, v224
    v_add_f32 v225, 1.0, v225
    v_add_f32 v226, 1.0, v226
    v_add_f32 v227, 1.0, v227
    v_rcp_f32 v224, v224
    v_rcp_f32 v225, v225
    v_rcp_f32 v226, v226
    v_rcp_f32 v227, v227
    v_mul_f32 v224, v224, v240
    v_mul_f32 v225, v225, v241
    v_mul_f32 v226, v226, v242
    v_mul_f32 v227, v227, v243
    v_cvt_pk_bf16_f32 v22, v224, v225
    v_cvt_pk_bf16_f32 v23, v226, v227
    s_mov_b32 s33, 4096
    s_nop 0
    v_permlane16_swap_b32 v20, v22
    v_permlane16_swap_b32 v21, v23
    s_nop 0
    buffer_store_dwordx4 v[20:23], v7, s[24:27], s33 offen offset:0 sc0 sc1
    v_mul_f32 v100, s46, v100
    v_mul_f32 v101, s46, v101
    v_mul_f32 v102, s46, v102
    v_mul_f32 v103, s46, v103
    v_exp_f32 v100, v100
    v_exp_f32 v101, v101
    v_exp_f32 v102, v102
    v_exp_f32 v103, v103
    v_add_f32 v100, 1.0, v100
    v_add_f32 v101, 1.0, v101
    v_add_f32 v102, 1.0, v102
    v_add_f32 v103, 1.0, v103
    v_rcp_f32 v100, v100
    v_rcp_f32 v101, v101
    v_rcp_f32 v102, v102
    v_rcp_f32 v103, v103
    v_mul_f32 v100, v100, v116
    v_mul_f32 v101, v101, v117
    v_mul_f32 v102, v102, v118
    v_mul_f32 v103, v103, v119
    v_cvt_pk_bf16_f32 v24, v100, v101
    v_cvt_pk_bf16_f32 v25, v102, v103
    v_mul_f32 v104, s46, v104
    v_mul_f32 v105, s46, v105
    v_mul_f32 v106, s46, v106
    v_mul_f32 v107, s46, v107
    v_exp_f32 v104, v104
    v_exp_f32 v105, v105
    v_exp_f32 v106, v106
    v_exp_f32 v107, v107
    v_add_f32 v104, 1.0, v104
    v_add_f32 v105, 1.0, v105
    v_add_f32 v106, 1.0, v106
    v_add_f32 v107, 1.0, v107
    v_rcp_f32 v104, v104
    v_rcp_f32 v105, v105
    v_rcp_f32 v106, v106
    v_rcp_f32 v107, v107
    v_mul_f32 v104, v104, v120
    v_mul_f32 v105, v105, v121
    v_mul_f32 v106, v106, v122
    v_mul_f32 v107, v107, v123
    v_cvt_pk_bf16_f32 v26, v104, v105
    v_cvt_pk_bf16_f32 v27, v106, v107
    s_mov_b32 s33, 294912
    s_nop 0
    v_permlane16_swap_b32 v24, v26
    v_permlane16_swap_b32 v25, v27
    s_nop 0
    buffer_store_dwordx4 v[24:27], v7, s[24:27], s33 offen offset:0 sc0 sc1
    v_mul_f32 v132, s46, v132
    v_mul_f32 v133, s46, v133
    v_mul_f32 v134, s46, v134
    v_mul_f32 v135, s46, v135
    v_exp_f32 v132, v132
    v_exp_f32 v133, v133
    v_exp_f32 v134, v134
    v_exp_f32 v135, v135
    v_add_f32 v132, 1.0, v132
    v_add_f32 v133, 1.0, v133
    v_add_f32 v134, 1.0, v134
    v_add_f32 v135, 1.0, v135
    v_rcp_f32 v132, v132
    v_rcp_f32 v133, v133
    v_rcp_f32 v134, v134
    v_rcp_f32 v135, v135
    v_mul_f32 v132, v132, v148
    v_mul_f32 v133, v133, v149
    v_mul_f32 v134, v134, v150
    v_mul_f32 v135, v135, v151
    v_cvt_pk_bf16_f32 v28, v132, v133
    v_cvt_pk_bf16_f32 v29, v134, v135
    v_mul_f32 v136, s46, v136
    v_mul_f32 v137, s46, v137
    v_mul_f32 v138, s46, v138
    v_mul_f32 v139, s46, v139
    v_exp_f32 v136, v136
    v_exp_f32 v137, v137
    v_exp_f32 v138, v138
    v_exp_f32 v139, v139
    v_add_f32 v136, 1.0, v136
    v_add_f32 v137, 1.0, v137
    v_add_f32 v138, 1.0, v138
    v_add_f32 v139, 1.0, v139
    v_rcp_f32 v136, v136
    v_rcp_f32 v137, v137
    v_rcp_f32 v138, v138
    v_rcp_f32 v139, v139
    v_mul_f32 v136, v136, v152
    v_mul_f32 v137, v137, v153
    v_mul_f32 v138, v138, v154
    v_mul_f32 v139, v139, v155
    v_cvt_pk_bf16_f32 v30, v136, v137
    v_cvt_pk_bf16_f32 v31, v138, v139
    s_nop 0
    s_nop 0
    v_permlane16_swap_b32 v28, v30
    v_permlane16_swap_b32 v29, v31
    s_nop 0
    buffer_store_dwordx4 v[28:31], v7, s[24:27], s33 offen offset:1024 sc0 sc1
    v_mul_f32 v164, s46, v164
    v_mul_f32 v165, s46, v165
    v_mul_f32 v166, s46, v166
    v_mul_f32 v167, s46, v167
    v_exp_f32 v164, v164
    v_exp_f32 v165, v165
    v_exp_f32 v166, v166
    v_exp_f32 v167, v167
    v_add_f32 v164, 1.0, v164
    v_add_f32 v165, 1.0, v165
    v_add_f32 v166, 1.0, v166
    v_add_f32 v167, 1.0, v167
    v_rcp_f32 v164, v164
    v_rcp_f32 v165, v165
    v_rcp_f32 v166, v166
    v_rcp_f32 v167, v167
    v_mul_f32 v164, v164, v180
    v_mul_f32 v165, v165, v181
    v_mul_f32 v166, v166, v182
    v_mul_f32 v167, v167, v183
    v_cvt_pk_bf16_f32 v32, v164, v165
    v_cvt_pk_bf16_f32 v33, v166, v167
    v_mul_f32 v168, s46, v168
    v_mul_f32 v169, s46, v169
    v_mul_f32 v170, s46, v170
    v_mul_f32 v171, s46, v171
    v_exp_f32 v168, v168
    v_exp_f32 v169, v169
    v_exp_f32 v170, v170
    v_exp_f32 v171, v171
    v_add_f32 v168, 1.0, v168
    v_add_f32 v169, 1.0, v169
    v_add_f32 v170, 1.0, v170
    v_add_f32 v171, 1.0, v171
    v_rcp_f32 v168, v168
    v_rcp_f32 v169, v169
    v_rcp_f32 v170, v170
    v_rcp_f32 v171, v171
    v_mul_f32 v168, v168, v184
    v_mul_f32 v169, v169, v185
    v_mul_f32 v170, v170, v186
    v_mul_f32 v171, v171, v187
    v_cvt_pk_bf16_f32 v34, v168, v169
    v_cvt_pk_bf16_f32 v35, v170, v171
    s_nop 0
    s_nop 0
    v_permlane16_swap_b32 v32, v34
    v_permlane16_swap_b32 v33, v35
    s_nop 0
    buffer_store_dwordx4 v[32:35], v7, s[24:27], s33 offen offset:2048 sc0 sc1
    v_mul_f32 v196, s46, v196
    v_mul_f32 v197, s46, v197
    v_mul_f32 v198, s46, v198
    v_mul_f32 v199, s46, v199
    v_exp_f32 v196, v196
    v_exp_f32 v197, v197
    v_exp_f32 v198, v198
    v_exp_f32 v199, v199
    v_add_f32 v196, 1.0, v196
    v_add_f32 v197, 1.0, v197
    v_add_f32 v198, 1.0, v198
    v_add_f32 v199, 1.0, v199
    v_rcp_f32 v196, v196
    v_rcp_f32 v197, v197
    v_rcp_f32 v198, v198
    v_rcp_f32 v199, v199
    v_mul_f32 v196, v196, v212
    v_mul_f32 v197, v197, v213
    v_mul_f32 v198, v198, v214
    v_mul_f32 v199, v199, v215
    v_cvt_pk_bf16_f32 v20, v196, v197
    v_cvt_pk_bf16_f32 v21, v198, v199
    v_mul_f32 v200, s46, v200
    v_mul_f32 v201, s46, v201
    v_mul_f32 v202, s46, v202
    v_mul_f32 v203, s46, v203
    v_exp_f32 v200, v200
    v_exp_f32 v201, v201
    v_exp_f32 v202, v202
    v_exp_f32 v203, v203
    v_add_f32 v200, 1.0, v200
    v_add_f32 v201, 1.0, v201
    v_add_f32 v202, 1.0, v202
    v_add_f32 v203, 1.0, v203
    v_rcp_f32 v200, v200
    v_rcp_f32 v201, v201
    v_rcp_f32 v202, v202
    v_rcp_f32 v203, v203
    v_mul_f32 v200, v200, v216
    v_mul_f32 v201, v201, v217
    v_mul_f32 v202, v202, v218
    v_mul_f32 v203, v203, v219
    v_cvt_pk_bf16_f32 v22, v200, v201
    v_cvt_pk_bf16_f32 v23, v202, v203
    s_nop 0
    s_nop 0
    v_permlane16_swap_b32 v20, v22
    v_permlane16_swap_b32 v21, v23
    s_nop 0
    buffer_store_dwordx4 v[20:23], v7, s[24:27], s33 offen offset:3072 sc0 sc1
    v_mul_f32 v228, s46, v228
    v_mul_f32 v229, s46, v229
    v_mul_f32 v230, s46, v230
    v_mul_f32 v231, s46, v231
    v_exp_f32 v228, v228
    v_exp_f32 v229, v229
    v_exp_f32 v230, v230
    v_exp_f32 v231, v231
    v_add_f32 v228, 1.0, v228
    v_add_f32 v229, 1.0, v229
    v_add_f32 v230, 1.0, v230
    v_add_f32 v231, 1.0, v231
    v_rcp_f32 v228, v228
    v_rcp_f32 v229, v229
    v_rcp_f32 v230, v230
    v_rcp_f32 v231, v231
    v_mul_f32 v228, v228, v244
    v_mul_f32 v229, v229, v245
    v_mul_f32 v230, v230, v246
    v_mul_f32 v231, v231, v247
    v_cvt_pk_bf16_f32 v24, v228, v229
    v_cvt_pk_bf16_f32 v25, v230, v231
    v_mul_f32 v232, s46, v232
    v_mul_f32 v233, s46, v233
    v_mul_f32 v234, s46, v234
    v_mul_f32 v235, s46, v235
    v_exp_f32 v232, v232
    v_exp_f32 v233, v233
    v_exp_f32 v234, v234
    v_exp_f32 v235, v235
    v_add_f32 v232, 1.0, v232
    v_add_f32 v233, 1.0, v233
    v_add_f32 v234, 1.0, v234
    v_add_f32 v235, 1.0, v235
    v_rcp_f32 v232, v232
    v_rcp_f32 v233, v233
    v_rcp_f32 v234, v234
    v_rcp_f32 v235, v235
    v_mul_f32 v232, v232, v248
    v_mul_f32 v233, v233, v249
    v_mul_f32 v234, v234, v250
    v_mul_f32 v235, v235, v251
    v_cvt_pk_bf16_f32 v26, v232, v233
    v_cvt_pk_bf16_f32 v27, v234, v235
    s_mov_b32 s33, 299008
    s_nop 0
    v_permlane16_swap_b32 v24, v26
    v_permlane16_swap_b32 v25, v27
    s_nop 0
    buffer_store_dwordx4 v[24:27], v7, s[24:27], s33 offen offset:0 sc0 sc1
    s_branch LJ_rompt_kernel_52
LG_rompt_kernel_53:
    ds_read_b128 v[60:63], v12 offset:0
    ds_read_b128 v[64:67], v12 offset:1024
    ds_read_b128 v[68:71], v12 offset:2048
    ds_read_b128 v[72:75], v12 offset:3072
    ds_read_b64_tr_b16 v[20:21], v16 offset:160
    ds_read_b64_tr_b16 v[22:23], v16 offset:2464
    ds_read_b64_tr_b16 v[24:25], v16 offset:9376
    ds_read_b64_tr_b16 v[26:27], v16 offset:11680
    ds_read_b64_tr_b16 v[28:29], v16 offset:192
    ds_read_b64_tr_b16 v[30:31], v16 offset:2496
    ds_read_b64_tr_b16 v[32:33], v16 offset:9408
    ds_read_b64_tr_b16 v[34:35], v16 offset:11712
    ds_read_b64_tr_b16 v[36:37], v16 offset:224
    ds_read_b64_tr_b16 v[38:39], v16 offset:2528
    ds_read_b64_tr_b16 v[40:41], v16 offset:9440
    s_waitcnt lgkmcnt(13)
    ds_read_b64_tr_b16 v[42:43], v16 offset:11744
    s_waitcnt lgkmcnt(10)
    v_mfma_f32_16x16x32_bf16 v[92:95], v[20:23], v[60:63], 0
    v_mfma_f32_16x16x32_bf16 v[96:99], v[20:23], v[64:67], 0
    v_mfma_f32_16x16x32_bf16 v[100:103], v[20:23], v[68:71], 0
    v_mfma_f32_16x16x32_bf16 v[104:107], v[20:23], v[72:75], 0
    ds_read_b64_tr_b16 v[44:45], v16 offset:256
    ds_read_b64_tr_b16 v[46:47], v16 offset:2560
    s_waitcnt lgkmcnt(10)
    v_mfma_f32_16x16x32_bf16 v[108:111], v[24:27], v[60:63], 0
    v_mfma_f32_16x16x32_bf16 v[112:115], v[24:27], v[64:67], 0
    v_mfma_f32_16x16x32_bf16 v[116:119], v[24:27], v[68:71], 0
    v_mfma_f32_16x16x32_bf16 v[120:123], v[24:27], v[72:75], 0
    ds_read_b64_tr_b16 v[48:49], v16 offset:9472
    ds_read_b64_tr_b16 v[50:51], v16 offset:11776
    s_waitcnt lgkmcnt(10)
    v_mfma_f32_16x16x32_bf16 v[124:127], v[28:31], v[60:63], 0
    v_mfma_f32_16x16x32_bf16 v[128:131], v[28:31], v[64:67], 0
    v_mfma_f32_16x16x32_bf16 v[132:135], v[28:31], v[68:71], 0
    v_mfma_f32_16x16x32_bf16 v[136:139], v[28:31], v[72:75], 0
    s_waitcnt lgkmcnt(8)
    v_mfma_f32_16x16x32_bf16 v[140:143], v[32:35], v[60:63], 0
    v_mfma_f32_16x16x32_bf16 v[144:147], v[32:35], v[64:67], 0
    v_mfma_f32_16x16x32_bf16 v[148:151], v[32:35], v[68:71], 0
    v_mfma_f32_16x16x32_bf16 v[152:155], v[32:35], v[72:75], 0
    s_waitcnt vmcnt(2) lgkmcnt(0)
    s_barrier
    ds_read_b128 v[76:79], v13 offset:0
    ds_read_b128 v[80:83], v13 offset:1024
    ds_read_b128 v[84:87], v13 offset:2048
    s_add_u32 m0, s29, 0x0
    s_nop 0
    buffer_load_dwordx4 v8, s[12:15], s31 offen lds
    v_mfma_f32_16x16x32_bf16 v[156:159], v[36:39], v[60:63], 0
    v_mfma_f32_16x16x32_bf16 v[160:163], v[36:39], v[64:67], 0
    v_mfma_f32_16x16x32_bf16 v[164:167], v[36:39], v[68:71], 0
    v_mfma_f32_16x16x32_bf16 v[168:171], v[36:39], v[72:75], 0
    ds_read_b128 v[88:91], v13 offset:3072
    ds_read_b64_tr_b16 v[20:21], v17 offset:160
    ds_read_b64_tr_b16 v[22:23], v17 offset:2464
    s_add_u32 m0, s29, 0x2000
    s_add_u32 s33, s31, 0x24000
    buffer_load_dwordx4 v8, s[12:15], s33 offen lds
    s_add_u32 s31, s31, 64
    v_mfma_f32_16x16x32_bf16 v[172:175], v[40:43], v[60:63], 0
    v_mfma_f32_16x16x32_bf16 v[176:179], v[40:43], v[64:67], 0
    v_mfma_f32_16x16x32_bf16 v[180:183], v[40:43], v[68:71], 0
    v_mfma_f32_16x16x32_bf16 v[184:187], v[40:43], v[72:75], 0
    ds_read_b64_tr_b16 v[24:25], v17 offset:9376
    ds_read_b64_tr_b16 v[26:27], v17 offset:11680
    ds_read_b64_tr_b16 v[28:29], v17 offset:192
    ds_read_b64_tr_b16 v[30:31], v17 offset:2496
    s_add_u32 m0, s29, 0x4000
    s_nop 0
    buffer_load_dwordx4 v9, s[16:19], s32 offen lds
    v_mfma_f32_16x16x32_bf16 v[188:191], v[44:47], v[60:63], 0
    v_mfma_f32_16x16x32_bf16 v[192:195], v[44:47], v[64:67], 0
    v_mfma_f32_16x16x32_bf16 v[196:199], v[44:47], v[68:71], 0
    v_mfma_f32_16x16x32_bf16 v[200:203], v[44:47], v[72:75], 0
    ds_read_b64_tr_b16 v[32:33], v17 offset:9408
    ds_read_b64_tr_b16 v[34:35], v17 offset:11712
    ds_read_b64_tr_b16 v[36:37], v17 offset:224
    ds_read_b64_tr_b16 v[38:39], v17 offset:2528
    s_add_u32 m0, s29, 0x6400
    s_nop 0
    buffer_load_dwordx4 v9, s[20:23], s32 offen lds
    v_mfma_f32_16x16x32_bf16 v[204:207], v[48:51], v[60:63], 0
    v_mfma_f32_16x16x32_bf16 v[208:211], v[48:51], v[64:67], 0
    v_mfma_f32_16x16x32_bf16 v[212:215], v[48:51], v[68:71], 0
    v_mfma_f32_16x16x32_bf16 v[216:219], v[48:51], v[72:75], 0
    ds_read_b64_tr_b16 v[40:41], v17 offset:9440
    s_waitcnt lgkmcnt(13)
    ds_read_b64_tr_b16 v[42:43], v17 offset:11744
    s_add_u32 m0, s30, 0x6000
    s_mov_b64 exec, 0xffff
    buffer_load_dwordx4 v10, s[40:43], s32 offen lds
    s_mov_b64 exec, -1
    s_add_u32 s32, s32, 0x48000
    s_mov_b32 s39, 2
LP_rompt_kernel_55:
    s_waitcnt lgkmcnt(10)
    v_mfma_f32_16x16x32_bf16 v[92:95], v[20:23], v[76:79], v[92:95]
    v_mfma_f32_16x16x32_bf16 v[96:99], v[20:23], v[80:83], v[96:99]
    v_mfma_f32_16x16x32_bf16 v[100:103], v[20:23], v[84:87], v[100:103]
    v_mfma_f32_16x16x32_bf16 v[104:107], v[20:23], v[88:91], v[104:107]
    ds_read_b64_tr_b16 v[44:45], v17 offset:256
    ds_read_b64_tr_b16 v[46:47], v17 offset:2560
    s_waitcnt lgkmcnt(10)
    v_mfma_f32_16x16x32_bf16 v[108:111], v[24:27], v[76:79], v[108:111]
    v_mfma_f32_16x16x32_bf16 v[112:115], v[24:27], v[80:83], v[112:115]
    v_mfma_f32_16x16x32_bf16 v[116:119], v[24:27], v[84:87], v[116:119]
    v_mfma_f32_16x16x32_bf16 v[120:123], v[24:27], v[88:91], v[120:123]
    ds_read_b64_tr_b16 v[48:49], v17 offset:9472
    ds_read_b64_tr_b16 v[50:51], v17 offset:11776
    s_waitcnt lgkmcnt(10)
    v_mfma_f32_16x16x32_bf16 v[124:127], v[28:31], v[76:79], v[124:127]
    v_mfma_f32_16x16x32_bf16 v[128:131], v[28:31], v[80:83], v[128:131]
    v_mfma_f32_16x16x32_bf16 v[132:135], v[28:31], v[84:87], v[132:135]
    v_mfma_f32_16x16x32_bf16 v[136:139], v[28:31], v[88:91], v[136:139]
    s_waitcnt lgkmcnt(8)
    v_mfma_f32_16x16x32_bf16 v[140:143], v[32:35], v[76:79], v[140:143]
    v_mfma_f32_16x16x32_bf16 v[144:147], v[32:35], v[80:83], v[144:147]
    v_mfma_f32_16x16x32_bf16 v[148:151], v[32:35], v[84:87], v[148:151]
    v_mfma_f32_16x16x32_bf16 v[152:155], v[32:35], v[88:91], v[152:155]
    s_waitcnt vmcnt(5) lgkmcnt(0)
    s_barrier
    ds_read_b128 v[60:63], v14 offset:0
    ds_read_b128 v[64:67], v14 offset:1024
    ds_read_b128 v[68:71], v14 offset:2048
    s_add_u32 m0, s29, 0x8800
    s_nop 0
    buffer_load_dwordx4 v8, s[12:15], s31 offen lds
    v_mfma_f32_16x16x32_bf16 v[156:159], v[36:39], v[76:79], v[156:159]
    v_mfma_f32_16x16x32_bf16 v[160:163], v[36:39], v[80:83], v[160:163]
    v_mfma_f32_16x16x32_bf16 v[164:167], v[36:39], v[84:87], v[164:167]
    v_mfma_f32_16x16x32_bf16 v[168:171], v[36:39], v[88:91], v[168:171]
    ds_read_b128 v[72:75], v14 offset:3072
    ds_read_b64_tr_b16 v[20:21], v18 offset:160
    ds_read_b64_tr_b16 v[22:23], v18 offset:2464
    s_add_u32 m0, s29, 0xa800
    s_add_u32 s33, s31, 0x24000
    buffer_load_dwordx4 v8, s[12:15], s33 offen lds
    s_add_u32 s31, s31, 64
    v_mfma_f32_16x16x32_bf16 v[172:175], v[40:43], v[76:79], v[172:175]
    v_mfma_f32_16x16x32_bf16 v[176:179], v[40:43], v[80:83], v[176:179]
    v_mfma_f32_16x16x32_bf16 v[180:183], v[40:43], v[84:87], v[180:183]
    v_mfma_f32_16x16x32_bf16 v[184:187], v[40:43], v[88:91], v[184:187]
    ds_read_b64_tr_b16 v[24:25], v18 offset:9376
    ds_read_b64_tr_b16 v[26:27], v18 offset:11680
    ds_read_b64_tr_b16 v[28:29], v18 offset:192
    ds_read_b64_tr_b16 v[30:31], v18 offset:2496
    s_add_u32 m0, s29, 0xc800
    s_nop 0
    buffer_load_dwordx4 v9, s[16:19], s32 offen lds
    v_mfma_f32_16x16x32_bf16 v[188:191], v[44:47], v[76:79], v[188:191]
    v_mfma_f32_16x16x32_bf16 v[192:195], v[44:47], v[80:83], v[192:195]
    v_mfma_f32_16x16x32_bf16 v[196:199], v[44:47], v[84:87], v[196:199]
    v_mfma_f32_16x16x32_bf16 v[200:203], v[44:47], v[88:91], v[200:203]
    ds_read_b64_tr_b16 v[32:33], v18 offset:9408
    ds_read_b64_tr_b16 v[34:35], v18 offset:11712
    ds_read_b64_tr_b16 v[36:37], v18 offset:224
    ds_read_b64_tr_b16 v[38:39], v18 offset:2528
    s_add_u32 m0, s29, 0xec00
    s_nop 0
    buffer_load_dwordx4 v9, s[20:23], s32 offen lds
    v_mfma_f32_16x16x32_bf16 v[204:207], v[48:51], v[76:79], v[204:207]
    v_mfma_f32_16x16x32_bf16 v[208:211], v[48:51], v[80:83], v[208:211]
    v_mfma_f32_16x16x32_bf16 v[212:215], v[48:51], v[84:87], v[212:215]
    v_mfma_f32_16x16x32_bf16 v[216:219], v[48:51], v[88:91], v[216:219]
    ds_read_b64_tr_b16 v[40:41], v18 offset:9440
    s_waitcnt lgkmcnt(13)
    ds_read_b64_tr_b16 v[42:43], v18 offset:11744
    s_add_u32 m0, s30, 0xe800
    s_mov_b64 exec, 0xffff
    buffer_load_dwordx4 v10, s[40:43], s32 offen lds
    s_mov_b64 exec, -1
    s_add_u32 s32, s32, 0x48000
    s_waitcnt lgkmcnt(10)
    v_mfma_f32_16x16x32_bf16 v[92:95], v[20:23], v[60:63], v[92:95]
    v_mfma_f32_16x16x32_bf16 v[96:99], v[20:23], v[64:67], v[96:99]
    v_mfma_f32_16x16x32_bf16 v[100:103], v[20:23], v[68:71], v[100:103]
    v_mfma_f32_16x16x32_bf16 v[104:107], v[20:23], v[72:75], v[104:107]
    ds_read_b64_tr_b16 v[44:45], v18 offset:256
    ds_read_b64_tr_b16 v[46:47], v18 offset:2560
    s_waitcnt lgkmcnt(10)
    v_mfma_f32_16x16x32_bf16 v[108:111], v[24:27], v[60:63], v[108:111]
    v_mfma_f32_16x16x32_bf16 v[112:115], v[24:27], v[64:67], v[112:115]
    v_mfma_f32_16x16x32_bf16 v[116:119], v[24:27], v[68:71], v[116:119]
    v_mfma_f32_16x16x32_bf16 v[120:123], v[24:27], v[72:75], v[120:123]
    ds_read_b64_tr_b16 v[48:49], v18 offset:9472
    ds_read_b64_tr_b16 v[50:51], v18 offset:11776
    s_waitcnt lgkmcnt(10)
    v_mfma_f32_16x16x32_bf16 v[124:127], v[28:31], v[60:63], v[124:127]
    v_mfma_f32_16x16x32_bf16 v[128:131], v[28:31], v[64:67], v[128:131]
    v_mfma_f32_16x16x32_bf16 v[132:135], v[28:31], v[68:71], v[132:135]
    v_mfma_f32_16x16x32_bf16 v[136:139], v[28:31], v[72:75], v[136:139]
    s_waitcnt lgkmcnt(8)
    v_mfma_f32_16x16x32_bf16 v[140:143], v[32:35], v[60:63], v[140:143]
    v_mfma_f32_16x16x32_bf16 v[144:147], v[32:35], v[64:67], v[144:147]
    v_mfma_f32_16x16x32_bf16 v[148:151], v[32:35], v[68:71], v[148:151]
    v_mfma_f32_16x16x32_bf16 v[152:155], v[32:35], v[72:75], v[152:155]
    s_waitcnt vmcnt(5) lgkmcnt(0)
    s_barrier
    ds_read_b128 v[76:79], v12 offset:0
    ds_read_b128 v[80:83], v12 offset:1024
    ds_read_b128 v[84:87], v12 offset:2048
    s_add_u32 m0, s29, 0x11000
    s_nop 0
    buffer_load_dwordx4 v8, s[12:15], s31 offen lds
    v_mfma_f32_16x16x32_bf16 v[156:159], v[36:39], v[60:63], v[156:159]
    v_mfma_f32_16x16x32_bf16 v[160:163], v[36:39], v[64:67], v[160:163]
    v_mfma_f32_16x16x32_bf16 v[164:167], v[36:39], v[68:71], v[164:167]
    v_mfma_f32_16x16x32_bf16 v[168:171], v[36:39], v[72:75], v[168:171]
    ds_read_b128 v[88:91], v12 offset:3072
    ds_read_b64_tr_b16 v[20:21], v16 offset:160
    ds_read_b64_tr_b16 v[22:23], v16 offset:2464
    s_add_u32 m0, s29, 0x13000
    s_add_u32 s33, s31, 0x24000
    buffer_load_dwordx4 v8, s[12:15], s33 offen lds
    s_add_u32 s31, s31, 64
    v_mfma_f32_16x16x32_bf16 v[172:175], v[40:43], v[60:63], v[172:175]
    v_mfma_f32_16x16x32_bf16 v[176:179], v[40:43], v[64:67], v[176:179]
    v_mfma_f32_16x16x32_bf16 v[180:183], v[40:43], v[68:71], v[180:183]
    v_mfma_f32_16x16x32_bf16 v[184:187], v[40:43], v[72:75], v[184:187]
    ds_read_b64_tr_b16 v[24:25], v16 offset:9376
    ds_read_b64_tr_b16 v[26:27], v16 offset:11680
    ds_read_b64_tr_b16 v[28:29], v16 offset:192
    ds_read_b64_tr_b16 v[30:31], v16 offset:2496
    s_add_u32 m0, s29, 0x15000
    s_nop 0
    buffer_load_dwordx4 v9, s[16:19], s32 offen lds
    v_mfma_f32_16x16x32_bf16 v[188:191], v[44:47], v[60:63], v[188:191]
    v_mfma_f32_16x16x32_bf16 v[192:195], v[44:47], v[64:67], v[192:195]
    v_mfma_f32_16x16x32_bf16 v[196:199], v[44:47], v[68:71], v[196:199]
    v_mfma_f32_16x16x32_bf16 v[200:203], v[44:47], v[72:75], v[200:203]
    ds_read_b64_tr_b16 v[32:33], v16 offset:9408
    ds_read_b64_tr_b16 v[34:35], v16 offset:11712
    ds_read_b64_tr_b16 v[36:37], v16 offset:224
    ds_read_b64_tr_b16 v[38:39], v16 offset:2528
    s_add_u32 m0, s29, 0x17400
    s_nop 0
    buffer_load_dwordx4 v9, s[20:23], s32 offen lds
    v_mfma_f32_16x16x32_bf16 v[204:207], v[48:51], v[60:63], v[204:207]
    v_mfma_f32_16x16x32_bf16 v[208:211], v[48:51], v[64:67], v[208:211]
    v_mfma_f32_16x16x32_bf16 v[212:215], v[48:51], v[68:71], v[212:215]
    v_mfma_f32_16x16x32_bf16 v[216:219], v[48:51], v[72:75], v[216:219]
    ds_read_b64_tr_b16 v[40:41], v16 offset:9440
    s_waitcnt lgkmcnt(13)
    ds_read_b64_tr_b16 v[42:43], v16 offset:11744
    s_add_u32 m0, s30, 0x17000
    s_mov_b64 exec, 0xffff
    buffer_load_dwordx4 v10, s[40:43], s32 offen lds
    s_mov_b64 exec, -1
    s_add_u32 s32, s32, 0x48000
    s_waitcnt lgkmcnt(10)
    v_mfma_f32_16x16x32_bf16 v[92:95], v[20:23], v[76:79], v[92:95]
    v_mfma_f32_16x16x32_bf16 v[96:99], v[20:23], v[80:83], v[96:99]
    v_mfma_f32_16x16x32_bf16 v[100:103], v[20:23], v[84:87], v[100:103]
    v_mfma_f32_16x16x32_bf16 v[104:107], v[20:23], v[88:91], v[104:107]
    ds_read_b64_tr_b16 v[44:45], v16 offset:256
    ds_read_b64_tr_b16 v[46:47], v16 offset:2560
    s_waitcnt lgkmcnt(10)
    v_mfma_f32_16x16x32_bf16 v[108:111], v[24:27], v[76:79], v[108:111]
    v_mfma_f32_16x16x32_bf16 v[112:115], v[24:27], v[80:83], v[112:115]
    v_mfma_f32_16x16x32_bf16 v[116:119], v[24:27], v[84:87], v[116:119]
    v_mfma_f32_16x16x32_bf16 v[120:123], v[24:27], v[88:91], v[120:123]
    ds_read_b64_tr_b16 v[48:49], v16 offset:9472
    ds_read_b64_tr_b16 v[50:51], v16 offset:11776
    s_waitcnt lgkmcnt(10)
    v_mfma_f32_16x16x32_bf16 v[124:127], v[28:31], v[76:79], v[124:127]
    v_mfma_f32_16x16x32_bf16 v[128:131], v[28:31], v[80:83], v[128:131]
    v_mfma_f32_16x16x32_bf16 v[132:135], v[28:31], v[84:87], v[132:135]
    v_mfma_f32_16x16x32_bf16 v[136:139], v[28:31], v[88:91], v[136:139]
    s_waitcnt lgkmcnt(8)
    v_mfma_f32_16x16x32_bf16 v[140:143], v[32:35], v[76:79], v[140:143]
    v_mfma_f32_16x16x32_bf16 v[144:147], v[32:35], v[80:83], v[144:147]
    v_mfma_f32_16x16x32_bf16 v[148:151], v[32:35], v[84:87], v[148:151]
    v_mfma_f32_16x16x32_bf16 v[152:155], v[32:35], v[88:91], v[152:155]
    s_waitcnt vmcnt(5) lgkmcnt(0)
    s_barrier
    ds_read_b128 v[60:63], v13 offset:0
    ds_read_b128 v[64:67], v13 offset:1024
    ds_read_b128 v[68:71], v13 offset:2048
    s_add_u32 m0, s29, 0x0
    s_nop 0
    buffer_load_dwordx4 v8, s[12:15], s31 offen lds
    v_mfma_f32_16x16x32_bf16 v[156:159], v[36:39], v[76:79], v[156:159]
    v_mfma_f32_16x16x32_bf16 v[160:163], v[36:39], v[80:83], v[160:163]
    v_mfma_f32_16x16x32_bf16 v[164:167], v[36:39], v[84:87], v[164:167]
    v_mfma_f32_16x16x32_bf16 v[168:171], v[36:39], v[88:91], v[168:171]
    ds_read_b128 v[72:75], v13 offset:3072
    ds_read_b64_tr_b16 v[20:21], v17 offset:160
    ds_read_b64_tr_b16 v[22:23], v17 offset:2464
    s_add_u32 m0, s29, 0x2000
    s_add_u32 s33, s31, 0x24000
    buffer_load_dwordx4 v8, s[12:15], s33 offen lds
    s_add_u32 s31, s31, 64
    v_mfma_f32_16x16x32_bf16 v[172:175], v[40:43], v[76:79], v[172:175]
    v_mfma_f32_16x16x32_bf16 v[176:179], v[40:43], v[80:83], v[176:179]
    v_mfma_f32_16x16x32_bf16 v[180:183], v[40:43], v[84:87], v[180:183]
    v_mfma_f32_16x16x32_bf16 v[184:187], v[40:43], v[88:91], v[184:187]
    ds_read_b64_tr_b16 v[24:25], v17 offset:9376
    ds_read_b64_tr_b16 v[26:27], v17 offset:11680
    ds_read_b64_tr_b16 v[28:29], v17 offset:192
    ds_read_b64_tr_b16 v[30:31], v17 offset:2496
    s_add_u32 m0, s29, 0x4000
    s_nop 0
    buffer_load_dwordx4 v9, s[16:19], s32 offen lds
    v_mfma_f32_16x16x32_bf16 v[188:191], v[44:47], v[76:79], v[188:191]
    v_mfma_f32_16x16x32_bf16 v[192:195], v[44:47], v[80:83], v[192:195]
    v_mfma_f32_16x16x32_bf16 v[196:199], v[44:47], v[84:87], v[196:199]
    v_mfma_f32_16x16x32_bf16 v[200:203], v[44:47], v[88:91], v[200:203]
    ds_read_b64_tr_b16 v[32:33], v17 offset:9408
    ds_read_b64_tr_b16 v[34:35], v17 offset:11712
    ds_read_b64_tr_b16 v[36:37], v17 offset:224
    ds_read_b64_tr_b16 v[38:39], v17 offset:2528
    s_add_u32 m0, s29, 0x6400
    s_nop 0
    buffer_load_dwordx4 v9, s[20:23], s32 offen lds
    v_mfma_f32_16x16x32_bf16 v[204:207], v[48:51], v[76:79], v[204:207]
    v_mfma_f32_16x16x32_bf16 v[208:211], v[48:51], v[80:83], v[208:211]
    v_mfma_f32_16x16x32_bf16 v[212:215], v[48:51], v[84:87], v[212:215]
    v_mfma_f32_16x16x32_bf16 v[216:219], v[48:51], v[88:91], v[216:219]
    ds_read_b64_tr_b16 v[40:41], v17 offset:9440
    s_waitcnt lgkmcnt(13)
    ds_read_b64_tr_b16 v[42:43], v17 offset:11744
    s_add_u32 m0, s30, 0x6000
    s_mov_b64 exec, 0xffff
    buffer_load_dwordx4 v10, s[40:43], s32 offen lds
    s_mov_b64 exec, -1
    s_add_u32 s32, s32, 0x48000
    s_waitcnt lgkmcnt(10)
    v_mfma_f32_16x16x32_bf16 v[92:95], v[20:23], v[60:63], v[92:95]
    v_mfma_f32_16x16x32_bf16 v[96:99], v[20:23], v[64:67], v[96:99]
    v_mfma_f32_16x16x32_bf16 v[100:103], v[20:23], v[68:71], v[100:103]
    v_mfma_f32_16x16x32_bf16 v[104:107], v[20:23], v[72:75], v[104:107]
    ds_read_b64_tr_b16 v[44:45], v17 offset:256
    ds_read_b64_tr_b16 v[46:47], v17 offset:2560
    s_waitcnt lgkmcnt(10)
    v_mfma_f32_16x16x32_bf16 v[108:111], v[24:27], v[60:63], v[108:111]
    v_mfma_f32_16x16x32_bf16 v[112:115], v[24:27], v[64:67], v[112:115]
    v_mfma_f32_16x16x32_bf16 v[116:119], v[24:27], v[68:71], v[116:119]
    v_mfma_f32_16x16x32_bf16 v[120:123], v[24:27], v[72:75], v[120:123]
    ds_read_b64_tr_b16 v[48:49], v17 offset:9472
    ds_read_b64_tr_b16 v[50:51], v17 offset:11776
    s_waitcnt lgkmcnt(10)
    v_mfma_f32_16x16x32_bf16 v[124:127], v[28:31], v[60:63], v[124:127]
    v_mfma_f32_16x16x32_bf16 v[128:131], v[28:31], v[64:67], v[128:131]
    v_mfma_f32_16x16x32_bf16 v[132:135], v[28:31], v[68:71], v[132:135]
    v_mfma_f32_16x16x32_bf16 v[136:139], v[28:31], v[72:75], v[136:139]
    s_waitcnt lgkmcnt(8)
    v_mfma_f32_16x16x32_bf16 v[140:143], v[32:35], v[60:63], v[140:143]
    v_mfma_f32_16x16x32_bf16 v[144:147], v[32:35], v[64:67], v[144:147]
    v_mfma_f32_16x16x32_bf16 v[148:151], v[32:35], v[68:71], v[148:151]
    v_mfma_f32_16x16x32_bf16 v[152:155], v[32:35], v[72:75], v[152:155]
    s_waitcnt vmcnt(5) lgkmcnt(0)
    s_barrier
    ds_read_b128 v[76:79], v14 offset:0
    ds_read_b128 v[80:83], v14 offset:1024
    ds_read_b128 v[84:87], v14 offset:2048
    s_add_u32 m0, s29, 0x8800
    s_nop 0
    buffer_load_dwordx4 v8, s[12:15], s31 offen lds
    v_mfma_f32_16x16x32_bf16 v[156:159], v[36:39], v[60:63], v[156:159]
    v_mfma_f32_16x16x32_bf16 v[160:163], v[36:39], v[64:67], v[160:163]
    v_mfma_f32_16x16x32_bf16 v[164:167], v[36:39], v[68:71], v[164:167]
    v_mfma_f32_16x16x32_bf16 v[168:171], v[36:39], v[72:75], v[168:171]
    ds_read_b128 v[88:91], v14 offset:3072
    ds_read_b64_tr_b16 v[20:21], v18 offset:160
    ds_read_b64_tr_b16 v[22:23], v18 offset:2464
    s_add_u32 m0, s29, 0xa800
    s_add_u32 s33, s31, 0x24000
    buffer_load_dwordx4 v8, s[12:15], s33 offen lds
    s_add_u32 s31, s31, 64
    v_mfma_f32_16x16x32_bf16 v[172:175], v[40:43], v[60:63], v[172:175]
    v_mfma_f32_16x16x32_bf16 v[176:179], v[40:43], v[64:67], v[176:179]
    v_mfma_f32_16x16x32_bf16 v[180:183], v[40:43], v[68:71], v[180:183]
    v_mfma_f32_16x16x32_bf16 v[184:187], v[40:43], v[72:75], v[184:187]
    ds_read_b64_tr_b16 v[24:25], v18 offset:9376
    ds_read_b64_tr_b16 v[26:27], v18 offset:11680
    ds_read_b64_tr_b16 v[28:29], v18 offset:192
    ds_read_b64_tr_b16 v[30:31], v18 offset:2496
    s_add_u32 m0, s29, 0xc800
    s_nop 0
    buffer_load_dwordx4 v9, s[16:19], s32 offen lds
    v_mfma_f32_16x16x32_bf16 v[188:191], v[44:47], v[60:63], v[188:191]
    v_mfma_f32_16x16x32_bf16 v[192:195], v[44:47], v[64:67], v[192:195]
    v_mfma_f32_16x16x32_bf16 v[196:199], v[44:47], v[68:71], v[196:199]
    v_mfma_f32_16x16x32_bf16 v[200:203], v[44:47], v[72:75], v[200:203]
    ds_read_b64_tr_b16 v[32:33], v18 offset:9408
    ds_read_b64_tr_b16 v[34:35], v18 offset:11712
    ds_read_b64_tr_b16 v[36:37], v18 offset:224
    ds_read_b64_tr_b16 v[38:39], v18 offset:2528
    s_add_u32 m0, s29, 0xec00
    s_nop 0
    buffer_load_dwordx4 v9, s[20:23], s32 offen lds
    v_mfma_f32_16x16x32_bf16 v[204:207], v[48:51], v[60:63], v[204:207]
    v_mfma_f32_16x16x32_bf16 v[208:211], v[48:51], v[64:67], v[208:211]
    v_mfma_f32_16x16x32_bf16 v[212:215], v[48:51], v[68:71], v[212:215]
    v_mfma_f32_16x16x32_bf16 v[216:219], v[48:51], v[72:75], v[216:219]
    ds_read_b64_tr_b16 v[40:41], v18 offset:9440
    s_waitcnt lgkmcnt(13)
    ds_read_b64_tr_b16 v[42:43], v18 offset:11744
    s_add_u32 m0, s30, 0xe800
    s_mov_b64 exec, 0xffff
    buffer_load_dwordx4 v10, s[40:43], s32 offen lds
    s_mov_b64 exec, -1
    s_add_u32 s32, s32, 0x48000
    s_waitcnt lgkmcnt(10)
    v_mfma_f32_16x16x32_bf16 v[92:95], v[20:23], v[76:79], v[92:95]
    v_mfma_f32_16x16x32_bf16 v[96:99], v[20:23], v[80:83], v[96:99]
    v_mfma_f32_16x16x32_bf16 v[100:103], v[20:23], v[84:87], v[100:103]
    v_mfma_f32_16x16x32_bf16 v[104:107], v[20:23], v[88:91], v[104:107]
    ds_read_b64_tr_b16 v[44:45], v18 offset:256
    ds_read_b64_tr_b16 v[46:47], v18 offset:2560
    s_waitcnt lgkmcnt(10)
    v_mfma_f32_16x16x32_bf16 v[108:111], v[24:27], v[76:79], v[108:111]
    v_mfma_f32_16x16x32_bf16 v[112:115], v[24:27], v[80:83], v[112:115]
    v_mfma_f32_16x16x32_bf16 v[116:119], v[24:27], v[84:87], v[116:119]
    v_mfma_f32_16x16x32_bf16 v[120:123], v[24:27], v[88:91], v[120:123]
    ds_read_b64_tr_b16 v[48:49], v18 offset:9472
    ds_read_b64_tr_b16 v[50:51], v18 offset:11776
    s_waitcnt lgkmcnt(10)
    v_mfma_f32_16x16x32_bf16 v[124:127], v[28:31], v[76:79], v[124:127]
    v_mfma_f32_16x16x32_bf16 v[128:131], v[28:31], v[80:83], v[128:131]
    v_mfma_f32_16x16x32_bf16 v[132:135], v[28:31], v[84:87], v[132:135]
    v_mfma_f32_16x16x32_bf16 v[136:139], v[28:31], v[88:91], v[136:139]
    s_waitcnt lgkmcnt(8)
    v_mfma_f32_16x16x32_bf16 v[140:143], v[32:35], v[76:79], v[140:143]
    v_mfma_f32_16x16x32_bf16 v[144:147], v[32:35], v[80:83], v[144:147]
    v_mfma_f32_16x16x32_bf16 v[148:151], v[32:35], v[84:87], v[148:151]
    v_mfma_f32_16x16x32_bf16 v[152:155], v[32:35], v[88:91], v[152:155]
    s_waitcnt vmcnt(5) lgkmcnt(0)
    s_barrier
    ds_read_b128 v[60:63], v12 offset:0
    ds_read_b128 v[64:67], v12 offset:1024
    ds_read_b128 v[68:71], v12 offset:2048
    s_add_u32 m0, s29, 0x11000
    s_nop 0
    buffer_load_dwordx4 v8, s[12:15], s31 offen lds
    v_mfma_f32_16x16x32_bf16 v[156:159], v[36:39], v[76:79], v[156:159]
    v_mfma_f32_16x16x32_bf16 v[160:163], v[36:39], v[80:83], v[160:163]
    v_mfma_f32_16x16x32_bf16 v[164:167], v[36:39], v[84:87], v[164:167]
    v_mfma_f32_16x16x32_bf16 v[168:171], v[36:39], v[88:91], v[168:171]
    ds_read_b128 v[72:75], v12 offset:3072
    ds_read_b64_tr_b16 v[20:21], v16 offset:160
    ds_read_b64_tr_b16 v[22:23], v16 offset:2464
    s_add_u32 m0, s29, 0x13000
    s_add_u32 s33, s31, 0x24000
    buffer_load_dwordx4 v8, s[12:15], s33 offen lds
    s_add_u32 s31, s31, 64
    v_mfma_f32_16x16x32_bf16 v[172:175], v[40:43], v[76:79], v[172:175]
    v_mfma_f32_16x16x32_bf16 v[176:179], v[40:43], v[80:83], v[176:179]
    v_mfma_f32_16x16x32_bf16 v[180:183], v[40:43], v[84:87], v[180:183]
    v_mfma_f32_16x16x32_bf16 v[184:187], v[40:43], v[88:91], v[184:187]
    ds_read_b64_tr_b16 v[24:25], v16 offset:9376
    ds_read_b64_tr_b16 v[26:27], v16 offset:11680
    ds_read_b64_tr_b16 v[28:29], v16 offset:192
    ds_read_b64_tr_b16 v[30:31], v16 offset:2496
    s_add_u32 m0, s29, 0x15000
    s_nop 0
    buffer_load_dwordx4 v9, s[16:19], s32 offen lds
    v_mfma_f32_16x16x32_bf16 v[188:191], v[44:47], v[76:79], v[188:191]
    v_mfma_f32_16x16x32_bf16 v[192:195], v[44:47], v[80:83], v[192:195]
    v_mfma_f32_16x16x32_bf16 v[196:199], v[44:47], v[84:87], v[196:199]
    v_mfma_f32_16x16x32_bf16 v[200:203], v[44:47], v[88:91], v[200:203]
    ds_read_b64_tr_b16 v[32:33], v16 offset:9408
    ds_read_b64_tr_b16 v[34:35], v16 offset:11712
    ds_read_b64_tr_b16 v[36:37], v16 offset:224
    ds_read_b64_tr_b16 v[38:39], v16 offset:2528
    s_add_u32 m0, s29, 0x17400
    s_nop 0
    buffer_load_dwordx4 v9, s[20:23], s32 offen lds
    v_mfma_f32_16x16x32_bf16 v[204:207], v[48:51], v[76:79], v[204:207]
    v_mfma_f32_16x16x32_bf16 v[208:211], v[48:51], v[80:83], v[208:211]
    v_mfma_f32_16x16x32_bf16 v[212:215], v[48:51], v[84:87], v[212:215]
    v_mfma_f32_16x16x32_bf16 v[216:219], v[48:51], v[88:91], v[216:219]
    ds_read_b64_tr_b16 v[40:41], v16 offset:9440
    s_waitcnt lgkmcnt(13)
    ds_read_b64_tr_b16 v[42:43], v16 offset:11744
    s_add_u32 m0, s30, 0x17000
    s_mov_b64 exec, 0xffff
    buffer_load_dwordx4 v10, s[40:43], s32 offen lds
    s_mov_b64 exec, -1
    s_add_u32 s32, s32, 0x48000
    s_waitcnt lgkmcnt(10)
    v_mfma_f32_16x16x32_bf16 v[92:95], v[20:23], v[60:63], v[92:95]
    v_mfma_f32_16x16x32_bf16 v[96:99], v[20:23], v[64:67], v[96:99]
    v_mfma_f32_16x16x32_bf16 v[100:103], v[20:23], v[68:71], v[100:103]
    v_mfma_f32_16x16x32_bf16 v[104:107], v[20:23], v[72:75], v[104:107]
    ds_read_b64_tr_b16 v[44:45], v16 offset:256
    ds_read_b64_tr_b16 v[46:47], v16 offset:2560
    s_waitcnt lgkmcnt(10)
    v_mfma_f32_16x16x32_bf16 v[108:111], v[24:27], v[60:63], v[108:111]
    v_mfma_f32_16x16x32_bf16 v[112:115], v[24:27], v[64:67], v[112:115]
    v_mfma_f32_16x16x32_bf16 v[116:119], v[24:27], v[68:71], v[116:119]
    v_mfma_f32_16x16x32_bf16 v[120:123], v[24:27], v[72:75], v[120:123]
    ds_read_b64_tr_b16 v[48:49], v16 offset:9472
    ds_read_b64_tr_b16 v[50:51], v16 offset:11776
    s_waitcnt lgkmcnt(10)
    v_mfma_f32_16x16x32_bf16 v[124:127], v[28:31], v[60:63], v[124:127]
    v_mfma_f32_16x16x32_bf16 v[128:131], v[28:31], v[64:67], v[128:131]
    v_mfma_f32_16x16x32_bf16 v[132:135], v[28:31], v[68:71], v[132:135]
    v_mfma_f32_16x16x32_bf16 v[136:139], v[28:31], v[72:75], v[136:139]
    s_waitcnt lgkmcnt(8)
    v_mfma_f32_16x16x32_bf16 v[140:143], v[32:35], v[60:63], v[140:143]
    v_mfma_f32_16x16x32_bf16 v[144:147], v[32:35], v[64:67], v[144:147]
    v_mfma_f32_16x16x32_bf16 v[148:151], v[32:35], v[68:71], v[148:151]
    v_mfma_f32_16x16x32_bf16 v[152:155], v[32:35], v[72:75], v[152:155]
    s_waitcnt vmcnt(5) lgkmcnt(0)
    s_barrier
    ds_read_b128 v[76:79], v13 offset:0
    ds_read_b128 v[80:83], v13 offset:1024
    ds_read_b128 v[84:87], v13 offset:2048
    s_add_u32 m0, s29, 0x0
    s_nop 0
    buffer_load_dwordx4 v8, s[12:15], s31 offen lds
    v_mfma_f32_16x16x32_bf16 v[156:159], v[36:39], v[60:63], v[156:159]
    v_mfma_f32_16x16x32_bf16 v[160:163], v[36:39], v[64:67], v[160:163]
    v_mfma_f32_16x16x32_bf16 v[164:167], v[36:39], v[68:71], v[164:167]
    v_mfma_f32_16x16x32_bf16 v[168:171], v[36:39], v[72:75], v[168:171]
    ds_read_b128 v[88:91], v13 offset:3072
    ds_read_b64_tr_b16 v[20:21], v17 offset:160
    ds_read_b64_tr_b16 v[22:23], v17 offset:2464
    s_add_u32 m0, s29, 0x2000
    s_add_u32 s33, s31, 0x24000
    buffer_load_dwordx4 v8, s[12:15], s33 offen lds
    s_add_u32 s31, s31, 64
    v_mfma_f32_16x16x32_bf16 v[172:175], v[40:43], v[60:63], v[172:175]
    v_mfma_f32_16x16x32_bf16 v[176:179], v[40:43], v[64:67], v[176:179]
    v_mfma_f32_16x16x32_bf16 v[180:183], v[40:43], v[68:71], v[180:183]
    v_mfma_f32_16x16x32_bf16 v[184:187], v[40:43], v[72:75], v[184:187]
    ds_read_b64_tr_b16 v[24:25], v17 offset:9376
    ds_read_b64_tr_b16 v[26:27], v17 offset:11680
    ds_read_b64_tr_b16 v[28:29], v17 offset:192
    ds_read_b64_tr_b16 v[30:31], v17 offset:2496
    s_add_u32 m0, s29, 0x4000
    s_nop 0
    buffer_load_dwordx4 v9, s[16:19], s32 offen lds
    v_mfma_f32_16x16x32_bf16 v[188:191], v[44:47], v[60:63], v[188:191]
    v_mfma_f32_16x16x32_bf16 v[192:195], v[44:47], v[64:67], v[192:195]
    v_mfma_f32_16x16x32_bf16 v[196:199], v[44:47], v[68:71], v[196:199]
    v_mfma_f32_16x16x32_bf16 v[200:203], v[44:47], v[72:75], v[200:203]
    ds_read_b64_tr_b16 v[32:33], v17 offset:9408
    ds_read_b64_tr_b16 v[34:35], v17 offset:11712
    ds_read_b64_tr_b16 v[36:37], v17 offset:224
    ds_read_b64_tr_b16 v[38:39], v17 offset:2528
    s_add_u32 m0, s29, 0x6400
    s_nop 0
    buffer_load_dwordx4 v9, s[20:23], s32 offen lds
    v_mfma_f32_16x16x32_bf16 v[204:207], v[48:51], v[60:63], v[204:207]
    v_mfma_f32_16x16x32_bf16 v[208:211], v[48:51], v[64:67], v[208:211]
    v_mfma_f32_16x16x32_bf16 v[212:215], v[48:51], v[68:71], v[212:215]
    v_mfma_f32_16x16x32_bf16 v[216:219], v[48:51], v[72:75], v[216:219]
    ds_read_b64_tr_b16 v[40:41], v17 offset:9440
    s_waitcnt lgkmcnt(13)
    ds_read_b64_tr_b16 v[42:43], v17 offset:11744
    s_add_u32 m0, s30, 0x6000
    s_mov_b64 exec, 0xffff
    buffer_load_dwordx4 v10, s[40:43], s32 offen lds
    s_mov_b64 exec, -1
    s_add_u32 s32, s32, 0x48000
    s_sub_u32 s39, s39, 1
    s_cmp_lg_u32 s39, 0
    s_cbranch_scc1 LP_rompt_kernel_55
    s_waitcnt lgkmcnt(10)
    v_mfma_f32_16x16x32_bf16 v[92:95], v[20:23], v[76:79], v[92:95]
    v_mfma_f32_16x16x32_bf16 v[96:99], v[20:23], v[80:83], v[96:99]
    v_mfma_f32_16x16x32_bf16 v[100:103], v[20:23], v[84:87], v[100:103]
    v_mfma_f32_16x16x32_bf16 v[104:107], v[20:23], v[88:91], v[104:107]
    ds_read_b64_tr_b16 v[44:45], v17 offset:256
    ds_read_b64_tr_b16 v[46:47], v17 offset:2560
    s_waitcnt lgkmcnt(10)
    v_mfma_f32_16x16x32_bf16 v[108:111], v[24:27], v[76:79], v[108:111]
    v_mfma_f32_16x16x32_bf16 v[112:115], v[24:27], v[80:83], v[112:115]
    v_mfma_f32_16x16x32_bf16 v[116:119], v[24:27], v[84:87], v[116:119]
    v_mfma_f32_16x16x32_bf16 v[120:123], v[24:27], v[88:91], v[120:123]
    ds_read_b64_tr_b16 v[48:49], v17 offset:9472
    ds_read_b64_tr_b16 v[50:51], v17 offset:11776
    s_waitcnt lgkmcnt(10)
    v_mfma_f32_16x16x32_bf16 v[124:127], v[28:31], v[76:79], v[124:127]
    v_mfma_f32_16x16x32_bf16 v[128:131], v[28:31], v[80:83], v[128:131]
    v_mfma_f32_16x16x32_bf16 v[132:135], v[28:31], v[84:87], v[132:135]
    v_mfma_f32_16x16x32_bf16 v[136:139], v[28:31], v[88:91], v[136:139]
    s_waitcnt lgkmcnt(8)
    v_mfma_f32_16x16x32_bf16 v[140:143], v[32:35], v[76:79], v[140:143]
    v_mfma_f32_16x16x32_bf16 v[144:147], v[32:35], v[80:83], v[144:147]
    v_mfma_f32_16x16x32_bf16 v[148:151], v[32:35], v[84:87], v[148:151]
    v_mfma_f32_16x16x32_bf16 v[152:155], v[32:35], v[88:91], v[152:155]
    s_waitcnt vmcnt(5) lgkmcnt(0)
    s_barrier
    ds_read_b128 v[60:63], v14 offset:0
    ds_read_b128 v[64:67], v14 offset:1024
    ds_read_b128 v[68:71], v14 offset:2048
    s_add_u32 m0, s29, 0x8800
    s_nop 0
    buffer_load_dwordx4 v8, s[12:15], s31 offen lds
    v_mfma_f32_16x16x32_bf16 v[156:159], v[36:39], v[76:79], v[156:159]
    v_mfma_f32_16x16x32_bf16 v[160:163], v[36:39], v[80:83], v[160:163]
    v_mfma_f32_16x16x32_bf16 v[164:167], v[36:39], v[84:87], v[164:167]
    v_mfma_f32_16x16x32_bf16 v[168:171], v[36:39], v[88:91], v[168:171]
    ds_read_b128 v[72:75], v14 offset:3072
    ds_read_b64_tr_b16 v[20:21], v18 offset:160
    ds_read_b64_tr_b16 v[22:23], v18 offset:2464
    s_add_u32 m0, s29, 0xa800
    s_add_u32 s33, s31, 0x24000
    buffer_load_dwordx4 v8, s[12:15], s33 offen lds
    s_add_u32 s31, s31, 64
    v_mfma_f32_16x16x32_bf16 v[172:175], v[40:43], v[76:79], v[172:175]
    v_mfma_f32_16x16x32_bf16 v[176:179], v[40:43], v[80:83], v[176:179]
    v_mfma_f32_16x16x32_bf16 v[180:183], v[40:43], v[84:87], v[180:183]
    v_mfma_f32_16x16x32_bf16 v[184:187], v[40:43], v[88:91], v[184:187]
    ds_read_b64_tr_b16 v[24:25], v18 offset:9376
    ds_read_b64_tr_b16 v[26:27], v18 offset:11680
    ds_read_b64_tr_b16 v[28:29], v18 offset:192
    ds_read_b64_tr_b16 v[30:31], v18 offset:2496
    s_add_u32 m0, s29, 0xc800
    s_nop 0
    buffer_load_dwordx4 v9, s[16:19], s32 offen lds
    v_mfma_f32_16x16x32_bf16 v[188:191], v[44:47], v[76:79], v[188:191]
    v_mfma_f32_16x16x32_bf16 v[192:195], v[44:47], v[80:83], v[192:195]
    v_mfma_f32_16x16x32_bf16 v[196:199], v[44:47], v[84:87], v[196:199]
    v_mfma_f32_16x16x32_bf16 v[200:203], v[44:47], v[88:91], v[200:203]
    ds_read_b64_tr_b16 v[32:33], v18 offset:9408
    ds_read_b64_tr_b16 v[34:35], v18 offset:11712
    ds_read_b64_tr_b16 v[36:37], v18 offset:224
    ds_read_b64_tr_b16 v[38:39], v18 offset:2528
    s_add_u32 m0, s29, 0xec00
    s_nop 0
    buffer_load_dwordx4 v9, s[20:23], s32 offen lds
    v_mfma_f32_16x16x32_bf16 v[204:207], v[48:51], v[76:79], v[204:207]
    v_mfma_f32_16x16x32_bf16 v[208:211], v[48:51], v[80:83], v[208:211]
    v_mfma_f32_16x16x32_bf16 v[212:215], v[48:51], v[84:87], v[212:215]
    v_mfma_f32_16x16x32_bf16 v[216:219], v[48:51], v[88:91], v[216:219]
    ds_read_b64_tr_b16 v[40:41], v18 offset:9440
    s_waitcnt lgkmcnt(13)
    ds_read_b64_tr_b16 v[42:43], v18 offset:11744
    s_add_u32 m0, s30, 0xe800
    s_mov_b64 exec, 0xffff
    buffer_load_dwordx4 v10, s[40:43], s32 offen lds
    s_mov_b64 exec, -1
    s_add_u32 s32, s32, 0x48000
    s_waitcnt lgkmcnt(10)
    v_mfma_f32_16x16x32_bf16 v[92:95], v[20:23], v[60:63], v[92:95]
    v_mfma_f32_16x16x32_bf16 v[96:99], v[20:23], v[64:67], v[96:99]
    v_mfma_f32_16x16x32_bf16 v[100:103], v[20:23], v[68:71], v[100:103]
    v_mfma_f32_16x16x32_bf16 v[104:107], v[20:23], v[72:75], v[104:107]
    ds_read_b64_tr_b16 v[44:45], v18 offset:256
    ds_read_b64_tr_b16 v[46:47], v18 offset:2560
    s_waitcnt lgkmcnt(10)
    v_mfma_f32_16x16x32_bf16 v[108:111], v[24:27], v[60:63], v[108:111]
    v_mfma_f32_16x16x32_bf16 v[112:115], v[24:27], v[64:67], v[112:115]
    v_mfma_f32_16x16x32_bf16 v[116:119], v[24:27], v[68:71], v[116:119]
    v_mfma_f32_16x16x32_bf16 v[120:123], v[24:27], v[72:75], v[120:123]
    ds_read_b64_tr_b16 v[48:49], v18 offset:9472
    ds_read_b64_tr_b16 v[50:51], v18 offset:11776
    s_waitcnt lgkmcnt(10)
    v_mfma_f32_16x16x32_bf16 v[124:127], v[28:31], v[60:63], v[124:127]
    v_mfma_f32_16x16x32_bf16 v[128:131], v[28:31], v[64:67], v[128:131]
    v_mfma_f32_16x16x32_bf16 v[132:135], v[28:31], v[68:71], v[132:135]
    v_mfma_f32_16x16x32_bf16 v[136:139], v[28:31], v[72:75], v[136:139]
    s_waitcnt lgkmcnt(8)
    v_mfma_f32_16x16x32_bf16 v[140:143], v[32:35], v[60:63], v[140:143]
    v_mfma_f32_16x16x32_bf16 v[144:147], v[32:35], v[64:67], v[144:147]
    v_mfma_f32_16x16x32_bf16 v[148:151], v[32:35], v[68:71], v[148:151]
    v_mfma_f32_16x16x32_bf16 v[152:155], v[32:35], v[72:75], v[152:155]
    s_waitcnt vmcnt(5) lgkmcnt(0)
    s_barrier
    ds_read_b128 v[76:79], v12 offset:0
    ds_read_b128 v[80:83], v12 offset:1024
    ds_read_b128 v[84:87], v12 offset:2048
    s_add_u32 m0, s29, 0x11000
    s_nop 0
    buffer_load_dwordx4 v8, s[12:15], s31 offen lds
    v_mfma_f32_16x16x32_bf16 v[156:159], v[36:39], v[60:63], v[156:159]
    v_mfma_f32_16x16x32_bf16 v[160:163], v[36:39], v[64:67], v[160:163]
    v_mfma_f32_16x16x32_bf16 v[164:167], v[36:39], v[68:71], v[164:167]
    v_mfma_f32_16x16x32_bf16 v[168:171], v[36:39], v[72:75], v[168:171]
    ds_read_b128 v[88:91], v12 offset:3072
    ds_read_b64_tr_b16 v[20:21], v16 offset:160
    ds_read_b64_tr_b16 v[22:23], v16 offset:2464
    s_add_u32 m0, s29, 0x13000
    s_add_u32 s33, s31, 0x24000
    buffer_load_dwordx4 v8, s[12:15], s33 offen lds
    s_add_u32 s31, s31, 64
    v_mfma_f32_16x16x32_bf16 v[172:175], v[40:43], v[60:63], v[172:175]
    v_mfma_f32_16x16x32_bf16 v[176:179], v[40:43], v[64:67], v[176:179]
    v_mfma_f32_16x16x32_bf16 v[180:183], v[40:43], v[68:71], v[180:183]
    v_mfma_f32_16x16x32_bf16 v[184:187], v[40:43], v[72:75], v[184:187]
    ds_read_b64_tr_b16 v[24:25], v16 offset:9376
    ds_read_b64_tr_b16 v[26:27], v16 offset:11680
    ds_read_b64_tr_b16 v[28:29], v16 offset:192
    ds_read_b64_tr_b16 v[30:31], v16 offset:2496
    s_add_u32 m0, s29, 0x15000
    s_nop 0
    buffer_load_dwordx4 v9, s[16:19], s32 offen lds
    v_mfma_f32_16x16x32_bf16 v[188:191], v[44:47], v[60:63], v[188:191]
    v_mfma_f32_16x16x32_bf16 v[192:195], v[44:47], v[64:67], v[192:195]
    v_mfma_f32_16x16x32_bf16 v[196:199], v[44:47], v[68:71], v[196:199]
    v_mfma_f32_16x16x32_bf16 v[200:203], v[44:47], v[72:75], v[200:203]
    ds_read_b64_tr_b16 v[32:33], v16 offset:9408
    ds_read_b64_tr_b16 v[34:35], v16 offset:11712
    ds_read_b64_tr_b16 v[36:37], v16 offset:224
    ds_read_b64_tr_b16 v[38:39], v16 offset:2528
    s_add_u32 m0, s29, 0x17400
    s_nop 0
    buffer_load_dwordx4 v9, s[20:23], s32 offen lds
    v_mfma_f32_16x16x32_bf16 v[204:207], v[48:51], v[60:63], v[204:207]
    v_mfma_f32_16x16x32_bf16 v[208:211], v[48:51], v[64:67], v[208:211]
    v_mfma_f32_16x16x32_bf16 v[212:215], v[48:51], v[68:71], v[212:215]
    v_mfma_f32_16x16x32_bf16 v[216:219], v[48:51], v[72:75], v[216:219]
    ds_read_b64_tr_b16 v[40:41], v16 offset:9440
    s_waitcnt lgkmcnt(13)
    ds_read_b64_tr_b16 v[42:43], v16 offset:11744
    s_add_u32 m0, s30, 0x17000
    s_mov_b64 exec, 0xffff
    buffer_load_dwordx4 v10, s[40:43], s32 offen lds
    s_mov_b64 exec, -1
    s_add_u32 s32, s32, 0x48000
    s_waitcnt lgkmcnt(10)
    v_mfma_f32_16x16x32_bf16 v[92:95], v[20:23], v[76:79], v[92:95]
    v_mfma_f32_16x16x32_bf16 v[96:99], v[20:23], v[80:83], v[96:99]
    v_mfma_f32_16x16x32_bf16 v[100:103], v[20:23], v[84:87], v[100:103]
    v_mfma_f32_16x16x32_bf16 v[104:107], v[20:23], v[88:91], v[104:107]
    ds_read_b64_tr_b16 v[44:45], v16 offset:256
    ds_read_b64_tr_b16 v[46:47], v16 offset:2560
    s_waitcnt lgkmcnt(10)
    v_mfma_f32_16x16x32_bf16 v[108:111], v[24:27], v[76:79], v[108:111]
    v_mfma_f32_16x16x32_bf16 v[112:115], v[24:27], v[80:83], v[112:115]
    v_mfma_f32_16x16x32_bf16 v[116:119], v[24:27], v[84:87], v[116:119]
    v_mfma_f32_16x16x32_bf16 v[120:123], v[24:27], v[88:91], v[120:123]
    ds_read_b64_tr_b16 v[48:49], v16 offset:9472
    ds_read_b64_tr_b16 v[50:51], v16 offset:11776
    s_waitcnt lgkmcnt(10)
    v_mfma_f32_16x16x32_bf16 v[124:127], v[28:31], v[76:79], v[124:127]
    v_mfma_f32_16x16x32_bf16 v[128:131], v[28:31], v[80:83], v[128:131]
    v_mfma_f32_16x16x32_bf16 v[132:135], v[28:31], v[84:87], v[132:135]
    v_mfma_f32_16x16x32_bf16 v[136:139], v[28:31], v[88:91], v[136:139]
    s_waitcnt lgkmcnt(8)
    v_mfma_f32_16x16x32_bf16 v[140:143], v[32:35], v[76:79], v[140:143]
    v_mfma_f32_16x16x32_bf16 v[144:147], v[32:35], v[80:83], v[144:147]
    v_mfma_f32_16x16x32_bf16 v[148:151], v[32:35], v[84:87], v[148:151]
    v_mfma_f32_16x16x32_bf16 v[152:155], v[32:35], v[88:91], v[152:155]
    s_waitcnt vmcnt(5) lgkmcnt(0)
    s_barrier
    ds_read_b128 v[60:63], v13 offset:0
    ds_read_b128 v[64:67], v13 offset:1024
    ds_read_b128 v[68:71], v13 offset:2048
    v_mfma_f32_16x16x32_bf16 v[156:159], v[36:39], v[76:79], v[156:159]
    v_mfma_f32_16x16x32_bf16 v[160:163], v[36:39], v[80:83], v[160:163]
    v_mfma_f32_16x16x32_bf16 v[164:167], v[36:39], v[84:87], v[164:167]
    v_mfma_f32_16x16x32_bf16 v[168:171], v[36:39], v[88:91], v[168:171]
    ds_read_b128 v[72:75], v13 offset:3072
    ds_read_b64_tr_b16 v[20:21], v17 offset:160
    ds_read_b64_tr_b16 v[22:23], v17 offset:2464
    v_mfma_f32_16x16x32_bf16 v[172:175], v[40:43], v[76:79], v[172:175]
    v_mfma_f32_16x16x32_bf16 v[176:179], v[40:43], v[80:83], v[176:179]
    v_mfma_f32_16x16x32_bf16 v[180:183], v[40:43], v[84:87], v[180:183]
    v_mfma_f32_16x16x32_bf16 v[184:187], v[40:43], v[88:91], v[184:187]
    ds_read_b64_tr_b16 v[24:25], v17 offset:9376
    ds_read_b64_tr_b16 v[26:27], v17 offset:11680
    ds_read_b64_tr_b16 v[28:29], v17 offset:192
    ds_read_b64_tr_b16 v[30:31], v17 offset:2496
    v_mfma_f32_16x16x32_bf16 v[188:191], v[44:47], v[76:79], v[188:191]
    v_mfma_f32_16x16x32_bf16 v[192:195], v[44:47], v[80:83], v[192:195]
    v_mfma_f32_16x16x32_bf16 v[196:199], v[44:47], v[84:87], v[196:199]
    v_mfma_f32_16x16x32_bf16 v[200:203], v[44:47], v[88:91], v[200:203]
    ds_read_b64_tr_b16 v[32:33], v17 offset:9408
    ds_read_b64_tr_b16 v[34:35], v17 offset:11712
    ds_read_b64_tr_b16 v[36:37], v17 offset:224
    ds_read_b64_tr_b16 v[38:39], v17 offset:2528
    v_mfma_f32_16x16x32_bf16 v[204:207], v[48:51], v[76:79], v[204:207]
    v_mfma_f32_16x16x32_bf16 v[208:211], v[48:51], v[80:83], v[208:211]
    v_mfma_f32_16x16x32_bf16 v[212:215], v[48:51], v[84:87], v[212:215]
    v_mfma_f32_16x16x32_bf16 v[216:219], v[48:51], v[88:91], v[216:219]
    ds_read_b64_tr_b16 v[40:41], v17 offset:9440
    s_waitcnt lgkmcnt(13)
    ds_read_b64_tr_b16 v[42:43], v17 offset:11744
    s_waitcnt lgkmcnt(10)
    v_mfma_f32_16x16x32_bf16 v[92:95], v[20:23], v[60:63], v[92:95]
    v_mfma_f32_16x16x32_bf16 v[96:99], v[20:23], v[64:67], v[96:99]
    v_mfma_f32_16x16x32_bf16 v[100:103], v[20:23], v[68:71], v[100:103]
    v_mfma_f32_16x16x32_bf16 v[104:107], v[20:23], v[72:75], v[104:107]
    ds_read_b64_tr_b16 v[44:45], v17 offset:256
    ds_read_b64_tr_b16 v[46:47], v17 offset:2560
    s_waitcnt lgkmcnt(10)
    v_mfma_f32_16x16x32_bf16 v[108:111], v[24:27], v[60:63], v[108:111]
    v_mfma_f32_16x16x32_bf16 v[112:115], v[24:27], v[64:67], v[112:115]
    v_mfma_f32_16x16x32_bf16 v[116:119], v[24:27], v[68:71], v[116:119]
    v_mfma_f32_16x16x32_bf16 v[120:123], v[24:27], v[72:75], v[120:123]
    ds_read_b64_tr_b16 v[48:49], v17 offset:9472
    ds_read_b64_tr_b16 v[50:51], v17 offset:11776
    s_waitcnt lgkmcnt(10)
    v_mfma_f32_16x16x32_bf16 v[124:127], v[28:31], v[60:63], v[124:127]
    v_mfma_f32_16x16x32_bf16 v[128:131], v[28:31], v[64:67], v[128:131]
    v_mfma_f32_16x16x32_bf16 v[132:135], v[28:31], v[68:71], v[132:135]
    v_mfma_f32_16x16x32_bf16 v[136:139], v[28:31], v[72:75], v[136:139]
    s_waitcnt lgkmcnt(8)
    v_mfma_f32_16x16x32_bf16 v[140:143], v[32:35], v[60:63], v[140:143]
    v_mfma_f32_16x16x32_bf16 v[144:147], v[32:35], v[64:67], v[144:147]
    v_mfma_f32_16x16x32_bf16 v[148:151], v[32:35], v[68:71], v[148:151]
    v_mfma_f32_16x16x32_bf16 v[152:155], v[32:35], v[72:75], v[152:155]
    s_waitcnt vmcnt(0) lgkmcnt(0)
    s_barrier
    ds_read_b128 v[76:79], v14 offset:0
    ds_read_b128 v[80:83], v14 offset:1024
    ds_read_b128 v[84:87], v14 offset:2048
    v_mfma_f32_16x16x32_bf16 v[156:159], v[36:39], v[60:63], v[156:159]
    v_mfma_f32_16x16x32_bf16 v[160:163], v[36:39], v[64:67], v[160:163]
    v_mfma_f32_16x16x32_bf16 v[164:167], v[36:39], v[68:71], v[164:167]
    v_mfma_f32_16x16x32_bf16 v[168:171], v[36:39], v[72:75], v[168:171]
    ds_read_b128 v[88:91], v14 offset:3072
    ds_read_b64_tr_b16 v[20:21], v18 offset:160
    ds_read_b64_tr_b16 v[22:23], v18 offset:2464
    v_mfma_f32_16x16x32_bf16 v[172:175], v[40:43], v[60:63], v[172:175]
    v_mfma_f32_16x16x32_bf16 v[176:179], v[40:43], v[64:67], v[176:179]
    v_mfma_f32_16x16x32_bf16 v[180:183], v[40:43], v[68:71], v[180:183]
    v_mfma_f32_16x16x32_bf16 v[184:187], v[40:43], v[72:75], v[184:187]
    ds_read_b64_tr_b16 v[24:25], v18 offset:9376
    ds_read_b64_tr_b16 v[26:27], v18 offset:11680
    ds_read_b64_tr_b16 v[28:29], v18 offset:192
    ds_read_b64_tr_b16 v[30:31], v18 offset:2496
    v_mfma_f32_16x16x32_bf16 v[188:191], v[44:47], v[60:63], v[188:191]
    v_mfma_f32_16x16x32_bf16 v[192:195], v[44:47], v[64:67], v[192:195]
    v_mfma_f32_16x16x32_bf16 v[196:199], v[44:47], v[68:71], v[196:199]
    v_mfma_f32_16x16x32_bf16 v[200:203], v[44:47], v[72:75], v[200:203]
    ds_read_b64_tr_b16 v[32:33], v18 offset:9408
    ds_read_b64_tr_b16 v[34:35], v18 offset:11712
    ds_read_b64_tr_b16 v[36:37], v18 offset:224
    ds_read_b64_tr_b16 v[38:39], v18 offset:2528
    v_mfma_f32_16x16x32_bf16 v[204:207], v[48:51], v[60:63], v[204:207]
    v_mfma_f32_16x16x32_bf16 v[208:211], v[48:51], v[64:67], v[208:211]
    v_mfma_f32_16x16x32_bf16 v[212:215], v[48:51], v[68:71], v[212:215]
    v_mfma_f32_16x16x32_bf16 v[216:219], v[48:51], v[72:75], v[216:219]
    ds_read_b64_tr_b16 v[40:41], v18 offset:9440
    s_waitcnt lgkmcnt(13)
    ds_read_b64_tr_b16 v[42:43], v18 offset:11744
    s_waitcnt lgkmcnt(10)
    v_mfma_f32_16x16x32_bf16 v[92:95], v[20:23], v[76:79], v[92:95]
    v_mfma_f32_16x16x32_bf16 v[96:99], v[20:23], v[80:83], v[96:99]
    v_mfma_f32_16x16x32_bf16 v[100:103], v[20:23], v[84:87], v[100:103]
    v_mfma_f32_16x16x32_bf16 v[104:107], v[20:23], v[88:91], v[104:107]
    ds_read_b64_tr_b16 v[44:45], v18 offset:256
    ds_read_b64_tr_b16 v[46:47], v18 offset:2560
    s_waitcnt lgkmcnt(10)
    v_mfma_f32_16x16x32_bf16 v[108:111], v[24:27], v[76:79], v[108:111]
    v_mfma_f32_16x16x32_bf16 v[112:115], v[24:27], v[80:83], v[112:115]
    v_mfma_f32_16x16x32_bf16 v[116:119], v[24:27], v[84:87], v[116:119]
    v_mfma_f32_16x16x32_bf16 v[120:123], v[24:27], v[88:91], v[120:123]
    ds_read_b64_tr_b16 v[48:49], v18 offset:9472
    ds_read_b64_tr_b16 v[50:51], v18 offset:11776
    s_waitcnt lgkmcnt(10)
    v_mfma_f32_16x16x32_bf16 v[124:127], v[28:31], v[76:79], v[124:127]
    v_mfma_f32_16x16x32_bf16 v[128:131], v[28:31], v[80:83], v[128:131]
    v_mfma_f32_16x16x32_bf16 v[132:135], v[28:31], v[84:87], v[132:135]
    v_mfma_f32_16x16x32_bf16 v[136:139], v[28:31], v[88:91], v[136:139]
    s_waitcnt lgkmcnt(8)
    v_mfma_f32_16x16x32_bf16 v[140:143], v[32:35], v[76:79], v[140:143]
    v_mfma_f32_16x16x32_bf16 v[144:147], v[32:35], v[80:83], v[144:147]
    v_mfma_f32_16x16x32_bf16 v[148:151], v[32:35], v[84:87], v[148:151]
    v_mfma_f32_16x16x32_bf16 v[152:155], v[32:35], v[88:91], v[152:155]
    s_waitcnt lgkmcnt(6)
    v_mfma_f32_16x16x32_bf16 v[156:159], v[36:39], v[76:79], v[156:159]
    v_mfma_f32_16x16x32_bf16 v[160:163], v[36:39], v[80:83], v[160:163]
    v_mfma_f32_16x16x32_bf16 v[164:167], v[36:39], v[84:87], v[164:167]
    v_mfma_f32_16x16x32_bf16 v[168:171], v[36:39], v[88:91], v[168:171]
    s_waitcnt lgkmcnt(4)
    v_mfma_f32_16x16x32_bf16 v[172:175], v[40:43], v[76:79], v[172:175]
    v_mfma_f32_16x16x32_bf16 v[176:179], v[40:43], v[80:83], v[176:179]
    v_mfma_f32_16x16x32_bf16 v[180:183], v[40:43], v[84:87], v[180:183]
    v_mfma_f32_16x16x32_bf16 v[184:187], v[40:43], v[88:91], v[184:187]
    s_waitcnt lgkmcnt(2)
    v_mfma_f32_16x16x32_bf16 v[188:191], v[44:47], v[76:79], v[188:191]
    v_mfma_f32_16x16x32_bf16 v[192:195], v[44:47], v[80:83], v[192:195]
    v_mfma_f32_16x16x32_bf16 v[196:199], v[44:47], v[84:87], v[196:199]
    v_mfma_f32_16x16x32_bf16 v[200:203], v[44:47], v[88:91], v[200:203]
    s_waitcnt lgkmcnt(0)
    v_mfma_f32_16x16x32_bf16 v[204:207], v[48:51], v[76:79], v[204:207]
    v_mfma_f32_16x16x32_bf16 v[208:211], v[48:51], v[80:83], v[208:211]
    v_mfma_f32_16x16x32_bf16 v[212:215], v[48:51], v[84:87], v[212:215]
    v_mfma_f32_16x16x32_bf16 v[216:219], v[48:51], v[88:91], v[216:219]
    s_nop 7
    s_nop 3
    v_mul_f32 v92, s46, v92
    v_mul_f32 v93, s46, v93
    v_mul_f32 v94, s46, v94
    v_mul_f32 v95, s46, v95
    v_exp_f32 v92, v92
    v_exp_f32 v93, v93
    v_exp_f32 v94, v94
    v_exp_f32 v95, v95
    v_add_f32 v92, 1.0, v92
    v_add_f32 v93, 1.0, v93
    v_add_f32 v94, 1.0, v94
    v_add_f32 v95, 1.0, v95
    v_rcp_f32 v92, v92
    v_rcp_f32 v93, v93
    v_rcp_f32 v94, v94
    v_rcp_f32 v95, v95
    v_mul_f32 v92, v92, v108
    v_mul_f32 v93, v93, v109
    v_mul_f32 v94, v94, v110
    v_mul_f32 v95, v95, v111
    v_cvt_pk_bf16_f32 v20, v92, v93
    v_cvt_pk_bf16_f32 v21, v94, v95
    v_mul_f32 v96, s46, v96
    v_mul_f32 v97, s46, v97
    v_mul_f32 v98, s46, v98
    v_mul_f32 v99, s46, v99
    v_exp_f32 v96, v96
    v_exp_f32 v97, v97
    v_exp_f32 v98, v98
    v_exp_f32 v99, v99
    v_add_f32 v96, 1.0, v96
    v_add_f32 v97, 1.0, v97
    v_add_f32 v98, 1.0, v98
    v_add_f32 v99, 1.0, v99
    v_rcp_f32 v96, v96
    v_rcp_f32 v97, v97
    v_rcp_f32 v98, v98
    v_rcp_f32 v99, v99
    v_mul_f32 v96, v96, v112
    v_mul_f32 v97, v97, v113
    v_mul_f32 v98, v98, v114
    v_mul_f32 v99, v99, v115
    v_cvt_pk_bf16_f32 v22, v96, v97
    v_cvt_pk_bf16_f32 v23, v98, v99
    s_mov_b32 s33, 5120
    s_nop 0
    v_permlane16_swap_b32 v20, v22
    v_permlane16_swap_b32 v21, v23
    s_nop 0
    buffer_store_dwordx4 v[20:23], v7, s[24:27], s33 offen offset:0 sc0 sc1
    v_mul_f32 v124, s46, v124
    v_mul_f32 v125, s46, v125
    v_mul_f32 v126, s46, v126
    v_mul_f32 v127, s46, v127
    v_exp_f32 v124, v124
    v_exp_f32 v125, v125
    v_exp_f32 v126, v126
    v_exp_f32 v127, v127
    v_add_f32 v124, 1.0, v124
    v_add_f32 v125, 1.0, v125
    v_add_f32 v126, 1.0, v126
    v_add_f32 v127, 1.0, v127
    v_rcp_f32 v124, v124
    v_rcp_f32 v125, v125
    v_rcp_f32 v126, v126
    v_rcp_f32 v127, v127
    v_mul_f32 v124, v124, v140
    v_mul_f32 v125, v125, v141
    v_mul_f32 v126, v126, v142
    v_mul_f32 v127, v127, v143
    v_cvt_pk_bf16_f32 v24, v124, v125
    v_cvt_pk_bf16_f32 v25, v126, v127
    v_mul_f32 v128, s46, v128
    v_mul_f32 v129, s46, v129
    v_mul_f32 v130, s46, v130
    v_mul_f32 v131, s46, v131
    v_exp_f32 v128, v128
    v_exp_f32 v129, v129
    v_exp_f32 v130, v130
    v_exp_f32 v131, v131
    v_add_f32 v128, 1.0, v128
    v_add_f32 v129, 1.0, v129
    v_add_f32 v130, 1.0, v130
    v_add_f32 v131, 1.0, v131
    v_rcp_f32 v128, v128
    v_rcp_f32 v129, v129
    v_rcp_f32 v130, v130
    v_rcp_f32 v131, v131
    v_mul_f32 v128, v128, v144
    v_mul_f32 v129, v129, v145
    v_mul_f32 v130, v130, v146
    v_mul_f32 v131, v131, v147
    v_cvt_pk_bf16_f32 v26, v128, v129
    v_cvt_pk_bf16_f32 v27, v130, v131
    s_nop 0
    s_nop 0
    v_permlane16_swap_b32 v24, v26
    v_permlane16_swap_b32 v25, v27
    s_nop 0
    buffer_store_dwordx4 v[24:27], v7, s[24:27], s33 offen offset:1024 sc0 sc1
    v_mul_f32 v156, s46, v156
    v_mul_f32 v157, s46, v157
    v_mul_f32 v158, s46, v158
    v_mul_f32 v159, s46, v159
    v_exp_f32 v156, v156
    v_exp_f32 v157, v157
    v_exp_f32 v158, v158
    v_exp_f32 v159, v159
    v_add_f32 v156, 1.0, v156
    v_add_f32 v157, 1.0, v157
    v_add_f32 v158, 1.0, v158
    v_add_f32 v159, 1.0, v159
    v_rcp_f32 v156, v156
    v_rcp_f32 v157, v157
    v_rcp_f32 v158, v158
    v_rcp_f32 v159, v159
    v_mul_f32 v156, v156, v172
    v_mul_f32 v157, v157, v173
    v_mul_f32 v158, v158, v174
    v_mul_f32 v159, v159, v175
    v_cvt_pk_bf16_f32 v28, v156, v157
    v_cvt_pk_bf16_f32 v29, v158, v159
    v_mul_f32 v160, s46, v160
    v_mul_f32 v161, s46, v161
    v_mul_f32 v162, s46, v162
    v_mul_f32 v163, s46, v163
    v_exp_f32 v160, v160
    v_exp_f32 v161, v161
    v_exp_f32 v162, v162
    v_exp_f32 v163, v163
    v_add_f32 v160, 1.0, v160
    v_add_f32 v161, 1.0, v161
    v_add_f32 v162, 1.0, v162
    v_add_f32 v163, 1.0, v163
    v_rcp_f32 v160, v160
    v_rcp_f32 v161, v161
    v_rcp_f32 v162, v162
    v_rcp_f32 v163, v163
    v_mul_f32 v160, v160, v176
    v_mul_f32 v161, v161, v177
    v_mul_f32 v162, v162, v178
    v_mul_f32 v163, v163, v179
    v_cvt_pk_bf16_f32 v30, v160, v161
    v_cvt_pk_bf16_f32 v31, v162, v163
    s_nop 0
    s_nop 0
    v_permlane16_swap_b32 v28, v30
    v_permlane16_swap_b32 v29, v31
    s_nop 0
    buffer_store_dwordx4 v[28:31], v7, s[24:27], s33 offen offset:2048 sc0 sc1
    v_mul_f32 v188, s46, v188
    v_mul_f32 v189, s46, v189
    v_mul_f32 v190, s46, v190
    v_mul_f32 v191, s46, v191
    v_exp_f32 v188, v188
    v_exp_f32 v189, v189
    v_exp_f32 v190, v190
    v_exp_f32 v191, v191
    v_add_f32 v188, 1.0, v188
    v_add_f32 v189, 1.0, v189
    v_add_f32 v190, 1.0, v190
    v_add_f32 v191, 1.0, v191
    v_rcp_f32 v188, v188
    v_rcp_f32 v189, v189
    v_rcp_f32 v190, v190
    v_rcp_f32 v191, v191
    v_mul_f32 v188, v188, v204
    v_mul_f32 v189, v189, v205
    v_mul_f32 v190, v190, v206
    v_mul_f32 v191, v191, v207
    v_cvt_pk_bf16_f32 v32, v188, v189
    v_cvt_pk_bf16_f32 v33, v190, v191
    v_mul_f32 v192, s46, v192
    v_mul_f32 v193, s46, v193
    v_mul_f32 v194, s46, v194
    v_mul_f32 v195, s46, v195
    v_exp_f32 v192, v192
    v_exp_f32 v193, v193
    v_exp_f32 v194, v194
    v_exp_f32 v195, v195
    v_add_f32 v192, 1.0, v192
    v_add_f32 v193, 1.0, v193
    v_add_f32 v194, 1.0, v194
    v_add_f32 v195, 1.0, v195
    v_rcp_f32 v192, v192
    v_rcp_f32 v193, v193
    v_rcp_f32 v194, v194
    v_rcp_f32 v195, v195
    v_mul_f32 v192, v192, v208
    v_mul_f32 v193, v193, v209
    v_mul_f32 v194, v194, v210
    v_mul_f32 v195, v195, v211
    v_cvt_pk_bf16_f32 v34, v192, v193
    v_cvt_pk_bf16_f32 v35, v194, v195
    s_nop 0
    s_nop 0
    v_permlane16_swap_b32 v32, v34
    v_permlane16_swap_b32 v33, v35
    s_nop 0
    buffer_store_dwordx4 v[32:35], v7, s[24:27], s33 offen offset:3072 sc0 sc1
    v_mul_f32 v100, s46, v100
    v_mul_f32 v101, s46, v101
    v_mul_f32 v102, s46, v102
    v_mul_f32 v103, s46, v103
    v_exp_f32 v100, v100
    v_exp_f32 v101, v101
    v_exp_f32 v102, v102
    v_exp_f32 v103, v103
    v_add_f32 v100, 1.0, v100
    v_add_f32 v101, 1.0, v101
    v_add_f32 v102, 1.0, v102
    v_add_f32 v103, 1.0, v103
    v_rcp_f32 v100, v100
    v_rcp_f32 v101, v101
    v_rcp_f32 v102, v102
    v_rcp_f32 v103, v103
    v_mul_f32 v100, v100, v116
    v_mul_f32 v101, v101, v117
    v_mul_f32 v102, v102, v118
    v_mul_f32 v103, v103, v119
    v_cvt_pk_bf16_f32 v20, v100, v101
    v_cvt_pk_bf16_f32 v21, v102, v103
    v_mul_f32 v104, s46, v104
    v_mul_f32 v105, s46, v105
    v_mul_f32 v106, s46, v106
    v_mul_f32 v107, s46, v107
    v_exp_f32 v104, v104
    v_exp_f32 v105, v105
    v_exp_f32 v106, v106
    v_exp_f32 v107, v107
    v_add_f32 v104, 1.0, v104
    v_add_f32 v105, 1.0, v105
    v_add_f32 v106, 1.0, v106
    v_add_f32 v107, 1.0, v107
    v_rcp_f32 v104, v104
    v_rcp_f32 v105, v105
    v_rcp_f32 v106, v106
    v_rcp_f32 v107, v107
    v_mul_f32 v104, v104, v120
    v_mul_f32 v105, v105, v121
    v_mul_f32 v106, v106, v122
    v_mul_f32 v107, v107, v123
    v_cvt_pk_bf16_f32 v22, v104, v105
    v_cvt_pk_bf16_f32 v23, v106, v107
    s_mov_b32 s33, 300032
    s_nop 0
    v_permlane16_swap_b32 v20, v22
    v_permlane16_swap_b32 v21, v23
    s_nop 0
    buffer_store_dwordx4 v[20:23], v7, s[24:27], s33 offen offset:0 sc0 sc1
    v_mul_f32 v132, s46, v132
    v_mul_f32 v133, s46, v133
    v_mul_f32 v134, s46, v134
    v_mul_f32 v135, s46, v135
    v_exp_f32 v132, v132
    v_exp_f32 v133, v133
    v_exp_f32 v134, v134
    v_exp_f32 v135, v135
    v_add_f32 v132, 1.0, v132
    v_add_f32 v133, 1.0, v133
    v_add_f32 v134, 1.0, v134
    v_add_f32 v135, 1.0, v135
    v_rcp_f32 v132, v132
    v_rcp_f32 v133, v133
    v_rcp_f32 v134, v134
    v_rcp_f32 v135, v135
    v_mul_f32 v132, v132, v148
    v_mul_f32 v133, v133, v149
    v_mul_f32 v134, v134, v150
    v_mul_f32 v135, v135, v151
    v_cvt_pk_bf16_f32 v24, v132, v133
    v_cvt_pk_bf16_f32 v25, v134, v135
    v_mul_f32 v136, s46, v136
    v_mul_f32 v137, s46, v137
    v_mul_f32 v138, s46, v138
    v_mul_f32 v139, s46, v139
    v_exp_f32 v136, v136
    v_exp_f32 v137, v137
    v_exp_f32 v138, v138
    v_exp_f32 v139, v139
    v_add_f32 v136, 1.0, v136
    v_add_f32 v137, 1.0, v137
    v_add_f32 v138, 1.0, v138
    v_add_f32 v139, 1.0, v139
    v_rcp_f32 v136, v136
    v_rcp_f32 v137, v137
    v_rcp_f32 v138, v138
    v_rcp_f32 v139, v139
    v_mul_f32 v136, v136, v152
    v_mul_f32 v137, v137, v153
    v_mul_f32 v138, v138, v154
    v_mul_f32 v139, v139, v155
    v_cvt_pk_bf16_f32 v26, v136, v137
    v_cvt_pk_bf16_f32 v27, v138, v139
    s_nop 0
    s_nop 0
    v_permlane16_swap_b32 v24, v26
    v_permlane16_swap_b32 v25, v27
    s_nop 0
    buffer_store_dwordx4 v[24:27], v7, s[24:27], s33 offen offset:1024 sc0 sc1
    v_mul_f32 v164, s46, v164
    v_mul_f32 v165, s46, v165
    v_mul_f32 v166, s46, v166
    v_mul_f32 v167, s46, v167
    v_exp_f32 v164, v164
    v_exp_f32 v165, v165
    v_exp_f32 v166, v166
    v_exp_f32 v167, v167
    v_add_f32 v164, 1.0, v164
    v_add_f32 v165, 1.0, v165
    v_add_f32 v166, 1.0, v166
    v_add_f32 v167, 1.0, v167
    v_rcp_f32 v164, v164
    v_rcp_f32 v165, v165
    v_rcp_f32 v166, v166
    v_rcp_f32 v167, v167
    v_mul_f32 v164, v164, v180
    v_mul_f32 v165, v165, v181
    v_mul_f32 v166, v166, v182
    v_mul_f32 v167, v167, v183
    v_cvt_pk_bf16_f32 v28, v164, v165
    v_cvt_pk_bf16_f32 v29, v166, v167
    v_mul_f32 v168, s46, v168
    v_mul_f32 v169, s46, v169
    v_mul_f32 v170, s46, v170
    v_mul_f32 v171, s46, v171
    v_exp_f32 v168, v168
    v_exp_f32 v169, v169
    v_exp_f32 v170, v170
    v_exp_f32 v171, v171
    v_add_f32 v168, 1.0, v168
    v_add_f32 v169, 1.0, v169
    v_add_f32 v170, 1.0, v170
    v_add_f32 v171, 1.0, v171
    v_rcp_f32 v168, v168
    v_rcp_f32 v169, v169
    v_rcp_f32 v170, v170
    v_rcp_f32 v171, v171
    v_mul_f32 v168, v168, v184
    v_mul_f32 v169, v169, v185
    v_mul_f32 v170, v170, v186
    v_mul_f32 v171, v171, v187
    v_cvt_pk_bf16_f32 v30, v168, v169
    v_cvt_pk_bf16_f32 v31, v170, v171
    s_nop 0
    s_nop 0
    v_permlane16_swap_b32 v28, v30
    v_permlane16_swap_b32 v29, v31
    s_nop 0
    buffer_store_dwordx4 v[28:31], v7, s[24:27], s33 offen offset:2048 sc0 sc1
    v_mul_f32 v196, s46, v196
    v_mul_f32 v197, s46, v197
    v_mul_f32 v198, s46, v198
    v_mul_f32 v199, s46, v199
    v_exp_f32 v196, v196
    v_exp_f32 v197, v197
    v_exp_f32 v198, v198
    v_exp_f32 v199, v199
    v_add_f32 v196, 1.0, v196
    v_add_f32 v197, 1.0, v197
    v_add_f32 v198, 1.0, v198
    v_add_f32 v199, 1.0, v199
    v_rcp_f32 v196, v196
    v_rcp_f32 v197, v197
    v_rcp_f32 v198, v198
    v_rcp_f32 v199, v199
    v_mul_f32 v196, v196, v212
    v_mul_f32 v197, v197, v213
    v_mul_f32 v198, v198, v214
    v_mul_f32 v199, v199, v215
    v_cvt_pk_bf16_f32 v32, v196, v197
    v_cvt_pk_bf16_f32 v33, v198, v199
    v_mul_f32 v200, s46, v200
    v_mul_f32 v201, s46, v201
    v_mul_f32 v202, s46, v202
    v_mul_f32 v203, s46, v203
    v_exp_f32 v200, v200
    v_exp_f32 v201, v201
    v_exp_f32 v202, v202
    v_exp_f32 v203, v203
    v_add_f32 v200, 1.0, v200
    v_add_f32 v201, 1.0, v201
    v_add_f32 v202, 1.0, v202
    v_add_f32 v203, 1.0, v203
    v_rcp_f32 v200, v200
    v_rcp_f32 v201, v201
    v_rcp_f32 v202, v202
    v_rcp_f32 v203, v203
    v_mul_f32 v200, v200, v216
    v_mul_f32 v201, v201, v217
    v_mul_f32 v202, v202, v218
    v_mul_f32 v203, v203, v219
    v_cvt_pk_bf16_f32 v34, v200, v201
    v_cvt_pk_bf16_f32 v35, v202, v203
    s_nop 0
    s_nop 0
    v_permlane16_swap_b32 v32, v34
    v_permlane16_swap_b32 v33, v35
    s_nop 0
    buffer_store_dwordx4 v[32:35], v7, s[24:27], s33 offen offset:3072 sc0 sc1
LJ_rompt_kernel_52:
    s_lshl_b32 s44, s37, 5
    s_add_u32 s44, s44, s38
    s_waitcnt vmcnt(0)
    s_barrier
    s_cmp_lg_u32 s28, 0
    s_cbranch_scc1 LPB_rompt_kernel_56
    s_add_u32 s72, s4, 0x1201800
    s_addc_u32 s73, s5, 0
    s_mov_b32 s74, 0x800
    s_and_b32 s73, s73, 0xffff
    s_mov_b32 s75, 0x20000
    s_mov_b64 exec, 1
    s_lshl_b32 s46, s44, 2
    v_mov_b32 v2, s46
    v_mov_b32 v3, 1
    buffer_store_dword v3, v2, s[72:75], 0 offen sc0 sc1
    s_mov_b64 exec, -1
LPB_rompt_kernel_56:
    s_load_dwordx2 s[4:5], s[0:1], 88
    s_load_dwordx2 s[8:9], s[0:1], 64
    s_load_dwordx2 s[50:51], s[0:1], 72
    v_and_b32 v1, 63, v0
    v_lshrrev_b32 v2, 6, v0
    s_nop 0
    v_readfirstlane_b32 s28, v2
    s_and_b32 s34, s2, 7
    s_lshr_b32 s35, s2, 3
    s_and_b32 s36, s34, 3
    s_lshr_b32 s37, s34, 2
    s_lshl_b32 s37, s37, 3
    s_lshr_b32 s38, s35, 2
    s_add_u32 s37, s37, s38
    s_and_b32 s38, s35, 3
    s_lshl_b32 s29, s28, 10
    s_lshl_b32 s30, s28, 8
    v_lshrrev_b32 v2, 3, v1
    s_lshl_b32 s33, s28, 3
    v_add_u32 v2, s33, v2
    v_bfe_u32 v3, v2, 1, 3
    v_and_b32 v4, 7, v1
    v_xor_b32 v3, v3, v4
    s_lshr_b32 s44, s28, 2
    s_mul_i32 s44, s44, 294912
    s_and_b32 s45, s28, 3
    s_lshl_b32 s45, s45, 10
    s_add_u32 s44, s44, s45
    v_lshl_add_u32 v8, v1, 4, s44
    s_lshl_b32 s33, s28, 6
    s_add_u32 s33, s33, 0
    v_add_u32 v2, s33, v1
    v_mul_u32_u24 v3, 3641, v2
    v_lshrrev_b32 v3, 16, v3
    v_mul_u32_u24 v4, 18, v3
    v_sub_u32 v4, v2, v4
    v_and_b32 v5, 0x33, v3
    v_and_b32 v6, 4, v3
    v_lshl_or_b32 v5, v6, 1, v5
    v_and_b32 v6, 8, v3
    v_lshrrev_b32 v6, 1, v6
    v_or_b32 v5, v5, v6
    v_mul_u32_u24 v9, 1152, v5
    v_lshl_add_u32 v9, v4, 4, v9
    s_lshl_b32 s33, s28, 6
    s_add_u32 s33, s33, 512
    v_add_u32 v2, s33, v1
    v_mul_u32_u24 v3, 3641, v2
    v_lshrrev_b32 v3, 16, v3
    v_mul_u32_u24 v4, 18, v3
    v_sub_u32 v4, v2, v4
    v_and_b32 v5, 0x33, v3
    v_and_b32 v6, 4, v3
    v_lshl_or_b32 v5, v6, 1, v5
    v_and_b32 v6, 8, v3
    v_lshrrev_b32 v6, 1, v6
    v_or_b32 v5, v5, v6
    v_mul_u32_u24 v10, 1152, v5
    v_lshl_add_u32 v10, v4, 4, v10
    s_lshl_b32 s33, s28, 4
    s_add_u32 s33, s33, 1024
    v_add_u32 v2, s33, v1
    v_mul_u32_u24 v3, 3641, v2
    v_lshrrev_b32 v3, 16, v3
    v_mul_u32_u24 v4, 18, v3
    v_sub_u32 v4, v2, v4
    v_and_b32 v5, 0x33, v3
    v_and_b32 v6, 4, v3
    v_lshl_or_b32 v5, v6, 1, v5
    v_and_b32 v6, 8, v3
    v_lshrrev_b32 v6, 1, v6
    v_or_b32 v5, v5, v6
    v_mul_u32_u24 v11, 1152, v5
    v_lshl_add_u32 v11, v4, 4, v11
    s_mov_b32 s31, 0
    s_mov_b32 s32, 0
    s_waitcnt lgkmcnt(0)
    s_mul_i32 s44, s37, 1179648
    s_mul_i32 s45, s36, 73728
    s_add_u32 s44, s44, s45
    s_add_u32 s12, s4, 0x4400000
    s_addc_u32 s13, s5, 0
    s_add_u32 s12, s12, s44
    s_addc_u32 s13, s13, 0
    s_sub_u32 s14, 0x1200000, s44
    s_and_b32 s13, s13, 0xffff
    s_mov_b32 s15, 0x20000
    s_mul_i32 s44, s36, 1327104
    s_mul_i32 s45, s38, 288
    s_add_u32 s44, s44, s45
    s_add_u32 s16, s8, 0x0
    s_addc_u32 s17, s9, 0
    s_add_u32 s16, s16, s44
    s_addc_u32 s17, s17, 0
    s_sub_u32 s18, 0x510000, s44
    s_and_b32 s17, s17, 0xffff
    s_mov_b32 s19, 0x20000
    s_add_u32 m0, s29, 0x4000
    s_nop 0
    buffer_load_dwordx4 v9, s[16:19], s32 offen lds
    s_add_u32 m0, s29, 0x6000
    s_nop 0
    buffer_load_dwordx4 v10, s[16:19], s32 offen lds
    s_add_u32 m0, s30, 0x8000
    s_nop 0
    s_mov_b64 exec, 0xffff
    buffer_load_dwordx4 v11, s[16:19], s32 offen lds
    s_mov_b64 exec, -1
    s_add_u32 s32, s32, 0x12000
    s_add_u32 m0, s29, 0xc800
    s_nop 0
    buffer_load_dwordx4 v9, s[16:19], s32 offen lds
    s_add_u32 m0, s29, 0xe800
    s_nop 0
    buffer_load_dwordx4 v10, s[16:19], s32 offen lds
    s_add_u32 m0, s30, 0x10800
    s_nop 0
    s_mov_b64 exec, 0xffff
    buffer_load_dwordx4 v11, s[16:19], s32 offen lds
    s_mov_b64 exec, -1
    s_add_u32 s32, s32, 0x12000
    s_add_u32 m0, s29, 0x15000
    s_nop 0
    buffer_load_dwordx4 v9, s[16:19], s32 offen lds
    s_add_u32 m0, s29, 0x17000
    s_nop 0
    buffer_load_dwordx4 v10, s[16:19], s32 offen lds
    s_add_u32 m0, s30, 0x19000
    s_nop 0
    s_mov_b64 exec, 0xffff
    buffer_load_dwordx4 v11, s[16:19], s32 offen lds
    s_mov_b64 exec, -1
    s_add_u32 s32, s32, 0x12000
    s_add_u32 m0, s29, 0x1d800
    s_nop 0
    buffer_load_dwordx4 v9, s[16:19], s32 offen lds
    s_add_u32 m0, s29, 0x1f800
    s_nop 0
    buffer_load_dwordx4 v10, s[16:19], s32 offen lds
    s_add_u32 m0, s30, 0x21800
    s_nop 0
    s_mov_b64 exec, 0xffff
    buffer_load_dwordx4 v11, s[16:19], s32 offen lds
    s_mov_b64 exec, -1
    s_add_u32 s32, s32, 0x12000
    s_lshr_b32 s44, s37, 1
    s_lshl_b32 s44, s44, 5
    s_lshl_b32 s45, s36, 3
    s_add_u32 s44, s44, s45
    v_add_u32 v2, s44, v1
    s_cmp_lg_u32 s28, 0
    s_cbranch_scc1 LFS_rompt_kernel_57
    s_add_u32 s72, s4, 0x1201800
    s_addc_u32 s73, s5, 0
    s_mov_b32 s74, 0x800
    s_and_b32 s73, s73, 0xffff
    s_mov_b32 s75, 0x20000
    v_lshlrev_b32 v2, 2, v2
    s_mov_b64 exec, 0xff
    s_mov_b32 s45, 0
LFW_rompt_kernel_58:
    buffer_load_dword v3, v2, s[72:75], 0 offen sc0 sc1
    s_waitcnt vmcnt(0)
    v_cmp_ne_u32 vcc, 1, v3
    s_nop 3
    s_cmp_eq_u64 vcc, 0
    s_cbranch_scc1 LFD_rompt_kernel_59
    s_add_u32 s45, s45, 1
    s_cmp_lt_u32 s45, 0x100000
    s_cbranch_scc1 LFW_rompt_kernel_58
LFD_rompt_kernel_59:
    s_mov_b64 exec, -1
LFS_rompt_kernel_57:
    s_barrier
    s_add_u32 m0, s29, 0x0
    s_nop 0
    buffer_load_dwordx4 v8, s[12:15], s31 offen lds
    s_add_u32 m0, s29, 0x2000
    s_add_u32 s33, s31, 0x90000
    buffer_load_dwordx4 v8, s[12:15], s33 offen lds
    s_add_u32 s31, s31, 4096
    s_add_u32 m0, s29, 0x8800
    s_nop 0
    buffer_load_dwordx4 v8, s[12:15], s31 offen lds
    s_add_u32 m0, s29, 0xa800
    s_add_u32 s33, s31, 0x90000
    buffer_load_dwordx4 v8, s[12:15], s33 offen lds
    s_add_u32 s31, s31, 4096
    s_add_u32 m0, s29, 0x11000
    s_nop 0
    buffer_load_dwordx4 v8, s[12:15], s31 offen lds
    s_add_u32 m0, s29, 0x13000
    s_add_u32 s33, s31, 0x90000
    buffer_load_dwordx4 v8, s[12:15], s33 offen lds
    s_add_u32 s31, s31, 4096
    s_add_u32 m0, s29, 0x19800
    s_nop 0
    buffer_load_dwordx4 v8, s[12:15], s31 offen lds
    s_add_u32 m0, s29, 0x1b800
    s_add_u32 s33, s31, 0x90000
    buffer_load_dwordx4 v8, s[12:15], s33 offen lds
    s_add_u32 s31, s31, 4096
    s_and_b32 s33, s28, 3
    s_mul_i32 s33, s33, 4096
    v_and_b32 v2, 15, v1
    v_lshrrev_b32 v3, 4, v1
    v_bfe_u32 v4, v1, 1, 3
    v_xor_b32 v4, v3, v4
    v_lshlrev_b32 v4, 4, v4
    v_lshl_add_u32 v4, v2, 7, v4
    v_add_u32 v5, s33, v4
    v_lshlrev_b32 v5, 9, v3
    v_lshl_add_u32 v5, v2, 4, v5
    v_add_u32 v5, s33, v5
    v_add_u32 v12, 0x0, v5
    v_add_u32 v13, 2048, v12
    v_add_u32 v15, 0x8800, v5
    v_add_u32 v16, 2048, v15
    v_add_u32 v18, 0x11000, v5
    v_add_u32 v19, 2048, v18
    v_add_u32 v21, 0x19800, v5
    v_add_u32 v22, 2048, v21
    v_lshrrev_b32 v4, 5, v1
    v_lshlrev_b32 v4, 4, v4
    v_bfe_u32 v5, v1, 4, 1
    v_lshl_add_u32 v4, v5, 2, v4
    v_bfe_u32 v5, v1, 2, 2
    v_add_u32 v4, v4, v5
    v_mul_u32_u24 v4, 288, v4
    v_and_b32 v5, 3, v1
    v_lshl_add_u32 v4, v5, 3, v4
    v_add_u32 v14, 0x4000, v4
    v_add_u32 v17, 0xc800, v4
    v_add_u32 v20, 0x15000, v4
    v_add_u32 v23, 0x1d800, v4
    s_and_b32 s33, s28, 3
    s_mul_i32 s33, s33, 32
    v_and_b32 v5, 15, v1
    v_add_u32 v5, s33, v5
    v_lshrrev_b32 v6, 4, v1
    v_mul_u32_u24 v5, 288, v5
    v_and_b32 v2, 1, v6
    v_lshl_add_u32 v7, v2, 5, v5
    v_lshrrev_b32 v2, 1, v6
    v_lshl_add_u32 v7, v2, 4, v7
    v_lshl_add_u32 v6, v6, 3, v5
    s_lshl_b32 s44, s36, 4
    s_add_u32 s44, s44, s37
    s_lshl_b32 s44, s44, 2
    s_and_b32 s46, s28, 3
    s_add_u32 s44, s44, s46
    s_mul_i32 s44, s44, 36864
    s_mul_i32 s46, s38, 9216
    s_add_u32 s44, s44, s46
    s_add_u32 s24, s4, 0x1400000
    s_addc_u32 s25, s5, 0
    s_add_u32 s24, s24, s44
    s_addc_u32 s25, s25, 0
    s_sub_u32 s26, 0x900000, s44
    s_and_b32 s25, s25, 0xffff
    s_mov_b32 s27, 0x20000
    v_lshlrev_b32 v7, 4, v1
    s_waitcnt vmcnt(6)
    s_barrier
    s_cmp_ge_u32 s28, 4
    s_cbranch_scc1 LG_rompt_kernel_61
    ds_read_b128 v[68:71], v12 offset:0
    ds_read_b128 v[72:75], v12 offset:256
    ds_read_b64_tr_b16 v[28:29], v14 offset:0
    ds_read_b64_tr_b16 v[30:31], v14 offset:2304
    ds_read_b64_tr_b16 v[32:33], v14 offset:32
    ds_read_b64_tr_b16 v[34:35], v14 offset:2336
    ds_read_b64_tr_b16 v[36:37], v14 offset:64
    ds_read_b64_tr_b16 v[38:39], v14 offset:2368
    ds_read_b64_tr_b16 v[40:41], v14 offset:96
    ds_read_b64_tr_b16 v[42:43], v14 offset:2400
    ds_read_b64_tr_b16 v[44:45], v14 offset:128
    ds_read_b64_tr_b16 v[46:47], v14 offset:2432
    ds_read_b128 v[76:79], v13 offset:0
    ds_read_b128 v[80:83], v13 offset:256
    ds_read_b64_tr_b16 v[48:49], v14 offset:9216
    s_waitcnt lgkmcnt(13)
    ds_read_b64_tr_b16 v[50:51], v14 offset:11520
    ds_read_b64_tr_b16 v[52:53], v14 offset:9248
    s_waitcnt lgkmcnt(13)
    ds_read_b64_tr_b16 v[54:55], v14 offset:11552
    ds_read_b64_tr_b16 v[56:57], v14 offset:9280
    s_waitcnt lgkmcnt(13)
    ds_read_b64_tr_b16 v[58:59], v14 offset:11584
    v_mfma_f32_16x16x32_bf16 v[100:103], v[28:31], v[68:71], 0
    v_mfma_f32_16x16x32_bf16 v[104:107], v[28:31], v[72:75], 0
    ds_read_b64_tr_b16 v[60:61], v14 offset:9312
    s_waitcnt lgkmcnt(13)
    ds_read_b64_tr_b16 v[62:63], v14 offset:11616
    v_mfma_f32_16x16x32_bf16 v[108:111], v[32:35], v[68:71], 0
    v_mfma_f32_16x16x32_bf16 v[112:115], v[32:35], v[72:75], 0
    ds_read_b64_tr_b16 v[64:65], v14 offset:9344
    s_waitcnt lgkmcnt(13)
    ds_read_b64_tr_b16 v[66:67], v14 offset:11648
    v_mfma_f32_16x16x32_bf16 v[116:119], v[36:39], v[68:71], 0
    v_mfma_f32_16x16x32_bf16 v[120:123], v[36:39], v[72:75], 0
    s_waitcnt vmcnt(4) lgkmcnt(0)
    s_barrier
    ds_read_b128 v[84:87], v15 offset:0
    ds_read_b128 v[88:91], v15 offset:256
    ds_read_b64_tr_b16 v[28:29], v17 offset:0
    ds_read_b64_tr_b16 v[30:31], v17 offset:2304
    s_add_u32 m0, s29, 0x0
    s_nop 0
    buffer_load_dwordx4 v8, s[12:15], s31 offen lds
    v_mfma_f32_16x16x32_bf16 v[124:127], v[40:43], v[68:71], 0
    v_mfma_f32_16x16x32_bf16 v[128:131], v[40:43], v[72:75], 0
    ds_read_b64_tr_b16 v[32:33], v17 offset:32
    ds_read_b64_tr_b16 v[34:35], v17 offset:2336
    ds_read_b128 v[92:95], v16 offset:0
    s_add_u32 m0, s29, 0x2000
    s_add_u32 s33, s31, 0x90000
    buffer_load_dwordx4 v8, s[12:15], s33 offen lds
    s_add_u32 s31, s31, 4096
    v_mfma_f32_16x16x32_bf16 v[132:135], v[44:47], v[68:71], 0
    v_mfma_f32_16x16x32_bf16 v[136:139], v[44:47], v[72:75], 0
    ds_read_b64_tr_b16 v[36:37], v17 offset:64
    ds_read_b64_tr_b16 v[38:39], v17 offset:2368
    ds_read_b128 v[96:99], v16 offset:256
    s_add_u32 m0, s29, 0x4000
    s_nop 0
    buffer_load_dwordx4 v9, s[16:19], s32 offen lds
    v_mfma_f32_16x16x32_bf16 v[100:103], v[48:51], v[76:79], v[100:103]
    v_mfma_f32_16x16x32_bf16 v[104:107], v[48:51], v[80:83], v[104:107]
    ds_read_b64_tr_b16 v[40:41], v17 offset:96
    ds_read_b64_tr_b16 v[42:43], v17 offset:2400
    s_add_u32 m0, s29, 0x6000
    s_nop 0
    buffer_load_dwordx4 v10, s[16:19], s32 offen lds
    v_mfma_f32_16x16x32_bf16 v[108:111], v[52:55], v[76:79], v[108:111]
    v_mfma_f32_16x16x32_bf16 v[112:115], v[52:55], v[80:83], v[112:115]
    ds_read_b64_tr_b16 v[44:45], v17 offset:128
    ds_read_b64_tr_b16 v[46:47], v17 offset:2432
    s_add_u32 m0, s30, 0x8000
    s_nop 0
    s_mov_b64 exec, 0xffff
    buffer_load_dwordx4 v11, s[16:19], s32 offen lds
    s_mov_b64 exec, -1
    s_add_u32 s32, s32, 0x12000
    v_mfma_f32_16x16x32_bf16 v[116:119], v[56:59], v[76:79], v[116:119]
    v_mfma_f32_16x16x32_bf16 v[120:123], v[56:59], v[80:83], v[120:123]
    ds_read_b64_tr_b16 v[48:49], v17 offset:9216
    s_waitcnt lgkmcnt(13)
    ds_read_b64_tr_b16 v[50:51], v17 offset:11520
    v_mfma_f32_16x16x32_bf16 v[124:127], v[60:63], v[76:79], v[124:127]
    v_mfma_f32_16x16x32_bf16 v[128:131], v[60:63], v[80:83], v[128:131]
    ds_read_b64_tr_b16 v[52:53], v17 offset:9248
    s_waitcnt lgkmcnt(13)
    ds_read_b64_tr_b16 v[54:55], v17 offset:11552
    v_mfma_f32_16x16x32_bf16 v[132:135], v[64:67], v[76:79], v[132:135]
    v_mfma_f32_16x16x32_bf16 v[136:139], v[64:67], v[80:83], v[136:139]
    ds_read_b64_tr_b16 v[56:57], v17 offset:9280
    s_waitcnt lgkmcnt(13)
    ds_read_b64_tr_b16 v[58:59], v17 offset:11584
    v_mfma_f32_16x16x32_bf16 v[100:103], v[28:31], v[84:87], v[100:103]
    v_mfma_f32_16x16x32_bf16 v[104:107], v[28:31], v[88:91], v[104:107]
    ds_read_b64_tr_b16 v[60:61], v17 offset:9312
    s_waitcnt lgkmcnt(13)
    ds_read_b64_tr_b16 v[62:63], v17 offset:11616
    v_mfma_f32_16x16x32_bf16 v[108:111], v[32:35], v[84:87], v[108:111]
    v_mfma_f32_16x16x32_bf16 v[112:115], v[32:35], v[88:91], v[112:115]
    ds_read_b64_tr_b16 v[64:65], v17 offset:9344
    s_waitcnt lgkmcnt(13)
    ds_read_b64_tr_b16 v[66:67], v17 offset:11648
    v_mfma_f32_16x16x32_bf16 v[116:119], v[36:39], v[84:87], v[116:119]
    v_mfma_f32_16x16x32_bf16 v[120:123], v[36:39], v[88:91], v[120:123]
    s_waitcnt vmcnt(7) lgkmcnt(0)
    s_barrier
    ds_read_b128 v[68:71], v18 offset:0
    ds_read_b128 v[72:75], v18 offset:256
    ds_read_b64_tr_b16 v[28:29], v20 offset:0
    ds_read_b64_tr_b16 v[30:31], v20 offset:2304
    s_add_u32 m0, s29, 0x8800
    s_nop 0
    buffer_load_dwordx4 v8, s[12:15], s31 offen lds
    v_mfma_f32_16x16x32_bf16 v[124:127], v[40:43], v[84:87], v[124:127]
    v_mfma_f32_16x16x32_bf16 v[128:131], v[40:43], v[88:91], v[128:131]
    ds_read_b64_tr_b16 v[32:33], v20 offset:32
    ds_read_b64_tr_b16 v[34:35], v20 offset:2336
    ds_read_b128 v[76:79], v19 offset:0
    s_add_u32 m0, s29, 0xa800
    s_add_u32 s33, s31, 0x90000
    buffer_load_dwordx4 v8, s[12:15], s33 offen lds
    s_add_u32 s31, s31, 4096
    v_mfma_f32_16x16x32_bf16 v[132:135], v[44:47], v[84:87], v[132:135]
    v_mfma_f32_16x16x32_bf16 v[136:139], v[44:47], v[88:91], v[136:139]
    ds_read_b64_tr_b16 v[36:37], v20 offset:64
    ds_read_b64_tr_b16 v[38:39], v20 offset:2368
    ds_read_b128 v[80:83], v19 offset:256
    s_add_u32 m0, s29, 0xc800
    s_nop 0
    buffer_load_dwordx4 v9, s[16:19], s32 offen lds
    v_mfma_f32_16x16x32_bf16 v[100:103], v[48:51], v[92:95], v[100:103]
    v_mfma_f32_16x16x32_bf16 v[104:107], v[48:51], v[96:99], v[104:107]
    ds_read_b64_tr_b16 v[40:41], v20 offset:96
    ds_read_b64_tr_b16 v[42:43], v20 offset:2400
    s_add_u32 m0, s29, 0xe800
    s_nop 0
    buffer_load_dwordx4 v10, s[16:19], s32 offen lds
    v_mfma_f32_16x16x32_bf16 v[108:111], v[52:55], v[92:95], v[108:111]
    v_mfma_f32_16x16x32_bf16 v[112:115], v[52:55], v[96:99], v[112:115]
    ds_read_b64_tr_b16 v[44:45], v20 offset:128
    ds_read_b64_tr_b16 v[46:47], v20 offset:2432
    s_add_u32 m0, s30, 0x10800
    s_nop 0
    s_mov_b64 exec, 0xffff
    buffer_load_dwordx4 v11, s[16:19], s32 offen lds
    s_mov_b64 exec, -1
    s_add_u32 s32, s32, 0x12000
    v_mfma_f32_16x16x32_bf16 v[116:119], v[56:59], v[92:95], v[116:119]
    v_mfma_f32_16x16x32_bf16 v[120:123], v[56:59], v[96:99], v[120:123]
    ds_read_b64_tr_b16 v[48:49], v20 offset:9216
    s_waitcnt lgkmcnt(13)
    ds_read_b64_tr_b16 v[50:51], v20 offset:11520
    v_mfma_f32_16x16x32_bf16 v[124:127], v[60:63], v[92:95], v[124:127]
    v_mfma_f32_16x16x32_bf16 v[128:131], v[60:63], v[96:99], v[128:131]
    ds_read_b64_tr_b16 v[52:53], v20 offset:9248
    s_waitcnt lgkmcnt(13)
    ds_read_b64_tr_b16 v[54:55], v20 offset:11552
    v_mfma_f32_16x16x32_bf16 v[132:135], v[64:67], v[92:95], v[132:135]
    v_mfma_f32_16x16x32_bf16 v[136:139], v[64:67], v[96:99], v[136:139]
    ds_read_b64_tr_b16 v[56:57], v20 offset:9280
    s_waitcnt lgkmcnt(13)
    ds_read_b64_tr_b16 v[58:59], v20 offset:11584
    s_mov_b32 s40, 3
LP_rompt_kernel_62:
    v_mfma_f32_16x16x32_bf16 v[100:103], v[28:31], v[68:71], v[100:103]
    v_mfma_f32_16x16x32_bf16 v[104:107], v[28:31], v[72:75], v[104:107]
    ds_read_b64_tr_b16 v[60:61], v20 offset:9312
    s_waitcnt lgkmcnt(13)
    ds_read_b64_tr_b16 v[62:63], v20 offset:11616
    v_mfma_f32_16x16x32_bf16 v[108:111], v[32:35], v[68:71], v[108:111]
    v_mfma_f32_16x16x32_bf16 v[112:115], v[32:35], v[72:75], v[112:115]
    ds_read_b64_tr_b16 v[64:65], v20 offset:9344
    s_waitcnt lgkmcnt(13)
    ds_read_b64_tr_b16 v[66:67], v20 offset:11648
    v_mfma_f32_16x16x32_bf16 v[116:119], v[36:39], v[68:71], v[116:119]
    v_mfma_f32_16x16x32_bf16 v[120:123], v[36:39], v[72:75], v[120:123]
    s_waitcnt vmcnt(10) lgkmcnt(0)
    s_barrier
    ds_read_b128 v[84:87], v21 offset:0
    ds_read_b128 v[88:91], v21 offset:256
    ds_read_b64_tr_b16 v[28:29], v23 offset:0
    ds_read_b64_tr_b16 v[30:31], v23 offset:2304
    s_add_u32 m0, s29, 0x11000
    s_nop 0
    buffer_load_dwordx4 v8, s[12:15], s31 offen lds
    v_mfma_f32_16x16x32_bf16 v[124:127], v[40:43], v[68:71], v[124:127]
    v_mfma_f32_16x16x32_bf16 v[128:131], v[40:43], v[72:75], v[128:131]
    ds_read_b64_tr_b16 v[32:33], v23 offset:32
    ds_read_b64_tr_b16 v[34:35], v23 offset:2336
    ds_read_b128 v[92:95], v22 offset:0
    s_add_u32 m0, s29, 0x13000
    s_add_u32 s33, s31, 0x90000
    buffer_load_dwordx4 v8, s[12:15], s33 offen lds
    s_add_u32 s31, s31, 4096
    v_mfma_f32_16x16x32_bf16 v[132:135], v[44:47], v[68:71], v[132:135]
    v_mfma_f32_16x16x32_bf16 v[136:139], v[44:47], v[72:75], v[136:139]
    ds_read_b64_tr_b16 v[36:37], v23 offset:64
    ds_read_b64_tr_b16 v[38:39], v23 offset:2368
    ds_read_b128 v[96:99], v22 offset:256
    s_add_u32 m0, s29, 0x15000
    s_nop 0
    buffer_load_dwordx4 v9, s[16:19], s32 offen lds
    v_mfma_f32_16x16x32_bf16 v[100:103], v[48:51], v[76:79], v[100:103]
    v_mfma_f32_16x16x32_bf16 v[104:107], v[48:51], v[80:83], v[104:107]
    ds_read_b64_tr_b16 v[40:41], v23 offset:96
    ds_read_b64_tr_b16 v[42:43], v23 offset:2400
    s_add_u32 m0, s29, 0x17000
    s_nop 0
    buffer_load_dwordx4 v10, s[16:19], s32 offen lds
    v_mfma_f32_16x16x32_bf16 v[108:111], v[52:55], v[76:79], v[108:111]
    v_mfma_f32_16x16x32_bf16 v[112:115], v[52:55], v[80:83], v[112:115]
    ds_read_b64_tr_b16 v[44:45], v23 offset:128
    ds_read_b64_tr_b16 v[46:47], v23 offset:2432
    s_add_u32 m0, s30, 0x19000
    s_nop 0
    s_mov_b64 exec, 0xffff
    buffer_load_dwordx4 v11, s[16:19], s32 offen lds
    s_mov_b64 exec, -1
    s_add_u32 s32, s32, 0x12000
    v_mfma_f32_16x16x32_bf16 v[116:119], v[56:59], v[76:79], v[116:119]
    v_mfma_f32_16x16x32_bf16 v[120:123], v[56:59], v[80:83], v[120:123]
    ds_read_b64_tr_b16 v[48:49], v23 offset:9216
    s_waitcnt lgkmcnt(13)
    ds_read_b64_tr_b16 v[50:51], v23 offset:11520
    v_mfma_f32_16x16x32_bf16 v[124:127], v[60:63], v[76:79], v[124:127]
    v_mfma_f32_16x16x32_bf16 v[128:131], v[60:63], v[80:83], v[128:131]
    ds_read_b64_tr_b16 v[52:53], v23 offset:9248
    s_waitcnt lgkmcnt(13)
    ds_read_b64_tr_b16 v[54:55], v23 offset:11552
    v_mfma_f32_16x16x32_bf16 v[132:135], v[64:67], v[76:79], v[132:135]
    v_mfma_f32_16x16x32_bf16 v[136:139], v[64:67], v[80:83], v[136:139]
    ds_read_b64_tr_b16 v[56:57], v23 offset:9280
    s_waitcnt lgkmcnt(13)
    ds_read_b64_tr_b16 v[58:59], v23 offset:11584
    v_mfma_f32_16x16x32_bf16 v[100:103], v[28:31], v[84:87], v[100:103]
    v_mfma_f32_16x16x32_bf16 v[104:107], v[28:31], v[88:91], v[104:107]
    ds_read_b64_tr_b16 v[60:61], v23 offset:9312
    s_waitcnt lgkmcnt(13)
    ds_read_b64_tr_b16 v[62:63], v23 offset:11616
    v_mfma_f32_16x16x32_bf16 v[108:111], v[32:35], v[84:87], v[108:111]
    v_mfma_f32_16x16x32_bf16 v[112:115], v[32:35], v[88:91], v[112:115]
    ds_read_b64_tr_b16 v[64:65], v23 offset:9344
    s_waitcnt lgkmcnt(13)
    ds_read_b64_tr_b16 v[66:67], v23 offset:11648
    v_mfma_f32_16x16x32_bf16 v[116:119], v[36:39], v[84:87], v[116:119]
    v_mfma_f32_16x16x32_bf16 v[120:123], v[36:39], v[88:91], v[120:123]
    s_waitcnt vmcnt(10) lgkmcnt(0)
    s_barrier
    ds_read_b128 v[68:71], v12 offset:0
    ds_read_b128 v[72:75], v12 offset:256
    ds_read_b64_tr_b16 v[28:29], v14 offset:0
    ds_read_b64_tr_b16 v[30:31], v14 offset:2304
    s_add_u32 m0, s29, 0x19800
    s_nop 0
    buffer_load_dwordx4 v8, s[12:15], s31 offen lds
    v_mfma_f32_16x16x32_bf16 v[124:127], v[40:43], v[84:87], v[124:127]
    v_mfma_f32_16x16x32_bf16 v[128:131], v[40:43], v[88:91], v[128:131]
    ds_read_b64_tr_b16 v[32:33], v14 offset:32
    ds_read_b64_tr_b16 v[34:35], v14 offset:2336
    ds_read_b128 v[76:79], v13 offset:0
    s_add_u32 m0, s29, 0x1b800
    s_add_u32 s33, s31, 0x90000
    buffer_load_dwordx4 v8, s[12:15], s33 offen lds
    s_add_u32 s31, s31, 4096
    v_mfma_f32_16x16x32_bf16 v[132:135], v[44:47], v[84:87], v[132:135]
    v_mfma_f32_16x16x32_bf16 v[136:139], v[44:47], v[88:91], v[136:139]
    ds_read_b64_tr_b16 v[36:37], v14 offset:64
    ds_read_b64_tr_b16 v[38:39], v14 offset:2368
    ds_read_b128 v[80:83], v13 offset:256
    s_add_u32 m0, s29, 0x1d800
    s_nop 0
    buffer_load_dwordx4 v9, s[16:19], s32 offen lds
    v_mfma_f32_16x16x32_bf16 v[100:103], v[48:51], v[92:95], v[100:103]
    v_mfma_f32_16x16x32_bf16 v[104:107], v[48:51], v[96:99], v[104:107]
    ds_read_b64_tr_b16 v[40:41], v14 offset:96
    ds_read_b64_tr_b16 v[42:43], v14 offset:2400
    s_add_u32 m0, s29, 0x1f800
    s_nop 0
    buffer_load_dwordx4 v10, s[16:19], s32 offen lds
    v_mfma_f32_16x16x32_bf16 v[108:111], v[52:55], v[92:95], v[108:111]
    v_mfma_f32_16x16x32_bf16 v[112:115], v[52:55], v[96:99], v[112:115]
    ds_read_b64_tr_b16 v[44:45], v14 offset:128
    ds_read_b64_tr_b16 v[46:47], v14 offset:2432
    s_add_u32 m0, s30, 0x21800
    s_nop 0
    s_mov_b64 exec, 0xffff
    buffer_load_dwordx4 v11, s[16:19], s32 offen lds
    s_mov_b64 exec, -1
    s_add_u32 s32, s32, 0x12000
    v_mfma_f32_16x16x32_bf16 v[116:119], v[56:59], v[92:95], v[116:119]
    v_mfma_f32_16x16x32_bf16 v[120:123], v[56:59], v[96:99], v[120:123]
    ds_read_b64_tr_b16 v[48:49], v14 offset:9216
    s_waitcnt lgkmcnt(13)
    ds_read_b64_tr_b16 v[50:51], v14 offset:11520
    v_mfma_f32_16x16x32_bf16 v[124:127], v[60:63], v[92:95], v[124:127]
    v_mfma_f32_16x16x32_bf16 v[128:131], v[60:63], v[96:99], v[128:131]
    ds_read_b64_tr_b16 v[52:53], v14 offset:9248
    s_waitcnt lgkmcnt(13)
    ds_read_b64_tr_b16 v[54:55], v14 offset:11552
    v_mfma_f32_16x16x32_bf16 v[132:135], v[64:67], v[92:95], v[132:135]
    v_mfma_f32_16x16x32_bf16 v[136:139], v[64:67], v[96:99], v[136:139]
    ds_read_b64_tr_b16 v[56:57], v14 offset:9280
    s_waitcnt lgkmcnt(13)
    ds_read_b64_tr_b16 v[58:59], v14 offset:11584
    v_mfma_f32_16x16x32_bf16 v[100:103], v[28:31], v[68:71], v[100:103]
    v_mfma_f32_16x16x32_bf16 v[104:107], v[28:31], v[72:75], v[104:107]
    ds_read_b64_tr_b16 v[60:61], v14 offset:9312
    s_waitcnt lgkmcnt(13)
    ds_read_b64_tr_b16 v[62:63], v14 offset:11616
    v_mfma_f32_16x16x32_bf16 v[108:111], v[32:35], v[68:71], v[108:111]
    v_mfma_f32_16x16x32_bf16 v[112:115], v[32:35], v[72:75], v[112:115]
    ds_read_b64_tr_b16 v[64:65], v14 offset:9344
    s_waitcnt lgkmcnt(13)
    ds_read_b64_tr_b16 v[66:67], v14 offset:11648
    v_mfma_f32_16x16x32_bf16 v[116:119], v[36:39], v[68:71], v[116:119]
    v_mfma_f32_16x16x32_bf16 v[120:123], v[36:39], v[72:75], v[120:123]
    s_waitcnt vmcnt(10) lgkmcnt(0)
    s_barrier
    ds_read_b128 v[84:87], v15 offset:0
    ds_read_b128 v[88:91], v15 offset:256
    ds_read_b64_tr_b16 v[28:29], v17 offset:0
    ds_read_b64_tr_b16 v[30:31], v17 offset:2304
    s_add_u32 m0, s29, 0x0
    s_nop 0
    buffer_load_dwordx4 v8, s[12:15], s31 offen lds
    v_mfma_f32_16x16x32_bf16 v[124:127], v[40:43], v[68:71], v[124:127]
    v_mfma_f32_16x16x32_bf16 v[128:131], v[40:43], v[72:75], v[128:131]
    ds_read_b64_tr_b16 v[32:33], v17 offset:32
    ds_read_b64_tr_b16 v[34:35], v17 offset:2336
    ds_read_b128 v[92:95], v16 offset:0
    s_add_u32 m0, s29, 0x2000
    s_add_u32 s33, s31, 0x90000
    buffer_load_dwordx4 v8, s[12:15], s33 offen lds
    s_add_u32 s31, s31, 4096
    v_mfma_f32_16x16x32_bf16 v[132:135], v[44:47], v[68:71], v[132:135]
    v_mfma_f32_16x16x32_bf16 v[136:139], v[44:47], v[72:75], v[136:139]
    ds_read_b64_tr_b16 v[36:37], v17 offset:64
    ds_read_b64_tr_b16 v[38:39], v17 offset:2368
    ds_read_b128 v[96:99], v16 offset:256
    s_add_u32 m0, s29, 0x4000
    s_nop 0
    buffer_load_dwordx4 v9, s[16:19], s32 offen lds
    v_mfma_f32_16x16x32_bf16 v[100:103], v[48:51], v[76:79], v[100:103]
    v_mfma_f32_16x16x32_bf16 v[104:107], v[48:51], v[80:83], v[104:107]
    ds_read_b64_tr_b16 v[40:41], v17 offset:96
    ds_read_b64_tr_b16 v[42:43], v17 offset:2400
    s_add_u32 m0, s29, 0x6000
    s_nop 0
    buffer_load_dwordx4 v10, s[16:19], s32 offen lds
    v_mfma_f32_16x16x32_bf16 v[108:111], v[52:55], v[76:79], v[108:111]
    v_mfma_f32_16x16x32_bf16 v[112:115], v[52:55], v[80:83], v[112:115]
    ds_read_b64_tr_b16 v[44:45], v17 offset:128
    ds_read_b64_tr_b16 v[46:47], v17 offset:2432
    s_add_u32 m0, s30, 0x8000
    s_nop 0
    s_mov_b64 exec, 0xffff
    buffer_load_dwordx4 v11, s[16:19], s32 offen lds
    s_mov_b64 exec, -1
    s_add_u32 s32, s32, 0x12000
    v_mfma_f32_16x16x32_bf16 v[116:119], v[56:59], v[76:79], v[116:119]
    v_mfma_f32_16x16x32_bf16 v[120:123], v[56:59], v[80:83], v[120:123]
    ds_read_b64_tr_b16 v[48:49], v17 offset:9216
    s_waitcnt lgkmcnt(13)
    ds_read_b64_tr_b16 v[50:51], v17 offset:11520
    v_mfma_f32_16x16x32_bf16 v[124:127], v[60:63], v[76:79], v[124:127]
    v_mfma_f32_16x16x32_bf16 v[128:131], v[60:63], v[80:83], v[128:131]
    ds_read_b64_tr_b16 v[52:53], v17 offset:9248
    s_waitcnt lgkmcnt(13)
    ds_read_b64_tr_b16 v[54:55], v17 offset:11552
    v_mfma_f32_16x16x32_bf16 v[132:135], v[64:67], v[76:79], v[132:135]
    v_mfma_f32_16x16x32_bf16 v[136:139], v[64:67], v[80:83], v[136:139]
    ds_read_b64_tr_b16 v[56:57], v17 offset:9280
    s_waitcnt lgkmcnt(13)
    ds_read_b64_tr_b16 v[58:59], v17 offset:11584
    v_mfma_f32_16x16x32_bf16 v[100:103], v[28:31], v[84:87], v[100:103]
    v_mfma_f32_16x16x32_bf16 v[104:107], v[28:31], v[88:91], v[104:107]
    ds_read_b64_tr_b16 v[60:61], v17 offset:9312
    s_waitcnt lgkmcnt(13)
    ds_read_b64_tr_b16 v[62:63], v17 offset:11616
    v_mfma_f32_16x16x32_bf16 v[108:111], v[32:35], v[84:87], v[108:111]
    v_mfma_f32_16x16x32_bf16 v[112:115], v[32:35], v[88:91], v[112:115]
    ds_read_b64_tr_b16 v[64:65], v17 offset:9344
    s_waitcnt lgkmcnt(13)
    ds_read_b64_tr_b16 v[66:67], v17 offset:11648
    v_mfma_f32_16x16x32_bf16 v[116:119], v[36:39], v[84:87], v[116:119]
    v_mfma_f32_16x16x32_bf16 v[120:123], v[36:39], v[88:91], v[120:123]
    s_waitcnt vmcnt(10) lgkmcnt(0)
    s_barrier
    ds_read_b128 v[68:71], v18 offset:0
    ds_read_b128 v[72:75], v18 offset:256
    ds_read_b64_tr_b16 v[28:29], v20 offset:0
    ds_read_b64_tr_b16 v[30:31], v20 offset:2304
    s_add_u32 m0, s29, 0x8800
    s_nop 0
    buffer_load_dwordx4 v8, s[12:15], s31 offen lds
    v_mfma_f32_16x16x32_bf16 v[124:127], v[40:43], v[84:87], v[124:127]
    v_mfma_f32_16x16x32_bf16 v[128:131], v[40:43], v[88:91], v[128:131]
    ds_read_b64_tr_b16 v[32:33], v20 offset:32
    ds_read_b64_tr_b16 v[34:35], v20 offset:2336
    ds_read_b128 v[76:79], v19 offset:0
    s_add_u32 m0, s29, 0xa800
    s_add_u32 s33, s31, 0x90000
    buffer_load_dwordx4 v8, s[12:15], s33 offen lds
    s_add_u32 s31, s31, 4096
    v_mfma_f32_16x16x32_bf16 v[132:135], v[44:47], v[84:87], v[132:135]
    v_mfma_f32_16x16x32_bf16 v[136:139], v[44:47], v[88:91], v[136:139]
    ds_read_b64_tr_b16 v[36:37], v20 offset:64
    ds_read_b64_tr_b16 v[38:39], v20 offset:2368
    ds_read_b128 v[80:83], v19 offset:256
    s_add_u32 m0, s29, 0xc800
    s_nop 0
    buffer_load_dwordx4 v9, s[16:19], s32 offen lds
    v_mfma_f32_16x16x32_bf16 v[100:103], v[48:51], v[92:95], v[100:103]
    v_mfma_f32_16x16x32_bf16 v[104:107], v[48:51], v[96:99], v[104:107]
    ds_read_b64_tr_b16 v[40:41], v20 offset:96
    ds_read_b64_tr_b16 v[42:43], v20 offset:2400
    s_add_u32 m0, s29, 0xe800
    s_nop 0
    buffer_load_dwordx4 v10, s[16:19], s32 offen lds
    v_mfma_f32_16x16x32_bf16 v[108:111], v[52:55], v[92:95], v[108:111]
    v_mfma_f32_16x16x32_bf16 v[112:115], v[52:55], v[96:99], v[112:115]
    ds_read_b64_tr_b16 v[44:45], v20 offset:128
    ds_read_b64_tr_b16 v[46:47], v20 offset:2432
    s_add_u32 m0, s30, 0x10800
    s_nop 0
    s_mov_b64 exec, 0xffff
    buffer_load_dwordx4 v11, s[16:19], s32 offen lds
    s_mov_b64 exec, -1
    s_add_u32 s32, s32, 0x12000
    v_mfma_f32_16x16x32_bf16 v[116:119], v[56:59], v[92:95], v[116:119]
    v_mfma_f32_16x16x32_bf16 v[120:123], v[56:59], v[96:99], v[120:123]
    ds_read_b64_tr_b16 v[48:49], v20 offset:9216
    s_waitcnt lgkmcnt(13)
    ds_read_b64_tr_b16 v[50:51], v20 offset:11520
    v_mfma_f32_16x16x32_bf16 v[124:127], v[60:63], v[92:95], v[124:127]
    v_mfma_f32_16x16x32_bf16 v[128:131], v[60:63], v[96:99], v[128:131]
    ds_read_b64_tr_b16 v[52:53], v20 offset:9248
    s_waitcnt lgkmcnt(13)
    ds_read_b64_tr_b16 v[54:55], v20 offset:11552
    v_mfma_f32_16x16x32_bf16 v[132:135], v[64:67], v[92:95], v[132:135]
    v_mfma_f32_16x16x32_bf16 v[136:139], v[64:67], v[96:99], v[136:139]
    ds_read_b64_tr_b16 v[56:57], v20 offset:9280
    s_waitcnt lgkmcnt(13)
    ds_read_b64_tr_b16 v[58:59], v20 offset:11584
    s_sub_u32 s40, s40, 1
    s_cmp_lg_u32 s40, 0
    s_cbranch_scc1 LP_rompt_kernel_62
    v_mfma_f32_16x16x32_bf16 v[100:103], v[28:31], v[68:71], v[100:103]
    v_mfma_f32_16x16x32_bf16 v[104:107], v[28:31], v[72:75], v[104:107]
    ds_read_b64_tr_b16 v[60:61], v20 offset:9312
    s_waitcnt lgkmcnt(13)
    ds_read_b64_tr_b16 v[62:63], v20 offset:11616
    v_mfma_f32_16x16x32_bf16 v[108:111], v[32:35], v[68:71], v[108:111]
    v_mfma_f32_16x16x32_bf16 v[112:115], v[32:35], v[72:75], v[112:115]
    ds_read_b64_tr_b16 v[64:65], v20 offset:9344
    s_waitcnt lgkmcnt(13)
    ds_read_b64_tr_b16 v[66:67], v20 offset:11648
    v_mfma_f32_16x16x32_bf16 v[116:119], v[36:39], v[68:71], v[116:119]
    v_mfma_f32_16x16x32_bf16 v[120:123], v[36:39], v[72:75], v[120:123]
    s_waitcnt vmcnt(10) lgkmcnt(0)
    s_barrier
    ds_read_b128 v[84:87], v21 offset:0
    ds_read_b128 v[88:91], v21 offset:256
    ds_read_b64_tr_b16 v[28:29], v23 offset:0
    ds_read_b64_tr_b16 v[30:31], v23 offset:2304
    v_mfma_f32_16x16x32_bf16 v[124:127], v[40:43], v[68:71], v[124:127]
    v_mfma_f32_16x16x32_bf16 v[128:131], v[40:43], v[72:75], v[128:131]
    ds_read_b64_tr_b16 v[32:33], v23 offset:32
    ds_read_b64_tr_b16 v[34:35], v23 offset:2336
    ds_read_b128 v[92:95], v22 offset:0
    v_mfma_f32_16x16x32_bf16 v[132:135], v[44:47], v[68:71], v[132:135]
    v_mfma_f32_16x16x32_bf16 v[136:139], v[44:47], v[72:75], v[136:139]
    ds_read_b64_tr_b16 v[36:37], v23 offset:64
    ds_read_b64_tr_b16 v[38:39], v23 offset:2368
    ds_read_b128 v[96:99], v22 offset:256
    v_mfma_f32_16x16x32_bf16 v[100:103], v[48:51], v[76:79], v[100:103]
    v_mfma_f32_16x16x32_bf16 v[104:107], v[48:51], v[80:83], v[104:107]
    ds_read_b64_tr_b16 v[40:41], v23 offset:96
    ds_read_b64_tr_b16 v[42:43], v23 offset:2400
    v_mfma_f32_16x16x32_bf16 v[108:111], v[52:55], v[76:79], v[108:111]
    v_mfma_f32_16x16x32_bf16 v[112:115], v[52:55], v[80:83], v[112:115]
    ds_read_b64_tr_b16 v[44:45], v23 offset:128
    ds_read_b64_tr_b16 v[46:47], v23 offset:2432
    v_mfma_f32_16x16x32_bf16 v[116:119], v[56:59], v[76:79], v[116:119]
    v_mfma_f32_16x16x32_bf16 v[120:123], v[56:59], v[80:83], v[120:123]
    ds_read_b64_tr_b16 v[48:49], v23 offset:9216
    s_waitcnt lgkmcnt(13)
    ds_read_b64_tr_b16 v[50:51], v23 offset:11520
    v_mfma_f32_16x16x32_bf16 v[124:127], v[60:63], v[76:79], v[124:127]
    v_mfma_f32_16x16x32_bf16 v[128:131], v[60:63], v[80:83], v[128:131]
    ds_read_b64_tr_b16 v[52:53], v23 offset:9248
    s_waitcnt lgkmcnt(13)
    ds_read_b64_tr_b16 v[54:55], v23 offset:11552
    v_mfma_f32_16x16x32_bf16 v[132:135], v[64:67], v[76:79], v[132:135]
    v_mfma_f32_16x16x32_bf16 v[136:139], v[64:67], v[80:83], v[136:139]
    ds_read_b64_tr_b16 v[56:57], v23 offset:9280
    s_waitcnt lgkmcnt(13)
    ds_read_b64_tr_b16 v[58:59], v23 offset:11584
    v_mfma_f32_16x16x32_bf16 v[100:103], v[28:31], v[84:87], v[100:103]
    v_mfma_f32_16x16x32_bf16 v[104:107], v[28:31], v[88:91], v[104:107]
    ds_read_b64_tr_b16 v[60:61], v23 offset:9312
    s_waitcnt lgkmcnt(13)
    ds_read_b64_tr_b16 v[62:63], v23 offset:11616
    v_mfma_f32_16x16x32_bf16 v[108:111], v[32:35], v[84:87], v[108:111]
    v_mfma_f32_16x16x32_bf16 v[112:115], v[32:35], v[88:91], v[112:115]
    ds_read_b64_tr_b16 v[64:65], v23 offset:9344
    s_waitcnt lgkmcnt(13)
    ds_read_b64_tr_b16 v[66:67], v23 offset:11648
    v_mfma_f32_16x16x32_bf16 v[116:119], v[36:39], v[84:87], v[116:119]
    v_mfma_f32_16x16x32_bf16 v[120:123], v[36:39], v[88:91], v[120:123]
    s_waitcnt vmcnt(5) lgkmcnt(0)
    s_barrier
    ds_read_b128 v[68:71], v12 offset:0
    ds_read_b128 v[72:75], v12 offset:256
    ds_read_b64_tr_b16 v[28:29], v14 offset:0
    ds_read_b64_tr_b16 v[30:31], v14 offset:2304
    v_mfma_f32_16x16x32_bf16 v[124:127], v[40:43], v[84:87], v[124:127]
    v_mfma_f32_16x16x32_bf16 v[128:131], v[40:43], v[88:91], v[128:131]
    ds_read_b64_tr_b16 v[32:33], v14 offset:32
    ds_read_b64_tr_b16 v[34:35], v14 offset:2336
    ds_read_b128 v[76:79], v13 offset:0
    v_mfma_f32_16x16x32_bf16 v[132:135], v[44:47], v[84:87], v[132:135]
    v_mfma_f32_16x16x32_bf16 v[136:139], v[44:47], v[88:91], v[136:139]
    ds_read_b64_tr_b16 v[36:37], v14 offset:64
    ds_read_b64_tr_b16 v[38:39], v14 offset:2368
    ds_read_b128 v[80:83], v13 offset:256
    v_mfma_f32_16x16x32_bf16 v[100:103], v[48:51], v[92:95], v[100:103]
    v_mfma_f32_16x16x32_bf16 v[104:107], v[48:51], v[96:99], v[104:107]
    ds_read_b64_tr_b16 v[40:41], v14 offset:96
    ds_read_b64_tr_b16 v[42:43], v14 offset:2400
    v_mfma_f32_16x16x32_bf16 v[108:111], v[52:55], v[92:95], v[108:111]
    v_mfma_f32_16x16x32_bf16 v[112:115], v[52:55], v[96:99], v[112:115]
    ds_read_b64_tr_b16 v[44:45], v14 offset:128
    ds_read_b64_tr_b16 v[46:47], v14 offset:2432
    v_mfma_f32_16x16x32_bf16 v[116:119], v[56:59], v[92:95], v[116:119]
    v_mfma_f32_16x16x32_bf16 v[120:123], v[56:59], v[96:99], v[120:123]
    ds_read_b64_tr_b16 v[48:49], v14 offset:9216
    s_waitcnt lgkmcnt(13)
    ds_read_b64_tr_b16 v[50:51], v14 offset:11520
    v_mfma_f32_16x16x32_bf16 v[124:127], v[60:63], v[92:95], v[124:127]
    v_mfma_f32_16x16x32_bf16 v[128:131], v[60:63], v[96:99], v[128:131]
    ds_read_b64_tr_b16 v[52:53], v14 offset:9248
    s_waitcnt lgkmcnt(13)
    ds_read_b64_tr_b16 v[54:55], v14 offset:11552
    v_mfma_f32_16x16x32_bf16 v[132:135], v[64:67], v[92:95], v[132:135]
    v_mfma_f32_16x16x32_bf16 v[136:139], v[64:67], v[96:99], v[136:139]
    ds_read_b64_tr_b16 v[56:57], v14 offset:9280
    s_waitcnt lgkmcnt(13)
    ds_read_b64_tr_b16 v[58:59], v14 offset:11584
    v_mfma_f32_16x16x32_bf16 v[100:103], v[28:31], v[68:71], v[100:103]
    v_mfma_f32_16x16x32_bf16 v[104:107], v[28:31], v[72:75], v[104:107]
    ds_read_b64_tr_b16 v[60:61], v14 offset:9312
    s_waitcnt lgkmcnt(13)
    ds_read_b64_tr_b16 v[62:63], v14 offset:11616
    v_mfma_f32_16x16x32_bf16 v[108:111], v[32:35], v[68:71], v[108:111]
    v_mfma_f32_16x16x32_bf16 v[112:115], v[32:35], v[72:75], v[112:115]
    ds_read_b64_tr_b16 v[64:65], v14 offset:9344
    s_waitcnt lgkmcnt(13)
    ds_read_b64_tr_b16 v[66:67], v14 offset:11648
    v_mfma_f32_16x16x32_bf16 v[116:119], v[36:39], v[68:71], v[116:119]
    v_mfma_f32_16x16x32_bf16 v[120:123], v[36:39], v[72:75], v[120:123]
    s_waitcnt vmcnt(0) lgkmcnt(0)
    s_barrier
    ds_read_b128 v[84:87], v15 offset:0
    ds_read_b128 v[88:91], v15 offset:256
    ds_read_b64_tr_b16 v[28:29], v17 offset:0
    ds_read_b64_tr_b16 v[30:31], v17 offset:2304
    v_mfma_f32_16x16x32_bf16 v[124:127], v[40:43], v[68:71], v[124:127]
    v_mfma_f32_16x16x32_bf16 v[128:131], v[40:43], v[72:75], v[128:131]
    ds_read_b64_tr_b16 v[32:33], v17 offset:32
    ds_read_b64_tr_b16 v[34:35], v17 offset:2336
    ds_read_b128 v[92:95], v16 offset:0
    v_mfma_f32_16x16x32_bf16 v[132:135], v[44:47], v[68:71], v[132:135]
    v_mfma_f32_16x16x32_bf16 v[136:139], v[44:47], v[72:75], v[136:139]
    ds_read_b64_tr_b16 v[36:37], v17 offset:64
    ds_read_b64_tr_b16 v[38:39], v17 offset:2368
    ds_read_b128 v[96:99], v16 offset:256
    v_mfma_f32_16x16x32_bf16 v[100:103], v[48:51], v[76:79], v[100:103]
    v_mfma_f32_16x16x32_bf16 v[104:107], v[48:51], v[80:83], v[104:107]
    ds_read_b64_tr_b16 v[40:41], v17 offset:96
    ds_read_b64_tr_b16 v[42:43], v17 offset:2400
    v_mfma_f32_16x16x32_bf16 v[108:111], v[52:55], v[76:79], v[108:111]
    v_mfma_f32_16x16x32_bf16 v[112:115], v[52:55], v[80:83], v[112:115]
    ds_read_b64_tr_b16 v[44:45], v17 offset:128
    ds_read_b64_tr_b16 v[46:47], v17 offset:2432
    v_mfma_f32_16x16x32_bf16 v[116:119], v[56:59], v[76:79], v[116:119]
    v_mfma_f32_16x16x32_bf16 v[120:123], v[56:59], v[80:83], v[120:123]
    ds_read_b64_tr_b16 v[48:49], v17 offset:9216
    s_waitcnt lgkmcnt(13)
    ds_read_b64_tr_b16 v[50:51], v17 offset:11520
    v_mfma_f32_16x16x32_bf16 v[124:127], v[60:63], v[76:79], v[124:127]
    v_mfma_f32_16x16x32_bf16 v[128:131], v[60:63], v[80:83], v[128:131]
    ds_read_b64_tr_b16 v[52:53], v17 offset:9248
    s_waitcnt lgkmcnt(13)
    ds_read_b64_tr_b16 v[54:55], v17 offset:11552
    v_mfma_f32_16x16x32_bf16 v[132:135], v[64:67], v[76:79], v[132:135]
    v_mfma_f32_16x16x32_bf16 v[136:139], v[64:67], v[80:83], v[136:139]
    ds_read_b64_tr_b16 v[56:57], v17 offset:9280
    s_waitcnt lgkmcnt(13)
    ds_read_b64_tr_b16 v[58:59], v17 offset:11584
    v_mfma_f32_16x16x32_bf16 v[100:103], v[28:31], v[84:87], v[100:103]
    v_mfma_f32_16x16x32_bf16 v[104:107], v[28:31], v[88:91], v[104:107]
    ds_read_b64_tr_b16 v[60:61], v17 offset:9312
    s_waitcnt lgkmcnt(13)
    ds_read_b64_tr_b16 v[62:63], v17 offset:11616
    v_mfma_f32_16x16x32_bf16 v[108:111], v[32:35], v[84:87], v[108:111]
    v_mfma_f32_16x16x32_bf16 v[112:115], v[32:35], v[88:91], v[112:115]
    ds_read_b64_tr_b16 v[64:65], v17 offset:9344
    s_waitcnt lgkmcnt(13)
    ds_read_b64_tr_b16 v[66:67], v17 offset:11648
    v_mfma_f32_16x16x32_bf16 v[116:119], v[36:39], v[84:87], v[116:119]
    v_mfma_f32_16x16x32_bf16 v[120:123], v[36:39], v[88:91], v[120:123]
    s_waitcnt lgkmcnt(12)
    v_mfma_f32_16x16x32_bf16 v[124:127], v[40:43], v[84:87], v[124:127]
    v_mfma_f32_16x16x32_bf16 v[128:131], v[40:43], v[88:91], v[128:131]
    s_waitcnt lgkmcnt(10)
    v_mfma_f32_16x16x32_bf16 v[132:135], v[44:47], v[84:87], v[132:135]
    v_mfma_f32_16x16x32_bf16 v[136:139], v[44:47], v[88:91], v[136:139]
    s_waitcnt lgkmcnt(8)
    v_mfma_f32_16x16x32_bf16 v[100:103], v[48:51], v[92:95], v[100:103]
    v_mfma_f32_16x16x32_bf16 v[104:107], v[48:51], v[96:99], v[104:107]
    s_waitcnt lgkmcnt(6)
    v_mfma_f32_16x16x32_bf16 v[108:111], v[52:55], v[92:95], v[108:111]
    v_mfma_f32_16x16x32_bf16 v[112:115], v[52:55], v[96:99], v[112:115]
    s_waitcnt lgkmcnt(4)
    v_mfma_f32_16x16x32_bf16 v[116:119], v[56:59], v[92:95], v[116:119]
    v_mfma_f32_16x16x32_bf16 v[120:123], v[56:59], v[96:99], v[120:123]
    s_waitcnt lgkmcnt(2)
    v_mfma_f32_16x16x32_bf16 v[124:127], v[60:63], v[92:95], v[124:127]
    v_mfma_f32_16x16x32_bf16 v[128:131], v[60:63], v[96:99], v[128:131]
    s_waitcnt lgkmcnt(0)
    v_mfma_f32_16x16x32_bf16 v[132:135], v[64:67], v[92:95], v[132:135]
    v_mfma_f32_16x16x32_bf16 v[136:139], v[64:67], v[96:99], v[136:139]
    s_nop 7
    s_nop 3
    v_add_u32 v100, 0x10000, v100
    v_and_b32 v100, 0xfffe0000, v100
    v_cvt_pk_bf16_f32 v28, v100, v101
    v_cvt_pk_bf16_f32 v29, v102, v103
    v_and_b32 v28, -2, v28
    v_add_u32 v104, 0x10000, v104
    v_and_b32 v104, 0xfffe0000, v104
    v_cvt_pk_bf16_f32 v30, v104, v105
    v_cvt_pk_bf16_f32 v31, v106, v107
    v_and_b32 v30, -2, v30
    s_mov_b32 s33, 0
    s_nop 0
    v_permlane16_swap_b32 v28, v30
    v_permlane16_swap_b32 v29, v31
    s_nop 0
    buffer_store_dwordx4 v[28:31], v7, s[24:27], s33 offen offset:0 sc0 sc1
    v_add_u32 v108, 0x10000, v108
    v_and_b32 v108, 0xfffe0000, v108
    v_cvt_pk_bf16_f32 v32, v108, v109
    v_cvt_pk_bf16_f32 v33, v110, v111
    v_and_b32 v32, -2, v32
    v_add_u32 v112, 0x10000, v112
    v_and_b32 v112, 0xfffe0000, v112
    v_cvt_pk_bf16_f32 v34, v112, v113
    v_cvt_pk_bf16_f32 v35, v114, v115
    v_and_b32 v34, -2, v34
    s_nop 0
    s_nop 0
    v_permlane16_swap_b32 v32, v34
    v_permlane16_swap_b32 v33, v35
    s_nop 0
    buffer_store_dwordx4 v[32:35], v7, s[24:27], s33 offen offset:1024 sc0 sc1
    v_add_u32 v116, 0x10000, v116
    v_and_b32 v116, 0xfffe0000, v116
    v_cvt_pk_bf16_f32 v36, v116, v117
    v_cvt_pk_bf16_f32 v37, v118, v119
    v_and_b32 v36, -2, v36
    v_add_u32 v120, 0x10000, v120
    v_and_b32 v120, 0xfffe0000, v120
    v_cvt_pk_bf16_f32 v38, v120, v121
    v_cvt_pk_bf16_f32 v39, v122, v123
    v_and_b32 v38, -2, v38
    s_nop 0
    s_nop 0
    v_permlane16_swap_b32 v36, v38
    v_permlane16_swap_b32 v37, v39
    s_nop 0
    buffer_store_dwordx4 v[36:39], v7, s[24:27], s33 offen offset:2048 sc0 sc1
    v_add_u32 v124, 0x10000, v124
    v_and_b32 v124, 0xfffe0000, v124
    v_cvt_pk_bf16_f32 v40, v124, v125
    v_cvt_pk_bf16_f32 v41, v126, v127
    v_and_b32 v40, -2, v40
    v_add_u32 v128, 0x10000, v128
    v_and_b32 v128, 0xfffe0000, v128
    v_cvt_pk_bf16_f32 v42, v128, v129
    v_cvt_pk_bf16_f32 v43, v130, v131
    v_and_b32 v42, -2, v42
    s_nop 0
    s_nop 0
    v_permlane16_swap_b32 v40, v42
    v_permlane16_swap_b32 v41, v43
    s_nop 0
    buffer_store_dwordx4 v[40:43], v7, s[24:27], s33 offen offset:3072 sc0 sc1
    v_add_u32 v132, 0x10000, v132
    v_and_b32 v132, 0xfffe0000, v132
    v_cvt_pk_bf16_f32 v28, v132, v133
    v_cvt_pk_bf16_f32 v29, v134, v135
    v_and_b32 v28, -2, v28
    v_add_u32 v136, 0x10000, v136
    v_and_b32 v136, 0xfffe0000, v136
    v_cvt_pk_bf16_f32 v30, v136, v137
    v_cvt_pk_bf16_f32 v31, v138, v139
    v_and_b32 v30, -2, v30
    s_mov_b32 s33, 4096
    s_nop 0
    v_permlane16_swap_b32 v28, v30
    v_permlane16_swap_b32 v29, v31
    s_nop 0
    buffer_store_dwordx4 v[28:31], v7, s[24:27], s33 offen offset:0 sc0 sc1
    s_branch LJ_rompt_kernel_60
LG_rompt_kernel_61:
    ds_read_b128 v[68:71], v12 offset:0
    ds_read_b128 v[72:75], v12 offset:256
    ds_read_b64_tr_b16 v[28:29], v14 offset:160
    ds_read_b64_tr_b16 v[30:31], v14 offset:2464
    ds_read_b64_tr_b16 v[32:33], v14 offset:192
    ds_read_b64_tr_b16 v[34:35], v14 offset:2496
    ds_read_b64_tr_b16 v[36:37], v14 offset:224
    ds_read_b64_tr_b16 v[38:39], v14 offset:2528
    ds_read_b64_tr_b16 v[40:41], v14 offset:256
    ds_read_b64_tr_b16 v[42:43], v14 offset:2560
    ds_read_b128 v[76:79], v13 offset:0
    ds_read_b128 v[80:83], v13 offset:256
    ds_read_b64_tr_b16 v[44:45], v14 offset:9376
    ds_read_b64_tr_b16 v[46:47], v14 offset:11680
    ds_read_b64_tr_b16 v[48:49], v14 offset:9408
    s_waitcnt lgkmcnt(13)
    ds_read_b64_tr_b16 v[50:51], v14 offset:11712
    s_waitcnt lgkmcnt(12)
    v_mfma_f32_16x16x32_bf16 v[100:103], v[28:31], v[68:71], 0
    v_mfma_f32_16x16x32_bf16 v[104:107], v[28:31], v[72:75], 0
    ds_read_b64_tr_b16 v[52:53], v14 offset:9440
    ds_read_b64_tr_b16 v[54:55], v14 offset:11744
    s_waitcnt lgkmcnt(12)
    v_mfma_f32_16x16x32_bf16 v[108:111], v[32:35], v[68:71], 0
    v_mfma_f32_16x16x32_bf16 v[112:115], v[32:35], v[72:75], 0
    ds_read_b64_tr_b16 v[56:57], v14 offset:9472
    ds_read_b64_tr_b16 v[58:59], v14 offset:11776
    s_waitcnt lgkmcnt(12)
    v_mfma_f32_16x16x32_bf16 v[116:119], v[36:39], v[68:71], 0
    v_mfma_f32_16x16x32_bf16 v[120:123], v[36:39], v[72:75], 0
    s_waitcnt vmcnt(4) lgkmcnt(0)
    s_barrier
    ds_read_b128 v[84:87], v15 offset:0
    ds_read_b128 v[88:91], v15 offset:256
    ds_read_b64_tr_b16 v[28:29], v17 offset:160
    ds_read_b64_tr_b16 v[30:31], v17 offset:2464
    s_add_u32 m0, s29, 0x0
    s_nop 0
    buffer_load_dwordx4 v8, s[12:15], s31 offen lds
    v_mfma_f32_16x16x32_bf16 v[124:127], v[40:43], v[68:71], 0
    v_mfma_f32_16x16x32_bf16 v[128:131], v[40:43], v[72:75], 0
    ds_read_b64_tr_b16 v[32:33], v17 offset:192
    ds_read_b64_tr_b16 v[34:35], v17 offset:2496
    ds_read_b128 v[92:95], v16 offset:0
    s_add_u32 m0, s29, 0x2000
    s_add_u32 s33, s31, 0x90000
    buffer_load_dwordx4 v8, s[12:15], s33 offen lds
    s_add_u32 s31, s31, 4096
    v_mfma_f32_16x16x32_bf16 v[100:103], v[44:47], v[76:79], v[100:103]
    v_mfma_f32_16x16x32_bf16 v[104:107], v[44:47], v[80:83], v[104:107]
    ds_read_b64_tr_b16 v[36:37], v17 offset:224
    ds_read_b64_tr_b16 v[38:39], v17 offset:2528
    ds_read_b128 v[96:99], v16 offset:256
    s_add_u32 m0, s29, 0x4000
    s_nop 0
    buffer_load_dwordx4 v9, s[16:19], s32 offen lds
    v_mfma_f32_16x16x32_bf16 v[108:111], v[48:51], v[76:79], v[108:111]
    v_mfma_f32_16x16x32_bf16 v[112:115], v[48:51], v[80:83], v[112:115]
    ds_read_b64_tr_b16 v[40:41], v17 offset:256
    ds_read_b64_tr_b16 v[42:43], v17 offset:2560
    s_add_u32 m0, s29, 0x6000
    s_nop 0
    buffer_load_dwordx4 v10, s[16:19], s32 offen lds
    v_mfma_f32_16x16x32_bf16 v[116:119], v[52:55], v[76:79], v[116:119]
    v_mfma_f32_16x16x32_bf16 v[120:123], v[52:55], v[80:83], v[120:123]
    ds_read_b64_tr_b16 v[44:45], v17 offset:9376
    ds_read_b64_tr_b16 v[46:47], v17 offset:11680
    s_add_u32 m0, s30, 0x8000
    s_nop 0
    s_mov_b64 exec, 0xffff
    buffer_load_dwordx4 v11, s[16:19], s32 offen lds
    s_mov_b64 exec, -1
    s_add_u32 s32, s32, 0x12000
    v_mfma_f32_16x16x32_bf16 v[124:127], v[56:59], v[76:79], v[124:127]
    v_mfma_f32_16x16x32_bf16 v[128:131], v[56:59], v[80:83], v[128:131]
    ds_read_b64_tr_b16 v[48:49], v17 offset:9408
    s_waitcnt lgkmcnt(13)
    ds_read_b64_tr_b16 v[50:51], v17 offset:11712
    s_waitcnt lgkmcnt(12)
    v_mfma_f32_16x16x32_bf16 v[100:103], v[28:31], v[84:87], v[100:103]
    v_mfma_f32_16x16x32_bf16 v[104:107], v[28:31], v[88:91], v[104:107]
    ds_read_b64_tr_b16 v[52:53], v17 offset:9440
    ds_read_b64_tr_b16 v[54:55], v17 offset:11744
    s_waitcnt lgkmcnt(12)
    v_mfma_f32_16x16x32_bf16 v[108:111], v[32:35], v[84:87], v[108:111]
    v_mfma_f32_16x16x32_bf16 v[112:115], v[32:35], v[88:91], v[112:115]
    ds_read_b64_tr_b16 v[56:57], v17 offset:9472
    ds_read_b64_tr_b16 v[58:59], v17 offset:11776
    s_waitcnt lgkmcnt(11)
    v_mfma_f32_16x16x32_bf16 v[116:119], v[36:39], v[84:87], v[116:119]
    v_mfma_f32_16x16x32_bf16 v[120:123], v[36:39], v[88:91], v[120:123]
    s_waitcnt vmcnt(7) lgkmcnt(0)
    s_barrier
    ds_read_b128 v[68:71], v18 offset:0
    ds_read_b128 v[72:75], v18 offset:256
    ds_read_b64_tr_b16 v[28:29], v20 offset:160
    ds_read_b64_tr_b16 v[30:31], v20 offset:2464
    s_add_u32 m0, s29, 0x8800
    s_nop 0
    buffer_load_dwordx4 v8, s[12:15], s31 offen lds
    v_mfma_f32_16x16x32_bf16 v[124:127], v[40:43], v[84:87], v[124:127]
    v_mfma_f32_16x16x32_bf16 v[128:131], v[40:43], v[88:91], v[128:131]
    ds_read_b64_tr_b16 v[32:33], v20 offset:192
    ds_read_b64_tr_b16 v[34:35], v20 offset:2496
    ds_read_b128 v[76:79], v19 offset:0
    s_add_u32 m0, s29, 0xa800
    s_add_u32 s33, s31, 0x90000
    buffer_load_dwordx4 v8, s[12:15], s33 offen lds
    s_add_u32 s31, s31, 4096
    v_mfma_f32_16x16x32_bf16 v[100:103], v[44:47], v[92:95], v[100:103]
    v_mfma_f32_16x16x32_bf16 v[104:107], v[44:47], v[96:99], v[104:107]
    ds_read_b64_tr_b16 v[36:37], v20 offset:224
    ds_read_b64_tr_b16 v[38:39], v20 offset:2528
    ds_read_b128 v[80:83], v19 offset:256
    s_add_u32 m0, s29, 0xc800
    s_nop 0
    buffer_load_dwordx4 v9, s[16:19], s32 offen lds
    v_mfma_f32_16x16x32_bf16 v[108:111], v[48:51], v[92:95], v[108:111]
    v_mfma_f32_16x16x32_bf16 v[112:115], v[48:51], v[96:99], v[112:115]
    ds_read_b64_tr_b16 v[40:41], v20 offset:256
    ds_read_b64_tr_b16 v[42:43], v20 offset:2560
    s_add_u32 m0, s29, 0xe800
    s_nop 0
    buffer_load_dwordx4 v10, s[16:19], s32 offen lds
    v_mfma_f32_16x16x32_bf16 v[116:119], v[52:55], v[92:95], v[116:119]
    v_mfma_f32_16x16x32_bf16 v[120:123], v[52:55], v[96:99], v[120:123]
    ds_read_b64_tr_b16 v[44:45], v20 offset:9376
    ds_read_b64_tr_b16 v[46:47], v20 offset:11680
    s_add_u32 m0, s30, 0x10800
    s_nop 0
    s_mov_b64 exec, 0xffff
    buffer_load_dwordx4 v11, s[16:19], s32 offen lds
    s_mov_b64 exec, -1
    s_add_u32 s32, s32, 0x12000
    v_mfma_f32_16x16x32_bf16 v[124:127], v[56:59], v[92:95], v[124:127]
    v_mfma_f32_16x16x32_bf16 v[128:131], v[56:59], v[96:99], v[128:131]
    ds_read_b64_tr_b16 v[48:49], v20 offset:9408
    s_waitcnt lgkmcnt(13)
    ds_read_b64_tr_b16 v[50:51], v20 offset:11712
    s_mov_b32 s40, 3
LP_rompt_kernel_63:
    s_waitcnt lgkmcnt(12)
    v_mfma_f32_16x16x32_bf16 v[100:103], v[28:31], v[68:71], v[100:103]
    v_mfma_f32_16x16x32_bf16 v[104:107], v[28:31], v[72:75], v[104:107]
    ds_read_b64_tr_b16 v[52:53], v20 offset:9440
    ds_read_b64_tr_b16 v[54:55], v20 offset:11744
    s_waitcnt lgkmcnt(12)
    v_mfma_f32_16x16x32_bf16 v[108:111], v[32:35], v[68:71], v[108:111]
    v_mfma_f32_16x16x32_bf16 v[112:115], v[32:35], v[72:75], v[112:115]
    ds_read_b64_tr_b16 v[56:57], v20 offset:9472
    ds_read_b64_tr_b16 v[58:59], v20 offset:11776
    s_waitcnt lgkmcnt(11)
    v_mfma_f32_16x16x32_bf16 v[116:119], v[36:39], v[68:71], v[116:119]
    v_mfma_f32_16x16x32_bf16 v[120:123], v[36:39], v[72:75], v[120:123]
    s_waitcnt vmcnt(10) lgkmcnt(0)
    s_barrier
    ds_read_b128 v[84:87], v21 offset:0
    ds_read_b128 v[88:91], v21 offset:256
    ds_read_b64_tr_b16 v[28:29], v23 offset:160
    ds_read_b64_tr_b16 v[30:31], v23 offset:2464
    s_add_u32 m0, s29, 0x11000
    s_nop 0
    buffer_load_dwordx4 v8, s[12:15], s31 offen lds
    v_mfma_f32_16x16x32_bf16 v[124:127], v[40:43], v[68:71], v[124:127]
    v_mfma_f32_16x16x32_bf16 v[128:131], v[40:43], v[72:75], v[128:131]
    ds_read_b64_tr_b16 v[32:33], v23 offset:192
    ds_read_b64_tr_b16 v[34:35], v23 offset:2496
    ds_read_b128 v[92:95], v22 offset:0
    s_add_u32 m0, s29, 0x13000
    s_add_u32 s33, s31, 0x90000
    buffer_load_dwordx4 v8, s[12:15], s33 offen lds
    s_add_u32 s31, s31, 4096
    v_mfma_f32_16x16x32_bf16 v[100:103], v[44:47], v[76:79], v[100:103]
    v_mfma_f32_16x16x32_bf16 v[104:107], v[44:47], v[80:83], v[104:107]
    ds_read_b64_tr_b16 v[36:37], v23 offset:224
    ds_read_b64_tr_b16 v[38:39], v23 offset:2528
    ds_read_b128 v[96:99], v22 offset:256
    s_add_u32 m0, s29, 0x15000
    s_nop 0
    buffer_load_dwordx4 v9, s[16:19], s32 offen lds
    v_mfma_f32_16x16x32_bf16 v[108:111], v[48:51], v[76:79], v[108:111]
    v_mfma_f32_16x16x32_bf16 v[112:115], v[48:51], v[80:83], v[112:115]
    ds_read_b64_tr_b16 v[40:41], v23 offset:256
    ds_read_b64_tr_b16 v[42:43], v23 offset:2560
    s_add_u32 m0, s29, 0x17000
    s_nop 0
    buffer_load_dwordx4 v10, s[16:19], s32 offen lds
    v_mfma_f32_16x16x32_bf16 v[116:119], v[52:55], v[76:79], v[116:119]
    v_mfma_f32_16x16x32_bf16 v[120:123], v[52:55], v[80:83], v[120:123]
    ds_read_b64_tr_b16 v[44:45], v23 offset:9376
    ds_read_b64_tr_b16 v[46:47], v23 offset:11680
    s_add_u32 m0, s30, 0x19000
    s_nop 0
    s_mov_b64 exec, 0xffff
    buffer_load_dwordx4 v11, s[16:19], s32 offen lds
    s_mov_b64 exec, -1
    s_add_u32 s32, s32, 0x12000
    v_mfma_f32_16x16x32_bf16 v[124:127], v[56:59], v[76:79], v[124:127]
    v_mfma_f32_16x16x32_bf16 v[128:131], v[56:59], v[80:83], v[128:131]
    ds_read_b64_tr_b16 v[48:49], v23 offset:9408
    s_waitcnt lgkmcnt(13)
    ds_read_b64_tr_b16 v[50:51], v23 offset:11712
    s_waitcnt lgkmcnt(12)
    v_mfma_f32_16x16x32_bf16 v[100:103], v[28:31], v[84:87], v[100:103]
    v_mfma_f32_16x16x32_bf16 v[104:107], v[28:31], v[88:91], v[104:107]
    ds_read_b64_tr_b16 v[52:53], v23 offset:9440
    ds_read_b64_tr_b16 v[54:55], v23 offset:11744
    s_waitcnt lgkmcnt(12)
    v_mfma_f32_16x16x32_bf16 v[108:111], v[32:35], v[84:87], v[108:111]
    v_mfma_f32_16x16x32_bf16 v[112:115], v[32:35], v[88:91], v[112:115]
    ds_read_b64_tr_b16 v[56:57], v23 offset:9472
    ds_read_b64_tr_b16 v[58:59], v23 offset:11776
    s_waitcnt lgkmcnt(11)
    v_mfma_f32_16x16x32_bf16 v[116:119], v[36:39], v[84:87], v[116:119]
    v_mfma_f32_16x16x32_bf16 v[120:123], v[36:39], v[88:91], v[120:123]
    s_waitcnt vmcnt(10) lgkmcnt(0)
    s_barrier
    ds_read_b128 v[68:71], v12 offset:0
    ds_read_b128 v[72:75], v12 offset:256
    ds_read_b64_tr_b16 v[28:29], v14 offset:160
    ds_read_b64_tr_b16 v[30:31], v14 offset:2464
    s_add_u32 m0, s29, 0x19800
    s_nop 0
    buffer_load_dwordx4 v8, s[12:15], s31 offen lds
    v_mfma_f32_16x16x32_bf16 v[124:127], v[40:43], v[84:87], v[124:127]
    v_mfma_f32_16x16x32_bf16 v[128:131], v[40:43], v[88:91], v[128:131]
    ds_read_b64_tr_b16 v[32:33], v14 offset:192
    ds_read_b64_tr_b16 v[34:35], v14 offset:2496
    ds_read_b128 v[76:79], v13 offset:0
    s_add_u32 m0, s29, 0x1b800
    s_add_u32 s33, s31, 0x90000
    buffer_load_dwordx4 v8, s[12:15], s33 offen lds
    s_add_u32 s31, s31, 4096
    v_mfma_f32_16x16x32_bf16 v[100:103], v[44:47], v[92:95], v[100:103]
    v_mfma_f32_16x16x32_bf16 v[104:107], v[44:47], v[96:99], v[104:107]
    ds_read_b64_tr_b16 v[36:37], v14 offset:224
    ds_read_b64_tr_b16 v[38:39], v14 offset:2528
    ds_read_b128 v[80:83], v13 offset:256
    s_add_u32 m0, s29, 0x1d800
    s_nop 0
    buffer_load_dwordx4 v9, s[16:19], s32 offen lds
    v_mfma_f32_16x16x32_bf16 v[108:111], v[48:51], v[92:95], v[108:111]
    v_mfma_f32_16x16x32_bf16 v[112:115], v[48:51], v[96:99], v[112:115]
    ds_read_b64_tr_b16 v[40:41], v14 offset:256
    ds_read_b64_tr_b16 v[42:43], v14 offset:2560
    s_add_u32 m0, s29, 0x1f800
    s_nop 0
    buffer_load_dwordx4 v10, s[16:19], s32 offen lds
    v_mfma_f32_16x16x32_bf16 v[116:119], v[52:55], v[92:95], v[116:119]
    v_mfma_f32_16x16x32_bf16 v[120:123], v[52:55], v[96:99], v[120:123]
    ds_read_b64_tr_b16 v[44:45], v14 offset:9376
    ds_read_b64_tr_b16 v[46:47], v14 offset:11680
    s_add_u32 m0, s30, 0x21800
    s_nop 0
    s_mov_b64 exec, 0xffff
    buffer_load_dwordx4 v11, s[16:19], s32 offen lds
    s_mov_b64 exec, -1
    s_add_u32 s32, s32, 0x12000
    v_mfma_f32_16x16x32_bf16 v[124:127], v[56:59], v[92:95], v[124:127]
    v_mfma_f32_16x16x32_bf16 v[128:131], v[56:59], v[96:99], v[128:131]
    ds_read_b64_tr_b16 v[48:49], v14 offset:9408
    s_waitcnt lgkmcnt(13)
    ds_read_b64_tr_b16 v[50:51], v14 offset:11712
    s_waitcnt lgkmcnt(12)
    v_mfma_f32_16x16x32_bf16 v[100:103], v[28:31], v[68:71], v[100:103]
    v_mfma_f32_16x16x32_bf16 v[104:107], v[28:31], v[72:75], v[104:107]
    ds_read_b64_tr_b16 v[52:53], v14 offset:9440
    ds_read_b64_tr_b16 v[54:55], v14 offset:11744
    s_waitcnt lgkmcnt(12)
    v_mfma_f32_16x16x32_bf16 v[108:111], v[32:35], v[68:71], v[108:111]
    v_mfma_f32_16x16x32_bf16 v[112:115], v[32:35], v[72:75], v[112:115]
    ds_read_b64_tr_b16 v[56:57], v14 offset:9472
    ds_read_b64_tr_b16 v[58:59], v14 offset:11776
    s_waitcnt lgkmcnt(11)
    v_mfma_f32_16x16x32_bf16 v[116:119], v[36:39], v[68:71], v[116:119]
    v_mfma_f32_16x16x32_bf16 v[120:123], v[36:39], v[72:75], v[120:123]
    s_waitcnt vmcnt(10) lgkmcnt(0)
    s_barrier
    ds_read_b128 v[84:87], v15 offset:0
    ds_read_b128 v[88:91], v15 offset:256
    ds_read_b64_tr_b16 v[28:29], v17 offset:160
    ds_read_b64_tr_b16 v[30:31], v17 offset:2464
    s_add_u32 m0, s29, 0x0
    s_nop 0
    buffer_load_dwordx4 v8, s[12:15], s31 offen lds
    v_mfma_f32_16x16x32_bf16 v[124:127], v[40:43], v[68:71], v[124:127]
    v_mfma_f32_16x16x32_bf16 v[128:131], v[40:43], v[72:75], v[128:131]
    ds_read_b64_tr_b16 v[32:33], v17 offset:192
    ds_read_b64_tr_b16 v[34:35], v17 offset:2496
    ds_read_b128 v[92:95], v16 offset:0
    s_add_u32 m0, s29, 0x2000
    s_add_u32 s33, s31, 0x90000
    buffer_load_dwordx4 v8, s[12:15], s33 offen lds
    s_add_u32 s31, s31, 4096
    v_mfma_f32_16x16x32_bf16 v[100:103], v[44:47], v[76:79], v[100:103]
    v_mfma_f32_16x16x32_bf16 v[104:107], v[44:47], v[80:83], v[104:107]
    ds_read_b64_tr_b16 v[36:37], v17 offset:224
    ds_read_b64_tr_b16 v[38:39], v17 offset:2528
    ds_read_b128 v[96:99], v16 offset:256
    s_add_u32 m0, s29, 0x4000
    s_nop 0
    buffer_load_dwordx4 v9, s[16:19], s32 offen lds
    v_mfma_f32_16x16x32_bf16 v[108:111], v[48:51], v[76:79], v[108:111]
    v_mfma_f32_16x16x32_bf16 v[112:115], v[48:51], v[80:83], v[112:115]
    ds_read_b64_tr_b16 v[40:41], v17 offset:256
    ds_read_b64_tr_b16 v[42:43], v17 offset:2560
    s_add_u32 m0, s29, 0x6000
    s_nop 0
    buffer_load_dwordx4 v10, s[16:19], s32 offen lds
    v_mfma_f32_16x16x32_bf16 v[116:119], v[52:55], v[76:79], v[116:119]
    v_mfma_f32_16x16x32_bf16 v[120:123], v[52:55], v[80:83], v[120:123]
    ds_read_b64_tr_b16 v[44:45], v17 offset:9376
    ds_read_b64_tr_b16 v[46:47], v17 offset:11680
    s_add_u32 m0, s30, 0x8000
    s_nop 0
    s_mov_b64 exec, 0xffff
    buffer_load_dwordx4 v11, s[16:19], s32 offen lds
    s_mov_b64 exec, -1
    s_add_u32 s32, s32, 0x12000
    v_mfma_f32_16x16x32_bf16 v[124:127], v[56:59], v[76:79], v[124:127]
    v_mfma_f32_16x16x32_bf16 v[128:131], v[56:59], v[80:83], v[128:131]
    ds_read_b64_tr_b16 v[48:49], v17 offset:9408
    s_waitcnt lgkmcnt(13)
    ds_read_b64_tr_b16 v[50:51], v17 offset:11712
    s_waitcnt lgkmcnt(12)
    v_mfma_f32_16x16x32_bf16 v[100:103], v[28:31], v[84:87], v[100:103]
    v_mfma_f32_16x16x32_bf16 v[104:107], v[28:31], v[88:91], v[104:107]
    ds_read_b64_tr_b16 v[52:53], v17 offset:9440
    ds_read_b64_tr_b16 v[54:55], v17 offset:11744
    s_waitcnt lgkmcnt(12)
    v_mfma_f32_16x16x32_bf16 v[108:111], v[32:35], v[84:87], v[108:111]
    v_mfma_f32_16x16x32_bf16 v[112:115], v[32:35], v[88:91], v[112:115]
    ds_read_b64_tr_b16 v[56:57], v17 offset:9472
    ds_read_b64_tr_b16 v[58:59], v17 offset:11776
    s_waitcnt lgkmcnt(11)
    v_mfma_f32_16x16x32_bf16 v[116:119], v[36:39], v[84:87], v[116:119]
    v_mfma_f32_16x16x32_bf16 v[120:123], v[36:39], v[88:91], v[120:123]
    s_waitcnt vmcnt(10) lgkmcnt(0)
    s_barrier
    ds_read_b128 v[68:71], v18 offset:0
    ds_read_b128 v[72:75], v18 offset:256
    ds_read_b64_tr_b16 v[28:29], v20 offset:160
    ds_read_b64_tr_b16 v[30:31], v20 offset:2464
    s_add_u32 m0, s29, 0x8800
    s_nop 0
    buffer_load_dwordx4 v8, s[12:15], s31 offen lds
    v_mfma_f32_16x16x32_bf16 v[124:127], v[40:43], v[84:87], v[124:127]
    v_mfma_f32_16x16x32_bf16 v[128:131], v[40:43], v[88:91], v[128:131]
    ds_read_b64_tr_b16 v[32:33], v20 offset:192
    ds_read_b64_tr_b16 v[34:35], v20 offset:2496
    ds_read_b128 v[76:79], v19 offset:0
    s_add_u32 m0, s29, 0xa800
    s_add_u32 s33, s31, 0x90000
    buffer_load_dwordx4 v8, s[12:15], s33 offen lds
    s_add_u32 s31, s31, 4096
    v_mfma_f32_16x16x32_bf16 v[100:103], v[44:47], v[92:95], v[100:103]
    v_mfma_f32_16x16x32_bf16 v[104:107], v[44:47], v[96:99], v[104:107]
    ds_read_b64_tr_b16 v[36:37], v20 offset:224
    ds_read_b64_tr_b16 v[38:39], v20 offset:2528
    ds_read_b128 v[80:83], v19 offset:256
    s_add_u32 m0, s29, 0xc800
    s_nop 0
    buffer_load_dwordx4 v9, s[16:19], s32 offen lds
    v_mfma_f32_16x16x32_bf16 v[108:111], v[48:51], v[92:95], v[108:111]
    v_mfma_f32_16x16x32_bf16 v[112:115], v[48:51], v[96:99], v[112:115]
    ds_read_b64_tr_b16 v[40:41], v20 offset:256
    ds_read_b64_tr_b16 v[42:43], v20 offset:2560
    s_add_u32 m0, s29, 0xe800
    s_nop 0
    buffer_load_dwordx4 v10, s[16:19], s32 offen lds
    v_mfma_f32_16x16x32_bf16 v[116:119], v[52:55], v[92:95], v[116:119]
    v_mfma_f32_16x16x32_bf16 v[120:123], v[52:55], v[96:99], v[120:123]
    ds_read_b64_tr_b16 v[44:45], v20 offset:9376
    ds_read_b64_tr_b16 v[46:47], v20 offset:11680
    s_add_u32 m0, s30, 0x10800
    s_nop 0
    s_mov_b64 exec, 0xffff
    buffer_load_dwordx4 v11, s[16:19], s32 offen lds
    s_mov_b64 exec, -1
    s_add_u32 s32, s32, 0x12000
    v_mfma_f32_16x16x32_bf16 v[124:127], v[56:59], v[92:95], v[124:127]
    v_mfma_f32_16x16x32_bf16 v[128:131], v[56:59], v[96:99], v[128:131]
    ds_read_b64_tr_b16 v[48:49], v20 offset:9408
    s_waitcnt lgkmcnt(13)
    ds_read_b64_tr_b16 v[50:51], v20 offset:11712
    s_sub_u32 s40, s40, 1
    s_cmp_lg_u32 s40, 0
    s_cbranch_scc1 LP_rompt_kernel_63
    s_waitcnt lgkmcnt(12)
    v_mfma_f32_16x16x32_bf16 v[100:103], v[28:31], v[68:71], v[100:103]
    v_mfma_f32_16x16x32_bf16 v[104:107], v[28:31], v[72:75], v[104:107]
    ds_read_b64_tr_b16 v[52:53], v20 offset:9440
    ds_read_b64_tr_b16 v[54:55], v20 offset:11744
    s_waitcnt lgkmcnt(12)
    v_mfma_f32_16x16x32_bf16 v[108:111], v[32:35], v[68:71], v[108:111]
    v_mfma_f32_16x16x32_bf16 v[112:115], v[32:35], v[72:75], v[112:115]
    ds_read_b64_tr_b16 v[56:57], v20 offset:9472
    ds_read_b64_tr_b16 v[58:59], v20 offset:11776
    s_waitcnt lgkmcnt(11)
    v_mfma_f32_16x16x32_bf16 v[116:119], v[36:39], v[68:71], v[116:119]
    v_mfma_f32_16x16x32_bf16 v[120:123], v[36:39], v[72:75], v[120:123]
    s_waitcnt vmcnt(10) lgkmcnt(0)
    s_barrier
    ds_read_b128 v[84:87], v21 offset:0
    ds_read_b128 v[88:91], v21 offset:256
    ds_read_b64_tr_b16 v[28:29], v23 offset:160
    ds_read_b64_tr_b16 v[30:31], v23 offset:2464
    v_mfma_f32_16x16x32_bf16 v[124:127], v[40:43], v[68:71], v[124:127]
    v_mfma_f32_16x16x32_bf16 v[128:131], v[40:43], v[72:75], v[128:131]
    ds_read_b64_tr_b16 v[32:33], v23 offset:192
    ds_read_b64_tr_b16 v[34:35], v23 offset:2496
    ds_read_b128 v[92:95], v22 offset:0
    v_mfma_f32_16x16x32_bf16 v[100:103], v[44:47], v[76:79], v[100:103]
    v_mfma_f32_16x16x32_bf16 v[104:107], v[44:47], v[80:83], v[104:107]
    ds_read_b64_tr_b16 v[36:37], v23 offset:224
    ds_read_b64_tr_b16 v[38:39], v23 offset:2528
    ds_read_b128 v[96:99], v22 offset:256
    v_mfma_f32_16x16x32_bf16 v[108:111], v[48:51], v[76:79], v[108:111]
    v_mfma_f32_16x16x32_bf16 v[112:115], v[48:51], v[80:83], v[112:115]
    ds_read_b64_tr_b16 v[40:41], v23 offset:256
    ds_read_b64_tr_b16 v[42:43], v23 offset:2560
    v_mfma_f32_16x16x32_bf16 v[116:119], v[52:55], v[76:79], v[116:119]
    v_mfma_f32_16x16x32_bf16 v[120:123], v[52:55], v[80:83], v[120:123]
    ds_read_b64_tr_b16 v[44:45], v23 offset:9376
    ds_read_b64_tr_b16 v[46:47], v23 offset:11680
    v_mfma_f32_16x16x32_bf16 v[124:127], v[56:59], v[76:79], v[124:127]
    v_mfma_f32_16x16x32_bf16 v[128:131], v[56:59], v[80:83], v[128:131]
    ds_read_b64_tr_b16 v[48:49], v23 offset:9408
    s_waitcnt lgkmcnt(13)
    ds_read_b64_tr_b16 v[50:51], v23 offset:11712
    s_waitcnt lgkmcnt(12)
    v_mfma_f32_16x16x32_bf16 v[100:103], v[28:31], v[84:87], v[100:103]
    v_mfma_f32_16x16x32_bf16 v[104:107], v[28:31], v[88:91], v[104:107]
    ds_read_b64_tr_b16 v[52:53], v23 offset:9440
    ds_read_b64_tr_b16 v[54:55], v23 offset:11744
    s_waitcnt lgkmcnt(12)
    v_mfma_f32_16x16x32_bf16 v[108:111], v[32:35], v[84:87], v[108:111]
    v_mfma_f32_16x16x32_bf16 v[112:115], v[32:35], v[88:91], v[112:115]
    ds_read_b64_tr_b16 v[56:57], v23 offset:9472
    ds_read_b64_tr_b16 v[58:59], v23 offset:11776
    s_waitcnt lgkmcnt(11)
    v_mfma_f32_16x16x32_bf16 v[116:119], v[36:39], v[84:87], v[116:119]
    v_mfma_f32_16x16x32_bf16 v[120:123], v[36:39], v[88:91], v[120:123]
    s_waitcnt vmcnt(5) lgkmcnt(0)
    s_barrier
    ds_read_b128 v[68:71], v12 offset:0
    ds_read_b128 v[72:75], v12 offset:256
    ds_read_b64_tr_b16 v[28:29], v14 offset:160
    ds_read_b64_tr_b16 v[30:31], v14 offset:2464
    v_mfma_f32_16x16x32_bf16 v[124:127], v[40:43], v[84:87], v[124:127]
    v_mfma_f32_16x16x32_bf16 v[128:131], v[40:43], v[88:91], v[128:131]
    ds_read_b64_tr_b16 v[32:33], v14 offset:192
    ds_read_b64_tr_b16 v[34:35], v14 offset:2496
    ds_read_b128 v[76:79], v13 offset:0
    v_mfma_f32_16x16x32_bf16 v[100:103], v[44:47], v[92:95], v[100:103]
    v_mfma_f32_16x16x32_bf16 v[104:107], v[44:47], v[96:99], v[104:107]
    ds_read_b64_tr_b16 v[36:37], v14 offset:224
    ds_read_b64_tr_b16 v[38:39], v14 offset:2528
    ds_read_b128 v[80:83], v13 offset:256
    v_mfma_f32_16x16x32_bf16 v[108:111], v[48:51], v[92:95], v[108:111]
    v_mfma_f32_16x16x32_bf16 v[112:115], v[48:51], v[96:99], v[112:115]
    ds_read_b64_tr_b16 v[40:41], v14 offset:256
    ds_read_b64_tr_b16 v[42:43], v14 offset:2560
    v_mfma_f32_16x16x32_bf16 v[116:119], v[52:55], v[92:95], v[116:119]
    v_mfma_f32_16x16x32_bf16 v[120:123], v[52:55], v[96:99], v[120:123]
    ds_read_b64_tr_b16 v[44:45], v14 offset:9376
    ds_read_b64_tr_b16 v[46:47], v14 offset:11680
    v_mfma_f32_16x16x32_bf16 v[124:127], v[56:59], v[92:95], v[124:127]
    v_mfma_f32_16x16x32_bf16 v[128:131], v[56:59], v[96:99], v[128:131]
    ds_read_b64_tr_b16 v[48:49], v14 offset:9408
    s_waitcnt lgkmcnt(13)
    ds_read_b64_tr_b16 v[50:51], v14 offset:11712
    s_waitcnt lgkmcnt(12)
    v_mfma_f32_16x16x32_bf16 v[100:103], v[28:31], v[68:71], v[100:103]
    v_mfma_f32_16x16x32_bf16 v[104:107], v[28:31], v[72:75], v[104:107]
    ds_read_b64_tr_b16 v[52:53], v14 offset:9440
    ds_read_b64_tr_b16 v[54:55], v14 offset:11744
    s_waitcnt lgkmcnt(12)
    v_mfma_f32_16x16x32_bf16 v[108:111], v[32:35], v[68:71], v[108:111]
    v_mfma_f32_16x16x32_bf16 v[112:115], v[32:35], v[72:75], v[112:115]
    ds_read_b64_tr_b16 v[56:57], v14 offset:9472
    ds_read_b64_tr_b16 v[58:59], v14 offset:11776
    s_waitcnt lgkmcnt(11)
    v_mfma_f32_16x16x32_bf16 v[116:119], v[36:39], v[68:71], v[116:119]
    v_mfma_f32_16x16x32_bf16 v[120:123], v[36:39], v[72:75], v[120:123]
    s_waitcnt vmcnt(0) lgkmcnt(0)
    s_barrier
    ds_read_b128 v[84:87], v15 offset:0
    ds_read_b128 v[88:91], v15 offset:256
    ds_read_b64_tr_b16 v[28:29], v17 offset:160
    ds_read_b64_tr_b16 v[30:31], v17 offset:2464
    v_mfma_f32_16x16x32_bf16 v[124:127], v[40:43], v[68:71], v[124:127]
    v_mfma_f32_16x16x32_bf16 v[128:131], v[40:43], v[72:75], v[128:131]
    ds_read_b64_tr_b16 v[32:33], v17 offset:192
    ds_read_b64_tr_b16 v[34:35], v17 offset:2496
    ds_read_b128 v[92:95], v16 offset:0
    v_mfma_f32_16x16x32_bf16 v[100:103], v[44:47], v[76:79], v[100:103]
    v_mfma_f32_16x16x32_bf16 v[104:107], v[44:47], v[80:83], v[104:107]
    ds_read_b64_tr_b16 v[36:37], v17 offset:224
    ds_read_b64_tr_b16 v[38:39], v17 offset:2528
    ds_read_b128 v[96:99], v16 offset:256
    v_mfma_f32_16x16x32_bf16 v[108:111], v[48:51], v[76:79], v[108:111]
    v_mfma_f32_16x16x32_bf16 v[112:115], v[48:51], v[80:83], v[112:115]
    ds_read_b64_tr_b16 v[40:41], v17 offset:256
    ds_read_b64_tr_b16 v[42:43], v17 offset:2560
    v_mfma_f32_16x16x32_bf16 v[116:119], v[52:55], v[76:79], v[116:119]
    v_mfma_f32_16x16x32_bf16 v[120:123], v[52:55], v[80:83], v[120:123]
    ds_read_b64_tr_b16 v[44:45], v17 offset:9376
    ds_read_b64_tr_b16 v[46:47], v17 offset:11680
    v_mfma_f32_16x16x32_bf16 v[124:127], v[56:59], v[76:79], v[124:127]
    v_mfma_f32_16x16x32_bf16 v[128:131], v[56:59], v[80:83], v[128:131]
    ds_read_b64_tr_b16 v[48:49], v17 offset:9408
    s_waitcnt lgkmcnt(13)
    ds_read_b64_tr_b16 v[50:51], v17 offset:11712
    s_waitcnt lgkmcnt(12)
    v_mfma_f32_16x16x32_bf16 v[100:103], v[28:31], v[84:87], v[100:103]
    v_mfma_f32_16x16x32_bf16 v[104:107], v[28:31], v[88:91], v[104:107]
    ds_read_b64_tr_b16 v[52:53], v17 offset:9440
    ds_read_b64_tr_b16 v[54:55], v17 offset:11744
    s_waitcnt lgkmcnt(12)
    v_mfma_f32_16x16x32_bf16 v[108:111], v[32:35], v[84:87], v[108:111]
    v_mfma_f32_16x16x32_bf16 v[112:115], v[32:35], v[88:91], v[112:115]
    ds_read_b64_tr_b16 v[56:57], v17 offset:9472
    ds_read_b64_tr_b16 v[58:59], v17 offset:11776
    s_waitcnt lgkmcnt(11)
    v_mfma_f32_16x16x32_bf16 v[116:119], v[36:39], v[84:87], v[116:119]
    v_mfma_f32_16x16x32_bf16 v[120:123], v[36:39], v[88:91], v[120:123]
    s_waitcnt lgkmcnt(8)
    v_mfma_f32_16x16x32_bf16 v[124:127], v[40:43], v[84:87], v[124:127]
    v_mfma_f32_16x16x32_bf16 v[128:131], v[40:43], v[88:91], v[128:131]
    s_waitcnt lgkmcnt(6)
    v_mfma_f32_16x16x32_bf16 v[100:103], v[44:47], v[92:95], v[100:103]
    v_mfma_f32_16x16x32_bf16 v[104:107], v[44:47], v[96:99], v[104:107]
    s_waitcnt lgkmcnt(4)
    v_mfma_f32_16x16x32_bf16 v[108:111], v[48:51], v[92:95], v[108:111]
    v_mfma_f32_16x16x32_bf16 v[112:115], v[48:51], v[96:99], v[112:115]
    s_waitcnt lgkmcnt(2)
    v_mfma_f32_16x16x32_bf16 v[116:119], v[52:55], v[92:95], v[116:119]
    v_mfma_f32_16x16x32_bf16 v[120:123], v[52:55], v[96:99], v[120:123]
    s_waitcnt lgkmcnt(0)
    v_mfma_f32_16x16x32_bf16 v[124:127], v[56:59], v[92:95], v[124:127]
    v_mfma_f32_16x16x32_bf16 v[128:131], v[56:59], v[96:99], v[128:131]
    s_nop 7
    s_nop 3
    v_add_u32 v100, 0x10000, v100
    v_and_b32 v100, 0xfffe0000, v100
    v_cvt_pk_bf16_f32 v28, v100, v101
    v_cvt_pk_bf16_f32 v29, v102, v103
    v_and_b32 v28, -2, v28
    v_add_u32 v104, 0x10000, v104
    v_and_b32 v104, 0xfffe0000, v104
    v_cvt_pk_bf16_f32 v30, v104, v105
    v_cvt_pk_bf16_f32 v31, v106, v107
    v_and_b32 v30, -2, v30
    s_mov_b32 s33, 5120
    s_nop 0
    v_permlane16_swap_b32 v28, v30
    v_permlane16_swap_b32 v29, v31
    s_nop 0
    buffer_store_dwordx4 v[28:31], v7, s[24:27], s33 offen offset:0 sc0 sc1
    v_add_u32 v108, 0x10000, v108
    v_and_b32 v108, 0xfffe0000, v108
    v_cvt_pk_bf16_f32 v32, v108, v109
    v_cvt_pk_bf16_f32 v33, v110, v111
    v_and_b32 v32, -2, v32
    v_add_u32 v112, 0x10000, v112
    v_and_b32 v112, 0xfffe0000, v112
    v_cvt_pk_bf16_f32 v34, v112, v113
    v_cvt_pk_bf16_f32 v35, v114, v115
    v_and_b32 v34, -2, v34
    s_nop 0
    s_nop 0
    v_permlane16_swap_b32 v32, v34
    v_permlane16_swap_b32 v33, v35
    s_nop 0
    buffer_store_dwordx4 v[32:35], v7, s[24:27], s33 offen offset:1024 sc0 sc1
    v_add_u32 v116, 0x10000, v116
    v_and_b32 v116, 0xfffe0000, v116
    v_cvt_pk_bf16_f32 v36, v116, v117
    v_cvt_pk_bf16_f32 v37, v118, v119
    v_and_b32 v36, -2, v36
    v_add_u32 v120, 0x10000, v120
    v_and_b32 v120, 0xfffe0000, v120
    v_cvt_pk_bf16_f32 v38, v120, v121
    v_cvt_pk_bf16_f32 v39, v122, v123
    v_and_b32 v38, -2, v38
    s_nop 0
    s_nop 0
    v_permlane16_swap_b32 v36, v38
    v_permlane16_swap_b32 v37, v39
    s_nop 0
    buffer_store_dwordx4 v[36:39], v7, s[24:27], s33 offen offset:2048 sc0 sc1
    v_add_u32 v124, 0x10000, v124
    v_and_b32 v124, 0xfffe0000, v124
    v_cvt_pk_bf16_f32 v40, v124, v125
    v_cvt_pk_bf16_f32 v41, v126, v127
    v_and_b32 v40, -2, v40
    v_add_u32 v128, 0x10000, v128
    v_and_b32 v128, 0xfffe0000, v128
    v_cvt_pk_bf16_f32 v42, v128, v129
    v_cvt_pk_bf16_f32 v43, v130, v131
    v_and_b32 v42, -2, v42
    s_nop 0
    s_nop 0
    v_permlane16_swap_b32 v40, v42
    v_permlane16_swap_b32 v41, v43
    s_nop 0
    buffer_store_dwordx4 v[40:43], v7, s[24:27], s33 offen offset:3072 sc0 sc1
LJ_rompt_kernel_60:
    s_lshl_b32 s39, s36, 2
    s_add_u32 s39, s39, s38
    s_add_u32 s12, s4, 0x2800000
    s_addc_u32 s13, s5, 0
    s_mov_b32 s14, 0x240000
    s_and_b32 s13, s13, 0xffff
    s_mov_b32 s15, 0x20000
    s_lshr_b32 s46, s39, 2
    s_lshl_b32 s47, s37, 2
    s_add_u32 s46, s46, s47
    s_mul_i32 s46, s46, 36864
    s_add_u32 s20, s4, 0x1400000
    s_addc_u32 s21, s5, 0
    s_add_u32 s20, s20, s46
    s_addc_u32 s21, s21, 0
    s_sub_u32 s22, 0x900000, s46
    s_and_b32 s21, s21, 0xffff
    s_mov_b32 s23, 0x20000
    s_add_u32 s24, s50, 0x0
    s_addc_u32 s25, s51, 0
    s_mov_b32 s26, 0x240000
    s_and_b32 s25, s25, 0xffff
    s_mov_b32 s27, 0x20000
    s_lshl_b32 s46, s37, 7
    s_lshl_b32 s47, s39, 3
    s_add_u32 s46, s46, s47
    s_add_u32 s46, s46, s28
    v_mov_b32 v2, s46
    v_mul_u32_u24 v4, 1152, v2
    v_lshl_add_u32 v7, v1, 3, v4
    v_lshl_add_u32 v8, v1, 1, v4
    buffer_load_dwordx2 v[10:11], v7, s[12:15], 0 offen
    buffer_load_dwordx2 v[12:13], v7, s[12:15], 0 offen offset:512
    buffer_load_ushort v14, v8, s[12:15], 0 offen offset:1024
    s_lshr_b32 s46, s39, 1
    s_and_b32 s46, s46, 1
    s_lshl_b32 s46, s46, 8
    s_and_b32 s47, s39, 1
    s_lshl_b32 s47, s47, 7
    s_add_u32 s46, s46, s47
    s_mul_i32 s47, s28, 64
    s_add_u32 s47, s47, 0
    v_add_u32 v3, s47, v1
    v_lshrrev_b32 v5, 4, v3
    v_lshlrev_b32 v5, 10, v5
    v_bfe_u32 v6, v3, 3, 1
    v_lshl_add_u32 v5, v6, 9, v5
    v_and_b32 v6, 7, v3
    v_lshl_add_u32 v5, v6, 4, v5
    v_add_u32 v40, s46, v5
    v_mul_u32_u24 v5, 2336, v6
    v_lshrrev_b32 v6, 3, v3
    v_lshl_add_u32 v5, v6, 5, v5
    v_add_u32 v42, 0x22000, v5
    s_mul_i32 s47, s28, 8
    s_add_u32 s47, s47, 512
    v_add_u32 v3, s47, v1
    v_lshrrev_b32 v5, 4, v3
    v_lshlrev_b32 v5, 10, v5
    v_bfe_u32 v6, v3, 3, 1
    v_lshl_add_u32 v5, v6, 9, v5
    v_and_b32 v6, 7, v3
    v_lshl_add_u32 v5, v6, 4, v5
    v_add_u32 v41, s46, v5
    v_mul_u32_u24 v5, 2336, v6
    v_lshrrev_b32 v6, 3, v3
    v_lshl_add_u32 v5, v6, 5, v5
    v_add_u32 v43, 0x22000, v5
    v_mov_b32 v48, 0
    v_mov_b32 v49, 0
    v_mov_b32 v50, 0
    v_mov_b32 v51, 0
    v_mov_b32 v56, 0
    v_mov_b32 v57, 0
    v_mov_b32 v58, 0
    v_mov_b32 v59, 0
    v_mov_b32 v64, 0
    v_mov_b32 v65, 0
    v_mov_b32 v66, 0
    v_mov_b32 v67, 0
    v_mov_b32 v72, 0
    v_mov_b32 v73, 0
    v_mov_b32 v74, 0
    v_mov_b32 v75, 0
    s_mov_b32 s45, 0
LW_rompt_kernel_64:
    s_mov_b32 s47, 0x0
    buffer_load_dwordx4 v[44:47], v40, s[20:23], s47 offen sc0 sc1
    s_mov_b64 exec, 0xff
    buffer_load_dwordx4 v[48:51], v41, s[20:23], s47 offen sc0 sc1
    s_mov_b64 exec, -1
    s_mov_b32 s47, 0x240000
    buffer_load_dwordx4 v[52:55], v40, s[20:23], s47 offen sc0 sc1
    s_mov_b64 exec, 0xff
    buffer_load_dwordx4 v[56:59], v41, s[20:23], s47 offen sc0 sc1
    s_mov_b64 exec, -1
    s_mov_b32 s47, 0x480000
    buffer_load_dwordx4 v[60:63], v40, s[20:23], s47 offen sc0 sc1
    s_mov_b64 exec, 0xff
    buffer_load_dwordx4 v[64:67], v41, s[20:23], s47 offen sc0 sc1
    s_mov_b64 exec, -1
    s_mov_b32 s47, 0x6c0000
    buffer_load_dwordx4 v[68:71], v40, s[20:23], s47 offen sc0 sc1
    s_mov_b64 exec, 0xff
    buffer_load_dwordx4 v[72:75], v41, s[20:23], s47 offen sc0 sc1
    s_mov_b64 exec, -1
    s_waitcnt vmcnt(0)
    v_or_b32 v26, v44, v46
    v_or_b32 v27, v48, v50
    v_or3_b32 v26, v26, v52, v54
    v_or3_b32 v27, v27, v56, v58
    v_or3_b32 v26, v26, v60, v62
    v_or3_b32 v27, v27, v64, v66
    v_or3_b32 v26, v26, v68, v70
    v_or3_b32 v27, v27, v72, v74
    v_or_b32 v26, v26, v27
    v_and_b32 v26, 1, v26
    v_cmp_ne_u32 vcc, 0, v26
    s_nop 3
    s_cmp_eq_u64 vcc, 0
    s_cbranch_scc1 LD_rompt_kernel_65
    s_add_u32 s45, s45, 1
    s_cmp_lt_u32 s45, 0x100000
    s_cbranch_scc1 LW_rompt_kernel_64
LD_rompt_kernel_65:
    v_lshlrev_b32 v76, 16, v44
    v_and_b32 v77, 0xffff0000, v44
    v_lshlrev_b32 v78, 16, v45
    v_and_b32 v79, 0xffff0000, v45
    v_lshlrev_b32 v80, 16, v46
    v_and_b32 v81, 0xffff0000, v46
    v_lshlrev_b32 v82, 16, v47
    v_and_b32 v83, 0xffff0000, v47
    v_lshlrev_b32 v84, 16, v48
    v_and_b32 v85, 0xffff0000, v48
    v_lshlrev_b32 v86, 16, v49
    v_and_b32 v87, 0xffff0000, v49
    v_lshlrev_b32 v88, 16, v50
    v_and_b32 v89, 0xffff0000, v50
    v_lshlrev_b32 v90, 16, v51
    v_and_b32 v91, 0xffff0000, v51
    v_lshlrev_b32 v26, 16, v52
    v_and_b32 v27, 0xffff0000, v52
    v_add_f32 v76, v76, v26
    v_add_f32 v77, v77, v27
    v_lshlrev_b32 v26, 16, v53
    v_and_b32 v27, 0xffff0000, v53
    v_add_f32 v78, v78, v26
    v_add_f32 v79, v79, v27
    v_lshlrev_b32 v26, 16, v54
    v_and_b32 v27, 0xffff0000, v54
    v_add_f32 v80, v80, v26
    v_add_f32 v81, v81, v27
    v_lshlrev_b32 v26, 16, v55
    v_and_b32 v27, 0xffff0000, v55
    v_add_f32 v82, v82, v26
    v_add_f32 v83, v83, v27
    v_lshlrev_b32 v26, 16, v56
    v_and_b32 v27, 0xffff0000, v56
    v_add_f32 v84, v84, v26
    v_add_f32 v85, v85, v27
    v_lshlrev_b32 v26, 16, v57
    v_and_b32 v27, 0xffff0000, v57
    v_add_f32 v86, v86, v26
    v_add_f32 v87, v87, v27
    v_lshlrev_b32 v26, 16, v58
    v_and_b32 v27, 0xffff0000, v58
    v_add_f32 v88, v88, v26
    v_add_f32 v89, v89, v27
    v_lshlrev_b32 v26, 16, v59
    v_and_b32 v27, 0xffff0000, v59
    v_add_f32 v90, v90, v26
    v_add_f32 v91, v91, v27
    v_lshlrev_b32 v26, 16, v60
    v_and_b32 v27, 0xffff0000, v60
    v_add_f32 v76, v76, v26
    v_add_f32 v77, v77, v27
    v_lshlrev_b32 v26, 16, v61
    v_and_b32 v27, 0xffff0000, v61
    v_add_f32 v78, v78, v26
    v_add_f32 v79, v79, v27
    v_lshlrev_b32 v26, 16, v62
    v_and_b32 v27, 0xffff0000, v62
    v_add_f32 v80, v80, v26
    v_add_f32 v81, v81, v27
    v_lshlrev_b32 v26, 16, v63
    v_and_b32 v27, 0xffff0000, v63
    v_add_f32 v82, v82, v26
    v_add_f32 v83, v83, v27
    v_lshlrev_b32 v26, 16, v64
    v_and_b32 v27, 0xffff0000, v64
    v_add_f32 v84, v84, v26
    v_add_f32 v85, v85, v27
    v_lshlrev_b32 v26, 16, v65
    v_and_b32 v27, 0xffff0000, v65
    v_add_f32 v86, v86, v26
    v_add_f32 v87, v87, v27
    v_lshlrev_b32 v26, 16, v66
    v_and_b32 v27, 0xffff0000, v66
    v_add_f32 v88, v88, v26
    v_add_f32 v89, v89, v27
    v_lshlrev_b32 v26, 16, v67
    v_and_b32 v27, 0xffff0000, v67
    v_add_f32 v90, v90, v26
    v_add_f32 v91, v91, v27
    v_lshlrev_b32 v26, 16, v68
    v_and_b32 v27, 0xffff0000, v68
    v_add_f32 v76, v76, v26
    v_add_f32 v77, v77, v27
    v_lshlrev_b32 v26, 16, v69
    v_and_b32 v27, 0xffff0000, v69
    v_add_f32 v78, v78, v26
    v_add_f32 v79, v79, v27
    v_lshlrev_b32 v26, 16, v70
    v_and_b32 v27, 0xffff0000, v70
    v_add_f32 v80, v80, v26
    v_add_f32 v81, v81, v27
    v_lshlrev_b32 v26, 16, v71
    v_and_b32 v27, 0xffff0000, v71
    v_add_f32 v82, v82, v26
    v_add_f32 v83, v83, v27
    v_lshlrev_b32 v26, 16, v72
    v_and_b32 v27, 0xffff0000, v72
    v_add_f32 v84, v84, v26
    v_add_f32 v85, v85, v27
    v_lshlrev_b32 v26, 16, v73
    v_and_b32 v27, 0xffff0000, v73
    v_add_f32 v86, v86, v26
    v_add_f32 v87, v87, v27
    v_lshlrev_b32 v26, 16, v74
    v_and_b32 v27, 0xffff0000, v74
    v_add_f32 v88, v88, v26
    v_add_f32 v89, v89, v27
    v_lshlrev_b32 v26, 16, v75
    v_and_b32 v27, 0xffff0000, v75
    v_add_f32 v90, v90, v26
    v_add_f32 v91, v91, v27
    ds_write_b128 v42, v[76:79]
    ds_write_b128 v42, v[80:83] offset:16
    s_mov_b64 exec, 0xff
    ds_write_b128 v43, v[84:87]
    ds_write_b128 v43, v[88:91] offset:16
    s_mov_b64 exec, -1
    s_mul_i32 s47, s28, 2336
    s_add_u32 s47, s47, 0x22000
    v_lshl_add_u32 v5, v1, 4, s47
    v_lshl_add_u32 v6, v1, 2, s47
    s_waitcnt lgkmcnt(0)
    s_barrier
    ds_read_b128 v[16:19], v5
    ds_read_b128 v[20:23], v5 offset:1024
    ds_read_b32 v24, v6 offset:2048
    s_waitcnt lgkmcnt(0)
    v_lshlrev_b32 v30, 16, v10
    v_and_b32 v31, 0xffff0000, v10
    v_lshlrev_b32 v32, 16, v11
    v_and_b32 v33, 0xffff0000, v11
    v_lshlrev_b32 v34, 16, v12
    v_and_b32 v35, 0xffff0000, v12
    v_lshlrev_b32 v36, 16, v13
    v_and_b32 v37, 0xffff0000, v13
    v_lshlrev_b32 v38, 16, v14
    v_add_f32 v30, v30, v16
    v_add_f32 v31, v31, v17
    v_add_f32 v32, v32, v18
    v_add_f32 v33, v33, v19
    v_add_f32 v34, v34, v20
    v_add_f32 v35, v35, v21
    v_add_f32 v36, v36, v22
    v_add_f32 v37, v37, v23
    v_add_f32 v38, v38, v24
    v_cvt_pk_bf16_f32 v10, v30, v31
    v_cvt_pk_bf16_f32 v11, v32, v33
    v_cvt_pk_bf16_f32 v12, v34, v35
    v_cvt_pk_bf16_f32 v13, v36, v37
    v_cvt_pk_bf16_f32 v14, v38, v38
    buffer_store_dwordx2 v[10:11], v7, s[24:27], 0 offen sc0 sc1
    buffer_store_dwordx2 v[12:13], v7, s[24:27], 0 offen offset:512 sc0 sc1
    buffer_store_short v14, v8, s[24:27], 0 offen offset:1024 sc0 sc1
L_end_interleave_layers__spectral_fnet__glu_gated_glu__prompt_kernel:
    s_endpgm
.section .rodata,"a"
.p2align 6
.amdhsa_kernel interleave_layers__spectral_fnet__glu_gated_glu__prompt_kernel
  .amdhsa_next_free_vgpr 254
  .amdhsa_next_free_sgpr 102
  .amdhsa_accum_offset 256
  .amdhsa_group_segment_fixed_size 0
  .amdhsa_kernarg_size 96
  .amdhsa_user_sgpr_count 2
  .amdhsa_user_sgpr_kernarg_segment_ptr 1
  .amdhsa_system_sgpr_workgroup_id_x 1
.end_amdhsa_kernel
.text
```
